```python
import torch

def _softmax(x, axis=-1):
    return torch.softmax(x, dim=axis)
def _gelu(x):
    return torch.nn.functional.gelu(x, approximate="tanh")
def _silu(x):
    return torch.nn.functional.silu(x)
def _sigmoid(x):
    return torch.sigmoid(x)
def _layernorm(x, axis=-1, eps=1e-5):
    m = x.mean(dim=axis, keepdim=True)
    v = x.var(dim=axis, keepdim=True, unbiased=False)
    return (x - m) / torch.sqrt(v + eps)
def _scatter_add(tgt, idx, src, axis=0):
    return tgt.clone().index_add_(axis, idx, src)
def _segment_sum(src, seg, n):
    out = torch.zeros((n,) + src.shape[1:], dtype=src.dtype)
    return out.index_add_(0, seg, src)
def _pad(x, pw):
    flat = tuple(v for pair in reversed(pw) for v in pair)
    return torch.nn.functional.pad(x, flat)

kernel_name = 'standalone__edge_featured_mpnn_gatedgcn__graph'

def setup_inputs():

    _w = (lambda a: (lambda t: t.to(torch.bfloat16) if t.is_floating_point() else t)(torch.as_tensor(a)))
    N, deg, D, De = 50000, 16, 64, max(16, 1)
    E = N * deg
    return {
        "x": _w((lambda *s: torch.randn(*s, dtype=torch.bfloat16) * 0.4)(N, D)),
        "e_attr": _w((lambda *s: torch.randn(*s, dtype=torch.bfloat16) * 0.8)(E, De)),
        "src": _w((lambda lo, hi, *s: torch.randint(lo, hi, s))(0, N, E).to(torch.int64)),
        "dst": _w((lambda lo, hi, *s: torch.randint(lo, hi, s))(0, N, E).to(torch.int64)),
        "w_a": _w((lambda *s: torch.randn(*s, dtype=torch.bfloat16) * 0.8)(D, D)),
        "w_b": _w((lambda *s: torch.randn(*s, dtype=torch.bfloat16) * 0.4)(D, D)),
        "w_c": _w((lambda *s: torch.randn(*s, dtype=torch.bfloat16) * 0.8)(De, D)),
        "w_u": _w((lambda *s: torch.randn(*s, dtype=torch.bfloat16) * 0.05)(D, D)),
        "w_v": _w((lambda *s: torch.randn(*s, dtype=torch.bfloat16) * 0.05)(D, D)),
    }

def reference(x, e_attr, src, dst, w_a, w_b, w_c, w_u, w_v):
    N, D = x.shape
    hv = x @ w_v
    g = x[dst] @ w_a + x[src] @ w_b + e_attr @ w_c
    eta = _sigmoid(g)
    denom = _segment_sum(eta, dst, N) + 1e-6
    eta_n = eta / denom[dst]
    agg = _segment_sum(eta_n * hv[src], dst, N)
    z = x @ w_u + agg
    relu_z = torch.where(z > 0, z, 0 * z)
    return x + relu_z
```

```asm
; @launch grid=(256,1,1) block=(512,1,1) lds=157696
.amdgcn_target "amdgcn-amd-amdhsa--gfx950"
.text
.globl standalone__edge_featured_mpnn_gatedgcn__graph_kernel
.p2align 8
.type standalone__edge_featured_mpnn_gatedgcn__graph_kernel,@function
standalone__edge_featured_mpnn_gatedgcn__graph_kernel:
    s_cmp_ge_u32 s2, 256
    s_cbranch_scc1 K2_END
    s_load_dwordx4 s[44:47], s[0:1], 16
    s_load_dwordx2 s[8:9], s[0:1], 88
    s_load_dwordx4 s[40:43], s[0:1], 0
    s_load_dwordx8 s[48:55], s[0:1], 32
    s_load_dwordx4 s[56:59], s[0:1], 64
    s_getpc_b64 s[86:87]
K2_PC:
    v_lshlrev_b32 v252, 7, v0
    v_min_u32 v252, K2_LAST-K2_PC, v252
    v_cmp_gt_u32 vcc, 192, v0
    s_cbranch_vccz K2_NOCPF
    global_load_dword v253, v252, s[86:87]
K2_NOCPF:
    v_mov_b32 v255, v0
    v_lshrrev_b32 v188, 6, v0
    v_and_b32 v254, 63, v0
    v_readfirstlane_b32 s7, v188
    s_and_b32 s10, s2, 7
    s_lshr_b32 s11, s2, 3
    s_lshl_b32 s10, s10, 5
    s_add_u32 s12, s10, s11
    s_mul_i32 s13, s12, 12500
    v_lshlrev_b32 v189, 4, v0
    v_lshlrev_b32 v1, 3, v0
    v_lshlrev_b32 v2, 2, v0
    v_mov_b32 v3, 0
    v_and_b32 v4, 0x3fc, v2
    ds_write_b32 v4, v3 offset:6400
    s_and_b32 s10, s7, 3
    s_lshr_b32 s3, s7, 2
    s_lshl1_add_u32 s3, s10, s3
    s_xor_b32 s3, s3, 1
    s_movk_i32 s14, 8192
    s_movk_i32 s15, 12288
    s_waitcnt lgkmcnt(0)
    s_add_u32 s64, s46, s13
    s_addc_u32 s65, s47, 0
    s_mov_b32 s66, 12500
    s_mov_b32 s67, 0x20000
    s_add_u32 s68, s44, s13
    s_addc_u32 s69, s45, 0
    s_mov_b32 s70, 12500
    s_mov_b32 s71, 0x20000
    buffer_load_dwordx4 v[8:11], v189, s[64:67], 0 offen nt
    buffer_load_dwordx2 v[12:13], v1, s[64:67], s14 offen nt
    buffer_load_dword v14, v2, s[64:67], s15 offen nt
    s_barrier
    buffer_load_dwordx4 v[16:19], v189, s[68:71], 0 offen nt
    buffer_load_dwordx2 v[20:21], v1, s[68:71], s14 offen nt
    buffer_load_dword v22, v2, s[68:71], s15 offen nt
    s_add_u32 s10, s8, 24117248
    s_addc_u32 s11, s9, 0
    s_load_dword s100, s[10:11], 0
    v_lshrrev_b32 v1, 3, v0
    v_lshlrev_b32 v170, 2, v1
    v_and_b32 v197, 7, v0
    v_and_b32 v5, 16, v0
    v_lshlrev_b32 v5, 1, v5
    v_xor_b32 v5, v5, v189
    v_lshlrev_b32 v172, 4, v254
    v_and_b32 v241, 16, v254
    v_lshlrev_b32 v241, 2, v241
    v_xor_b32 v234, v241, v172
    v_and_b32 v241, 0x70, v234
    s_mov_b32 s16, s40
    s_mov_b32 s17, s41
    s_mov_b32 s18, 6400000
    s_mov_b32 s19, 0x20000
    s_mov_b32 s60, 85599
    s_mov_b32 s61, 4294967100
    s_movk_i32 s62, 2000
    v_mov_b32 v7, 87382
    s_mov_b32 s10, 0
    v_lshl_add_u32 v56, v254, 10, s10
    v_add_u32 v57, 256, v56
    v_add_u32 v58, 512, v56
    v_add_u32 v59, 768, v56
    v_and_b32 v60, 127, v255
    v_lshl_add_u32 v60, v60, 9, s10
    v_add_u32 v61, 256, v60
    v_lshl_add_u32 v62, v254, 8, s10
    v_lshrrev_b32 v23, 6, v255
    v_lshrrev_b32 v31, 7, v255
    v_add_u32 v31, 8, v31
    v_mov_b32 v39, 12
    v_cmp_gt_u32 s[78:79], 53, v255
    s_mov_b32 s11, 32896
    v_lshlrev_b32 v3, 4, v197
    v_mad_u32_u24 v4, v1, s11, v3
    v_mul_u32_u24 v6, 52, v1
    v_lshl_add_u32 v6, v197, 2, v6
    v_lshlrev_b32 v3, 2, v6
    v_add_u32 v3, 104448, v3
    v_add_u32 v6, 91136, v6
    v_mov_b32 v214, 0xf0f0f0
    v_mov_b32 v15, 0x0f0f0f
    s_waitcnt vmcnt(3)
    v_mul_u32_u24 v48, s60, v8
    v_mul_u32_u24 v49, s60, v9
    v_mul_u32_u24 v50, s60, v10
    v_mul_u32_u24 v51, s60, v11
    v_mul_u32_u24 v52, s60, v12
    v_mul_u32_u24 v53, s60, v13
    v_lshrrev_b32 v48, 24, v48
    v_lshrrev_b32 v49, 24, v49
    v_lshrrev_b32 v50, 24, v50
    v_lshrrev_b32 v51, 24, v51
    v_lshrrev_b32 v52, 24, v52
    v_lshrrev_b32 v53, 24, v53
    v_lshl_add_u32 v24, v48, 2, s62
    ds_add_rtn_u32 v32, v24, v7 offset:4400
    v_lshl_add_u32 v25, v49, 2, s62
    ds_add_rtn_u32 v33, v25, v7 offset:4400
    v_lshl_add_u32 v26, v50, 2, s62
    ds_add_rtn_u32 v34, v26, v7 offset:4400
    v_lshl_add_u32 v27, v51, 2, s62
    ds_add_rtn_u32 v35, v27, v7 offset:4400
    v_lshl_add_u32 v28, v52, 2, s62
    ds_add_rtn_u32 v36, v28, v7 offset:4400
    v_lshl_add_u32 v29, v53, 2, s62
    ds_add_rtn_u32 v37, v29, v7 offset:4400
    v_mad_i32_i24 v8, v48, s61, v8
    v_or_b32 v8, v8, v56
    v_mad_i32_i24 v9, v49, s61, v9
    v_or_b32 v9, v9, v57
    v_mad_i32_i24 v10, v50, s61, v10
    v_or_b32 v10, v10, v58
    v_mad_i32_i24 v11, v51, s61, v11
    v_or_b32 v11, v11, v59
    v_mad_i32_i24 v12, v52, s61, v12
    v_or_b32 v12, v12, v60
    v_mad_i32_i24 v13, v53, s61, v13
    v_or_b32 v13, v13, v61
    s_waitcnt lgkmcnt(5)
    v_lshrrev_b32 v32, 16, v32
    v_min_u32 v40, 48, v32
    v_mad_u32_u24 v40, v24, 13, v40
    v_lshlrev_b32 v48, 2, v40
    ds_write_b8 v40, v23 offset:65136
    s_waitcnt lgkmcnt(5)
    v_lshrrev_b32 v33, 16, v33
    v_min_u32 v41, 48, v33
    v_mad_u32_u24 v41, v25, 13, v41
    v_lshlrev_b32 v49, 2, v41
    ds_write_b8 v41, v23 offset:65136
    s_waitcnt lgkmcnt(5)
    v_lshrrev_b32 v34, 16, v34
    v_min_u32 v42, 48, v34
    v_mad_u32_u24 v42, v26, 13, v42
    v_lshlrev_b32 v50, 2, v42
    ds_write_b8 v42, v23 offset:65136
    s_waitcnt lgkmcnt(5)
    v_lshrrev_b32 v35, 16, v35
    v_min_u32 v43, 48, v35
    v_mad_u32_u24 v43, v27, 13, v43
    v_lshlrev_b32 v51, 2, v43
    ds_write_b8 v43, v23 offset:65136
    s_waitcnt lgkmcnt(5)
    v_lshrrev_b32 v36, 16, v36
    v_min_u32 v44, 48, v36
    v_mad_u32_u24 v44, v28, 13, v44
    v_lshlrev_b32 v52, 2, v44
    ds_write_b8 v44, v31 offset:65136
    s_waitcnt lgkmcnt(5)
    v_lshrrev_b32 v37, 16, v37
    v_min_u32 v45, 48, v37
    v_mad_u32_u24 v45, v29, 13, v45
    v_lshlrev_b32 v53, 2, v45
    ds_write_b8 v45, v31 offset:65136
    s_cmp_lg_u32 s7, 0
    s_cbranch_scc1 K1_NO7
    s_mov_b64 exec, s[78:79]
    s_waitcnt lgkmcnt(0)
    v_mul_u32_u24 v54, s60, v14
    v_lshrrev_b32 v54, 24, v54
    v_lshl_add_u32 v30, v54, 2, s62
    ds_add_rtn_u32 v38, v30, v7 offset:4400
    v_mad_i32_i24 v14, v54, s61, v14
    v_or_b32 v14, v14, v62
    s_waitcnt lgkmcnt(0)
    v_lshrrev_b32 v38, 16, v38
    v_min_u32 v46, 48, v38
    v_mad_u32_u24 v46, v30, 13, v46
    v_lshlrev_b32 v54, 2, v46
    ds_write_b8 v46, v39 offset:65136
    s_waitcnt vmcnt(0)
    v_lshl_add_u32 v22, v22, 16, v14
    ds_write_b32 v54, v22 offset:448
    s_mov_b64 exec, -1
K1_NO7:
    s_mov_b32 s64, s50
    s_mov_b32 s65, s51
    s_mov_b32 s66, 8192
    s_mov_b32 s67, 0x20000
    buffer_load_dwordx4 v[64:67], v5, s[64:67], 0 offen
    s_mov_b32 s68, s52
    s_mov_b32 s69, s53
    s_mov_b32 s70, 2048
    s_mov_b32 s71, 0x20000
    buffer_load_dwordx4 v[68:71], v5, s[68:71], 0 offen
    s_lshl_b32 s10, s7, 10
    s_mov_b32 s64, s48
    s_mov_b32 s65, s49
    s_add_u32 m0, s10, 34304
    s_nop 0
    buffer_load_dwordx4 v5, s[64:67], 0 offen lds
    s_mov_b32 s64, s56
    s_mov_b32 s65, s57
    s_add_u32 m0, s10, 26112
    s_nop 0
    buffer_load_dwordx4 v5, s[64:67], 0 offen lds
    s_mov_b32 s64, s54
    s_mov_b32 s65, s55
    s_add_u32 m0, s10, 9728
    s_nop 0
    buffer_load_dwordx4 v5, s[64:67], 0 offen lds
    s_waitcnt vmcnt(5)
    v_lshl_add_u32 v16, v16, 16, v8
    ds_write_b32 v48, v16 offset:448
    v_lshl_add_u32 v17, v17, 16, v9
    ds_write_b32 v49, v17 offset:448
    v_lshl_add_u32 v18, v18, 16, v10
    ds_write_b32 v50, v18 offset:448
    v_lshl_add_u32 v19, v19, 16, v11
    ds_write_b32 v51, v19 offset:448
    v_lshl_add_u32 v20, v20, 16, v12
    ds_write_b32 v52, v20 offset:448
    v_lshl_add_u32 v21, v21, 16, v13
    ds_write_b32 v53, v21 offset:448
    s_lshl_b32 s15, s12, 7
    s_add_u32 s32, s8, s15
    s_addc_u32 s33, s9, 0
    s_mov_b32 s34, 16809984
    s_mov_b32 s35, 0x20000
    s_waitcnt lgkmcnt(0)
    s_add_u32 s100, s100, 1
    s_and_b32 s10, s100, 15
    s_and_b32 s11, s100, 0xf0
    s_mul_i32 s36, s10, 0x1010
    s_lshl_b32 s11, s11, 16
    s_xor_b32 s36, s36, 0xf000
    s_or_b32 s36, s36, s11
    s_mov_b32 s101, 200000
    s_barrier
    ds_read_b128 v[112:115], v172 offset:6400
    ds_read_u16 v108, v170 offset:6402
    ds_read_b32 v104, v6 offset:0
    ds_read_b128 v[88:91], v3 offset:0
    ds_read_u16 v109, v170 offset:6658
    ds_read_b32 v105, v6 offset:3328
    ds_read_b128 v[92:95], v3 offset:13312
    ds_read_u16 v110, v170 offset:6914
    ds_read_b32 v106, v6 offset:6656
    ds_read_b128 v[96:99], v3 offset:26624
    ds_read_u16 v111, v170 offset:7170
    ds_read_b32 v107, v6 offset:9984
    ds_read_b128 v[100:103], v3 offset:39936
    s_waitcnt lgkmcnt(12)
    v_max3_u32 v1, v112, v113, v114
    v_max_u32 v1, v1, v115
    v_cmp_le_u32 vcc, 3211264, v1
    s_mov_b32 s10, 0
    s_cbranch_vccnz K1_OVF
K1_OUT:
    s_waitcnt lgkmcnt(9)
    v_lshl_or_b32 v108, v108, 24, s36
    v_and_or_b32 v91, v104, v15, v108
    buffer_store_dwordx4 v[88:91], v4, s[32:35], s10 offen sc1
    s_add_u32 s10, s10, 2105344
    s_waitcnt lgkmcnt(6)
    v_lshl_or_b32 v109, v109, 24, s36
    v_and_or_b32 v95, v105, v15, v109
    buffer_store_dwordx4 v[92:95], v4, s[32:35], s10 offen sc1
    s_add_u32 s10, s10, 2105344
    s_waitcnt lgkmcnt(3)
    v_lshl_or_b32 v110, v110, 24, s36
    v_and_or_b32 v99, v106, v15, v110
    buffer_store_dwordx4 v[96:99], v4, s[32:35], s10 offen sc1
    s_add_u32 s10, s10, 2105344
    s_waitcnt lgkmcnt(0)
    v_lshl_or_b32 v111, v111, 24, s36
    v_and_or_b32 v103, v107, v15, v111
    buffer_store_dwordx4 v[100:103], v4, s[32:35], s10 offen sc1
    s_add_u32 s10, s10, 2105344
    v_max3_u32 v1, v108, v109, v110
    v_max_u32 v1, v1, v111
    v_cmp_le_u32 vcc, 553648128, v1
    s_cbranch_vccnz K1_EXT
K1_EXTR:
    s_lshr_b32 s10, s3, 1
    s_mul_i32 s10, s10, 49
    s_bitcmp1_b32 s3, 0
    s_cselect_b32 s72, 20, -4
    s_cselect_b32 s73, 28, 3
    s_cselect_b32 s84, 45, 20
    s_add_i32 s72, s72, s10
    s_add_i32 s73, s73, s10
    s_add_i32 s84, s84, s10
    s_add_i32 s85, s72, 32
    s_max_i32 s96, s72, 0
    s_cmp_eq_u32 s3, 7
    s_cselect_b32 s84, 196, s84
    s_cselect_b32 s85, 196, s85
    v_lshrrev_b32 v193, 5, v254
    s_mov_b32 s20, s42
    s_mov_b32 s21, s43
    s_mov_b32 s22, 25600000
    s_mov_b32 s23, 0x20000
    s_mov_b32 s28, s58
    s_mov_b32 s29, s59
    s_mov_b32 s30, 6400000
    s_mov_b32 s31, 0x20000
    s_mov_b32 s24, s8
    s_mov_b32 s25, s9
    s_mov_b32 s26, 24117376
    s_mov_b32 s27, 0x20000
    v_lshrrev_b32 v194, 5, v255
    v_and_b32 v195, 15, v255
    v_cmp_eq_u32 vcc, v194, v195
    v_and_b32 v194, 16, v255
    v_mov_b32 v195, 0x3f80
    v_lshlrev_b32 v195, v194, v195
    v_cndmask_b32 v195, 0, v195, vcc
    v_lshlrev_b32 v194, 2, v255
    v_mov_b32 v196, 0
    ds_write_b32 v194, v195
    v_bfe_u32 v195, v255, 3, 1
    v_and_b32 v201, 7, v255
    v_lshl_add_u32 v195, v195, 2, v201
    v_lshrrev_b32 v200, 6, v255
    v_cmp_eq_u32 vcc, v195, v200
    v_bfe_u32 v200, v255, 4, 2
    v_mov_b32 v195, 0x3f80
    v_cndmask_b32 v195, 0, v195, vcc
    v_cmp_lt_u32 vcc, 3, v201
    v_mul_u32_u24 v200, 0x5555, v200
    v_and_b32 v201, 60, v194
    v_cndmask_b32 v195, v195, v200, vcc
    ds_write_b32 v194, v195 offset:7424
    ds_write_b32 v201, v196 offset:9472
    ds_write_b32 v194, v196 offset:2048
    ds_write2st64_b32 v194, v196, v196 offset0:9 offset1:17
    s_movk_i32 s75, 128
    s_mul_i32 s74, s3, 5184
    s_add_u32 s74, s74, 95232
    s_movk_i32 s77, 48
    s_add_u32 s39, s96, 32
    s_lshl_b32 s11, s96, 6
    s_mov_b32 s97, 0
    v_bfe_u32 v194, v254, 4, 1
    v_and_b32 v242, 1, v254
    v_lshlrev_b32 v242, 4, v242
    v_lshlrev_b32 v245, 5, v193
    v_subrev_u32 v245, s11, v245
    v_and_b32 v195, 3, v254
    v_lshlrev_b32 v195, 3, v195
    v_lshl_add_u32 v246, v194, 5, v195
    v_subrev_u32 v246, s11, v246
    v_bfe_u32 v196, v254, 2, 2
    v_mul_u32_u24 v196, 1040, v196
    v_lshl_add_u32 v196, v194, 9, v196
    v_lshl_add_u32 v196, v195, 4, v196
    v_bfe_u32 v194, v254, 1, 1
    v_xor_b32 v194, v194, v193
    v_lshl_add_u32 v196, v194, 6, v196
    v_add_u32 v243, s74, v196
    v_bfe_u32 v194, v254, 2, 3
    v_add_u32 v194, v194, v195
    v_lshl_add_u32 v194, v194, 1, v193
    v_lshl_add_u32 v244, v194, 4, s74
    v_add_u32 v244, 4160, v244
    s_mul_i32 s76, s3, 2688
    s_add_u32 s76, s76, 9728
    v_bfe_u32 v194, v254, 3, 2
    v_lshl_add_u32 v247, v194, 5, s76
    v_lshrrev_b32 v194, 5, v254
    v_lshl_add_u32 v247, v194, 4, v247
    v_and_b32 v194, 3, v254
    v_and_b32 v195, 28, v254
    v_lshl_add_u32 v194, v194, 5, v195
    v_add_u32 v249, s76, v194
    v_lshrrev_b32 v195, 1, v254
    v_lshl_add_u32 v251, v195, 2, s76
    v_add_u32 v251, 21504, v251
    v_bfe_u32 v194, v254, 2, 2
    v_lshl_add_u32 v248, v194, 5, s76
    v_lshrrev_b32 v194, 5, v254
    v_lshl_add_u32 v248, v194, 3, v248
    v_and_b32 v202, 31, v254
    v_add_u32 v202, s96, v202
    v_bfe_u32 v194, v202, 1, 1
    v_xor_b32 v194, v194, v193
    v_lshlrev_b32 v194, 6, v194
    v_lshl_add_u32 v194, v202, 7, v194
    v_lshrrev_b32 v202, 3, v202
    v_lshl_add_u32 v202, v202, 4, v194
    v_add_u32 v202, 69120, v202
    v_lshrrev_b32 v194, 1, v254
    v_xor_b32 v194, v194, v254
    v_and_b32 v194, 4, v194
    v_mul_u32_u24 v194, 3, v194
    v_xor_b32 v194, v194, v254
    v_and_b32 v235, 31, v194
    v_add_u32 v235, s96, v235
    v_bfe_u32 v195, v235, 1, 1
    v_xor_b32 v195, v195, v193
    v_lshlrev_b32 v195, 6, v195
    v_lshl_add_u32 v195, v235, 7, v195
    v_lshrrev_b32 v235, 3, v235
    v_lshl_add_u32 v235, v235, 4, v195
    v_add_u32 v235, 69120, v235
    v_mov_b32 v177, 0xdddd
    v_lshlrev_b32 v168, 2, v197
    v_mul_u32_u24 v208, 25000, v170
    v_add_u32 v209, 6400000, v208
    v_add_u32 v210, 12800000, v208
    v_add_u32 v211, 19200000, v208
    v_mov_b32 v171, 4
    v_mov_b32 v169, 1
    v_and_b32 v199, 31, v254
    v_add_u32 v199, s96, v199
    v_lshlrev_b32 v200, 4, v199
    v_lshl_add_u32 v200, v193, 3, v200
    v_mov_b64 v[180:181], 0
    v_mov_b64 v[182:183], 0
    v_mov_b64 v[184:185], 0
    v_mov_b64 v[186:187], 0
    s_lshl_b32 s15, s3, 2
    v_mov_b32 v212, s15
    v_lshlrev_b32 v213, 2, v199
    s_mul_i32 s10, s12, 32896
    s_add_u32 s32, s8, s10
    s_addc_u32 s33, s9, 0
    s_mov_b32 s34, 32768
    s_mov_b32 s35, 0x20000
    s_movk_i32 s79, 8192
    s_movk_i32 s80, 16384
    s_movk_i32 s81, 24576
    s_mov_b32 s10, 0xbfb8aa3b
    s_waitcnt vmcnt(7)
    v_lshlrev_b32 v72, 16, v64
    v_and_b32 v73, 0xffff0000, v64
    v_lshlrev_b32 v74, 16, v65
    v_and_b32 v75, 0xffff0000, v65
    v_lshlrev_b32 v76, 16, v66
    v_and_b32 v77, 0xffff0000, v66
    v_lshlrev_b32 v78, 16, v67
    v_and_b32 v79, 0xffff0000, v67
    v_lshlrev_b32 v80, 16, v68
    v_and_b32 v81, 0xffff0000, v68
    v_lshlrev_b32 v82, 16, v69
    v_and_b32 v83, 0xffff0000, v69
    v_lshlrev_b32 v84, 16, v70
    v_and_b32 v85, 0xffff0000, v70
    v_lshlrev_b32 v86, 16, v71
    v_and_b32 v87, 0xffff0000, v71
    v_mul_f32 v72, s10, v72
    v_mul_f32 v73, s10, v73
    v_mul_f32 v74, s10, v74
    v_mul_f32 v75, s10, v75
    v_mul_f32 v76, s10, v76
    v_mul_f32 v77, s10, v77
    v_mul_f32 v78, s10, v78
    v_mul_f32 v79, s10, v79
    v_mul_f32 v80, s10, v80
    v_mul_f32 v81, s10, v81
    v_mul_f32 v82, s10, v82
    v_mul_f32 v83, s10, v83
    v_mul_f32 v84, s10, v84
    v_mul_f32 v85, s10, v85
    v_mul_f32 v86, s10, v86
    v_mul_f32 v87, s10, v87
    v_cvt_pk_bf16_f32 v64, v72, v73
    v_cvt_pk_bf16_f32 v65, v74, v75
    v_cvt_pk_bf16_f32 v66, v76, v77
    v_cvt_pk_bf16_f32 v67, v78, v79
    v_cvt_pk_bf16_f32 v68, v80, v81
    v_cvt_pk_bf16_f32 v69, v82, v83
    v_cvt_pk_bf16_f32 v70, v84, v85
    v_cvt_pk_bf16_f32 v71, v86, v87
    ds_write_b128 v189, v[64:67] offset:17920
    s_cmp_ge_u32 s7, 2
    s_cbranch_scc1 K1_NOWC
    ds_write_b128 v189, v[68:71] offset:42496
K1_NOWC:
    v_bfe_u32 v173, v254, 2, 2
    v_lshlrev_b32 v173, 7, v173
    v_lshl_add_u32 v173, v242, 2, v173
    v_and_b32 v174, 16, v254
    v_and_b32 v175, 2, v254
    v_lshl_add_u32 v174, v175, 2, v174
    v_and_b32 v175, 8, v254
    v_lshl_add_u32 v174, v175, 2, v174
    v_add_u32 v173, v173, v174
    v_lshl_add_u32 v175, v193, 10, v173
    v_lshl_add_u32 v173, v193, 12, v173
    v_xor_b32 v174, 32, v173
    v_xor_b32 v176, 32, v175
    s_lshl_b32 s10, s7, 10
    s_and_b32 s11, s7, 4
    s_mul_i32 s11, s11, -1016
    s_add_u32 s11, s11, s10
    v_xor_b32 v252, s11, v173
    s_waitcnt vmcnt(0) lgkmcnt(0)
    s_barrier
    ds_read_b64_tr_b16 v[72:73], v252 offset:9728
    ds_read_b64_tr_b16 v[76:77], v252 offset:34304
    ds_read_b64_tr_b16 v[74:75], v252 offset:10240
    ds_read_b64_tr_b16 v[78:79], v252 offset:34816
    v_add_u32 v252, s10, v172
    ds_read_b64_tr_b16 v[0:1], v173 offset:17920
    ds_read_b64_tr_b16 v[2:3], v173 offset:18432
    ds_read_b64_tr_b16 v[4:5], v173 offset:18944
    ds_read_b64_tr_b16 v[6:7], v173 offset:19456
    ds_read_b64_tr_b16 v[8:9], v173 offset:19968
    ds_read_b64_tr_b16 v[10:11], v173 offset:20480
    ds_read_b64_tr_b16 v[12:13], v173 offset:20992
    ds_read_b64_tr_b16 v[14:15], v173 offset:21504
    s_waitcnt lgkmcnt(8)
    ds_write_b128 v252, v[72:75] offset:52736
    ds_write_b128 v252, v[76:79] offset:60928
    s_waitcnt lgkmcnt(8)
    ds_read_b64_tr_b16 v[16:17], v174 offset:17920
    ds_read_b64_tr_b16 v[18:19], v174 offset:18432
    ds_read_b64_tr_b16 v[20:21], v174 offset:18944
    ds_read_b64_tr_b16 v[22:23], v174 offset:19456
    ds_read_b64_tr_b16 v[24:25], v174 offset:19968
    ds_read_b64_tr_b16 v[26:27], v174 offset:20480
    s_waitcnt lgkmcnt(8)
    ds_read_b64_tr_b16 v[28:29], v174 offset:20992
    ds_read_b64_tr_b16 v[30:31], v174 offset:21504
    ds_read_b64_tr_b16 v[64:65], v175 offset:42496
    ds_read_b64_tr_b16 v[66:67], v175 offset:43008
    ds_read_b64_tr_b16 v[68:69], v176 offset:42496
    ds_read_b64_tr_b16 v[70:71], v176 offset:43008
    s_waitcnt lgkmcnt(8)
    ds_read_b64_tr_b16 v[32:33], v173 offset:26112
    ds_read_b64_tr_b16 v[34:35], v173 offset:26624
    ds_read_b64_tr_b16 v[36:37], v173 offset:27136
    ds_read_b64_tr_b16 v[38:39], v173 offset:27648
    ds_read_b64_tr_b16 v[40:41], v173 offset:28160
    ds_read_b64_tr_b16 v[42:43], v173 offset:28672
    s_waitcnt lgkmcnt(8)
    ds_read_b64_tr_b16 v[44:45], v173 offset:29184
    ds_read_b64_tr_b16 v[46:47], v173 offset:29696
    ds_read_b64_tr_b16 v[48:49], v174 offset:26112
    ds_read_b64_tr_b16 v[50:51], v174 offset:26624
    ds_read_b64_tr_b16 v[52:53], v174 offset:27136
    ds_read_b64_tr_b16 v[54:55], v174 offset:27648
    s_waitcnt lgkmcnt(8)
    ds_read_b64_tr_b16 v[56:57], v174 offset:28160
    ds_read_b64_tr_b16 v[58:59], v174 offset:28672
    ds_read_b64_tr_b16 v[60:61], v174 offset:29184
    ds_read_b64_tr_b16 v[62:63], v174 offset:29696
    s_mov_b32 s5, 85899
    buffer_load_dwordx4 v[88:91], v189, s[32:35], 0 offen sc1
    buffer_load_dwordx4 v[92:95], v189, s[32:35], s79 offen sc1
    buffer_load_dwordx4 v[96:99], v189, s[32:35], s80 offen sc1
    buffer_load_dwordx4 v[100:103], v189, s[32:35], s81 offen sc1
K2_CHK0:
    s_waitcnt vmcnt(3)
    v_bitop3_b32 v188, v91, s36, v214 bitop3:0x28
    v_cmp_ne_u32 vcc, 0, v188
    v_sub_u32_sdwa v188, v91, v168 dst_sel:DWORD dst_unused:UNUSED_PAD src0_sel:BYTE_3 src1_sel:DWORD
    v_mul_u32_u24_sdwa v104, s5, v88 dst_sel:DWORD dst_unused:UNUSED_PAD src0_sel:DWORD src1_sel:WORD_1
    v_mul_u32_u24_sdwa v105, s5, v89 dst_sel:DWORD dst_unused:UNUSED_PAD src0_sel:DWORD src1_sel:WORD_1
    v_mul_u32_u24_sdwa v106, s5, v90 dst_sel:DWORD dst_unused:UNUSED_PAD src0_sel:DWORD src1_sel:WORD_1
    s_cbranch_vccnz K2_RETRY0
    v_cmp_lt_i32 s[40:41], 0, v188
    v_cmp_lt_i32 s[42:43], 1, v188
    v_cmp_lt_i32 s[44:45], 2, v188
    v_alignbit_b32 v104, v88, v104, 28
    v_alignbit_b32 v105, v89, v105, 28
    v_alignbit_b32 v106, v90, v106, 28
    v_and_b32 v104, 0xffc, v104
    v_and_b32 v105, 0xffc, v105
    v_and_b32 v106, 0xffc, v106
    s_mov_b64 exec, s[40:41]
    ds_add_rtn_u32 v220, v104, v171 offset:2304
    s_mov_b64 exec, s[42:43]
    ds_add_rtn_u32 v221, v105, v171 offset:2304
    s_mov_b64 exec, s[44:45]
    ds_add_rtn_u32 v222, v106, v171 offset:2304
    s_mov_b64 exec, -1
K2_CHK1:
    s_waitcnt vmcnt(2)
    v_bitop3_b32 v188, v95, s36, v214 bitop3:0x28
    v_cmp_ne_u32 vcc, 0, v188
    v_sub_u32_sdwa v188, v95, v168 dst_sel:DWORD dst_unused:UNUSED_PAD src0_sel:BYTE_3 src1_sel:DWORD
    v_mul_u32_u24_sdwa v107, s5, v92 dst_sel:DWORD dst_unused:UNUSED_PAD src0_sel:DWORD src1_sel:WORD_1
    v_mul_u32_u24_sdwa v108, s5, v93 dst_sel:DWORD dst_unused:UNUSED_PAD src0_sel:DWORD src1_sel:WORD_1
    v_mul_u32_u24_sdwa v109, s5, v94 dst_sel:DWORD dst_unused:UNUSED_PAD src0_sel:DWORD src1_sel:WORD_1
    s_cbranch_vccnz K2_RETRY1
    v_cmp_lt_i32 s[46:47], 0, v188
    v_cmp_lt_i32 s[48:49], 1, v188
    v_cmp_lt_i32 s[50:51], 2, v188
    v_alignbit_b32 v107, v92, v107, 28
    v_alignbit_b32 v108, v93, v108, 28
    v_alignbit_b32 v109, v94, v109, 28
    v_and_b32 v107, 0xffc, v107
    v_and_b32 v108, 0xffc, v108
    v_and_b32 v109, 0xffc, v109
    s_mov_b64 exec, s[46:47]
    ds_add_rtn_u32 v223, v107, v171 offset:2304
    s_mov_b64 exec, s[48:49]
    ds_add_rtn_u32 v224, v108, v171 offset:2304
    s_mov_b64 exec, s[50:51]
    ds_add_rtn_u32 v225, v109, v171 offset:2304
    s_mov_b64 exec, -1
K2_CHK2:
    s_waitcnt vmcnt(1)
    v_bitop3_b32 v188, v99, s36, v214 bitop3:0x28
    v_cmp_ne_u32 vcc, 0, v188
    v_sub_u32_sdwa v188, v99, v168 dst_sel:DWORD dst_unused:UNUSED_PAD src0_sel:BYTE_3 src1_sel:DWORD
    v_mul_u32_u24_sdwa v110, s5, v96 dst_sel:DWORD dst_unused:UNUSED_PAD src0_sel:DWORD src1_sel:WORD_1
    v_mul_u32_u24_sdwa v111, s5, v97 dst_sel:DWORD dst_unused:UNUSED_PAD src0_sel:DWORD src1_sel:WORD_1
    v_mul_u32_u24_sdwa v112, s5, v98 dst_sel:DWORD dst_unused:UNUSED_PAD src0_sel:DWORD src1_sel:WORD_1
    s_cbranch_vccnz K2_RETRY2
    v_cmp_lt_i32 s[52:53], 0, v188
    v_cmp_lt_i32 s[54:55], 1, v188
    v_cmp_lt_i32 s[56:57], 2, v188
    v_alignbit_b32 v110, v96, v110, 28
    v_alignbit_b32 v111, v97, v111, 28
    v_alignbit_b32 v112, v98, v112, 28
    v_and_b32 v110, 0xffc, v110
    v_and_b32 v111, 0xffc, v111
    v_and_b32 v112, 0xffc, v112
    s_mov_b64 exec, s[52:53]
    ds_add_rtn_u32 v226, v110, v171 offset:2304
    s_mov_b64 exec, s[54:55]
    ds_add_rtn_u32 v227, v111, v171 offset:2304
    s_mov_b64 exec, s[56:57]
    ds_add_rtn_u32 v228, v112, v171 offset:2304
    s_mov_b64 exec, -1
K2_CHK3:
    s_waitcnt vmcnt(0)
    v_bitop3_b32 v188, v103, s36, v214 bitop3:0x28
    v_cmp_ne_u32 vcc, 0, v188
    v_sub_u32_sdwa v188, v103, v168 dst_sel:DWORD dst_unused:UNUSED_PAD src0_sel:BYTE_3 src1_sel:DWORD
    v_mul_u32_u24_sdwa v113, s5, v100 dst_sel:DWORD dst_unused:UNUSED_PAD src0_sel:DWORD src1_sel:WORD_1
    v_mul_u32_u24_sdwa v114, s5, v101 dst_sel:DWORD dst_unused:UNUSED_PAD src0_sel:DWORD src1_sel:WORD_1
    v_mul_u32_u24_sdwa v115, s5, v102 dst_sel:DWORD dst_unused:UNUSED_PAD src0_sel:DWORD src1_sel:WORD_1
    s_cbranch_vccnz K2_RETRY3
    v_cmp_lt_i32 s[58:59], 0, v188
    v_cmp_lt_i32 s[60:61], 1, v188
    v_cmp_lt_i32 s[62:63], 2, v188
    v_alignbit_b32 v113, v100, v113, 28
    v_alignbit_b32 v114, v101, v114, 28
    v_alignbit_b32 v115, v102, v115, 28
    v_and_b32 v113, 0xffc, v113
    v_and_b32 v114, 0xffc, v114
    v_and_b32 v115, 0xffc, v115
    s_mov_b64 exec, s[58:59]
    ds_add_rtn_u32 v229, v113, v171 offset:2304
    s_mov_b64 exec, s[60:61]
    ds_add_rtn_u32 v230, v114, v171 offset:2304
    s_mov_b64 exec, s[62:63]
    ds_add_rtn_u32 v231, v115, v171 offset:2304
    s_mov_b64 exec, -1
    v_max3_u32 v188, v91, v95, v99
    v_max_u32 v188, v188, v103
    v_cmp_le_u32 vcc, 553648128, v188
    s_mov_b32 s64, 0xc0c0401
    s_mov_b32 s65, 0xc0c0501
    s_mov_b32 s66, 0xc0c0601
    s_mov_b32 s67, 0x05040100
    s_cbranch_vccnz K2_XT1
K2_XT1R:
    s_waitcnt lgkmcnt(0)
    s_barrier
    ds_read_b128 v[116:119], v172 offset:2304
    ds_read_b128 v[120:123], v172 offset:3328
    ds_read_b128 v[124:127], v172 offset:4352
    ds_read_b128 v[128:131], v172 offset:5376
    ds_read_b64 v[194:195], v200 offset:2304
    s_mul_i32 s10, s12, 25088
    s_lshl_b32 s11, s7, 10
    s_add_u32 s10, s10, s11
    s_mul_i32 s11, s7, 1040
    s_cmp_lg_u32 s7, 0
    s_cbranch_scc1 K2_NOX3
    s_add_u32 m0, s11, 94080
    s_add_u32 s14, s10, 24576
    buffer_load_dwordx4 v234, s[16:19], s14 offen lds
K2_NOX3:
    s_add_u32 m0, s11, 69120
    s_add_u32 s14, s10, 0
    buffer_load_dwordx4 v234, s[16:19], s14 offen lds
    s_add_u32 m0, s11, 77440
    s_add_u32 s14, s10, 8192
    buffer_load_dwordx4 v234, s[16:19], s14 offen lds
    s_add_u32 m0, s11, 85760
    s_add_u32 s14, s10, 16384
    buffer_load_dwordx4 v234, s[16:19], s14 offen lds
    v_and_b32 v91, 0x0f0f0f, v91
    v_and_b32 v95, 0x0f0f0f, v95
    v_and_b32 v99, 0x0f0f0f, v99
    v_and_b32 v103, 0x0f0f0f, v103
    v_perm_b32 v152, v91, v88, s64
    v_perm_b32 v153, v91, v89, s65
    v_perm_b32 v154, v91, v90, s66
    v_perm_b32 v155, v95, v92, s64
    s_waitcnt lgkmcnt(4)
    v_add_u32_sdwa v188, v116, v117 dst_sel:DWORD dst_unused:UNUSED_PAD src0_sel:WORD_0 src1_sel:WORD_0
    v_add_u32_sdwa v116, v118, v119 dst_sel:DWORD dst_unused:UNUSED_PAD src0_sel:WORD_0 src1_sel:WORD_0
    v_add_u32 v188, v188, v116
    s_waitcnt lgkmcnt(3)
    v_add_u32_sdwa v189, v120, v121 dst_sel:DWORD dst_unused:UNUSED_PAD src0_sel:WORD_0 src1_sel:WORD_0
    v_add_u32_sdwa v120, v122, v123 dst_sel:DWORD dst_unused:UNUSED_PAD src0_sel:WORD_0 src1_sel:WORD_0
    v_add_u32 v189, v189, v120
    s_waitcnt lgkmcnt(2)
    v_add_u32_sdwa v190, v124, v125 dst_sel:DWORD dst_unused:UNUSED_PAD src0_sel:WORD_0 src1_sel:WORD_0
    v_add_u32_sdwa v124, v126, v127 dst_sel:DWORD dst_unused:UNUSED_PAD src0_sel:WORD_0 src1_sel:WORD_0
    v_add_u32 v190, v190, v124
    s_waitcnt lgkmcnt(1)
    v_add_u32_sdwa v191, v128, v129 dst_sel:DWORD dst_unused:UNUSED_PAD src0_sel:WORD_0 src1_sel:WORD_0
    v_add_u32_sdwa v128, v130, v131 dst_sel:DWORD dst_unused:UNUSED_PAD src0_sel:WORD_0 src1_sel:WORD_0
    v_add_u32 v191, v191, v128
    v_lshl_or_b32 v192, v189, 16, v188
    v_lshl_or_b32 v193, v191, 16, v190
    s_waitcnt lgkmcnt(0)
    v_perm_b32 v198, v195, v194, s67
    v_add_u32_dpp v192, v192, v192 row_shr:1 row_mask:0xf bank_mask:0xf bound_ctrl:0
    v_add_u32_dpp v193, v193, v193 row_shr:1 row_mask:0xf bank_mask:0xf bound_ctrl:0
    v_perm_b32 v156, v95, v93, s65
    v_add_u32_dpp v192, v192, v192 row_shr:2 row_mask:0xf bank_mask:0xf bound_ctrl:0
    v_add_u32_dpp v193, v193, v193 row_shr:2 row_mask:0xf bank_mask:0xf bound_ctrl:0
    v_perm_b32 v157, v95, v94, s66
    v_add_u32_dpp v192, v192, v192 row_shr:4 row_mask:0xf bank_mask:0xf bound_ctrl:0
    v_add_u32_dpp v193, v193, v193 row_shr:4 row_mask:0xf bank_mask:0xf bound_ctrl:0
    v_perm_b32 v158, v99, v96, s64
    v_add_u32_dpp v192, v192, v192 row_shr:8 row_mask:0xf bank_mask:0xf bound_ctrl:0
    v_add_u32_dpp v193, v193, v193 row_shr:8 row_mask:0xf bank_mask:0xf bound_ctrl:0
    v_perm_b32 v159, v99, v97, s65
    v_add_u32_dpp v192, v192, v192 row_bcast:15 row_mask:0xa bank_mask:0xf
    v_add_u32_dpp v193, v193, v193 row_bcast:15 row_mask:0xa bank_mask:0xf
    v_perm_b32 v160, v99, v98, s66
    v_add_u32_dpp v192, v192, v192 row_bcast:31 row_mask:0xc bank_mask:0xf
    v_add_u32_dpp v193, v193, v193 row_bcast:31 row_mask:0xc bank_mask:0xf
    v_perm_b32 v161, v103, v100, s64
    v_readlane_b32 s10, v192, 63
    v_readlane_b32 s11, v193, 63
    v_lshlrev_b32_sdwa v116, v169, v192 dst_sel:DWORD dst_unused:UNUSED_PAD src0_sel:DWORD src1_sel:WORD_0
    v_sub_u32 v188, v116, v188
    v_lshlrev_b32_sdwa v117, v169, v192 dst_sel:DWORD dst_unused:UNUSED_PAD src0_sel:DWORD src1_sel:WORD_1
    v_sub_u32 v189, v117, v189
    v_lshlrev_b32_sdwa v118, v169, v193 dst_sel:DWORD dst_unused:UNUSED_PAD src0_sel:DWORD src1_sel:WORD_0
    v_sub_u32 v190, v118, v190
    v_lshlrev_b32_sdwa v119, v169, v193 dst_sel:DWORD dst_unused:UNUSED_PAD src0_sel:DWORD src1_sel:WORD_1
    v_sub_u32 v191, v119, v191
    s_and_b32 s4, s10, 0xffff
    s_lshr_b32 s10, s10, 16
    s_add_u32 s5, s4, s10
    s_and_b32 s10, s11, 0xffff
    s_add_u32 s6, s5, s10
    s_lshr_b32 s11, s11, 16
    s_add_u32 s10, s6, s11
    v_lshl_add_u32 v189, s4, 1, v189
    v_lshl_add_u32 v190, s5, 1, v190
    v_lshl_add_u32 v191, s6, 1, v191
    s_sub_i32 s37, 12928, s10
    s_ashr_i32 s37, s37, 7
    s_max_i32 s37, s37, 1
    s_min_i32 s37, s37, 4
    s_lshr_b32 s11, s10, 5
    s_add_u32 s11, s11, 16
    s_and_b32 s11, s11, -32
    s_cmp_ge_i32 s37, 1
    s_cselect_b32 s13, 42, 10
    s_sub_i32 s11, s11, s13
    s_cmp_lt_i32 s37, 1
    s_cselect_b32 s37, -1, s37
    s_lshl_b32 s11, s11, 3
    s_lshr_b32 s10, s10, 1
    s_lshr_b32 s13, s3, 1
    s_mul_i32 s13, s13, s10
    s_add_i32 s11, s11, s13
    s_add_i32 s10, s10, s13
    s_bitcmp1_b32 s3, 0
    s_cselect_b32 s15, s11, s13
    s_cselect_b32 s10, s10, s11
    s_mov_b32 s13, 0
    s_mov_b32 s14, 0
    v_cmp_gt_i32 vcc, s15, v188
    v_cmp_gt_i32 s[86:87], s10, v188
    s_bcnt1_i32_b64 s11, vcc
    s_add_u32 s13, s13, s11
    s_bcnt1_i32_b64 s11, s[86:87]
    s_add_u32 s14, s14, s11
    v_cmp_gt_i32 vcc, s15, v189
    v_cmp_gt_i32 s[86:87], s10, v189
    s_bcnt1_i32_b64 s11, vcc
    s_add_u32 s13, s13, s11
    s_bcnt1_i32_b64 s11, s[86:87]
    s_add_u32 s14, s14, s11
    v_cmp_gt_i32 vcc, s15, v190
    v_cmp_gt_i32 s[86:87], s10, v190
    s_bcnt1_i32_b64 s11, vcc
    s_add_u32 s13, s13, s11
    s_bcnt1_i32_b64 s11, s[86:87]
    s_add_u32 s14, s14, s11
    v_cmp_gt_i32 vcc, s15, v191
    v_cmp_gt_i32 s[86:87], s10, v191
    s_bcnt1_i32_b64 s11, vcc
    s_add_u32 s13, s13, s11
    s_bcnt1_i32_b64 s11, s[86:87]
    s_add_u32 s14, s14, s11
    s_max_i32 s13, s13, s72
    s_min_i32 s13, s13, s73
    s_max_i32 s14, s14, s84
    s_min_i32 s14, s14, s85
    v_cmp_le_u32 vcc, s13, v199
    v_cmp_gt_u32 s[10:11], s14, v199
    s_mov_b32 s78, 2
    s_and_b64 vcc, vcc, s[10:11]
    v_cndmask_b32 v198, 0, v198, vcc
    v_mov_b32 v196, v198
    v_perm_b32 v162, v103, v101, s65
    v_perm_b32 v163, v103, v102, s66
    v_add_u32_dpp v196, v196, v196 row_shr:1 row_mask:0xf bank_mask:0xf bound_ctrl:0
    v_lshl_add_u32 v152, v152, 5, v208
    v_lshl_add_u32 v153, v153, 5, v208
    v_add_u32_dpp v196, v196, v196 row_shr:2 row_mask:0xf bank_mask:0xf bound_ctrl:0
    v_lshl_add_u32 v154, v154, 5, v208
    v_lshl_add_u32 v155, v155, 5, v209
    v_add_u32_dpp v196, v196, v196 row_shr:4 row_mask:0xf bank_mask:0xf bound_ctrl:0
    v_lshl_add_u32 v156, v156, 5, v209
    v_lshl_add_u32 v157, v157, 5, v209
    v_add_u32_dpp v196, v196, v196 row_shr:8 row_mask:0xf bank_mask:0xf bound_ctrl:0
    v_lshl_add_u32 v158, v158, 5, v210
    v_lshl_add_u32 v159, v159, 5, v210
    v_add_u32_dpp v196, v196, v196 row_bcast:15 row_mask:0xa bank_mask:0xf
    v_lshl_add_u32 v160, v160, 5, v210
    v_lshl_add_u32 v161, v161, 5, v211
    v_lshl_add_u32 v162, v162, 5, v211
    v_lshl_add_u32 v163, v163, 5, v211
    s_sub_u32 s86, s76, 9728
    v_readlane_b32 s10, v196, 31
    v_readlane_b32 s11, v196, 63
    v_sub_u32 v196, v196, v198
    v_mov_b32 v253, v202
    s_and_b32 s4, s10, 0xffff
    s_lshr_b32 s10, s10, 16
    s_add_u32 s5, s4, s10
    s_and_b32 s10, s11, 0xffff
    s_add_u32 s6, s5, s10
    s_lshr_b32 s11, s11, 16
    s_add_u32 s15, s6, s11
    s_lshl_b32 s10, s4, 16
    s_pack_ll_b32_b16 s11, s5, s6
    s_pack_ll_b32_b16 s86, s86, s86
    s_add_u32 s10, s10, s86
    s_add_u32 s11, s11, s86
    s_mov_b32 exec_lo, vcc_lo
    s_mov_b32 exec_hi, 0
    v_add_u32 v196, s10, v196
    s_mov_b32 exec_lo, 0
    s_mov_b32 exec_hi, vcc_hi
    v_add_u32 v196, s11, v196
    s_mov_b64 exec, vcc
    ds_write_b16 v200, v196 offset:2306
    ds_write_b16_d16_hi v200, v196 offset:2310
    ds_write_b32 v213, v212 offset:6400
    s_mov_b64 exec, -1
    v_mov_b32 v197, 2176
    s_cmp_le_u32 s15, 2176
    s_cbranch_scc1 K2_LFIT
    ds_write_b32 v197, v197
    s_mov_b32 s15, 0
K2_LFIT:
    s_add_u32 s15, s15, s76
    s_add_i32 s4, s4, 64
    s_lshr_b32 s4, s4, 7
    s_add_i32 s5, s5, 64
    s_lshr_b32 s5, s5, 7
    s_add_i32 s6, s6, 64
    s_lshr_b32 s6, s6, 7
    v_mov_b32 v190, 0xffff0000
    v_or_b32 v189, s39, v190
    v_mov_b32 v190, 0x7fffff00
    v_lshl_add_u32 v188, v254, 2, s15
    s_sub_u32 s73, s15, s76
    ds_write2st64_b32 v188, v189, v190 offset0:0 offset1:84
    ds_write2st64_b32 v188, v189, v190 offset0:1 offset1:85
    s_add_u32 s73, s73, 127
    s_lshr_b32 s73, s73, 7
    s_sub_i32 s38, s73, 1
    v_mov_b32 v188, s15
    ds_write_b32 v212, v188 offset:2112
    s_waitcnt lgkmcnt(0)
    s_barrier
    ds_read_b64 v[194:195], v197
    s_mov_b64 exec, s[40:41]
    ds_read_u16 v104, v104 offset:2306
    s_mov_b64 exec, s[42:43]
    ds_read_u16 v105, v105 offset:2306
    s_mov_b64 exec, s[44:45]
    ds_read_u16 v106, v106 offset:2306
    s_mov_b64 exec, s[46:47]
    ds_read_u16 v107, v107 offset:2306
    s_mov_b64 exec, s[48:49]
    ds_read_u16 v108, v108 offset:2306
    s_mov_b64 exec, s[50:51]
    ds_read_u16 v109, v109 offset:2306
    s_mov_b64 exec, s[52:53]
    ds_read_u16 v110, v110 offset:2306
    s_mov_b64 exec, s[54:55]
    ds_read_u16 v111, v111 offset:2306
    s_mov_b64 exec, s[56:57]
    ds_read_u16 v112, v112 offset:2306
    s_mov_b64 exec, s[58:59]
    ds_read_u16 v113, v113 offset:2306
    s_mov_b64 exec, s[60:61]
    ds_read_u16 v114, v114 offset:2306
    s_mov_b64 exec, s[62:63]
    ds_read_u16 v115, v115 offset:2306
    s_mov_b64 exec, -1
    s_waitcnt lgkmcnt(0)
    v_readfirstlane_b32 s83, v194
    v_readfirstlane_b32 s80, v195
    v_add_u32 v104, v104, v220
    v_add_u32 v105, v105, v221
    v_add_u32 v106, v106, v222
    v_add_u32 v107, v107, v223
    v_add_u32 v108, v108, v224
    v_add_u32 v109, v109, v225
    v_add_u32 v110, v110, v226
    v_add_u32 v111, v111, v227
    v_add_u32 v112, v112, v228
    v_add_u32 v113, v113, v229
    v_add_u32 v114, v114, v230
    v_add_u32 v115, v115, v231
    s_cmp_gt_u32 s83, 64
    s_cbranch_scc1 K2_OVF
    s_mov_b64 exec, s[40:41]
    ds_write2st64_b32 v104, v88, v152 offset0:38 offset1:122
    s_mov_b64 exec, s[42:43]
    ds_write2st64_b32 v105, v89, v153 offset0:38 offset1:122
    s_mov_b64 exec, s[44:45]
    ds_write2st64_b32 v106, v90, v154 offset0:38 offset1:122
    s_mov_b64 exec, s[46:47]
    ds_write2st64_b32 v107, v92, v155 offset0:38 offset1:122
    s_mov_b64 exec, s[48:49]
    ds_write2st64_b32 v108, v93, v156 offset0:38 offset1:122
    s_mov_b64 exec, s[50:51]
    ds_write2st64_b32 v109, v94, v157 offset0:38 offset1:122
    s_mov_b64 exec, s[52:53]
    ds_write2st64_b32 v110, v96, v158 offset0:38 offset1:122
    s_mov_b64 exec, s[54:55]
    ds_write2st64_b32 v111, v97, v159 offset0:38 offset1:122
    s_mov_b64 exec, s[56:57]
    ds_write2st64_b32 v112, v98, v160 offset0:38 offset1:122
    s_mov_b64 exec, s[58:59]
    ds_write2st64_b32 v113, v100, v161 offset0:38 offset1:122
    s_mov_b64 exec, s[60:61]
    ds_write2st64_b32 v114, v101, v162 offset0:38 offset1:122
    s_mov_b64 exec, s[62:63]
    ds_write2st64_b32 v115, v102, v163 offset0:38 offset1:122
    s_mov_b64 exec, -1
    s_cmp_lg_u32 s97, 0
    s_cbranch_scc1 K2_XT2
K2_PADS0:
    s_waitcnt vmcnt(0)
    s_waitcnt lgkmcnt(0)
    s_barrier
    s_cmp_lg_u32 s83, 0
    s_cbranch_scc1 K2_XT3
K2_GO:
    ds_read_b128 v[236:239], v247
    ds_read_b32 v240, v251
    ds_read_u8 v250, v249
    s_waitcnt lgkmcnt(1)
    s_movk_i32 s10, 170
    s_bitcmp1_b32 s10, s3
    s_cbranch_scc0 K2_LATE0
    s_add_u32 m0, s74, 0
    v_mad_u32_u16 v236, v236, s75, v241 op_sel:[1,0,0,0]
    buffer_load_dwordx4 v236, s[16:19], 0 offen lds
    s_add_u32 m0, s74, 1040
    v_mad_u32_u16 v237, v237, s75, v241 op_sel:[1,0,0,0]
    buffer_load_dwordx4 v237, s[16:19], 0 offen lds
    s_add_u32 m0, s74, 2080
    v_mad_u32_u16 v238, v238, s75, v241 op_sel:[1,0,0,0]
    buffer_load_dwordx4 v238, s[16:19], 0 offen lds
    s_add_u32 m0, s74, 3120
    v_mad_u32_u16 v239, v239, s75, v241 op_sel:[1,0,0,0]
    buffer_load_dwordx4 v239, s[16:19], 0 offen lds
    s_add_u32 m0, s74, 4160
    v_add_u32 v240, v240, v242
    buffer_load_dwordx4 v240, s[20:23], 0 offen lds
K2_LATE0:
    s_cmp_lg_u32 s78, 2
    s_cbranch_scc1 K2_BUILT
    ds_read_b128 v[152:155], v235 offset:0
    ds_read_b128 v[156:159], v235 offset:16
    ds_read_b128 v[160:163], v235 offset:32
    ds_read_b128 v[164:167], v235 offset:48
    v_add_u32 v172, 8192, v172
    ds_read_b128 v[88:91], v172 offset:52736
    ds_read_b128 v[92:95], v172 offset:53760
    ds_read_b128 v[96:99], v172 offset:54784
    ds_read_b128 v[100:103], v172 offset:55808
    ds_read_b128 v[104:107], v172 offset:56832
    ds_read_b128 v[108:111], v172 offset:57856
    ds_read_b128 v[112:115], v172 offset:58880
    ds_read_b128 v[116:119], v172 offset:59904
    s_mov_b32 s10, 0x358637bd
    s_mov_b32 s11, s10
    v_mfma_f32_32x32x16_bf16 v[136:151], v[180:183], v[180:183], 0
    v_mov_b64 v[120:121], s[10:11]
    v_mov_b64 v[122:123], s[10:11]
    v_mov_b64 v[124:125], s[10:11]
    v_mov_b64 v[126:127], s[10:11]
    v_mov_b64 v[128:129], s[10:11]
    v_mov_b64 v[130:131], s[10:11]
    v_mov_b64 v[132:133], s[10:11]
    v_mov_b64 v[134:135], s[10:11]
    s_waitcnt lgkmcnt(7)
    v_mfma_f32_32x32x16_bf16 v[188:203], v[152:155], v[88:91], 0
    s_waitcnt lgkmcnt(6)
    v_mfma_f32_32x32x16_bf16 v[188:203], v[156:159], v[92:95], v[188:203]
    s_waitcnt lgkmcnt(5)
    v_mfma_f32_32x32x16_bf16 v[188:203], v[160:163], v[96:99], v[188:203]
    s_waitcnt lgkmcnt(4)
    v_mfma_f32_32x32x16_bf16 v[188:203], v[164:167], v[100:103], v[188:203]
    s_waitcnt lgkmcnt(3)
    v_mfma_f32_32x32x16_bf16 v[204:219], v[152:155], v[104:107], 0
    s_waitcnt lgkmcnt(2)
    v_mfma_f32_32x32x16_bf16 v[204:219], v[156:159], v[108:111], v[204:219]
    s_waitcnt lgkmcnt(1)
    v_mfma_f32_32x32x16_bf16 v[204:219], v[160:163], v[112:115], v[204:219]
    s_waitcnt lgkmcnt(0)
    v_mfma_f32_32x32x16_bf16 v[204:219], v[164:167], v[116:119], v[204:219]
    v_mfma_f32_32x32x16_bf16 v[104:119], v[180:183], v[180:183], 0
    v_mov_b64 v[88:89], s[10:11]
    v_mov_b64 v[90:91], s[10:11]
    v_mov_b64 v[92:93], s[10:11]
    v_mov_b64 v[94:95], s[10:11]
    v_mov_b64 v[96:97], s[10:11]
    v_mov_b64 v[98:99], s[10:11]
    v_mov_b64 v[100:101], s[10:11]
    v_mov_b64 v[102:103], s[10:11]
    s_mov_b32 s10, 0xbfb8aa3b
    v_mul_f32 v188, s10, v188
    v_mul_f32 v189, s10, v189
    v_mul_f32 v190, s10, v190
    v_mul_f32 v191, s10, v191
    v_mul_f32 v192, s10, v192
    v_mul_f32 v193, s10, v193
    v_mul_f32 v194, s10, v194
    v_mul_f32 v195, s10, v195
    v_mul_f32 v196, s10, v196
    v_mul_f32 v197, s10, v197
    v_mul_f32 v198, s10, v198
    v_mul_f32 v199, s10, v199
    v_mul_f32 v200, s10, v200
    v_mul_f32 v201, s10, v201
    v_mul_f32 v202, s10, v202
    v_mul_f32 v203, s10, v203
    v_mul_f32 v204, s10, v204
    v_mul_f32 v205, s10, v205
    v_mul_f32 v206, s10, v206
    v_mul_f32 v207, s10, v207
    v_mul_f32 v208, s10, v208
    v_mul_f32 v209, s10, v209
    v_mul_f32 v210, s10, v210
    v_mul_f32 v211, s10, v211
    v_mul_f32 v212, s10, v212
    v_mul_f32 v213, s10, v213
    v_mul_f32 v214, s10, v214
    v_mul_f32 v215, s10, v215
    v_mul_f32 v216, s10, v216
    v_mul_f32 v217, s10, v217
    v_mul_f32 v218, s10, v218
    v_mul_f32 v219, s10, v219
    v_cvt_pk_bf16_f32 v72, v188, v189
    v_cvt_pk_bf16_f32 v73, v190, v191
    v_cvt_pk_bf16_f32 v74, v192, v193
    v_cvt_pk_bf16_f32 v75, v194, v195
    v_cvt_pk_bf16_f32 v76, v196, v197
    v_cvt_pk_bf16_f32 v77, v198, v199
    v_cvt_pk_bf16_f32 v78, v200, v201
    v_cvt_pk_bf16_f32 v79, v202, v203
    v_cvt_pk_bf16_f32 v80, v204, v205
    v_cvt_pk_bf16_f32 v81, v206, v207
    v_cvt_pk_bf16_f32 v82, v208, v209
    v_cvt_pk_bf16_f32 v83, v210, v211
    v_cvt_pk_bf16_f32 v84, v212, v213
    v_cvt_pk_bf16_f32 v85, v214, v215
    v_cvt_pk_bf16_f32 v86, v216, v217
    v_cvt_pk_bf16_f32 v87, v218, v219
    s_mov_b32 s79, -1
    s_mov_b64 s[84:85], 0
    s_mov_b32 s81, 0
    s_mov_b32 s82, 0
    s_cmp_lg_u32 s80, 0
    s_cselect_b32 s78, 1, 0
K2_BUILT:
    s_waitcnt lgkmcnt(0)
    v_lshl_add_u32 v250, v250, 6, v245
    s_movk_i32 s10, 170
    s_bitcmp1_b32 s10, s3
    s_cbranch_scc1 K2_HAD0
    s_cmp_lt_i32 s37, 0
    s_cbranch_scc1 K2_SBY
    s_barrier
    s_mov_b32 s37, -1
K2_SBY:
    s_add_u32 m0, s74, 0
    v_mad_u32_u16 v236, v236, s75, v241 op_sel:[1,0,0,0]
    buffer_load_dwordx4 v236, s[16:19], 0 offen lds
    s_add_u32 m0, s74, 1040
    v_mad_u32_u16 v237, v237, s75, v241 op_sel:[1,0,0,0]
    buffer_load_dwordx4 v237, s[16:19], 0 offen lds
    s_add_u32 m0, s74, 2080
    v_mad_u32_u16 v238, v238, s75, v241 op_sel:[1,0,0,0]
    buffer_load_dwordx4 v238, s[16:19], 0 offen lds
    s_add_u32 m0, s74, 3120
    v_mad_u32_u16 v239, v239, s75, v241 op_sel:[1,0,0,0]
    buffer_load_dwordx4 v239, s[16:19], 0 offen lds
    s_add_u32 m0, s74, 4160
    v_add_u32 v240, v240, v242
    buffer_load_dwordx4 v240, s[20:23], 0 offen lds
K2_HAD0:
    ds_read_b128 v[236:239], v247 offset:128
    ds_read_b32 v240, v251 offset:128
    ds_read_b128 v[172:175], v250 offset:7424
    ds_read_b32 v176, v250 offset:7440
    v_mfma_f32_32x32x16_bf16 v[204:219], v[180:183], v[180:183], 0
    s_waitcnt vmcnt(0)
    ds_read_b128 v[168:171], v244
    ds_read_b128 v[152:155], v243 offset:0
    ds_read_b128 v[156:159], v243 offset:16
    ds_read_b128 v[160:163], v243 offset:32
    ds_read_b128 v[164:167], v243 offset:48
    s_waitcnt lgkmcnt(0)
    s_cmp_eq_u32 s73, 0
    s_cbranch_scc1 K2_DONE
    v_mfma_f32_32x32x16_bf16 v[188:203], v[168:171], v[64:67], 0
    v_mfma_f32_32x32x16_bf16 v[188:203], v[152:155], v[0:3], v[188:203]
    v_mfma_f32_32x32x16_bf16 v[188:203], v[156:159], v[4:7], v[188:203]
    v_mfma_f32_32x32x16_bf16 v[188:203], v[160:163], v[8:11], v[188:203]
    v_mfma_f32_32x32x16_bf16 v[188:203], v[164:167], v[12:15], v[188:203]
    s_add_u32 m0, s74, 0
    v_mad_u32_u16 v236, v236, s75, v241 op_sel:[1,0,0,0]
    buffer_load_dwordx4 v236, s[16:19], 0 offen lds
    s_add_u32 m0, s74, 1040
    v_mad_u32_u16 v237, v237, s75, v241 op_sel:[1,0,0,0]
    buffer_load_dwordx4 v237, s[16:19], 0 offen lds
    s_add_u32 m0, s74, 2080
    v_mad_u32_u16 v238, v238, s75, v241 op_sel:[1,0,0,0]
    buffer_load_dwordx4 v238, s[16:19], 0 offen lds
    s_add_u32 m0, s74, 3120
    v_mad_u32_u16 v239, v239, s75, v241 op_sel:[1,0,0,0]
    buffer_load_dwordx4 v239, s[16:19], 0 offen lds
    s_add_u32 m0, s74, 4160
    v_add_u32 v240, v240, v242
    buffer_load_dwordx4 v240, s[20:23], 0 offen lds
    v_smfmac_f32_32x32x32_bf16 v[188:203], v[172:175], v[72:79], v176
    s_mov_b32 s72, 0
    s_sub_u32 s10, s73, 1
    s_bitcmp1_b32 s3, 0
    s_cselect_b32 s6, s6, s10
    s_setprio 3
    s_mov_b32 s87, s73
    s_cmp_gt_i32 s4, s72
    s_cselect_b32 s10, s4, s87
    s_min_u32 s87, s87, s10
    s_cmp_gt_i32 s5, s72
    s_cselect_b32 s10, s5, s87
    s_min_u32 s87, s87, s10
    s_cmp_gt_i32 s6, s72
    s_cselect_b32 s10, s6, s87
    s_min_u32 s87, s87, s10
    s_cmp_gt_i32 s37, s72
    s_cselect_b32 s10, s37, s87
    s_min_u32 s87, s87, s10
.p2align 6
K2_LOOP:
    v_smfmac_f32_32x32x32_bf16 v[136:151], v[180:183], v[204:211], v177
    ds_read_u8 v236, v248 offset:0
    ds_read_u8 v237, v248 offset:4
    ds_read_u8 v238, v248 offset:16
    ds_read_u8 v239, v248 offset:20
    ds_read_u8 v250, v249 offset:128
    v_exp_f32 v188, v188
    v_exp_f32 v189, v189
    v_exp_f32 v190, v190
    v_add_f32 v188, 1.0, v188
    v_smfmac_f32_32x32x32_bf16 v[136:151], v[184:187], v[212:219], v177
    v_exp_f32 v191, v191
    v_add_f32 v189, 1.0, v189
    v_exp_f32 v192, v192
    v_add_f32 v190, 1.0, v190
    v_rcp_f32 v188, v188
    v_mfma_f32_32x32x16_bf16 v[220:235], v[168:171], v[68:71], 0
    v_exp_f32 v193, v193
    v_add_f32 v191, 1.0, v191
    v_rcp_f32 v189, v189
    v_exp_f32 v194, v194
    v_mfma_f32_32x32x16_bf16 v[204:219], v[152:155], v[32:35], 0
    v_add_f32 v192, 1.0, v192
    v_rcp_f32 v190, v190
    v_exp_f32 v195, v195
    v_mfma_f32_32x32x16_bf16 v[204:219], v[156:159], v[36:39], v[204:219]
    s_waitcnt lgkmcnt(0)
    v_lshl_add_u32 v236, v236, 6, v246
    v_lshl_add_u32 v237, v237, 6, v246
    v_lshl_add_u32 v238, v238, 6, v246
    v_lshl_add_u32 v239, v239, 6, v246
    v_lshl_add_u32 v250, v250, 6, v245
    v_add_f32 v193, 1.0, v193
    v_rcp_f32 v191, v191
    v_exp_f32 v196, v196
    v_add_f32 v194, 1.0, v194
    v_rcp_f32 v192, v192
    v_smfmac_f32_32x32x32_bf16 v[220:235], v[172:175], v[80:87], v176
    ds_read_b64_tr_b16 v[180:181], v236
    ds_read_b64_tr_b16 v[182:183], v237
    ds_read_b64_tr_b16 v[184:185], v238
    ds_read_b64_tr_b16 v[186:187], v239
    ds_read_b128 v[172:175], v250 offset:7424
    ds_read_b32 v176, v250 offset:7440
    v_exp_f32 v197, v197
    v_add_f32 v195, 1.0, v195
    v_rcp_f32 v193, v193
    v_exp_f32 v198, v198
    v_mfma_f32_32x32x16_bf16 v[204:219], v[160:163], v[40:43], v[204:219]
    v_add_f32 v196, 1.0, v196
    v_rcp_f32 v194, v194
    v_exp_f32 v199, v199
    v_add_f32 v197, 1.0, v197
    v_mfma_f32_32x32x16_bf16 v[204:219], v[164:167], v[44:47], v[204:219]
    v_rcp_f32 v195, v195
    v_exp_f32 v200, v200
    v_add_f32 v198, 1.0, v198
    v_rcp_f32 v196, v196
    v_mfma_f32_32x32x16_bf16 v[220:235], v[152:155], v[16:19], v[220:235]
    ds_read_b128 v[236:239], v247 offset:256
    ds_read_b32 v240, v251 offset:256
    s_add_u32 s72, s72, 1
    v_exp_f32 v201, v201
    v_add_f32 v199, 1.0, v199
    v_rcp_f32 v197, v197
    v_exp_f32 v202, v202
    v_mfma_f32_32x32x16_bf16 v[220:235], v[156:159], v[20:23], v[220:235]
    v_add_f32 v200, 1.0, v200
    v_rcp_f32 v198, v198
    v_exp_f32 v203, v203
    v_add_f32 v201, 1.0, v201
    v_mfma_f32_32x32x16_bf16 v[220:235], v[160:163], v[24:27], v[220:235]
    v_rcp_f32 v199, v199
    v_add_f32 v202, 1.0, v202
    v_rcp_f32 v200, v200
    v_add_f32 v203, 1.0, v203
    v_rcp_f32 v201, v201
    v_mfma_f32_32x32x16_bf16 v[220:235], v[164:167], v[28:31], v[220:235]
    v_rcp_f32 v202, v202
    v_rcp_f32 v203, v203
    v_mul_f32 v204, v188, v204
    v_mul_f32 v205, v189, v205
    s_waitcnt lgkmcnt(0)
    v_smfmac_f32_32x32x32_bf16 v[88:103], v[180:183], v[188:195], v177
    v_mul_f32 v206, v190, v206
    v_mul_f32 v207, v191, v207
    v_mul_f32 v208, v192, v208
    v_mul_f32 v209, v193, v209
    v_mul_f32 v210, v194, v210
    v_mul_f32 v211, v195, v211
    v_mul_f32 v212, v196, v212
    v_smfmac_f32_32x32x32_bf16 v[88:103], v[184:187], v[196:203], v177
    v_mul_f32 v213, v197, v213
    v_mul_f32 v214, v198, v214
    v_mul_f32 v215, v199, v215
    v_mul_f32 v216, v200, v216
    v_mul_f32 v217, v201, v217
    v_mul_f32 v218, v202, v218
    v_mul_f32 v219, v203, v219
    v_smfmac_f32_32x32x32_bf16 v[104:119], v[180:183], v[204:211], v177
    s_waitcnt vmcnt(0)
    ds_read_b128 v[168:171], v244
    v_exp_f32 v220, v220
    v_exp_f32 v221, v221
    v_exp_f32 v222, v222
    v_add_f32 v220, 1.0, v220
    v_smfmac_f32_32x32x32_bf16 v[104:119], v[184:187], v[212:219], v177
    v_exp_f32 v223, v223
    v_add_f32 v221, 1.0, v221
    v_exp_f32 v224, v224
    v_add_f32 v222, 1.0, v222
    v_rcp_f32 v220, v220
    s_waitcnt lgkmcnt(0)
    v_mfma_f32_32x32x16_bf16 v[188:203], v[168:171], v[64:67], 0
    v_exp_f32 v225, v225
    v_add_f32 v223, 1.0, v223
    v_rcp_f32 v221, v221
    v_exp_f32 v226, v226
    v_mfma_f32_32x32x16_bf16 v[204:219], v[152:155], v[48:51], 0
    ds_read_b128 v[152:155], v243 offset:0
    v_add_f32 v224, 1.0, v224
    v_rcp_f32 v222, v222
    v_exp_f32 v227, v227
    v_mfma_f32_32x32x16_bf16 v[204:219], v[156:159], v[52:55], v[204:219]
    ds_read_b128 v[156:159], v243 offset:16
    v_add_f32 v225, 1.0, v225
    v_rcp_f32 v223, v223
    v_exp_f32 v228, v228
    v_add_f32 v226, 1.0, v226
    v_rcp_f32 v224, v224
    v_smfmac_f32_32x32x32_bf16 v[188:203], v[172:175], v[72:79], v176
    v_exp_f32 v229, v229
    v_add_f32 v227, 1.0, v227
    v_rcp_f32 v225, v225
    v_exp_f32 v230, v230
    v_mfma_f32_32x32x16_bf16 v[204:219], v[160:163], v[56:59], v[204:219]
    ds_read_b128 v[160:163], v243 offset:32
    v_add_f32 v228, 1.0, v228
    v_rcp_f32 v226, v226
    v_exp_f32 v231, v231
    v_add_f32 v229, 1.0, v229
    v_mfma_f32_32x32x16_bf16 v[204:219], v[164:167], v[60:63], v[204:219]
    ds_read_b128 v[164:167], v243 offset:48
    v_rcp_f32 v227, v227
    v_exp_f32 v232, v232
    v_add_f32 v230, 1.0, v230
    v_rcp_f32 v228, v228
    s_waitcnt lgkmcnt(3)
    v_mfma_f32_32x32x16_bf16 v[188:203], v[152:155], v[0:3], v[188:203]
    v_exp_f32 v233, v233
    v_add_f32 v231, 1.0, v231
    v_rcp_f32 v229, v229
    v_exp_f32 v234, v234
    s_waitcnt lgkmcnt(2)
    v_mfma_f32_32x32x16_bf16 v[188:203], v[156:159], v[4:7], v[188:203]
    v_add_f32 v232, 1.0, v232
    v_rcp_f32 v230, v230
    v_exp_f32 v235, v235
    v_add_f32 v233, 1.0, v233
    s_waitcnt lgkmcnt(1)
    v_mfma_f32_32x32x16_bf16 v[188:203], v[160:163], v[8:11], v[188:203]
    v_rcp_f32 v231, v231
    v_add_f32 v234, 1.0, v234
    v_rcp_f32 v232, v232
    v_add_f32 v235, 1.0, v235
    v_rcp_f32 v233, v233
    s_waitcnt lgkmcnt(0)
    v_mfma_f32_32x32x16_bf16 v[188:203], v[164:167], v[12:15], v[188:203]
    s_cmp_lt_i32 s72, s38
    s_cbranch_scc0 K2_ND_0
    s_add_u32 m0, s74, 0
    v_mad_u32_u16 v236, v236, s75, v241 op_sel:[1,0,0,0]
    buffer_load_dwordx4 v236, s[16:19], 0 offen lds
    s_add_u32 m0, s74, 1040
    v_mad_u32_u16 v237, v237, s75, v241 op_sel:[1,0,0,0]
    buffer_load_dwordx4 v237, s[16:19], 0 offen lds
    s_add_u32 m0, s74, 2080
    v_mad_u32_u16 v238, v238, s75, v241 op_sel:[1,0,0,0]
    buffer_load_dwordx4 v238, s[16:19], 0 offen lds
    s_add_u32 m0, s74, 3120
    v_mad_u32_u16 v239, v239, s75, v241 op_sel:[1,0,0,0]
    buffer_load_dwordx4 v239, s[16:19], 0 offen lds
    s_add_u32 m0, s74, 4160
    v_add_u32 v240, v240, v242
    buffer_load_dwordx4 v240, s[20:23], 0 offen lds
K2_ND_0:
    v_rcp_f32 v234, v234
    v_rcp_f32 v235, v235
    v_mul_f32 v204, v220, v204
    v_mul_f32 v205, v221, v205
    v_smfmac_f32_32x32x32_bf16 v[120:135], v[180:183], v[220:227], v177
    v_mul_f32 v206, v222, v206
    v_mul_f32 v207, v223, v207
    v_mul_f32 v208, v224, v208
    v_mul_f32 v209, v225, v209
    v_mul_f32 v210, v226, v210
    v_mul_f32 v211, v227, v211
    v_mul_f32 v212, v228, v212
    v_smfmac_f32_32x32x32_bf16 v[120:135], v[184:187], v[228:235], v177
    v_mul_f32 v213, v229, v213
    v_mul_f32 v214, v230, v214
    v_mul_f32 v215, v231, v215
    v_mul_f32 v216, v232, v216
    v_mul_f32 v217, v233, v217
    v_mul_f32 v218, v234, v218
    v_mul_f32 v219, v235, v219
    s_cmp_ge_u32 s72, s87
    s_cbranch_scc1 K2_EV0
K2_EVR0:
    v_smfmac_f32_32x32x32_bf16 v[136:151], v[180:183], v[204:211], v177
    ds_read_u8 v236, v248 offset:128
    ds_read_u8 v237, v248 offset:132
    ds_read_u8 v238, v248 offset:144
    ds_read_u8 v239, v248 offset:148
    ds_read_u8 v250, v249 offset:256
    v_exp_f32 v188, v188
    v_exp_f32 v189, v189
    v_exp_f32 v190, v190
    v_add_f32 v188, 1.0, v188
    v_smfmac_f32_32x32x32_bf16 v[136:151], v[184:187], v[212:219], v177
    v_exp_f32 v191, v191
    v_add_f32 v189, 1.0, v189
    v_exp_f32 v192, v192
    v_add_f32 v190, 1.0, v190
    v_rcp_f32 v188, v188
    v_mfma_f32_32x32x16_bf16 v[220:235], v[168:171], v[68:71], 0
    v_exp_f32 v193, v193
    v_add_f32 v191, 1.0, v191
    v_rcp_f32 v189, v189
    v_exp_f32 v194, v194
    v_mfma_f32_32x32x16_bf16 v[204:219], v[152:155], v[32:35], 0
    v_add_f32 v192, 1.0, v192
    v_rcp_f32 v190, v190
    v_exp_f32 v195, v195
    v_mfma_f32_32x32x16_bf16 v[204:219], v[156:159], v[36:39], v[204:219]
    s_waitcnt lgkmcnt(0)
    v_lshl_add_u32 v236, v236, 6, v246
    v_lshl_add_u32 v237, v237, 6, v246
    v_lshl_add_u32 v238, v238, 6, v246
    v_lshl_add_u32 v239, v239, 6, v246
    v_lshl_add_u32 v250, v250, 6, v245
    v_add_f32 v193, 1.0, v193
    v_rcp_f32 v191, v191
    v_exp_f32 v196, v196
    v_add_f32 v194, 1.0, v194
    v_rcp_f32 v192, v192
    v_smfmac_f32_32x32x32_bf16 v[220:235], v[172:175], v[80:87], v176
    ds_read_b64_tr_b16 v[180:181], v236
    ds_read_b64_tr_b16 v[182:183], v237
    ds_read_b64_tr_b16 v[184:185], v238
    ds_read_b64_tr_b16 v[186:187], v239
    ds_read_b128 v[172:175], v250 offset:7424
    ds_read_b32 v176, v250 offset:7440
    v_exp_f32 v197, v197
    v_add_f32 v195, 1.0, v195
    v_rcp_f32 v193, v193
    v_exp_f32 v198, v198
    v_mfma_f32_32x32x16_bf16 v[204:219], v[160:163], v[40:43], v[204:219]
    v_add_f32 v196, 1.0, v196
    v_rcp_f32 v194, v194
    v_exp_f32 v199, v199
    v_add_f32 v197, 1.0, v197
    v_mfma_f32_32x32x16_bf16 v[204:219], v[164:167], v[44:47], v[204:219]
    v_rcp_f32 v195, v195
    v_exp_f32 v200, v200
    v_add_f32 v198, 1.0, v198
    v_rcp_f32 v196, v196
    v_mfma_f32_32x32x16_bf16 v[220:235], v[152:155], v[16:19], v[220:235]
    ds_read_b128 v[236:239], v247 offset:384
    ds_read_b32 v240, v251 offset:384
    s_add_u32 s72, s72, 1
    v_exp_f32 v201, v201
    v_add_f32 v199, 1.0, v199
    v_rcp_f32 v197, v197
    v_exp_f32 v202, v202
    v_mfma_f32_32x32x16_bf16 v[220:235], v[156:159], v[20:23], v[220:235]
    v_add_f32 v200, 1.0, v200
    v_rcp_f32 v198, v198
    v_exp_f32 v203, v203
    v_add_f32 v201, 1.0, v201
    v_mfma_f32_32x32x16_bf16 v[220:235], v[160:163], v[24:27], v[220:235]
    v_rcp_f32 v199, v199
    v_add_f32 v202, 1.0, v202
    v_rcp_f32 v200, v200
    v_add_f32 v203, 1.0, v203
    v_rcp_f32 v201, v201
    v_mfma_f32_32x32x16_bf16 v[220:235], v[164:167], v[28:31], v[220:235]
    v_rcp_f32 v202, v202
    v_rcp_f32 v203, v203
    v_mul_f32 v204, v188, v204
    v_mul_f32 v205, v189, v205
    s_waitcnt lgkmcnt(0)
    v_smfmac_f32_32x32x32_bf16 v[88:103], v[180:183], v[188:195], v177
    v_mul_f32 v206, v190, v206
    v_mul_f32 v207, v191, v207
    v_mul_f32 v208, v192, v208
    v_mul_f32 v209, v193, v209
    v_mul_f32 v210, v194, v210
    v_mul_f32 v211, v195, v211
    v_mul_f32 v212, v196, v212
    v_smfmac_f32_32x32x32_bf16 v[88:103], v[184:187], v[196:203], v177
    v_mul_f32 v213, v197, v213
    v_mul_f32 v214, v198, v214
    v_mul_f32 v215, v199, v215
    v_mul_f32 v216, v200, v216
    v_mul_f32 v217, v201, v217
    v_mul_f32 v218, v202, v218
    v_mul_f32 v219, v203, v219
    v_smfmac_f32_32x32x32_bf16 v[104:119], v[180:183], v[204:211], v177
    s_waitcnt vmcnt(0)
    ds_read_b128 v[168:171], v244
    v_exp_f32 v220, v220
    v_exp_f32 v221, v221
    v_exp_f32 v222, v222
    v_add_f32 v220, 1.0, v220
    v_smfmac_f32_32x32x32_bf16 v[104:119], v[184:187], v[212:219], v177
    v_exp_f32 v223, v223
    v_add_f32 v221, 1.0, v221
    v_exp_f32 v224, v224
    v_add_f32 v222, 1.0, v222
    v_rcp_f32 v220, v220
    s_waitcnt lgkmcnt(0)
    v_mfma_f32_32x32x16_bf16 v[188:203], v[168:171], v[64:67], 0
    v_exp_f32 v225, v225
    v_add_f32 v223, 1.0, v223
    v_rcp_f32 v221, v221
    v_exp_f32 v226, v226
    v_mfma_f32_32x32x16_bf16 v[204:219], v[152:155], v[48:51], 0
    ds_read_b128 v[152:155], v243 offset:0
    v_add_f32 v224, 1.0, v224
    v_rcp_f32 v222, v222
    v_exp_f32 v227, v227
    v_mfma_f32_32x32x16_bf16 v[204:219], v[156:159], v[52:55], v[204:219]
    ds_read_b128 v[156:159], v243 offset:16
    v_add_f32 v225, 1.0, v225
    v_rcp_f32 v223, v223
    v_exp_f32 v228, v228
    v_add_f32 v226, 1.0, v226
    v_rcp_f32 v224, v224
    v_smfmac_f32_32x32x32_bf16 v[188:203], v[172:175], v[72:79], v176
    v_exp_f32 v229, v229
    v_add_f32 v227, 1.0, v227
    v_rcp_f32 v225, v225
    v_exp_f32 v230, v230
    v_mfma_f32_32x32x16_bf16 v[204:219], v[160:163], v[56:59], v[204:219]
    ds_read_b128 v[160:163], v243 offset:32
    v_add_f32 v228, 1.0, v228
    v_rcp_f32 v226, v226
    v_exp_f32 v231, v231
    v_add_f32 v229, 1.0, v229
    v_mfma_f32_32x32x16_bf16 v[204:219], v[164:167], v[60:63], v[204:219]
    ds_read_b128 v[164:167], v243 offset:48
    v_rcp_f32 v227, v227
    v_exp_f32 v232, v232
    v_add_f32 v230, 1.0, v230
    v_rcp_f32 v228, v228
    s_waitcnt lgkmcnt(3)
    v_mfma_f32_32x32x16_bf16 v[188:203], v[152:155], v[0:3], v[188:203]
    v_exp_f32 v233, v233
    v_add_f32 v231, 1.0, v231
    v_rcp_f32 v229, v229
    v_exp_f32 v234, v234
    s_waitcnt lgkmcnt(2)
    v_mfma_f32_32x32x16_bf16 v[188:203], v[156:159], v[4:7], v[188:203]
    v_add_f32 v232, 1.0, v232
    v_rcp_f32 v230, v230
    v_exp_f32 v235, v235
    v_add_f32 v233, 1.0, v233
    s_waitcnt lgkmcnt(1)
    v_mfma_f32_32x32x16_bf16 v[188:203], v[160:163], v[8:11], v[188:203]
    v_rcp_f32 v231, v231
    v_add_f32 v234, 1.0, v234
    v_rcp_f32 v232, v232
    v_add_f32 v235, 1.0, v235
    v_rcp_f32 v233, v233
    s_waitcnt lgkmcnt(0)
    v_mfma_f32_32x32x16_bf16 v[188:203], v[164:167], v[12:15], v[188:203]
    s_cmp_lt_i32 s72, s38
    s_cbranch_scc0 K2_ND_1
    s_add_u32 m0, s74, 0
    v_mad_u32_u16 v236, v236, s75, v241 op_sel:[1,0,0,0]
    buffer_load_dwordx4 v236, s[16:19], 0 offen lds
    s_add_u32 m0, s74, 1040
    v_mad_u32_u16 v237, v237, s75, v241 op_sel:[1,0,0,0]
    buffer_load_dwordx4 v237, s[16:19], 0 offen lds
    s_add_u32 m0, s74, 2080
    v_mad_u32_u16 v238, v238, s75, v241 op_sel:[1,0,0,0]
    buffer_load_dwordx4 v238, s[16:19], 0 offen lds
    s_add_u32 m0, s74, 3120
    v_mad_u32_u16 v239, v239, s75, v241 op_sel:[1,0,0,0]
    buffer_load_dwordx4 v239, s[16:19], 0 offen lds
    s_add_u32 m0, s74, 4160
    v_add_u32 v240, v240, v242
    buffer_load_dwordx4 v240, s[20:23], 0 offen lds
K2_ND_1:
    v_rcp_f32 v234, v234
    v_rcp_f32 v235, v235
    v_mul_f32 v204, v220, v204
    v_mul_f32 v205, v221, v205
    v_smfmac_f32_32x32x32_bf16 v[120:135], v[180:183], v[220:227], v177
    v_mul_f32 v206, v222, v206
    v_mul_f32 v207, v223, v207
    v_mul_f32 v208, v224, v208
    v_mul_f32 v209, v225, v209
    v_mul_f32 v210, v226, v210
    v_mul_f32 v211, v227, v211
    v_mul_f32 v212, v228, v212
    v_smfmac_f32_32x32x32_bf16 v[120:135], v[184:187], v[228:235], v177
    v_mul_f32 v213, v229, v213
    v_mul_f32 v214, v230, v214
    v_mul_f32 v215, v231, v215
    v_mul_f32 v216, v232, v216
    v_mul_f32 v217, v233, v217
    v_mul_f32 v218, v234, v218
    v_mul_f32 v219, v235, v219
    v_add_u32 v247, 0x100, v247
    v_add_u32 v249, 0x100, v249
    v_add_u32 v251, 0x100, v251
    v_add_u32 v248, 0x100, v248
    s_cmp_lt_u32 s72, s87
    s_cbranch_scc1 K2_LOOP
    s_cmp_ge_u32 s72, s73
    s_cbranch_scc1 K2_TAIL
    s_cmp_lg_u32 s72, s37
    s_cbranch_scc1 K2_SB1
    s_barrier
    s_mov_b32 s37, -1
K2_SB1:
    s_cmp_lg_u32 s72, s4
    s_cbranch_scc1 K2_PR1_0
    s_setprio 2
K2_PR1_0:
    s_cmp_lg_u32 s72, s5
    s_cbranch_scc1 K2_PR1_1
    s_setprio 1
K2_PR1_1:
    s_cmp_lg_u32 s72, s6
    s_cbranch_scc1 K2_PR1_2
    s_setprio 0
K2_PR1_2:
    s_mov_b32 s87, s73
    s_cmp_gt_i32 s4, s72
    s_cselect_b32 s10, s4, s87
    s_min_u32 s87, s87, s10
    s_cmp_gt_i32 s5, s72
    s_cselect_b32 s10, s5, s87
    s_min_u32 s87, s87, s10
    s_cmp_gt_i32 s6, s72
    s_cselect_b32 s10, s6, s87
    s_min_u32 s87, s87, s10
    s_cmp_gt_i32 s37, s72
    s_cselect_b32 s10, s37, s87
    s_min_u32 s87, s87, s10
    s_branch K2_LOOP
K2_EV0:
    s_cmp_ge_u32 s72, s73
    s_cbranch_scc1 K2_TAIL
    s_cmp_lg_u32 s72, s37
    s_cbranch_scc1 K2_SB0
    s_barrier
    s_mov_b32 s37, -1
K2_SB0:
    s_cmp_lg_u32 s72, s4
    s_cbranch_scc1 K2_PR0_0
    s_setprio 2
K2_PR0_0:
    s_cmp_lg_u32 s72, s5
    s_cbranch_scc1 K2_PR0_1
    s_setprio 1
K2_PR0_1:
    s_cmp_lg_u32 s72, s6
    s_cbranch_scc1 K2_PR0_2
    s_setprio 0
K2_PR0_2:
    s_mov_b32 s87, s73
    s_cmp_gt_i32 s4, s72
    s_cselect_b32 s10, s4, s87
    s_min_u32 s87, s87, s10
    s_cmp_gt_i32 s5, s72
    s_cselect_b32 s10, s5, s87
    s_min_u32 s87, s87, s10
    s_cmp_gt_i32 s6, s72
    s_cselect_b32 s10, s6, s87
    s_min_u32 s87, s87, s10
    s_cmp_gt_i32 s37, s72
    s_cselect_b32 s10, s37, s87
    s_min_u32 s87, s87, s10
    s_branch K2_EVR0
K2_TAIL:
    v_smfmac_f32_32x32x32_bf16 v[136:151], v[180:183], v[204:211], v177
    v_smfmac_f32_32x32x32_bf16 v[136:151], v[184:187], v[212:219], v177
K2_DONE:
    s_cmp_lt_i32 s37, 0
    s_cbranch_scc1 K2_SBD
    s_barrier
    s_mov_b32 s37, -1
K2_SBD:
    s_cmp_lg_u32 s78, 0
    s_cbranch_scc1 K2_SLOW
K2_EPI:
    v_lshlrev_b32 v252, 4, v254
    ds_read_b128 v[152:155], v253 offset:0
    ds_read_b128 v[156:159], v253 offset:16
    ds_read_b128 v[160:163], v253 offset:32
    ds_read_b128 v[164:167], v253 offset:48
    ds_read_b128 v[0:3], v252 offset:52736
    ds_read_b128 v[4:7], v252 offset:53760
    ds_read_b128 v[8:11], v252 offset:54784
    ds_read_b128 v[12:15], v252 offset:55808
    ds_read_b128 v[16:19], v252 offset:56832
    ds_read_b128 v[20:23], v252 offset:57856
    ds_read_b128 v[24:27], v252 offset:58880
    ds_read_b128 v[28:31], v252 offset:59904
    v_and_b32 v237, 31, v254
    v_and_b32 v245, 32, v254
    v_mul_u32_u24 v246, 144, v237
    v_lshrrev_b32 v238, 2, v245
    v_lshl_add_u32 v237, v237, 6, v238
    ds_read2_b64 v[180:183], v237 offset0:0 offset1:2
    ds_read2_b64 v[184:187], v237 offset0:4 offset1:6
    s_waitcnt lgkmcnt(10)
    v_lshlrev_b32 v32, 16, v152
    v_and_b32 v33, 0xffff0000, v152
    v_lshlrev_b32 v34, 16, v153
    v_and_b32 v35, 0xffff0000, v153
    v_lshlrev_b32 v36, 16, v154
    v_and_b32 v37, 0xffff0000, v154
    v_lshlrev_b32 v38, 16, v155
    v_and_b32 v39, 0xffff0000, v155
    v_lshlrev_b32 v40, 16, v156
    v_and_b32 v41, 0xffff0000, v156
    v_lshlrev_b32 v42, 16, v157
    v_and_b32 v43, 0xffff0000, v157
    v_lshlrev_b32 v44, 16, v158
    v_and_b32 v45, 0xffff0000, v158
    v_lshlrev_b32 v46, 16, v159
    v_and_b32 v47, 0xffff0000, v159
    v_lshlrev_b32 v48, 16, v160
    v_and_b32 v49, 0xffff0000, v160
    v_lshlrev_b32 v50, 16, v161
    v_and_b32 v51, 0xffff0000, v161
    v_lshlrev_b32 v52, 16, v162
    v_and_b32 v53, 0xffff0000, v162
    v_lshlrev_b32 v54, 16, v163
    v_and_b32 v55, 0xffff0000, v163
    v_lshlrev_b32 v56, 16, v164
    v_and_b32 v57, 0xffff0000, v164
    v_lshlrev_b32 v58, 16, v165
    v_and_b32 v59, 0xffff0000, v165
    v_lshlrev_b32 v60, 16, v166
    v_and_b32 v61, 0xffff0000, v166
    v_lshlrev_b32 v62, 16, v167
    v_and_b32 v63, 0xffff0000, v167
    v_lshl_add_u32 v253, v245, 1, v246
    v_add_u32 v253, s74, v253
    s_sub_u32 s10, s13, s96
    s_mul_i32 s10, s10, 144
    s_add_u32 s10, s10, s74
    v_lshrrev_b32 v236, 3, v254
    v_lshl_add_u32 v236, v236, 4, v252
    v_add_u32 v236, s10, v236
    s_mul_i32 s10, s12, 196
    s_add_u32 s11, s10, s14
    s_add_u32 s10, s10, s13
    s_min_u32 s11, s11, 50000
    s_min_u32 s10, s10, 50000
    s_sub_u32 s11, s11, s10
    s_lshl_b32 s10, s10, 7
    s_add_u32 s28, s28, s10
    s_addc_u32 s29, s29, 0
    s_lshl_b32 s30, s11, 7
    s_waitcnt lgkmcnt(9)
    v_mfma_f32_32x32x16_bf16 v[188:203], v[0:3], v[152:155], v[32:47]
    v_rcp_f32 v88, v88
    v_rcp_f32 v89, v89
    v_rcp_f32 v90, v90
    v_rcp_f32 v91, v91
    s_waitcnt lgkmcnt(8)
    v_mfma_f32_32x32x16_bf16 v[188:203], v[4:7], v[156:159], v[188:203]
    v_rcp_f32 v92, v92
    v_rcp_f32 v93, v93
    v_rcp_f32 v94, v94
    v_rcp_f32 v95, v95
    s_waitcnt lgkmcnt(7)
    v_mfma_f32_32x32x16_bf16 v[188:203], v[8:11], v[160:163], v[188:203]
    v_rcp_f32 v96, v96
    v_rcp_f32 v97, v97
    v_rcp_f32 v98, v98
    v_rcp_f32 v99, v99
    s_waitcnt lgkmcnt(6)
    v_mfma_f32_32x32x16_bf16 v[188:203], v[12:15], v[164:167], v[188:203]
    v_rcp_f32 v100, v100
    v_rcp_f32 v101, v101
    v_rcp_f32 v102, v102
    v_rcp_f32 v103, v103
    s_waitcnt lgkmcnt(5)
    v_mfma_f32_32x32x16_bf16 v[204:219], v[16:19], v[152:155], v[48:63]
    v_rcp_f32 v120, v120
    v_rcp_f32 v121, v121
    v_rcp_f32 v122, v122
    v_rcp_f32 v123, v123
    s_waitcnt lgkmcnt(4)
    v_mfma_f32_32x32x16_bf16 v[204:219], v[20:23], v[156:159], v[204:219]
    v_rcp_f32 v124, v124
    v_rcp_f32 v125, v125
    v_rcp_f32 v126, v126
    v_rcp_f32 v127, v127
    s_waitcnt lgkmcnt(3)
    v_mfma_f32_32x32x16_bf16 v[204:219], v[24:27], v[160:163], v[204:219]
    v_rcp_f32 v128, v128
    v_rcp_f32 v129, v129
    v_rcp_f32 v130, v130
    v_rcp_f32 v131, v131
    s_waitcnt lgkmcnt(2)
    v_mfma_f32_32x32x16_bf16 v[204:219], v[28:31], v[164:167], v[204:219]
    v_rcp_f32 v132, v132
    v_rcp_f32 v133, v133
    v_rcp_f32 v134, v134
    v_rcp_f32 v135, v135
    s_waitcnt lgkmcnt(0)
    v_mul_f32 v104, v104, v88
    v_mul_f32 v105, v105, v89
    v_mul_f32 v106, v106, v90
    v_mul_f32 v107, v107, v91
    v_mul_f32 v108, v108, v92
    v_mul_f32 v109, v109, v93
    v_mul_f32 v110, v110, v94
    v_mul_f32 v111, v111, v95
    v_mul_f32 v112, v112, v96
    v_mul_f32 v113, v113, v97
    v_mul_f32 v114, v114, v98
    v_mul_f32 v115, v115, v99
    v_mul_f32 v116, v116, v100
    v_mul_f32 v117, v117, v101
    v_mul_f32 v118, v118, v102
    v_mul_f32 v119, v119, v103
    v_cvt_pk_bf16_f32 v88, v104, v105
    v_cvt_pk_bf16_f32 v89, v106, v107
    v_cvt_pk_bf16_f32 v90, v108, v109
    v_cvt_pk_bf16_f32 v91, v110, v111
    v_cvt_pk_bf16_f32 v92, v112, v113
    v_cvt_pk_bf16_f32 v93, v114, v115
    v_cvt_pk_bf16_f32 v94, v116, v117
    v_cvt_pk_bf16_f32 v95, v118, v119
    v_mfma_f32_32x32x16_bf16 v[188:203], v[88:91], v[180:183], v[188:203]
    s_nop 0
    v_mfma_f32_32x32x16_bf16 v[188:203], v[92:95], v[184:187], v[188:203]
    v_mul_f32 v136, v136, v120
    v_mul_f32 v137, v137, v121
    v_mul_f32 v138, v138, v122
    v_mul_f32 v139, v139, v123
    v_mul_f32 v140, v140, v124
    v_mul_f32 v141, v141, v125
    v_mul_f32 v142, v142, v126
    v_mul_f32 v143, v143, v127
    v_mul_f32 v144, v144, v128
    v_mul_f32 v145, v145, v129
    v_mul_f32 v146, v146, v130
    v_mul_f32 v147, v147, v131
    v_mul_f32 v148, v148, v132
    v_mul_f32 v149, v149, v133
    v_mul_f32 v150, v150, v134
    v_mul_f32 v151, v151, v135
    v_cvt_pk_bf16_f32 v120, v136, v137
    v_cvt_pk_bf16_f32 v121, v138, v139
    v_cvt_pk_bf16_f32 v122, v140, v141
    v_cvt_pk_bf16_f32 v123, v142, v143
    v_cvt_pk_bf16_f32 v124, v144, v145
    v_cvt_pk_bf16_f32 v125, v146, v147
    v_cvt_pk_bf16_f32 v126, v148, v149
    v_cvt_pk_bf16_f32 v127, v150, v151
    v_mfma_f32_32x32x16_bf16 v[204:219], v[120:123], v[180:183], v[204:219]
    s_nop 0
    v_mfma_f32_32x32x16_bf16 v[204:219], v[124:127], v[184:187], v[204:219]
    v_max_f32 v188, v188, v32
    v_max_f32 v189, v189, v33
    v_max_f32 v190, v190, v34
    v_max_f32 v191, v191, v35
    v_max_f32 v192, v192, v36
    v_max_f32 v193, v193, v37
    v_max_f32 v194, v194, v38
    v_max_f32 v195, v195, v39
    v_cvt_pk_bf16_f32 v220, v188, v189
    v_cvt_pk_bf16_f32 v221, v190, v191
    v_cvt_pk_bf16_f32 v222, v192, v193
    v_cvt_pk_bf16_f32 v223, v194, v195
    ds_write_b128 v253, v[220:223] offset:0
    v_max_f32 v196, v196, v40
    v_max_f32 v197, v197, v41
    v_max_f32 v198, v198, v42
    v_max_f32 v199, v199, v43
    v_max_f32 v200, v200, v44
    v_max_f32 v201, v201, v45
    v_max_f32 v202, v202, v46
    v_max_f32 v203, v203, v47
    v_cvt_pk_bf16_f32 v224, v196, v197
    v_cvt_pk_bf16_f32 v225, v198, v199
    v_cvt_pk_bf16_f32 v226, v200, v201
    v_cvt_pk_bf16_f32 v227, v202, v203
    ds_write_b128 v253, v[224:227] offset:16
    v_max_f32 v204, v204, v48
    v_max_f32 v205, v205, v49
    v_max_f32 v206, v206, v50
    v_max_f32 v207, v207, v51
    v_max_f32 v208, v208, v52
    v_max_f32 v209, v209, v53
    v_max_f32 v210, v210, v54
    v_max_f32 v211, v211, v55
    v_cvt_pk_bf16_f32 v228, v204, v205
    v_cvt_pk_bf16_f32 v229, v206, v207
    v_cvt_pk_bf16_f32 v230, v208, v209
    v_cvt_pk_bf16_f32 v231, v210, v211
    ds_write_b128 v253, v[228:231] offset:32
    v_max_f32 v212, v212, v56
    v_max_f32 v213, v213, v57
    v_max_f32 v214, v214, v58
    v_max_f32 v215, v215, v59
    v_max_f32 v216, v216, v60
    v_max_f32 v217, v217, v61
    v_max_f32 v218, v218, v62
    v_max_f32 v219, v219, v63
    v_cvt_pk_bf16_f32 v232, v212, v213
    v_cvt_pk_bf16_f32 v233, v214, v215
    v_cvt_pk_bf16_f32 v234, v216, v217
    v_cvt_pk_bf16_f32 v235, v218, v219
    ds_write_b128 v253, v[232:235] offset:48
    ds_read_b128 v[152:155], v236 offset:0
    ds_read_b128 v[156:159], v236 offset:1152
    ds_read_b128 v[160:163], v236 offset:2304
    ds_read_b128 v[164:167], v236 offset:3456
    s_waitcnt lgkmcnt(3)
    buffer_store_dwordx4 v[152:155], v252, s[28:31], 0 offen offset:0 sc1
    s_waitcnt lgkmcnt(2)
    buffer_store_dwordx4 v[156:159], v252, s[28:31], 0 offen offset:1024 sc1
    s_waitcnt lgkmcnt(1)
    buffer_store_dwordx4 v[160:163], v252, s[28:31], 0 offen offset:2048 sc1
    s_waitcnt lgkmcnt(0)
    buffer_store_dwordx4 v[164:167], v252, s[28:31], 0 offen offset:3072 sc1
    s_add_u32 s10, s2, s7
    s_cmp_lg_u32 s10, 0
    s_cbranch_scc1 K2_NOEP
    v_mov_b32 v188, 24117248
    v_mov_b32 v189, s100
    buffer_store_dword v189, v188, s[24:27], 0 offen sc1
K2_NOEP:
K2_END:
    s_endpgm
K2_RETRY0:
    s_sleep 1
    s_sub_u32 s101, s101, 1
    s_cbranch_scc1 K2_END
    s_waitcnt vmcnt(0)
    v_bitop3_b32 v188, v91, s36, v214 bitop3:0x28
    s_nop 1
    v_or_b32_dpp v188, v188, v188 quad_perm:[1,0,3,2] row_mask:0xf bank_mask:0xf
    s_nop 1
    v_or_b32_dpp v188, v188, v188 quad_perm:[2,3,0,1] row_mask:0xf bank_mask:0xf
    s_nop 1
    v_or_b32_dpp v188, v188, v188 row_half_mirror row_mask:0xf bank_mask:0xf
    v_cmp_ne_u32 vcc, 0, v188
    s_and_b64 exec, exec, vcc
    s_cbranch_execz K2_RT00
    buffer_load_dwordx4 v[88:91], v189, s[32:35], 0 offen sc1
K2_RT00:
    s_mov_b64 exec, -1
    v_bitop3_b32 v188, v95, s36, v214 bitop3:0x28
    s_nop 1
    v_or_b32_dpp v188, v188, v188 quad_perm:[1,0,3,2] row_mask:0xf bank_mask:0xf
    s_nop 1
    v_or_b32_dpp v188, v188, v188 quad_perm:[2,3,0,1] row_mask:0xf bank_mask:0xf
    s_nop 1
    v_or_b32_dpp v188, v188, v188 row_half_mirror row_mask:0xf bank_mask:0xf
    v_cmp_ne_u32 vcc, 0, v188
    s_and_b64 exec, exec, vcc
    s_cbranch_execz K2_RT01
    buffer_load_dwordx4 v[92:95], v189, s[32:35], s79 offen sc1
K2_RT01:
    s_mov_b64 exec, -1
    v_bitop3_b32 v188, v99, s36, v214 bitop3:0x28
    s_nop 1
    v_or_b32_dpp v188, v188, v188 quad_perm:[1,0,3,2] row_mask:0xf bank_mask:0xf
    s_nop 1
    v_or_b32_dpp v188, v188, v188 quad_perm:[2,3,0,1] row_mask:0xf bank_mask:0xf
    s_nop 1
    v_or_b32_dpp v188, v188, v188 row_half_mirror row_mask:0xf bank_mask:0xf
    v_cmp_ne_u32 vcc, 0, v188
    s_and_b64 exec, exec, vcc
    s_cbranch_execz K2_RT02
    buffer_load_dwordx4 v[96:99], v189, s[32:35], s80 offen sc1
K2_RT02:
    s_mov_b64 exec, -1
    v_bitop3_b32 v188, v103, s36, v214 bitop3:0x28
    s_nop 1
    v_or_b32_dpp v188, v188, v188 quad_perm:[1,0,3,2] row_mask:0xf bank_mask:0xf
    s_nop 1
    v_or_b32_dpp v188, v188, v188 quad_perm:[2,3,0,1] row_mask:0xf bank_mask:0xf
    s_nop 1
    v_or_b32_dpp v188, v188, v188 row_half_mirror row_mask:0xf bank_mask:0xf
    v_cmp_ne_u32 vcc, 0, v188
    s_and_b64 exec, exec, vcc
    s_cbranch_execz K2_RT03
    buffer_load_dwordx4 v[100:103], v189, s[32:35], s81 offen sc1
K2_RT03:
    s_mov_b64 exec, -1
    s_waitcnt vmcnt(0)
    s_branch K2_CHK0
K2_RETRY1:
    s_sleep 1
    s_sub_u32 s101, s101, 1
    s_cbranch_scc1 K2_END
    s_waitcnt vmcnt(0)
    v_bitop3_b32 v188, v95, s36, v214 bitop3:0x28
    s_nop 1
    v_or_b32_dpp v188, v188, v188 quad_perm:[1,0,3,2] row_mask:0xf bank_mask:0xf
    s_nop 1
    v_or_b32_dpp v188, v188, v188 quad_perm:[2,3,0,1] row_mask:0xf bank_mask:0xf
    s_nop 1
    v_or_b32_dpp v188, v188, v188 row_half_mirror row_mask:0xf bank_mask:0xf
    v_cmp_ne_u32 vcc, 0, v188
    s_and_b64 exec, exec, vcc
    s_cbranch_execz K2_RT11
    buffer_load_dwordx4 v[92:95], v189, s[32:35], s79 offen sc1
K2_RT11:
    s_mov_b64 exec, -1
    v_bitop3_b32 v188, v99, s36, v214 bitop3:0x28
    s_nop 1
    v_or_b32_dpp v188, v188, v188 quad_perm:[1,0,3,2] row_mask:0xf bank_mask:0xf
    s_nop 1
    v_or_b32_dpp v188, v188, v188 quad_perm:[2,3,0,1] row_mask:0xf bank_mask:0xf
    s_nop 1
    v_or_b32_dpp v188, v188, v188 row_half_mirror row_mask:0xf bank_mask:0xf
    v_cmp_ne_u32 vcc, 0, v188
    s_and_b64 exec, exec, vcc
    s_cbranch_execz K2_RT12
    buffer_load_dwordx4 v[96:99], v189, s[32:35], s80 offen sc1
K2_RT12:
    s_mov_b64 exec, -1
    v_bitop3_b32 v188, v103, s36, v214 bitop3:0x28
    s_nop 1
    v_or_b32_dpp v188, v188, v188 quad_perm:[1,0,3,2] row_mask:0xf bank_mask:0xf
    s_nop 1
    v_or_b32_dpp v188, v188, v188 quad_perm:[2,3,0,1] row_mask:0xf bank_mask:0xf
    s_nop 1
    v_or_b32_dpp v188, v188, v188 row_half_mirror row_mask:0xf bank_mask:0xf
    v_cmp_ne_u32 vcc, 0, v188
    s_and_b64 exec, exec, vcc
    s_cbranch_execz K2_RT13
    buffer_load_dwordx4 v[100:103], v189, s[32:35], s81 offen sc1
K2_RT13:
    s_mov_b64 exec, -1
    s_waitcnt vmcnt(0)
    s_branch K2_CHK1
K2_RETRY2:
    s_sleep 1
    s_sub_u32 s101, s101, 1
    s_cbranch_scc1 K2_END
    s_waitcnt vmcnt(0)
    v_bitop3_b32 v188, v99, s36, v214 bitop3:0x28
    s_nop 1
    v_or_b32_dpp v188, v188, v188 quad_perm:[1,0,3,2] row_mask:0xf bank_mask:0xf
    s_nop 1
    v_or_b32_dpp v188, v188, v188 quad_perm:[2,3,0,1] row_mask:0xf bank_mask:0xf
    s_nop 1
    v_or_b32_dpp v188, v188, v188 row_half_mirror row_mask:0xf bank_mask:0xf
    v_cmp_ne_u32 vcc, 0, v188
    s_and_b64 exec, exec, vcc
    s_cbranch_execz K2_RT22
    buffer_load_dwordx4 v[96:99], v189, s[32:35], s80 offen sc1
K2_RT22:
    s_mov_b64 exec, -1
    v_bitop3_b32 v188, v103, s36, v214 bitop3:0x28
    s_nop 1
    v_or_b32_dpp v188, v188, v188 quad_perm:[1,0,3,2] row_mask:0xf bank_mask:0xf
    s_nop 1
    v_or_b32_dpp v188, v188, v188 quad_perm:[2,3,0,1] row_mask:0xf bank_mask:0xf
    s_nop 1
    v_or_b32_dpp v188, v188, v188 row_half_mirror row_mask:0xf bank_mask:0xf
    v_cmp_ne_u32 vcc, 0, v188
    s_and_b64 exec, exec, vcc
    s_cbranch_execz K2_RT23
    buffer_load_dwordx4 v[100:103], v189, s[32:35], s81 offen sc1
K2_RT23:
    s_mov_b64 exec, -1
    s_waitcnt vmcnt(0)
    s_branch K2_CHK2
K2_RETRY3:
    s_sleep 1
    s_sub_u32 s101, s101, 1
    s_cbranch_scc1 K2_END
    s_waitcnt vmcnt(0)
    v_bitop3_b32 v188, v103, s36, v214 bitop3:0x28
    s_nop 1
    v_or_b32_dpp v188, v188, v188 quad_perm:[1,0,3,2] row_mask:0xf bank_mask:0xf
    s_nop 1
    v_or_b32_dpp v188, v188, v188 quad_perm:[2,3,0,1] row_mask:0xf bank_mask:0xf
    s_nop 1
    v_or_b32_dpp v188, v188, v188 row_half_mirror row_mask:0xf bank_mask:0xf
    v_cmp_ne_u32 vcc, 0, v188
    s_and_b64 exec, exec, vcc
    s_cbranch_execz K2_RT33
    buffer_load_dwordx4 v[100:103], v189, s[32:35], s81 offen sc1
K2_RT33:
    s_mov_b64 exec, -1
    s_waitcnt vmcnt(0)
    s_branch K2_CHK3
K1_EXT:
    s_mov_b32 s14, 0x0f0f0f0f
    s_mov_b32 s15, s14
    ds_read_b32 v104, v6 offset:32
    ds_read_b128 v[8:11], v3 offset:128
    ds_read_b32 v105, v6 offset:3360
    ds_read_b128 v[16:19], v3 offset:13440
    ds_read_b32 v106, v6 offset:6688
    ds_read_b128 v[24:27], v3 offset:26752
    ds_read_b32 v107, v6 offset:10016
    ds_read_b128 v[32:35], v3 offset:40064
    s_waitcnt lgkmcnt(0)
    v_cmp_le_u32 vcc, 553648128, v108
    v_and_or_b32 v11, v104, v15, v108
    s_and_b64 exec, vcc, s[14:15]
    s_cbranch_execz K1_EX0
    buffer_store_dwordx4 v[8:11], v4, s[32:35], s10 offen sc1
K1_EX0:
    s_mov_b64 exec, -1
    s_add_u32 s10, s10, 2105344
    v_cmp_le_u32 vcc, 553648128, v109
    v_and_or_b32 v19, v105, v15, v109
    s_and_b64 exec, vcc, s[14:15]
    s_cbranch_execz K1_EX1
    buffer_store_dwordx4 v[16:19], v4, s[32:35], s10 offen sc1
K1_EX1:
    s_mov_b64 exec, -1
    s_add_u32 s10, s10, 2105344
    v_cmp_le_u32 vcc, 553648128, v110
    v_and_or_b32 v27, v106, v15, v110
    s_and_b64 exec, vcc, s[14:15]
    s_cbranch_execz K1_EX2
    buffer_store_dwordx4 v[24:27], v4, s[32:35], s10 offen sc1
K1_EX2:
    s_mov_b64 exec, -1
    s_add_u32 s10, s10, 2105344
    v_cmp_le_u32 vcc, 553648128, v111
    v_and_or_b32 v35, v107, v15, v111
    s_and_b64 exec, vcc, s[14:15]
    s_cbranch_execz K1_EX3
    buffer_store_dwordx4 v[32:35], v4, s[32:35], s10 offen sc1
K1_EX3:
    s_mov_b64 exec, -1
    s_add_u32 s10, s10, 2105344
    s_branch K1_EXTR
K1_OVF:
    v_lshrrev_b32 v72, 16, v112
    v_lshrrev_b32 v76, 18, v112
    v_sub_u32 v72, v72, v76
    v_lshrrev_b32 v73, 16, v113
    v_lshrrev_b32 v76, 18, v113
    v_sub_u32 v73, v73, v76
    v_lshrrev_b32 v74, 16, v114
    v_lshrrev_b32 v76, 18, v114
    v_sub_u32 v74, v74, v76
    v_lshrrev_b32 v75, 16, v115
    v_lshrrev_b32 v76, 18, v115
    v_sub_u32 v75, v75, v76
    v_add_u32 v77, v72, v73
    v_add_u32 v78, v77, v74
    v_add_u32 v79, v78, v75
    v_mov_b32 v1, v79
    s_nop 1
    v_add_u32_dpp v1, v1, v1 row_shr:1 row_mask:0xf bank_mask:0xf bound_ctrl:0
    s_nop 1
    v_add_u32_dpp v1, v1, v1 row_shr:2 row_mask:0xf bank_mask:0xf bound_ctrl:0
    s_nop 1
    v_add_u32_dpp v1, v1, v1 row_shr:4 row_mask:0xf bank_mask:0xf bound_ctrl:0
    s_nop 1
    v_add_u32_dpp v1, v1, v1 row_shr:8 row_mask:0xf bank_mask:0xf bound_ctrl:0
    s_nop 1
    v_add_u32_dpp v1, v1, v1 row_bcast:15 row_mask:0xa bank_mask:0xf
    s_nop 1
    v_add_u32_dpp v1, v1, v1 row_bcast:31 row_mask:0xc bank_mask:0xf
    s_nop 0
    v_sub_u32 v76, v1, v79
    v_add_u32 v79, v76, v78
    v_add_u32 v78, v76, v77
    v_add_u32 v77, v76, v72
    v_lshl_or_b32 v76, v72, 16, v76
    v_lshl_or_b32 v77, v73, 16, v77
    v_lshl_or_b32 v78, v74, 16, v78
    v_lshl_or_b32 v79, v75, 16, v79
    s_waitcnt lgkmcnt(0)
    ds_write_b128 v172, v[76:79] offset:52736
    v_min_u32 v108, 255, v108
    v_min_u32 v109, 255, v109
    v_min_u32 v110, 255, v110
    v_min_u32 v111, 255, v111
    s_lshl_b32 s15, s12, 2
    s_add_u32 s15, s15, 23068672
    s_add_u32 s64, s8, s15
    s_addc_u32 s65, s9, 0
    s_mov_b32 s66, 262144
    s_mov_b32 s67, 0x20000
    v_lshlrev_b32 v1, 12, v254
    buffer_store_dword v76, v1, s[64:67], 0 offen offset:0 sc1
    buffer_store_dword v77, v1, s[64:67], 0 offen offset:1024 sc1
    buffer_store_dword v78, v1, s[64:67], 0 offen offset:2048 sc1
    buffer_store_dword v79, v1, s[64:67], 0 offen offset:3072 sc1
    s_add_u32 s15, s13, 17825792
    s_add_u32 s64, s8, s15
    s_addc_u32 s65, s9, 0
    s_mov_b32 s66, 12500
    s_mov_b32 s67, 0x20000
    s_lshr_b32 s15, s13, 2
    s_add_u32 s15, s15, 22020096
    s_add_u32 s68, s8, s15
    s_addc_u32 s69, s9, 0
    s_mov_b32 s70, 3125
    s_mov_b32 s71, 0x20000
    v_cndmask_b32 v30, v24, v30, s[78:79]
    v_cndmask_b32 v38, 0, v38, s[78:79]
    ds_read_u16 v40, v24 offset:50736
    ds_read_u16 v41, v25 offset:50736
    ds_read_u16 v42, v26 offset:50736
    ds_read_u16 v43, v27 offset:50736
    ds_read_u16 v44, v28 offset:50736
    ds_read_u16 v45, v29 offset:50736
    ds_read_u16 v46, v30 offset:50736
    s_waitcnt lgkmcnt(0)
    v_lshrrev_b32 v1, 2, v32
    v_sub_u32 v1, v32, v1
    v_add_u32 v40, v40, v1
    v_cmp_le_u32 vcc, 48, v32
    v_lshlrev_b32 v48, 2, v40
    s_and_saveexec_b64 s[14:15], vcc
    s_cbranch_execz K1_OV3_0
    buffer_store_byte v23, v40, s[68:71], 0 offen sc1
    buffer_store_dword v16, v48, s[64:67], 0 offen sc1
K1_OV3_0:
    s_mov_b64 exec, -1
    v_lshrrev_b32 v1, 2, v33
    v_sub_u32 v1, v33, v1
    v_add_u32 v41, v41, v1
    v_cmp_le_u32 vcc, 48, v33
    v_lshlrev_b32 v49, 2, v41
    s_and_saveexec_b64 s[14:15], vcc
    s_cbranch_execz K1_OV3_1
    buffer_store_byte v23, v41, s[68:71], 0 offen sc1
    buffer_store_dword v17, v49, s[64:67], 0 offen sc1
K1_OV3_1:
    s_mov_b64 exec, -1
    v_lshrrev_b32 v1, 2, v34
    v_sub_u32 v1, v34, v1
    v_add_u32 v42, v42, v1
    v_cmp_le_u32 vcc, 48, v34
    v_lshlrev_b32 v50, 2, v42
    s_and_saveexec_b64 s[14:15], vcc
    s_cbranch_execz K1_OV3_2
    buffer_store_byte v23, v42, s[68:71], 0 offen sc1
    buffer_store_dword v18, v50, s[64:67], 0 offen sc1
K1_OV3_2:
    s_mov_b64 exec, -1
    v_lshrrev_b32 v1, 2, v35
    v_sub_u32 v1, v35, v1
    v_add_u32 v43, v43, v1
    v_cmp_le_u32 vcc, 48, v35
    v_lshlrev_b32 v51, 2, v43
    s_and_saveexec_b64 s[14:15], vcc
    s_cbranch_execz K1_OV3_3
    buffer_store_byte v23, v43, s[68:71], 0 offen sc1
    buffer_store_dword v19, v51, s[64:67], 0 offen sc1
K1_OV3_3:
    s_mov_b64 exec, -1
    v_lshrrev_b32 v1, 2, v36
    v_sub_u32 v1, v36, v1
    v_add_u32 v44, v44, v1
    v_cmp_le_u32 vcc, 48, v36
    v_lshlrev_b32 v52, 2, v44
    s_and_saveexec_b64 s[14:15], vcc
    s_cbranch_execz K1_OV3_4
    buffer_store_byte v31, v44, s[68:71], 0 offen sc1
    buffer_store_dword v20, v52, s[64:67], 0 offen sc1
K1_OV3_4:
    s_mov_b64 exec, -1
    v_lshrrev_b32 v1, 2, v37
    v_sub_u32 v1, v37, v1
    v_add_u32 v45, v45, v1
    v_cmp_le_u32 vcc, 48, v37
    v_lshlrev_b32 v53, 2, v45
    s_and_saveexec_b64 s[14:15], vcc
    s_cbranch_execz K1_OV3_5
    buffer_store_byte v31, v45, s[68:71], 0 offen sc1
    buffer_store_dword v21, v53, s[64:67], 0 offen sc1
K1_OV3_5:
    s_mov_b64 exec, -1
    v_lshrrev_b32 v1, 2, v38
    v_sub_u32 v1, v38, v1
    v_add_u32 v46, v46, v1
    v_cmp_le_u32 vcc, 48, v38
    v_lshlrev_b32 v54, 2, v46
    s_and_saveexec_b64 s[14:15], vcc
    s_cbranch_execz K1_OV3_6
    buffer_store_byte v39, v46, s[68:71], 0 offen sc1
    buffer_store_dword v22, v54, s[64:67], 0 offen sc1
K1_OV3_6:
    s_mov_b64 exec, -1
    s_waitcnt vmcnt(0)
    s_barrier
    s_branch K1_OUT
K2_XT1:
    s_mov_b32 s97, 1
    v_cmp_le_u32 vcc, 822083584, v188
    v_mov_b32 v166, 2180
    s_cbranch_vccz K2_XT1A
    ds_write_b32 v166, v171
K2_XT1A:
    s_mov_b32 s10, 0xf0f0f0f0
    s_mov_b32 s11, s10
    v_and_b32 v166, 12, v168
    v_add_u32 v166, 32, v166
    v_and_b32 v164, 64, v189
    v_mul_u32_u24 v164, 127, v164
    v_add_u32 v164, v164, v189
    v_add_u32 v165, 16384, v164
    v_mov_b32 v167, 0x7ffffff0
    v_cndmask_b32 v204, v91, v95, s[10:11]
    v_cndmask_b32 v206, v208, v209, s[10:11]
    v_cmp_le_u32 vcc, 553648128, v204
    v_sub_u32_sdwa v204, v204, v166 dst_sel:DWORD dst_unused:UNUSED_PAD src0_sel:BYTE_3 src1_sel:DWORD
    s_nop 0
    v_cndmask_b32 v164, v167, v164, vcc
    v_cndmask_b32 v205, v99, v103, s[10:11]
    v_cndmask_b32 v207, v210, v211, s[10:11]
    v_cmp_le_u32 vcc, 553648128, v205
    v_sub_u32_sdwa v205, v205, v166 dst_sel:DWORD dst_unused:UNUSED_PAD src0_sel:BYTE_3 src1_sel:DWORD
    s_nop 0
    v_cndmask_b32 v165, v167, v165, vcc
    s_add_u32 s32, s32, 8421376
    s_addc_u32 s33, s33, 0
    buffer_load_dwordx4 v[132:135], v164, s[32:35], 0 offen sc1
    buffer_load_dwordx4 v[136:139], v165, s[32:35], 0 offen sc1
    v_med3_i32 v166, v204, 0, 3
    v_med3_i32 v167, v205, 0, 3
    v_add_u32 v166, v166, v167
    v_mov_b32 v167, 2176
    v_cmpx_lt_u32 vcc, 0, v166
    ds_add_u32 v167, v166
    s_mov_b64 exec, -1
    s_branch K2_XT1R
K2_XT2:
K2_XVa:
    s_waitcnt vmcnt(0)
    s_mov_b64 s[10:11], 0
    v_bitop3_b32 v166, v135, s36, v214 bitop3:0x28
    v_cmp_ne_u32 s[86:87], 0, v166
    v_cmp_gt_u32 vcc, 0x7ffffff0, v164
    s_and_b64 vcc, vcc, s[86:87]
    s_or_b64 s[10:11], s[10:11], vcc
    v_bitop3_b32 v166, v139, s36, v214 bitop3:0x28
    v_cmp_ne_u32 s[86:87], 0, v166
    v_cmp_gt_u32 vcc, 0x7ffffff0, v165
    s_and_b64 vcc, vcc, s[86:87]
    s_or_b64 s[10:11], s[10:11], vcc
    s_cbranch_scc0 K2_XWa
    s_sleep 1
    s_sub_u32 s101, s101, 1
    s_cbranch_scc1 K2_END
    buffer_load_dwordx4 v[132:135], v164, s[32:35], 0 offen sc1
    buffer_load_dwordx4 v[136:139], v165, s[32:35], 0 offen sc1
    s_branch K2_XVa
K2_XWa:
    v_and_b32 v140, 255, v132
    v_lshlrev_b32 v140, 2, v140
    ds_read_b32 v140, v140 offset:6400
    v_and_b32 v141, 255, v133
    v_lshlrev_b32 v141, 2, v141
    ds_read_b32 v141, v141 offset:6400
    v_and_b32 v142, 255, v134
    v_lshlrev_b32 v142, 2, v142
    ds_read_b32 v142, v142 offset:6400
    v_and_b32 v135, 0x0f0f0f, v135
    v_and_b32 v143, 255, v136
    v_lshlrev_b32 v143, 2, v143
    ds_read_b32 v143, v143 offset:6400
    v_and_b32 v144, 255, v137
    v_lshlrev_b32 v144, 2, v144
    ds_read_b32 v144, v144 offset:6400
    v_and_b32 v145, 255, v138
    v_lshlrev_b32 v145, 2, v145
    ds_read_b32 v145, v145 offset:6400
    v_and_b32 v139, 0x0f0f0f, v139
    s_waitcnt lgkmcnt(0)
    v_perm_b32 v146, v135, v132, s64
    v_lshl_add_u32 v146, v146, 5, v206
    v_cmpx_lt_i32 vcc, 0, v204
    ds_add_rtn_u32 v140, v140, v171 offset:2112
    s_mov_b64 exec, -1
    v_perm_b32 v147, v135, v133, s65
    v_lshl_add_u32 v147, v147, 5, v206
    v_cmpx_lt_i32 vcc, 1, v204
    ds_add_rtn_u32 v141, v141, v171 offset:2112
    s_mov_b64 exec, -1
    v_perm_b32 v148, v135, v134, s66
    v_lshl_add_u32 v148, v148, 5, v206
    v_cmpx_lt_i32 vcc, 2, v204
    ds_add_rtn_u32 v142, v142, v171 offset:2112
    s_mov_b64 exec, -1
    v_perm_b32 v149, v139, v136, s64
    v_lshl_add_u32 v149, v149, 5, v207
    v_cmpx_lt_i32 vcc, 0, v205
    ds_add_rtn_u32 v143, v143, v171 offset:2112
    s_mov_b64 exec, -1
    v_perm_b32 v150, v139, v137, s65
    v_lshl_add_u32 v150, v150, 5, v207
    v_cmpx_lt_i32 vcc, 1, v205
    ds_add_rtn_u32 v144, v144, v171 offset:2112
    s_mov_b64 exec, -1
    v_perm_b32 v151, v139, v138, s66
    v_lshl_add_u32 v151, v151, 5, v207
    v_cmpx_lt_i32 vcc, 2, v205
    ds_add_rtn_u32 v145, v145, v171 offset:2112
    s_mov_b64 exec, -1
    s_waitcnt lgkmcnt(0)
    v_cmpx_lt_i32 vcc, 0, v204
    ds_write2st64_b32 v140, v132, v146 offset0:0 offset1:84
    s_mov_b64 exec, -1
    v_cmpx_lt_i32 vcc, 1, v204
    ds_write2st64_b32 v141, v133, v147 offset0:0 offset1:84
    s_mov_b64 exec, -1
    v_cmpx_lt_i32 vcc, 2, v204
    ds_write2st64_b32 v142, v134, v148 offset0:0 offset1:84
    s_mov_b64 exec, -1
    v_cmpx_lt_i32 vcc, 0, v205
    ds_write2st64_b32 v143, v136, v149 offset0:0 offset1:84
    s_mov_b64 exec, -1
    v_cmpx_lt_i32 vcc, 1, v205
    ds_write2st64_b32 v144, v137, v150 offset0:0 offset1:84
    s_mov_b64 exec, -1
    v_cmpx_lt_i32 vcc, 2, v205
    ds_write2st64_b32 v145, v138, v151 offset0:0 offset1:84
    s_mov_b64 exec, -1
    s_branch K2_PADS0
K2_XT3:
    ds_read_b32 v166, v212 offset:2112
    s_waitcnt lgkmcnt(0)
    v_readfirstlane_b32 s15, v166
    s_nop 3
    s_sub_u32 s73, s15, s76
    s_add_u32 s73, s73, 127
    s_lshr_b32 s73, s73, 7
    s_sub_i32 s38, s73, 1
    s_branch K2_GO
K2_OVF:
    s_mov_b32 s80, 1
    s_mov_b32 s83, 0
    s_mov_b32 s77, 0
    s_mov_b32 s15, s76
    v_mov_b32 v190, 0xffff0000
    v_or_b32 v189, s39, v190
    v_mov_b32 v190, 0x7fffff00
    v_lshl_add_u32 v188, v254, 2, s15
    s_sub_u32 s73, s15, s76
    ds_write2st64_b32 v188, v189, v190 offset0:0 offset1:84
    ds_write2st64_b32 v188, v189, v190 offset0:1 offset1:85
    s_add_u32 s73, s73, 127
    s_lshr_b32 s73, s73, 7
    s_sub_i32 s38, s73, 1
    s_cmp_eq_u32 s97, 0
    s_cbranch_scc1 K2_PADS0
K2_XVb:
    s_waitcnt vmcnt(0)
    s_mov_b64 s[10:11], 0
    v_bitop3_b32 v166, v135, s36, v214 bitop3:0x28
    v_cmp_ne_u32 s[86:87], 0, v166
    v_cmp_gt_u32 vcc, 0x7ffffff0, v164
    s_and_b64 vcc, vcc, s[86:87]
    s_or_b64 s[10:11], s[10:11], vcc
    v_bitop3_b32 v166, v139, s36, v214 bitop3:0x28
    v_cmp_ne_u32 s[86:87], 0, v166
    v_cmp_gt_u32 vcc, 0x7ffffff0, v165
    s_and_b64 vcc, vcc, s[86:87]
    s_or_b64 s[10:11], s[10:11], vcc
    s_cbranch_scc0 K2_XWb
    s_sleep 1
    s_sub_u32 s101, s101, 1
    s_cbranch_scc1 K2_END
    buffer_load_dwordx4 v[132:135], v164, s[32:35], 0 offen sc1
    buffer_load_dwordx4 v[136:139], v165, s[32:35], 0 offen sc1
    s_branch K2_XVb
K2_XWb:
    s_branch K2_PADS0
K2_SLOW:
    s_add_u32 s81, s81, 448
    s_cmp_lt_u32 s81, s82
    s_cbranch_scc1 K2_BATCH
K2_FIND:
    s_cmp_lg_u64 s[84:85], 0
    s_cbranch_scc1 K2_GOT
    s_add_u32 s79, s79, 1
    s_cmp_ge_u32 s79, 4
    s_cbranch_scc1 K2_EPI
    s_mul_i32 s10, s12, 32896
    s_lshl_b32 s11, s79, 13
    s_add_u32 s10, s10, s11
    v_lshlrev_b32 v252, 7, v254
    buffer_load_ubyte v252, v252, s[24:27], s10 offen offset:15 sc1
    s_waitcnt vmcnt(0)
    v_cmp_lt_u32 s[84:85], s77, v252
    s_nop 3
    s_branch K2_FIND
K2_GOT:
    s_ff1_i32_b64 s10, s[84:85]
    s_bitset0_b64 s[84:85], s10
    s_lshl_b32 s11, s79, 6
    s_add_u32 s80, s10, s11
    s_mul_i32 s10, s12, 32896
    s_lshl_b32 s11, s80, 7
    s_add_u32 s10, s10, s11
    s_lshl_b32 s11, s12, 8
    s_add_u32 s11, s11, s80
    s_lshl_b32 s11, s11, 2
    s_add_u32 s11, s11, 23068672
    v_mov_b32 v188, 0
    buffer_load_ubyte v189, v188, s[24:27], s10 offen offset:15 sc1
    buffer_load_dword v190, v188, s[24:27], s11 offen sc1
    s_waitcnt vmcnt(0)
    v_readfirstlane_b32 s10, v189
    v_readfirstlane_b32 s11, v190
    s_nop 3
    s_and_b32 s83, s11, 0xffff
    s_lshr_b32 s11, s11, 16
    s_lshr_b32 s82, s10, 2
    s_sub_u32 s82, s10, s82
    s_cmp_gt_u32 s10, 48
    s_cselect_b32 s82, s11, s82
    s_lshr_b32 s10, s77, 2
    s_sub_u32 s81, s77, s10
K2_BATCH:
    s_barrier
    v_and_b32 v188, 7, v254
    v_mul_u32_u24 v189, 2688, v188
    v_add_u32 v189, 9728, v189
    v_lshlrev_b32 v188, 2, v188
    ds_write_b32 v188, v189 offset:2112
    v_add_u32 v188, s81, v255
    s_mul_i32 s10, s12, 32896
    s_lshl_b32 s11, s80, 7
    s_add_u32 s10, s10, s11
    v_mul_u32_u24 v190, 87382, v188
    v_lshrrev_b32 v190, 16, v190
    v_lshl_add_u32 v189, v190, 2, s10
    v_add_u32 v191, 8421248, v189
    v_cmp_lt_u32 vcc, 31, v190
    s_mul_i32 s11, s80, 3125
    s_add_u32 s11, s11, s83
    v_cndmask_b32 v189, v189, v191, vcc
    v_or_b32 v191, 12, v189
    v_and_b32 v192, 3, v190
    v_add_u32 v191, v191, v192
    v_cmp_le_u32 vcc, 48, v190
    v_add_u32 v190, s11, v188
    v_add_u32 v192, 22020096, v190
    v_cndmask_b32 v191, v191, v192, vcc
    v_lshlrev_b32 v190, 2, v190
    v_add_u32 v190, 17825792, v190
    v_cndmask_b32 v189, v189, v190, vcc
    s_add_u32 s10, s81, 448
    s_min_u32 s10, s10, s82
    v_cmp_gt_u32 vcc, s10, v188
    v_mov_b32 v190, 0x7ffffff0
    s_mul_i32 s86, s80, 100000
    v_cndmask_b32 v189, v190, v189, vcc
    v_cndmask_b32 v191, v190, v191, vcc
    buffer_load_dword v189, v189, s[24:27], 0 offen sc1
    buffer_load_ubyte v191, v191, s[24:27], 0 offen sc1
    s_waitcnt lgkmcnt(0)
    s_barrier
    s_and_saveexec_b64 s[10:11], vcc
    s_waitcnt vmcnt(0)
    v_and_b32 v188, 255, v189
    v_lshlrev_b32 v188, 2, v188
    ds_read_b32 v188, v188 offset:6400
    v_bfe_u32 v190, v189, 8, 8
    v_and_b32 v191, 15, v191
    v_lshl_or_b32 v191, v191, 8, v190
    v_mov_b32 v190, 4
    v_lshl_add_u32 v191, v191, 5, s86
    s_waitcnt lgkmcnt(0)
    ds_add_rtn_u32 v188, v188, v190 offset:2112
    s_waitcnt lgkmcnt(0)
    ds_write2st64_b32 v188, v189, v191 offset0:0 offset1:84
    s_mov_b64 exec, -1
    s_waitcnt lgkmcnt(0)
    s_barrier
    s_lshl_b32 s10, s3, 2
    v_mov_b32 v188, s10
    ds_read_b32 v188, v188 offset:2112
    v_mov_b32 v180, 0
    v_mov_b32 v181, 0
    v_mov_b32 v182, 0
    v_mov_b32 v183, 0
    v_mov_b32 v184, 0
    v_mov_b32 v185, 0
    v_mov_b32 v186, 0
    v_mov_b32 v187, 0
    v_bfe_u32 v189, v254, 3, 2
    v_lshl_add_u32 v247, v189, 5, s76
    v_lshrrev_b32 v189, 5, v254
    v_lshl_add_u32 v247, v189, 4, v247
    v_and_b32 v189, 3, v254
    v_and_b32 v190, 28, v254
    v_lshl_add_u32 v189, v189, 5, v190
    v_add_u32 v249, s76, v189
    v_lshrrev_b32 v190, 1, v254
    v_lshl_add_u32 v251, v190, 2, s76
    v_add_u32 v251, 21504, v251
    v_bfe_u32 v189, v254, 2, 2
    v_lshl_add_u32 v248, v189, 5, s76
    v_lshrrev_b32 v189, 5, v254
    v_lshl_add_u32 v248, v189, 3, v248
    s_waitcnt lgkmcnt(0)
    v_readfirstlane_b32 s15, v188
    s_nop 3
    v_mov_b32 v190, 0xffff0000
    v_or_b32 v189, s39, v190
    v_mov_b32 v190, 0x7fffff00
    v_lshl_add_u32 v188, v254, 2, s15
    s_sub_u32 s73, s15, s76
    ds_write2st64_b32 v188, v189, v190 offset0:0 offset1:84
    ds_write2st64_b32 v188, v189, v190 offset0:1 offset1:85
    s_add_u32 s73, s73, 127
    s_lshr_b32 s73, s73, 7
    s_sub_i32 s38, s73, 1
K2_LAST:
    s_branch K2_GO
.section .rodata,"a"
.p2align 6
.amdhsa_kernel standalone__edge_featured_mpnn_gatedgcn__graph_kernel
  .amdhsa_next_free_vgpr 256
  .amdhsa_next_free_sgpr 102
  .amdhsa_accum_offset 256
  .amdhsa_group_segment_fixed_size 0
  .amdhsa_kernarg_size 96
  .amdhsa_user_sgpr_count 2
  .amdhsa_user_sgpr_kernarg_segment_ptr 1
  .amdhsa_system_sgpr_workgroup_id_x 1
.end_amdhsa_kernel
```

```asm
; @launch grid=(256,1,1) block=(512,1,1) lds=157696
.amdgcn_target "amdgcn-amd-amdhsa--gfx950"
.text
.globl standalone__edge_featured_mpnn_gatedgcn__graph_kernel
.p2align 8
.type standalone__edge_featured_mpnn_gatedgcn__graph_kernel,@function
standalone__edge_featured_mpnn_gatedgcn__graph_kernel:
    s_cmp_ge_u32 s2, 256
    s_cbranch_scc1 K2_END
    s_load_dwordx4 s[44:47], s[0:1], 16
    s_load_dwordx2 s[8:9], s[0:1], 88
    s_load_dwordx4 s[40:43], s[0:1], 0
    s_load_dwordx8 s[48:55], s[0:1], 32
    s_load_dwordx4 s[56:59], s[0:1], 64
    s_getpc_b64 s[86:87]
K2_PC:
    v_lshlrev_b32 v252, 7, v0
    v_min_u32 v252, K2_LAST-K2_PC, v252
    v_cmp_gt_u32 vcc, 192, v0
    s_cbranch_vccz K2_NOCPF
    global_load_dword v253, v252, s[86:87]
K2_NOCPF:
    v_mov_b32 v255, v0
    v_lshrrev_b32 v188, 6, v0
    v_and_b32 v254, 63, v0
    v_readfirstlane_b32 s7, v188
    s_and_b32 s10, s2, 7
    s_lshr_b32 s11, s2, 3
    s_lshl_b32 s10, s10, 5
    s_add_u32 s12, s10, s11
    s_mul_i32 s13, s12, 12500
    v_lshlrev_b32 v189, 4, v0
    v_lshlrev_b32 v1, 3, v0
    v_lshlrev_b32 v2, 2, v0
    v_mov_b32 v3, 0
    v_and_b32 v4, 0x3fc, v2
    ds_write_b32 v4, v3 offset:6400
    s_and_b32 s10, s7, 3
    s_lshr_b32 s3, s7, 2
    s_lshl1_add_u32 s3, s10, s3
    s_xor_b32 s3, s3, 1
    s_movk_i32 s14, 8192
    s_movk_i32 s15, 12288
    s_waitcnt lgkmcnt(0)
    s_add_u32 s64, s46, s13
    s_addc_u32 s65, s47, 0
    s_mov_b32 s66, 12500
    s_mov_b32 s67, 0x20000
    s_add_u32 s68, s44, s13
    s_addc_u32 s69, s45, 0
    s_mov_b32 s70, 12500
    s_mov_b32 s71, 0x20000
    buffer_load_dwordx4 v[8:11], v189, s[64:67], 0 offen nt
    buffer_load_dwordx2 v[12:13], v1, s[64:67], s14 offen nt
    buffer_load_dword v14, v2, s[64:67], s15 offen nt
    s_barrier
    buffer_load_dwordx4 v[16:19], v189, s[68:71], 0 offen nt
    buffer_load_dwordx2 v[20:21], v1, s[68:71], s14 offen nt
    buffer_load_dword v22, v2, s[68:71], s15 offen nt
    s_add_u32 s10, s8, 24117248
    s_addc_u32 s11, s9, 0
    s_load_dword s100, s[10:11], 0
    v_lshrrev_b32 v1, 3, v0
    v_lshlrev_b32 v170, 2, v1
    v_and_b32 v197, 7, v0
    v_and_b32 v5, 16, v0
    v_lshlrev_b32 v5, 1, v5
    v_xor_b32 v5, v5, v189
    v_lshlrev_b32 v172, 4, v254
    v_and_b32 v241, 16, v254
    v_lshlrev_b32 v241, 2, v241
    v_xor_b32 v234, v241, v172
    v_and_b32 v241, 0x70, v234
    s_mov_b32 s16, s40
    s_mov_b32 s17, s41
    s_mov_b32 s18, 6400000
    s_mov_b32 s19, 0x20000
    s_mov_b32 s60, 85599
    s_mov_b32 s61, 4294967100
    s_movk_i32 s62, 2000
    v_mov_b32 v7, 87382
    s_mov_b32 s10, 0
    v_lshl_add_u32 v56, v254, 10, s10
    v_add_u32 v57, 256, v56
    v_add_u32 v58, 512, v56
    v_add_u32 v59, 768, v56
    v_and_b32 v60, 127, v255
    v_lshl_add_u32 v60, v60, 9, s10
    v_add_u32 v61, 256, v60
    v_lshl_add_u32 v62, v254, 8, s10
    v_lshrrev_b32 v23, 6, v255
    v_lshrrev_b32 v31, 7, v255
    v_add_u32 v31, 8, v31
    v_mov_b32 v39, 12
    v_cmp_gt_u32 s[78:79], 53, v255
    s_mov_b32 s11, 32896
    v_lshlrev_b32 v3, 4, v197
    v_mad_u32_u24 v4, v1, s11, v3
    v_mul_u32_u24 v6, 52, v1
    v_lshl_add_u32 v6, v197, 2, v6
    v_lshlrev_b32 v3, 2, v6
    v_add_u32 v3, 104448, v3
    v_add_u32 v6, 91136, v6
    v_mov_b32 v214, 0xf0f0f0
    v_mov_b32 v15, 0x0f0f0f
    s_waitcnt vmcnt(3)
    v_mul_u32_u24 v48, s60, v8
    v_mul_u32_u24 v49, s60, v9
    v_mul_u32_u24 v50, s60, v10
    v_mul_u32_u24 v51, s60, v11
    v_mul_u32_u24 v52, s60, v12
    v_mul_u32_u24 v53, s60, v13
    v_lshrrev_b32 v48, 24, v48
    v_lshrrev_b32 v49, 24, v49
    v_lshrrev_b32 v50, 24, v50
    v_lshrrev_b32 v51, 24, v51
    v_lshrrev_b32 v52, 24, v52
    v_lshrrev_b32 v53, 24, v53
    v_lshl_add_u32 v24, v48, 2, s62
    ds_add_rtn_u32 v32, v24, v7 offset:4400
    v_lshl_add_u32 v25, v49, 2, s62
    ds_add_rtn_u32 v33, v25, v7 offset:4400
    v_lshl_add_u32 v26, v50, 2, s62
    ds_add_rtn_u32 v34, v26, v7 offset:4400
    v_lshl_add_u32 v27, v51, 2, s62
    ds_add_rtn_u32 v35, v27, v7 offset:4400
    v_lshl_add_u32 v28, v52, 2, s62
    ds_add_rtn_u32 v36, v28, v7 offset:4400
    v_lshl_add_u32 v29, v53, 2, s62
    ds_add_rtn_u32 v37, v29, v7 offset:4400
    v_mad_i32_i24 v8, v48, s61, v8
    v_or_b32 v8, v8, v56
    v_mad_i32_i24 v9, v49, s61, v9
    v_or_b32 v9, v9, v57
    v_mad_i32_i24 v10, v50, s61, v10
    v_or_b32 v10, v10, v58
    v_mad_i32_i24 v11, v51, s61, v11
    v_or_b32 v11, v11, v59
    v_mad_i32_i24 v12, v52, s61, v12
    v_or_b32 v12, v12, v60
    v_mad_i32_i24 v13, v53, s61, v13
    v_or_b32 v13, v13, v61
    s_waitcnt lgkmcnt(5)
    v_lshrrev_b32 v32, 16, v32
    v_min_u32 v40, 48, v32
    v_mad_u32_u24 v40, v24, 13, v40
    v_lshlrev_b32 v48, 2, v40
    ds_write_b8 v40, v23 offset:65136
    s_waitcnt lgkmcnt(5)
    v_lshrrev_b32 v33, 16, v33
    v_min_u32 v41, 48, v33
    v_mad_u32_u24 v41, v25, 13, v41
    v_lshlrev_b32 v49, 2, v41
    ds_write_b8 v41, v23 offset:65136
    s_waitcnt lgkmcnt(5)
    v_lshrrev_b32 v34, 16, v34
    v_min_u32 v42, 48, v34
    v_mad_u32_u24 v42, v26, 13, v42
    v_lshlrev_b32 v50, 2, v42
    ds_write_b8 v42, v23 offset:65136
    s_waitcnt lgkmcnt(5)
    v_lshrrev_b32 v35, 16, v35
    v_min_u32 v43, 48, v35
    v_mad_u32_u24 v43, v27, 13, v43
    v_lshlrev_b32 v51, 2, v43
    ds_write_b8 v43, v23 offset:65136
    s_waitcnt lgkmcnt(5)
    v_lshrrev_b32 v36, 16, v36
    v_min_u32 v44, 48, v36
    v_mad_u32_u24 v44, v28, 13, v44
    v_lshlrev_b32 v52, 2, v44
    ds_write_b8 v44, v31 offset:65136
    s_waitcnt lgkmcnt(5)
    v_lshrrev_b32 v37, 16, v37
    v_min_u32 v45, 48, v37
    v_mad_u32_u24 v45, v29, 13, v45
    v_lshlrev_b32 v53, 2, v45
    ds_write_b8 v45, v31 offset:65136
    s_cmp_lg_u32 s7, 0
    s_cbranch_scc1 K1_NO7
    s_mov_b64 exec, s[78:79]
    s_waitcnt lgkmcnt(0)
    v_mul_u32_u24 v54, s60, v14
    v_lshrrev_b32 v54, 24, v54
    v_lshl_add_u32 v30, v54, 2, s62
    ds_add_rtn_u32 v38, v30, v7 offset:4400
    v_mad_i32_i24 v14, v54, s61, v14
    v_or_b32 v14, v14, v62
    s_waitcnt lgkmcnt(0)
    v_lshrrev_b32 v38, 16, v38
    v_min_u32 v46, 48, v38
    v_mad_u32_u24 v46, v30, 13, v46
    v_lshlrev_b32 v54, 2, v46
    ds_write_b8 v46, v39 offset:65136
    s_waitcnt vmcnt(0)
    v_lshl_add_u32 v22, v22, 16, v14
    ds_write_b32 v54, v22 offset:448
    s_mov_b64 exec, -1
K1_NO7:
    s_mov_b32 s64, s50
    s_mov_b32 s65, s51
    s_mov_b32 s66, 8192
    s_mov_b32 s67, 0x20000
    buffer_load_dwordx4 v[64:67], v5, s[64:67], 0 offen
    s_mov_b32 s68, s52
    s_mov_b32 s69, s53
    s_mov_b32 s70, 2048
    s_mov_b32 s71, 0x20000
    buffer_load_dwordx4 v[68:71], v5, s[68:71], 0 offen
    s_lshl_b32 s10, s7, 10
    s_mov_b32 s64, s48
    s_mov_b32 s65, s49
    s_add_u32 m0, s10, 34304
    s_nop 0
    buffer_load_dwordx4 v5, s[64:67], 0 offen lds
    s_mov_b32 s64, s56
    s_mov_b32 s65, s57
    s_add_u32 m0, s10, 26112
    s_nop 0
    buffer_load_dwordx4 v5, s[64:67], 0 offen lds
    s_mov_b32 s64, s54
    s_mov_b32 s65, s55
    s_add_u32 m0, s10, 9728
    s_nop 0
    buffer_load_dwordx4 v5, s[64:67], 0 offen lds
    s_waitcnt vmcnt(5)
    v_lshl_add_u32 v16, v16, 16, v8
    ds_write_b32 v48, v16 offset:448
    v_lshl_add_u32 v17, v17, 16, v9
    ds_write_b32 v49, v17 offset:448
    v_lshl_add_u32 v18, v18, 16, v10
    ds_write_b32 v50, v18 offset:448
    v_lshl_add_u32 v19, v19, 16, v11
    ds_write_b32 v51, v19 offset:448
    v_lshl_add_u32 v20, v20, 16, v12
    ds_write_b32 v52, v20 offset:448
    v_lshl_add_u32 v21, v21, 16, v13
    ds_write_b32 v53, v21 offset:448
    s_lshl_b32 s15, s12, 7
    s_add_u32 s32, s8, s15
    s_addc_u32 s33, s9, 0
    s_mov_b32 s34, 16809984
    s_mov_b32 s35, 0x20000
    s_waitcnt lgkmcnt(0)
    s_add_u32 s100, s100, 1
    s_and_b32 s10, s100, 15
    s_and_b32 s11, s100, 0xf0
    s_mul_i32 s36, s10, 0x1010
    s_lshl_b32 s11, s11, 16
    s_xor_b32 s36, s36, 0xf000
    s_or_b32 s36, s36, s11
    s_mov_b32 s101, 200000
    s_barrier
    ds_read_b128 v[112:115], v172 offset:6400
    ds_read_u16 v108, v170 offset:6402
    ds_read_b32 v104, v6 offset:0
    ds_read_b128 v[88:91], v3 offset:0
    ds_read_u16 v109, v170 offset:6658
    ds_read_b32 v105, v6 offset:3328
    ds_read_b128 v[92:95], v3 offset:13312
    ds_read_u16 v110, v170 offset:6914
    ds_read_b32 v106, v6 offset:6656
    ds_read_b128 v[96:99], v3 offset:26624
    ds_read_u16 v111, v170 offset:7170
    ds_read_b32 v107, v6 offset:9984
    ds_read_b128 v[100:103], v3 offset:39936
    s_waitcnt lgkmcnt(12)
    v_max3_u32 v1, v112, v113, v114
    v_max_u32 v1, v1, v115
    v_cmp_le_u32 vcc, 3211264, v1
    s_mov_b32 s10, 0
    s_cbranch_vccnz K1_OVF
K1_OUT:
    s_waitcnt lgkmcnt(9)
    v_lshl_or_b32 v108, v108, 24, s36
    v_and_or_b32 v91, v104, v15, v108
    buffer_store_dwordx4 v[88:91], v4, s[32:35], s10 offen sc1
    s_add_u32 s10, s10, 2105344
    s_waitcnt lgkmcnt(6)
    v_lshl_or_b32 v109, v109, 24, s36
    v_and_or_b32 v95, v105, v15, v109
    buffer_store_dwordx4 v[92:95], v4, s[32:35], s10 offen sc1
    s_add_u32 s10, s10, 2105344
    s_waitcnt lgkmcnt(3)
    v_lshl_or_b32 v110, v110, 24, s36
    v_and_or_b32 v99, v106, v15, v110
    buffer_store_dwordx4 v[96:99], v4, s[32:35], s10 offen sc1
    s_add_u32 s10, s10, 2105344
    s_waitcnt lgkmcnt(0)
    v_lshl_or_b32 v111, v111, 24, s36
    v_and_or_b32 v103, v107, v15, v111
    buffer_store_dwordx4 v[100:103], v4, s[32:35], s10 offen sc1
    s_add_u32 s10, s10, 2105344
    v_max3_u32 v1, v108, v109, v110
    v_max_u32 v1, v1, v111
    v_cmp_le_u32 vcc, 553648128, v1
    s_cbranch_vccnz K1_EXT
K1_EXTR:
    s_lshr_b32 s10, s3, 1
    s_mul_i32 s10, s10, 49
    s_bitcmp1_b32 s3, 0
    s_cselect_b32 s72, 20, -4
    s_cselect_b32 s73, 28, 3
    s_cselect_b32 s84, 45, 20
    s_add_i32 s72, s72, s10
    s_add_i32 s73, s73, s10
    s_add_i32 s84, s84, s10
    s_add_i32 s85, s72, 32
    s_max_i32 s96, s72, 0
    s_cmp_eq_u32 s3, 7
    s_cselect_b32 s84, 196, s84
    s_cselect_b32 s85, 196, s85
    v_lshrrev_b32 v193, 5, v254
    s_mov_b32 s20, s42
    s_mov_b32 s21, s43
    s_mov_b32 s22, 25600000
    s_mov_b32 s23, 0x20000
    s_mov_b32 s28, s58
    s_mov_b32 s29, s59
    s_mov_b32 s30, 6400000
    s_mov_b32 s31, 0x20000
    s_mov_b32 s24, s8
    s_mov_b32 s25, s9
    s_mov_b32 s26, 24117376
    s_mov_b32 s27, 0x20000
    v_lshrrev_b32 v194, 5, v255
    v_and_b32 v195, 15, v255
    v_cmp_eq_u32 vcc, v194, v195
    v_and_b32 v194, 16, v255
    v_mov_b32 v195, 0x3f80
    v_lshlrev_b32 v195, v194, v195
    v_cndmask_b32 v195, 0, v195, vcc
    v_lshlrev_b32 v194, 2, v255
    v_mov_b32 v196, 0
    ds_write_b32 v194, v195
    v_bfe_u32 v195, v255, 3, 1
    v_and_b32 v201, 7, v255
    v_lshl_add_u32 v195, v195, 2, v201
    v_lshrrev_b32 v200, 6, v255
    v_cmp_eq_u32 vcc, v195, v200
    v_bfe_u32 v200, v255, 4, 2
    v_mov_b32 v195, 0x3f80
    v_cndmask_b32 v195, 0, v195, vcc
    v_cmp_lt_u32 vcc, 3, v201
    v_mul_u32_u24 v200, 0x5555, v200
    v_and_b32 v201, 60, v194
    v_cndmask_b32 v195, v195, v200, vcc
    ds_write_b32 v194, v195 offset:7424
    ds_write_b32 v201, v196 offset:9472
    ds_write_b32 v194, v196 offset:2048
    ds_write2st64_b32 v194, v196, v196 offset0:9 offset1:17
    s_movk_i32 s75, 128
    s_mul_i32 s74, s3, 5184
    s_add_u32 s74, s74, 102400
    s_movk_i32 s77, 48
    s_add_u32 s39, s96, 32
    s_lshl_b32 s11, s96, 6
    s_mov_b32 s97, 0
    v_bfe_u32 v194, v254, 4, 1
    v_and_b32 v242, 1, v254
    v_lshlrev_b32 v242, 4, v242
    v_lshlrev_b32 v245, 5, v193
    v_subrev_u32 v245, s11, v245
    v_and_b32 v195, 3, v254
    v_lshlrev_b32 v195, 3, v195
    v_lshl_add_u32 v246, v194, 5, v195
    v_subrev_u32 v246, s11, v246
    v_mul_u32_u24 v196, 130, v195
    v_and_b32 v194, 28, v254
    v_lshl_add_u32 v196, v194, 5, v196
    v_bfe_u32 v194, v254, 3, 1
    v_xor_b32 v194, v194, v193
    v_lshl_add_u32 v196, v194, 6, v196
    v_add_u32 v243, s74, v196
    v_and_b32 v194, 31, v254
    v_lshl_add_u32 v194, v194, 1, v193
    v_lshl_add_u32 v244, v194, 4, s74
    v_add_u32 v244, 4160, v244
    s_mul_i32 s76, s3, 2688
    s_add_u32 s76, s76, 9728
    v_lshrrev_b32 v194, 3, v254
    v_lshl_add_u32 v247, v194, 4, s76
    v_and_b32 v194, 31, v254
    v_lshl_add_u32 v249, v194, 2, s76
    v_lshrrev_b32 v195, 1, v254
    v_lshl_add_u32 v251, v195, 2, s76
    v_add_u32 v251, 21504, v251
    v_and_b32 v194, 44, v254
    v_add_u32 v248, s76, v194
    s_mul_i32 s10, s7, 4160
    s_add_u32 s10, s10, 69120
    v_and_b32 v202, 31, v254
    v_bfe_u32 v194, v202, 1, 1
    v_xor_b32 v194, v194, v193
    v_lshlrev_b32 v194, 6, v194
    v_lshl_add_u32 v194, v202, 7, v194
    v_lshrrev_b32 v202, 3, v202
    v_lshl_add_u32 v202, v202, 4, v194
    v_add_u32 v202, s10, v202
    v_lshrrev_b32 v194, 1, v254
    v_xor_b32 v194, v194, v254
    v_and_b32 v194, 4, v194
    v_mul_u32_u24 v194, 3, v194
    v_xor_b32 v194, v194, v254
    v_and_b32 v235, 31, v194
    v_bfe_u32 v195, v235, 1, 1
    v_xor_b32 v195, v195, v193
    v_lshlrev_b32 v195, 6, v195
    v_lshl_add_u32 v195, v235, 7, v195
    v_lshrrev_b32 v235, 3, v235
    v_lshl_add_u32 v235, v235, 4, v195
    v_add_u32 v235, s10, v235
    v_mov_b32 v177, 0xdddd
    v_lshlrev_b32 v168, 2, v197
    v_mul_u32_u24 v208, 25000, v170
    v_add_u32 v209, 6400000, v208
    v_add_u32 v210, 12800000, v208
    v_add_u32 v211, 19200000, v208
    v_mov_b32 v171, 4
    v_mov_b32 v169, 1
    v_and_b32 v199, 31, v254
    v_add_u32 v199, s96, v199
    v_lshlrev_b32 v200, 4, v199
    v_lshl_add_u32 v200, v193, 3, v200
    v_mov_b64 v[180:181], 0
    v_mov_b64 v[182:183], 0
    v_mov_b64 v[184:185], 0
    v_mov_b64 v[186:187], 0
    s_lshl_b32 s15, s3, 2
    v_mov_b32 v212, s15
    v_lshlrev_b32 v213, 2, v199
    s_mul_i32 s10, s12, 32896
    s_add_u32 s32, s8, s10
    s_addc_u32 s33, s9, 0
    s_mov_b32 s34, 32768
    s_mov_b32 s35, 0x20000
    s_movk_i32 s79, 8192
    s_movk_i32 s80, 16384
    s_movk_i32 s81, 24576
    s_mov_b32 s10, 0xbfb8aa3b
    s_waitcnt vmcnt(7)
    v_lshlrev_b32 v72, 16, v64
    v_and_b32 v73, 0xffff0000, v64
    v_lshlrev_b32 v74, 16, v65
    v_and_b32 v75, 0xffff0000, v65
    v_lshlrev_b32 v76, 16, v66
    v_and_b32 v77, 0xffff0000, v66
    v_lshlrev_b32 v78, 16, v67
    v_and_b32 v79, 0xffff0000, v67
    v_lshlrev_b32 v80, 16, v68
    v_and_b32 v81, 0xffff0000, v68
    v_lshlrev_b32 v82, 16, v69
    v_and_b32 v83, 0xffff0000, v69
    v_lshlrev_b32 v84, 16, v70
    v_and_b32 v85, 0xffff0000, v70
    v_lshlrev_b32 v86, 16, v71
    v_and_b32 v87, 0xffff0000, v71
    v_mul_f32 v72, s10, v72
    v_mul_f32 v73, s10, v73
    v_mul_f32 v74, s10, v74
    v_mul_f32 v75, s10, v75
    v_mul_f32 v76, s10, v76
    v_mul_f32 v77, s10, v77
    v_mul_f32 v78, s10, v78
    v_mul_f32 v79, s10, v79
    v_mul_f32 v80, s10, v80
    v_mul_f32 v81, s10, v81
    v_mul_f32 v82, s10, v82
    v_mul_f32 v83, s10, v83
    v_mul_f32 v84, s10, v84
    v_mul_f32 v85, s10, v85
    v_mul_f32 v86, s10, v86
    v_mul_f32 v87, s10, v87
    v_cvt_pk_bf16_f32 v64, v72, v73
    v_cvt_pk_bf16_f32 v65, v74, v75
    v_cvt_pk_bf16_f32 v66, v76, v77
    v_cvt_pk_bf16_f32 v67, v78, v79
    v_cvt_pk_bf16_f32 v68, v80, v81
    v_cvt_pk_bf16_f32 v69, v82, v83
    v_cvt_pk_bf16_f32 v70, v84, v85
    v_cvt_pk_bf16_f32 v71, v86, v87
    ds_write_b128 v189, v[64:67] offset:17920
    s_cmp_ge_u32 s7, 2
    s_cbranch_scc1 K1_NOWC
    ds_write_b128 v189, v[68:71] offset:42496
K1_NOWC:
    v_bfe_u32 v173, v254, 2, 2
    v_lshlrev_b32 v173, 7, v173
    v_lshl_add_u32 v173, v242, 2, v173
    v_and_b32 v174, 16, v254
    v_and_b32 v175, 2, v254
    v_lshl_add_u32 v174, v175, 2, v174
    v_and_b32 v175, 8, v254
    v_lshl_add_u32 v174, v175, 2, v174
    v_add_u32 v173, v173, v174
    v_lshl_add_u32 v175, v193, 10, v173
    v_lshl_add_u32 v173, v193, 12, v173
    v_xor_b32 v174, 32, v173
    v_xor_b32 v176, 32, v175
    s_lshl_b32 s10, s7, 10
    s_and_b32 s11, s7, 4
    s_mul_i32 s11, s11, -1016
    s_add_u32 s11, s11, s10
    v_xor_b32 v252, s11, v173
    s_waitcnt vmcnt(0) lgkmcnt(0)
    s_barrier
    ds_read_b64_tr_b16 v[72:73], v252 offset:9728
    ds_read_b64_tr_b16 v[76:77], v252 offset:34304
    ds_read_b64_tr_b16 v[74:75], v252 offset:10240
    ds_read_b64_tr_b16 v[78:79], v252 offset:34816
    v_add_u32 v252, s10, v172
    ds_read_b64_tr_b16 v[0:1], v173 offset:17920
    ds_read_b64_tr_b16 v[2:3], v173 offset:18432
    ds_read_b64_tr_b16 v[4:5], v173 offset:18944
    ds_read_b64_tr_b16 v[6:7], v173 offset:19456
    ds_read_b64_tr_b16 v[8:9], v173 offset:19968
    ds_read_b64_tr_b16 v[10:11], v173 offset:20480
    ds_read_b64_tr_b16 v[12:13], v173 offset:20992
    ds_read_b64_tr_b16 v[14:15], v173 offset:21504
    s_waitcnt lgkmcnt(8)
    ds_write_b128 v252, v[72:75] offset:52736
    ds_write_b128 v252, v[76:79] offset:60928
    s_waitcnt lgkmcnt(8)
    ds_read_b64_tr_b16 v[16:17], v174 offset:17920
    ds_read_b64_tr_b16 v[18:19], v174 offset:18432
    ds_read_b64_tr_b16 v[20:21], v174 offset:18944
    ds_read_b64_tr_b16 v[22:23], v174 offset:19456
    ds_read_b64_tr_b16 v[24:25], v174 offset:19968
    ds_read_b64_tr_b16 v[26:27], v174 offset:20480
    s_waitcnt lgkmcnt(8)
    ds_read_b64_tr_b16 v[28:29], v174 offset:20992
    ds_read_b64_tr_b16 v[30:31], v174 offset:21504
    ds_read_b64_tr_b16 v[64:65], v175 offset:42496
    ds_read_b64_tr_b16 v[66:67], v175 offset:43008
    ds_read_b64_tr_b16 v[68:69], v176 offset:42496
    ds_read_b64_tr_b16 v[70:71], v176 offset:43008
    s_waitcnt lgkmcnt(8)
    ds_read_b64_tr_b16 v[32:33], v173 offset:26112
    ds_read_b64_tr_b16 v[34:35], v173 offset:26624
    ds_read_b64_tr_b16 v[36:37], v173 offset:27136
    ds_read_b64_tr_b16 v[38:39], v173 offset:27648
    ds_read_b64_tr_b16 v[40:41], v173 offset:28160
    ds_read_b64_tr_b16 v[42:43], v173 offset:28672
    s_waitcnt lgkmcnt(8)
    ds_read_b64_tr_b16 v[44:45], v173 offset:29184
    ds_read_b64_tr_b16 v[46:47], v173 offset:29696
    ds_read_b64_tr_b16 v[48:49], v174 offset:26112
    ds_read_b64_tr_b16 v[50:51], v174 offset:26624
    ds_read_b64_tr_b16 v[52:53], v174 offset:27136
    ds_read_b64_tr_b16 v[54:55], v174 offset:27648
    s_waitcnt lgkmcnt(8)
    ds_read_b64_tr_b16 v[56:57], v174 offset:28160
    ds_read_b64_tr_b16 v[58:59], v174 offset:28672
    ds_read_b64_tr_b16 v[60:61], v174 offset:29184
    ds_read_b64_tr_b16 v[62:63], v174 offset:29696
    s_mov_b32 s5, 85899
    buffer_load_dwordx4 v[88:91], v189, s[32:35], 0 offen sc1
    buffer_load_dwordx4 v[92:95], v189, s[32:35], s79 offen sc1
    buffer_load_dwordx4 v[96:99], v189, s[32:35], s80 offen sc1
    buffer_load_dwordx4 v[100:103], v189, s[32:35], s81 offen sc1
K2_CHK0:
    s_waitcnt vmcnt(3)
    v_bitop3_b32 v188, v91, s36, v214 bitop3:0x28
    v_cmp_ne_u32 vcc, 0, v188
    v_sub_u32_sdwa v188, v91, v168 dst_sel:DWORD dst_unused:UNUSED_PAD src0_sel:BYTE_3 src1_sel:DWORD
    v_mul_u32_u24_sdwa v104, s5, v88 dst_sel:DWORD dst_unused:UNUSED_PAD src0_sel:DWORD src1_sel:WORD_1
    v_mul_u32_u24_sdwa v105, s5, v89 dst_sel:DWORD dst_unused:UNUSED_PAD src0_sel:DWORD src1_sel:WORD_1
    v_mul_u32_u24_sdwa v106, s5, v90 dst_sel:DWORD dst_unused:UNUSED_PAD src0_sel:DWORD src1_sel:WORD_1
    s_cbranch_vccnz K2_RETRY0
    v_cmp_lt_i32 s[40:41], 0, v188
    v_cmp_lt_i32 s[42:43], 1, v188
    v_cmp_lt_i32 s[44:45], 2, v188
    v_alignbit_b32 v104, v88, v104, 28
    v_alignbit_b32 v105, v89, v105, 28
    v_alignbit_b32 v106, v90, v106, 28
    v_and_b32 v104, 0xffc, v104
    v_and_b32 v105, 0xffc, v105
    v_and_b32 v106, 0xffc, v106
    s_mov_b64 exec, s[40:41]
    ds_add_rtn_u32 v220, v104, v171 offset:2304
    s_mov_b64 exec, s[42:43]
    ds_add_rtn_u32 v221, v105, v171 offset:2304
    s_mov_b64 exec, s[44:45]
    ds_add_rtn_u32 v222, v106, v171 offset:2304
    s_mov_b64 exec, -1
K2_CHK1:
    s_waitcnt vmcnt(2)
    v_bitop3_b32 v188, v95, s36, v214 bitop3:0x28
    v_cmp_ne_u32 vcc, 0, v188
    v_sub_u32_sdwa v188, v95, v168 dst_sel:DWORD dst_unused:UNUSED_PAD src0_sel:BYTE_3 src1_sel:DWORD
    v_mul_u32_u24_sdwa v107, s5, v92 dst_sel:DWORD dst_unused:UNUSED_PAD src0_sel:DWORD src1_sel:WORD_1
    v_mul_u32_u24_sdwa v108, s5, v93 dst_sel:DWORD dst_unused:UNUSED_PAD src0_sel:DWORD src1_sel:WORD_1
    v_mul_u32_u24_sdwa v109, s5, v94 dst_sel:DWORD dst_unused:UNUSED_PAD src0_sel:DWORD src1_sel:WORD_1
    s_cbranch_vccnz K2_RETRY1
    v_cmp_lt_i32 s[46:47], 0, v188
    v_cmp_lt_i32 s[48:49], 1, v188
    v_cmp_lt_i32 s[50:51], 2, v188
    v_alignbit_b32 v107, v92, v107, 28
    v_alignbit_b32 v108, v93, v108, 28
    v_alignbit_b32 v109, v94, v109, 28
    v_and_b32 v107, 0xffc, v107
    v_and_b32 v108, 0xffc, v108
    v_and_b32 v109, 0xffc, v109
    s_mov_b64 exec, s[46:47]
    ds_add_rtn_u32 v223, v107, v171 offset:2304
    s_mov_b64 exec, s[48:49]
    ds_add_rtn_u32 v224, v108, v171 offset:2304
    s_mov_b64 exec, s[50:51]
    ds_add_rtn_u32 v225, v109, v171 offset:2304
    s_mov_b64 exec, -1
K2_CHK2:
    s_waitcnt vmcnt(1)
    v_bitop3_b32 v188, v99, s36, v214 bitop3:0x28
    v_cmp_ne_u32 vcc, 0, v188
    v_sub_u32_sdwa v188, v99, v168 dst_sel:DWORD dst_unused:UNUSED_PAD src0_sel:BYTE_3 src1_sel:DWORD
    v_mul_u32_u24_sdwa v110, s5, v96 dst_sel:DWORD dst_unused:UNUSED_PAD src0_sel:DWORD src1_sel:WORD_1
    v_mul_u32_u24_sdwa v111, s5, v97 dst_sel:DWORD dst_unused:UNUSED_PAD src0_sel:DWORD src1_sel:WORD_1
    v_mul_u32_u24_sdwa v112, s5, v98 dst_sel:DWORD dst_unused:UNUSED_PAD src0_sel:DWORD src1_sel:WORD_1
    s_cbranch_vccnz K2_RETRY2
    v_cmp_lt_i32 s[52:53], 0, v188
    v_cmp_lt_i32 s[54:55], 1, v188
    v_cmp_lt_i32 s[56:57], 2, v188
    v_alignbit_b32 v110, v96, v110, 28
    v_alignbit_b32 v111, v97, v111, 28
    v_alignbit_b32 v112, v98, v112, 28
    v_and_b32 v110, 0xffc, v110
    v_and_b32 v111, 0xffc, v111
    v_and_b32 v112, 0xffc, v112
    s_mov_b64 exec, s[52:53]
    ds_add_rtn_u32 v226, v110, v171 offset:2304
    s_mov_b64 exec, s[54:55]
    ds_add_rtn_u32 v227, v111, v171 offset:2304
    s_mov_b64 exec, s[56:57]
    ds_add_rtn_u32 v228, v112, v171 offset:2304
    s_mov_b64 exec, -1
K2_CHK3:
    s_waitcnt vmcnt(0)
    v_bitop3_b32 v188, v103, s36, v214 bitop3:0x28
    v_cmp_ne_u32 vcc, 0, v188
    v_sub_u32_sdwa v188, v103, v168 dst_sel:DWORD dst_unused:UNUSED_PAD src0_sel:BYTE_3 src1_sel:DWORD
    v_mul_u32_u24_sdwa v113, s5, v100 dst_sel:DWORD dst_unused:UNUSED_PAD src0_sel:DWORD src1_sel:WORD_1
    v_mul_u32_u24_sdwa v114, s5, v101 dst_sel:DWORD dst_unused:UNUSED_PAD src0_sel:DWORD src1_sel:WORD_1
    v_mul_u32_u24_sdwa v115, s5, v102 dst_sel:DWORD dst_unused:UNUSED_PAD src0_sel:DWORD src1_sel:WORD_1
    s_cbranch_vccnz K2_RETRY3
    v_cmp_lt_i32 s[58:59], 0, v188
    v_cmp_lt_i32 s[60:61], 1, v188
    v_cmp_lt_i32 s[62:63], 2, v188
    v_alignbit_b32 v113, v100, v113, 28
    v_alignbit_b32 v114, v101, v114, 28
    v_alignbit_b32 v115, v102, v115, 28
    v_and_b32 v113, 0xffc, v113
    v_and_b32 v114, 0xffc, v114
    v_and_b32 v115, 0xffc, v115
    s_mov_b64 exec, s[58:59]
    ds_add_rtn_u32 v229, v113, v171 offset:2304
    s_mov_b64 exec, s[60:61]
    ds_add_rtn_u32 v230, v114, v171 offset:2304
    s_mov_b64 exec, s[62:63]
    ds_add_rtn_u32 v231, v115, v171 offset:2304
    s_mov_b64 exec, -1
    v_max3_u32 v188, v91, v95, v99
    v_max_u32 v188, v188, v103
    v_cmp_le_u32 vcc, 553648128, v188
    s_mov_b32 s64, 0xc0c0401
    s_mov_b32 s65, 0xc0c0501
    s_mov_b32 s66, 0xc0c0601
    s_mov_b32 s67, 0x05040100
    s_cbranch_vccnz K2_XT1
K2_XT1R:
    s_waitcnt lgkmcnt(0)
    s_barrier
    ds_read_b128 v[116:119], v172 offset:2304
    ds_read_b128 v[120:123], v172 offset:3328
    ds_read_b128 v[124:127], v172 offset:4352
    ds_read_b128 v[128:131], v172 offset:5376
    ds_read_b64 v[194:195], v200 offset:2304
    s_mul_i32 s10, s12, 196
    s_add_u32 s10, s10, s96
    s_lshl_b32 s10, s10, 7
    s_mul_i32 s11, s7, 4160
    s_add_u32 m0, s11, 69120
    s_add_u32 s86, s10, 0
    buffer_load_dwordx4 v234, s[16:19], s86 offen lds
    s_add_u32 m0, s11, 70160
    s_add_u32 s86, s10, 1024
    buffer_load_dwordx4 v234, s[16:19], s86 offen lds
    s_add_u32 m0, s11, 71200
    s_add_u32 s86, s10, 2048
    buffer_load_dwordx4 v234, s[16:19], s86 offen lds
    s_add_u32 m0, s11, 72240
    s_add_u32 s86, s10, 3072
    buffer_load_dwordx4 v234, s[16:19], s86 offen lds
K2_NOXE:
    v_and_b32 v91, 0x0f0f0f, v91
    v_and_b32 v95, 0x0f0f0f, v95
    v_and_b32 v99, 0x0f0f0f, v99
    v_and_b32 v103, 0x0f0f0f, v103
    v_perm_b32 v152, v91, v88, s64
    v_perm_b32 v153, v91, v89, s65
    v_perm_b32 v154, v91, v90, s66
    v_perm_b32 v155, v95, v92, s64
    s_waitcnt lgkmcnt(4)
    v_add_u32_sdwa v188, v116, v117 dst_sel:DWORD dst_unused:UNUSED_PAD src0_sel:WORD_0 src1_sel:WORD_0
    v_add_u32_sdwa v116, v118, v119 dst_sel:DWORD dst_unused:UNUSED_PAD src0_sel:WORD_0 src1_sel:WORD_0
    v_add_u32 v188, v188, v116
    s_waitcnt lgkmcnt(3)
    v_add_u32_sdwa v189, v120, v121 dst_sel:DWORD dst_unused:UNUSED_PAD src0_sel:WORD_0 src1_sel:WORD_0
    v_add_u32_sdwa v120, v122, v123 dst_sel:DWORD dst_unused:UNUSED_PAD src0_sel:WORD_0 src1_sel:WORD_0
    v_add_u32 v189, v189, v120
    s_waitcnt lgkmcnt(2)
    v_add_u32_sdwa v190, v124, v125 dst_sel:DWORD dst_unused:UNUSED_PAD src0_sel:WORD_0 src1_sel:WORD_0
    v_add_u32_sdwa v124, v126, v127 dst_sel:DWORD dst_unused:UNUSED_PAD src0_sel:WORD_0 src1_sel:WORD_0
    v_add_u32 v190, v190, v124
    s_waitcnt lgkmcnt(1)
    v_add_u32_sdwa v191, v128, v129 dst_sel:DWORD dst_unused:UNUSED_PAD src0_sel:WORD_0 src1_sel:WORD_0
    v_add_u32_sdwa v128, v130, v131 dst_sel:DWORD dst_unused:UNUSED_PAD src0_sel:WORD_0 src1_sel:WORD_0
    v_add_u32 v191, v191, v128
    v_lshl_or_b32 v192, v189, 16, v188
    v_lshl_or_b32 v193, v191, 16, v190
    s_waitcnt lgkmcnt(0)
    v_perm_b32 v198, v195, v194, s67
    v_add_u32_dpp v192, v192, v192 row_shr:1 row_mask:0xf bank_mask:0xf bound_ctrl:0
    v_add_u32_dpp v193, v193, v193 row_shr:1 row_mask:0xf bank_mask:0xf bound_ctrl:0
    v_perm_b32 v156, v95, v93, s65
    v_add_u32_dpp v192, v192, v192 row_shr:2 row_mask:0xf bank_mask:0xf bound_ctrl:0
    v_add_u32_dpp v193, v193, v193 row_shr:2 row_mask:0xf bank_mask:0xf bound_ctrl:0
    v_perm_b32 v157, v95, v94, s66
    v_add_u32_dpp v192, v192, v192 row_shr:4 row_mask:0xf bank_mask:0xf bound_ctrl:0
    v_add_u32_dpp v193, v193, v193 row_shr:4 row_mask:0xf bank_mask:0xf bound_ctrl:0
    v_perm_b32 v158, v99, v96, s64
    v_add_u32_dpp v192, v192, v192 row_shr:8 row_mask:0xf bank_mask:0xf bound_ctrl:0
    v_add_u32_dpp v193, v193, v193 row_shr:8 row_mask:0xf bank_mask:0xf bound_ctrl:0
    v_perm_b32 v159, v99, v97, s65
    v_add_u32_dpp v192, v192, v192 row_bcast:15 row_mask:0xa bank_mask:0xf
    v_add_u32_dpp v193, v193, v193 row_bcast:15 row_mask:0xa bank_mask:0xf
    v_perm_b32 v160, v99, v98, s66
    v_add_u32_dpp v192, v192, v192 row_bcast:31 row_mask:0xc bank_mask:0xf
    v_add_u32_dpp v193, v193, v193 row_bcast:31 row_mask:0xc bank_mask:0xf
    v_perm_b32 v161, v103, v100, s64
    v_readlane_b32 s10, v192, 63
    v_readlane_b32 s11, v193, 63
    v_lshlrev_b32_sdwa v116, v169, v192 dst_sel:DWORD dst_unused:UNUSED_PAD src0_sel:DWORD src1_sel:WORD_0
    v_sub_u32 v188, v116, v188
    v_lshlrev_b32_sdwa v117, v169, v192 dst_sel:DWORD dst_unused:UNUSED_PAD src0_sel:DWORD src1_sel:WORD_1
    v_sub_u32 v189, v117, v189
    v_lshlrev_b32_sdwa v118, v169, v193 dst_sel:DWORD dst_unused:UNUSED_PAD src0_sel:DWORD src1_sel:WORD_0
    v_sub_u32 v190, v118, v190
    v_lshlrev_b32_sdwa v119, v169, v193 dst_sel:DWORD dst_unused:UNUSED_PAD src0_sel:DWORD src1_sel:WORD_1
    v_sub_u32 v191, v119, v191
    s_and_b32 s4, s10, 0xffff
    s_lshr_b32 s10, s10, 16
    s_add_u32 s5, s4, s10
    s_and_b32 s10, s11, 0xffff
    s_add_u32 s6, s5, s10
    s_lshr_b32 s11, s11, 16
    s_add_u32 s10, s6, s11
    v_lshl_add_u32 v189, s4, 1, v189
    v_lshl_add_u32 v190, s5, 1, v190
    v_lshl_add_u32 v191, s6, 1, v191
    s_sub_i32 s37, 12928, s10
    s_ashr_i32 s37, s37, 7
    s_max_i32 s37, s37, 1
    s_min_i32 s37, s37, 4
    s_lshr_b32 s11, s10, 5
    s_add_u32 s11, s11, 16
    s_and_b32 s11, s11, -32
    s_cmp_ge_i32 s37, 1
    s_cselect_b32 s13, 42, 10
    s_sub_i32 s11, s11, s13
    s_cmp_lt_i32 s37, 1
    s_cselect_b32 s37, -1, s37
    s_lshl_b32 s11, s11, 3
    s_lshr_b32 s10, s10, 1
    s_lshr_b32 s13, s3, 1
    s_mul_i32 s13, s13, s10
    s_add_i32 s11, s11, s13
    s_add_i32 s10, s10, s13
    s_bitcmp1_b32 s3, 0
    s_cselect_b32 s15, s11, s13
    s_cselect_b32 s10, s10, s11
    s_mov_b32 s13, 0
    s_mov_b32 s14, 0
    v_cmp_gt_i32 vcc, s15, v188
    v_cmp_gt_i32 s[86:87], s10, v188
    s_bcnt1_i32_b64 s11, vcc
    s_add_u32 s13, s13, s11
    s_bcnt1_i32_b64 s11, s[86:87]
    s_add_u32 s14, s14, s11
    v_cmp_gt_i32 vcc, s15, v189
    v_cmp_gt_i32 s[86:87], s10, v189
    s_bcnt1_i32_b64 s11, vcc
    s_add_u32 s13, s13, s11
    s_bcnt1_i32_b64 s11, s[86:87]
    s_add_u32 s14, s14, s11
    v_cmp_gt_i32 vcc, s15, v190
    v_cmp_gt_i32 s[86:87], s10, v190
    s_bcnt1_i32_b64 s11, vcc
    s_add_u32 s13, s13, s11
    s_bcnt1_i32_b64 s11, s[86:87]
    s_add_u32 s14, s14, s11
    v_cmp_gt_i32 vcc, s15, v191
    v_cmp_gt_i32 s[86:87], s10, v191
    s_bcnt1_i32_b64 s11, vcc
    s_add_u32 s13, s13, s11
    s_bcnt1_i32_b64 s11, s[86:87]
    s_add_u32 s14, s14, s11
    s_max_i32 s13, s13, s72
    s_min_i32 s13, s13, s73
    s_max_i32 s14, s14, s84
    s_min_i32 s14, s14, s85
    v_cmp_le_u32 vcc, s13, v199
    v_cmp_gt_u32 s[10:11], s14, v199
    s_mov_b32 s78, 2
    s_and_b64 vcc, vcc, s[10:11]
    v_cndmask_b32 v198, 0, v198, vcc
    v_mov_b32 v196, v198
    v_perm_b32 v162, v103, v101, s65
    v_perm_b32 v163, v103, v102, s66
    v_add_u32_dpp v196, v196, v196 row_shr:1 row_mask:0xf bank_mask:0xf bound_ctrl:0
    v_lshl_add_u32 v152, v152, 5, v208
    v_lshl_add_u32 v153, v153, 5, v208
    v_add_u32_dpp v196, v196, v196 row_shr:2 row_mask:0xf bank_mask:0xf bound_ctrl:0
    v_lshl_add_u32 v154, v154, 5, v208
    v_lshl_add_u32 v155, v155, 5, v209
    v_add_u32_dpp v196, v196, v196 row_shr:4 row_mask:0xf bank_mask:0xf bound_ctrl:0
    v_lshl_add_u32 v156, v156, 5, v209
    v_lshl_add_u32 v157, v157, 5, v209
    v_add_u32_dpp v196, v196, v196 row_shr:8 row_mask:0xf bank_mask:0xf bound_ctrl:0
    v_lshl_add_u32 v158, v158, 5, v210
    v_lshl_add_u32 v159, v159, 5, v210
    v_add_u32_dpp v196, v196, v196 row_bcast:15 row_mask:0xa bank_mask:0xf
    v_lshl_add_u32 v160, v160, 5, v210
    v_lshl_add_u32 v161, v161, 5, v211
    v_lshl_add_u32 v162, v162, 5, v211
    v_lshl_add_u32 v163, v163, 5, v211
    s_sub_u32 s86, s76, 9728
    v_readlane_b32 s10, v196, 31
    v_readlane_b32 s11, v196, 63
    v_sub_u32 v196, v196, v198
    v_mov_b32 v253, v202
    s_and_b32 s4, s10, 0xffff
    s_lshr_b32 s10, s10, 16
    s_add_u32 s5, s4, s10
    s_and_b32 s10, s11, 0xffff
    s_add_u32 s6, s5, s10
    s_lshr_b32 s11, s11, 16
    s_add_u32 s15, s6, s11
    s_lshl_b32 s10, s4, 16
    s_pack_ll_b32_b16 s11, s5, s6
    s_pack_ll_b32_b16 s86, s86, s86
    s_add_u32 s10, s10, s86
    s_add_u32 s11, s11, s86
    s_mov_b32 exec_lo, vcc_lo
    s_mov_b32 exec_hi, 0
    v_add_u32 v196, s10, v196
    s_mov_b32 exec_lo, 0
    s_mov_b32 exec_hi, vcc_hi
    v_add_u32 v196, s11, v196
    s_mov_b64 exec, vcc
    ds_write_b16 v200, v196 offset:2306
    ds_write_b16_d16_hi v200, v196 offset:2310
    ds_write_b32 v213, v212 offset:6400
    s_mov_b64 exec, -1
    v_mov_b32 v197, 2176
    s_cmp_le_u32 s15, 2176
    s_cbranch_scc1 K2_LFIT
    ds_write_b32 v197, v197
    s_mov_b32 s15, 0
K2_LFIT:
    s_add_u32 s15, s15, s76
    s_add_i32 s4, s4, 64
    s_lshr_b32 s4, s4, 7
    s_add_i32 s5, s5, 64
    s_lshr_b32 s5, s5, 7
    s_add_i32 s6, s6, 64
    s_lshr_b32 s6, s6, 7
    v_mov_b32 v190, 0xffff0000
    v_or_b32 v189, s39, v190
    v_mov_b32 v190, 0x7fffff00
    v_lshl_add_u32 v188, v254, 2, s15
    s_sub_u32 s73, s15, s76
    ds_write2st64_b32 v188, v189, v190 offset0:0 offset1:84
    ds_write2st64_b32 v188, v189, v190 offset0:1 offset1:85
    s_add_u32 s73, s73, 127
    s_lshr_b32 s73, s73, 7
    s_sub_i32 s38, s73, 1
    v_mov_b32 v188, s15
    ds_write_b32 v212, v188 offset:2112
    s_waitcnt lgkmcnt(0)
    s_barrier
    ds_read_b64 v[194:195], v197
    s_mov_b64 exec, s[40:41]
    ds_read_u16 v104, v104 offset:2306
    s_mov_b64 exec, s[42:43]
    ds_read_u16 v105, v105 offset:2306
    s_mov_b64 exec, s[44:45]
    ds_read_u16 v106, v106 offset:2306
    s_mov_b64 exec, s[46:47]
    ds_read_u16 v107, v107 offset:2306
    s_mov_b64 exec, s[48:49]
    ds_read_u16 v108, v108 offset:2306
    s_mov_b64 exec, s[50:51]
    ds_read_u16 v109, v109 offset:2306
    s_mov_b64 exec, s[52:53]
    ds_read_u16 v110, v110 offset:2306
    s_mov_b64 exec, s[54:55]
    ds_read_u16 v111, v111 offset:2306
    s_mov_b64 exec, s[56:57]
    ds_read_u16 v112, v112 offset:2306
    s_mov_b64 exec, s[58:59]
    ds_read_u16 v113, v113 offset:2306
    s_mov_b64 exec, s[60:61]
    ds_read_u16 v114, v114 offset:2306
    s_mov_b64 exec, s[62:63]
    ds_read_u16 v115, v115 offset:2306
    s_mov_b64 exec, -1
    s_waitcnt lgkmcnt(0)
    v_readfirstlane_b32 s83, v194
    v_readfirstlane_b32 s80, v195
    v_add_u32 v104, v104, v220
    v_add_u32 v105, v105, v221
    v_add_u32 v106, v106, v222
    v_add_u32 v107, v107, v223
    v_add_u32 v108, v108, v224
    v_add_u32 v109, v109, v225
    v_add_u32 v110, v110, v226
    v_add_u32 v111, v111, v227
    v_add_u32 v112, v112, v228
    v_add_u32 v113, v113, v229
    v_add_u32 v114, v114, v230
    v_add_u32 v115, v115, v231
    s_cmp_gt_u32 s83, 64
    s_cbranch_scc1 K2_OVF
    s_mov_b64 exec, s[40:41]
    ds_write2st64_b32 v104, v88, v152 offset0:38 offset1:122
    s_mov_b64 exec, s[42:43]
    ds_write2st64_b32 v105, v89, v153 offset0:38 offset1:122
    s_mov_b64 exec, s[44:45]
    ds_write2st64_b32 v106, v90, v154 offset0:38 offset1:122
    s_mov_b64 exec, s[46:47]
    ds_write2st64_b32 v107, v92, v155 offset0:38 offset1:122
    s_mov_b64 exec, s[48:49]
    ds_write2st64_b32 v108, v93, v156 offset0:38 offset1:122
    s_mov_b64 exec, s[50:51]
    ds_write2st64_b32 v109, v94, v157 offset0:38 offset1:122
    s_mov_b64 exec, s[52:53]
    ds_write2st64_b32 v110, v96, v158 offset0:38 offset1:122
    s_mov_b64 exec, s[54:55]
    ds_write2st64_b32 v111, v97, v159 offset0:38 offset1:122
    s_mov_b64 exec, s[56:57]
    ds_write2st64_b32 v112, v98, v160 offset0:38 offset1:122
    s_mov_b64 exec, s[58:59]
    ds_write2st64_b32 v113, v100, v161 offset0:38 offset1:122
    s_mov_b64 exec, s[60:61]
    ds_write2st64_b32 v114, v101, v162 offset0:38 offset1:122
    s_mov_b64 exec, s[62:63]
    ds_write2st64_b32 v115, v102, v163 offset0:38 offset1:122
    s_mov_b64 exec, -1
    s_cmp_lg_u32 s97, 0
    s_cbranch_scc1 K2_XT2
K2_PADS0:
    s_waitcnt lgkmcnt(0)
    s_barrier
    s_cmp_lg_u32 s83, 0
    s_cbranch_scc1 K2_XT3
K2_GO:
    ds_read_b128 v[236:239], v247
    ds_read_b32 v240, v251
    ds_read_u8 v250, v249
    s_waitcnt lgkmcnt(1)
    s_movk_i32 s10, 170
    s_bitcmp1_b32 s10, s3
    s_cbranch_scc0 K2_LATE0
    s_add_u32 m0, s74, 0
    v_mad_u32_u16 v236, v236, s75, v241 op_sel:[1,0,0,0]
    buffer_load_dwordx4 v236, s[16:19], 0 offen lds
    s_add_u32 m0, s74, 1040
    v_mad_u32_u16 v237, v237, s75, v241 op_sel:[1,0,0,0]
    buffer_load_dwordx4 v237, s[16:19], 0 offen lds
    s_add_u32 m0, s74, 2080
    v_mad_u32_u16 v238, v238, s75, v241 op_sel:[1,0,0,0]
    buffer_load_dwordx4 v238, s[16:19], 0 offen lds
    s_add_u32 m0, s74, 3120
    v_mad_u32_u16 v239, v239, s75, v241 op_sel:[1,0,0,0]
    buffer_load_dwordx4 v239, s[16:19], 0 offen lds
    s_add_u32 m0, s74, 4160
    v_add_u32 v240, v240, v242
    buffer_load_dwordx4 v240, s[20:23], 0 offen lds
K2_LATE0:
    s_cmp_lg_u32 s78, 2
    s_cbranch_scc1 K2_BUILT
    s_bitcmp1_b32 s3, 0
    s_cbranch_scc1 K2_XOLD
    s_waitcnt vmcnt(0)
K2_XOLD:
    s_waitcnt vmcnt(5)
    ds_read_b128 v[152:155], v235 offset:0
    ds_read_b128 v[156:159], v235 offset:16
    ds_read_b128 v[160:163], v235 offset:32
    ds_read_b128 v[164:167], v235 offset:48
    v_add_u32 v172, 8192, v172
    ds_read_b128 v[88:91], v172 offset:52736
    ds_read_b128 v[92:95], v172 offset:53760
    ds_read_b128 v[96:99], v172 offset:54784
    ds_read_b128 v[100:103], v172 offset:55808
    ds_read_b128 v[104:107], v172 offset:56832
    ds_read_b128 v[108:111], v172 offset:57856
    ds_read_b128 v[112:115], v172 offset:58880
    ds_read_b128 v[116:119], v172 offset:59904
    s_mov_b32 s10, 0x358637bd
    s_mov_b32 s11, s10
    v_mfma_f32_32x32x16_bf16 v[136:151], v[180:183], v[180:183], 0
    v_mov_b64 v[120:121], s[10:11]
    v_mov_b64 v[122:123], s[10:11]
    v_mov_b64 v[124:125], s[10:11]
    v_mov_b64 v[126:127], s[10:11]
    v_mov_b64 v[128:129], s[10:11]
    v_mov_b64 v[130:131], s[10:11]
    v_mov_b64 v[132:133], s[10:11]
    v_mov_b64 v[134:135], s[10:11]
    s_waitcnt lgkmcnt(7)
    v_mfma_f32_32x32x16_bf16 v[188:203], v[152:155], v[88:91], 0
    s_waitcnt lgkmcnt(6)
    v_mfma_f32_32x32x16_bf16 v[188:203], v[156:159], v[92:95], v[188:203]
    s_waitcnt lgkmcnt(5)
    v_mfma_f32_32x32x16_bf16 v[188:203], v[160:163], v[96:99], v[188:203]
    s_waitcnt lgkmcnt(4)
    v_mfma_f32_32x32x16_bf16 v[188:203], v[164:167], v[100:103], v[188:203]
    s_waitcnt lgkmcnt(3)
    v_mfma_f32_32x32x16_bf16 v[204:219], v[152:155], v[104:107], 0
    s_waitcnt lgkmcnt(2)
    v_mfma_f32_32x32x16_bf16 v[204:219], v[156:159], v[108:111], v[204:219]
    s_waitcnt lgkmcnt(1)
    v_mfma_f32_32x32x16_bf16 v[204:219], v[160:163], v[112:115], v[204:219]
    s_waitcnt lgkmcnt(0)
    v_mfma_f32_32x32x16_bf16 v[204:219], v[164:167], v[116:119], v[204:219]
    v_mfma_f32_32x32x16_bf16 v[104:119], v[180:183], v[180:183], 0
    v_mov_b64 v[88:89], s[10:11]
    v_mov_b64 v[90:91], s[10:11]
    v_mov_b64 v[92:93], s[10:11]
    v_mov_b64 v[94:95], s[10:11]
    v_mov_b64 v[96:97], s[10:11]
    v_mov_b64 v[98:99], s[10:11]
    v_mov_b64 v[100:101], s[10:11]
    v_mov_b64 v[102:103], s[10:11]
    s_mov_b32 s10, 0xbfb8aa3b
    v_mul_f32 v188, s10, v188
    v_mul_f32 v189, s10, v189
    v_mul_f32 v190, s10, v190
    v_mul_f32 v191, s10, v191
    v_mul_f32 v192, s10, v192
    v_mul_f32 v193, s10, v193
    v_mul_f32 v194, s10, v194
    v_mul_f32 v195, s10, v195
    v_mul_f32 v196, s10, v196
    v_mul_f32 v197, s10, v197
    v_mul_f32 v198, s10, v198
    v_mul_f32 v199, s10, v199
    v_mul_f32 v200, s10, v200
    v_mul_f32 v201, s10, v201
    v_mul_f32 v202, s10, v202
    v_mul_f32 v203, s10, v203
    v_mul_f32 v204, s10, v204
    v_mul_f32 v205, s10, v205
    v_mul_f32 v206, s10, v206
    v_mul_f32 v207, s10, v207
    v_mul_f32 v208, s10, v208
    v_mul_f32 v209, s10, v209
    v_mul_f32 v210, s10, v210
    v_mul_f32 v211, s10, v211
    v_mul_f32 v212, s10, v212
    v_mul_f32 v213, s10, v213
    v_mul_f32 v214, s10, v214
    v_mul_f32 v215, s10, v215
    v_mul_f32 v216, s10, v216
    v_mul_f32 v217, s10, v217
    v_mul_f32 v218, s10, v218
    v_mul_f32 v219, s10, v219
    v_cvt_pk_bf16_f32 v72, v188, v189
    v_cvt_pk_bf16_f32 v73, v190, v191
    v_cvt_pk_bf16_f32 v74, v192, v193
    v_cvt_pk_bf16_f32 v75, v194, v195
    v_cvt_pk_bf16_f32 v76, v196, v197
    v_cvt_pk_bf16_f32 v77, v198, v199
    v_cvt_pk_bf16_f32 v78, v200, v201
    v_cvt_pk_bf16_f32 v79, v202, v203
    v_cvt_pk_bf16_f32 v80, v204, v205
    v_cvt_pk_bf16_f32 v81, v206, v207
    v_cvt_pk_bf16_f32 v82, v208, v209
    v_cvt_pk_bf16_f32 v83, v210, v211
    v_cvt_pk_bf16_f32 v84, v212, v213
    v_cvt_pk_bf16_f32 v85, v214, v215
    v_cvt_pk_bf16_f32 v86, v216, v217
    v_cvt_pk_bf16_f32 v87, v218, v219
    s_mov_b32 s79, -1
    s_mov_b64 s[84:85], 0
    s_mov_b32 s81, 0
    s_mov_b32 s82, 0
    s_cmp_lg_u32 s80, 0
    s_cselect_b32 s78, 1, 0
K2_BUILT:
    s_waitcnt lgkmcnt(0)
    v_lshl_add_u32 v250, v250, 6, v245
    s_movk_i32 s10, 170
    s_bitcmp1_b32 s10, s3
    s_cbranch_scc1 K2_HAD0
    s_cmp_lt_i32 s37, 0
    s_cbranch_scc1 K2_SBY
    s_barrier
    s_mov_b32 s37, -1
K2_SBY:
    s_add_u32 m0, s74, 0
    v_mad_u32_u16 v236, v236, s75, v241 op_sel:[1,0,0,0]
    buffer_load_dwordx4 v236, s[16:19], 0 offen lds
    s_add_u32 m0, s74, 1040
    v_mad_u32_u16 v237, v237, s75, v241 op_sel:[1,0,0,0]
    buffer_load_dwordx4 v237, s[16:19], 0 offen lds
    s_add_u32 m0, s74, 2080
    v_mad_u32_u16 v238, v238, s75, v241 op_sel:[1,0,0,0]
    buffer_load_dwordx4 v238, s[16:19], 0 offen lds
    s_add_u32 m0, s74, 3120
    v_mad_u32_u16 v239, v239, s75, v241 op_sel:[1,0,0,0]
    buffer_load_dwordx4 v239, s[16:19], 0 offen lds
    s_add_u32 m0, s74, 4160
    v_add_u32 v240, v240, v242
    buffer_load_dwordx4 v240, s[20:23], 0 offen lds
K2_HAD0:
    ds_read_b128 v[236:239], v247 offset:128
    ds_read_b32 v240, v251 offset:128
    ds_read_b128 v[172:175], v250 offset:7424
    ds_read_b32 v176, v250 offset:7440
    v_mfma_f32_32x32x16_bf16 v[204:219], v[180:183], v[180:183], 0
    s_waitcnt vmcnt(0)
    ds_read_b128 v[168:171], v244
    ds_read_b128 v[152:155], v243 offset:0
    ds_read_b128 v[156:159], v243 offset:16
    ds_read_b128 v[160:163], v243 offset:32
    ds_read_b128 v[164:167], v243 offset:48
    s_waitcnt lgkmcnt(0)
    s_cmp_eq_u32 s73, 0
    s_cbranch_scc1 K2_DONE
    v_mfma_f32_32x32x16_bf16 v[188:203], v[168:171], v[64:67], 0
    v_mfma_f32_32x32x16_bf16 v[188:203], v[152:155], v[0:3], v[188:203]
    v_mfma_f32_32x32x16_bf16 v[188:203], v[156:159], v[4:7], v[188:203]
    v_mfma_f32_32x32x16_bf16 v[188:203], v[160:163], v[8:11], v[188:203]
    v_mfma_f32_32x32x16_bf16 v[188:203], v[164:167], v[12:15], v[188:203]
    s_add_u32 m0, s74, 0
    v_mad_u32_u16 v236, v236, s75, v241 op_sel:[1,0,0,0]
    buffer_load_dwordx4 v236, s[16:19], 0 offen lds
    s_add_u32 m0, s74, 1040
    v_mad_u32_u16 v237, v237, s75, v241 op_sel:[1,0,0,0]
    buffer_load_dwordx4 v237, s[16:19], 0 offen lds
    s_add_u32 m0, s74, 2080
    v_mad_u32_u16 v238, v238, s75, v241 op_sel:[1,0,0,0]
    buffer_load_dwordx4 v238, s[16:19], 0 offen lds
    s_add_u32 m0, s74, 3120
    v_mad_u32_u16 v239, v239, s75, v241 op_sel:[1,0,0,0]
    buffer_load_dwordx4 v239, s[16:19], 0 offen lds
    s_add_u32 m0, s74, 4160
    v_add_u32 v240, v240, v242
    buffer_load_dwordx4 v240, s[20:23], 0 offen lds
    v_smfmac_f32_32x32x32_bf16 v[188:203], v[172:175], v[72:79], v176
    s_mov_b32 s72, 0
    s_sub_u32 s10, s73, 1
    s_bitcmp1_b32 s3, 0
    s_cselect_b32 s6, s6, s10
    s_setprio 3
    s_mov_b32 s87, s73
    s_cmp_gt_i32 s4, s72
    s_cselect_b32 s10, s4, s87
    s_min_u32 s87, s87, s10
    s_cmp_gt_i32 s5, s72
    s_cselect_b32 s10, s5, s87
    s_min_u32 s87, s87, s10
    s_cmp_gt_i32 s6, s72
    s_cselect_b32 s10, s6, s87
    s_min_u32 s87, s87, s10
    s_cmp_gt_i32 s37, s72
    s_cselect_b32 s10, s37, s87
    s_min_u32 s87, s87, s10
    s_cmp_gt_i32 s38, s72
    s_cselect_b32 s10, s38, s87
    s_min_u32 s87, s87, s10
.p2align 6
K2_LOOP:
    v_smfmac_f32_32x32x32_bf16 v[136:151], v[180:183], v[204:211], v177
    ds_read_u8 v236, v248 offset:0
    ds_read_u8 v237, v248 offset:16
    ds_read_u8 v238, v248 offset:64
    ds_read_u8 v239, v248 offset:80
    ds_read_u8 v250, v249 offset:128
    v_exp_f32 v188, v188
    v_exp_f32 v189, v189
    v_exp_f32 v190, v190
    v_add_f32 v188, 1.0, v188
    v_smfmac_f32_32x32x32_bf16 v[136:151], v[184:187], v[212:219], v177
    v_exp_f32 v191, v191
    v_add_f32 v189, 1.0, v189
    v_exp_f32 v192, v192
    v_add_f32 v190, 1.0, v190
    v_rcp_f32 v188, v188
    v_mfma_f32_32x32x16_bf16 v[220:235], v[168:171], v[68:71], 0
    v_exp_f32 v193, v193
    v_add_f32 v191, 1.0, v191
    v_rcp_f32 v189, v189
    v_exp_f32 v194, v194
    v_mfma_f32_32x32x16_bf16 v[204:219], v[152:155], v[32:35], 0
    v_add_f32 v192, 1.0, v192
    v_rcp_f32 v190, v190
    v_exp_f32 v195, v195
    v_mfma_f32_32x32x16_bf16 v[204:219], v[156:159], v[36:39], v[204:219]
    s_waitcnt lgkmcnt(0)
    v_lshl_add_u32 v236, v236, 6, v246
    v_lshl_add_u32 v237, v237, 6, v246
    v_lshl_add_u32 v238, v238, 6, v246
    v_lshl_add_u32 v239, v239, 6, v246
    v_lshl_add_u32 v250, v250, 6, v245
    v_add_f32 v193, 1.0, v193
    v_rcp_f32 v191, v191
    v_exp_f32 v196, v196
    v_add_f32 v194, 1.0, v194
    v_rcp_f32 v192, v192
    v_smfmac_f32_32x32x32_bf16 v[220:235], v[172:175], v[80:87], v176
    ds_read_b64_tr_b16 v[180:181], v236
    ds_read_b64_tr_b16 v[182:183], v237
    ds_read_b64_tr_b16 v[184:185], v238
    ds_read_b64_tr_b16 v[186:187], v239
    ds_read_b128 v[172:175], v250 offset:7424
    ds_read_b32 v176, v250 offset:7440
    v_exp_f32 v197, v197
    v_add_f32 v195, 1.0, v195
    v_rcp_f32 v193, v193
    v_exp_f32 v198, v198
    v_mfma_f32_32x32x16_bf16 v[204:219], v[160:163], v[40:43], v[204:219]
    v_add_f32 v196, 1.0, v196
    v_rcp_f32 v194, v194
    v_exp_f32 v199, v199
    v_add_f32 v197, 1.0, v197
    v_mfma_f32_32x32x16_bf16 v[204:219], v[164:167], v[44:47], v[204:219]
    v_rcp_f32 v195, v195
    v_exp_f32 v200, v200
    v_add_f32 v198, 1.0, v198
    v_rcp_f32 v196, v196
    v_mfma_f32_32x32x16_bf16 v[220:235], v[152:155], v[16:19], v[220:235]
    ds_read_b128 v[236:239], v247 offset:256
    ds_read_b32 v240, v251 offset:256
    s_add_u32 s72, s72, 1
    v_exp_f32 v201, v201
    v_add_f32 v199, 1.0, v199
    v_rcp_f32 v197, v197
    v_exp_f32 v202, v202
    v_mfma_f32_32x32x16_bf16 v[220:235], v[156:159], v[20:23], v[220:235]
    v_add_f32 v200, 1.0, v200
    v_rcp_f32 v198, v198
    v_exp_f32 v203, v203
    v_add_f32 v201, 1.0, v201
    v_mfma_f32_32x32x16_bf16 v[220:235], v[160:163], v[24:27], v[220:235]
    v_rcp_f32 v199, v199
    v_add_f32 v202, 1.0, v202
    v_rcp_f32 v200, v200
    v_add_f32 v203, 1.0, v203
    v_rcp_f32 v201, v201
    v_mfma_f32_32x32x16_bf16 v[220:235], v[164:167], v[28:31], v[220:235]
    v_rcp_f32 v202, v202
    v_rcp_f32 v203, v203
    v_mul_f32 v204, v188, v204
    v_mul_f32 v205, v189, v205
    s_waitcnt lgkmcnt(0)
    v_smfmac_f32_32x32x32_bf16 v[88:103], v[180:183], v[188:195], v177
    v_mul_f32 v206, v190, v206
    v_mul_f32 v207, v191, v207
    v_mul_f32 v208, v192, v208
    v_mul_f32 v209, v193, v209
    v_mul_f32 v210, v194, v210
    v_mul_f32 v211, v195, v211
    v_mul_f32 v212, v196, v212
    v_smfmac_f32_32x32x32_bf16 v[88:103], v[184:187], v[196:203], v177
    v_mul_f32 v213, v197, v213
    v_mul_f32 v214, v198, v214
    v_mul_f32 v215, v199, v215
    v_mul_f32 v216, v200, v216
    v_mul_f32 v217, v201, v217
    v_mul_f32 v218, v202, v218
    v_mul_f32 v219, v203, v219
    v_smfmac_f32_32x32x32_bf16 v[104:119], v[180:183], v[204:211], v177
    s_waitcnt vmcnt(0)
    ds_read_b128 v[168:171], v244
    v_exp_f32 v220, v220
    v_exp_f32 v221, v221
    v_exp_f32 v222, v222
    v_add_f32 v220, 1.0, v220
    v_smfmac_f32_32x32x32_bf16 v[104:119], v[184:187], v[212:219], v177
    v_exp_f32 v223, v223
    v_add_f32 v221, 1.0, v221
    v_exp_f32 v224, v224
    v_add_f32 v222, 1.0, v222
    v_rcp_f32 v220, v220
    s_waitcnt lgkmcnt(0)
    v_mfma_f32_32x32x16_bf16 v[188:203], v[168:171], v[64:67], 0
    v_exp_f32 v225, v225
    v_add_f32 v223, 1.0, v223
    v_rcp_f32 v221, v221
    v_exp_f32 v226, v226
    v_mfma_f32_32x32x16_bf16 v[204:219], v[152:155], v[48:51], 0
    ds_read_b128 v[152:155], v243 offset:0
    v_add_f32 v224, 1.0, v224
    v_rcp_f32 v222, v222
    v_exp_f32 v227, v227
    v_mfma_f32_32x32x16_bf16 v[204:219], v[156:159], v[52:55], v[204:219]
    ds_read_b128 v[156:159], v243 offset:16
    v_add_f32 v225, 1.0, v225
    v_rcp_f32 v223, v223
    v_exp_f32 v228, v228
    v_add_f32 v226, 1.0, v226
    v_rcp_f32 v224, v224
    v_smfmac_f32_32x32x32_bf16 v[188:203], v[172:175], v[72:79], v176
    v_exp_f32 v229, v229
    v_add_f32 v227, 1.0, v227
    v_rcp_f32 v225, v225
    v_exp_f32 v230, v230
    v_mfma_f32_32x32x16_bf16 v[204:219], v[160:163], v[56:59], v[204:219]
    ds_read_b128 v[160:163], v243 offset:32
    v_add_f32 v228, 1.0, v228
    v_rcp_f32 v226, v226
    v_exp_f32 v231, v231
    v_add_f32 v229, 1.0, v229
    v_mfma_f32_32x32x16_bf16 v[204:219], v[164:167], v[60:63], v[204:219]
    ds_read_b128 v[164:167], v243 offset:48
    v_rcp_f32 v227, v227
    v_exp_f32 v232, v232
    v_add_f32 v230, 1.0, v230
    v_rcp_f32 v228, v228
    s_waitcnt lgkmcnt(3)
    v_mfma_f32_32x32x16_bf16 v[188:203], v[152:155], v[0:3], v[188:203]
    v_exp_f32 v233, v233
    v_add_f32 v231, 1.0, v231
    v_rcp_f32 v229, v229
    v_exp_f32 v234, v234
    s_waitcnt lgkmcnt(2)
    v_mfma_f32_32x32x16_bf16 v[188:203], v[156:159], v[4:7], v[188:203]
    v_add_f32 v232, 1.0, v232
    v_rcp_f32 v230, v230
    v_exp_f32 v235, v235
    v_add_f32 v233, 1.0, v233
    s_waitcnt lgkmcnt(1)
    v_mfma_f32_32x32x16_bf16 v[188:203], v[160:163], v[8:11], v[188:203]
    v_rcp_f32 v231, v231
    v_add_f32 v234, 1.0, v234
    v_rcp_f32 v232, v232
    v_add_f32 v235, 1.0, v235
    v_rcp_f32 v233, v233
    s_waitcnt lgkmcnt(0)
    v_mfma_f32_32x32x16_bf16 v[188:203], v[164:167], v[12:15], v[188:203]
    s_cmp_lt_i32 s72, s38
    s_cbranch_scc0 K2_ND_0
    s_add_u32 m0, s74, 0
    v_mad_u32_u16 v236, v236, s75, v241 op_sel:[1,0,0,0]
    buffer_load_dwordx4 v236, s[16:19], 0 offen lds
    s_add_u32 m0, s74, 1040
    v_mad_u32_u16 v237, v237, s75, v241 op_sel:[1,0,0,0]
    buffer_load_dwordx4 v237, s[16:19], 0 offen lds
    s_add_u32 m0, s74, 2080
    v_mad_u32_u16 v238, v238, s75, v241 op_sel:[1,0,0,0]
    buffer_load_dwordx4 v238, s[16:19], 0 offen lds
    s_add_u32 m0, s74, 3120
    v_mad_u32_u16 v239, v239, s75, v241 op_sel:[1,0,0,0]
    buffer_load_dwordx4 v239, s[16:19], 0 offen lds
    s_add_u32 m0, s74, 4160
    v_add_u32 v240, v240, v242
    buffer_load_dwordx4 v240, s[20:23], 0 offen lds
K2_ND_0:
    v_rcp_f32 v234, v234
    v_rcp_f32 v235, v235
    v_mul_f32 v204, v220, v204
    v_mul_f32 v205, v221, v205
    v_smfmac_f32_32x32x32_bf16 v[120:135], v[180:183], v[220:227], v177
    v_mul_f32 v206, v222, v206
    v_mul_f32 v207, v223, v207
    v_mul_f32 v208, v224, v208
    v_mul_f32 v209, v225, v209
    v_mul_f32 v210, v226, v210
    v_mul_f32 v211, v227, v211
    v_mul_f32 v212, v228, v212
    v_smfmac_f32_32x32x32_bf16 v[120:135], v[184:187], v[228:235], v177
    v_mul_f32 v213, v229, v213
    v_mul_f32 v214, v230, v214
    v_mul_f32 v215, v231, v215
    v_mul_f32 v216, v232, v216
    v_mul_f32 v217, v233, v217
    v_mul_f32 v218, v234, v218
    v_mul_f32 v219, v235, v219
    s_cmp_ge_u32 s72, s87
    s_cbranch_scc1 K2_EV0
K2_EVR0:
    v_smfmac_f32_32x32x32_bf16 v[136:151], v[180:183], v[204:211], v177
    ds_read_u8 v236, v248 offset:128
    ds_read_u8 v237, v248 offset:144
    ds_read_u8 v238, v248 offset:192
    ds_read_u8 v239, v248 offset:208
    ds_read_u8 v250, v249 offset:256
    v_exp_f32 v188, v188
    v_exp_f32 v189, v189
    v_exp_f32 v190, v190
    v_add_f32 v188, 1.0, v188
    v_smfmac_f32_32x32x32_bf16 v[136:151], v[184:187], v[212:219], v177
    v_exp_f32 v191, v191
    v_add_f32 v189, 1.0, v189
    v_exp_f32 v192, v192
    v_add_f32 v190, 1.0, v190
    v_rcp_f32 v188, v188
    v_mfma_f32_32x32x16_bf16 v[220:235], v[168:171], v[68:71], 0
    v_exp_f32 v193, v193
    v_add_f32 v191, 1.0, v191
    v_rcp_f32 v189, v189
    v_exp_f32 v194, v194
    v_mfma_f32_32x32x16_bf16 v[204:219], v[152:155], v[32:35], 0
    v_add_f32 v192, 1.0, v192
    v_rcp_f32 v190, v190
    v_exp_f32 v195, v195
    v_mfma_f32_32x32x16_bf16 v[204:219], v[156:159], v[36:39], v[204:219]
    s_waitcnt lgkmcnt(0)
    v_lshl_add_u32 v236, v236, 6, v246
    v_lshl_add_u32 v237, v237, 6, v246
    v_lshl_add_u32 v238, v238, 6, v246
    v_lshl_add_u32 v239, v239, 6, v246
    v_lshl_add_u32 v250, v250, 6, v245
    v_add_f32 v193, 1.0, v193
    v_rcp_f32 v191, v191
    v_exp_f32 v196, v196
    v_add_f32 v194, 1.0, v194
    v_rcp_f32 v192, v192
    v_smfmac_f32_32x32x32_bf16 v[220:235], v[172:175], v[80:87], v176
    ds_read_b64_tr_b16 v[180:181], v236
    ds_read_b64_tr_b16 v[182:183], v237
    ds_read_b64_tr_b16 v[184:185], v238
    ds_read_b64_tr_b16 v[186:187], v239
    ds_read_b128 v[172:175], v250 offset:7424
    ds_read_b32 v176, v250 offset:7440
    v_exp_f32 v197, v197
    v_add_f32 v195, 1.0, v195
    v_rcp_f32 v193, v193
    v_exp_f32 v198, v198
    v_mfma_f32_32x32x16_bf16 v[204:219], v[160:163], v[40:43], v[204:219]
    v_add_f32 v196, 1.0, v196
    v_rcp_f32 v194, v194
    v_exp_f32 v199, v199
    v_add_f32 v197, 1.0, v197
    v_mfma_f32_32x32x16_bf16 v[204:219], v[164:167], v[44:47], v[204:219]
    v_rcp_f32 v195, v195
    v_exp_f32 v200, v200
    v_add_f32 v198, 1.0, v198
    v_rcp_f32 v196, v196
    v_mfma_f32_32x32x16_bf16 v[220:235], v[152:155], v[16:19], v[220:235]
    ds_read_b128 v[236:239], v247 offset:384
    ds_read_b32 v240, v251 offset:384
    s_add_u32 s72, s72, 1
    v_exp_f32 v201, v201
    v_add_f32 v199, 1.0, v199
    v_rcp_f32 v197, v197
    v_exp_f32 v202, v202
    v_mfma_f32_32x32x16_bf16 v[220:235], v[156:159], v[20:23], v[220:235]
    v_add_f32 v200, 1.0, v200
    v_rcp_f32 v198, v198
    v_exp_f32 v203, v203
    v_add_f32 v201, 1.0, v201
    v_mfma_f32_32x32x16_bf16 v[220:235], v[160:163], v[24:27], v[220:235]
    v_rcp_f32 v199, v199
    v_add_f32 v202, 1.0, v202
    v_rcp_f32 v200, v200
    v_add_f32 v203, 1.0, v203
    v_rcp_f32 v201, v201
    v_mfma_f32_32x32x16_bf16 v[220:235], v[164:167], v[28:31], v[220:235]
    v_rcp_f32 v202, v202
    v_rcp_f32 v203, v203
    v_mul_f32 v204, v188, v204
    v_mul_f32 v205, v189, v205
    s_waitcnt lgkmcnt(0)
    v_smfmac_f32_32x32x32_bf16 v[88:103], v[180:183], v[188:195], v177
    v_mul_f32 v206, v190, v206
    v_mul_f32 v207, v191, v207
    v_mul_f32 v208, v192, v208
    v_mul_f32 v209, v193, v209
    v_mul_f32 v210, v194, v210
    v_mul_f32 v211, v195, v211
    v_mul_f32 v212, v196, v212
    v_smfmac_f32_32x32x32_bf16 v[88:103], v[184:187], v[196:203], v177
    v_mul_f32 v213, v197, v213
    v_mul_f32 v214, v198, v214
    v_mul_f32 v215, v199, v215
    v_mul_f32 v216, v200, v216
    v_mul_f32 v217, v201, v217
    v_mul_f32 v218, v202, v218
    v_mul_f32 v219, v203, v219
    v_smfmac_f32_32x32x32_bf16 v[104:119], v[180:183], v[204:211], v177
    s_waitcnt vmcnt(0)
    ds_read_b128 v[168:171], v244
    v_exp_f32 v220, v220
    v_exp_f32 v221, v221
    v_exp_f32 v222, v222
    v_add_f32 v220, 1.0, v220
    v_smfmac_f32_32x32x32_bf16 v[104:119], v[184:187], v[212:219], v177
    v_exp_f32 v223, v223
    v_add_f32 v221, 1.0, v221
    v_exp_f32 v224, v224
    v_add_f32 v222, 1.0, v222
    v_rcp_f32 v220, v220
    s_waitcnt lgkmcnt(0)
    v_mfma_f32_32x32x16_bf16 v[188:203], v[168:171], v[64:67], 0
    v_exp_f32 v225, v225
    v_add_f32 v223, 1.0, v223
    v_rcp_f32 v221, v221
    v_exp_f32 v226, v226
    v_mfma_f32_32x32x16_bf16 v[204:219], v[152:155], v[48:51], 0
    ds_read_b128 v[152:155], v243 offset:0
    v_add_f32 v224, 1.0, v224
    v_rcp_f32 v222, v222
    v_exp_f32 v227, v227
    v_mfma_f32_32x32x16_bf16 v[204:219], v[156:159], v[52:55], v[204:219]
    ds_read_b128 v[156:159], v243 offset:16
    v_add_f32 v225, 1.0, v225
    v_rcp_f32 v223, v223
    v_exp_f32 v228, v228
    v_add_f32 v226, 1.0, v226
    v_rcp_f32 v224, v224
    v_smfmac_f32_32x32x32_bf16 v[188:203], v[172:175], v[72:79], v176
    v_exp_f32 v229, v229
    v_add_f32 v227, 1.0, v227
    v_rcp_f32 v225, v225
    v_exp_f32 v230, v230
    v_mfma_f32_32x32x16_bf16 v[204:219], v[160:163], v[56:59], v[204:219]
    ds_read_b128 v[160:163], v243 offset:32
    v_add_f32 v228, 1.0, v228
    v_rcp_f32 v226, v226
    v_exp_f32 v231, v231
    v_add_f32 v229, 1.0, v229
    v_mfma_f32_32x32x16_bf16 v[204:219], v[164:167], v[60:63], v[204:219]
    ds_read_b128 v[164:167], v243 offset:48
    v_rcp_f32 v227, v227
    v_exp_f32 v232, v232
    v_add_f32 v230, 1.0, v230
    v_rcp_f32 v228, v228
    s_waitcnt lgkmcnt(3)
    v_mfma_f32_32x32x16_bf16 v[188:203], v[152:155], v[0:3], v[188:203]
    v_exp_f32 v233, v233
    v_add_f32 v231, 1.0, v231
    v_rcp_f32 v229, v229
    v_exp_f32 v234, v234
    s_waitcnt lgkmcnt(2)
    v_mfma_f32_32x32x16_bf16 v[188:203], v[156:159], v[4:7], v[188:203]
    v_add_f32 v232, 1.0, v232
    v_rcp_f32 v230, v230
    v_exp_f32 v235, v235
    v_add_f32 v233, 1.0, v233
    s_waitcnt lgkmcnt(1)
    v_mfma_f32_32x32x16_bf16 v[188:203], v[160:163], v[8:11], v[188:203]
    v_rcp_f32 v231, v231
    v_add_f32 v234, 1.0, v234
    v_rcp_f32 v232, v232
    v_add_f32 v235, 1.0, v235
    v_rcp_f32 v233, v233
    s_waitcnt lgkmcnt(0)
    v_mfma_f32_32x32x16_bf16 v[188:203], v[164:167], v[12:15], v[188:203]
    s_cmp_lt_i32 s72, s38
    s_cbranch_scc0 K2_ND_1
    s_add_u32 m0, s74, 0
    v_mad_u32_u16 v236, v236, s75, v241 op_sel:[1,0,0,0]
    buffer_load_dwordx4 v236, s[16:19], 0 offen lds
    s_add_u32 m0, s74, 1040
    v_mad_u32_u16 v237, v237, s75, v241 op_sel:[1,0,0,0]
    buffer_load_dwordx4 v237, s[16:19], 0 offen lds
    s_add_u32 m0, s74, 2080
    v_mad_u32_u16 v238, v238, s75, v241 op_sel:[1,0,0,0]
    buffer_load_dwordx4 v238, s[16:19], 0 offen lds
    s_add_u32 m0, s74, 3120
    v_mad_u32_u16 v239, v239, s75, v241 op_sel:[1,0,0,0]
    buffer_load_dwordx4 v239, s[16:19], 0 offen lds
    s_add_u32 m0, s74, 4160
    v_add_u32 v240, v240, v242
    buffer_load_dwordx4 v240, s[20:23], 0 offen lds
K2_ND_1:
    v_rcp_f32 v234, v234
    v_rcp_f32 v235, v235
    v_mul_f32 v204, v220, v204
    v_mul_f32 v205, v221, v205
    v_smfmac_f32_32x32x32_bf16 v[120:135], v[180:183], v[220:227], v177
    v_mul_f32 v206, v222, v206
    v_mul_f32 v207, v223, v207
    v_mul_f32 v208, v224, v208
    v_mul_f32 v209, v225, v209
    v_mul_f32 v210, v226, v210
    v_mul_f32 v211, v227, v211
    v_mul_f32 v212, v228, v212
    v_smfmac_f32_32x32x32_bf16 v[120:135], v[184:187], v[228:235], v177
    v_mul_f32 v213, v229, v213
    v_mul_f32 v214, v230, v214
    v_mul_f32 v215, v231, v215
    v_mul_f32 v216, v232, v216
    v_mul_f32 v217, v233, v217
    v_mul_f32 v218, v234, v218
    v_mul_f32 v219, v235, v219
    v_add_u32 v247, 0x100, v247
    v_add_u32 v249, 0x100, v249
    v_add_u32 v251, 0x100, v251
    v_add_u32 v248, 0x100, v248
    s_cmp_lt_u32 s72, s87
    s_cbranch_scc1 K2_LOOP
    s_cmp_ge_u32 s72, s73
    s_cbranch_scc1 K2_TAIL
    s_cmp_lg_u32 s72, s37
    s_cbranch_scc1 K2_SB1
    s_barrier
    s_mov_b32 s37, -1
K2_SB1:
    s_cmp_lg_u32 s72, s4
    s_cbranch_scc1 K2_PR1_0
    s_setprio 2
K2_PR1_0:
    s_cmp_lg_u32 s72, s5
    s_cbranch_scc1 K2_PR1_1
    s_setprio 1
K2_PR1_1:
    s_cmp_lg_u32 s72, s6
    s_cbranch_scc1 K2_PR1_2
    s_setprio 0
K2_PR1_2:
    s_cmp_eq_u32 s72, s38
    s_cbranch_scc1 K2_LT1
    s_mov_b32 s87, s73
    s_cmp_gt_i32 s4, s72
    s_cselect_b32 s10, s4, s87
    s_min_u32 s87, s87, s10
    s_cmp_gt_i32 s5, s72
    s_cselect_b32 s10, s5, s87
    s_min_u32 s87, s87, s10
    s_cmp_gt_i32 s6, s72
    s_cselect_b32 s10, s6, s87
    s_min_u32 s87, s87, s10
    s_cmp_gt_i32 s37, s72
    s_cselect_b32 s10, s37, s87
    s_min_u32 s87, s87, s10
    s_cmp_gt_i32 s38, s72
    s_cselect_b32 s10, s38, s87
    s_min_u32 s87, s87, s10
    s_branch K2_LOOP
K2_EV0:
    s_cmp_ge_u32 s72, s73
    s_cbranch_scc1 K2_TAIL
    s_cmp_lg_u32 s72, s37
    s_cbranch_scc1 K2_SB0
    s_barrier
    s_mov_b32 s37, -1
K2_SB0:
    s_cmp_lg_u32 s72, s4
    s_cbranch_scc1 K2_PR0_0
    s_setprio 2
K2_PR0_0:
    s_cmp_lg_u32 s72, s5
    s_cbranch_scc1 K2_PR0_1
    s_setprio 1
K2_PR0_1:
    s_cmp_lg_u32 s72, s6
    s_cbranch_scc1 K2_PR0_2
    s_setprio 0
K2_PR0_2:
    s_cmp_eq_u32 s72, s38
    s_cbranch_scc1 K2_LT0
    s_mov_b32 s87, s73
    s_cmp_gt_i32 s4, s72
    s_cselect_b32 s10, s4, s87
    s_min_u32 s87, s87, s10
    s_cmp_gt_i32 s5, s72
    s_cselect_b32 s10, s5, s87
    s_min_u32 s87, s87, s10
    s_cmp_gt_i32 s6, s72
    s_cselect_b32 s10, s6, s87
    s_min_u32 s87, s87, s10
    s_cmp_gt_i32 s37, s72
    s_cselect_b32 s10, s37, s87
    s_min_u32 s87, s87, s10
    s_cmp_gt_i32 s38, s72
    s_cselect_b32 s10, s38, s87
    s_min_u32 s87, s87, s10
    s_branch K2_EVR0
K2_LT0:
    v_add_u32 v248, 128, v248
K2_LT1:
    s_sub_u32 s10, s15, s76
    s_sub_u32 s10, s10, 4
    s_and_b32 s10, s10, 127
    s_cmp_lt_u32 s10, 32
    s_cbranch_scc1 K2_LG1
    s_cmp_lt_u32 s10, 64
    s_cbranch_scc1 K2_LG2
    s_cmp_lt_u32 s10, 96
    s_cbranch_scc1 K2_LG3
    v_smfmac_f32_32x32x32_bf16 v[136:151], v[180:183], v[204:211], v177
    ds_read_u8 v236, v248 offset:0
    ds_read_u8 v237, v248 offset:16
    ds_read_u8 v238, v248 offset:64
    ds_read_u8 v239, v248 offset:80
    v_exp_f32 v188, v188
    v_exp_f32 v189, v189
    v_exp_f32 v190, v190
    v_add_f32 v188, 1.0, v188
    v_smfmac_f32_32x32x32_bf16 v[136:151], v[184:187], v[212:219], v177
    v_exp_f32 v191, v191
    v_add_f32 v189, 1.0, v189
    v_exp_f32 v192, v192
    v_add_f32 v190, 1.0, v190
    v_rcp_f32 v188, v188
    v_mfma_f32_32x32x16_bf16 v[220:235], v[168:171], v[68:71], 0
    v_exp_f32 v193, v193
    v_add_f32 v191, 1.0, v191
    v_rcp_f32 v189, v189
    v_exp_f32 v194, v194
    v_mfma_f32_32x32x16_bf16 v[204:219], v[152:155], v[32:35], 0
    v_add_f32 v192, 1.0, v192
    v_rcp_f32 v190, v190
    v_exp_f32 v195, v195
    v_mfma_f32_32x32x16_bf16 v[204:219], v[156:159], v[36:39], v[204:219]
    s_waitcnt lgkmcnt(0)
    v_lshl_add_u32 v236, v236, 6, v246
    v_lshl_add_u32 v237, v237, 6, v246
    v_lshl_add_u32 v238, v238, 6, v246
    v_lshl_add_u32 v239, v239, 6, v246
    v_add_f32 v193, 1.0, v193
    v_rcp_f32 v191, v191
    v_exp_f32 v196, v196
    v_add_f32 v194, 1.0, v194
    v_rcp_f32 v192, v192
    v_smfmac_f32_32x32x32_bf16 v[220:235], v[172:175], v[80:87], v176
    ds_read_b64_tr_b16 v[180:181], v236
    ds_read_b64_tr_b16 v[182:183], v237
    ds_read_b64_tr_b16 v[184:185], v238
    ds_read_b64_tr_b16 v[186:187], v239
    v_exp_f32 v197, v197
    v_add_f32 v195, 1.0, v195
    v_rcp_f32 v193, v193
    v_exp_f32 v198, v198
    v_mfma_f32_32x32x16_bf16 v[204:219], v[160:163], v[40:43], v[204:219]
    v_add_f32 v196, 1.0, v196
    v_rcp_f32 v194, v194
    v_exp_f32 v199, v199
    v_add_f32 v197, 1.0, v197
    v_mfma_f32_32x32x16_bf16 v[204:219], v[164:167], v[44:47], v[204:219]
    v_rcp_f32 v195, v195
    v_exp_f32 v200, v200
    v_add_f32 v198, 1.0, v198
    v_rcp_f32 v196, v196
    v_mfma_f32_32x32x16_bf16 v[220:235], v[152:155], v[16:19], v[220:235]
    v_exp_f32 v201, v201
    v_add_f32 v199, 1.0, v199
    v_rcp_f32 v197, v197
    v_exp_f32 v202, v202
    v_mfma_f32_32x32x16_bf16 v[220:235], v[156:159], v[20:23], v[220:235]
    v_add_f32 v200, 1.0, v200
    v_rcp_f32 v198, v198
    v_exp_f32 v203, v203
    v_add_f32 v201, 1.0, v201
    v_mfma_f32_32x32x16_bf16 v[220:235], v[160:163], v[24:27], v[220:235]
    v_rcp_f32 v199, v199
    v_add_f32 v202, 1.0, v202
    v_rcp_f32 v200, v200
    v_add_f32 v203, 1.0, v203
    v_rcp_f32 v201, v201
    v_mfma_f32_32x32x16_bf16 v[220:235], v[164:167], v[28:31], v[220:235]
    v_rcp_f32 v202, v202
    v_rcp_f32 v203, v203
    v_mul_f32 v204, v188, v204
    v_mul_f32 v205, v189, v205
    s_waitcnt lgkmcnt(0)
    v_smfmac_f32_32x32x32_bf16 v[88:103], v[180:183], v[188:195], v177
    v_mul_f32 v206, v190, v206
    v_mul_f32 v207, v191, v207
    v_mul_f32 v208, v192, v208
    v_mul_f32 v209, v193, v209
    v_mul_f32 v210, v194, v210
    v_mul_f32 v211, v195, v211
    v_mul_f32 v212, v196, v212
    v_smfmac_f32_32x32x32_bf16 v[88:103], v[184:187], v[196:203], v177
    v_mul_f32 v213, v197, v213
    v_mul_f32 v214, v198, v214
    v_mul_f32 v215, v199, v215
    v_mul_f32 v216, v200, v216
    v_mul_f32 v217, v201, v217
    v_mul_f32 v218, v202, v218
    v_mul_f32 v219, v203, v219
    v_smfmac_f32_32x32x32_bf16 v[104:119], v[180:183], v[204:211], v177
    v_exp_f32 v220, v220
    v_exp_f32 v221, v221
    v_exp_f32 v222, v222
    v_add_f32 v220, 1.0, v220
    v_exp_f32 v223, v223
    v_smfmac_f32_32x32x32_bf16 v[104:119], v[184:187], v[212:219], v177
    v_add_f32 v221, 1.0, v221
    v_exp_f32 v224, v224
    v_add_f32 v222, 1.0, v222
    v_rcp_f32 v220, v220
    v_exp_f32 v225, v225
    v_add_f32 v223, 1.0, v223
    v_mfma_f32_32x32x16_bf16 v[204:219], v[152:155], v[48:51], 0
    v_rcp_f32 v221, v221
    v_exp_f32 v226, v226
    v_add_f32 v224, 1.0, v224
    v_rcp_f32 v222, v222
    v_exp_f32 v227, v227
    v_mfma_f32_32x32x16_bf16 v[204:219], v[156:159], v[52:55], v[204:219]
    v_add_f32 v225, 1.0, v225
    v_rcp_f32 v223, v223
    v_exp_f32 v228, v228
    v_add_f32 v226, 1.0, v226
    v_rcp_f32 v224, v224
    v_exp_f32 v229, v229
    v_mfma_f32_32x32x16_bf16 v[204:219], v[160:163], v[56:59], v[204:219]
    v_add_f32 v227, 1.0, v227
    v_rcp_f32 v225, v225
    v_exp_f32 v230, v230
    v_add_f32 v228, 1.0, v228
    v_rcp_f32 v226, v226
    v_mfma_f32_32x32x16_bf16 v[204:219], v[164:167], v[60:63], v[204:219]
    v_exp_f32 v231, v231
    v_add_f32 v229, 1.0, v229
    v_rcp_f32 v227, v227
    v_exp_f32 v232, v232
    v_add_f32 v230, 1.0, v230
    v_rcp_f32 v228, v228
    v_exp_f32 v233, v233
    v_add_f32 v231, 1.0, v231
    v_rcp_f32 v229, v229
    v_exp_f32 v234, v234
    v_add_f32 v232, 1.0, v232
    v_rcp_f32 v230, v230
    v_exp_f32 v235, v235
    v_add_f32 v233, 1.0, v233
    v_rcp_f32 v231, v231
    v_add_f32 v234, 1.0, v234
    v_rcp_f32 v232, v232
    v_add_f32 v235, 1.0, v235
    v_rcp_f32 v233, v233
    v_rcp_f32 v234, v234
    v_rcp_f32 v235, v235
    v_mul_f32 v204, v220, v204
    v_mul_f32 v205, v221, v205
    v_smfmac_f32_32x32x32_bf16 v[120:135], v[180:183], v[220:227], v177
    v_mul_f32 v206, v222, v206
    v_mul_f32 v207, v223, v207
    v_mul_f32 v208, v224, v208
    v_mul_f32 v209, v225, v209
    v_mul_f32 v210, v226, v210
    v_mul_f32 v211, v227, v211
    v_mul_f32 v212, v228, v212
    v_smfmac_f32_32x32x32_bf16 v[120:135], v[184:187], v[228:235], v177
    v_mul_f32 v213, v229, v213
    v_mul_f32 v214, v230, v214
    v_mul_f32 v215, v231, v215
    v_mul_f32 v216, v232, v216
    v_mul_f32 v217, v233, v217
    v_mul_f32 v218, v234, v218
    v_mul_f32 v219, v235, v219
    v_smfmac_f32_32x32x32_bf16 v[136:151], v[180:183], v[204:211], v177
    s_nop 0
    v_smfmac_f32_32x32x32_bf16 v[136:151], v[184:187], v[212:219], v177
    s_branch K2_DONE
K2_LG3:
    v_smfmac_f32_32x32x32_bf16 v[136:151], v[180:183], v[204:211], v177
    ds_read_u8 v236, v248 offset:0
    ds_read_u8 v237, v248 offset:16
    ds_read_u8 v238, v248 offset:64
    ds_read_u8 v239, v248 offset:80
    v_exp_f32 v188, v188
    v_exp_f32 v189, v189
    v_exp_f32 v190, v190
    v_smfmac_f32_32x32x32_bf16 v[136:151], v[184:187], v[212:219], v177
    v_add_f32 v188, 1.0, v188
    v_exp_f32 v191, v191
    v_add_f32 v189, 1.0, v189
    v_exp_f32 v192, v192
    v_mfma_f32_32x32x16_bf16 v[220:235], v[168:171], v[68:71], 0
    v_add_f32 v190, 1.0, v190
    v_rcp_f32 v188, v188
    v_exp_f32 v193, v193
    v_mfma_f32_32x32x16_bf16 v[204:219], v[152:155], v[32:35], 0
    v_add_f32 v191, 1.0, v191
    v_rcp_f32 v189, v189
    v_exp_f32 v194, v194
    v_mfma_f32_32x32x16_bf16 v[204:219], v[156:159], v[36:39], v[204:219]
    s_waitcnt lgkmcnt(0)
    v_lshl_add_u32 v236, v236, 6, v246
    v_lshl_add_u32 v237, v237, 6, v246
    v_lshl_add_u32 v238, v238, 6, v246
    v_lshl_add_u32 v239, v239, 6, v246
    v_add_f32 v192, 1.0, v192
    v_rcp_f32 v190, v190
    v_exp_f32 v195, v195
    v_smfmac_f32_32x32x32_bf16 v[220:235], v[172:175], v[80:87], v176
    ds_read_b64_tr_b16 v[180:181], v236
    ds_read_b64_tr_b16 v[182:183], v237
    ds_read_b64_tr_b16 v[184:185], v238
    ds_read_b64_tr_b16 v[186:187], v239
    v_add_f32 v193, 1.0, v193
    v_rcp_f32 v191, v191
    v_exp_f32 v196, v196
    v_mfma_f32_32x32x16_bf16 v[204:219], v[160:163], v[40:43], v[204:219]
    v_add_f32 v194, 1.0, v194
    v_rcp_f32 v192, v192
    v_exp_f32 v197, v197
    v_mfma_f32_32x32x16_bf16 v[204:219], v[164:167], v[44:47], v[204:219]
    v_add_f32 v195, 1.0, v195
    v_rcp_f32 v193, v193
    v_exp_f32 v198, v198
    v_mfma_f32_32x32x16_bf16 v[220:235], v[152:155], v[16:19], v[220:235]
    v_add_f32 v196, 1.0, v196
    v_rcp_f32 v194, v194
    v_exp_f32 v199, v199
    v_mfma_f32_32x32x16_bf16 v[220:235], v[156:159], v[20:23], v[220:235]
    v_add_f32 v197, 1.0, v197
    v_rcp_f32 v195, v195
    v_add_f32 v198, 1.0, v198
    v_mfma_f32_32x32x16_bf16 v[220:235], v[160:163], v[24:27], v[220:235]
    v_rcp_f32 v196, v196
    v_add_f32 v199, 1.0, v199
    v_rcp_f32 v197, v197
    v_mfma_f32_32x32x16_bf16 v[220:235], v[164:167], v[28:31], v[220:235]
    v_rcp_f32 v198, v198
    v_rcp_f32 v199, v199
    v_mul_f32 v204, v188, v204
    v_mul_f32 v205, v189, v205
    s_waitcnt lgkmcnt(0)
    v_smfmac_f32_32x32x32_bf16 v[88:103], v[180:183], v[188:195], v177
    v_mul_f32 v206, v190, v206
    v_mul_f32 v207, v191, v207
    v_mul_f32 v208, v192, v208
    v_mul_f32 v209, v193, v209
    v_mul_f32 v210, v194, v210
    v_smfmac_f32_32x32x32_bf16 v[88:103], v[184:187], v[196:203], v177
    v_mul_f32 v211, v195, v211
    v_mul_f32 v212, v196, v212
    v_mul_f32 v213, v197, v213
    v_mul_f32 v214, v198, v214
    v_mul_f32 v215, v199, v215
    v_smfmac_f32_32x32x32_bf16 v[104:119], v[180:183], v[204:211], v177
    v_exp_f32 v220, v220
    v_exp_f32 v221, v221
    v_exp_f32 v222, v222
    v_add_f32 v220, 1.0, v220
    v_smfmac_f32_32x32x32_bf16 v[104:119], v[184:187], v[212:219], v177
    v_exp_f32 v223, v223
    v_add_f32 v221, 1.0, v221
    v_exp_f32 v224, v224
    v_add_f32 v222, 1.0, v222
    v_rcp_f32 v220, v220
    v_mfma_f32_32x32x16_bf16 v[204:219], v[152:155], v[48:51], 0
    v_exp_f32 v225, v225
    v_add_f32 v223, 1.0, v223
    v_rcp_f32 v221, v221
    v_exp_f32 v226, v226
    v_mfma_f32_32x32x16_bf16 v[204:219], v[156:159], v[52:55], v[204:219]
    v_add_f32 v224, 1.0, v224
    v_rcp_f32 v222, v222
    v_exp_f32 v227, v227
    v_mfma_f32_32x32x16_bf16 v[204:219], v[160:163], v[56:59], v[204:219]
    v_add_f32 v225, 1.0, v225
    v_rcp_f32 v223, v223
    v_exp_f32 v228, v228
    v_add_f32 v226, 1.0, v226
    v_rcp_f32 v224, v224
    v_mfma_f32_32x32x16_bf16 v[204:219], v[164:167], v[60:63], v[204:219]
    v_exp_f32 v229, v229
    v_add_f32 v227, 1.0, v227
    v_rcp_f32 v225, v225
    v_exp_f32 v230, v230
    v_add_f32 v228, 1.0, v228
    v_rcp_f32 v226, v226
    v_exp_f32 v231, v231
    v_add_f32 v229, 1.0, v229
    v_rcp_f32 v227, v227
    v_add_f32 v230, 1.0, v230
    v_rcp_f32 v228, v228
    v_add_f32 v231, 1.0, v231
    v_rcp_f32 v229, v229
    v_rcp_f32 v230, v230
    v_rcp_f32 v231, v231
    v_mul_f32 v204, v220, v204
    v_mul_f32 v205, v221, v205
    v_smfmac_f32_32x32x32_bf16 v[120:135], v[180:183], v[220:227], v177
    v_mul_f32 v206, v222, v206
    v_mul_f32 v207, v223, v207
    v_mul_f32 v208, v224, v208
    v_mul_f32 v209, v225, v209
    v_mul_f32 v210, v226, v210
    v_smfmac_f32_32x32x32_bf16 v[120:135], v[184:187], v[228:235], v177
    v_mul_f32 v211, v227, v211
    v_mul_f32 v212, v228, v212
    v_mul_f32 v213, v229, v213
    v_mul_f32 v214, v230, v214
    v_mul_f32 v215, v231, v215
    v_smfmac_f32_32x32x32_bf16 v[136:151], v[180:183], v[204:211], v177
    s_nop 0
    v_smfmac_f32_32x32x32_bf16 v[136:151], v[184:187], v[212:219], v177
    s_branch K2_DONE
K2_LG2:
    v_smfmac_f32_32x32x32_bf16 v[136:151], v[180:183], v[204:211], v177
    ds_read_u8 v236, v248 offset:0
    ds_read_u8 v237, v248 offset:16
    ds_read_u8 v238, v248 offset:64
    ds_read_u8 v239, v248 offset:80
    v_exp_f32 v188, v188
    v_exp_f32 v189, v189
    v_smfmac_f32_32x32x32_bf16 v[136:151], v[184:187], v[212:219], v177
    v_exp_f32 v190, v190
    v_add_f32 v188, 1.0, v188
    v_mfma_f32_32x32x16_bf16 v[220:235], v[168:171], v[68:71], 0
    v_exp_f32 v191, v191
    v_add_f32 v189, 1.0, v189
    v_exp_f32 v192, v192
    v_mfma_f32_32x32x16_bf16 v[204:219], v[152:155], v[32:35], 0
    v_add_f32 v190, 1.0, v190
    v_rcp_f32 v188, v188
    v_mfma_f32_32x32x16_bf16 v[204:219], v[156:159], v[36:39], v[204:219]
    s_waitcnt lgkmcnt(0)
    v_lshl_add_u32 v236, v236, 6, v246
    v_lshl_add_u32 v237, v237, 6, v246
    v_lshl_add_u32 v238, v238, 6, v246
    v_lshl_add_u32 v239, v239, 6, v246
    v_exp_f32 v193, v193
    v_smfmac_f32_32x32x32_bf16 v[220:235], v[172:175], v[80:87], v176
    ds_read_b64_tr_b16 v[180:181], v236
    ds_read_b64_tr_b16 v[182:183], v237
    ds_read_b64_tr_b16 v[184:185], v238
    ds_read_b64_tr_b16 v[186:187], v239
    v_add_f32 v191, 1.0, v191
    v_rcp_f32 v189, v189
    v_exp_f32 v194, v194
    v_mfma_f32_32x32x16_bf16 v[204:219], v[160:163], v[40:43], v[204:219]
    v_add_f32 v192, 1.0, v192
    v_rcp_f32 v190, v190
    v_mfma_f32_32x32x16_bf16 v[204:219], v[164:167], v[44:47], v[204:219]
    v_exp_f32 v195, v195
    v_mfma_f32_32x32x16_bf16 v[220:235], v[152:155], v[16:19], v[220:235]
    v_add_f32 v193, 1.0, v193
    v_rcp_f32 v191, v191
    v_add_f32 v194, 1.0, v194
    v_mfma_f32_32x32x16_bf16 v[220:235], v[156:159], v[20:23], v[220:235]
    v_rcp_f32 v192, v192
    v_add_f32 v195, 1.0, v195
    v_mfma_f32_32x32x16_bf16 v[220:235], v[160:163], v[24:27], v[220:235]
    v_rcp_f32 v193, v193
    v_rcp_f32 v194, v194
    v_mfma_f32_32x32x16_bf16 v[220:235], v[164:167], v[28:31], v[220:235]
    v_rcp_f32 v195, v195
    v_mul_f32 v204, v188, v204
    v_mul_f32 v205, v189, v205
    v_mul_f32 v206, v190, v206
    s_waitcnt lgkmcnt(0)
    v_smfmac_f32_32x32x32_bf16 v[88:103], v[180:183], v[188:195], v177
    v_mul_f32 v207, v191, v207
    v_mul_f32 v208, v192, v208
    v_mul_f32 v209, v193, v209
    v_mul_f32 v210, v194, v210
    v_mul_f32 v211, v195, v211
    s_nop 1
    v_smfmac_f32_32x32x32_bf16 v[104:119], v[180:183], v[204:211], v177
    v_exp_f32 v220, v220
    v_exp_f32 v221, v221
    v_exp_f32 v222, v222
    v_mfma_f32_32x32x16_bf16 v[204:219], v[152:155], v[48:51], 0
    v_add_f32 v220, 1.0, v220
    v_exp_f32 v223, v223
    v_add_f32 v221, 1.0, v221
    v_mfma_f32_32x32x16_bf16 v[204:219], v[156:159], v[52:55], v[204:219]
    v_exp_f32 v224, v224
    v_add_f32 v222, 1.0, v222
    v_rcp_f32 v220, v220
    v_mfma_f32_32x32x16_bf16 v[204:219], v[160:163], v[56:59], v[204:219]
    v_exp_f32 v225, v225
    v_add_f32 v223, 1.0, v223
    v_rcp_f32 v221, v221
    v_mfma_f32_32x32x16_bf16 v[204:219], v[164:167], v[60:63], v[204:219]
    v_exp_f32 v226, v226
    v_add_f32 v224, 1.0, v224
    v_rcp_f32 v222, v222
    v_exp_f32 v227, v227
    v_add_f32 v225, 1.0, v225
    v_rcp_f32 v223, v223
    v_add_f32 v226, 1.0, v226
    v_rcp_f32 v224, v224
    v_add_f32 v227, 1.0, v227
    v_rcp_f32 v225, v225
    v_rcp_f32 v226, v226
    v_rcp_f32 v227, v227
    v_mul_f32 v204, v220, v204
    v_mul_f32 v205, v221, v205
    v_mul_f32 v206, v222, v206
    v_smfmac_f32_32x32x32_bf16 v[120:135], v[180:183], v[220:227], v177
    v_mul_f32 v207, v223, v207
    v_mul_f32 v208, v224, v208
    v_mul_f32 v209, v225, v209
    v_mul_f32 v210, v226, v210
    v_mul_f32 v211, v227, v211
    s_nop 1
    v_smfmac_f32_32x32x32_bf16 v[136:151], v[180:183], v[204:211], v177
    s_branch K2_DONE
K2_LG1:
    v_smfmac_f32_32x32x32_bf16 v[136:151], v[180:183], v[204:211], v177
    ds_read_u8 v236, v248 offset:0
    ds_read_u8 v237, v248 offset:16
    ds_read_u8 v238, v248 offset:64
    ds_read_u8 v239, v248 offset:80
    v_exp_f32 v188, v188
    v_smfmac_f32_32x32x32_bf16 v[136:151], v[184:187], v[212:219], v177
    v_exp_f32 v189, v189
    v_mfma_f32_32x32x16_bf16 v[220:235], v[168:171], v[68:71], 0
    v_exp_f32 v190, v190
    v_mfma_f32_32x32x16_bf16 v[204:219], v[152:155], v[32:35], 0
    v_add_f32 v188, 1.0, v188
    v_mfma_f32_32x32x16_bf16 v[204:219], v[156:159], v[36:39], v[204:219]
    s_waitcnt lgkmcnt(0)
    v_lshl_add_u32 v236, v236, 6, v246
    v_lshl_add_u32 v237, v237, 6, v246
    v_lshl_add_u32 v238, v238, 6, v246
    v_lshl_add_u32 v239, v239, 6, v246
    v_exp_f32 v191, v191
    v_smfmac_f32_32x32x32_bf16 v[220:235], v[172:175], v[80:87], v176
    ds_read_b64_tr_b16 v[180:181], v236
    ds_read_b64_tr_b16 v[182:183], v237
    ds_read_b64_tr_b16 v[184:185], v238
    ds_read_b64_tr_b16 v[186:187], v239
    v_add_f32 v189, 1.0, v189
    v_add_f32 v190, 1.0, v190
    v_mfma_f32_32x32x16_bf16 v[204:219], v[160:163], v[40:43], v[204:219]
    v_rcp_f32 v188, v188
    v_mfma_f32_32x32x16_bf16 v[204:219], v[164:167], v[44:47], v[204:219]
    v_add_f32 v191, 1.0, v191
    v_mfma_f32_32x32x16_bf16 v[220:235], v[152:155], v[16:19], v[220:235]
    v_rcp_f32 v189, v189
    v_mfma_f32_32x32x16_bf16 v[220:235], v[156:159], v[20:23], v[220:235]
    v_rcp_f32 v190, v190
    v_mfma_f32_32x32x16_bf16 v[220:235], v[160:163], v[24:27], v[220:235]
    v_rcp_f32 v191, v191
    v_mfma_f32_32x32x16_bf16 v[220:235], v[164:167], v[28:31], v[220:235]
    s_nop 3
    v_mul_f32 v204, v188, v204
    v_mul_f32 v205, v189, v205
    s_waitcnt lgkmcnt(0)
    v_smfmac_f32_32x32x32_bf16 v[88:103], v[180:183], v[188:195], v177
    v_mul_f32 v206, v190, v206
    v_mul_f32 v207, v191, v207
    s_nop 1
    v_smfmac_f32_32x32x32_bf16 v[104:119], v[180:183], v[204:211], v177
    v_exp_f32 v220, v220
    v_exp_f32 v221, v221
    v_mfma_f32_32x32x16_bf16 v[204:219], v[152:155], v[48:51], 0
    v_exp_f32 v222, v222
    v_mfma_f32_32x32x16_bf16 v[204:219], v[156:159], v[52:55], v[204:219]
    v_add_f32 v220, 1.0, v220
    v_exp_f32 v223, v223
    v_mfma_f32_32x32x16_bf16 v[204:219], v[160:163], v[56:59], v[204:219]
    v_add_f32 v221, 1.0, v221
    v_mfma_f32_32x32x16_bf16 v[204:219], v[164:167], v[60:63], v[204:219]
    v_add_f32 v222, 1.0, v222
    v_rcp_f32 v220, v220
    v_add_f32 v223, 1.0, v223
    v_rcp_f32 v221, v221
    v_rcp_f32 v222, v222
    v_rcp_f32 v223, v223
    s_nop 5
    v_mul_f32 v204, v220, v204
    v_mul_f32 v205, v221, v205
    v_smfmac_f32_32x32x32_bf16 v[120:135], v[180:183], v[220:227], v177
    v_mul_f32 v206, v222, v206
    v_mul_f32 v207, v223, v207
    s_nop 1
    v_smfmac_f32_32x32x32_bf16 v[136:151], v[180:183], v[204:211], v177
    s_branch K2_DONE
K2_TAIL:
    v_smfmac_f32_32x32x32_bf16 v[136:151], v[180:183], v[204:211], v177
    v_smfmac_f32_32x32x32_bf16 v[136:151], v[184:187], v[212:219], v177
K2_DONE:
    s_cmp_lt_i32 s37, 0
    s_cbranch_scc1 K2_SBD
    s_barrier
    s_mov_b32 s37, -1
K2_SBD:
    s_cmp_lg_u32 s78, 0
    s_cbranch_scc1 K2_SLOW
K2_EPI:
    v_lshlrev_b32 v252, 4, v254
    ds_read_b128 v[152:155], v253 offset:0
    ds_read_b128 v[156:159], v253 offset:16
    ds_read_b128 v[160:163], v253 offset:32
    ds_read_b128 v[164:167], v253 offset:48
    ds_read_b128 v[0:3], v252 offset:52736
    ds_read_b128 v[4:7], v252 offset:53760
    ds_read_b128 v[8:11], v252 offset:54784
    ds_read_b128 v[12:15], v252 offset:55808
    ds_read_b128 v[16:19], v252 offset:56832
    ds_read_b128 v[20:23], v252 offset:57856
    ds_read_b128 v[24:27], v252 offset:58880
    ds_read_b128 v[28:31], v252 offset:59904
    v_and_b32 v237, 31, v254
    v_and_b32 v245, 32, v254
    v_mul_u32_u24 v246, 144, v237
    v_lshrrev_b32 v238, 2, v245
    v_lshl_add_u32 v237, v237, 6, v238
    ds_read2_b64 v[180:183], v237 offset0:0 offset1:2
    ds_read2_b64 v[184:187], v237 offset0:4 offset1:6
    s_waitcnt lgkmcnt(10)
    v_lshlrev_b32 v32, 16, v152
    v_and_b32 v33, 0xffff0000, v152
    v_lshlrev_b32 v34, 16, v153
    v_and_b32 v35, 0xffff0000, v153
    v_lshlrev_b32 v36, 16, v154
    v_and_b32 v37, 0xffff0000, v154
    v_lshlrev_b32 v38, 16, v155
    v_and_b32 v39, 0xffff0000, v155
    v_lshlrev_b32 v40, 16, v156
    v_and_b32 v41, 0xffff0000, v156
    v_lshlrev_b32 v42, 16, v157
    v_and_b32 v43, 0xffff0000, v157
    v_lshlrev_b32 v44, 16, v158
    v_and_b32 v45, 0xffff0000, v158
    v_lshlrev_b32 v46, 16, v159
    v_and_b32 v47, 0xffff0000, v159
    v_lshlrev_b32 v48, 16, v160
    v_and_b32 v49, 0xffff0000, v160
    v_lshlrev_b32 v50, 16, v161
    v_and_b32 v51, 0xffff0000, v161
    v_lshlrev_b32 v52, 16, v162
    v_and_b32 v53, 0xffff0000, v162
    v_lshlrev_b32 v54, 16, v163
    v_and_b32 v55, 0xffff0000, v163
    v_lshlrev_b32 v56, 16, v164
    v_and_b32 v57, 0xffff0000, v164
    v_lshlrev_b32 v58, 16, v165
    v_and_b32 v59, 0xffff0000, v165
    v_lshlrev_b32 v60, 16, v166
    v_and_b32 v61, 0xffff0000, v166
    v_lshlrev_b32 v62, 16, v167
    v_and_b32 v63, 0xffff0000, v167
    v_lshl_add_u32 v253, v245, 1, v246
    v_add_u32 v253, s74, v253
    s_sub_u32 s10, s13, s96
    s_mul_i32 s10, s10, 144
    s_add_u32 s10, s10, s74
    v_lshrrev_b32 v236, 3, v254
    v_lshl_add_u32 v236, v236, 4, v252
    v_add_u32 v236, s10, v236
    s_mul_i32 s10, s12, 196
    s_add_u32 s11, s10, s14
    s_add_u32 s10, s10, s13
    s_min_u32 s11, s11, 50000
    s_min_u32 s10, s10, 50000
    s_sub_u32 s11, s11, s10
    s_lshl_b32 s10, s10, 7
    s_add_u32 s28, s28, s10
    s_addc_u32 s29, s29, 0
    s_lshl_b32 s30, s11, 7
    s_waitcnt lgkmcnt(9)
    v_mfma_f32_32x32x16_bf16 v[188:203], v[0:3], v[152:155], v[32:47]
    v_rcp_f32 v88, v88
    v_rcp_f32 v89, v89
    v_rcp_f32 v90, v90
    v_rcp_f32 v91, v91
    s_waitcnt lgkmcnt(8)
    v_mfma_f32_32x32x16_bf16 v[188:203], v[4:7], v[156:159], v[188:203]
    v_rcp_f32 v92, v92
    v_rcp_f32 v93, v93
    v_rcp_f32 v94, v94
    v_rcp_f32 v95, v95
    s_waitcnt lgkmcnt(7)
    v_mfma_f32_32x32x16_bf16 v[188:203], v[8:11], v[160:163], v[188:203]
    v_rcp_f32 v96, v96
    v_rcp_f32 v97, v97
    v_rcp_f32 v98, v98
    v_rcp_f32 v99, v99
    s_waitcnt lgkmcnt(6)
    v_mfma_f32_32x32x16_bf16 v[188:203], v[12:15], v[164:167], v[188:203]
    v_rcp_f32 v100, v100
    v_rcp_f32 v101, v101
    v_rcp_f32 v102, v102
    v_rcp_f32 v103, v103
    s_waitcnt lgkmcnt(5)
    v_mfma_f32_32x32x16_bf16 v[204:219], v[16:19], v[152:155], v[48:63]
    v_rcp_f32 v120, v120
    v_rcp_f32 v121, v121
    v_rcp_f32 v122, v122
    v_rcp_f32 v123, v123
    s_waitcnt lgkmcnt(4)
    v_mfma_f32_32x32x16_bf16 v[204:219], v[20:23], v[156:159], v[204:219]
    v_rcp_f32 v124, v124
    v_rcp_f32 v125, v125
    v_rcp_f32 v126, v126
    v_rcp_f32 v127, v127
    s_waitcnt lgkmcnt(3)
    v_mfma_f32_32x32x16_bf16 v[204:219], v[24:27], v[160:163], v[204:219]
    v_rcp_f32 v128, v128
    v_rcp_f32 v129, v129
    v_rcp_f32 v130, v130
    v_rcp_f32 v131, v131
    s_waitcnt lgkmcnt(2)
    v_mfma_f32_32x32x16_bf16 v[204:219], v[28:31], v[164:167], v[204:219]
    v_rcp_f32 v132, v132
    v_rcp_f32 v133, v133
    v_rcp_f32 v134, v134
    v_rcp_f32 v135, v135
    s_waitcnt lgkmcnt(0)
    v_mul_f32 v104, v104, v88
    v_mul_f32 v105, v105, v89
    v_mul_f32 v106, v106, v90
    v_mul_f32 v107, v107, v91
    v_mul_f32 v108, v108, v92
    v_mul_f32 v109, v109, v93
    v_mul_f32 v110, v110, v94
    v_mul_f32 v111, v111, v95
    v_mul_f32 v112, v112, v96
    v_mul_f32 v113, v113, v97
    v_mul_f32 v114, v114, v98
    v_mul_f32 v115, v115, v99
    v_mul_f32 v116, v116, v100
    v_mul_f32 v117, v117, v101
    v_mul_f32 v118, v118, v102
    v_mul_f32 v119, v119, v103
    v_cvt_pk_bf16_f32 v88, v104, v105
    v_cvt_pk_bf16_f32 v89, v106, v107
    v_cvt_pk_bf16_f32 v90, v108, v109
    v_cvt_pk_bf16_f32 v91, v110, v111
    v_cvt_pk_bf16_f32 v92, v112, v113
    v_cvt_pk_bf16_f32 v93, v114, v115
    v_cvt_pk_bf16_f32 v94, v116, v117
    v_cvt_pk_bf16_f32 v95, v118, v119
    v_mfma_f32_32x32x16_bf16 v[188:203], v[88:91], v[180:183], v[188:203]
    s_nop 0
    v_mfma_f32_32x32x16_bf16 v[188:203], v[92:95], v[184:187], v[188:203]
    v_mul_f32 v136, v136, v120
    v_mul_f32 v137, v137, v121
    v_mul_f32 v138, v138, v122
    v_mul_f32 v139, v139, v123
    v_mul_f32 v140, v140, v124
    v_mul_f32 v141, v141, v125
    v_mul_f32 v142, v142, v126
    v_mul_f32 v143, v143, v127
    v_mul_f32 v144, v144, v128
    v_mul_f32 v145, v145, v129
    v_mul_f32 v146, v146, v130
    v_mul_f32 v147, v147, v131
    v_mul_f32 v148, v148, v132
    v_mul_f32 v149, v149, v133
    v_mul_f32 v150, v150, v134
    v_mul_f32 v151, v151, v135
    v_cvt_pk_bf16_f32 v120, v136, v137
    v_cvt_pk_bf16_f32 v121, v138, v139
    v_cvt_pk_bf16_f32 v122, v140, v141
    v_cvt_pk_bf16_f32 v123, v142, v143
    v_cvt_pk_bf16_f32 v124, v144, v145
    v_cvt_pk_bf16_f32 v125, v146, v147
    v_cvt_pk_bf16_f32 v126, v148, v149
    v_cvt_pk_bf16_f32 v127, v150, v151
    v_mfma_f32_32x32x16_bf16 v[204:219], v[120:123], v[180:183], v[204:219]
    s_nop 0
    v_mfma_f32_32x32x16_bf16 v[204:219], v[124:127], v[184:187], v[204:219]
    v_max_f32 v188, v188, v32
    v_max_f32 v189, v189, v33
    v_max_f32 v190, v190, v34
    v_max_f32 v191, v191, v35
    v_max_f32 v192, v192, v36
    v_max_f32 v193, v193, v37
    v_max_f32 v194, v194, v38
    v_max_f32 v195, v195, v39
    v_cvt_pk_bf16_f32 v220, v188, v189
    v_cvt_pk_bf16_f32 v221, v190, v191
    v_cvt_pk_bf16_f32 v222, v192, v193
    v_cvt_pk_bf16_f32 v223, v194, v195
    ds_write_b128 v253, v[220:223] offset:0
    v_max_f32 v196, v196, v40
    v_max_f32 v197, v197, v41
    v_max_f32 v198, v198, v42
    v_max_f32 v199, v199, v43
    v_max_f32 v200, v200, v44
    v_max_f32 v201, v201, v45
    v_max_f32 v202, v202, v46
    v_max_f32 v203, v203, v47
    v_cvt_pk_bf16_f32 v224, v196, v197
    v_cvt_pk_bf16_f32 v225, v198, v199
    v_cvt_pk_bf16_f32 v226, v200, v201
    v_cvt_pk_bf16_f32 v227, v202, v203
    ds_write_b128 v253, v[224:227] offset:16
    v_max_f32 v204, v204, v48
    v_max_f32 v205, v205, v49
    v_max_f32 v206, v206, v50
    v_max_f32 v207, v207, v51
    v_max_f32 v208, v208, v52
    v_max_f32 v209, v209, v53
    v_max_f32 v210, v210, v54
    v_max_f32 v211, v211, v55
    v_cvt_pk_bf16_f32 v228, v204, v205
    v_cvt_pk_bf16_f32 v229, v206, v207
    v_cvt_pk_bf16_f32 v230, v208, v209
    v_cvt_pk_bf16_f32 v231, v210, v211
    ds_write_b128 v253, v[228:231] offset:32
    v_max_f32 v212, v212, v56
    v_max_f32 v213, v213, v57
    v_max_f32 v214, v214, v58
    v_max_f32 v215, v215, v59
    v_max_f32 v216, v216, v60
    v_max_f32 v217, v217, v61
    v_max_f32 v218, v218, v62
    v_max_f32 v219, v219, v63
    v_cvt_pk_bf16_f32 v232, v212, v213
    v_cvt_pk_bf16_f32 v233, v214, v215
    v_cvt_pk_bf16_f32 v234, v216, v217
    v_cvt_pk_bf16_f32 v235, v218, v219
    ds_write_b128 v253, v[232:235] offset:48
    ds_read_b128 v[152:155], v236 offset:0
    ds_read_b128 v[156:159], v236 offset:1152
    ds_read_b128 v[160:163], v236 offset:2304
    ds_read_b128 v[164:167], v236 offset:3456
    s_waitcnt lgkmcnt(3)
    buffer_store_dwordx4 v[152:155], v252, s[28:31], 0 offen offset:0 sc1
    s_waitcnt lgkmcnt(2)
    buffer_store_dwordx4 v[156:159], v252, s[28:31], 0 offen offset:1024 sc1
    s_waitcnt lgkmcnt(1)
    buffer_store_dwordx4 v[160:163], v252, s[28:31], 0 offen offset:2048 sc1
    s_waitcnt lgkmcnt(0)
    buffer_store_dwordx4 v[164:167], v252, s[28:31], 0 offen offset:3072 sc1
    s_add_u32 s10, s2, s7
    s_cmp_lg_u32 s10, 0
    s_cbranch_scc1 K2_NOEP
    v_mov_b32 v188, 24117248
    v_mov_b32 v189, s100
    buffer_store_dword v189, v188, s[24:27], 0 offen sc1
K2_NOEP:
K2_END:
    s_endpgm
K2_RETRY0:
    s_sleep 1
    s_sub_u32 s101, s101, 1
    s_cbranch_scc1 K2_END
    s_waitcnt vmcnt(0)
    v_bitop3_b32 v188, v91, s36, v214 bitop3:0x28
    s_nop 1
    v_or_b32_dpp v188, v188, v188 quad_perm:[1,0,3,2] row_mask:0xf bank_mask:0xf
    s_nop 1
    v_or_b32_dpp v188, v188, v188 quad_perm:[2,3,0,1] row_mask:0xf bank_mask:0xf
    s_nop 1
    v_or_b32_dpp v188, v188, v188 row_half_mirror row_mask:0xf bank_mask:0xf
    v_cmp_ne_u32 vcc, 0, v188
    s_and_b64 exec, exec, vcc
    s_cbranch_execz K2_RT00
    buffer_load_dwordx4 v[88:91], v189, s[32:35], 0 offen sc1
K2_RT00:
    s_mov_b64 exec, -1
    v_bitop3_b32 v188, v95, s36, v214 bitop3:0x28
    s_nop 1
    v_or_b32_dpp v188, v188, v188 quad_perm:[1,0,3,2] row_mask:0xf bank_mask:0xf
    s_nop 1
    v_or_b32_dpp v188, v188, v188 quad_perm:[2,3,0,1] row_mask:0xf bank_mask:0xf
    s_nop 1
    v_or_b32_dpp v188, v188, v188 row_half_mirror row_mask:0xf bank_mask:0xf
    v_cmp_ne_u32 vcc, 0, v188
    s_and_b64 exec, exec, vcc
    s_cbranch_execz K2_RT01
    buffer_load_dwordx4 v[92:95], v189, s[32:35], s79 offen sc1
K2_RT01:
    s_mov_b64 exec, -1
    v_bitop3_b32 v188, v99, s36, v214 bitop3:0x28
    s_nop 1
    v_or_b32_dpp v188, v188, v188 quad_perm:[1,0,3,2] row_mask:0xf bank_mask:0xf
    s_nop 1
    v_or_b32_dpp v188, v188, v188 quad_perm:[2,3,0,1] row_mask:0xf bank_mask:0xf
    s_nop 1
    v_or_b32_dpp v188, v188, v188 row_half_mirror row_mask:0xf bank_mask:0xf
    v_cmp_ne_u32 vcc, 0, v188
    s_and_b64 exec, exec, vcc
    s_cbranch_execz K2_RT02
    buffer_load_dwordx4 v[96:99], v189, s[32:35], s80 offen sc1
K2_RT02:
    s_mov_b64 exec, -1
    v_bitop3_b32 v188, v103, s36, v214 bitop3:0x28
    s_nop 1
    v_or_b32_dpp v188, v188, v188 quad_perm:[1,0,3,2] row_mask:0xf bank_mask:0xf
    s_nop 1
    v_or_b32_dpp v188, v188, v188 quad_perm:[2,3,0,1] row_mask:0xf bank_mask:0xf
    s_nop 1
    v_or_b32_dpp v188, v188, v188 row_half_mirror row_mask:0xf bank_mask:0xf
    v_cmp_ne_u32 vcc, 0, v188
    s_and_b64 exec, exec, vcc
    s_cbranch_execz K2_RT03
    buffer_load_dwordx4 v[100:103], v189, s[32:35], s81 offen sc1
K2_RT03:
    s_mov_b64 exec, -1
    s_waitcnt vmcnt(0)
    s_branch K2_CHK0
K2_RETRY1:
    s_sleep 1
    s_sub_u32 s101, s101, 1
    s_cbranch_scc1 K2_END
    s_waitcnt vmcnt(0)
    v_bitop3_b32 v188, v95, s36, v214 bitop3:0x28
    s_nop 1
    v_or_b32_dpp v188, v188, v188 quad_perm:[1,0,3,2] row_mask:0xf bank_mask:0xf
    s_nop 1
    v_or_b32_dpp v188, v188, v188 quad_perm:[2,3,0,1] row_mask:0xf bank_mask:0xf
    s_nop 1
    v_or_b32_dpp v188, v188, v188 row_half_mirror row_mask:0xf bank_mask:0xf
    v_cmp_ne_u32 vcc, 0, v188
    s_and_b64 exec, exec, vcc
    s_cbranch_execz K2_RT11
    buffer_load_dwordx4 v[92:95], v189, s[32:35], s79 offen sc1
K2_RT11:
    s_mov_b64 exec, -1
    v_bitop3_b32 v188, v99, s36, v214 bitop3:0x28
    s_nop 1
    v_or_b32_dpp v188, v188, v188 quad_perm:[1,0,3,2] row_mask:0xf bank_mask:0xf
    s_nop 1
    v_or_b32_dpp v188, v188, v188 quad_perm:[2,3,0,1] row_mask:0xf bank_mask:0xf
    s_nop 1
    v_or_b32_dpp v188, v188, v188 row_half_mirror row_mask:0xf bank_mask:0xf
    v_cmp_ne_u32 vcc, 0, v188
    s_and_b64 exec, exec, vcc
    s_cbranch_execz K2_RT12
    buffer_load_dwordx4 v[96:99], v189, s[32:35], s80 offen sc1
K2_RT12:
    s_mov_b64 exec, -1
    v_bitop3_b32 v188, v103, s36, v214 bitop3:0x28
    s_nop 1
    v_or_b32_dpp v188, v188, v188 quad_perm:[1,0,3,2] row_mask:0xf bank_mask:0xf
    s_nop 1
    v_or_b32_dpp v188, v188, v188 quad_perm:[2,3,0,1] row_mask:0xf bank_mask:0xf
    s_nop 1
    v_or_b32_dpp v188, v188, v188 row_half_mirror row_mask:0xf bank_mask:0xf
    v_cmp_ne_u32 vcc, 0, v188
    s_and_b64 exec, exec, vcc
    s_cbranch_execz K2_RT13
    buffer_load_dwordx4 v[100:103], v189, s[32:35], s81 offen sc1
K2_RT13:
    s_mov_b64 exec, -1
    s_waitcnt vmcnt(0)
    s_branch K2_CHK1
K2_RETRY2:
    s_sleep 1
    s_sub_u32 s101, s101, 1
    s_cbranch_scc1 K2_END
    s_waitcnt vmcnt(0)
    v_bitop3_b32 v188, v99, s36, v214 bitop3:0x28
    s_nop 1
    v_or_b32_dpp v188, v188, v188 quad_perm:[1,0,3,2] row_mask:0xf bank_mask:0xf
    s_nop 1
    v_or_b32_dpp v188, v188, v188 quad_perm:[2,3,0,1] row_mask:0xf bank_mask:0xf
    s_nop 1
    v_or_b32_dpp v188, v188, v188 row_half_mirror row_mask:0xf bank_mask:0xf
    v_cmp_ne_u32 vcc, 0, v188
    s_and_b64 exec, exec, vcc
    s_cbranch_execz K2_RT22
    buffer_load_dwordx4 v[96:99], v189, s[32:35], s80 offen sc1
K2_RT22:
    s_mov_b64 exec, -1
    v_bitop3_b32 v188, v103, s36, v214 bitop3:0x28
    s_nop 1
    v_or_b32_dpp v188, v188, v188 quad_perm:[1,0,3,2] row_mask:0xf bank_mask:0xf
    s_nop 1
    v_or_b32_dpp v188, v188, v188 quad_perm:[2,3,0,1] row_mask:0xf bank_mask:0xf
    s_nop 1
    v_or_b32_dpp v188, v188, v188 row_half_mirror row_mask:0xf bank_mask:0xf
    v_cmp_ne_u32 vcc, 0, v188
    s_and_b64 exec, exec, vcc
    s_cbranch_execz K2_RT23
    buffer_load_dwordx4 v[100:103], v189, s[32:35], s81 offen sc1
K2_RT23:
    s_mov_b64 exec, -1
    s_waitcnt vmcnt(0)
    s_branch K2_CHK2
K2_RETRY3:
    s_sleep 1
    s_sub_u32 s101, s101, 1
    s_cbranch_scc1 K2_END
    s_waitcnt vmcnt(0)
    v_bitop3_b32 v188, v103, s36, v214 bitop3:0x28
    s_nop 1
    v_or_b32_dpp v188, v188, v188 quad_perm:[1,0,3,2] row_mask:0xf bank_mask:0xf
    s_nop 1
    v_or_b32_dpp v188, v188, v188 quad_perm:[2,3,0,1] row_mask:0xf bank_mask:0xf
    s_nop 1
    v_or_b32_dpp v188, v188, v188 row_half_mirror row_mask:0xf bank_mask:0xf
    v_cmp_ne_u32 vcc, 0, v188
    s_and_b64 exec, exec, vcc
    s_cbranch_execz K2_RT33
    buffer_load_dwordx4 v[100:103], v189, s[32:35], s81 offen sc1
K2_RT33:
    s_mov_b64 exec, -1
    s_waitcnt vmcnt(0)
    s_branch K2_CHK3
K1_EXT:
    s_mov_b32 s14, 0x0f0f0f0f
    s_mov_b32 s15, s14
    ds_read_b32 v104, v6 offset:32
    ds_read_b128 v[8:11], v3 offset:128
    ds_read_b32 v105, v6 offset:3360
    ds_read_b128 v[16:19], v3 offset:13440
    ds_read_b32 v106, v6 offset:6688
    ds_read_b128 v[24:27], v3 offset:26752
    ds_read_b32 v107, v6 offset:10016
    ds_read_b128 v[32:35], v3 offset:40064
    s_waitcnt lgkmcnt(0)
    v_cmp_le_u32 vcc, 553648128, v108
    v_and_or_b32 v11, v104, v15, v108
    s_and_b64 exec, vcc, s[14:15]
    s_cbranch_execz K1_EX0
    buffer_store_dwordx4 v[8:11], v4, s[32:35], s10 offen sc1
K1_EX0:
    s_mov_b64 exec, -1
    s_add_u32 s10, s10, 2105344
    v_cmp_le_u32 vcc, 553648128, v109
    v_and_or_b32 v19, v105, v15, v109
    s_and_b64 exec, vcc, s[14:15]
    s_cbranch_execz K1_EX1
    buffer_store_dwordx4 v[16:19], v4, s[32:35], s10 offen sc1
K1_EX1:
    s_mov_b64 exec, -1
    s_add_u32 s10, s10, 2105344
    v_cmp_le_u32 vcc, 553648128, v110
    v_and_or_b32 v27, v106, v15, v110
    s_and_b64 exec, vcc, s[14:15]
    s_cbranch_execz K1_EX2
    buffer_store_dwordx4 v[24:27], v4, s[32:35], s10 offen sc1
K1_EX2:
    s_mov_b64 exec, -1
    s_add_u32 s10, s10, 2105344
    v_cmp_le_u32 vcc, 553648128, v111
    v_and_or_b32 v35, v107, v15, v111
    s_and_b64 exec, vcc, s[14:15]
    s_cbranch_execz K1_EX3
    buffer_store_dwordx4 v[32:35], v4, s[32:35], s10 offen sc1
K1_EX3:
    s_mov_b64 exec, -1
    s_add_u32 s10, s10, 2105344
    s_branch K1_EXTR
K1_OVF:
    v_lshrrev_b32 v72, 16, v112
    v_lshrrev_b32 v76, 18, v112
    v_sub_u32 v72, v72, v76
    v_lshrrev_b32 v73, 16, v113
    v_lshrrev_b32 v76, 18, v113
    v_sub_u32 v73, v73, v76
    v_lshrrev_b32 v74, 16, v114
    v_lshrrev_b32 v76, 18, v114
    v_sub_u32 v74, v74, v76
    v_lshrrev_b32 v75, 16, v115
    v_lshrrev_b32 v76, 18, v115
    v_sub_u32 v75, v75, v76
    v_add_u32 v77, v72, v73
    v_add_u32 v78, v77, v74
    v_add_u32 v79, v78, v75
    v_mov_b32 v1, v79
    s_nop 1
    v_add_u32_dpp v1, v1, v1 row_shr:1 row_mask:0xf bank_mask:0xf bound_ctrl:0
    s_nop 1
    v_add_u32_dpp v1, v1, v1 row_shr:2 row_mask:0xf bank_mask:0xf bound_ctrl:0
    s_nop 1
    v_add_u32_dpp v1, v1, v1 row_shr:4 row_mask:0xf bank_mask:0xf bound_ctrl:0
    s_nop 1
    v_add_u32_dpp v1, v1, v1 row_shr:8 row_mask:0xf bank_mask:0xf bound_ctrl:0
    s_nop 1
    v_add_u32_dpp v1, v1, v1 row_bcast:15 row_mask:0xa bank_mask:0xf
    s_nop 1
    v_add_u32_dpp v1, v1, v1 row_bcast:31 row_mask:0xc bank_mask:0xf
    s_nop 0
    v_sub_u32 v76, v1, v79
    v_add_u32 v79, v76, v78
    v_add_u32 v78, v76, v77
    v_add_u32 v77, v76, v72
    v_lshl_or_b32 v76, v72, 16, v76
    v_lshl_or_b32 v77, v73, 16, v77
    v_lshl_or_b32 v78, v74, 16, v78
    v_lshl_or_b32 v79, v75, 16, v79
    s_waitcnt lgkmcnt(0)
    ds_write_b128 v172, v[76:79] offset:52736
    v_min_u32 v108, 255, v108
    v_min_u32 v109, 255, v109
    v_min_u32 v110, 255, v110
    v_min_u32 v111, 255, v111
    s_lshl_b32 s15, s12, 2
    s_add_u32 s15, s15, 23068672
    s_add_u32 s64, s8, s15
    s_addc_u32 s65, s9, 0
    s_mov_b32 s66, 262144
    s_mov_b32 s67, 0x20000
    v_lshlrev_b32 v1, 12, v254
    buffer_store_dword v76, v1, s[64:67], 0 offen offset:0 sc1
    buffer_store_dword v77, v1, s[64:67], 0 offen offset:1024 sc1
    buffer_store_dword v78, v1, s[64:67], 0 offen offset:2048 sc1
    buffer_store_dword v79, v1, s[64:67], 0 offen offset:3072 sc1
    s_add_u32 s15, s13, 17825792
    s_add_u32 s64, s8, s15
    s_addc_u32 s65, s9, 0
    s_mov_b32 s66, 12500
    s_mov_b32 s67, 0x20000
    s_lshr_b32 s15, s13, 2
    s_add_u32 s15, s15, 22020096
    s_add_u32 s68, s8, s15
    s_addc_u32 s69, s9, 0
    s_mov_b32 s70, 3125
    s_mov_b32 s71, 0x20000
    v_cndmask_b32 v30, v24, v30, s[78:79]
    v_cndmask_b32 v38, 0, v38, s[78:79]
    ds_read_u16 v40, v24 offset:50736
    ds_read_u16 v41, v25 offset:50736
    ds_read_u16 v42, v26 offset:50736
    ds_read_u16 v43, v27 offset:50736
    ds_read_u16 v44, v28 offset:50736
    ds_read_u16 v45, v29 offset:50736
    ds_read_u16 v46, v30 offset:50736
    s_waitcnt lgkmcnt(0)
    v_lshrrev_b32 v1, 2, v32
    v_sub_u32 v1, v32, v1
    v_add_u32 v40, v40, v1
    v_cmp_le_u32 vcc, 48, v32
    v_lshlrev_b32 v48, 2, v40
    s_and_saveexec_b64 s[14:15], vcc
    s_cbranch_execz K1_OV3_0
    buffer_store_byte v23, v40, s[68:71], 0 offen sc1
    buffer_store_dword v16, v48, s[64:67], 0 offen sc1
K1_OV3_0:
    s_mov_b64 exec, -1
    v_lshrrev_b32 v1, 2, v33
    v_sub_u32 v1, v33, v1
    v_add_u32 v41, v41, v1
    v_cmp_le_u32 vcc, 48, v33
    v_lshlrev_b32 v49, 2, v41
    s_and_saveexec_b64 s[14:15], vcc
    s_cbranch_execz K1_OV3_1
    buffer_store_byte v23, v41, s[68:71], 0 offen sc1
    buffer_store_dword v17, v49, s[64:67], 0 offen sc1
K1_OV3_1:
    s_mov_b64 exec, -1
    v_lshrrev_b32 v1, 2, v34
    v_sub_u32 v1, v34, v1
    v_add_u32 v42, v42, v1
    v_cmp_le_u32 vcc, 48, v34
    v_lshlrev_b32 v50, 2, v42
    s_and_saveexec_b64 s[14:15], vcc
    s_cbranch_execz K1_OV3_2
    buffer_store_byte v23, v42, s[68:71], 0 offen sc1
    buffer_store_dword v18, v50, s[64:67], 0 offen sc1
K1_OV3_2:
    s_mov_b64 exec, -1
    v_lshrrev_b32 v1, 2, v35
    v_sub_u32 v1, v35, v1
    v_add_u32 v43, v43, v1
    v_cmp_le_u32 vcc, 48, v35
    v_lshlrev_b32 v51, 2, v43
    s_and_saveexec_b64 s[14:15], vcc
    s_cbranch_execz K1_OV3_3
    buffer_store_byte v23, v43, s[68:71], 0 offen sc1
    buffer_store_dword v19, v51, s[64:67], 0 offen sc1
K1_OV3_3:
    s_mov_b64 exec, -1
    v_lshrrev_b32 v1, 2, v36
    v_sub_u32 v1, v36, v1
    v_add_u32 v44, v44, v1
    v_cmp_le_u32 vcc, 48, v36
    v_lshlrev_b32 v52, 2, v44
    s_and_saveexec_b64 s[14:15], vcc
    s_cbranch_execz K1_OV3_4
    buffer_store_byte v31, v44, s[68:71], 0 offen sc1
    buffer_store_dword v20, v52, s[64:67], 0 offen sc1
K1_OV3_4:
    s_mov_b64 exec, -1
    v_lshrrev_b32 v1, 2, v37
    v_sub_u32 v1, v37, v1
    v_add_u32 v45, v45, v1
    v_cmp_le_u32 vcc, 48, v37
    v_lshlrev_b32 v53, 2, v45
    s_and_saveexec_b64 s[14:15], vcc
    s_cbranch_execz K1_OV3_5
    buffer_store_byte v31, v45, s[68:71], 0 offen sc1
    buffer_store_dword v21, v53, s[64:67], 0 offen sc1
K1_OV3_5:
    s_mov_b64 exec, -1
    v_lshrrev_b32 v1, 2, v38
    v_sub_u32 v1, v38, v1
    v_add_u32 v46, v46, v1
    v_cmp_le_u32 vcc, 48, v38
    v_lshlrev_b32 v54, 2, v46
    s_and_saveexec_b64 s[14:15], vcc
    s_cbranch_execz K1_OV3_6
    buffer_store_byte v39, v46, s[68:71], 0 offen sc1
    buffer_store_dword v22, v54, s[64:67], 0 offen sc1
K1_OV3_6:
    s_mov_b64 exec, -1
    s_waitcnt vmcnt(0)
    s_barrier
    s_branch K1_OUT
K2_XT1:
    s_mov_b32 s97, 1
    v_cmp_le_u32 vcc, 822083584, v188
    v_mov_b32 v166, 2180
    s_cbranch_vccz K2_XT1A
    ds_write_b32 v166, v171
K2_XT1A:
    s_mov_b32 s10, 0xf0f0f0f0
    s_mov_b32 s11, s10
    v_and_b32 v166, 12, v168
    v_add_u32 v166, 32, v166
    v_and_b32 v164, 64, v189
    v_mul_u32_u24 v164, 127, v164
    v_add_u32 v164, v164, v189
    v_add_u32 v165, 16384, v164
    v_mov_b32 v167, 0x7ffffff0
    v_cndmask_b32 v204, v91, v95, s[10:11]
    v_cndmask_b32 v206, v208, v209, s[10:11]
    v_cmp_le_u32 vcc, 553648128, v204
    v_sub_u32_sdwa v204, v204, v166 dst_sel:DWORD dst_unused:UNUSED_PAD src0_sel:BYTE_3 src1_sel:DWORD
    s_nop 0
    v_cndmask_b32 v164, v167, v164, vcc
    v_cndmask_b32 v205, v99, v103, s[10:11]
    v_cndmask_b32 v207, v210, v211, s[10:11]
    v_cmp_le_u32 vcc, 553648128, v205
    v_sub_u32_sdwa v205, v205, v166 dst_sel:DWORD dst_unused:UNUSED_PAD src0_sel:BYTE_3 src1_sel:DWORD
    s_nop 0
    v_cndmask_b32 v165, v167, v165, vcc
    s_add_u32 s32, s32, 8421376
    s_addc_u32 s33, s33, 0
    buffer_load_dwordx4 v[132:135], v164, s[32:35], 0 offen sc1
    buffer_load_dwordx4 v[136:139], v165, s[32:35], 0 offen sc1
    v_med3_i32 v166, v204, 0, 3
    v_med3_i32 v167, v205, 0, 3
    v_add_u32 v166, v166, v167
    v_mov_b32 v167, 2176
    v_cmpx_lt_u32 vcc, 0, v166
    ds_add_u32 v167, v166
    s_mov_b64 exec, -1
    s_branch K2_XT1R
K2_XT2:
K2_XVa:
    s_waitcnt vmcnt(0)
    s_mov_b64 s[10:11], 0
    v_bitop3_b32 v166, v135, s36, v214 bitop3:0x28
    v_cmp_ne_u32 s[86:87], 0, v166
    v_cmp_gt_u32 vcc, 0x7ffffff0, v164
    s_and_b64 vcc, vcc, s[86:87]
    s_or_b64 s[10:11], s[10:11], vcc
    v_bitop3_b32 v166, v139, s36, v214 bitop3:0x28
    v_cmp_ne_u32 s[86:87], 0, v166
    v_cmp_gt_u32 vcc, 0x7ffffff0, v165
    s_and_b64 vcc, vcc, s[86:87]
    s_or_b64 s[10:11], s[10:11], vcc
    s_cbranch_scc0 K2_XWa
    s_sleep 1
    s_sub_u32 s101, s101, 1
    s_cbranch_scc1 K2_END
    buffer_load_dwordx4 v[132:135], v164, s[32:35], 0 offen sc1
    buffer_load_dwordx4 v[136:139], v165, s[32:35], 0 offen sc1
    s_branch K2_XVa
K2_XWa:
    v_and_b32 v140, 255, v132
    v_lshlrev_b32 v140, 2, v140
    ds_read_b32 v140, v140 offset:6400
    v_and_b32 v141, 255, v133
    v_lshlrev_b32 v141, 2, v141
    ds_read_b32 v141, v141 offset:6400
    v_and_b32 v142, 255, v134
    v_lshlrev_b32 v142, 2, v142
    ds_read_b32 v142, v142 offset:6400
    v_and_b32 v135, 0x0f0f0f, v135
    v_and_b32 v143, 255, v136
    v_lshlrev_b32 v143, 2, v143
    ds_read_b32 v143, v143 offset:6400
    v_and_b32 v144, 255, v137
    v_lshlrev_b32 v144, 2, v144
    ds_read_b32 v144, v144 offset:6400
    v_and_b32 v145, 255, v138
    v_lshlrev_b32 v145, 2, v145
    ds_read_b32 v145, v145 offset:6400
    v_and_b32 v139, 0x0f0f0f, v139
    s_waitcnt lgkmcnt(0)
    v_perm_b32 v146, v135, v132, s64
    v_lshl_add_u32 v146, v146, 5, v206
    v_cmpx_lt_i32 vcc, 0, v204
    ds_add_rtn_u32 v140, v140, v171 offset:2112
    s_mov_b64 exec, -1
    v_perm_b32 v147, v135, v133, s65
    v_lshl_add_u32 v147, v147, 5, v206
    v_cmpx_lt_i32 vcc, 1, v204
    ds_add_rtn_u32 v141, v141, v171 offset:2112
    s_mov_b64 exec, -1
    v_perm_b32 v148, v135, v134, s66
    v_lshl_add_u32 v148, v148, 5, v206
    v_cmpx_lt_i32 vcc, 2, v204
    ds_add_rtn_u32 v142, v142, v171 offset:2112
    s_mov_b64 exec, -1
    v_perm_b32 v149, v139, v136, s64
    v_lshl_add_u32 v149, v149, 5, v207
    v_cmpx_lt_i32 vcc, 0, v205
    ds_add_rtn_u32 v143, v143, v171 offset:2112
    s_mov_b64 exec, -1
    v_perm_b32 v150, v139, v137, s65
    v_lshl_add_u32 v150, v150, 5, v207
    v_cmpx_lt_i32 vcc, 1, v205
    ds_add_rtn_u32 v144, v144, v171 offset:2112
    s_mov_b64 exec, -1
    v_perm_b32 v151, v139, v138, s66
    v_lshl_add_u32 v151, v151, 5, v207
    v_cmpx_lt_i32 vcc, 2, v205
    ds_add_rtn_u32 v145, v145, v171 offset:2112
    s_mov_b64 exec, -1
    s_waitcnt lgkmcnt(0)
    v_cmpx_lt_i32 vcc, 0, v204
    ds_write2st64_b32 v140, v132, v146 offset0:0 offset1:84
    s_mov_b64 exec, -1
    v_cmpx_lt_i32 vcc, 1, v204
    ds_write2st64_b32 v141, v133, v147 offset0:0 offset1:84
    s_mov_b64 exec, -1
    v_cmpx_lt_i32 vcc, 2, v204
    ds_write2st64_b32 v142, v134, v148 offset0:0 offset1:84
    s_mov_b64 exec, -1
    v_cmpx_lt_i32 vcc, 0, v205
    ds_write2st64_b32 v143, v136, v149 offset0:0 offset1:84
    s_mov_b64 exec, -1
    v_cmpx_lt_i32 vcc, 1, v205
    ds_write2st64_b32 v144, v137, v150 offset0:0 offset1:84
    s_mov_b64 exec, -1
    v_cmpx_lt_i32 vcc, 2, v205
    ds_write2st64_b32 v145, v138, v151 offset0:0 offset1:84
    s_mov_b64 exec, -1
    s_branch K2_PADS0
K2_XT3:
    ds_read_b32 v166, v212 offset:2112
    s_waitcnt lgkmcnt(0)
    v_readfirstlane_b32 s15, v166
    s_nop 3
    s_sub_u32 s73, s15, s76
    s_add_u32 s73, s73, 127
    s_lshr_b32 s73, s73, 7
    s_sub_i32 s38, s73, 1
    s_branch K2_GO
K2_OVF:
    s_mov_b32 s80, 1
    s_mov_b32 s83, 0
    s_mov_b32 s77, 0
    s_mov_b32 s15, s76
    v_mov_b32 v190, 0xffff0000
    v_or_b32 v189, s39, v190
    v_mov_b32 v190, 0x7fffff00
    v_lshl_add_u32 v188, v254, 2, s15
    s_sub_u32 s73, s15, s76
    ds_write2st64_b32 v188, v189, v190 offset0:0 offset1:84
    ds_write2st64_b32 v188, v189, v190 offset0:1 offset1:85
    s_add_u32 s73, s73, 127
    s_lshr_b32 s73, s73, 7
    s_sub_i32 s38, s73, 1
    s_cmp_eq_u32 s97, 0
    s_cbranch_scc1 K2_PADS0
K2_XVb:
    s_waitcnt vmcnt(0)
    s_mov_b64 s[10:11], 0
    v_bitop3_b32 v166, v135, s36, v214 bitop3:0x28
    v_cmp_ne_u32 s[86:87], 0, v166
    v_cmp_gt_u32 vcc, 0x7ffffff0, v164
    s_and_b64 vcc, vcc, s[86:87]
    s_or_b64 s[10:11], s[10:11], vcc
    v_bitop3_b32 v166, v139, s36, v214 bitop3:0x28
    v_cmp_ne_u32 s[86:87], 0, v166
    v_cmp_gt_u32 vcc, 0x7ffffff0, v165
    s_and_b64 vcc, vcc, s[86:87]
    s_or_b64 s[10:11], s[10:11], vcc
    s_cbranch_scc0 K2_XWb
    s_sleep 1
    s_sub_u32 s101, s101, 1
    s_cbranch_scc1 K2_END
    buffer_load_dwordx4 v[132:135], v164, s[32:35], 0 offen sc1
    buffer_load_dwordx4 v[136:139], v165, s[32:35], 0 offen sc1
    s_branch K2_XVb
K2_XWb:
    s_branch K2_PADS0
K2_SLOW:
    s_add_u32 s81, s81, 448
    s_cmp_lt_u32 s81, s82
    s_cbranch_scc1 K2_BATCH
K2_FIND:
    s_cmp_lg_u64 s[84:85], 0
    s_cbranch_scc1 K2_GOT
    s_add_u32 s79, s79, 1
    s_cmp_ge_u32 s79, 4
    s_cbranch_scc1 K2_EPI
    s_mul_i32 s10, s12, 32896
    s_lshl_b32 s11, s79, 13
    s_add_u32 s10, s10, s11
    v_lshlrev_b32 v252, 7, v254
    buffer_load_ubyte v252, v252, s[24:27], s10 offen offset:15 sc1
    s_waitcnt vmcnt(0)
    v_cmp_lt_u32 s[84:85], s77, v252
    s_nop 3
    s_branch K2_FIND
K2_GOT:
    s_ff1_i32_b64 s10, s[84:85]
    s_bitset0_b64 s[84:85], s10
    s_lshl_b32 s11, s79, 6
    s_add_u32 s80, s10, s11
    s_mul_i32 s10, s12, 32896
    s_lshl_b32 s11, s80, 7
    s_add_u32 s10, s10, s11
    s_lshl_b32 s11, s12, 8
    s_add_u32 s11, s11, s80
    s_lshl_b32 s11, s11, 2
    s_add_u32 s11, s11, 23068672
    v_mov_b32 v188, 0
    buffer_load_ubyte v189, v188, s[24:27], s10 offen offset:15 sc1
    buffer_load_dword v190, v188, s[24:27], s11 offen sc1
    s_waitcnt vmcnt(0)
    v_readfirstlane_b32 s10, v189
    v_readfirstlane_b32 s11, v190
    s_nop 3
    s_and_b32 s83, s11, 0xffff
    s_lshr_b32 s11, s11, 16
    s_lshr_b32 s82, s10, 2
    s_sub_u32 s82, s10, s82
    s_cmp_gt_u32 s10, 48
    s_cselect_b32 s82, s11, s82
    s_lshr_b32 s10, s77, 2
    s_sub_u32 s81, s77, s10
K2_BATCH:
    s_barrier
    v_and_b32 v188, 7, v254
    v_mul_u32_u24 v189, 2688, v188
    v_add_u32 v189, 9728, v189
    v_lshlrev_b32 v188, 2, v188
    ds_write_b32 v188, v189 offset:2112
    v_add_u32 v188, s81, v255
    s_mul_i32 s10, s12, 32896
    s_lshl_b32 s11, s80, 7
    s_add_u32 s10, s10, s11
    v_mul_u32_u24 v190, 87382, v188
    v_lshrrev_b32 v190, 16, v190
    v_lshl_add_u32 v189, v190, 2, s10
    v_add_u32 v191, 8421248, v189
    v_cmp_lt_u32 vcc, 31, v190
    s_mul_i32 s11, s80, 3125
    s_add_u32 s11, s11, s83
    v_cndmask_b32 v189, v189, v191, vcc
    v_or_b32 v191, 12, v189
    v_and_b32 v192, 3, v190
    v_add_u32 v191, v191, v192
    v_cmp_le_u32 vcc, 48, v190
    v_add_u32 v190, s11, v188
    v_add_u32 v192, 22020096, v190
    v_cndmask_b32 v191, v191, v192, vcc
    v_lshlrev_b32 v190, 2, v190
    v_add_u32 v190, 17825792, v190
    v_cndmask_b32 v189, v189, v190, vcc
    s_add_u32 s10, s81, 448
    s_min_u32 s10, s10, s82
    v_cmp_gt_u32 vcc, s10, v188
    v_mov_b32 v190, 0x7ffffff0
    s_mul_i32 s86, s80, 100000
    v_cndmask_b32 v189, v190, v189, vcc
    v_cndmask_b32 v191, v190, v191, vcc
    buffer_load_dword v189, v189, s[24:27], 0 offen sc1
    buffer_load_ubyte v191, v191, s[24:27], 0 offen sc1
    s_waitcnt lgkmcnt(0)
    s_barrier
    s_and_saveexec_b64 s[10:11], vcc
    s_waitcnt vmcnt(0)
    v_and_b32 v188, 255, v189
    v_lshlrev_b32 v188, 2, v188
    ds_read_b32 v188, v188 offset:6400
    v_bfe_u32 v190, v189, 8, 8
    v_and_b32 v191, 15, v191
    v_lshl_or_b32 v191, v191, 8, v190
    v_mov_b32 v190, 4
    v_lshl_add_u32 v191, v191, 5, s86
    s_waitcnt lgkmcnt(0)
    ds_add_rtn_u32 v188, v188, v190 offset:2112
    s_waitcnt lgkmcnt(0)
    ds_write2st64_b32 v188, v189, v191 offset0:0 offset1:84
    s_mov_b64 exec, -1
    s_waitcnt lgkmcnt(0)
    s_barrier
    s_lshl_b32 s10, s3, 2
    v_mov_b32 v188, s10
    ds_read_b32 v188, v188 offset:2112
    v_mov_b32 v180, 0
    v_mov_b32 v181, 0
    v_mov_b32 v182, 0
    v_mov_b32 v183, 0
    v_mov_b32 v184, 0
    v_mov_b32 v185, 0
    v_mov_b32 v186, 0
    v_mov_b32 v187, 0
    v_lshrrev_b32 v189, 3, v254
    v_lshl_add_u32 v247, v189, 4, s76
    v_and_b32 v189, 31, v254
    v_lshl_add_u32 v249, v189, 2, s76
    v_lshrrev_b32 v190, 1, v254
    v_lshl_add_u32 v251, v190, 2, s76
    v_add_u32 v251, 21504, v251
    v_and_b32 v189, 44, v254
    v_add_u32 v248, s76, v189
    s_waitcnt lgkmcnt(0)
    v_readfirstlane_b32 s15, v188
    s_nop 3
    v_mov_b32 v190, 0xffff0000
    v_or_b32 v189, s39, v190
    v_mov_b32 v190, 0x7fffff00
    v_lshl_add_u32 v188, v254, 2, s15
    s_sub_u32 s73, s15, s76
    ds_write2st64_b32 v188, v189, v190 offset0:0 offset1:84
    ds_write2st64_b32 v188, v189, v190 offset0:1 offset1:85
    s_add_u32 s73, s73, 127
    s_lshr_b32 s73, s73, 7
    s_sub_i32 s38, s73, 1
K2_LAST:
    s_branch K2_GO
.section .rodata,"a"
.p2align 6
.amdhsa_kernel standalone__edge_featured_mpnn_gatedgcn__graph_kernel
  .amdhsa_next_free_vgpr 256
  .amdhsa_next_free_sgpr 102
  .amdhsa_accum_offset 256
  .amdhsa_group_segment_fixed_size 0
  .amdhsa_kernarg_size 96
  .amdhsa_user_sgpr_count 2
  .amdhsa_user_sgpr_kernarg_segment_ptr 1
  .amdhsa_system_sgpr_workgroup_id_x 1
.end_amdhsa_kernel
```

```asm
; @launch grid=(256,1,1) block=(512,1,1) lds=157696
.amdgcn_target "amdgcn-amd-amdhsa--gfx950"
.text
.globl standalone__edge_featured_mpnn_gatedgcn__graph_kernel
.p2align 8
.type standalone__edge_featured_mpnn_gatedgcn__graph_kernel,@function
standalone__edge_featured_mpnn_gatedgcn__graph_kernel:
    s_cmp_ge_u32 s2, 256
    s_cbranch_scc1 K2_END
    s_load_dwordx4 s[44:47], s[0:1], 16
    s_load_dwordx2 s[8:9], s[0:1], 88
    s_load_dwordx4 s[40:43], s[0:1], 0
    s_load_dwordx8 s[48:55], s[0:1], 32
    s_load_dwordx4 s[56:59], s[0:1], 64
    s_getpc_b64 s[86:87]
K2_PC:
    v_lshlrev_b32 v252, 7, v0
    v_min_u32 v252, K2_LAST-K2_PC, v252
    v_cmp_gt_u32 vcc, 192, v0
    s_cbranch_vccz K2_NOCPF
    global_load_dword v253, v252, s[86:87]
K2_NOCPF:
    v_mov_b32 v255, v0
    v_lshrrev_b32 v188, 6, v0
    v_and_b32 v254, 63, v0
    v_readfirstlane_b32 s7, v188
    s_and_b32 s10, s2, 7
    s_lshr_b32 s11, s2, 3
    s_lshl_b32 s10, s10, 5
    s_add_u32 s12, s10, s11
    s_mul_i32 s13, s12, 12500
    v_lshlrev_b32 v189, 4, v0
    v_lshlrev_b32 v1, 3, v0
    v_lshlrev_b32 v2, 2, v0
    v_mov_b32 v3, 0
    v_and_b32 v4, 0x3fc, v2
    ds_write_b32 v4, v3 offset:6400
    s_and_b32 s10, s7, 3
    s_lshr_b32 s3, s7, 2
    s_lshl1_add_u32 s3, s10, s3
    s_xor_b32 s3, s3, 1
    s_movk_i32 s14, 8192
    s_movk_i32 s15, 12288
    s_waitcnt lgkmcnt(0)
    s_add_u32 s64, s46, s13
    s_addc_u32 s65, s47, 0
    s_mov_b32 s66, 12500
    s_mov_b32 s67, 0x20000
    s_add_u32 s68, s44, s13
    s_addc_u32 s69, s45, 0
    s_mov_b32 s70, 12500
    s_mov_b32 s71, 0x20000
    buffer_load_dwordx4 v[8:11], v189, s[64:67], 0 offen nt
    buffer_load_dwordx2 v[12:13], v1, s[64:67], s14 offen nt
    buffer_load_dword v14, v2, s[64:67], s15 offen nt
    s_barrier
    buffer_load_dwordx4 v[16:19], v189, s[68:71], 0 offen nt
    buffer_load_dwordx2 v[20:21], v1, s[68:71], s14 offen nt
    buffer_load_dword v22, v2, s[68:71], s15 offen nt
    s_add_u32 s10, s8, 24117248
    s_addc_u32 s11, s9, 0
    s_load_dword s100, s[10:11], 0
    v_lshrrev_b32 v1, 3, v0
    v_lshlrev_b32 v170, 2, v1
    v_and_b32 v197, 7, v0
    v_and_b32 v5, 16, v0
    v_lshlrev_b32 v5, 1, v5
    v_xor_b32 v5, v5, v189
    v_lshlrev_b32 v172, 4, v254
    v_and_b32 v241, 16, v254
    v_lshlrev_b32 v241, 2, v241
    v_xor_b32 v234, v241, v172
    v_and_b32 v241, 0x70, v234
    s_mov_b32 s16, s40
    s_mov_b32 s17, s41
    s_mov_b32 s18, 6400000
    s_mov_b32 s19, 0x20000
    s_mov_b32 s60, 85599
    s_mov_b32 s61, 4294967100
    s_movk_i32 s62, 2000
    v_mov_b32 v7, 87382
    s_mov_b32 s10, 0
    v_lshl_add_u32 v56, v254, 10, s10
    v_add_u32 v57, 256, v56
    v_add_u32 v58, 512, v56
    v_add_u32 v59, 768, v56
    v_and_b32 v60, 127, v255
    v_lshl_add_u32 v60, v60, 9, s10
    v_add_u32 v61, 256, v60
    v_lshl_add_u32 v62, v254, 8, s10
    v_lshrrev_b32 v23, 6, v255
    v_lshrrev_b32 v31, 7, v255
    v_add_u32 v31, 8, v31
    v_mov_b32 v39, 12
    v_cmp_gt_u32 s[78:79], 53, v255
    s_mov_b32 s11, 32896
    v_lshlrev_b32 v3, 4, v197
    v_mad_u32_u24 v4, v1, s11, v3
    v_mul_u32_u24 v6, 52, v1
    v_lshl_add_u32 v6, v197, 2, v6
    v_lshlrev_b32 v3, 2, v6
    v_add_u32 v3, 104448, v3
    v_add_u32 v6, 91136, v6
    v_mov_b32 v214, 0xf0f0f0
    v_mov_b32 v15, 0x0f0f0f
    s_waitcnt vmcnt(3)
    v_mul_u32_u24 v48, s60, v8
    v_mul_u32_u24 v49, s60, v9
    v_mul_u32_u24 v50, s60, v10
    v_mul_u32_u24 v51, s60, v11
    v_mul_u32_u24 v52, s60, v12
    v_mul_u32_u24 v53, s60, v13
    v_lshrrev_b32 v48, 24, v48
    v_lshrrev_b32 v49, 24, v49
    v_lshrrev_b32 v50, 24, v50
    v_lshrrev_b32 v51, 24, v51
    v_lshrrev_b32 v52, 24, v52
    v_lshrrev_b32 v53, 24, v53
    v_lshl_add_u32 v24, v48, 2, s62
    ds_add_rtn_u32 v32, v24, v7 offset:4400
    v_lshl_add_u32 v25, v49, 2, s62
    ds_add_rtn_u32 v33, v25, v7 offset:4400
    v_lshl_add_u32 v26, v50, 2, s62
    ds_add_rtn_u32 v34, v26, v7 offset:4400
    v_lshl_add_u32 v27, v51, 2, s62
    ds_add_rtn_u32 v35, v27, v7 offset:4400
    v_lshl_add_u32 v28, v52, 2, s62
    ds_add_rtn_u32 v36, v28, v7 offset:4400
    v_lshl_add_u32 v29, v53, 2, s62
    ds_add_rtn_u32 v37, v29, v7 offset:4400
    v_mad_i32_i24 v8, v48, s61, v8
    v_or_b32 v8, v8, v56
    v_mad_i32_i24 v9, v49, s61, v9
    v_or_b32 v9, v9, v57
    v_mad_i32_i24 v10, v50, s61, v10
    v_or_b32 v10, v10, v58
    v_mad_i32_i24 v11, v51, s61, v11
    v_or_b32 v11, v11, v59
    v_mad_i32_i24 v12, v52, s61, v12
    v_or_b32 v12, v12, v60
    v_mad_i32_i24 v13, v53, s61, v13
    v_or_b32 v13, v13, v61
    s_waitcnt lgkmcnt(5)
    v_lshrrev_b32 v32, 16, v32
    v_min_u32 v40, 48, v32
    v_mad_u32_u24 v40, v24, 13, v40
    v_lshlrev_b32 v48, 2, v40
    ds_write_b8 v40, v23 offset:65136
    s_waitcnt lgkmcnt(5)
    v_lshrrev_b32 v33, 16, v33
    v_min_u32 v41, 48, v33
    v_mad_u32_u24 v41, v25, 13, v41
    v_lshlrev_b32 v49, 2, v41
    ds_write_b8 v41, v23 offset:65136
    s_waitcnt lgkmcnt(5)
    v_lshrrev_b32 v34, 16, v34
    v_min_u32 v42, 48, v34
    v_mad_u32_u24 v42, v26, 13, v42
    v_lshlrev_b32 v50, 2, v42
    ds_write_b8 v42, v23 offset:65136
    s_waitcnt lgkmcnt(5)
    v_lshrrev_b32 v35, 16, v35
    v_min_u32 v43, 48, v35
    v_mad_u32_u24 v43, v27, 13, v43
    v_lshlrev_b32 v51, 2, v43
    ds_write_b8 v43, v23 offset:65136
    s_waitcnt lgkmcnt(5)
    v_lshrrev_b32 v36, 16, v36
    v_min_u32 v44, 48, v36
    v_mad_u32_u24 v44, v28, 13, v44
    v_lshlrev_b32 v52, 2, v44
    ds_write_b8 v44, v31 offset:65136
    s_waitcnt lgkmcnt(5)
    v_lshrrev_b32 v37, 16, v37
    v_min_u32 v45, 48, v37
    v_mad_u32_u24 v45, v29, 13, v45
    v_lshlrev_b32 v53, 2, v45
    ds_write_b8 v45, v31 offset:65136
    s_cmp_lg_u32 s7, 0
    s_cbranch_scc1 K1_NO7
    s_mov_b64 exec, s[78:79]
    s_waitcnt lgkmcnt(0)
    v_mul_u32_u24 v54, s60, v14
    v_lshrrev_b32 v54, 24, v54
    v_lshl_add_u32 v30, v54, 2, s62
    ds_add_rtn_u32 v38, v30, v7 offset:4400
    v_mad_i32_i24 v14, v54, s61, v14
    v_or_b32 v14, v14, v62
    s_waitcnt lgkmcnt(0)
    v_lshrrev_b32 v38, 16, v38
    v_min_u32 v46, 48, v38
    v_mad_u32_u24 v46, v30, 13, v46
    v_lshlrev_b32 v54, 2, v46
    ds_write_b8 v46, v39 offset:65136
    s_waitcnt vmcnt(0)
    v_lshl_add_u32 v22, v22, 16, v14
    ds_write_b32 v54, v22 offset:448
    s_mov_b64 exec, -1
K1_NO7:
    s_mov_b32 s64, s50
    s_mov_b32 s65, s51
    s_mov_b32 s66, 8192
    s_mov_b32 s67, 0x20000
    buffer_load_dwordx4 v[64:67], v5, s[64:67], 0 offen
    s_mov_b32 s68, s52
    s_mov_b32 s69, s53
    s_mov_b32 s70, 2048
    s_mov_b32 s71, 0x20000
    buffer_load_dwordx4 v[68:71], v5, s[68:71], 0 offen
    s_lshl_b32 s10, s7, 10
    s_mov_b32 s64, s48
    s_mov_b32 s65, s49
    s_add_u32 m0, s10, 34304
    s_nop 0
    buffer_load_dwordx4 v5, s[64:67], 0 offen lds
    s_mov_b32 s64, s56
    s_mov_b32 s65, s57
    s_add_u32 m0, s10, 26112
    s_nop 0
    buffer_load_dwordx4 v5, s[64:67], 0 offen lds
    s_mov_b32 s64, s54
    s_mov_b32 s65, s55
    s_add_u32 m0, s10, 9728
    s_nop 0
    buffer_load_dwordx4 v5, s[64:67], 0 offen lds
    s_waitcnt vmcnt(5)
    v_lshl_add_u32 v16, v16, 16, v8
    ds_write_b32 v48, v16 offset:448
    v_lshl_add_u32 v17, v17, 16, v9
    ds_write_b32 v49, v17 offset:448
    v_lshl_add_u32 v18, v18, 16, v10
    ds_write_b32 v50, v18 offset:448
    v_lshl_add_u32 v19, v19, 16, v11
    ds_write_b32 v51, v19 offset:448
    v_lshl_add_u32 v20, v20, 16, v12
    ds_write_b32 v52, v20 offset:448
    v_lshl_add_u32 v21, v21, 16, v13
    ds_write_b32 v53, v21 offset:448
    s_lshl_b32 s15, s12, 7
    s_add_u32 s32, s8, s15
    s_addc_u32 s33, s9, 0
    s_mov_b32 s34, 16809984
    s_mov_b32 s35, 0x20000
    s_waitcnt lgkmcnt(0)
    s_add_u32 s100, s100, 1
    s_and_b32 s10, s100, 15
    s_and_b32 s11, s100, 0xf0
    s_mul_i32 s36, s10, 0x1010
    s_lshl_b32 s11, s11, 16
    s_xor_b32 s36, s36, 0xf000
    s_or_b32 s36, s36, s11
    s_mov_b32 s101, 300000
    s_barrier
    ds_read_b128 v[112:115], v172 offset:6400
    ds_read_u16 v108, v170 offset:6402
    ds_read_b32 v104, v6 offset:0
    ds_read_b128 v[88:91], v3 offset:0
    ds_read_u16 v109, v170 offset:6658
    ds_read_b32 v105, v6 offset:3328
    ds_read_b128 v[92:95], v3 offset:13312
    ds_read_u16 v110, v170 offset:6914
    ds_read_b32 v106, v6 offset:6656
    ds_read_b128 v[96:99], v3 offset:26624
    ds_read_u16 v111, v170 offset:7170
    ds_read_b32 v107, v6 offset:9984
    ds_read_b128 v[100:103], v3 offset:39936
    s_waitcnt lgkmcnt(12)
    v_max3_u32 v1, v112, v113, v114
    v_max_u32 v1, v1, v115
    v_cmp_le_u32 vcc, 3211264, v1
    s_mov_b32 s10, 0
    s_cbranch_vccnz K1_OVF
K1_OUT:
    s_waitcnt lgkmcnt(9)
    v_lshl_or_b32 v108, v108, 24, s36
    v_and_or_b32 v91, v104, v15, v108
    buffer_store_dwordx4 v[88:91], v4, s[32:35], s10 offen sc1
    s_add_u32 s10, s10, 2105344
    s_waitcnt lgkmcnt(6)
    v_lshl_or_b32 v109, v109, 24, s36
    v_and_or_b32 v95, v105, v15, v109
    buffer_store_dwordx4 v[92:95], v4, s[32:35], s10 offen sc1
    s_add_u32 s10, s10, 2105344
    s_waitcnt lgkmcnt(3)
    v_lshl_or_b32 v110, v110, 24, s36
    v_and_or_b32 v99, v106, v15, v110
    buffer_store_dwordx4 v[96:99], v4, s[32:35], s10 offen sc1
    s_add_u32 s10, s10, 2105344
    s_waitcnt lgkmcnt(0)
    v_lshl_or_b32 v111, v111, 24, s36
    v_and_or_b32 v103, v107, v15, v111
    buffer_store_dwordx4 v[100:103], v4, s[32:35], s10 offen sc1
    s_add_u32 s10, s10, 2105344
    v_max3_u32 v1, v108, v109, v110
    v_max_u32 v1, v1, v111
    v_cmp_le_u32 vcc, 553648128, v1
    s_cbranch_vccnz K1_EXT
K1_EXTR:
    s_lshr_b32 s10, s3, 1
    s_mul_i32 s10, s10, 49
    s_bitcmp1_b32 s3, 0
    s_cselect_b32 s72, 20, -4
    s_cselect_b32 s73, 28, 3
    s_cselect_b32 s84, 45, 20
    s_add_i32 s72, s72, s10
    s_add_i32 s73, s73, s10
    s_add_i32 s84, s84, s10
    s_add_i32 s85, s72, 32
    s_max_i32 s96, s72, 0
    s_cmp_eq_u32 s3, 7
    s_cselect_b32 s84, 196, s84
    s_cselect_b32 s85, 196, s85
    v_lshrrev_b32 v193, 5, v254
    s_mov_b32 s20, s42
    s_mov_b32 s21, s43
    s_mov_b32 s22, 25600000
    s_mov_b32 s23, 0x20000
    s_mov_b32 s28, s58
    s_mov_b32 s29, s59
    s_mov_b32 s30, 6400000
    s_mov_b32 s31, 0x20000
    s_mov_b32 s24, s8
    s_mov_b32 s25, s9
    s_mov_b32 s26, 24117376
    s_mov_b32 s27, 0x20000
    v_lshrrev_b32 v194, 5, v255
    v_and_b32 v195, 15, v255
    v_cmp_eq_u32 vcc, v194, v195
    v_and_b32 v194, 16, v255
    v_mov_b32 v195, 0x3f80
    v_lshlrev_b32 v195, v194, v195
    v_cndmask_b32 v195, 0, v195, vcc
    v_lshlrev_b32 v194, 2, v255
    v_mov_b32 v196, 0
    ds_write_b32 v194, v195
    v_bfe_u32 v195, v255, 3, 1
    v_and_b32 v201, 7, v255
    v_lshl_add_u32 v195, v195, 2, v201
    v_lshrrev_b32 v200, 6, v255
    v_cmp_eq_u32 vcc, v195, v200
    v_bfe_u32 v200, v255, 4, 2
    v_mov_b32 v195, 0x3f80
    v_cndmask_b32 v195, 0, v195, vcc
    v_cmp_lt_u32 vcc, 3, v201
    v_mul_u32_u24 v200, 0x5555, v200
    v_and_b32 v201, 60, v194
    v_cndmask_b32 v195, v195, v200, vcc
    ds_write_b32 v194, v195 offset:7424
    ds_write_b32 v201, v196 offset:9472
    ds_write_b32 v194, v196 offset:2048
    ds_write2st64_b32 v194, v196, v196 offset0:9 offset1:17
    s_movk_i32 s75, 128
    s_mul_i32 s74, s3, 5184
    s_add_u32 s74, s74, 102400
    s_movk_i32 s77, 48
    s_add_u32 s39, s96, 32
    s_lshl_b32 s11, s96, 6
    s_mov_b32 s97, 0
    v_bfe_u32 v194, v254, 4, 1
    v_and_b32 v242, 1, v254
    v_lshlrev_b32 v242, 4, v242
    v_lshlrev_b32 v245, 5, v193
    v_subrev_u32 v245, s11, v245
    v_and_b32 v195, 3, v254
    v_lshlrev_b32 v195, 3, v195
    v_lshl_add_u32 v246, v194, 5, v195
    v_subrev_u32 v246, s11, v246
    v_mul_u32_u24 v196, 130, v195
    v_and_b32 v194, 28, v254
    v_lshl_add_u32 v196, v194, 5, v196
    v_bfe_u32 v194, v254, 3, 1
    v_xor_b32 v194, v194, v193
    v_lshl_add_u32 v196, v194, 6, v196
    v_add_u32 v243, s74, v196
    v_and_b32 v194, 31, v254
    v_lshl_add_u32 v194, v194, 1, v193
    v_lshl_add_u32 v244, v194, 4, s74
    v_add_u32 v244, 4160, v244
    s_mul_i32 s76, s3, 2688
    s_add_u32 s76, s76, 9728
    v_lshrrev_b32 v194, 3, v254
    v_lshl_add_u32 v247, v194, 4, s76
    v_and_b32 v194, 31, v254
    v_lshl_add_u32 v249, v194, 2, s76
    v_lshrrev_b32 v195, 1, v254
    v_lshl_add_u32 v251, v195, 2, s76
    v_add_u32 v251, 21504, v251
    v_and_b32 v194, 44, v254
    v_add_u32 v248, s76, v194
    s_mul_i32 s10, s7, 4160
    s_add_u32 s10, s10, 69120
    v_and_b32 v202, 31, v254
    v_bfe_u32 v194, v202, 1, 1
    v_xor_b32 v194, v194, v193
    v_lshlrev_b32 v194, 6, v194
    v_lshl_add_u32 v194, v202, 7, v194
    v_lshrrev_b32 v202, 3, v202
    v_lshl_add_u32 v202, v202, 4, v194
    v_add_u32 v202, s10, v202
    v_lshrrev_b32 v194, 1, v254
    v_xor_b32 v194, v194, v254
    v_and_b32 v194, 4, v194
    v_mul_u32_u24 v194, 3, v194
    v_xor_b32 v194, v194, v254
    v_and_b32 v235, 31, v194
    v_bfe_u32 v195, v235, 1, 1
    v_xor_b32 v195, v195, v193
    v_lshlrev_b32 v195, 6, v195
    v_lshl_add_u32 v195, v235, 7, v195
    v_lshrrev_b32 v235, 3, v235
    v_lshl_add_u32 v235, v235, 4, v195
    v_add_u32 v235, s10, v235
    v_mov_b32 v177, 0xdddd
    v_lshlrev_b32 v168, 2, v197
    v_mul_u32_u24 v208, 25000, v170
    v_add_u32 v209, 6400000, v208
    v_add_u32 v210, 12800000, v208
    v_add_u32 v211, 19200000, v208
    v_mov_b32 v171, 4
    v_mov_b32 v169, 1
    v_and_b32 v199, 31, v254
    v_add_u32 v199, s96, v199
    v_lshlrev_b32 v200, 4, v199
    v_lshl_add_u32 v200, v193, 3, v200
    v_mov_b64 v[180:181], 0
    v_mov_b64 v[182:183], 0
    v_mov_b64 v[184:185], 0
    v_mov_b64 v[186:187], 0
    s_lshl_b32 s15, s3, 2
    v_mov_b32 v212, s15
    v_lshlrev_b32 v213, 2, v199
    s_mul_i32 s10, s12, 32896
    s_add_u32 s32, s8, s10
    s_addc_u32 s33, s9, 0
    s_mov_b32 s34, 32768
    s_mov_b32 s35, 0x20000
    s_movk_i32 s79, 8192
    s_movk_i32 s80, 16384
    s_movk_i32 s81, 24576
    s_mov_b32 s10, 0xbfb8aa3b
    s_waitcnt vmcnt(7)
    v_lshlrev_b32 v72, 16, v64
    v_and_b32 v73, 0xffff0000, v64
    v_lshlrev_b32 v74, 16, v65
    v_and_b32 v75, 0xffff0000, v65
    v_lshlrev_b32 v76, 16, v66
    v_and_b32 v77, 0xffff0000, v66
    v_lshlrev_b32 v78, 16, v67
    v_and_b32 v79, 0xffff0000, v67
    v_lshlrev_b32 v80, 16, v68
    v_and_b32 v81, 0xffff0000, v68
    v_lshlrev_b32 v82, 16, v69
    v_and_b32 v83, 0xffff0000, v69
    v_lshlrev_b32 v84, 16, v70
    v_and_b32 v85, 0xffff0000, v70
    v_lshlrev_b32 v86, 16, v71
    v_and_b32 v87, 0xffff0000, v71
    v_mul_f32 v72, s10, v72
    v_mul_f32 v73, s10, v73
    v_mul_f32 v74, s10, v74
    v_mul_f32 v75, s10, v75
    v_mul_f32 v76, s10, v76
    v_mul_f32 v77, s10, v77
    v_mul_f32 v78, s10, v78
    v_mul_f32 v79, s10, v79
    v_mul_f32 v80, s10, v80
    v_mul_f32 v81, s10, v81
    v_mul_f32 v82, s10, v82
    v_mul_f32 v83, s10, v83
    v_mul_f32 v84, s10, v84
    v_mul_f32 v85, s10, v85
    v_mul_f32 v86, s10, v86
    v_mul_f32 v87, s10, v87
    v_cvt_pk_bf16_f32 v64, v72, v73
    v_cvt_pk_bf16_f32 v65, v74, v75
    v_cvt_pk_bf16_f32 v66, v76, v77
    v_cvt_pk_bf16_f32 v67, v78, v79
    v_cvt_pk_bf16_f32 v68, v80, v81
    v_cvt_pk_bf16_f32 v69, v82, v83
    v_cvt_pk_bf16_f32 v70, v84, v85
    v_cvt_pk_bf16_f32 v71, v86, v87
    ds_write_b128 v189, v[64:67] offset:17920
    s_cmp_ge_u32 s7, 2
    s_cbranch_scc1 K1_NOWC
    ds_write_b128 v189, v[68:71] offset:42496
K1_NOWC:
    v_bfe_u32 v173, v254, 2, 2
    v_lshlrev_b32 v173, 7, v173
    v_lshl_add_u32 v173, v242, 2, v173
    v_and_b32 v174, 16, v254
    v_and_b32 v175, 2, v254
    v_lshl_add_u32 v174, v175, 2, v174
    v_and_b32 v175, 8, v254
    v_lshl_add_u32 v174, v175, 2, v174
    v_add_u32 v173, v173, v174
    v_lshl_add_u32 v175, v193, 10, v173
    v_lshl_add_u32 v173, v193, 12, v173
    v_xor_b32 v174, 32, v173
    v_xor_b32 v176, 32, v175
    s_lshl_b32 s10, s7, 10
    s_and_b32 s11, s7, 4
    s_mul_i32 s11, s11, -1016
    s_add_u32 s11, s11, s10
    v_xor_b32 v252, s11, v173
    s_waitcnt vmcnt(0) lgkmcnt(0)
    s_barrier
    ds_read_b64_tr_b16 v[72:73], v252 offset:9728
    ds_read_b64_tr_b16 v[76:77], v252 offset:34304
    ds_read_b64_tr_b16 v[74:75], v252 offset:10240
    ds_read_b64_tr_b16 v[78:79], v252 offset:34816
    v_add_u32 v252, s10, v172
    ds_read_b64_tr_b16 v[0:1], v173 offset:17920
    ds_read_b64_tr_b16 v[2:3], v173 offset:18432
    ds_read_b64_tr_b16 v[4:5], v173 offset:18944
    ds_read_b64_tr_b16 v[6:7], v173 offset:19456
    ds_read_b64_tr_b16 v[8:9], v173 offset:19968
    ds_read_b64_tr_b16 v[10:11], v173 offset:20480
    ds_read_b64_tr_b16 v[12:13], v173 offset:20992
    ds_read_b64_tr_b16 v[14:15], v173 offset:21504
    s_waitcnt lgkmcnt(8)
    ds_write_b128 v252, v[72:75] offset:52736
    ds_write_b128 v252, v[76:79] offset:60928
    s_waitcnt lgkmcnt(8)
    ds_read_b64_tr_b16 v[16:17], v174 offset:17920
    ds_read_b64_tr_b16 v[18:19], v174 offset:18432
    ds_read_b64_tr_b16 v[20:21], v174 offset:18944
    ds_read_b64_tr_b16 v[22:23], v174 offset:19456
    ds_read_b64_tr_b16 v[24:25], v174 offset:19968
    ds_read_b64_tr_b16 v[26:27], v174 offset:20480
    s_waitcnt lgkmcnt(8)
    ds_read_b64_tr_b16 v[28:29], v174 offset:20992
    ds_read_b64_tr_b16 v[30:31], v174 offset:21504
    ds_read_b64_tr_b16 v[64:65], v175 offset:42496
    ds_read_b64_tr_b16 v[66:67], v175 offset:43008
    ds_read_b64_tr_b16 v[68:69], v176 offset:42496
    ds_read_b64_tr_b16 v[70:71], v176 offset:43008
    s_waitcnt lgkmcnt(8)
    ds_read_b64_tr_b16 v[32:33], v173 offset:26112
    ds_read_b64_tr_b16 v[34:35], v173 offset:26624
    ds_read_b64_tr_b16 v[36:37], v173 offset:27136
    ds_read_b64_tr_b16 v[38:39], v173 offset:27648
    ds_read_b64_tr_b16 v[40:41], v173 offset:28160
    ds_read_b64_tr_b16 v[42:43], v173 offset:28672
    s_waitcnt lgkmcnt(8)
    ds_read_b64_tr_b16 v[44:45], v173 offset:29184
    ds_read_b64_tr_b16 v[46:47], v173 offset:29696
    ds_read_b64_tr_b16 v[48:49], v174 offset:26112
    ds_read_b64_tr_b16 v[50:51], v174 offset:26624
    ds_read_b64_tr_b16 v[52:53], v174 offset:27136
    ds_read_b64_tr_b16 v[54:55], v174 offset:27648
    s_waitcnt lgkmcnt(8)
    ds_read_b64_tr_b16 v[56:57], v174 offset:28160
    ds_read_b64_tr_b16 v[58:59], v174 offset:28672
    ds_read_b64_tr_b16 v[60:61], v174 offset:29184
    ds_read_b64_tr_b16 v[62:63], v174 offset:29696
    s_mov_b32 s5, 85899
    s_lshr_b32 s6, s12, 5
    s_mul_i32 s6, s6, 538758528
    s_sub_u32 s6, s6, 0
    buffer_load_dwordx4 v[88:91], v189, s[32:35], 0 offen sc1
    buffer_load_dwordx4 v[92:95], v189, s[32:35], s79 offen sc1
    buffer_load_dwordx4 v[96:99], v189, s[32:35], s80 offen sc1
    buffer_load_dwordx4 v[100:103], v189, s[32:35], s81 offen sc1
K2_CHK0:
    s_waitcnt vmcnt(3)
    v_bitop3_b32 v188, v91, s36, v214 bitop3:0x28
    v_cmp_ne_u32 vcc, 0, v188
    v_sub_u32_sdwa v188, v91, v168 dst_sel:DWORD dst_unused:UNUSED_PAD src0_sel:BYTE_3 src1_sel:DWORD
    v_mul_u32_u24_sdwa v104, s5, v88 dst_sel:DWORD dst_unused:UNUSED_PAD src0_sel:DWORD src1_sel:WORD_1
    v_mul_u32_u24_sdwa v105, s5, v89 dst_sel:DWORD dst_unused:UNUSED_PAD src0_sel:DWORD src1_sel:WORD_1
    v_mul_u32_u24_sdwa v106, s5, v90 dst_sel:DWORD dst_unused:UNUSED_PAD src0_sel:DWORD src1_sel:WORD_1
    s_cbranch_vccnz K2_RETRY0
    v_cmp_lt_i32 s[40:41], 0, v188
    v_cmp_lt_i32 s[42:43], 1, v188
    v_cmp_lt_i32 s[44:45], 2, v188
    v_subrev_u32 v104, s6, v104
    v_subrev_u32 v105, s6, v105
    v_subrev_u32 v106, s6, v106
    v_alignbit_b32 v104, v88, v104, 28
    v_alignbit_b32 v105, v89, v105, 28
    v_alignbit_b32 v106, v90, v106, 28
    v_and_b32 v104, 0xffc, v104
    v_and_b32 v105, 0xffc, v105
    v_and_b32 v106, 0xffc, v106
    s_mov_b64 exec, s[40:41]
    ds_add_rtn_u32 v220, v104, v171 offset:2304
    s_mov_b64 exec, s[42:43]
    ds_add_rtn_u32 v221, v105, v171 offset:2304
    s_mov_b64 exec, s[44:45]
    ds_add_rtn_u32 v222, v106, v171 offset:2304
    s_mov_b64 exec, -1
K2_CHK1:
    s_waitcnt vmcnt(2)
    v_bitop3_b32 v188, v95, s36, v214 bitop3:0x28
    v_cmp_ne_u32 vcc, 0, v188
    v_sub_u32_sdwa v188, v95, v168 dst_sel:DWORD dst_unused:UNUSED_PAD src0_sel:BYTE_3 src1_sel:DWORD
    v_mul_u32_u24_sdwa v107, s5, v92 dst_sel:DWORD dst_unused:UNUSED_PAD src0_sel:DWORD src1_sel:WORD_1
    v_mul_u32_u24_sdwa v108, s5, v93 dst_sel:DWORD dst_unused:UNUSED_PAD src0_sel:DWORD src1_sel:WORD_1
    v_mul_u32_u24_sdwa v109, s5, v94 dst_sel:DWORD dst_unused:UNUSED_PAD src0_sel:DWORD src1_sel:WORD_1
    s_cbranch_vccnz K2_RETRY1
    v_cmp_lt_i32 s[46:47], 0, v188
    v_cmp_lt_i32 s[48:49], 1, v188
    v_cmp_lt_i32 s[50:51], 2, v188
    v_subrev_u32 v107, s6, v107
    v_subrev_u32 v108, s6, v108
    v_subrev_u32 v109, s6, v109
    v_alignbit_b32 v107, v92, v107, 28
    v_alignbit_b32 v108, v93, v108, 28
    v_alignbit_b32 v109, v94, v109, 28
    v_and_b32 v107, 0xffc, v107
    v_and_b32 v108, 0xffc, v108
    v_and_b32 v109, 0xffc, v109
    s_mov_b64 exec, s[46:47]
    ds_add_rtn_u32 v223, v107, v171 offset:2304
    s_mov_b64 exec, s[48:49]
    ds_add_rtn_u32 v224, v108, v171 offset:2304
    s_mov_b64 exec, s[50:51]
    ds_add_rtn_u32 v225, v109, v171 offset:2304
    s_mov_b64 exec, -1
K2_CHK2:
    s_waitcnt vmcnt(1)
    v_bitop3_b32 v188, v99, s36, v214 bitop3:0x28
    v_cmp_ne_u32 vcc, 0, v188
    v_sub_u32_sdwa v188, v99, v168 dst_sel:DWORD dst_unused:UNUSED_PAD src0_sel:BYTE_3 src1_sel:DWORD
    v_mul_u32_u24_sdwa v110, s5, v96 dst_sel:DWORD dst_unused:UNUSED_PAD src0_sel:DWORD src1_sel:WORD_1
    v_mul_u32_u24_sdwa v111, s5, v97 dst_sel:DWORD dst_unused:UNUSED_PAD src0_sel:DWORD src1_sel:WORD_1
    v_mul_u32_u24_sdwa v112, s5, v98 dst_sel:DWORD dst_unused:UNUSED_PAD src0_sel:DWORD src1_sel:WORD_1
    s_cbranch_vccnz K2_RETRY2
    v_cmp_lt_i32 s[52:53], 0, v188
    v_cmp_lt_i32 s[54:55], 1, v188
    v_cmp_lt_i32 s[56:57], 2, v188
    v_subrev_u32 v110, s6, v110
    v_subrev_u32 v111, s6, v111
    v_subrev_u32 v112, s6, v112
    v_alignbit_b32 v110, v96, v110, 28
    v_alignbit_b32 v111, v97, v111, 28
    v_alignbit_b32 v112, v98, v112, 28
    v_and_b32 v110, 0xffc, v110
    v_and_b32 v111, 0xffc, v111
    v_and_b32 v112, 0xffc, v112
    s_mov_b64 exec, s[52:53]
    ds_add_rtn_u32 v226, v110, v171 offset:2304
    s_mov_b64 exec, s[54:55]
    ds_add_rtn_u32 v227, v111, v171 offset:2304
    s_mov_b64 exec, s[56:57]
    ds_add_rtn_u32 v228, v112, v171 offset:2304
    s_mov_b64 exec, -1
K2_CHK3:
    s_waitcnt vmcnt(0)
    v_bitop3_b32 v188, v103, s36, v214 bitop3:0x28
    v_cmp_ne_u32 vcc, 0, v188
    v_sub_u32_sdwa v188, v103, v168 dst_sel:DWORD dst_unused:UNUSED_PAD src0_sel:BYTE_3 src1_sel:DWORD
    v_mul_u32_u24_sdwa v113, s5, v100 dst_sel:DWORD dst_unused:UNUSED_PAD src0_sel:DWORD src1_sel:WORD_1
    v_mul_u32_u24_sdwa v114, s5, v101 dst_sel:DWORD dst_unused:UNUSED_PAD src0_sel:DWORD src1_sel:WORD_1
    v_mul_u32_u24_sdwa v115, s5, v102 dst_sel:DWORD dst_unused:UNUSED_PAD src0_sel:DWORD src1_sel:WORD_1
    s_cbranch_vccnz K2_RETRY3
    v_cmp_lt_i32 s[58:59], 0, v188
    v_cmp_lt_i32 s[60:61], 1, v188
    v_cmp_lt_i32 s[62:63], 2, v188
    v_subrev_u32 v113, s6, v113
    v_subrev_u32 v114, s6, v114
    v_subrev_u32 v115, s6, v115
    v_alignbit_b32 v113, v100, v113, 28
    v_alignbit_b32 v114, v101, v114, 28
    v_alignbit_b32 v115, v102, v115, 28
    v_and_b32 v113, 0xffc, v113
    v_and_b32 v114, 0xffc, v114
    v_and_b32 v115, 0xffc, v115
    s_mov_b64 exec, s[58:59]
    ds_add_rtn_u32 v229, v113, v171 offset:2304
    s_mov_b64 exec, s[60:61]
    ds_add_rtn_u32 v230, v114, v171 offset:2304
    s_mov_b64 exec, s[62:63]
    ds_add_rtn_u32 v231, v115, v171 offset:2304
    s_mov_b64 exec, -1
    v_max3_u32 v188, v91, v95, v99
    v_max_u32 v188, v188, v103
    v_cmp_le_u32 vcc, 553648128, v188
    s_mov_b32 s64, 0xc0c0401
    s_mov_b32 s65, 0xc0c0501
    s_mov_b32 s66, 0xc0c0601
    s_mov_b32 s67, 0x05040100
    s_cbranch_vccnz K2_XT1
K2_XT1R:
    s_waitcnt lgkmcnt(0)
    s_barrier
    ds_read_b128 v[116:119], v172 offset:2304
    ds_read_b128 v[120:123], v172 offset:3328
    ds_read_b128 v[124:127], v172 offset:4352
    ds_read_b128 v[128:131], v172 offset:5376
    ds_read_b64 v[194:195], v200 offset:2304
    s_mul_i32 s10, s12, 196
    s_add_u32 s10, s10, s96
    s_lshl_b32 s10, s10, 7
    s_mul_i32 s11, s7, 4160
    s_add_u32 m0, s11, 69120
    s_add_u32 s86, s10, 0
    buffer_load_dwordx4 v234, s[16:19], s86 offen lds
    s_add_u32 m0, s11, 70160
    s_add_u32 s86, s10, 1024
    buffer_load_dwordx4 v234, s[16:19], s86 offen lds
    s_add_u32 m0, s11, 71200
    s_add_u32 s86, s10, 2048
    buffer_load_dwordx4 v234, s[16:19], s86 offen lds
    s_add_u32 m0, s11, 72240
    s_add_u32 s86, s10, 3072
    buffer_load_dwordx4 v234, s[16:19], s86 offen lds
    v_and_b32 v91, 0x0f0f0f, v91
    v_and_b32 v95, 0x0f0f0f, v95
    v_and_b32 v99, 0x0f0f0f, v99
    v_and_b32 v103, 0x0f0f0f, v103
    v_perm_b32 v152, v91, v88, s64
    v_perm_b32 v153, v91, v89, s65
    v_perm_b32 v154, v91, v90, s66
    v_perm_b32 v155, v95, v92, s64
    s_waitcnt lgkmcnt(4)
    v_add_u32_sdwa v188, v116, v117 dst_sel:DWORD dst_unused:UNUSED_PAD src0_sel:WORD_0 src1_sel:WORD_0
    v_add_u32_sdwa v116, v118, v119 dst_sel:DWORD dst_unused:UNUSED_PAD src0_sel:WORD_0 src1_sel:WORD_0
    v_add_u32 v188, v188, v116
    s_waitcnt lgkmcnt(3)
    v_add_u32_sdwa v189, v120, v121 dst_sel:DWORD dst_unused:UNUSED_PAD src0_sel:WORD_0 src1_sel:WORD_0
    v_add_u32_sdwa v120, v122, v123 dst_sel:DWORD dst_unused:UNUSED_PAD src0_sel:WORD_0 src1_sel:WORD_0
    v_add_u32 v189, v189, v120
    s_waitcnt lgkmcnt(2)
    v_add_u32_sdwa v190, v124, v125 dst_sel:DWORD dst_unused:UNUSED_PAD src0_sel:WORD_0 src1_sel:WORD_0
    v_add_u32_sdwa v124, v126, v127 dst_sel:DWORD dst_unused:UNUSED_PAD src0_sel:WORD_0 src1_sel:WORD_0
    v_add_u32 v190, v190, v124
    s_waitcnt lgkmcnt(1)
    v_add_u32_sdwa v191, v128, v129 dst_sel:DWORD dst_unused:UNUSED_PAD src0_sel:WORD_0 src1_sel:WORD_0
    v_add_u32_sdwa v128, v130, v131 dst_sel:DWORD dst_unused:UNUSED_PAD src0_sel:WORD_0 src1_sel:WORD_0
    v_add_u32 v191, v191, v128
    v_lshl_or_b32 v192, v189, 16, v188
    v_lshl_or_b32 v193, v191, 16, v190
    s_waitcnt lgkmcnt(0)
    v_perm_b32 v198, v195, v194, s67
    v_add_u32_dpp v192, v192, v192 row_shr:1 row_mask:0xf bank_mask:0xf bound_ctrl:0
    v_add_u32_dpp v193, v193, v193 row_shr:1 row_mask:0xf bank_mask:0xf bound_ctrl:0
    v_perm_b32 v156, v95, v93, s65
    v_add_u32_dpp v192, v192, v192 row_shr:2 row_mask:0xf bank_mask:0xf bound_ctrl:0
    v_add_u32_dpp v193, v193, v193 row_shr:2 row_mask:0xf bank_mask:0xf bound_ctrl:0
    v_perm_b32 v157, v95, v94, s66
    v_add_u32_dpp v192, v192, v192 row_shr:4 row_mask:0xf bank_mask:0xf bound_ctrl:0
    v_add_u32_dpp v193, v193, v193 row_shr:4 row_mask:0xf bank_mask:0xf bound_ctrl:0
    v_perm_b32 v158, v99, v96, s64
    v_add_u32_dpp v192, v192, v192 row_shr:8 row_mask:0xf bank_mask:0xf bound_ctrl:0
    v_add_u32_dpp v193, v193, v193 row_shr:8 row_mask:0xf bank_mask:0xf bound_ctrl:0
    v_perm_b32 v159, v99, v97, s65
    v_add_u32_dpp v192, v192, v192 row_bcast:15 row_mask:0xa bank_mask:0xf
    v_add_u32_dpp v193, v193, v193 row_bcast:15 row_mask:0xa bank_mask:0xf
    v_perm_b32 v160, v99, v98, s66
    v_add_u32_dpp v192, v192, v192 row_bcast:31 row_mask:0xc bank_mask:0xf
    v_add_u32_dpp v193, v193, v193 row_bcast:31 row_mask:0xc bank_mask:0xf
    v_perm_b32 v161, v103, v100, s64
    v_readlane_b32 s10, v192, 63
    v_readlane_b32 s11, v193, 63
    v_lshlrev_b32_sdwa v116, v169, v192 dst_sel:DWORD dst_unused:UNUSED_PAD src0_sel:DWORD src1_sel:WORD_0
    v_sub_u32 v188, v116, v188
    v_lshlrev_b32_sdwa v117, v169, v192 dst_sel:DWORD dst_unused:UNUSED_PAD src0_sel:DWORD src1_sel:WORD_1
    v_sub_u32 v189, v117, v189
    v_lshlrev_b32_sdwa v118, v169, v193 dst_sel:DWORD dst_unused:UNUSED_PAD src0_sel:DWORD src1_sel:WORD_0
    v_sub_u32 v190, v118, v190
    v_lshlrev_b32_sdwa v119, v169, v193 dst_sel:DWORD dst_unused:UNUSED_PAD src0_sel:DWORD src1_sel:WORD_1
    v_sub_u32 v191, v119, v191
    s_and_b32 s4, s10, 0xffff
    s_lshr_b32 s10, s10, 16
    s_add_u32 s5, s4, s10
    s_and_b32 s10, s11, 0xffff
    s_add_u32 s6, s5, s10
    s_lshr_b32 s11, s11, 16
    s_add_u32 s10, s6, s11
    v_lshl_add_u32 v189, s4, 1, v189
    v_lshl_add_u32 v190, s5, 1, v190
    v_lshl_add_u32 v191, s6, 1, v191
    s_sub_i32 s37, 12928, s10
    s_ashr_i32 s37, s37, 7
    s_max_i32 s37, s37, 1
    s_min_i32 s37, s37, 4
    s_lshr_b32 s11, s10, 5
    s_add_u32 s11, s11, 16
    s_and_b32 s11, s11, -32
    s_cmp_ge_i32 s37, 1
    s_cselect_b32 s13, 42, 10
    s_sub_i32 s11, s11, s13
    s_lshl_b32 s11, s11, 3
    s_lshr_b32 s10, s10, 1
    s_lshr_b32 s13, s3, 1
    s_mul_i32 s13, s13, s10
    s_add_i32 s11, s11, s13
    s_add_i32 s10, s10, s13
    s_bitcmp1_b32 s3, 0
    s_cselect_b32 s15, s11, s13
    s_cselect_b32 s10, s10, s11
    s_mov_b32 s13, 0
    s_mov_b32 s14, 0
    v_cmp_gt_i32 vcc, s15, v188
    v_cmp_gt_i32 s[86:87], s10, v188
    s_bcnt1_i32_b64 s11, vcc
    s_add_u32 s13, s13, s11
    s_bcnt1_i32_b64 s11, s[86:87]
    s_add_u32 s14, s14, s11
    v_cmp_gt_i32 vcc, s15, v189
    v_cmp_gt_i32 s[86:87], s10, v189
    s_bcnt1_i32_b64 s11, vcc
    s_add_u32 s13, s13, s11
    s_bcnt1_i32_b64 s11, s[86:87]
    s_add_u32 s14, s14, s11
    v_cmp_gt_i32 vcc, s15, v190
    v_cmp_gt_i32 s[86:87], s10, v190
    s_bcnt1_i32_b64 s11, vcc
    s_add_u32 s13, s13, s11
    s_bcnt1_i32_b64 s11, s[86:87]
    s_add_u32 s14, s14, s11
    v_cmp_gt_i32 vcc, s15, v191
    v_cmp_gt_i32 s[86:87], s10, v191
    s_bcnt1_i32_b64 s11, vcc
    s_add_u32 s13, s13, s11
    s_bcnt1_i32_b64 s11, s[86:87]
    s_add_u32 s14, s14, s11
    s_max_i32 s13, s13, s72
    s_min_i32 s13, s13, s73
    s_max_i32 s14, s14, s84
    s_min_i32 s14, s14, s85
    v_cmp_le_u32 vcc, s13, v199
    v_cmp_gt_u32 s[10:11], s14, v199
    s_nop 0
    s_and_b64 vcc, vcc, s[10:11]
    v_cndmask_b32 v198, 0, v198, vcc
    v_mov_b32 v196, v198
    v_perm_b32 v162, v103, v101, s65
    v_perm_b32 v163, v103, v102, s66
    v_add_u32_dpp v196, v196, v196 row_shr:1 row_mask:0xf bank_mask:0xf bound_ctrl:0
    v_lshl_add_u32 v152, v152, 5, v208
    v_lshl_add_u32 v153, v153, 5, v208
    v_add_u32_dpp v196, v196, v196 row_shr:2 row_mask:0xf bank_mask:0xf bound_ctrl:0
    v_lshl_add_u32 v154, v154, 5, v208
    v_lshl_add_u32 v155, v155, 5, v209
    v_add_u32_dpp v196, v196, v196 row_shr:4 row_mask:0xf bank_mask:0xf bound_ctrl:0
    v_lshl_add_u32 v156, v156, 5, v209
    v_lshl_add_u32 v157, v157, 5, v209
    v_add_u32_dpp v196, v196, v196 row_shr:8 row_mask:0xf bank_mask:0xf bound_ctrl:0
    v_lshl_add_u32 v158, v158, 5, v210
    v_lshl_add_u32 v159, v159, 5, v210
    v_add_u32_dpp v196, v196, v196 row_bcast:15 row_mask:0xa bank_mask:0xf
    v_lshl_add_u32 v160, v160, 5, v210
    v_lshl_add_u32 v161, v161, 5, v211
    v_lshl_add_u32 v162, v162, 5, v211
    v_lshl_add_u32 v163, v163, 5, v211
    s_sub_u32 s86, s76, 9728
    v_readlane_b32 s10, v196, 31
    v_readlane_b32 s11, v196, 63
    v_sub_u32 v196, v196, v198
    v_mov_b32 v253, v202
    s_and_b32 s4, s10, 0xffff
    s_lshr_b32 s10, s10, 16
    s_add_u32 s5, s4, s10
    s_and_b32 s10, s11, 0xffff
    s_add_u32 s6, s5, s10
    s_lshr_b32 s11, s11, 16
    s_add_u32 s15, s6, s11
    s_lshl_b32 s10, s4, 16
    s_pack_ll_b32_b16 s11, s5, s6
    s_pack_ll_b32_b16 s86, s86, s86
    s_add_u32 s10, s10, s86
    s_add_u32 s11, s11, s86
    s_mov_b32 exec_lo, vcc_lo
    s_mov_b32 exec_hi, 0
    v_add_u32 v196, s10, v196
    s_mov_b32 exec_lo, 0
    s_mov_b32 exec_hi, vcc_hi
    v_add_u32 v196, s11, v196
    s_mov_b64 exec, vcc
    ds_write_b16 v200, v196 offset:2306
    ds_write_b16_d16_hi v200, v196 offset:2310
    ds_write_b32 v213, v212 offset:6400
    s_mov_b64 exec, -1
    v_mov_b32 v197, 2176
    s_cmp_le_u32 s15, 2176
    s_cbranch_scc1 K2_LFIT
    ds_write_b32 v197, v197
    s_mov_b32 s15, 0
K2_LFIT:
    s_add_u32 s15, s15, s76
    s_add_i32 s4, s4, 64
    s_lshr_b32 s4, s4, 7
    s_add_i32 s5, s5, 64
    s_lshr_b32 s5, s5, 7
    s_add_i32 s6, s6, 64
    s_lshr_b32 s6, s6, 7
    v_mov_b32 v190, 0xffff0000
    v_or_b32 v189, s39, v190
    v_mov_b32 v190, 0x7fffff00
    v_lshl_add_u32 v188, v254, 2, s15
    s_sub_u32 s73, s15, s76
    ds_write2st64_b32 v188, v189, v190 offset0:0 offset1:84
    ds_write2st64_b32 v188, v189, v190 offset0:1 offset1:85
    s_add_u32 s73, s73, 127
    s_lshr_b32 s73, s73, 7
    s_sub_i32 s38, s73, 1
    v_mov_b32 v188, s15
    ds_write_b32 v212, v188 offset:2112
    s_waitcnt lgkmcnt(0)
    s_barrier
    ds_read_b64 v[194:195], v197
    s_mov_b64 exec, s[40:41]
    ds_read_u16 v104, v104 offset:2306
    s_mov_b64 exec, s[42:43]
    ds_read_u16 v105, v105 offset:2306
    s_mov_b64 exec, s[44:45]
    ds_read_u16 v106, v106 offset:2306
    s_mov_b64 exec, s[46:47]
    ds_read_u16 v107, v107 offset:2306
    s_mov_b64 exec, s[48:49]
    ds_read_u16 v108, v108 offset:2306
    s_mov_b64 exec, s[50:51]
    ds_read_u16 v109, v109 offset:2306
    s_mov_b64 exec, s[52:53]
    ds_read_u16 v110, v110 offset:2306
    s_mov_b64 exec, s[54:55]
    ds_read_u16 v111, v111 offset:2306
    s_mov_b64 exec, s[56:57]
    ds_read_u16 v112, v112 offset:2306
    s_mov_b64 exec, s[58:59]
    ds_read_u16 v113, v113 offset:2306
    s_mov_b64 exec, s[60:61]
    ds_read_u16 v114, v114 offset:2306
    s_mov_b64 exec, s[62:63]
    ds_read_u16 v115, v115 offset:2306
    s_mov_b64 exec, -1
    s_waitcnt lgkmcnt(0)
    v_readfirstlane_b32 s83, v194
    v_readfirstlane_b32 s80, v195
    v_add_u32 v104, v104, v220
    v_add_u32 v105, v105, v221
    v_add_u32 v106, v106, v222
    v_add_u32 v107, v107, v223
    v_add_u32 v108, v108, v224
    v_add_u32 v109, v109, v225
    v_add_u32 v110, v110, v226
    v_add_u32 v111, v111, v227
    v_add_u32 v112, v112, v228
    v_add_u32 v113, v113, v229
    v_add_u32 v114, v114, v230
    v_add_u32 v115, v115, v231
    s_cmp_gt_u32 s83, 64
    s_cbranch_scc1 K2_OVF
    s_mov_b64 exec, s[40:41]
    ds_write2st64_b32 v104, v88, v152 offset0:38 offset1:122
    s_mov_b64 exec, s[42:43]
    ds_write2st64_b32 v105, v89, v153 offset0:38 offset1:122
    s_mov_b64 exec, s[44:45]
    ds_write2st64_b32 v106, v90, v154 offset0:38 offset1:122
    s_mov_b64 exec, s[46:47]
    ds_write2st64_b32 v107, v92, v155 offset0:38 offset1:122
    s_mov_b64 exec, s[48:49]
    ds_write2st64_b32 v108, v93, v156 offset0:38 offset1:122
    s_mov_b64 exec, s[50:51]
    ds_write2st64_b32 v109, v94, v157 offset0:38 offset1:122
    s_mov_b64 exec, s[52:53]
    ds_write2st64_b32 v110, v96, v158 offset0:38 offset1:122
    s_mov_b64 exec, s[54:55]
    ds_write2st64_b32 v111, v97, v159 offset0:38 offset1:122
    s_mov_b64 exec, s[56:57]
    ds_write2st64_b32 v112, v98, v160 offset0:38 offset1:122
    s_mov_b64 exec, s[58:59]
    ds_write2st64_b32 v113, v100, v161 offset0:38 offset1:122
    s_mov_b64 exec, s[60:61]
    ds_write2st64_b32 v114, v101, v162 offset0:38 offset1:122
    s_mov_b64 exec, s[62:63]
    ds_write2st64_b32 v115, v102, v163 offset0:38 offset1:122
    s_mov_b64 exec, -1
K2_PADS0:
    s_add_u32 s10, s37, 2
    s_cmp_gt_u32 s73, s10
    s_cselect_b32 s1, s3, 0
    s_waitcnt lgkmcnt(0)
    s_barrier
    s_bitcmp1_b32 s1, 0
    s_cbranch_scc1 K2_EARLY
    s_waitcnt vmcnt(0)
    s_branch K2_LATE0
K2_EARLY:
    ds_read_b128 v[236:239], v247
    ds_read_b32 v240, v251
    ds_read_u8 v250, v249
    s_waitcnt lgkmcnt(1)
    s_add_u32 m0, s74, 0
    v_mad_u32_u16 v236, v236, s75, v241 op_sel:[1,0,0,0]
    buffer_load_dwordx4 v236, s[16:19], 0 offen lds
    s_add_u32 m0, s74, 1040
    v_mad_u32_u16 v237, v237, s75, v241 op_sel:[1,0,0,0]
    buffer_load_dwordx4 v237, s[16:19], 0 offen lds
    s_add_u32 m0, s74, 2080
    v_mad_u32_u16 v238, v238, s75, v241 op_sel:[1,0,0,0]
    buffer_load_dwordx4 v238, s[16:19], 0 offen lds
    s_add_u32 m0, s74, 3120
    v_mad_u32_u16 v239, v239, s75, v241 op_sel:[1,0,0,0]
    buffer_load_dwordx4 v239, s[16:19], 0 offen lds
    s_add_u32 m0, s74, 4160
    v_add_u32 v240, v240, v242
    buffer_load_dwordx4 v240, s[20:23], 0 offen lds
K2_LATE0:
    s_waitcnt vmcnt(5)
    s_cmp_lg_u32 s97, 0
    s_cbranch_scc1 K2_XT2
K2_XT2R:
    ds_read_b128 v[152:155], v235 offset:0
    ds_read_b128 v[156:159], v235 offset:16
    ds_read_b128 v[160:163], v235 offset:32
    ds_read_b128 v[164:167], v235 offset:48
    v_add_u32 v172, 8192, v172
    ds_read_b128 v[88:91], v172 offset:52736
    ds_read_b128 v[92:95], v172 offset:53760
    ds_read_b128 v[96:99], v172 offset:54784
    ds_read_b128 v[100:103], v172 offset:55808
    ds_read_b128 v[104:107], v172 offset:56832
    ds_read_b128 v[108:111], v172 offset:57856
    ds_read_b128 v[112:115], v172 offset:58880
    ds_read_b128 v[116:119], v172 offset:59904
    s_mov_b32 s10, 0x358637bd
    s_mov_b32 s11, s10
    v_mfma_f32_32x32x16_bf16 v[136:151], v[180:183], v[180:183], 0
    v_mov_b64 v[120:121], s[10:11]
    v_mov_b64 v[122:123], s[10:11]
    v_mov_b64 v[124:125], s[10:11]
    v_mov_b64 v[126:127], s[10:11]
    v_mov_b64 v[128:129], s[10:11]
    v_mov_b64 v[130:131], s[10:11]
    v_mov_b64 v[132:133], s[10:11]
    v_mov_b64 v[134:135], s[10:11]
    s_waitcnt lgkmcnt(7)
    v_mfma_f32_32x32x16_bf16 v[188:203], v[152:155], v[88:91], 0
    s_waitcnt lgkmcnt(6)
    v_mfma_f32_32x32x16_bf16 v[188:203], v[156:159], v[92:95], v[188:203]
    s_waitcnt lgkmcnt(5)
    v_mfma_f32_32x32x16_bf16 v[188:203], v[160:163], v[96:99], v[188:203]
    s_waitcnt lgkmcnt(4)
    v_mfma_f32_32x32x16_bf16 v[188:203], v[164:167], v[100:103], v[188:203]
    s_waitcnt lgkmcnt(3)
    v_mfma_f32_32x32x16_bf16 v[204:219], v[152:155], v[104:107], 0
    s_waitcnt lgkmcnt(2)
    v_mfma_f32_32x32x16_bf16 v[204:219], v[156:159], v[108:111], v[204:219]
    s_waitcnt lgkmcnt(1)
    v_mfma_f32_32x32x16_bf16 v[204:219], v[160:163], v[112:115], v[204:219]
    s_waitcnt lgkmcnt(0)
    v_mfma_f32_32x32x16_bf16 v[204:219], v[164:167], v[116:119], v[204:219]
    v_mfma_f32_32x32x16_bf16 v[104:119], v[180:183], v[180:183], 0
    v_mov_b64 v[88:89], s[10:11]
    v_mov_b64 v[90:91], s[10:11]
    v_mov_b64 v[92:93], s[10:11]
    v_mov_b64 v[94:95], s[10:11]
    v_mov_b64 v[96:97], s[10:11]
    v_mov_b64 v[98:99], s[10:11]
    v_mov_b64 v[100:101], s[10:11]
    v_mov_b64 v[102:103], s[10:11]
    s_mov_b32 s10, 0xbfb8aa3b
    v_mul_f32 v188, s10, v188
    v_mul_f32 v189, s10, v189
    v_mul_f32 v190, s10, v190
    v_mul_f32 v191, s10, v191
    v_mul_f32 v192, s10, v192
    v_mul_f32 v193, s10, v193
    v_mul_f32 v194, s10, v194
    v_mul_f32 v195, s10, v195
    v_mul_f32 v196, s10, v196
    v_mul_f32 v197, s10, v197
    v_mul_f32 v198, s10, v198
    v_mul_f32 v199, s10, v199
    v_mul_f32 v200, s10, v200
    v_mul_f32 v201, s10, v201
    v_mul_f32 v202, s10, v202
    v_mul_f32 v203, s10, v203
    v_mul_f32 v204, s10, v204
    v_mul_f32 v205, s10, v205
    v_mul_f32 v206, s10, v206
    v_mul_f32 v207, s10, v207
    v_mul_f32 v208, s10, v208
    v_mul_f32 v209, s10, v209
    v_mul_f32 v210, s10, v210
    v_mul_f32 v211, s10, v211
    v_mul_f32 v212, s10, v212
    v_mul_f32 v213, s10, v213
    v_mul_f32 v214, s10, v214
    v_mul_f32 v215, s10, v215
    v_mul_f32 v216, s10, v216
    v_mul_f32 v217, s10, v217
    v_mul_f32 v218, s10, v218
    v_mul_f32 v219, s10, v219
    v_cvt_pk_bf16_f32 v72, v188, v189
    v_cvt_pk_bf16_f32 v73, v190, v191
    v_cvt_pk_bf16_f32 v74, v192, v193
    v_cvt_pk_bf16_f32 v75, v194, v195
    v_cvt_pk_bf16_f32 v76, v196, v197
    v_cvt_pk_bf16_f32 v77, v198, v199
    v_cvt_pk_bf16_f32 v78, v200, v201
    v_cvt_pk_bf16_f32 v79, v202, v203
    v_cvt_pk_bf16_f32 v80, v204, v205
    v_cvt_pk_bf16_f32 v81, v206, v207
    v_cvt_pk_bf16_f32 v82, v208, v209
    v_cvt_pk_bf16_f32 v83, v210, v211
    v_cvt_pk_bf16_f32 v84, v212, v213
    v_cvt_pk_bf16_f32 v85, v214, v215
    v_cvt_pk_bf16_f32 v86, v216, v217
    v_cvt_pk_bf16_f32 v87, v218, v219
    s_mov_b32 s79, -1
    s_mov_b64 s[84:85], 0
    s_mov_b32 s81, 0
    s_mov_b32 s82, 0
    s_cmp_lg_u32 s80, 0
    s_cselect_b32 s78, 1, 0
    s_bitcmp1_b32 s1, 0
    s_cbranch_scc1 K2_HAD0
    s_barrier
    s_mov_b32 s37, -1
    s_cmp_eq_u32 s83, 0
    s_cbranch_scc1 K2_NEy
    s_lshl_b32 s10, s3, 2
    v_mov_b32 v178, s10
    ds_read_b32 v178, v178 offset:2112
    s_waitcnt lgkmcnt(0)
    v_readfirstlane_b32 s15, v178
    s_nop 3
    s_sub_u32 s73, s15, s76
    s_add_u32 s73, s73, 127
    s_lshr_b32 s73, s73, 7
    s_sub_i32 s38, s73, 1
K2_NEy:
K2_GO:
    ds_read_b128 v[236:239], v247
    ds_read_b32 v240, v251
    ds_read_u8 v250, v249
    s_waitcnt lgkmcnt(1)
    s_add_u32 m0, s74, 0
    v_mad_u32_u16 v236, v236, s75, v241 op_sel:[1,0,0,0]
    buffer_load_dwordx4 v236, s[16:19], 0 offen lds
    s_add_u32 m0, s74, 1040
    v_mad_u32_u16 v237, v237, s75, v241 op_sel:[1,0,0,0]
    buffer_load_dwordx4 v237, s[16:19], 0 offen lds
    s_add_u32 m0, s74, 2080
    v_mad_u32_u16 v238, v238, s75, v241 op_sel:[1,0,0,0]
    buffer_load_dwordx4 v238, s[16:19], 0 offen lds
    s_add_u32 m0, s74, 3120
    v_mad_u32_u16 v239, v239, s75, v241 op_sel:[1,0,0,0]
    buffer_load_dwordx4 v239, s[16:19], 0 offen lds
    s_add_u32 m0, s74, 4160
    v_add_u32 v240, v240, v242
    buffer_load_dwordx4 v240, s[20:23], 0 offen lds
K2_HAD0:
    s_waitcnt lgkmcnt(0)
    v_lshl_add_u32 v250, v250, 6, v245
    ds_read_b128 v[236:239], v247 offset:128
    ds_read_b32 v240, v251 offset:128
    ds_read_b128 v[172:175], v250 offset:7424
    ds_read_b32 v176, v250 offset:7440
    v_mfma_f32_32x32x16_bf16 v[204:219], v[180:183], v[180:183], 0
    s_waitcnt vmcnt(0)
    ds_read_b128 v[168:171], v244
    ds_read_b128 v[152:155], v243 offset:0
    ds_read_b128 v[156:159], v243 offset:16
    ds_read_b128 v[160:163], v243 offset:32
    ds_read_b128 v[164:167], v243 offset:48
    s_waitcnt lgkmcnt(0)
    s_cmp_eq_u32 s73, 0
    s_cbranch_scc1 K2_DONE
    v_mfma_f32_32x32x16_bf16 v[188:203], v[168:171], v[64:67], 0
    v_mfma_f32_32x32x16_bf16 v[188:203], v[152:155], v[0:3], v[188:203]
    v_mfma_f32_32x32x16_bf16 v[188:203], v[156:159], v[4:7], v[188:203]
    v_mfma_f32_32x32x16_bf16 v[188:203], v[160:163], v[8:11], v[188:203]
    v_mfma_f32_32x32x16_bf16 v[188:203], v[164:167], v[12:15], v[188:203]
    s_add_u32 m0, s74, 0
    v_mad_u32_u16 v236, v236, s75, v241 op_sel:[1,0,0,0]
    buffer_load_dwordx4 v236, s[16:19], 0 offen lds
    s_add_u32 m0, s74, 1040
    v_mad_u32_u16 v237, v237, s75, v241 op_sel:[1,0,0,0]
    buffer_load_dwordx4 v237, s[16:19], 0 offen lds
    s_add_u32 m0, s74, 2080
    v_mad_u32_u16 v238, v238, s75, v241 op_sel:[1,0,0,0]
    buffer_load_dwordx4 v238, s[16:19], 0 offen lds
    s_add_u32 m0, s74, 3120
    v_mad_u32_u16 v239, v239, s75, v241 op_sel:[1,0,0,0]
    buffer_load_dwordx4 v239, s[16:19], 0 offen lds
    s_add_u32 m0, s74, 4160
    v_add_u32 v240, v240, v242
    buffer_load_dwordx4 v240, s[20:23], 0 offen lds
    v_smfmac_f32_32x32x32_bf16 v[188:203], v[172:175], v[72:79], v176
    s_mov_b32 s72, 0
    s_sub_u32 s10, s73, 1
    s_bitcmp1_b32 s3, 0
    s_cselect_b32 s6, s6, s10
    s_setprio 3
    s_mov_b32 s87, s73
    s_cmp_gt_i32 s4, s72
    s_cselect_b32 s10, s4, s87
    s_min_u32 s87, s87, s10
    s_cmp_gt_i32 s5, s72
    s_cselect_b32 s10, s5, s87
    s_min_u32 s87, s87, s10
    s_cmp_gt_i32 s6, s72
    s_cselect_b32 s10, s6, s87
    s_min_u32 s87, s87, s10
    s_cmp_gt_i32 s37, s72
    s_cselect_b32 s10, s37, s87
    s_min_u32 s87, s87, s10
    s_cmp_gt_i32 s38, s72
    s_cselect_b32 s10, s38, s87
    s_min_u32 s87, s87, s10
.p2align 6
K2_LOOP:
    v_smfmac_f32_32x32x32_bf16 v[136:151], v[180:183], v[204:211], v177
    ds_read_u8 v236, v248 offset:0
    ds_read_u8 v237, v248 offset:16
    ds_read_u8 v238, v248 offset:64
    ds_read_u8 v239, v248 offset:80
    ds_read_u8 v250, v249 offset:128
    v_exp_f32 v188, v188
    v_exp_f32 v189, v189
    v_exp_f32 v190, v190
    v_add_f32 v188, 1.0, v188
    v_smfmac_f32_32x32x32_bf16 v[136:151], v[184:187], v[212:219], v177
    v_exp_f32 v191, v191
    v_add_f32 v189, 1.0, v189
    v_exp_f32 v192, v192
    v_add_f32 v190, 1.0, v190
    v_rcp_f32 v188, v188
    v_mfma_f32_32x32x16_bf16 v[220:235], v[168:171], v[68:71], 0
    v_exp_f32 v193, v193
    v_add_f32 v191, 1.0, v191
    v_rcp_f32 v189, v189
    v_exp_f32 v194, v194
    v_mfma_f32_32x32x16_bf16 v[204:219], v[152:155], v[32:35], 0
    v_add_f32 v192, 1.0, v192
    v_rcp_f32 v190, v190
    v_exp_f32 v195, v195
    v_mfma_f32_32x32x16_bf16 v[204:219], v[156:159], v[36:39], v[204:219]
    s_waitcnt lgkmcnt(0)
    v_lshl_add_u32 v236, v236, 6, v246
    v_lshl_add_u32 v237, v237, 6, v246
    v_lshl_add_u32 v238, v238, 6, v246
    v_lshl_add_u32 v239, v239, 6, v246
    v_lshl_add_u32 v250, v250, 6, v245
    v_add_f32 v193, 1.0, v193
    v_rcp_f32 v191, v191
    v_exp_f32 v196, v196
    v_add_f32 v194, 1.0, v194
    v_rcp_f32 v192, v192
    v_smfmac_f32_32x32x32_bf16 v[220:235], v[172:175], v[80:87], v176
    ds_read_b64_tr_b16 v[180:181], v236
    ds_read_b64_tr_b16 v[182:183], v237
    ds_read_b64_tr_b16 v[184:185], v238
    ds_read_b64_tr_b16 v[186:187], v239
    ds_read_b128 v[172:175], v250 offset:7424
    ds_read_b32 v176, v250 offset:7440
    v_exp_f32 v197, v197
    v_add_f32 v195, 1.0, v195
    v_rcp_f32 v193, v193
    v_exp_f32 v198, v198
    v_mfma_f32_32x32x16_bf16 v[204:219], v[160:163], v[40:43], v[204:219]
    v_add_f32 v196, 1.0, v196
    v_rcp_f32 v194, v194
    v_exp_f32 v199, v199
    v_add_f32 v197, 1.0, v197
    v_mfma_f32_32x32x16_bf16 v[204:219], v[164:167], v[44:47], v[204:219]
    v_rcp_f32 v195, v195
    v_exp_f32 v200, v200
    v_add_f32 v198, 1.0, v198
    v_rcp_f32 v196, v196
    v_mfma_f32_32x32x16_bf16 v[220:235], v[152:155], v[16:19], v[220:235]
    ds_read_b128 v[236:239], v247 offset:256
    ds_read_b32 v240, v251 offset:256
    s_add_u32 s72, s72, 1
    v_exp_f32 v201, v201
    v_add_f32 v199, 1.0, v199
    v_rcp_f32 v197, v197
    v_exp_f32 v202, v202
    v_mfma_f32_32x32x16_bf16 v[220:235], v[156:159], v[20:23], v[220:235]
    v_add_f32 v200, 1.0, v200
    v_rcp_f32 v198, v198
    v_exp_f32 v203, v203
    v_add_f32 v201, 1.0, v201
    v_mfma_f32_32x32x16_bf16 v[220:235], v[160:163], v[24:27], v[220:235]
    v_rcp_f32 v199, v199
    v_add_f32 v202, 1.0, v202
    v_rcp_f32 v200, v200
    v_add_f32 v203, 1.0, v203
    v_rcp_f32 v201, v201
    v_mfma_f32_32x32x16_bf16 v[220:235], v[164:167], v[28:31], v[220:235]
    v_rcp_f32 v202, v202
    v_rcp_f32 v203, v203
    v_mul_f32 v204, v188, v204
    v_mul_f32 v205, v189, v205
    s_waitcnt lgkmcnt(0)
    v_smfmac_f32_32x32x32_bf16 v[88:103], v[180:183], v[188:195], v177
    v_mul_f32 v206, v190, v206
    v_mul_f32 v207, v191, v207
    v_mul_f32 v208, v192, v208
    v_mul_f32 v209, v193, v209
    v_mul_f32 v210, v194, v210
    v_mul_f32 v211, v195, v211
    v_mul_f32 v212, v196, v212
    v_smfmac_f32_32x32x32_bf16 v[88:103], v[184:187], v[196:203], v177
    v_mul_f32 v213, v197, v213
    v_mul_f32 v214, v198, v214
    v_mul_f32 v215, v199, v215
    v_mul_f32 v216, v200, v216
    v_mul_f32 v217, v201, v217
    v_mul_f32 v218, v202, v218
    v_mul_f32 v219, v203, v219
    v_smfmac_f32_32x32x32_bf16 v[104:119], v[180:183], v[204:211], v177
    s_waitcnt vmcnt(0)
    ds_read_b128 v[168:171], v244
    v_exp_f32 v220, v220
    v_exp_f32 v221, v221
    v_exp_f32 v222, v222
    v_add_f32 v220, 1.0, v220
    v_smfmac_f32_32x32x32_bf16 v[104:119], v[184:187], v[212:219], v177
    v_exp_f32 v223, v223
    v_add_f32 v221, 1.0, v221
    v_exp_f32 v224, v224
    v_add_f32 v222, 1.0, v222
    v_rcp_f32 v220, v220
    s_waitcnt lgkmcnt(0)
    v_mfma_f32_32x32x16_bf16 v[188:203], v[168:171], v[64:67], 0
    v_exp_f32 v225, v225
    v_add_f32 v223, 1.0, v223
    v_rcp_f32 v221, v221
    v_exp_f32 v226, v226
    v_mfma_f32_32x32x16_bf16 v[204:219], v[152:155], v[48:51], 0
    ds_read_b128 v[152:155], v243 offset:0
    v_add_f32 v224, 1.0, v224
    v_rcp_f32 v222, v222
    v_exp_f32 v227, v227
    v_mfma_f32_32x32x16_bf16 v[204:219], v[156:159], v[52:55], v[204:219]
    ds_read_b128 v[156:159], v243 offset:16
    v_add_f32 v225, 1.0, v225
    v_rcp_f32 v223, v223
    v_exp_f32 v228, v228
    v_add_f32 v226, 1.0, v226
    v_rcp_f32 v224, v224
    v_smfmac_f32_32x32x32_bf16 v[188:203], v[172:175], v[72:79], v176
    v_exp_f32 v229, v229
    v_add_f32 v227, 1.0, v227
    v_rcp_f32 v225, v225
    v_exp_f32 v230, v230
    v_mfma_f32_32x32x16_bf16 v[204:219], v[160:163], v[56:59], v[204:219]
    ds_read_b128 v[160:163], v243 offset:32
    v_add_f32 v228, 1.0, v228
    v_rcp_f32 v226, v226
    v_exp_f32 v231, v231
    v_add_f32 v229, 1.0, v229
    v_mfma_f32_32x32x16_bf16 v[204:219], v[164:167], v[60:63], v[204:219]
    ds_read_b128 v[164:167], v243 offset:48
    v_rcp_f32 v227, v227
    v_exp_f32 v232, v232
    v_add_f32 v230, 1.0, v230
    v_rcp_f32 v228, v228
    s_waitcnt lgkmcnt(3)
    v_mfma_f32_32x32x16_bf16 v[188:203], v[152:155], v[0:3], v[188:203]
    v_exp_f32 v233, v233
    v_add_f32 v231, 1.0, v231
    v_rcp_f32 v229, v229
    v_exp_f32 v234, v234
    s_waitcnt lgkmcnt(2)
    v_mfma_f32_32x32x16_bf16 v[188:203], v[156:159], v[4:7], v[188:203]
    v_add_f32 v232, 1.0, v232
    v_rcp_f32 v230, v230
    v_exp_f32 v235, v235
    v_add_f32 v233, 1.0, v233
    s_waitcnt lgkmcnt(1)
    v_mfma_f32_32x32x16_bf16 v[188:203], v[160:163], v[8:11], v[188:203]
    v_rcp_f32 v231, v231
    v_add_f32 v234, 1.0, v234
    v_rcp_f32 v232, v232
    v_add_f32 v235, 1.0, v235
    v_rcp_f32 v233, v233
    s_waitcnt lgkmcnt(0)
    v_mfma_f32_32x32x16_bf16 v[188:203], v[164:167], v[12:15], v[188:203]
    s_cmp_lt_i32 s72, s38
    s_cbranch_scc0 K2_ND_0
    s_add_u32 m0, s74, 0
    v_mad_u32_u16 v236, v236, s75, v241 op_sel:[1,0,0,0]
    buffer_load_dwordx4 v236, s[16:19], 0 offen lds
    s_add_u32 m0, s74, 1040
    v_mad_u32_u16 v237, v237, s75, v241 op_sel:[1,0,0,0]
    buffer_load_dwordx4 v237, s[16:19], 0 offen lds
    s_add_u32 m0, s74, 2080
    v_mad_u32_u16 v238, v238, s75, v241 op_sel:[1,0,0,0]
    buffer_load_dwordx4 v238, s[16:19], 0 offen lds
    s_add_u32 m0, s74, 3120
    v_mad_u32_u16 v239, v239, s75, v241 op_sel:[1,0,0,0]
    buffer_load_dwordx4 v239, s[16:19], 0 offen lds
    s_add_u32 m0, s74, 4160
    v_add_u32 v240, v240, v242
    buffer_load_dwordx4 v240, s[20:23], 0 offen lds
K2_ND_0:
    v_rcp_f32 v234, v234
    v_rcp_f32 v235, v235
    v_mul_f32 v204, v220, v204
    v_mul_f32 v205, v221, v205
    v_smfmac_f32_32x32x32_bf16 v[120:135], v[180:183], v[220:227], v177
    v_mul_f32 v206, v222, v206
    v_mul_f32 v207, v223, v207
    v_mul_f32 v208, v224, v208
    v_mul_f32 v209, v225, v209
    v_mul_f32 v210, v226, v210
    v_mul_f32 v211, v227, v211
    v_mul_f32 v212, v228, v212
    v_smfmac_f32_32x32x32_bf16 v[120:135], v[184:187], v[228:235], v177
    v_mul_f32 v213, v229, v213
    v_mul_f32 v214, v230, v214
    v_mul_f32 v215, v231, v215
    v_mul_f32 v216, v232, v216
    v_mul_f32 v217, v233, v217
    v_mul_f32 v218, v234, v218
    v_mul_f32 v219, v235, v219
    s_cmp_ge_u32 s72, s87
    s_cbranch_scc1 K2_EV0
K2_EVR0:
    v_smfmac_f32_32x32x32_bf16 v[136:151], v[180:183], v[204:211], v177
    ds_read_u8 v236, v248 offset:128
    ds_read_u8 v237, v248 offset:144
    ds_read_u8 v238, v248 offset:192
    ds_read_u8 v239, v248 offset:208
    ds_read_u8 v250, v249 offset:256
    v_exp_f32 v188, v188
    v_exp_f32 v189, v189
    v_exp_f32 v190, v190
    v_add_f32 v188, 1.0, v188
    v_smfmac_f32_32x32x32_bf16 v[136:151], v[184:187], v[212:219], v177
    v_exp_f32 v191, v191
    v_add_f32 v189, 1.0, v189
    v_exp_f32 v192, v192
    v_add_f32 v190, 1.0, v190
    v_rcp_f32 v188, v188
    v_mfma_f32_32x32x16_bf16 v[220:235], v[168:171], v[68:71], 0
    v_exp_f32 v193, v193
    v_add_f32 v191, 1.0, v191
    v_rcp_f32 v189, v189
    v_exp_f32 v194, v194
    v_mfma_f32_32x32x16_bf16 v[204:219], v[152:155], v[32:35], 0
    v_add_f32 v192, 1.0, v192
    v_rcp_f32 v190, v190
    v_exp_f32 v195, v195
    v_mfma_f32_32x32x16_bf16 v[204:219], v[156:159], v[36:39], v[204:219]
    s_waitcnt lgkmcnt(0)
    v_lshl_add_u32 v236, v236, 6, v246
    v_lshl_add_u32 v237, v237, 6, v246
    v_lshl_add_u32 v238, v238, 6, v246
    v_lshl_add_u32 v239, v239, 6, v246
    v_lshl_add_u32 v250, v250, 6, v245
    v_add_f32 v193, 1.0, v193
    v_rcp_f32 v191, v191
    v_exp_f32 v196, v196
    v_add_f32 v194, 1.0, v194
    v_rcp_f32 v192, v192
    v_smfmac_f32_32x32x32_bf16 v[220:235], v[172:175], v[80:87], v176
    ds_read_b64_tr_b16 v[180:181], v236
    ds_read_b64_tr_b16 v[182:183], v237
    ds_read_b64_tr_b16 v[184:185], v238
    ds_read_b64_tr_b16 v[186:187], v239
    ds_read_b128 v[172:175], v250 offset:7424
    ds_read_b32 v176, v250 offset:7440
    v_exp_f32 v197, v197
    v_add_f32 v195, 1.0, v195
    v_rcp_f32 v193, v193
    v_exp_f32 v198, v198
    v_mfma_f32_32x32x16_bf16 v[204:219], v[160:163], v[40:43], v[204:219]
    v_add_f32 v196, 1.0, v196
    v_rcp_f32 v194, v194
    v_exp_f32 v199, v199
    v_add_f32 v197, 1.0, v197
    v_mfma_f32_32x32x16_bf16 v[204:219], v[164:167], v[44:47], v[204:219]
    v_rcp_f32 v195, v195
    v_exp_f32 v200, v200
    v_add_f32 v198, 1.0, v198
    v_rcp_f32 v196, v196
    v_mfma_f32_32x32x16_bf16 v[220:235], v[152:155], v[16:19], v[220:235]
    ds_read_b128 v[236:239], v247 offset:384
    ds_read_b32 v240, v251 offset:384
    s_add_u32 s72, s72, 1
    v_exp_f32 v201, v201
    v_add_f32 v199, 1.0, v199
    v_rcp_f32 v197, v197
    v_exp_f32 v202, v202
    v_mfma_f32_32x32x16_bf16 v[220:235], v[156:159], v[20:23], v[220:235]
    v_add_f32 v200, 1.0, v200
    v_rcp_f32 v198, v198
    v_exp_f32 v203, v203
    v_add_f32 v201, 1.0, v201
    v_mfma_f32_32x32x16_bf16 v[220:235], v[160:163], v[24:27], v[220:235]
    v_rcp_f32 v199, v199
    v_add_f32 v202, 1.0, v202
    v_rcp_f32 v200, v200
    v_add_f32 v203, 1.0, v203
    v_rcp_f32 v201, v201
    v_mfma_f32_32x32x16_bf16 v[220:235], v[164:167], v[28:31], v[220:235]
    v_rcp_f32 v202, v202
    v_rcp_f32 v203, v203
    v_mul_f32 v204, v188, v204
    v_mul_f32 v205, v189, v205
    s_waitcnt lgkmcnt(0)
    v_smfmac_f32_32x32x32_bf16 v[88:103], v[180:183], v[188:195], v177
    v_mul_f32 v206, v190, v206
    v_mul_f32 v207, v191, v207
    v_mul_f32 v208, v192, v208
    v_mul_f32 v209, v193, v209
    v_mul_f32 v210, v194, v210
    v_mul_f32 v211, v195, v211
    v_mul_f32 v212, v196, v212
    v_smfmac_f32_32x32x32_bf16 v[88:103], v[184:187], v[196:203], v177
    v_mul_f32 v213, v197, v213
    v_mul_f32 v214, v198, v214
    v_mul_f32 v215, v199, v215
    v_mul_f32 v216, v200, v216
    v_mul_f32 v217, v201, v217
    v_mul_f32 v218, v202, v218
    v_mul_f32 v219, v203, v219
    v_smfmac_f32_32x32x32_bf16 v[104:119], v[180:183], v[204:211], v177
    s_waitcnt vmcnt(0)
    ds_read_b128 v[168:171], v244
    v_exp_f32 v220, v220
    v_exp_f32 v221, v221
    v_exp_f32 v222, v222
    v_add_f32 v220, 1.0, v220
    v_smfmac_f32_32x32x32_bf16 v[104:119], v[184:187], v[212:219], v177
    v_exp_f32 v223, v223
    v_add_f32 v221, 1.0, v221
    v_exp_f32 v224, v224
    v_add_f32 v222, 1.0, v222
    v_rcp_f32 v220, v220
    s_waitcnt lgkmcnt(0)
    v_mfma_f32_32x32x16_bf16 v[188:203], v[168:171], v[64:67], 0
    v_exp_f32 v225, v225
    v_add_f32 v223, 1.0, v223
    v_rcp_f32 v221, v221
    v_exp_f32 v226, v226
    v_mfma_f32_32x32x16_bf16 v[204:219], v[152:155], v[48:51], 0
    ds_read_b128 v[152:155], v243 offset:0
    v_add_f32 v224, 1.0, v224
    v_rcp_f32 v222, v222
    v_exp_f32 v227, v227
    v_mfma_f32_32x32x16_bf16 v[204:219], v[156:159], v[52:55], v[204:219]
    ds_read_b128 v[156:159], v243 offset:16
    v_add_f32 v225, 1.0, v225
    v_rcp_f32 v223, v223
    v_exp_f32 v228, v228
    v_add_f32 v226, 1.0, v226
    v_rcp_f32 v224, v224
    v_smfmac_f32_32x32x32_bf16 v[188:203], v[172:175], v[72:79], v176
    v_exp_f32 v229, v229
    v_add_f32 v227, 1.0, v227
    v_rcp_f32 v225, v225
    v_exp_f32 v230, v230
    v_mfma_f32_32x32x16_bf16 v[204:219], v[160:163], v[56:59], v[204:219]
    ds_read_b128 v[160:163], v243 offset:32
    v_add_f32 v228, 1.0, v228
    v_rcp_f32 v226, v226
    v_exp_f32 v231, v231
    v_add_f32 v229, 1.0, v229
    v_mfma_f32_32x32x16_bf16 v[204:219], v[164:167], v[60:63], v[204:219]
    ds_read_b128 v[164:167], v243 offset:48
    v_rcp_f32 v227, v227
    v_exp_f32 v232, v232
    v_add_f32 v230, 1.0, v230
    v_rcp_f32 v228, v228
    s_waitcnt lgkmcnt(3)
    v_mfma_f32_32x32x16_bf16 v[188:203], v[152:155], v[0:3], v[188:203]
    v_exp_f32 v233, v233
    v_add_f32 v231, 1.0, v231
    v_rcp_f32 v229, v229
    v_exp_f32 v234, v234
    s_waitcnt lgkmcnt(2)
    v_mfma_f32_32x32x16_bf16 v[188:203], v[156:159], v[4:7], v[188:203]
    v_add_f32 v232, 1.0, v232
    v_rcp_f32 v230, v230
    v_exp_f32 v235, v235
    v_add_f32 v233, 1.0, v233
    s_waitcnt lgkmcnt(1)
    v_mfma_f32_32x32x16_bf16 v[188:203], v[160:163], v[8:11], v[188:203]
    v_rcp_f32 v231, v231
    v_add_f32 v234, 1.0, v234
    v_rcp_f32 v232, v232
    v_add_f32 v235, 1.0, v235
    v_rcp_f32 v233, v233
    s_waitcnt lgkmcnt(0)
    v_mfma_f32_32x32x16_bf16 v[188:203], v[164:167], v[12:15], v[188:203]
    s_cmp_lt_i32 s72, s38
    s_cbranch_scc0 K2_ND_1
    s_add_u32 m0, s74, 0
    v_mad_u32_u16 v236, v236, s75, v241 op_sel:[1,0,0,0]
    buffer_load_dwordx4 v236, s[16:19], 0 offen lds
    s_add_u32 m0, s74, 1040
    v_mad_u32_u16 v237, v237, s75, v241 op_sel:[1,0,0,0]
    buffer_load_dwordx4 v237, s[16:19], 0 offen lds
    s_add_u32 m0, s74, 2080
    v_mad_u32_u16 v238, v238, s75, v241 op_sel:[1,0,0,0]
    buffer_load_dwordx4 v238, s[16:19], 0 offen lds
    s_add_u32 m0, s74, 3120
    v_mad_u32_u16 v239, v239, s75, v241 op_sel:[1,0,0,0]
    buffer_load_dwordx4 v239, s[16:19], 0 offen lds
    s_add_u32 m0, s74, 4160
    v_add_u32 v240, v240, v242
    buffer_load_dwordx4 v240, s[20:23], 0 offen lds
K2_ND_1:
    v_rcp_f32 v234, v234
    v_rcp_f32 v235, v235
    v_mul_f32 v204, v220, v204
    v_mul_f32 v205, v221, v205
    v_smfmac_f32_32x32x32_bf16 v[120:135], v[180:183], v[220:227], v177
    v_mul_f32 v206, v222, v206
    v_mul_f32 v207, v223, v207
    v_mul_f32 v208, v224, v208
    v_mul_f32 v209, v225, v209
    v_mul_f32 v210, v226, v210
    v_mul_f32 v211, v227, v211
    v_mul_f32 v212, v228, v212
    v_smfmac_f32_32x32x32_bf16 v[120:135], v[184:187], v[228:235], v177
    v_mul_f32 v213, v229, v213
    v_mul_f32 v214, v230, v214
    v_mul_f32 v215, v231, v215
    v_mul_f32 v216, v232, v216
    v_mul_f32 v217, v233, v217
    v_mul_f32 v218, v234, v218
    v_mul_f32 v219, v235, v219
    v_add_u32 v247, 0x100, v247
    v_add_u32 v249, 0x100, v249
    v_add_u32 v251, 0x100, v251
    v_add_u32 v248, 0x100, v248
    s_cmp_lt_u32 s72, s87
    s_cbranch_scc1 K2_LOOP
    s_cmp_ge_u32 s72, s73
    s_cbranch_scc1 K2_TAIL
    s_cmp_lg_u32 s72, s37
    s_cbranch_scc1 K2_SB1
    s_barrier
    s_mov_b32 s37, -1
    s_cmp_eq_u32 s83, 0
    s_cbranch_scc1 K2_NE1
    s_lshl_b32 s10, s3, 2
    v_mov_b32 v178, s10
    ds_read_b32 v178, v178 offset:2112
    s_waitcnt lgkmcnt(0)
    v_readfirstlane_b32 s15, v178
    s_nop 3
    s_sub_u32 s73, s15, s76
    s_add_u32 s73, s73, 127
    s_lshr_b32 s73, s73, 7
    s_sub_i32 s38, s73, 1
K2_NE1:
K2_SB1:
    s_cmp_lg_u32 s72, s4
    s_cbranch_scc1 K2_PR1_0
    s_setprio 2
K2_PR1_0:
    s_cmp_lg_u32 s72, s5
    s_cbranch_scc1 K2_PR1_1
    s_setprio 1
K2_PR1_1:
    s_cmp_lg_u32 s72, s6
    s_cbranch_scc1 K2_PR1_2
    s_setprio 0
K2_PR1_2:
    s_cmp_eq_u32 s72, s38
    s_cbranch_scc1 K2_LT1
    s_mov_b32 s87, s73
    s_cmp_gt_i32 s4, s72
    s_cselect_b32 s10, s4, s87
    s_min_u32 s87, s87, s10
    s_cmp_gt_i32 s5, s72
    s_cselect_b32 s10, s5, s87
    s_min_u32 s87, s87, s10
    s_cmp_gt_i32 s6, s72
    s_cselect_b32 s10, s6, s87
    s_min_u32 s87, s87, s10
    s_cmp_gt_i32 s37, s72
    s_cselect_b32 s10, s37, s87
    s_min_u32 s87, s87, s10
    s_cmp_gt_i32 s38, s72
    s_cselect_b32 s10, s38, s87
    s_min_u32 s87, s87, s10
    s_branch K2_LOOP
K2_EV0:
    s_cmp_ge_u32 s72, s73
    s_cbranch_scc1 K2_TAIL
    s_cmp_lg_u32 s72, s37
    s_cbranch_scc1 K2_SB0
    s_barrier
    s_mov_b32 s37, -1
    s_cmp_eq_u32 s83, 0
    s_cbranch_scc1 K2_NE0
    s_lshl_b32 s10, s3, 2
    v_mov_b32 v178, s10
    ds_read_b32 v178, v178 offset:2112
    s_waitcnt lgkmcnt(0)
    v_readfirstlane_b32 s15, v178
    s_nop 3
    s_sub_u32 s73, s15, s76
    s_add_u32 s73, s73, 127
    s_lshr_b32 s73, s73, 7
    s_sub_i32 s38, s73, 1
K2_NE0:
K2_SB0:
    s_cmp_lg_u32 s72, s4
    s_cbranch_scc1 K2_PR0_0
    s_setprio 2
K2_PR0_0:
    s_cmp_lg_u32 s72, s5
    s_cbranch_scc1 K2_PR0_1
    s_setprio 1
K2_PR0_1:
    s_cmp_lg_u32 s72, s6
    s_cbranch_scc1 K2_PR0_2
    s_setprio 0
K2_PR0_2:
    s_cmp_eq_u32 s72, s38
    s_cbranch_scc1 K2_LT0
    s_mov_b32 s87, s73
    s_cmp_gt_i32 s4, s72
    s_cselect_b32 s10, s4, s87
    s_min_u32 s87, s87, s10
    s_cmp_gt_i32 s5, s72
    s_cselect_b32 s10, s5, s87
    s_min_u32 s87, s87, s10
    s_cmp_gt_i32 s6, s72
    s_cselect_b32 s10, s6, s87
    s_min_u32 s87, s87, s10
    s_cmp_gt_i32 s37, s72
    s_cselect_b32 s10, s37, s87
    s_min_u32 s87, s87, s10
    s_cmp_gt_i32 s38, s72
    s_cselect_b32 s10, s38, s87
    s_min_u32 s87, s87, s10
    s_branch K2_EVR0
K2_LT0:
    v_add_u32 v248, 128, v248
K2_LT1:
    s_sub_u32 s10, s15, s76
    s_sub_u32 s10, s10, 4
    s_and_b32 s10, s10, 127
    s_cmp_lt_u32 s10, 32
    s_cbranch_scc1 K2_LG1
    s_cmp_lt_u32 s10, 64
    s_cbranch_scc1 K2_LG2
    s_cmp_lt_u32 s10, 96
    s_cbranch_scc1 K2_LG3
    v_smfmac_f32_32x32x32_bf16 v[136:151], v[180:183], v[204:211], v177
    ds_read_u8 v236, v248 offset:0
    ds_read_u8 v237, v248 offset:16
    ds_read_u8 v238, v248 offset:64
    ds_read_u8 v239, v248 offset:80
    v_exp_f32 v188, v188
    v_exp_f32 v189, v189
    v_exp_f32 v190, v190
    v_add_f32 v188, 1.0, v188
    v_smfmac_f32_32x32x32_bf16 v[136:151], v[184:187], v[212:219], v177
    v_exp_f32 v191, v191
    v_add_f32 v189, 1.0, v189
    v_exp_f32 v192, v192
    v_add_f32 v190, 1.0, v190
    v_rcp_f32 v188, v188
    v_mfma_f32_32x32x16_bf16 v[220:235], v[168:171], v[68:71], 0
    v_exp_f32 v193, v193
    v_add_f32 v191, 1.0, v191
    v_rcp_f32 v189, v189
    v_exp_f32 v194, v194
    v_mfma_f32_32x32x16_bf16 v[204:219], v[152:155], v[32:35], 0
    v_add_f32 v192, 1.0, v192
    v_rcp_f32 v190, v190
    v_exp_f32 v195, v195
    v_mfma_f32_32x32x16_bf16 v[204:219], v[156:159], v[36:39], v[204:219]
    s_waitcnt lgkmcnt(0)
    v_lshl_add_u32 v236, v236, 6, v246
    v_lshl_add_u32 v237, v237, 6, v246
    v_lshl_add_u32 v238, v238, 6, v246
    v_lshl_add_u32 v239, v239, 6, v246
    v_add_f32 v193, 1.0, v193
    v_rcp_f32 v191, v191
    v_exp_f32 v196, v196
    v_add_f32 v194, 1.0, v194
    v_rcp_f32 v192, v192
    v_smfmac_f32_32x32x32_bf16 v[220:235], v[172:175], v[80:87], v176
    ds_read_b64_tr_b16 v[180:181], v236
    ds_read_b64_tr_b16 v[182:183], v237
    ds_read_b64_tr_b16 v[184:185], v238
    ds_read_b64_tr_b16 v[186:187], v239
    v_exp_f32 v197, v197
    v_add_f32 v195, 1.0, v195
    v_rcp_f32 v193, v193
    v_exp_f32 v198, v198
    v_mfma_f32_32x32x16_bf16 v[204:219], v[160:163], v[40:43], v[204:219]
    v_add_f32 v196, 1.0, v196
    v_rcp_f32 v194, v194
    v_exp_f32 v199, v199
    v_add_f32 v197, 1.0, v197
    v_mfma_f32_32x32x16_bf16 v[204:219], v[164:167], v[44:47], v[204:219]
    v_rcp_f32 v195, v195
    v_exp_f32 v200, v200
    v_add_f32 v198, 1.0, v198
    v_rcp_f32 v196, v196
    v_mfma_f32_32x32x16_bf16 v[220:235], v[152:155], v[16:19], v[220:235]
    v_exp_f32 v201, v201
    v_add_f32 v199, 1.0, v199
    v_rcp_f32 v197, v197
    v_exp_f32 v202, v202
    v_mfma_f32_32x32x16_bf16 v[220:235], v[156:159], v[20:23], v[220:235]
    v_add_f32 v200, 1.0, v200
    v_rcp_f32 v198, v198
    v_exp_f32 v203, v203
    v_add_f32 v201, 1.0, v201
    v_mfma_f32_32x32x16_bf16 v[220:235], v[160:163], v[24:27], v[220:235]
    v_rcp_f32 v199, v199
    v_add_f32 v202, 1.0, v202
    v_rcp_f32 v200, v200
    v_add_f32 v203, 1.0, v203
    v_rcp_f32 v201, v201
    v_mfma_f32_32x32x16_bf16 v[220:235], v[164:167], v[28:31], v[220:235]
    v_rcp_f32 v202, v202
    v_rcp_f32 v203, v203
    v_mul_f32 v204, v188, v204
    v_mul_f32 v205, v189, v205
    s_waitcnt lgkmcnt(0)
    v_smfmac_f32_32x32x32_bf16 v[88:103], v[180:183], v[188:195], v177
    v_mul_f32 v206, v190, v206
    v_mul_f32 v207, v191, v207
    v_mul_f32 v208, v192, v208
    v_mul_f32 v209, v193, v209
    v_mul_f32 v210, v194, v210
    v_mul_f32 v211, v195, v211
    v_mul_f32 v212, v196, v212
    v_smfmac_f32_32x32x32_bf16 v[88:103], v[184:187], v[196:203], v177
    v_mul_f32 v213, v197, v213
    v_mul_f32 v214, v198, v214
    v_mul_f32 v215, v199, v215
    v_mul_f32 v216, v200, v216
    v_mul_f32 v217, v201, v217
    v_mul_f32 v218, v202, v218
    v_mul_f32 v219, v203, v219
    v_smfmac_f32_32x32x32_bf16 v[104:119], v[180:183], v[204:211], v177
    v_exp_f32 v220, v220
    v_exp_f32 v221, v221
    v_exp_f32 v222, v222
    v_add_f32 v220, 1.0, v220
    v_exp_f32 v223, v223
    v_smfmac_f32_32x32x32_bf16 v[104:119], v[184:187], v[212:219], v177
    v_add_f32 v221, 1.0, v221
    v_exp_f32 v224, v224
    v_add_f32 v222, 1.0, v222
    v_rcp_f32 v220, v220
    v_exp_f32 v225, v225
    v_add_f32 v223, 1.0, v223
    v_mfma_f32_32x32x16_bf16 v[204:219], v[152:155], v[48:51], 0
    v_rcp_f32 v221, v221
    v_exp_f32 v226, v226
    v_add_f32 v224, 1.0, v224
    v_rcp_f32 v222, v222
    v_exp_f32 v227, v227
    v_mfma_f32_32x32x16_bf16 v[204:219], v[156:159], v[52:55], v[204:219]
    v_add_f32 v225, 1.0, v225
    v_rcp_f32 v223, v223
    v_exp_f32 v228, v228
    v_add_f32 v226, 1.0, v226
    v_rcp_f32 v224, v224
    v_exp_f32 v229, v229
    v_mfma_f32_32x32x16_bf16 v[204:219], v[160:163], v[56:59], v[204:219]
    v_add_f32 v227, 1.0, v227
    v_rcp_f32 v225, v225
    v_exp_f32 v230, v230
    v_add_f32 v228, 1.0, v228
    v_rcp_f32 v226, v226
    v_mfma_f32_32x32x16_bf16 v[204:219], v[164:167], v[60:63], v[204:219]
    v_exp_f32 v231, v231
    v_add_f32 v229, 1.0, v229
    v_rcp_f32 v227, v227
    v_exp_f32 v232, v232
    v_add_f32 v230, 1.0, v230
    v_rcp_f32 v228, v228
    v_exp_f32 v233, v233
    v_add_f32 v231, 1.0, v231
    v_rcp_f32 v229, v229
    v_exp_f32 v234, v234
    v_add_f32 v232, 1.0, v232
    v_rcp_f32 v230, v230
    v_exp_f32 v235, v235
    v_add_f32 v233, 1.0, v233
    v_rcp_f32 v231, v231
    v_add_f32 v234, 1.0, v234
    v_rcp_f32 v232, v232
    v_add_f32 v235, 1.0, v235
    v_rcp_f32 v233, v233
    v_rcp_f32 v234, v234
    v_rcp_f32 v235, v235
    v_mul_f32 v204, v220, v204
    v_mul_f32 v205, v221, v205
    v_smfmac_f32_32x32x32_bf16 v[120:135], v[180:183], v[220:227], v177
    v_mul_f32 v206, v222, v206
    v_mul_f32 v207, v223, v207
    v_mul_f32 v208, v224, v208
    v_mul_f32 v209, v225, v209
    v_mul_f32 v210, v226, v210
    v_mul_f32 v211, v227, v211
    v_mul_f32 v212, v228, v212
    v_smfmac_f32_32x32x32_bf16 v[120:135], v[184:187], v[228:235], v177
    v_mul_f32 v213, v229, v213
    v_mul_f32 v214, v230, v214
    v_mul_f32 v215, v231, v215
    v_mul_f32 v216, v232, v216
    v_mul_f32 v217, v233, v217
    v_mul_f32 v218, v234, v218
    v_mul_f32 v219, v235, v219
    v_smfmac_f32_32x32x32_bf16 v[136:151], v[180:183], v[204:211], v177
    s_nop 0
    v_smfmac_f32_32x32x32_bf16 v[136:151], v[184:187], v[212:219], v177
    s_branch K2_DONE
K2_LG3:
    v_smfmac_f32_32x32x32_bf16 v[136:151], v[180:183], v[204:211], v177
    ds_read_u8 v236, v248 offset:0
    ds_read_u8 v237, v248 offset:16
    ds_read_u8 v238, v248 offset:64
    ds_read_u8 v239, v248 offset:80
    v_exp_f32 v188, v188
    v_exp_f32 v189, v189
    v_exp_f32 v190, v190
    v_smfmac_f32_32x32x32_bf16 v[136:151], v[184:187], v[212:219], v177
    v_add_f32 v188, 1.0, v188
    v_exp_f32 v191, v191
    v_add_f32 v189, 1.0, v189
    v_exp_f32 v192, v192
    v_mfma_f32_32x32x16_bf16 v[220:235], v[168:171], v[68:71], 0
    v_add_f32 v190, 1.0, v190
    v_rcp_f32 v188, v188
    v_exp_f32 v193, v193
    v_mfma_f32_32x32x16_bf16 v[204:219], v[152:155], v[32:35], 0
    v_add_f32 v191, 1.0, v191
    v_rcp_f32 v189, v189
    v_exp_f32 v194, v194
    v_mfma_f32_32x32x16_bf16 v[204:219], v[156:159], v[36:39], v[204:219]
    s_waitcnt lgkmcnt(0)
    v_lshl_add_u32 v236, v236, 6, v246
    v_lshl_add_u32 v237, v237, 6, v246
    v_lshl_add_u32 v238, v238, 6, v246
    v_lshl_add_u32 v239, v239, 6, v246
    v_add_f32 v192, 1.0, v192
    v_rcp_f32 v190, v190
    v_exp_f32 v195, v195
    v_smfmac_f32_32x32x32_bf16 v[220:235], v[172:175], v[80:87], v176
    ds_read_b64_tr_b16 v[180:181], v236
    ds_read_b64_tr_b16 v[182:183], v237
    ds_read_b64_tr_b16 v[184:185], v238
    ds_read_b64_tr_b16 v[186:187], v239
    v_add_f32 v193, 1.0, v193
    v_rcp_f32 v191, v191
    v_exp_f32 v196, v196
    v_mfma_f32_32x32x16_bf16 v[204:219], v[160:163], v[40:43], v[204:219]
    v_add_f32 v194, 1.0, v194
    v_rcp_f32 v192, v192
    v_exp_f32 v197, v197
    v_mfma_f32_32x32x16_bf16 v[204:219], v[164:167], v[44:47], v[204:219]
    v_add_f32 v195, 1.0, v195
    v_rcp_f32 v193, v193
    v_exp_f32 v198, v198
    v_mfma_f32_32x32x16_bf16 v[220:235], v[152:155], v[16:19], v[220:235]
    v_add_f32 v196, 1.0, v196
    v_rcp_f32 v194, v194
    v_exp_f32 v199, v199
    v_mfma_f32_32x32x16_bf16 v[220:235], v[156:159], v[20:23], v[220:235]
    v_add_f32 v197, 1.0, v197
    v_rcp_f32 v195, v195
    v_add_f32 v198, 1.0, v198
    v_mfma_f32_32x32x16_bf16 v[220:235], v[160:163], v[24:27], v[220:235]
    v_rcp_f32 v196, v196
    v_add_f32 v199, 1.0, v199
    v_rcp_f32 v197, v197
    v_mfma_f32_32x32x16_bf16 v[220:235], v[164:167], v[28:31], v[220:235]
    v_rcp_f32 v198, v198
    v_rcp_f32 v199, v199
    v_mul_f32 v204, v188, v204
    v_mul_f32 v205, v189, v205
    s_waitcnt lgkmcnt(0)
    v_smfmac_f32_32x32x32_bf16 v[88:103], v[180:183], v[188:195], v177
    v_mul_f32 v206, v190, v206
    v_mul_f32 v207, v191, v207
    v_mul_f32 v208, v192, v208
    v_mul_f32 v209, v193, v209
    v_mul_f32 v210, v194, v210
    v_smfmac_f32_32x32x32_bf16 v[88:103], v[184:187], v[196:203], v177
    v_mul_f32 v211, v195, v211
    v_mul_f32 v212, v196, v212
    v_mul_f32 v213, v197, v213
    v_mul_f32 v214, v198, v214
    v_mul_f32 v215, v199, v215
    v_smfmac_f32_32x32x32_bf16 v[104:119], v[180:183], v[204:211], v177
    v_exp_f32 v220, v220
    v_exp_f32 v221, v221
    v_exp_f32 v222, v222
    v_add_f32 v220, 1.0, v220
    v_smfmac_f32_32x32x32_bf16 v[104:119], v[184:187], v[212:219], v177
    v_exp_f32 v223, v223
    v_add_f32 v221, 1.0, v221
    v_exp_f32 v224, v224
    v_add_f32 v222, 1.0, v222
    v_rcp_f32 v220, v220
    v_mfma_f32_32x32x16_bf16 v[204:219], v[152:155], v[48:51], 0
    v_exp_f32 v225, v225
    v_add_f32 v223, 1.0, v223
    v_rcp_f32 v221, v221
    v_exp_f32 v226, v226
    v_mfma_f32_32x32x16_bf16 v[204:219], v[156:159], v[52:55], v[204:219]
    v_add_f32 v224, 1.0, v224
    v_rcp_f32 v222, v222
    v_exp_f32 v227, v227
    v_mfma_f32_32x32x16_bf16 v[204:219], v[160:163], v[56:59], v[204:219]
    v_add_f32 v225, 1.0, v225
    v_rcp_f32 v223, v223
    v_exp_f32 v228, v228
    v_add_f32 v226, 1.0, v226
    v_rcp_f32 v224, v224
    v_mfma_f32_32x32x16_bf16 v[204:219], v[164:167], v[60:63], v[204:219]
    v_exp_f32 v229, v229
    v_add_f32 v227, 1.0, v227
    v_rcp_f32 v225, v225
    v_exp_f32 v230, v230
    v_add_f32 v228, 1.0, v228
    v_rcp_f32 v226, v226
    v_exp_f32 v231, v231
    v_add_f32 v229, 1.0, v229
    v_rcp_f32 v227, v227
    v_add_f32 v230, 1.0, v230
    v_rcp_f32 v228, v228
    v_add_f32 v231, 1.0, v231
    v_rcp_f32 v229, v229
    v_rcp_f32 v230, v230
    v_rcp_f32 v231, v231
    v_mul_f32 v204, v220, v204
    v_mul_f32 v205, v221, v205
    v_smfmac_f32_32x32x32_bf16 v[120:135], v[180:183], v[220:227], v177
    v_mul_f32 v206, v222, v206
    v_mul_f32 v207, v223, v207
    v_mul_f32 v208, v224, v208
    v_mul_f32 v209, v225, v209
    v_mul_f32 v210, v226, v210
    v_smfmac_f32_32x32x32_bf16 v[120:135], v[184:187], v[228:235], v177
    v_mul_f32 v211, v227, v211
    v_mul_f32 v212, v228, v212
    v_mul_f32 v213, v229, v213
    v_mul_f32 v214, v230, v214
    v_mul_f32 v215, v231, v215
    v_smfmac_f32_32x32x32_bf16 v[136:151], v[180:183], v[204:211], v177
    s_nop 0
    v_smfmac_f32_32x32x32_bf16 v[136:151], v[184:187], v[212:219], v177
    s_branch K2_DONE
K2_LG2:
    v_smfmac_f32_32x32x32_bf16 v[136:151], v[180:183], v[204:211], v177
    ds_read_u8 v236, v248 offset:0
    ds_read_u8 v237, v248 offset:16
    ds_read_u8 v238, v248 offset:64
    ds_read_u8 v239, v248 offset:80
    v_exp_f32 v188, v188
    v_exp_f32 v189, v189
    v_smfmac_f32_32x32x32_bf16 v[136:151], v[184:187], v[212:219], v177
    v_exp_f32 v190, v190
    v_add_f32 v188, 1.0, v188
    v_mfma_f32_32x32x16_bf16 v[220:235], v[168:171], v[68:71], 0
    v_exp_f32 v191, v191
    v_add_f32 v189, 1.0, v189
    v_exp_f32 v192, v192
    v_mfma_f32_32x32x16_bf16 v[204:219], v[152:155], v[32:35], 0
    v_add_f32 v190, 1.0, v190
    v_rcp_f32 v188, v188
    v_mfma_f32_32x32x16_bf16 v[204:219], v[156:159], v[36:39], v[204:219]
    s_waitcnt lgkmcnt(0)
    v_lshl_add_u32 v236, v236, 6, v246
    v_lshl_add_u32 v237, v237, 6, v246
    v_lshl_add_u32 v238, v238, 6, v246
    v_lshl_add_u32 v239, v239, 6, v246
    v_exp_f32 v193, v193
    v_smfmac_f32_32x32x32_bf16 v[220:235], v[172:175], v[80:87], v176
    ds_read_b64_tr_b16 v[180:181], v236
    ds_read_b64_tr_b16 v[182:183], v237
    ds_read_b64_tr_b16 v[184:185], v238
    ds_read_b64_tr_b16 v[186:187], v239
    v_add_f32 v191, 1.0, v191
    v_rcp_f32 v189, v189
    v_exp_f32 v194, v194
    v_mfma_f32_32x32x16_bf16 v[204:219], v[160:163], v[40:43], v[204:219]
    v_add_f32 v192, 1.0, v192
    v_rcp_f32 v190, v190
    v_mfma_f32_32x32x16_bf16 v[204:219], v[164:167], v[44:47], v[204:219]
    v_exp_f32 v195, v195
    v_mfma_f32_32x32x16_bf16 v[220:235], v[152:155], v[16:19], v[220:235]
    v_add_f32 v193, 1.0, v193
    v_rcp_f32 v191, v191
    v_add_f32 v194, 1.0, v194
    v_mfma_f32_32x32x16_bf16 v[220:235], v[156:159], v[20:23], v[220:235]
    v_rcp_f32 v192, v192
    v_add_f32 v195, 1.0, v195
    v_mfma_f32_32x32x16_bf16 v[220:235], v[160:163], v[24:27], v[220:235]
    v_rcp_f32 v193, v193
    v_rcp_f32 v194, v194
    v_mfma_f32_32x32x16_bf16 v[220:235], v[164:167], v[28:31], v[220:235]
    v_rcp_f32 v195, v195
    v_mul_f32 v204, v188, v204
    v_mul_f32 v205, v189, v205
    v_mul_f32 v206, v190, v206
    s_waitcnt lgkmcnt(0)
    v_smfmac_f32_32x32x32_bf16 v[88:103], v[180:183], v[188:195], v177
    v_mul_f32 v207, v191, v207
    v_mul_f32 v208, v192, v208
    v_mul_f32 v209, v193, v209
    v_mul_f32 v210, v194, v210
    v_mul_f32 v211, v195, v211
    s_nop 1
    v_smfmac_f32_32x32x32_bf16 v[104:119], v[180:183], v[204:211], v177
    v_exp_f32 v220, v220
    v_exp_f32 v221, v221
    v_exp_f32 v222, v222
    v_mfma_f32_32x32x16_bf16 v[204:219], v[152:155], v[48:51], 0
    v_add_f32 v220, 1.0, v220
    v_exp_f32 v223, v223
    v_add_f32 v221, 1.0, v221
    v_mfma_f32_32x32x16_bf16 v[204:219], v[156:159], v[52:55], v[204:219]
    v_exp_f32 v224, v224
    v_add_f32 v222, 1.0, v222
    v_rcp_f32 v220, v220
    v_mfma_f32_32x32x16_bf16 v[204:219], v[160:163], v[56:59], v[204:219]
    v_exp_f32 v225, v225
    v_add_f32 v223, 1.0, v223
    v_rcp_f32 v221, v221
    v_mfma_f32_32x32x16_bf16 v[204:219], v[164:167], v[60:63], v[204:219]
    v_exp_f32 v226, v226
    v_add_f32 v224, 1.0, v224
    v_rcp_f32 v222, v222
    v_exp_f32 v227, v227
    v_add_f32 v225, 1.0, v225
    v_rcp_f32 v223, v223
    v_add_f32 v226, 1.0, v226
    v_rcp_f32 v224, v224
    v_add_f32 v227, 1.0, v227
    v_rcp_f32 v225, v225
    v_rcp_f32 v226, v226
    v_rcp_f32 v227, v227
    v_mul_f32 v204, v220, v204
    v_mul_f32 v205, v221, v205
    v_mul_f32 v206, v222, v206
    v_smfmac_f32_32x32x32_bf16 v[120:135], v[180:183], v[220:227], v177
    v_mul_f32 v207, v223, v207
    v_mul_f32 v208, v224, v208
    v_mul_f32 v209, v225, v209
    v_mul_f32 v210, v226, v210
    v_mul_f32 v211, v227, v211
    s_nop 1
    v_smfmac_f32_32x32x32_bf16 v[136:151], v[180:183], v[204:211], v177
    s_branch K2_DONE
K2_LG1:
    v_smfmac_f32_32x32x32_bf16 v[136:151], v[180:183], v[204:211], v177
    ds_read_u8 v236, v248 offset:0
    ds_read_u8 v237, v248 offset:16
    ds_read_u8 v238, v248 offset:64
    ds_read_u8 v239, v248 offset:80
    v_exp_f32 v188, v188
    v_smfmac_f32_32x32x32_bf16 v[136:151], v[184:187], v[212:219], v177
    v_exp_f32 v189, v189
    v_mfma_f32_32x32x16_bf16 v[220:235], v[168:171], v[68:71], 0
    v_exp_f32 v190, v190
    v_mfma_f32_32x32x16_bf16 v[204:219], v[152:155], v[32:35], 0
    v_add_f32 v188, 1.0, v188
    v_mfma_f32_32x32x16_bf16 v[204:219], v[156:159], v[36:39], v[204:219]
    s_waitcnt lgkmcnt(0)
    v_lshl_add_u32 v236, v236, 6, v246
    v_lshl_add_u32 v237, v237, 6, v246
    v_lshl_add_u32 v238, v238, 6, v246
    v_lshl_add_u32 v239, v239, 6, v246
    v_exp_f32 v191, v191
    v_smfmac_f32_32x32x32_bf16 v[220:235], v[172:175], v[80:87], v176
    ds_read_b64_tr_b16 v[180:181], v236
    ds_read_b64_tr_b16 v[182:183], v237
    ds_read_b64_tr_b16 v[184:185], v238
    ds_read_b64_tr_b16 v[186:187], v239
    v_add_f32 v189, 1.0, v189
    v_add_f32 v190, 1.0, v190
    v_mfma_f32_32x32x16_bf16 v[204:219], v[160:163], v[40:43], v[204:219]
    v_rcp_f32 v188, v188
    v_mfma_f32_32x32x16_bf16 v[204:219], v[164:167], v[44:47], v[204:219]
    v_add_f32 v191, 1.0, v191
    v_mfma_f32_32x32x16_bf16 v[220:235], v[152:155], v[16:19], v[220:235]
    v_rcp_f32 v189, v189
    v_mfma_f32_32x32x16_bf16 v[220:235], v[156:159], v[20:23], v[220:235]
    v_rcp_f32 v190, v190
    v_mfma_f32_32x32x16_bf16 v[220:235], v[160:163], v[24:27], v[220:235]
    v_rcp_f32 v191, v191
    v_mfma_f32_32x32x16_bf16 v[220:235], v[164:167], v[28:31], v[220:235]
    s_nop 3
    v_mul_f32 v204, v188, v204
    v_mul_f32 v205, v189, v205
    s_waitcnt lgkmcnt(0)
    v_smfmac_f32_32x32x32_bf16 v[88:103], v[180:183], v[188:195], v177
    v_mul_f32 v206, v190, v206
    v_mul_f32 v207, v191, v207
    s_nop 1
    v_smfmac_f32_32x32x32_bf16 v[104:119], v[180:183], v[204:211], v177
    v_exp_f32 v220, v220
    v_exp_f32 v221, v221
    v_mfma_f32_32x32x16_bf16 v[204:219], v[152:155], v[48:51], 0
    v_exp_f32 v222, v222
    v_mfma_f32_32x32x16_bf16 v[204:219], v[156:159], v[52:55], v[204:219]
    v_add_f32 v220, 1.0, v220
    v_exp_f32 v223, v223
    v_mfma_f32_32x32x16_bf16 v[204:219], v[160:163], v[56:59], v[204:219]
    v_add_f32 v221, 1.0, v221
    v_mfma_f32_32x32x16_bf16 v[204:219], v[164:167], v[60:63], v[204:219]
    v_add_f32 v222, 1.0, v222
    v_rcp_f32 v220, v220
    v_add_f32 v223, 1.0, v223
    v_rcp_f32 v221, v221
    v_rcp_f32 v222, v222
    v_rcp_f32 v223, v223
    s_nop 5
    v_mul_f32 v204, v220, v204
    v_mul_f32 v205, v221, v205
    v_smfmac_f32_32x32x32_bf16 v[120:135], v[180:183], v[220:227], v177
    v_mul_f32 v206, v222, v206
    v_mul_f32 v207, v223, v207
    s_nop 1
    v_smfmac_f32_32x32x32_bf16 v[136:151], v[180:183], v[204:211], v177
    s_branch K2_DONE
K2_TAIL:
    v_smfmac_f32_32x32x32_bf16 v[136:151], v[180:183], v[204:211], v177
    v_smfmac_f32_32x32x32_bf16 v[136:151], v[184:187], v[212:219], v177
K2_DONE:
    s_cmp_lg_u32 s78, 0
    s_cbranch_scc1 K2_SLOW
K2_EPI:
    v_lshlrev_b32 v252, 4, v254
    ds_read_b128 v[152:155], v253 offset:0
    ds_read_b128 v[156:159], v253 offset:16
    ds_read_b128 v[160:163], v253 offset:32
    ds_read_b128 v[164:167], v253 offset:48
    ds_read_b128 v[0:3], v252 offset:52736
    ds_read_b128 v[4:7], v252 offset:53760
    ds_read_b128 v[8:11], v252 offset:54784
    ds_read_b128 v[12:15], v252 offset:55808
    ds_read_b128 v[16:19], v252 offset:56832
    ds_read_b128 v[20:23], v252 offset:57856
    ds_read_b128 v[24:27], v252 offset:58880
    ds_read_b128 v[28:31], v252 offset:59904
    v_and_b32 v237, 31, v254
    v_and_b32 v245, 32, v254
    v_mul_u32_u24 v246, 144, v237
    v_lshrrev_b32 v238, 2, v245
    v_lshl_add_u32 v237, v237, 6, v238
    ds_read2_b64 v[180:183], v237 offset0:0 offset1:2
    ds_read2_b64 v[184:187], v237 offset0:4 offset1:6
    s_waitcnt lgkmcnt(10)
    v_lshlrev_b32 v32, 16, v152
    v_and_b32 v33, 0xffff0000, v152
    v_lshlrev_b32 v34, 16, v153
    v_and_b32 v35, 0xffff0000, v153
    v_lshlrev_b32 v36, 16, v154
    v_and_b32 v37, 0xffff0000, v154
    v_lshlrev_b32 v38, 16, v155
    v_and_b32 v39, 0xffff0000, v155
    v_lshlrev_b32 v40, 16, v156
    v_and_b32 v41, 0xffff0000, v156
    v_lshlrev_b32 v42, 16, v157
    v_and_b32 v43, 0xffff0000, v157
    v_lshlrev_b32 v44, 16, v158
    v_and_b32 v45, 0xffff0000, v158
    v_lshlrev_b32 v46, 16, v159
    v_and_b32 v47, 0xffff0000, v159
    v_lshlrev_b32 v48, 16, v160
    v_and_b32 v49, 0xffff0000, v160
    v_lshlrev_b32 v50, 16, v161
    v_and_b32 v51, 0xffff0000, v161
    v_lshlrev_b32 v52, 16, v162
    v_and_b32 v53, 0xffff0000, v162
    v_lshlrev_b32 v54, 16, v163
    v_and_b32 v55, 0xffff0000, v163
    v_lshlrev_b32 v56, 16, v164
    v_and_b32 v57, 0xffff0000, v164
    v_lshlrev_b32 v58, 16, v165
    v_and_b32 v59, 0xffff0000, v165
    v_lshlrev_b32 v60, 16, v166
    v_and_b32 v61, 0xffff0000, v166
    v_lshlrev_b32 v62, 16, v167
    v_and_b32 v63, 0xffff0000, v167
    v_lshl_add_u32 v253, v245, 1, v246
    v_add_u32 v253, s74, v253
    s_sub_u32 s10, s13, s96
    s_mul_i32 s10, s10, 144
    s_add_u32 s10, s10, s74
    v_lshrrev_b32 v236, 3, v254
    v_lshl_add_u32 v236, v236, 4, v252
    v_add_u32 v236, s10, v236
    s_mul_i32 s10, s12, 196
    s_add_u32 s11, s10, s14
    s_add_u32 s10, s10, s13
    s_min_u32 s11, s11, 50000
    s_min_u32 s10, s10, 50000
    s_sub_u32 s11, s11, s10
    s_lshl_b32 s10, s10, 7
    s_add_u32 s28, s28, s10
    s_addc_u32 s29, s29, 0
    s_lshl_b32 s30, s11, 7
    s_waitcnt lgkmcnt(9)
    v_mfma_f32_32x32x16_bf16 v[188:203], v[0:3], v[152:155], v[32:47]
    v_rcp_f32 v88, v88
    v_rcp_f32 v89, v89
    v_rcp_f32 v90, v90
    v_rcp_f32 v91, v91
    s_waitcnt lgkmcnt(8)
    v_mfma_f32_32x32x16_bf16 v[188:203], v[4:7], v[156:159], v[188:203]
    v_rcp_f32 v92, v92
    v_rcp_f32 v93, v93
    v_rcp_f32 v94, v94
    v_rcp_f32 v95, v95
    s_waitcnt lgkmcnt(7)
    v_mfma_f32_32x32x16_bf16 v[188:203], v[8:11], v[160:163], v[188:203]
    v_rcp_f32 v96, v96
    v_rcp_f32 v97, v97
    v_rcp_f32 v98, v98
    v_rcp_f32 v99, v99
    s_waitcnt lgkmcnt(6)
    v_mfma_f32_32x32x16_bf16 v[188:203], v[12:15], v[164:167], v[188:203]
    v_rcp_f32 v100, v100
    v_rcp_f32 v101, v101
    v_rcp_f32 v102, v102
    v_rcp_f32 v103, v103
    s_waitcnt lgkmcnt(5)
    v_mfma_f32_32x32x16_bf16 v[204:219], v[16:19], v[152:155], v[48:63]
    v_rcp_f32 v120, v120
    v_rcp_f32 v121, v121
    v_rcp_f32 v122, v122
    v_rcp_f32 v123, v123
    s_waitcnt lgkmcnt(4)
    v_mfma_f32_32x32x16_bf16 v[204:219], v[20:23], v[156:159], v[204:219]
    v_rcp_f32 v124, v124
    v_rcp_f32 v125, v125
    v_rcp_f32 v126, v126
    v_rcp_f32 v127, v127
    s_waitcnt lgkmcnt(3)
    v_mfma_f32_32x32x16_bf16 v[204:219], v[24:27], v[160:163], v[204:219]
    v_rcp_f32 v128, v128
    v_rcp_f32 v129, v129
    v_rcp_f32 v130, v130
    v_rcp_f32 v131, v131
    s_waitcnt lgkmcnt(2)
    v_mfma_f32_32x32x16_bf16 v[204:219], v[28:31], v[164:167], v[204:219]
    v_rcp_f32 v132, v132
    v_rcp_f32 v133, v133
    v_rcp_f32 v134, v134
    v_rcp_f32 v135, v135
    s_waitcnt lgkmcnt(0)
    v_mul_f32 v104, v104, v88
    v_mul_f32 v105, v105, v89
    v_mul_f32 v106, v106, v90
    v_mul_f32 v107, v107, v91
    v_mul_f32 v108, v108, v92
    v_mul_f32 v109, v109, v93
    v_mul_f32 v110, v110, v94
    v_mul_f32 v111, v111, v95
    v_mul_f32 v112, v112, v96
    v_mul_f32 v113, v113, v97
    v_mul_f32 v114, v114, v98
    v_mul_f32 v115, v115, v99
    v_mul_f32 v116, v116, v100
    v_mul_f32 v117, v117, v101
    v_mul_f32 v118, v118, v102
    v_mul_f32 v119, v119, v103
    v_cvt_pk_bf16_f32 v88, v104, v105
    v_cvt_pk_bf16_f32 v89, v106, v107
    v_cvt_pk_bf16_f32 v90, v108, v109
    v_cvt_pk_bf16_f32 v91, v110, v111
    v_cvt_pk_bf16_f32 v92, v112, v113
    v_cvt_pk_bf16_f32 v93, v114, v115
    v_cvt_pk_bf16_f32 v94, v116, v117
    v_cvt_pk_bf16_f32 v95, v118, v119
    v_mfma_f32_32x32x16_bf16 v[188:203], v[88:91], v[180:183], v[188:203]
    s_nop 0
    v_mfma_f32_32x32x16_bf16 v[188:203], v[92:95], v[184:187], v[188:203]
    v_mul_f32 v136, v136, v120
    v_mul_f32 v137, v137, v121
    v_mul_f32 v138, v138, v122
    v_mul_f32 v139, v139, v123
    v_mul_f32 v140, v140, v124
    v_mul_f32 v141, v141, v125
    v_mul_f32 v142, v142, v126
    v_mul_f32 v143, v143, v127
    v_mul_f32 v144, v144, v128
    v_mul_f32 v145, v145, v129
    v_mul_f32 v146, v146, v130
    v_mul_f32 v147, v147, v131
    v_mul_f32 v148, v148, v132
    v_mul_f32 v149, v149, v133
    v_mul_f32 v150, v150, v134
    v_mul_f32 v151, v151, v135
    v_cvt_pk_bf16_f32 v120, v136, v137
    v_cvt_pk_bf16_f32 v121, v138, v139
    v_cvt_pk_bf16_f32 v122, v140, v141
    v_cvt_pk_bf16_f32 v123, v142, v143
    v_cvt_pk_bf16_f32 v124, v144, v145
    v_cvt_pk_bf16_f32 v125, v146, v147
    v_cvt_pk_bf16_f32 v126, v148, v149
    v_cvt_pk_bf16_f32 v127, v150, v151
    v_mfma_f32_32x32x16_bf16 v[204:219], v[120:123], v[180:183], v[204:219]
    s_nop 0
    v_mfma_f32_32x32x16_bf16 v[204:219], v[124:127], v[184:187], v[204:219]
    v_max_f32 v188, v188, v32
    v_max_f32 v189, v189, v33
    v_max_f32 v190, v190, v34
    v_max_f32 v191, v191, v35
    v_max_f32 v192, v192, v36
    v_max_f32 v193, v193, v37
    v_max_f32 v194, v194, v38
    v_max_f32 v195, v195, v39
    v_cvt_pk_bf16_f32 v220, v188, v189
    v_cvt_pk_bf16_f32 v221, v190, v191
    v_cvt_pk_bf16_f32 v222, v192, v193
    v_cvt_pk_bf16_f32 v223, v194, v195
    ds_write_b128 v253, v[220:223] offset:0
    v_max_f32 v196, v196, v40
    v_max_f32 v197, v197, v41
    v_max_f32 v198, v198, v42
    v_max_f32 v199, v199, v43
    v_max_f32 v200, v200, v44
    v_max_f32 v201, v201, v45
    v_max_f32 v202, v202, v46
    v_max_f32 v203, v203, v47
    v_cvt_pk_bf16_f32 v224, v196, v197
    v_cvt_pk_bf16_f32 v225, v198, v199
    v_cvt_pk_bf16_f32 v226, v200, v201
    v_cvt_pk_bf16_f32 v227, v202, v203
    ds_write_b128 v253, v[224:227] offset:16
    v_max_f32 v204, v204, v48
    v_max_f32 v205, v205, v49
    v_max_f32 v206, v206, v50
    v_max_f32 v207, v207, v51
    v_max_f32 v208, v208, v52
    v_max_f32 v209, v209, v53
    v_max_f32 v210, v210, v54
    v_max_f32 v211, v211, v55
    v_cvt_pk_bf16_f32 v228, v204, v205
    v_cvt_pk_bf16_f32 v229, v206, v207
    v_cvt_pk_bf16_f32 v230, v208, v209
    v_cvt_pk_bf16_f32 v231, v210, v211
    ds_write_b128 v253, v[228:231] offset:32
    v_max_f32 v212, v212, v56
    v_max_f32 v213, v213, v57
    v_max_f32 v214, v214, v58
    v_max_f32 v215, v215, v59
    v_max_f32 v216, v216, v60
    v_max_f32 v217, v217, v61
    v_max_f32 v218, v218, v62
    v_max_f32 v219, v219, v63
    v_cvt_pk_bf16_f32 v232, v212, v213
    v_cvt_pk_bf16_f32 v233, v214, v215
    v_cvt_pk_bf16_f32 v234, v216, v217
    v_cvt_pk_bf16_f32 v235, v218, v219
    ds_write_b128 v253, v[232:235] offset:48
    ds_read_b128 v[152:155], v236 offset:0
    ds_read_b128 v[156:159], v236 offset:1152
    ds_read_b128 v[160:163], v236 offset:2304
    ds_read_b128 v[164:167], v236 offset:3456
    s_waitcnt lgkmcnt(3)
    buffer_store_dwordx4 v[152:155], v252, s[28:31], 0 offen offset:0 sc1
    s_waitcnt lgkmcnt(2)
    buffer_store_dwordx4 v[156:159], v252, s[28:31], 0 offen offset:1024 sc1
    s_waitcnt lgkmcnt(1)
    buffer_store_dwordx4 v[160:163], v252, s[28:31], 0 offen offset:2048 sc1
    s_waitcnt lgkmcnt(0)
    buffer_store_dwordx4 v[164:167], v252, s[28:31], 0 offen offset:3072 sc1
    s_add_u32 s10, s2, s7
    s_cmp_lg_u32 s10, 0
    s_cbranch_scc1 K2_NOEP
    v_mov_b32 v188, 24117248
    v_mov_b32 v189, s100
    buffer_store_dword v189, v188, s[24:27], 0 offen sc1
K2_NOEP:
K2_END:
    s_endpgm
K2_RETRY0:
    s_sub_u32 s101, s101, 1
    s_cbranch_scc1 K2_END
    s_waitcnt vmcnt(0)
    v_bitop3_b32 v188, v91, s36, v214 bitop3:0x28
    s_nop 1
    v_or_b32_dpp v188, v188, v188 quad_perm:[1,0,3,2] row_mask:0xf bank_mask:0xf
    s_nop 1
    v_or_b32_dpp v188, v188, v188 quad_perm:[2,3,0,1] row_mask:0xf bank_mask:0xf
    s_nop 1
    v_or_b32_dpp v188, v188, v188 row_half_mirror row_mask:0xf bank_mask:0xf
    v_cmp_ne_u32 vcc, 0, v188
    s_and_b64 exec, exec, vcc
    s_cbranch_execz K2_RT00
    buffer_load_dwordx4 v[88:91], v189, s[32:35], 0 offen sc1
K2_RT00:
    s_mov_b64 exec, -1
    v_bitop3_b32 v188, v95, s36, v214 bitop3:0x28
    s_nop 1
    v_or_b32_dpp v188, v188, v188 quad_perm:[1,0,3,2] row_mask:0xf bank_mask:0xf
    s_nop 1
    v_or_b32_dpp v188, v188, v188 quad_perm:[2,3,0,1] row_mask:0xf bank_mask:0xf
    s_nop 1
    v_or_b32_dpp v188, v188, v188 row_half_mirror row_mask:0xf bank_mask:0xf
    v_cmp_ne_u32 vcc, 0, v188
    s_and_b64 exec, exec, vcc
    s_cbranch_execz K2_RT01
    buffer_load_dwordx4 v[92:95], v189, s[32:35], s79 offen sc1
K2_RT01:
    s_mov_b64 exec, -1
    v_bitop3_b32 v188, v99, s36, v214 bitop3:0x28
    s_nop 1
    v_or_b32_dpp v188, v188, v188 quad_perm:[1,0,3,2] row_mask:0xf bank_mask:0xf
    s_nop 1
    v_or_b32_dpp v188, v188, v188 quad_perm:[2,3,0,1] row_mask:0xf bank_mask:0xf
    s_nop 1
    v_or_b32_dpp v188, v188, v188 row_half_mirror row_mask:0xf bank_mask:0xf
    v_cmp_ne_u32 vcc, 0, v188
    s_and_b64 exec, exec, vcc
    s_cbranch_execz K2_RT02
    buffer_load_dwordx4 v[96:99], v189, s[32:35], s80 offen sc1
K2_RT02:
    s_mov_b64 exec, -1
    v_bitop3_b32 v188, v103, s36, v214 bitop3:0x28
    s_nop 1
    v_or_b32_dpp v188, v188, v188 quad_perm:[1,0,3,2] row_mask:0xf bank_mask:0xf
    s_nop 1
    v_or_b32_dpp v188, v188, v188 quad_perm:[2,3,0,1] row_mask:0xf bank_mask:0xf
    s_nop 1
    v_or_b32_dpp v188, v188, v188 row_half_mirror row_mask:0xf bank_mask:0xf
    v_cmp_ne_u32 vcc, 0, v188
    s_and_b64 exec, exec, vcc
    s_cbranch_execz K2_RT03
    buffer_load_dwordx4 v[100:103], v189, s[32:35], s81 offen sc1
K2_RT03:
    s_mov_b64 exec, -1
    s_waitcnt vmcnt(0)
    s_branch K2_CHK0
K2_RETRY1:
    s_sub_u32 s101, s101, 1
    s_cbranch_scc1 K2_END
    s_waitcnt vmcnt(0)
    v_bitop3_b32 v188, v95, s36, v214 bitop3:0x28
    s_nop 1
    v_or_b32_dpp v188, v188, v188 quad_perm:[1,0,3,2] row_mask:0xf bank_mask:0xf
    s_nop 1
    v_or_b32_dpp v188, v188, v188 quad_perm:[2,3,0,1] row_mask:0xf bank_mask:0xf
    s_nop 1
    v_or_b32_dpp v188, v188, v188 row_half_mirror row_mask:0xf bank_mask:0xf
    v_cmp_ne_u32 vcc, 0, v188
    s_and_b64 exec, exec, vcc
    s_cbranch_execz K2_RT11
    buffer_load_dwordx4 v[92:95], v189, s[32:35], s79 offen sc1
K2_RT11:
    s_mov_b64 exec, -1
    v_bitop3_b32 v188, v99, s36, v214 bitop3:0x28
    s_nop 1
    v_or_b32_dpp v188, v188, v188 quad_perm:[1,0,3,2] row_mask:0xf bank_mask:0xf
    s_nop 1
    v_or_b32_dpp v188, v188, v188 quad_perm:[2,3,0,1] row_mask:0xf bank_mask:0xf
    s_nop 1
    v_or_b32_dpp v188, v188, v188 row_half_mirror row_mask:0xf bank_mask:0xf
    v_cmp_ne_u32 vcc, 0, v188
    s_and_b64 exec, exec, vcc
    s_cbranch_execz K2_RT12
    buffer_load_dwordx4 v[96:99], v189, s[32:35], s80 offen sc1
K2_RT12:
    s_mov_b64 exec, -1
    v_bitop3_b32 v188, v103, s36, v214 bitop3:0x28
    s_nop 1
    v_or_b32_dpp v188, v188, v188 quad_perm:[1,0,3,2] row_mask:0xf bank_mask:0xf
    s_nop 1
    v_or_b32_dpp v188, v188, v188 quad_perm:[2,3,0,1] row_mask:0xf bank_mask:0xf
    s_nop 1
    v_or_b32_dpp v188, v188, v188 row_half_mirror row_mask:0xf bank_mask:0xf
    v_cmp_ne_u32 vcc, 0, v188
    s_and_b64 exec, exec, vcc
    s_cbranch_execz K2_RT13
    buffer_load_dwordx4 v[100:103], v189, s[32:35], s81 offen sc1
K2_RT13:
    s_mov_b64 exec, -1
    s_waitcnt vmcnt(0)
    s_branch K2_CHK1
K2_RETRY2:
    s_sub_u32 s101, s101, 1
    s_cbranch_scc1 K2_END
    s_waitcnt vmcnt(0)
    v_bitop3_b32 v188, v99, s36, v214 bitop3:0x28
    s_nop 1
    v_or_b32_dpp v188, v188, v188 quad_perm:[1,0,3,2] row_mask:0xf bank_mask:0xf
    s_nop 1
    v_or_b32_dpp v188, v188, v188 quad_perm:[2,3,0,1] row_mask:0xf bank_mask:0xf
    s_nop 1
    v_or_b32_dpp v188, v188, v188 row_half_mirror row_mask:0xf bank_mask:0xf
    v_cmp_ne_u32 vcc, 0, v188
    s_and_b64 exec, exec, vcc
    s_cbranch_execz K2_RT22
    buffer_load_dwordx4 v[96:99], v189, s[32:35], s80 offen sc1
K2_RT22:
    s_mov_b64 exec, -1
    v_bitop3_b32 v188, v103, s36, v214 bitop3:0x28
    s_nop 1
    v_or_b32_dpp v188, v188, v188 quad_perm:[1,0,3,2] row_mask:0xf bank_mask:0xf
    s_nop 1
    v_or_b32_dpp v188, v188, v188 quad_perm:[2,3,0,1] row_mask:0xf bank_mask:0xf
    s_nop 1
    v_or_b32_dpp v188, v188, v188 row_half_mirror row_mask:0xf bank_mask:0xf
    v_cmp_ne_u32 vcc, 0, v188
    s_and_b64 exec, exec, vcc
    s_cbranch_execz K2_RT23
    buffer_load_dwordx4 v[100:103], v189, s[32:35], s81 offen sc1
K2_RT23:
    s_mov_b64 exec, -1
    s_waitcnt vmcnt(0)
    s_branch K2_CHK2
K2_RETRY3:
    s_sub_u32 s101, s101, 1
    s_cbranch_scc1 K2_END
    s_waitcnt vmcnt(0)
    v_bitop3_b32 v188, v103, s36, v214 bitop3:0x28
    s_nop 1
    v_or_b32_dpp v188, v188, v188 quad_perm:[1,0,3,2] row_mask:0xf bank_mask:0xf
    s_nop 1
    v_or_b32_dpp v188, v188, v188 quad_perm:[2,3,0,1] row_mask:0xf bank_mask:0xf
    s_nop 1
    v_or_b32_dpp v188, v188, v188 row_half_mirror row_mask:0xf bank_mask:0xf
    v_cmp_ne_u32 vcc, 0, v188
    s_and_b64 exec, exec, vcc
    s_cbranch_execz K2_RT33
    buffer_load_dwordx4 v[100:103], v189, s[32:35], s81 offen sc1
K2_RT33:
    s_mov_b64 exec, -1
    s_waitcnt vmcnt(0)
    s_branch K2_CHK3
K1_EXT:
    s_mov_b32 s14, 0x0f0f0f0f
    s_mov_b32 s15, s14
    ds_read_b32 v104, v6 offset:32
    ds_read_b128 v[8:11], v3 offset:128
    ds_read_b32 v105, v6 offset:3360
    ds_read_b128 v[16:19], v3 offset:13440
    ds_read_b32 v106, v6 offset:6688
    ds_read_b128 v[24:27], v3 offset:26752
    ds_read_b32 v107, v6 offset:10016
    ds_read_b128 v[32:35], v3 offset:40064
    s_waitcnt lgkmcnt(0)
    v_cmp_le_u32 vcc, 553648128, v108
    v_and_or_b32 v11, v104, v15, v108
    s_and_b64 exec, vcc, s[14:15]
    s_cbranch_execz K1_EX0
    buffer_store_dwordx4 v[8:11], v4, s[32:35], s10 offen sc1
K1_EX0:
    s_mov_b64 exec, -1
    s_add_u32 s10, s10, 2105344
    v_cmp_le_u32 vcc, 553648128, v109
    v_and_or_b32 v19, v105, v15, v109
    s_and_b64 exec, vcc, s[14:15]
    s_cbranch_execz K1_EX1
    buffer_store_dwordx4 v[16:19], v4, s[32:35], s10 offen sc1
K1_EX1:
    s_mov_b64 exec, -1
    s_add_u32 s10, s10, 2105344
    v_cmp_le_u32 vcc, 553648128, v110
    v_and_or_b32 v27, v106, v15, v110
    s_and_b64 exec, vcc, s[14:15]
    s_cbranch_execz K1_EX2
    buffer_store_dwordx4 v[24:27], v4, s[32:35], s10 offen sc1
K1_EX2:
    s_mov_b64 exec, -1
    s_add_u32 s10, s10, 2105344
    v_cmp_le_u32 vcc, 553648128, v111
    v_and_or_b32 v35, v107, v15, v111
    s_and_b64 exec, vcc, s[14:15]
    s_cbranch_execz K1_EX3
    buffer_store_dwordx4 v[32:35], v4, s[32:35], s10 offen sc1
K1_EX3:
    s_mov_b64 exec, -1
    s_add_u32 s10, s10, 2105344
    s_branch K1_EXTR
K1_OVF:
    v_lshrrev_b32 v72, 16, v112
    v_lshrrev_b32 v76, 18, v112
    v_sub_u32 v72, v72, v76
    v_lshrrev_b32 v73, 16, v113
    v_lshrrev_b32 v76, 18, v113
    v_sub_u32 v73, v73, v76
    v_lshrrev_b32 v74, 16, v114
    v_lshrrev_b32 v76, 18, v114
    v_sub_u32 v74, v74, v76
    v_lshrrev_b32 v75, 16, v115
    v_lshrrev_b32 v76, 18, v115
    v_sub_u32 v75, v75, v76
    v_add_u32 v77, v72, v73
    v_add_u32 v78, v77, v74
    v_add_u32 v79, v78, v75
    v_mov_b32 v1, v79
    s_nop 1
    v_add_u32_dpp v1, v1, v1 row_shr:1 row_mask:0xf bank_mask:0xf bound_ctrl:0
    s_nop 1
    v_add_u32_dpp v1, v1, v1 row_shr:2 row_mask:0xf bank_mask:0xf bound_ctrl:0
    s_nop 1
    v_add_u32_dpp v1, v1, v1 row_shr:4 row_mask:0xf bank_mask:0xf bound_ctrl:0
    s_nop 1
    v_add_u32_dpp v1, v1, v1 row_shr:8 row_mask:0xf bank_mask:0xf bound_ctrl:0
    s_nop 1
    v_add_u32_dpp v1, v1, v1 row_bcast:15 row_mask:0xa bank_mask:0xf
    s_nop 1
    v_add_u32_dpp v1, v1, v1 row_bcast:31 row_mask:0xc bank_mask:0xf
    s_nop 0
    v_sub_u32 v76, v1, v79
    v_add_u32 v79, v76, v78
    v_add_u32 v78, v76, v77
    v_add_u32 v77, v76, v72
    v_lshl_or_b32 v76, v72, 16, v76
    v_lshl_or_b32 v77, v73, 16, v77
    v_lshl_or_b32 v78, v74, 16, v78
    v_lshl_or_b32 v79, v75, 16, v79
    s_waitcnt lgkmcnt(0)
    ds_write_b128 v172, v[76:79] offset:52736
    v_min_u32 v108, 255, v108
    v_min_u32 v109, 255, v109
    v_min_u32 v110, 255, v110
    v_min_u32 v111, 255, v111
    s_lshl_b32 s15, s12, 2
    s_add_u32 s15, s15, 23068672
    s_add_u32 s64, s8, s15
    s_addc_u32 s65, s9, 0
    s_mov_b32 s66, 262144
    s_mov_b32 s67, 0x20000
    v_lshlrev_b32 v1, 12, v254
    buffer_store_dword v76, v1, s[64:67], 0 offen offset:0 sc1
    buffer_store_dword v77, v1, s[64:67], 0 offen offset:1024 sc1
    buffer_store_dword v78, v1, s[64:67], 0 offen offset:2048 sc1
    buffer_store_dword v79, v1, s[64:67], 0 offen offset:3072 sc1
    s_add_u32 s15, s13, 17825792
    s_add_u32 s64, s8, s15
    s_addc_u32 s65, s9, 0
    s_mov_b32 s66, 12500
    s_mov_b32 s67, 0x20000
    s_lshr_b32 s15, s13, 2
    s_add_u32 s15, s15, 22020096
    s_add_u32 s68, s8, s15
    s_addc_u32 s69, s9, 0
    s_mov_b32 s70, 3125
    s_mov_b32 s71, 0x20000
    v_cndmask_b32 v30, v24, v30, s[78:79]
    v_cndmask_b32 v38, 0, v38, s[78:79]
    ds_read_u16 v40, v24 offset:50736
    ds_read_u16 v41, v25 offset:50736
    ds_read_u16 v42, v26 offset:50736
    ds_read_u16 v43, v27 offset:50736
    ds_read_u16 v44, v28 offset:50736
    ds_read_u16 v45, v29 offset:50736
    ds_read_u16 v46, v30 offset:50736
    s_waitcnt lgkmcnt(0)
    v_lshrrev_b32 v1, 2, v32
    v_sub_u32 v1, v32, v1
    v_add_u32 v40, v40, v1
    v_cmp_le_u32 vcc, 48, v32
    v_lshlrev_b32 v48, 2, v40
    s_and_saveexec_b64 s[14:15], vcc
    s_cbranch_execz K1_OV3_0
    buffer_store_byte v23, v40, s[68:71], 0 offen sc1
    buffer_store_dword v16, v48, s[64:67], 0 offen sc1
K1_OV3_0:
    s_mov_b64 exec, -1
    v_lshrrev_b32 v1, 2, v33
    v_sub_u32 v1, v33, v1
    v_add_u32 v41, v41, v1
    v_cmp_le_u32 vcc, 48, v33
    v_lshlrev_b32 v49, 2, v41
    s_and_saveexec_b64 s[14:15], vcc
    s_cbranch_execz K1_OV3_1
    buffer_store_byte v23, v41, s[68:71], 0 offen sc1
    buffer_store_dword v17, v49, s[64:67], 0 offen sc1
K1_OV3_1:
    s_mov_b64 exec, -1
    v_lshrrev_b32 v1, 2, v34
    v_sub_u32 v1, v34, v1
    v_add_u32 v42, v42, v1
    v_cmp_le_u32 vcc, 48, v34
    v_lshlrev_b32 v50, 2, v42
    s_and_saveexec_b64 s[14:15], vcc
    s_cbranch_execz K1_OV3_2
    buffer_store_byte v23, v42, s[68:71], 0 offen sc1
    buffer_store_dword v18, v50, s[64:67], 0 offen sc1
K1_OV3_2:
    s_mov_b64 exec, -1
    v_lshrrev_b32 v1, 2, v35
    v_sub_u32 v1, v35, v1
    v_add_u32 v43, v43, v1
    v_cmp_le_u32 vcc, 48, v35
    v_lshlrev_b32 v51, 2, v43
    s_and_saveexec_b64 s[14:15], vcc
    s_cbranch_execz K1_OV3_3
    buffer_store_byte v23, v43, s[68:71], 0 offen sc1
    buffer_store_dword v19, v51, s[64:67], 0 offen sc1
K1_OV3_3:
    s_mov_b64 exec, -1
    v_lshrrev_b32 v1, 2, v36
    v_sub_u32 v1, v36, v1
    v_add_u32 v44, v44, v1
    v_cmp_le_u32 vcc, 48, v36
    v_lshlrev_b32 v52, 2, v44
    s_and_saveexec_b64 s[14:15], vcc
    s_cbranch_execz K1_OV3_4
    buffer_store_byte v31, v44, s[68:71], 0 offen sc1
    buffer_store_dword v20, v52, s[64:67], 0 offen sc1
K1_OV3_4:
    s_mov_b64 exec, -1
    v_lshrrev_b32 v1, 2, v37
    v_sub_u32 v1, v37, v1
    v_add_u32 v45, v45, v1
    v_cmp_le_u32 vcc, 48, v37
    v_lshlrev_b32 v53, 2, v45
    s_and_saveexec_b64 s[14:15], vcc
    s_cbranch_execz K1_OV3_5
    buffer_store_byte v31, v45, s[68:71], 0 offen sc1
    buffer_store_dword v21, v53, s[64:67], 0 offen sc1
K1_OV3_5:
    s_mov_b64 exec, -1
    v_lshrrev_b32 v1, 2, v38
    v_sub_u32 v1, v38, v1
    v_add_u32 v46, v46, v1
    v_cmp_le_u32 vcc, 48, v38
    v_lshlrev_b32 v54, 2, v46
    s_and_saveexec_b64 s[14:15], vcc
    s_cbranch_execz K1_OV3_6
    buffer_store_byte v39, v46, s[68:71], 0 offen sc1
    buffer_store_dword v22, v54, s[64:67], 0 offen sc1
K1_OV3_6:
    s_mov_b64 exec, -1
    s_waitcnt vmcnt(0)
    s_barrier
    s_branch K1_OUT
K2_XT1:
    s_mov_b32 s97, 1
    v_cmp_le_u32 vcc, 822083584, v188
    v_mov_b32 v166, 2180
    s_cbranch_vccz K2_XT1A
    ds_write_b32 v166, v171
K2_XT1A:
    s_mov_b32 s10, 0xf0f0f0f0
    s_mov_b32 s11, s10
    v_and_b32 v166, 12, v168
    v_add_u32 v166, 32, v166
    v_and_b32 v164, 64, v189
    v_mul_u32_u24 v164, 127, v164
    v_add_u32 v164, v164, v189
    v_add_u32 v165, 16384, v164
    v_mov_b32 v167, 0x7ffffff0
    v_cndmask_b32 v204, v91, v95, s[10:11]
    v_cndmask_b32 v206, v208, v209, s[10:11]
    v_cmp_le_u32 vcc, 553648128, v204
    v_sub_u32_sdwa v204, v204, v166 dst_sel:DWORD dst_unused:UNUSED_PAD src0_sel:BYTE_3 src1_sel:DWORD
    s_nop 0
    v_cndmask_b32 v164, v167, v164, vcc
    v_cndmask_b32 v205, v99, v103, s[10:11]
    v_cndmask_b32 v207, v210, v211, s[10:11]
    v_cmp_le_u32 vcc, 553648128, v205
    v_sub_u32_sdwa v205, v205, v166 dst_sel:DWORD dst_unused:UNUSED_PAD src0_sel:BYTE_3 src1_sel:DWORD
    s_nop 0
    v_cndmask_b32 v165, v167, v165, vcc
    s_add_u32 s32, s32, 8421376
    s_addc_u32 s33, s33, 0
    buffer_load_dwordx4 v[132:135], v164, s[32:35], 0 offen sc1
    buffer_load_dwordx4 v[136:139], v165, s[32:35], 0 offen sc1
    v_med3_i32 v166, v204, 0, 3
    v_med3_i32 v167, v205, 0, 3
    v_add_u32 v166, v166, v167
    v_mov_b32 v167, 2176
    v_cmpx_lt_u32 vcc, 0, v166
    ds_add_u32 v167, v166
    s_mov_b64 exec, -1
    s_branch K2_XT1R
K2_XT2:
K2_XVa:
    s_mov_b64 s[10:11], 0
    v_bitop3_b32 v166, v135, s36, v214 bitop3:0x28
    v_cmp_ne_u32 s[86:87], 0, v166
    v_cmp_gt_u32 vcc, 0x7ffffff0, v164
    s_and_b64 vcc, vcc, s[86:87]
    s_or_b64 s[10:11], s[10:11], vcc
    v_bitop3_b32 v166, v139, s36, v214 bitop3:0x28
    v_cmp_ne_u32 s[86:87], 0, v166
    v_cmp_gt_u32 vcc, 0x7ffffff0, v165
    s_and_b64 vcc, vcc, s[86:87]
    s_or_b64 s[10:11], s[10:11], vcc
    s_cbranch_scc0 K2_XWa
    s_sub_u32 s101, s101, 1
    s_cbranch_scc1 K2_END
    buffer_load_dwordx4 v[132:135], v164, s[32:35], 0 offen sc1
    buffer_load_dwordx4 v[136:139], v165, s[32:35], 0 offen sc1
    s_waitcnt vmcnt(0)
    s_branch K2_XVa
K2_XWa:
    v_and_b32 v140, 255, v132
    v_lshlrev_b32 v140, 2, v140
    ds_read_b32 v140, v140 offset:6400
    v_and_b32 v141, 255, v133
    v_lshlrev_b32 v141, 2, v141
    ds_read_b32 v141, v141 offset:6400
    v_and_b32 v142, 255, v134
    v_lshlrev_b32 v142, 2, v142
    ds_read_b32 v142, v142 offset:6400
    v_and_b32 v135, 0x0f0f0f, v135
    v_and_b32 v143, 255, v136
    v_lshlrev_b32 v143, 2, v143
    ds_read_b32 v143, v143 offset:6400
    v_and_b32 v144, 255, v137
    v_lshlrev_b32 v144, 2, v144
    ds_read_b32 v144, v144 offset:6400
    v_and_b32 v145, 255, v138
    v_lshlrev_b32 v145, 2, v145
    ds_read_b32 v145, v145 offset:6400
    v_and_b32 v139, 0x0f0f0f, v139
    s_waitcnt lgkmcnt(0)
    v_perm_b32 v146, v135, v132, s64
    v_lshl_add_u32 v146, v146, 5, v206
    v_cmpx_lt_i32 vcc, 0, v204
    ds_add_rtn_u32 v140, v140, v171 offset:2112
    s_mov_b64 exec, -1
    v_perm_b32 v147, v135, v133, s65
    v_lshl_add_u32 v147, v147, 5, v206
    v_cmpx_lt_i32 vcc, 1, v204
    ds_add_rtn_u32 v141, v141, v171 offset:2112
    s_mov_b64 exec, -1
    v_perm_b32 v148, v135, v134, s66
    v_lshl_add_u32 v148, v148, 5, v206
    v_cmpx_lt_i32 vcc, 2, v204
    ds_add_rtn_u32 v142, v142, v171 offset:2112
    s_mov_b64 exec, -1
    v_perm_b32 v149, v139, v136, s64
    v_lshl_add_u32 v149, v149, 5, v207
    v_cmpx_lt_i32 vcc, 0, v205
    ds_add_rtn_u32 v143, v143, v171 offset:2112
    s_mov_b64 exec, -1
    v_perm_b32 v150, v139, v137, s65
    v_lshl_add_u32 v150, v150, 5, v207
    v_cmpx_lt_i32 vcc, 1, v205
    ds_add_rtn_u32 v144, v144, v171 offset:2112
    s_mov_b64 exec, -1
    v_perm_b32 v151, v139, v138, s66
    v_lshl_add_u32 v151, v151, 5, v207
    v_cmpx_lt_i32 vcc, 2, v205
    ds_add_rtn_u32 v145, v145, v171 offset:2112
    s_mov_b64 exec, -1
    s_waitcnt lgkmcnt(0)
    v_cmpx_lt_i32 vcc, 0, v204
    ds_write2st64_b32 v140, v132, v146 offset0:0 offset1:84
    s_mov_b64 exec, -1
    v_cmpx_lt_i32 vcc, 1, v204
    ds_write2st64_b32 v141, v133, v147 offset0:0 offset1:84
    s_mov_b64 exec, -1
    v_cmpx_lt_i32 vcc, 2, v204
    ds_write2st64_b32 v142, v134, v148 offset0:0 offset1:84
    s_mov_b64 exec, -1
    v_cmpx_lt_i32 vcc, 0, v205
    ds_write2st64_b32 v143, v136, v149 offset0:0 offset1:84
    s_mov_b64 exec, -1
    v_cmpx_lt_i32 vcc, 1, v205
    ds_write2st64_b32 v144, v137, v150 offset0:0 offset1:84
    s_mov_b64 exec, -1
    v_cmpx_lt_i32 vcc, 2, v205
    ds_write2st64_b32 v145, v138, v151 offset0:0 offset1:84
    s_mov_b64 exec, -1
    s_waitcnt lgkmcnt(0)
    s_branch K2_XT2R
K2_OVF:
    s_mov_b32 s80, 1
    s_mov_b32 s83, 0
    s_mov_b32 s77, 0
    s_mov_b32 s15, s76
    v_mov_b32 v190, 0xffff0000
    v_or_b32 v189, s39, v190
    v_mov_b32 v190, 0x7fffff00
    v_lshl_add_u32 v188, v254, 2, s15
    s_sub_u32 s73, s15, s76
    ds_write2st64_b32 v188, v189, v190 offset0:0 offset1:84
    ds_write2st64_b32 v188, v189, v190 offset0:1 offset1:85
    s_add_u32 s73, s73, 127
    s_lshr_b32 s73, s73, 7
    s_sub_i32 s38, s73, 1
    s_cmp_eq_u32 s97, 0
    s_cbranch_scc1 K2_PADS0
    s_mov_b32 s97, 0
    s_waitcnt vmcnt(0)
K2_XVb:
    s_mov_b64 s[10:11], 0
    v_bitop3_b32 v166, v135, s36, v214 bitop3:0x28
    v_cmp_ne_u32 s[86:87], 0, v166
    v_cmp_gt_u32 vcc, 0x7ffffff0, v164
    s_and_b64 vcc, vcc, s[86:87]
    s_or_b64 s[10:11], s[10:11], vcc
    v_bitop3_b32 v166, v139, s36, v214 bitop3:0x28
    v_cmp_ne_u32 s[86:87], 0, v166
    v_cmp_gt_u32 vcc, 0x7ffffff0, v165
    s_and_b64 vcc, vcc, s[86:87]
    s_or_b64 s[10:11], s[10:11], vcc
    s_cbranch_scc0 K2_XWb
    s_sub_u32 s101, s101, 1
    s_cbranch_scc1 K2_END
    buffer_load_dwordx4 v[132:135], v164, s[32:35], 0 offen sc1
    buffer_load_dwordx4 v[136:139], v165, s[32:35], 0 offen sc1
    s_waitcnt vmcnt(0)
    s_branch K2_XVb
K2_XWb:
    s_branch K2_PADS0
K2_SLOW:
    s_add_u32 s81, s81, 448
    s_cmp_lt_u32 s81, s82
    s_cbranch_scc1 K2_BATCH
K2_FIND:
    s_cmp_lg_u64 s[84:85], 0
    s_cbranch_scc1 K2_GOT
    s_add_u32 s79, s79, 1
    s_cmp_ge_u32 s79, 4
    s_cbranch_scc1 K2_EPI
    s_mul_i32 s10, s12, 32896
    s_lshl_b32 s11, s79, 13
    s_add_u32 s10, s10, s11
    v_lshlrev_b32 v252, 7, v254
    buffer_load_ubyte v252, v252, s[24:27], s10 offen offset:15 sc1
    s_waitcnt vmcnt(0)
    v_cmp_lt_u32 s[84:85], s77, v252
    s_nop 3
    s_branch K2_FIND
K2_GOT:
    s_ff1_i32_b64 s10, s[84:85]
    s_bitset0_b64 s[84:85], s10
    s_lshl_b32 s11, s79, 6
    s_add_u32 s80, s10, s11
    s_mul_i32 s10, s12, 32896
    s_lshl_b32 s11, s80, 7
    s_add_u32 s10, s10, s11
    s_lshl_b32 s11, s12, 8
    s_add_u32 s11, s11, s80
    s_lshl_b32 s11, s11, 2
    s_add_u32 s11, s11, 23068672
    v_mov_b32 v188, 0
    buffer_load_ubyte v189, v188, s[24:27], s10 offen offset:15 sc1
    buffer_load_dword v190, v188, s[24:27], s11 offen sc1
    s_waitcnt vmcnt(0)
    v_readfirstlane_b32 s10, v189
    v_readfirstlane_b32 s11, v190
    s_nop 3
    s_and_b32 s83, s11, 0xffff
    s_lshr_b32 s11, s11, 16
    s_lshr_b32 s82, s10, 2
    s_sub_u32 s82, s10, s82
    s_cmp_gt_u32 s10, 48
    s_cselect_b32 s82, s11, s82
    s_lshr_b32 s10, s77, 2
    s_sub_u32 s81, s77, s10
K2_BATCH:
    s_barrier
    v_and_b32 v188, 7, v254
    v_mul_u32_u24 v189, 2688, v188
    v_add_u32 v189, 9728, v189
    v_lshlrev_b32 v188, 2, v188
    ds_write_b32 v188, v189 offset:2112
    v_add_u32 v188, s81, v255
    s_mul_i32 s10, s12, 32896
    s_lshl_b32 s11, s80, 7
    s_add_u32 s10, s10, s11
    v_mul_u32_u24 v190, 87382, v188
    v_lshrrev_b32 v190, 16, v190
    v_lshl_add_u32 v189, v190, 2, s10
    v_add_u32 v191, 8421248, v189
    v_cmp_lt_u32 vcc, 31, v190
    s_mul_i32 s11, s80, 3125
    s_add_u32 s11, s11, s83
    v_cndmask_b32 v189, v189, v191, vcc
    v_or_b32 v191, 12, v189
    v_and_b32 v192, 3, v190
    v_add_u32 v191, v191, v192
    v_cmp_le_u32 vcc, 48, v190
    v_add_u32 v190, s11, v188
    v_add_u32 v192, 22020096, v190
    v_cndmask_b32 v191, v191, v192, vcc
    v_lshlrev_b32 v190, 2, v190
    v_add_u32 v190, 17825792, v190
    v_cndmask_b32 v189, v189, v190, vcc
    s_add_u32 s10, s81, 448
    s_min_u32 s10, s10, s82
    v_cmp_gt_u32 vcc, s10, v188
    v_mov_b32 v190, 0x7ffffff0
    s_mul_i32 s86, s80, 100000
    v_cndmask_b32 v189, v190, v189, vcc
    v_cndmask_b32 v191, v190, v191, vcc
    buffer_load_dword v189, v189, s[24:27], 0 offen sc1
    buffer_load_ubyte v191, v191, s[24:27], 0 offen sc1
    s_waitcnt lgkmcnt(0)
    s_barrier
    s_and_saveexec_b64 s[10:11], vcc
    s_waitcnt vmcnt(0)
    v_and_b32 v188, 255, v189
    v_lshlrev_b32 v188, 2, v188
    ds_read_b32 v188, v188 offset:6400
    v_bfe_u32 v190, v189, 8, 8
    v_and_b32 v191, 15, v191
    v_lshl_or_b32 v191, v191, 8, v190
    v_mov_b32 v190, 4
    v_lshl_add_u32 v191, v191, 5, s86
    s_waitcnt lgkmcnt(0)
    ds_add_rtn_u32 v188, v188, v190 offset:2112
    s_waitcnt lgkmcnt(0)
    ds_write2st64_b32 v188, v189, v191 offset0:0 offset1:84
    s_mov_b64 exec, -1
    s_waitcnt lgkmcnt(0)
    s_barrier
    s_lshl_b32 s10, s3, 2
    v_mov_b32 v188, s10
    ds_read_b32 v188, v188 offset:2112
    v_mov_b32 v180, 0
    v_mov_b32 v181, 0
    v_mov_b32 v182, 0
    v_mov_b32 v183, 0
    v_mov_b32 v184, 0
    v_mov_b32 v185, 0
    v_mov_b32 v186, 0
    v_mov_b32 v187, 0
    v_lshrrev_b32 v189, 3, v254
    v_lshl_add_u32 v247, v189, 4, s76
    v_and_b32 v189, 31, v254
    v_lshl_add_u32 v249, v189, 2, s76
    v_lshrrev_b32 v190, 1, v254
    v_lshl_add_u32 v251, v190, 2, s76
    v_add_u32 v251, 21504, v251
    v_and_b32 v189, 44, v254
    v_add_u32 v248, s76, v189
    s_waitcnt lgkmcnt(0)
    v_readfirstlane_b32 s15, v188
    s_nop 3
    v_mov_b32 v190, 0xffff0000
    v_or_b32 v189, s39, v190
    v_mov_b32 v190, 0x7fffff00
    v_lshl_add_u32 v188, v254, 2, s15
    s_sub_u32 s73, s15, s76
    ds_write2st64_b32 v188, v189, v190 offset0:0 offset1:84
    ds_write2st64_b32 v188, v189, v190 offset0:1 offset1:85
    s_add_u32 s73, s73, 127
    s_lshr_b32 s73, s73, 7
    s_sub_i32 s38, s73, 1
K2_LAST:
    s_branch K2_GO
.section .rodata,"a"
.p2align 6
.amdhsa_kernel standalone__edge_featured_mpnn_gatedgcn__graph_kernel
  .amdhsa_next_free_vgpr 256
  .amdhsa_next_free_sgpr 102
  .amdhsa_accum_offset 256
  .amdhsa_group_segment_fixed_size 0
  .amdhsa_kernarg_size 96
  .amdhsa_user_sgpr_count 2
  .amdhsa_user_sgpr_kernarg_segment_ptr 1
  .amdhsa_system_sgpr_workgroup_id_x 1
.end_amdhsa_kernel
```

```asm
; @launch grid=(256,1,1) block=(512,1,1) lds=157696
.amdgcn_target "amdgcn-amd-amdhsa--gfx950"
.text
.globl standalone__edge_featured_mpnn_gatedgcn__graph_kernel
.p2align 8
.type standalone__edge_featured_mpnn_gatedgcn__graph_kernel,@function
standalone__edge_featured_mpnn_gatedgcn__graph_kernel:
    s_cmp_ge_u32 s2, 256
    s_cbranch_scc1 K2_END
    s_load_dwordx4 s[44:47], s[0:1], 16
    s_load_dwordx2 s[8:9], s[0:1], 88
    s_load_dwordx4 s[40:43], s[0:1], 0
    s_load_dwordx8 s[48:55], s[0:1], 32
    s_load_dwordx4 s[56:59], s[0:1], 64
    s_getpc_b64 s[86:87]
K2_PC:
    v_lshlrev_b32 v252, 7, v0
    v_min_u32 v252, K2_LAST-K2_PC, v252
    v_cmp_gt_u32 vcc, 192, v0
    s_cbranch_vccz K2_NOCPF
    global_load_dword v253, v252, s[86:87]
K2_NOCPF:
    v_mov_b32 v255, v0
    v_lshrrev_b32 v188, 6, v0
    v_and_b32 v254, 63, v0
    v_readfirstlane_b32 s7, v188
    s_and_b32 s10, s2, 7
    s_lshr_b32 s11, s2, 3
    s_lshl_b32 s10, s10, 5
    s_add_u32 s12, s10, s11
    s_mul_i32 s13, s12, 12500
    v_lshlrev_b32 v189, 4, v0
    v_lshlrev_b32 v1, 3, v0
    v_lshlrev_b32 v2, 2, v0
    v_mov_b32 v3, 0
    v_and_b32 v4, 0x3fc, v2
    ds_write_b32 v4, v3 offset:6400
    s_and_b32 s10, s7, 3
    s_lshr_b32 s3, s7, 2
    s_lshl1_add_u32 s3, s10, s3
    s_xor_b32 s3, s3, 1
    s_movk_i32 s14, 8192
    s_movk_i32 s15, 12288
    s_waitcnt lgkmcnt(0)
    s_add_u32 s64, s46, s13
    s_addc_u32 s65, s47, 0
    s_mov_b32 s66, 12500
    s_mov_b32 s67, 0x20000
    s_add_u32 s68, s44, s13
    s_addc_u32 s69, s45, 0
    s_mov_b32 s70, 12500
    s_mov_b32 s71, 0x20000
    buffer_load_dwordx4 v[8:11], v189, s[64:67], 0 offen nt
    buffer_load_dwordx2 v[12:13], v1, s[64:67], s14 offen nt
    buffer_load_dword v14, v2, s[64:67], s15 offen nt
    s_barrier
    buffer_load_dwordx4 v[16:19], v189, s[68:71], 0 offen nt
    buffer_load_dwordx2 v[20:21], v1, s[68:71], s14 offen nt
    buffer_load_dword v22, v2, s[68:71], s15 offen nt
    s_add_u32 s10, s8, 24117248
    s_addc_u32 s11, s9, 0
    s_load_dword s100, s[10:11], 0
    v_lshrrev_b32 v1, 3, v0
    v_lshlrev_b32 v170, 2, v1
    v_and_b32 v197, 7, v0
    v_and_b32 v5, 16, v0
    v_lshlrev_b32 v5, 1, v5
    v_xor_b32 v5, v5, v189
    v_lshlrev_b32 v172, 4, v254
    v_and_b32 v241, 16, v254
    v_lshlrev_b32 v241, 2, v241
    v_xor_b32 v234, v241, v172
    v_and_b32 v241, 0x70, v234
    s_mov_b32 s16, s40
    s_mov_b32 s17, s41
    s_mov_b32 s18, 6400000
    s_mov_b32 s19, 0x20000
    s_mov_b32 s60, 85599
    s_mov_b32 s61, 4294967100
    s_movk_i32 s62, 2000
    v_mov_b32 v7, 87382
    s_mov_b32 s10, 0
    v_lshl_add_u32 v56, v254, 10, s10
    v_add_u32 v57, 256, v56
    v_add_u32 v58, 512, v56
    v_add_u32 v59, 768, v56
    v_and_b32 v60, 127, v255
    v_lshl_add_u32 v60, v60, 9, s10
    v_add_u32 v61, 256, v60
    v_lshl_add_u32 v62, v254, 8, s10
    v_lshrrev_b32 v23, 6, v255
    v_lshrrev_b32 v31, 7, v255
    v_add_u32 v31, 8, v31
    v_mov_b32 v39, 12
    v_cmp_gt_u32 s[78:79], 53, v255
    s_mov_b32 s11, 32896
    v_lshlrev_b32 v3, 4, v197
    v_mad_u32_u24 v4, v1, s11, v3
    v_mul_u32_u24 v6, 52, v1
    v_lshl_add_u32 v6, v197, 2, v6
    v_lshlrev_b32 v3, 2, v6
    v_add_u32 v3, 104448, v3
    v_add_u32 v6, 91136, v6
    v_mov_b32 v214, 0xf0f0f0
    v_mov_b32 v15, 0x0f0f0f
    s_waitcnt vmcnt(3)
    v_mul_u32_u24 v48, s60, v8
    v_mul_u32_u24 v49, s60, v9
    v_mul_u32_u24 v50, s60, v10
    v_mul_u32_u24 v51, s60, v11
    v_mul_u32_u24 v52, s60, v12
    v_mul_u32_u24 v53, s60, v13
    v_lshrrev_b32 v48, 24, v48
    v_lshrrev_b32 v49, 24, v49
    v_lshrrev_b32 v50, 24, v50
    v_lshrrev_b32 v51, 24, v51
    v_lshrrev_b32 v52, 24, v52
    v_lshrrev_b32 v53, 24, v53
    v_lshl_add_u32 v24, v48, 2, s62
    ds_add_rtn_u32 v32, v24, v7 offset:4400
    v_lshl_add_u32 v25, v49, 2, s62
    ds_add_rtn_u32 v33, v25, v7 offset:4400
    v_lshl_add_u32 v26, v50, 2, s62
    ds_add_rtn_u32 v34, v26, v7 offset:4400
    v_lshl_add_u32 v27, v51, 2, s62
    ds_add_rtn_u32 v35, v27, v7 offset:4400
    v_lshl_add_u32 v28, v52, 2, s62
    ds_add_rtn_u32 v36, v28, v7 offset:4400
    v_lshl_add_u32 v29, v53, 2, s62
    ds_add_rtn_u32 v37, v29, v7 offset:4400
    v_mad_i32_i24 v8, v48, s61, v8
    v_or_b32 v8, v8, v56
    v_mad_i32_i24 v9, v49, s61, v9
    v_or_b32 v9, v9, v57
    v_mad_i32_i24 v10, v50, s61, v10
    v_or_b32 v10, v10, v58
    v_mad_i32_i24 v11, v51, s61, v11
    v_or_b32 v11, v11, v59
    v_mad_i32_i24 v12, v52, s61, v12
    v_or_b32 v12, v12, v60
    v_mad_i32_i24 v13, v53, s61, v13
    v_or_b32 v13, v13, v61
    s_waitcnt lgkmcnt(5)
    v_lshrrev_b32 v32, 16, v32
    v_min_u32 v40, 48, v32
    v_mad_u32_u24 v40, v24, 13, v40
    v_lshlrev_b32 v48, 2, v40
    ds_write_b8 v40, v23 offset:65136
    s_waitcnt lgkmcnt(5)
    v_lshrrev_b32 v33, 16, v33
    v_min_u32 v41, 48, v33
    v_mad_u32_u24 v41, v25, 13, v41
    v_lshlrev_b32 v49, 2, v41
    ds_write_b8 v41, v23 offset:65136
    s_waitcnt lgkmcnt(5)
    v_lshrrev_b32 v34, 16, v34
    v_min_u32 v42, 48, v34
    v_mad_u32_u24 v42, v26, 13, v42
    v_lshlrev_b32 v50, 2, v42
    ds_write_b8 v42, v23 offset:65136
    s_waitcnt lgkmcnt(5)
    v_lshrrev_b32 v35, 16, v35
    v_min_u32 v43, 48, v35
    v_mad_u32_u24 v43, v27, 13, v43
    v_lshlrev_b32 v51, 2, v43
    ds_write_b8 v43, v23 offset:65136
    s_waitcnt lgkmcnt(5)
    v_lshrrev_b32 v36, 16, v36
    v_min_u32 v44, 48, v36
    v_mad_u32_u24 v44, v28, 13, v44
    v_lshlrev_b32 v52, 2, v44
    ds_write_b8 v44, v31 offset:65136
    s_waitcnt lgkmcnt(5)
    v_lshrrev_b32 v37, 16, v37
    v_min_u32 v45, 48, v37
    v_mad_u32_u24 v45, v29, 13, v45
    v_lshlrev_b32 v53, 2, v45
    ds_write_b8 v45, v31 offset:65136
    s_cmp_lg_u32 s7, 0
    s_cbranch_scc1 K1_NO7
    s_mov_b64 exec, s[78:79]
    s_waitcnt lgkmcnt(0)
    v_mul_u32_u24 v54, s60, v14
    v_lshrrev_b32 v54, 24, v54
    v_lshl_add_u32 v30, v54, 2, s62
    ds_add_rtn_u32 v38, v30, v7 offset:4400
    v_mad_i32_i24 v14, v54, s61, v14
    v_or_b32 v14, v14, v62
    s_waitcnt lgkmcnt(0)
    v_lshrrev_b32 v38, 16, v38
    v_min_u32 v46, 48, v38
    v_mad_u32_u24 v46, v30, 13, v46
    v_lshlrev_b32 v54, 2, v46
    ds_write_b8 v46, v39 offset:65136
    s_waitcnt vmcnt(0)
    v_lshl_add_u32 v22, v22, 16, v14
    ds_write_b32 v54, v22 offset:448
    s_mov_b64 exec, -1
K1_NO7:
    s_mov_b32 s64, s50
    s_mov_b32 s65, s51
    s_mov_b32 s66, 8192
    s_mov_b32 s67, 0x20000
    buffer_load_dwordx4 v[64:67], v5, s[64:67], 0 offen
    s_mov_b32 s68, s52
    s_mov_b32 s69, s53
    s_mov_b32 s70, 2048
    s_mov_b32 s71, 0x20000
    buffer_load_dwordx4 v[68:71], v5, s[68:71], 0 offen
    s_lshl_b32 s10, s7, 10
    s_mov_b32 s64, s48
    s_mov_b32 s65, s49
    s_add_u32 m0, s10, 34304
    s_nop 0
    buffer_load_dwordx4 v5, s[64:67], 0 offen lds
    s_mov_b32 s64, s56
    s_mov_b32 s65, s57
    s_add_u32 m0, s10, 26112
    s_nop 0
    buffer_load_dwordx4 v5, s[64:67], 0 offen lds
    s_mov_b32 s64, s54
    s_mov_b32 s65, s55
    s_add_u32 m0, s10, 9728
    s_nop 0
    buffer_load_dwordx4 v5, s[64:67], 0 offen lds
    s_waitcnt vmcnt(5)
    v_lshl_add_u32 v16, v16, 16, v8
    ds_write_b32 v48, v16 offset:448
    v_lshl_add_u32 v17, v17, 16, v9
    ds_write_b32 v49, v17 offset:448
    v_lshl_add_u32 v18, v18, 16, v10
    ds_write_b32 v50, v18 offset:448
    v_lshl_add_u32 v19, v19, 16, v11
    ds_write_b32 v51, v19 offset:448
    v_lshl_add_u32 v20, v20, 16, v12
    ds_write_b32 v52, v20 offset:448
    v_lshl_add_u32 v21, v21, 16, v13
    ds_write_b32 v53, v21 offset:448
    s_lshl_b32 s15, s12, 7
    s_add_u32 s32, s8, s15
    s_addc_u32 s33, s9, 0
    s_mov_b32 s34, 16809984
    s_mov_b32 s35, 0x20000
    s_waitcnt lgkmcnt(0)
    s_add_u32 s100, s100, 1
    s_and_b32 s10, s100, 15
    s_and_b32 s11, s100, 0xf0
    s_mul_i32 s36, s10, 0x1010
    s_lshl_b32 s11, s11, 16
    s_xor_b32 s36, s36, 0xf000
    s_or_b32 s36, s36, s11
    s_mov_b32 s101, 300000
    s_barrier
    ds_read_b128 v[112:115], v172 offset:6400
    ds_read_u16 v108, v170 offset:6402
    ds_read_b32 v104, v6 offset:0
    ds_read_b128 v[88:91], v3 offset:0
    ds_read_u16 v109, v170 offset:6658
    ds_read_b32 v105, v6 offset:3328
    ds_read_b128 v[92:95], v3 offset:13312
    ds_read_u16 v110, v170 offset:6914
    ds_read_b32 v106, v6 offset:6656
    ds_read_b128 v[96:99], v3 offset:26624
    ds_read_u16 v111, v170 offset:7170
    ds_read_b32 v107, v6 offset:9984
    ds_read_b128 v[100:103], v3 offset:39936
    s_waitcnt lgkmcnt(12)
    v_max3_u32 v1, v112, v113, v114
    v_max_u32 v1, v1, v115
    v_cmp_le_u32 vcc, 3211264, v1
    s_mov_b32 s10, 0
    s_cbranch_vccnz K1_OVF
K1_OUT:
    s_waitcnt lgkmcnt(9)
    v_lshl_or_b32 v108, v108, 24, s36
    v_and_or_b32 v91, v104, v15, v108
    buffer_store_dwordx4 v[88:91], v4, s[32:35], s10 offen sc1
    s_add_u32 s10, s10, 2105344
    s_waitcnt lgkmcnt(6)
    v_lshl_or_b32 v109, v109, 24, s36
    v_and_or_b32 v95, v105, v15, v109
    buffer_store_dwordx4 v[92:95], v4, s[32:35], s10 offen sc1
    s_add_u32 s10, s10, 2105344
    s_waitcnt lgkmcnt(3)
    v_lshl_or_b32 v110, v110, 24, s36
    v_and_or_b32 v99, v106, v15, v110
    buffer_store_dwordx4 v[96:99], v4, s[32:35], s10 offen sc1
    s_add_u32 s10, s10, 2105344
    s_waitcnt lgkmcnt(0)
    v_lshl_or_b32 v111, v111, 24, s36
    v_and_or_b32 v103, v107, v15, v111
    buffer_store_dwordx4 v[100:103], v4, s[32:35], s10 offen sc1
    s_add_u32 s10, s10, 2105344
    v_max3_u32 v1, v108, v109, v110
    v_max_u32 v1, v1, v111
    v_cmp_le_u32 vcc, 553648128, v1
    s_cbranch_vccnz K1_EXT
K1_EXTR:
    s_lshr_b32 s10, s3, 1
    s_mul_i32 s10, s10, 49
    s_bitcmp1_b32 s3, 0
    s_cselect_b32 s72, 20, -4
    s_cselect_b32 s73, 28, 3
    s_cselect_b32 s84, 45, 20
    s_add_i32 s72, s72, s10
    s_add_i32 s73, s73, s10
    s_add_i32 s84, s84, s10
    s_add_i32 s85, s72, 32
    s_max_i32 s96, s72, 0
    s_cmp_eq_u32 s3, 7
    s_cselect_b32 s84, 196, s84
    s_cselect_b32 s85, 196, s85
    v_lshrrev_b32 v193, 5, v254
    s_mov_b32 s20, s42
    s_mov_b32 s21, s43
    s_mov_b32 s22, 25600000
    s_mov_b32 s23, 0x20000
    s_mov_b32 s28, s58
    s_mov_b32 s29, s59
    s_mov_b32 s30, 6400000
    s_mov_b32 s31, 0x20000
    s_mov_b32 s24, s8
    s_mov_b32 s25, s9
    s_mov_b32 s26, 24117376
    s_mov_b32 s27, 0x20000
    v_lshrrev_b32 v194, 5, v255
    v_and_b32 v195, 15, v255
    v_cmp_eq_u32 vcc, v194, v195
    v_and_b32 v194, 16, v255
    v_mov_b32 v195, 0x3f80
    v_lshlrev_b32 v195, v194, v195
    v_cndmask_b32 v195, 0, v195, vcc
    v_lshlrev_b32 v194, 2, v255
    v_mov_b32 v196, 0
    ds_write_b32 v194, v195
    v_bfe_u32 v195, v255, 3, 1
    v_and_b32 v201, 7, v255
    v_lshl_add_u32 v195, v195, 2, v201
    v_lshrrev_b32 v200, 6, v255
    v_cmp_eq_u32 vcc, v195, v200
    v_bfe_u32 v200, v255, 4, 2
    v_mov_b32 v195, 0x3f80
    v_cndmask_b32 v195, 0, v195, vcc
    v_cmp_lt_u32 vcc, 3, v201
    v_mul_u32_u24 v200, 0x5555, v200
    v_and_b32 v201, 60, v194
    v_cndmask_b32 v195, v195, v200, vcc
    ds_write_b32 v194, v195 offset:7424
    ds_write_b32 v201, v196 offset:9472
    ds_write_b32 v194, v196 offset:2048
    ds_write2st64_b32 v194, v196, v196 offset0:9 offset1:17
    s_movk_i32 s75, 128
    s_mul_i32 s74, s3, 5184
    s_add_u32 s74, s74, 102400
    s_movk_i32 s77, 48
    s_add_u32 s39, s96, 32
    s_lshl_b32 s11, s96, 6
    s_mov_b32 s97, 0
    v_bfe_u32 v194, v254, 4, 1
    v_and_b32 v242, 1, v254
    v_lshlrev_b32 v242, 4, v242
    v_lshlrev_b32 v245, 5, v193
    v_subrev_u32 v245, s11, v245
    v_and_b32 v195, 3, v254
    v_lshlrev_b32 v195, 3, v195
    v_lshl_add_u32 v246, v194, 5, v195
    v_subrev_u32 v246, s11, v246
    v_mul_u32_u24 v196, 130, v195
    v_and_b32 v194, 28, v254
    v_lshl_add_u32 v196, v194, 5, v196
    v_bfe_u32 v194, v254, 3, 1
    v_xor_b32 v194, v194, v193
    v_lshl_add_u32 v196, v194, 6, v196
    v_add_u32 v243, s74, v196
    v_and_b32 v194, 31, v254
    v_lshl_add_u32 v194, v194, 1, v193
    v_lshl_add_u32 v244, v194, 4, s74
    v_add_u32 v244, 4160, v244
    s_mul_i32 s76, s3, 2688
    s_add_u32 s76, s76, 9728
    v_lshrrev_b32 v194, 3, v254
    v_lshl_add_u32 v247, v194, 4, s76
    v_and_b32 v194, 31, v254
    v_lshl_add_u32 v249, v194, 2, s76
    v_lshrrev_b32 v195, 1, v254
    v_lshl_add_u32 v251, v195, 2, s76
    v_add_u32 v251, 21504, v251
    v_and_b32 v194, 44, v254
    v_add_u32 v248, s76, v194
    s_mul_i32 s10, s7, 4160
    s_add_u32 s10, s10, 69120
    v_and_b32 v202, 31, v254
    v_bfe_u32 v194, v202, 1, 1
    v_xor_b32 v194, v194, v193
    v_lshlrev_b32 v194, 6, v194
    v_lshl_add_u32 v194, v202, 7, v194
    v_lshrrev_b32 v202, 3, v202
    v_lshl_add_u32 v202, v202, 4, v194
    v_add_u32 v202, s10, v202
    v_lshrrev_b32 v194, 1, v254
    v_xor_b32 v194, v194, v254
    v_and_b32 v194, 4, v194
    v_mul_u32_u24 v194, 3, v194
    v_xor_b32 v194, v194, v254
    v_and_b32 v235, 31, v194
    v_bfe_u32 v195, v235, 1, 1
    v_xor_b32 v195, v195, v193
    v_lshlrev_b32 v195, 6, v195
    v_lshl_add_u32 v195, v235, 7, v195
    v_lshrrev_b32 v235, 3, v235
    v_lshl_add_u32 v235, v235, 4, v195
    v_add_u32 v235, s10, v235
    v_mov_b32 v177, 0xdddd
    v_lshlrev_b32 v168, 2, v197
    v_mul_u32_u24 v208, 25000, v170
    v_add_u32 v209, 6400000, v208
    v_add_u32 v210, 12800000, v208
    v_add_u32 v211, 19200000, v208
    v_mov_b32 v171, 4
    v_mov_b32 v169, 1
    v_and_b32 v199, 31, v254
    v_add_u32 v199, s96, v199
    v_lshlrev_b32 v200, 4, v199
    v_lshl_add_u32 v200, v193, 3, v200
    v_mov_b64 v[180:181], 0
    v_mov_b64 v[182:183], 0
    v_mov_b64 v[184:185], 0
    v_mov_b64 v[186:187], 0
    s_lshl_b32 s15, s3, 2
    v_mov_b32 v212, s15
    v_lshlrev_b32 v213, 2, v199
    s_mul_i32 s10, s12, 32896
    s_add_u32 s32, s8, s10
    s_addc_u32 s33, s9, 0
    s_mov_b32 s34, 32768
    s_mov_b32 s35, 0x20000
    s_movk_i32 s79, 8192
    s_movk_i32 s80, 16384
    s_movk_i32 s81, 24576
    s_mov_b32 s10, 0xbfb8aa3b
    s_waitcnt vmcnt(7)
    v_lshlrev_b32 v72, 16, v64
    v_and_b32 v73, 0xffff0000, v64
    v_lshlrev_b32 v74, 16, v65
    v_and_b32 v75, 0xffff0000, v65
    v_lshlrev_b32 v76, 16, v66
    v_and_b32 v77, 0xffff0000, v66
    v_lshlrev_b32 v78, 16, v67
    v_and_b32 v79, 0xffff0000, v67
    v_lshlrev_b32 v80, 16, v68
    v_and_b32 v81, 0xffff0000, v68
    v_lshlrev_b32 v82, 16, v69
    v_and_b32 v83, 0xffff0000, v69
    v_lshlrev_b32 v84, 16, v70
    v_and_b32 v85, 0xffff0000, v70
    v_lshlrev_b32 v86, 16, v71
    v_and_b32 v87, 0xffff0000, v71
    v_mul_f32 v72, s10, v72
    v_mul_f32 v73, s10, v73
    v_mul_f32 v74, s10, v74
    v_mul_f32 v75, s10, v75
    v_mul_f32 v76, s10, v76
    v_mul_f32 v77, s10, v77
    v_mul_f32 v78, s10, v78
    v_mul_f32 v79, s10, v79
    v_mul_f32 v80, s10, v80
    v_mul_f32 v81, s10, v81
    v_mul_f32 v82, s10, v82
    v_mul_f32 v83, s10, v83
    v_mul_f32 v84, s10, v84
    v_mul_f32 v85, s10, v85
    v_mul_f32 v86, s10, v86
    v_mul_f32 v87, s10, v87
    v_cvt_pk_bf16_f32 v64, v72, v73
    v_cvt_pk_bf16_f32 v65, v74, v75
    v_cvt_pk_bf16_f32 v66, v76, v77
    v_cvt_pk_bf16_f32 v67, v78, v79
    v_cvt_pk_bf16_f32 v68, v80, v81
    v_cvt_pk_bf16_f32 v69, v82, v83
    v_cvt_pk_bf16_f32 v70, v84, v85
    v_cvt_pk_bf16_f32 v71, v86, v87
    ds_write_b128 v189, v[64:67] offset:17920
    s_cmp_ge_u32 s7, 2
    s_cbranch_scc1 K1_NOWC
    ds_write_b128 v189, v[68:71] offset:42496
K1_NOWC:
    v_bfe_u32 v173, v254, 2, 2
    v_lshlrev_b32 v173, 7, v173
    v_lshl_add_u32 v173, v242, 2, v173
    v_and_b32 v174, 16, v254
    v_and_b32 v175, 2, v254
    v_lshl_add_u32 v174, v175, 2, v174
    v_and_b32 v175, 8, v254
    v_lshl_add_u32 v174, v175, 2, v174
    v_add_u32 v173, v173, v174
    v_lshl_add_u32 v175, v193, 10, v173
    v_lshl_add_u32 v173, v193, 12, v173
    v_xor_b32 v174, 32, v173
    v_xor_b32 v176, 32, v175
    s_lshl_b32 s10, s7, 10
    s_and_b32 s11, s7, 4
    s_mul_i32 s11, s11, -1016
    s_add_u32 s11, s11, s10
    v_xor_b32 v252, s11, v173
    s_waitcnt vmcnt(0) lgkmcnt(0)
    s_barrier
    ds_read_b64_tr_b16 v[72:73], v252 offset:9728
    ds_read_b64_tr_b16 v[76:77], v252 offset:34304
    ds_read_b64_tr_b16 v[74:75], v252 offset:10240
    ds_read_b64_tr_b16 v[78:79], v252 offset:34816
    v_add_u32 v252, s10, v172
    ds_read_b64_tr_b16 v[0:1], v173 offset:17920
    ds_read_b64_tr_b16 v[2:3], v173 offset:18432
    ds_read_b64_tr_b16 v[4:5], v173 offset:18944
    ds_read_b64_tr_b16 v[6:7], v173 offset:19456
    ds_read_b64_tr_b16 v[8:9], v173 offset:19968
    ds_read_b64_tr_b16 v[10:11], v173 offset:20480
    ds_read_b64_tr_b16 v[12:13], v173 offset:20992
    ds_read_b64_tr_b16 v[14:15], v173 offset:21504
    s_waitcnt lgkmcnt(8)
    ds_write_b128 v252, v[72:75] offset:52736
    ds_write_b128 v252, v[76:79] offset:60928
    s_waitcnt lgkmcnt(8)
    ds_read_b64_tr_b16 v[16:17], v174 offset:17920
    ds_read_b64_tr_b16 v[18:19], v174 offset:18432
    ds_read_b64_tr_b16 v[20:21], v174 offset:18944
    ds_read_b64_tr_b16 v[22:23], v174 offset:19456
    ds_read_b64_tr_b16 v[24:25], v174 offset:19968
    ds_read_b64_tr_b16 v[26:27], v174 offset:20480
    s_waitcnt lgkmcnt(8)
    ds_read_b64_tr_b16 v[28:29], v174 offset:20992
    ds_read_b64_tr_b16 v[30:31], v174 offset:21504
    ds_read_b64_tr_b16 v[64:65], v175 offset:42496
    ds_read_b64_tr_b16 v[66:67], v175 offset:43008
    ds_read_b64_tr_b16 v[68:69], v176 offset:42496
    ds_read_b64_tr_b16 v[70:71], v176 offset:43008
    s_waitcnt lgkmcnt(8)
    ds_read_b64_tr_b16 v[32:33], v173 offset:26112
    ds_read_b64_tr_b16 v[34:35], v173 offset:26624
    ds_read_b64_tr_b16 v[36:37], v173 offset:27136
    ds_read_b64_tr_b16 v[38:39], v173 offset:27648
    ds_read_b64_tr_b16 v[40:41], v173 offset:28160
    ds_read_b64_tr_b16 v[42:43], v173 offset:28672
    s_waitcnt lgkmcnt(8)
    ds_read_b64_tr_b16 v[44:45], v173 offset:29184
    ds_read_b64_tr_b16 v[46:47], v173 offset:29696
    ds_read_b64_tr_b16 v[48:49], v174 offset:26112
    ds_read_b64_tr_b16 v[50:51], v174 offset:26624
    ds_read_b64_tr_b16 v[52:53], v174 offset:27136
    ds_read_b64_tr_b16 v[54:55], v174 offset:27648
    s_waitcnt lgkmcnt(8)
    ds_read_b64_tr_b16 v[56:57], v174 offset:28160
    ds_read_b64_tr_b16 v[58:59], v174 offset:28672
    ds_read_b64_tr_b16 v[60:61], v174 offset:29184
    ds_read_b64_tr_b16 v[62:63], v174 offset:29696
    s_mov_b32 s5, 85899
    s_lshr_b32 s6, s12, 5
    s_mul_i32 s6, s6, 538758528
    s_sub_u32 s6, s6, 0
    buffer_load_dwordx4 v[88:91], v189, s[32:35], 0 offen sc1
    buffer_load_dwordx4 v[92:95], v189, s[32:35], s79 offen sc1
    buffer_load_dwordx4 v[96:99], v189, s[32:35], s80 offen sc1
    buffer_load_dwordx4 v[100:103], v189, s[32:35], s81 offen sc1
K2_CHK0:
    s_waitcnt vmcnt(3)
    v_bitop3_b32 v188, v91, s36, v214 bitop3:0x28
    v_cmp_ne_u32 vcc, 0, v188
    v_sub_u32_sdwa v188, v91, v168 dst_sel:DWORD dst_unused:UNUSED_PAD src0_sel:BYTE_3 src1_sel:DWORD
    v_mul_u32_u24_sdwa v104, s5, v88 dst_sel:DWORD dst_unused:UNUSED_PAD src0_sel:DWORD src1_sel:WORD_1
    v_mul_u32_u24_sdwa v105, s5, v89 dst_sel:DWORD dst_unused:UNUSED_PAD src0_sel:DWORD src1_sel:WORD_1
    v_mul_u32_u24_sdwa v106, s5, v90 dst_sel:DWORD dst_unused:UNUSED_PAD src0_sel:DWORD src1_sel:WORD_1
    s_cbranch_vccnz K2_RETRY0
    v_cmp_lt_i32 s[40:41], 0, v188
    v_cmp_lt_i32 s[42:43], 1, v188
    v_cmp_lt_i32 s[44:45], 2, v188
    v_subrev_u32 v104, s6, v104
    v_subrev_u32 v105, s6, v105
    v_subrev_u32 v106, s6, v106
    v_alignbit_b32 v104, v88, v104, 28
    v_alignbit_b32 v105, v89, v105, 28
    v_alignbit_b32 v106, v90, v106, 28
    v_and_b32 v104, 0xffc, v104
    v_and_b32 v105, 0xffc, v105
    v_and_b32 v106, 0xffc, v106
    s_mov_b64 exec, s[40:41]
    ds_add_rtn_u32 v220, v104, v171 offset:2304
    s_mov_b64 exec, s[42:43]
    ds_add_rtn_u32 v221, v105, v171 offset:2304
    s_mov_b64 exec, s[44:45]
    ds_add_rtn_u32 v222, v106, v171 offset:2304
    s_mov_b64 exec, -1
K2_CHK1:
    s_waitcnt vmcnt(2)
    v_bitop3_b32 v188, v95, s36, v214 bitop3:0x28
    v_cmp_ne_u32 vcc, 0, v188
    v_sub_u32_sdwa v188, v95, v168 dst_sel:DWORD dst_unused:UNUSED_PAD src0_sel:BYTE_3 src1_sel:DWORD
    v_mul_u32_u24_sdwa v107, s5, v92 dst_sel:DWORD dst_unused:UNUSED_PAD src0_sel:DWORD src1_sel:WORD_1
    v_mul_u32_u24_sdwa v108, s5, v93 dst_sel:DWORD dst_unused:UNUSED_PAD src0_sel:DWORD src1_sel:WORD_1
    v_mul_u32_u24_sdwa v109, s5, v94 dst_sel:DWORD dst_unused:UNUSED_PAD src0_sel:DWORD src1_sel:WORD_1
    s_cbranch_vccnz K2_RETRY1
    v_cmp_lt_i32 s[46:47], 0, v188
    v_cmp_lt_i32 s[48:49], 1, v188
    v_cmp_lt_i32 s[50:51], 2, v188
    v_subrev_u32 v107, s6, v107
    v_subrev_u32 v108, s6, v108
    v_subrev_u32 v109, s6, v109
    v_alignbit_b32 v107, v92, v107, 28
    v_alignbit_b32 v108, v93, v108, 28
    v_alignbit_b32 v109, v94, v109, 28
    v_and_b32 v107, 0xffc, v107
    v_and_b32 v108, 0xffc, v108
    v_and_b32 v109, 0xffc, v109
    s_mov_b64 exec, s[46:47]
    ds_add_rtn_u32 v223, v107, v171 offset:2304
    s_mov_b64 exec, s[48:49]
    ds_add_rtn_u32 v224, v108, v171 offset:2304
    s_mov_b64 exec, s[50:51]
    ds_add_rtn_u32 v225, v109, v171 offset:2304
    s_mov_b64 exec, -1
K2_CHK2:
    s_waitcnt vmcnt(1)
    v_bitop3_b32 v188, v99, s36, v214 bitop3:0x28
    v_cmp_ne_u32 vcc, 0, v188
    v_sub_u32_sdwa v188, v99, v168 dst_sel:DWORD dst_unused:UNUSED_PAD src0_sel:BYTE_3 src1_sel:DWORD
    v_mul_u32_u24_sdwa v110, s5, v96 dst_sel:DWORD dst_unused:UNUSED_PAD src0_sel:DWORD src1_sel:WORD_1
    v_mul_u32_u24_sdwa v111, s5, v97 dst_sel:DWORD dst_unused:UNUSED_PAD src0_sel:DWORD src1_sel:WORD_1
    v_mul_u32_u24_sdwa v112, s5, v98 dst_sel:DWORD dst_unused:UNUSED_PAD src0_sel:DWORD src1_sel:WORD_1
    s_cbranch_vccnz K2_RETRY2
    v_cmp_lt_i32 s[52:53], 0, v188
    v_cmp_lt_i32 s[54:55], 1, v188
    v_cmp_lt_i32 s[56:57], 2, v188
    v_subrev_u32 v110, s6, v110
    v_subrev_u32 v111, s6, v111
    v_subrev_u32 v112, s6, v112
    v_alignbit_b32 v110, v96, v110, 28
    v_alignbit_b32 v111, v97, v111, 28
    v_alignbit_b32 v112, v98, v112, 28
    v_and_b32 v110, 0xffc, v110
    v_and_b32 v111, 0xffc, v111
    v_and_b32 v112, 0xffc, v112
    s_mov_b64 exec, s[52:53]
    ds_add_rtn_u32 v226, v110, v171 offset:2304
    s_mov_b64 exec, s[54:55]
    ds_add_rtn_u32 v227, v111, v171 offset:2304
    s_mov_b64 exec, s[56:57]
    ds_add_rtn_u32 v228, v112, v171 offset:2304
    s_mov_b64 exec, -1
K2_CHK3:
    s_waitcnt vmcnt(0)
    v_bitop3_b32 v188, v103, s36, v214 bitop3:0x28
    v_cmp_ne_u32 vcc, 0, v188
    v_sub_u32_sdwa v188, v103, v168 dst_sel:DWORD dst_unused:UNUSED_PAD src0_sel:BYTE_3 src1_sel:DWORD
    v_mul_u32_u24_sdwa v113, s5, v100 dst_sel:DWORD dst_unused:UNUSED_PAD src0_sel:DWORD src1_sel:WORD_1
    v_mul_u32_u24_sdwa v114, s5, v101 dst_sel:DWORD dst_unused:UNUSED_PAD src0_sel:DWORD src1_sel:WORD_1
    v_mul_u32_u24_sdwa v115, s5, v102 dst_sel:DWORD dst_unused:UNUSED_PAD src0_sel:DWORD src1_sel:WORD_1
    s_cbranch_vccnz K2_RETRY3
    v_cmp_lt_i32 s[58:59], 0, v188
    v_cmp_lt_i32 s[60:61], 1, v188
    v_cmp_lt_i32 s[62:63], 2, v188
    v_subrev_u32 v113, s6, v113
    v_subrev_u32 v114, s6, v114
    v_subrev_u32 v115, s6, v115
    v_alignbit_b32 v113, v100, v113, 28
    v_alignbit_b32 v114, v101, v114, 28
    v_alignbit_b32 v115, v102, v115, 28
    v_and_b32 v113, 0xffc, v113
    v_and_b32 v114, 0xffc, v114
    v_and_b32 v115, 0xffc, v115
    s_mov_b64 exec, s[58:59]
    ds_add_rtn_u32 v229, v113, v171 offset:2304
    s_mov_b64 exec, s[60:61]
    ds_add_rtn_u32 v230, v114, v171 offset:2304
    s_mov_b64 exec, s[62:63]
    ds_add_rtn_u32 v231, v115, v171 offset:2304
    s_mov_b64 exec, -1
    v_max3_u32 v188, v91, v95, v99
    v_max_u32 v188, v188, v103
    v_cmp_le_u32 vcc, 553648128, v188
    s_mov_b32 s64, 0xc0c0401
    s_mov_b32 s65, 0xc0c0501
    s_mov_b32 s66, 0xc0c0601
    s_mov_b32 s67, 0x05040100
    s_cbranch_vccnz K2_XT1
K2_XT1R:
    s_waitcnt lgkmcnt(0)
    s_barrier
    ds_read_b128 v[116:119], v172 offset:2304
    ds_read_b128 v[120:123], v172 offset:3328
    ds_read_b128 v[124:127], v172 offset:4352
    ds_read_b128 v[128:131], v172 offset:5376
    ds_read_b64 v[194:195], v200 offset:2304
    s_mul_i32 s10, s12, 196
    s_add_u32 s10, s10, s96
    s_lshl_b32 s10, s10, 7
    s_mul_i32 s11, s7, 4160
    s_add_u32 m0, s11, 69120
    s_add_u32 s86, s10, 0
    buffer_load_dwordx4 v234, s[16:19], s86 offen lds
    s_add_u32 m0, s11, 70160
    s_add_u32 s86, s10, 1024
    buffer_load_dwordx4 v234, s[16:19], s86 offen lds
    s_add_u32 m0, s11, 71200
    s_add_u32 s86, s10, 2048
    buffer_load_dwordx4 v234, s[16:19], s86 offen lds
    s_add_u32 m0, s11, 72240
    s_add_u32 s86, s10, 3072
    buffer_load_dwordx4 v234, s[16:19], s86 offen lds
    v_and_b32 v91, 0x0f0f0f, v91
    v_and_b32 v95, 0x0f0f0f, v95
    v_and_b32 v99, 0x0f0f0f, v99
    v_and_b32 v103, 0x0f0f0f, v103
    v_perm_b32 v152, v91, v88, s64
    v_perm_b32 v153, v91, v89, s65
    v_perm_b32 v154, v91, v90, s66
    v_perm_b32 v155, v95, v92, s64
    s_waitcnt lgkmcnt(4)
    v_add_u32_sdwa v188, v116, v117 dst_sel:DWORD dst_unused:UNUSED_PAD src0_sel:WORD_0 src1_sel:WORD_0
    v_add_u32_sdwa v116, v118, v119 dst_sel:DWORD dst_unused:UNUSED_PAD src0_sel:WORD_0 src1_sel:WORD_0
    v_add_u32 v188, v188, v116
    s_waitcnt lgkmcnt(3)
    v_add_u32_sdwa v189, v120, v121 dst_sel:DWORD dst_unused:UNUSED_PAD src0_sel:WORD_0 src1_sel:WORD_0
    v_add_u32_sdwa v120, v122, v123 dst_sel:DWORD dst_unused:UNUSED_PAD src0_sel:WORD_0 src1_sel:WORD_0
    v_add_u32 v189, v189, v120
    s_waitcnt lgkmcnt(2)
    v_add_u32_sdwa v190, v124, v125 dst_sel:DWORD dst_unused:UNUSED_PAD src0_sel:WORD_0 src1_sel:WORD_0
    v_add_u32_sdwa v124, v126, v127 dst_sel:DWORD dst_unused:UNUSED_PAD src0_sel:WORD_0 src1_sel:WORD_0
    v_add_u32 v190, v190, v124
    s_waitcnt lgkmcnt(1)
    v_add_u32_sdwa v191, v128, v129 dst_sel:DWORD dst_unused:UNUSED_PAD src0_sel:WORD_0 src1_sel:WORD_0
    v_add_u32_sdwa v128, v130, v131 dst_sel:DWORD dst_unused:UNUSED_PAD src0_sel:WORD_0 src1_sel:WORD_0
    v_add_u32 v191, v191, v128
    v_lshl_or_b32 v192, v189, 16, v188
    v_lshl_or_b32 v193, v191, 16, v190
    s_waitcnt lgkmcnt(0)
    v_perm_b32 v198, v195, v194, s67
    v_add_u32_dpp v192, v192, v192 row_shr:1 row_mask:0xf bank_mask:0xf bound_ctrl:0
    v_add_u32_dpp v193, v193, v193 row_shr:1 row_mask:0xf bank_mask:0xf bound_ctrl:0
    v_perm_b32 v156, v95, v93, s65
    v_add_u32_dpp v192, v192, v192 row_shr:2 row_mask:0xf bank_mask:0xf bound_ctrl:0
    v_add_u32_dpp v193, v193, v193 row_shr:2 row_mask:0xf bank_mask:0xf bound_ctrl:0
    v_perm_b32 v157, v95, v94, s66
    v_add_u32_dpp v192, v192, v192 row_shr:4 row_mask:0xf bank_mask:0xf bound_ctrl:0
    v_add_u32_dpp v193, v193, v193 row_shr:4 row_mask:0xf bank_mask:0xf bound_ctrl:0
    v_perm_b32 v158, v99, v96, s64
    v_add_u32_dpp v192, v192, v192 row_shr:8 row_mask:0xf bank_mask:0xf bound_ctrl:0
    v_add_u32_dpp v193, v193, v193 row_shr:8 row_mask:0xf bank_mask:0xf bound_ctrl:0
    v_perm_b32 v159, v99, v97, s65
    v_add_u32_dpp v192, v192, v192 row_bcast:15 row_mask:0xa bank_mask:0xf
    v_add_u32_dpp v193, v193, v193 row_bcast:15 row_mask:0xa bank_mask:0xf
    v_perm_b32 v160, v99, v98, s66
    v_add_u32_dpp v192, v192, v192 row_bcast:31 row_mask:0xc bank_mask:0xf
    v_add_u32_dpp v193, v193, v193 row_bcast:31 row_mask:0xc bank_mask:0xf
    v_perm_b32 v161, v103, v100, s64
    v_readlane_b32 s10, v192, 63
    v_readlane_b32 s11, v193, 63
    v_lshlrev_b32_sdwa v116, v169, v192 dst_sel:DWORD dst_unused:UNUSED_PAD src0_sel:DWORD src1_sel:WORD_0
    v_sub_u32 v188, v116, v188
    v_lshlrev_b32_sdwa v117, v169, v192 dst_sel:DWORD dst_unused:UNUSED_PAD src0_sel:DWORD src1_sel:WORD_1
    v_sub_u32 v189, v117, v189
    v_lshlrev_b32_sdwa v118, v169, v193 dst_sel:DWORD dst_unused:UNUSED_PAD src0_sel:DWORD src1_sel:WORD_0
    v_sub_u32 v190, v118, v190
    v_lshlrev_b32_sdwa v119, v169, v193 dst_sel:DWORD dst_unused:UNUSED_PAD src0_sel:DWORD src1_sel:WORD_1
    v_sub_u32 v191, v119, v191
    s_and_b32 s4, s10, 0xffff
    s_lshr_b32 s10, s10, 16
    s_add_u32 s5, s4, s10
    s_and_b32 s10, s11, 0xffff
    s_add_u32 s6, s5, s10
    s_lshr_b32 s11, s11, 16
    s_add_u32 s10, s6, s11
    v_lshl_add_u32 v189, s4, 1, v189
    v_lshl_add_u32 v190, s5, 1, v190
    v_lshl_add_u32 v191, s6, 1, v191
    s_sub_i32 s37, 12928, s10
    s_ashr_i32 s37, s37, 7
    s_max_i32 s37, s37, 1
    s_min_i32 s37, s37, 4
    s_lshr_b32 s11, s10, 5
    s_add_u32 s11, s11, 16
    s_and_b32 s11, s11, -32
    s_cmp_ge_i32 s37, 1
    s_cselect_b32 s13, 42, 10
    s_sub_i32 s11, s11, s13
    s_lshl_b32 s11, s11, 3
    s_lshr_b32 s10, s10, 1
    s_lshr_b32 s13, s3, 1
    s_mul_i32 s13, s13, s10
    s_add_i32 s11, s11, s13
    s_add_i32 s10, s10, s13
    s_bitcmp1_b32 s3, 0
    s_cselect_b32 s15, s11, s13
    s_cselect_b32 s10, s10, s11
    s_mov_b32 s13, 0
    s_mov_b32 s14, 0
    v_cmp_gt_i32 vcc, s15, v188
    v_cmp_gt_i32 s[86:87], s10, v188
    s_bcnt1_i32_b64 s11, vcc
    s_add_u32 s13, s13, s11
    s_bcnt1_i32_b64 s11, s[86:87]
    s_add_u32 s14, s14, s11
    v_cmp_gt_i32 vcc, s15, v189
    v_cmp_gt_i32 s[86:87], s10, v189
    s_bcnt1_i32_b64 s11, vcc
    s_add_u32 s13, s13, s11
    s_bcnt1_i32_b64 s11, s[86:87]
    s_add_u32 s14, s14, s11
    v_cmp_gt_i32 vcc, s15, v190
    v_cmp_gt_i32 s[86:87], s10, v190
    s_bcnt1_i32_b64 s11, vcc
    s_add_u32 s13, s13, s11
    s_bcnt1_i32_b64 s11, s[86:87]
    s_add_u32 s14, s14, s11
    v_cmp_gt_i32 vcc, s15, v191
    v_cmp_gt_i32 s[86:87], s10, v191
    s_bcnt1_i32_b64 s11, vcc
    s_add_u32 s13, s13, s11
    s_bcnt1_i32_b64 s11, s[86:87]
    s_add_u32 s14, s14, s11
    s_max_i32 s13, s13, s72
    s_min_i32 s13, s13, s73
    s_max_i32 s14, s14, s84
    s_min_i32 s14, s14, s85
    v_cmp_le_u32 vcc, s13, v199
    v_cmp_gt_u32 s[10:11], s14, v199
    s_nop 0
    s_and_b64 vcc, vcc, s[10:11]
    v_cndmask_b32 v198, 0, v198, vcc
    v_mov_b32 v196, v198
    v_perm_b32 v162, v103, v101, s65
    v_perm_b32 v163, v103, v102, s66
    v_add_u32_dpp v196, v196, v196 row_shr:1 row_mask:0xf bank_mask:0xf bound_ctrl:0
    v_lshl_add_u32 v152, v152, 5, v208
    v_lshl_add_u32 v153, v153, 5, v208
    v_add_u32_dpp v196, v196, v196 row_shr:2 row_mask:0xf bank_mask:0xf bound_ctrl:0
    v_lshl_add_u32 v154, v154, 5, v208
    v_lshl_add_u32 v155, v155, 5, v209
    v_add_u32_dpp v196, v196, v196 row_shr:4 row_mask:0xf bank_mask:0xf bound_ctrl:0
    v_lshl_add_u32 v156, v156, 5, v209
    v_lshl_add_u32 v157, v157, 5, v209
    v_add_u32_dpp v196, v196, v196 row_shr:8 row_mask:0xf bank_mask:0xf bound_ctrl:0
    v_lshl_add_u32 v158, v158, 5, v210
    v_lshl_add_u32 v159, v159, 5, v210
    v_add_u32_dpp v196, v196, v196 row_bcast:15 row_mask:0xa bank_mask:0xf
    v_lshl_add_u32 v160, v160, 5, v210
    v_lshl_add_u32 v161, v161, 5, v211
    v_lshl_add_u32 v162, v162, 5, v211
    v_lshl_add_u32 v163, v163, 5, v211
    s_sub_u32 s86, s76, 9728
    v_readlane_b32 s10, v196, 31
    v_readlane_b32 s11, v196, 63
    v_sub_u32 v196, v196, v198
    v_mov_b32 v253, v202
    s_and_b32 s4, s10, 0xffff
    s_lshr_b32 s10, s10, 16
    s_add_u32 s5, s4, s10
    s_and_b32 s10, s11, 0xffff
    s_add_u32 s6, s5, s10
    s_lshr_b32 s11, s11, 16
    s_add_u32 s15, s6, s11
    s_lshl_b32 s10, s4, 16
    s_pack_ll_b32_b16 s11, s5, s6
    s_pack_ll_b32_b16 s86, s86, s86
    s_add_u32 s10, s10, s86
    s_add_u32 s11, s11, s86
    s_mov_b32 exec_lo, vcc_lo
    s_mov_b32 exec_hi, 0
    v_add_u32 v196, s10, v196
    s_mov_b32 exec_lo, 0
    s_mov_b32 exec_hi, vcc_hi
    v_add_u32 v196, s11, v196
    s_mov_b64 exec, vcc
    ds_write_b16 v200, v196 offset:2306
    ds_write_b16_d16_hi v200, v196 offset:2310
    ds_write_b32 v213, v212 offset:6400
    s_mov_b64 exec, -1
    v_mov_b32 v197, 2176
    s_cmp_le_u32 s15, 2176
    s_cbranch_scc1 K2_LFIT
    ds_write_b32 v197, v197
    s_mov_b32 s15, 0
K2_LFIT:
    s_add_u32 s15, s15, s76
    s_add_i32 s4, s4, 64
    s_lshr_b32 s4, s4, 7
    s_add_i32 s5, s5, 64
    s_lshr_b32 s5, s5, 7
    s_add_i32 s6, s6, 64
    s_lshr_b32 s6, s6, 7
    v_mov_b32 v190, 0xffff0000
    v_or_b32 v189, s39, v190
    v_mov_b32 v190, 0x7fffff00
    v_lshl_add_u32 v188, v254, 2, s15
    s_sub_u32 s73, s15, s76
    ds_write2st64_b32 v188, v189, v190 offset0:0 offset1:84
    ds_write2st64_b32 v188, v189, v190 offset0:1 offset1:85
    s_add_u32 s73, s73, 127
    s_lshr_b32 s73, s73, 7
    s_sub_i32 s38, s73, 1
    v_mov_b32 v188, s15
    ds_write_b32 v212, v188 offset:2112
    s_waitcnt lgkmcnt(0)
    s_barrier
    ds_read_b64 v[194:195], v197
    s_mov_b64 exec, s[40:41]
    ds_read_u16 v104, v104 offset:2306
    s_mov_b64 exec, s[42:43]
    ds_read_u16 v105, v105 offset:2306
    s_mov_b64 exec, s[44:45]
    ds_read_u16 v106, v106 offset:2306
    s_mov_b64 exec, s[46:47]
    ds_read_u16 v107, v107 offset:2306
    s_mov_b64 exec, s[48:49]
    ds_read_u16 v108, v108 offset:2306
    s_mov_b64 exec, s[50:51]
    ds_read_u16 v109, v109 offset:2306
    s_mov_b64 exec, s[52:53]
    ds_read_u16 v110, v110 offset:2306
    s_mov_b64 exec, s[54:55]
    ds_read_u16 v111, v111 offset:2306
    s_mov_b64 exec, s[56:57]
    ds_read_u16 v112, v112 offset:2306
    s_mov_b64 exec, s[58:59]
    ds_read_u16 v113, v113 offset:2306
    s_mov_b64 exec, s[60:61]
    ds_read_u16 v114, v114 offset:2306
    s_mov_b64 exec, s[62:63]
    ds_read_u16 v115, v115 offset:2306
    s_mov_b64 exec, -1
    s_waitcnt lgkmcnt(0)
    v_readfirstlane_b32 s83, v194
    v_readfirstlane_b32 s80, v195
    v_add_u32 v104, v104, v220
    v_add_u32 v105, v105, v221
    v_add_u32 v106, v106, v222
    v_add_u32 v107, v107, v223
    v_add_u32 v108, v108, v224
    v_add_u32 v109, v109, v225
    v_add_u32 v110, v110, v226
    v_add_u32 v111, v111, v227
    v_add_u32 v112, v112, v228
    v_add_u32 v113, v113, v229
    v_add_u32 v114, v114, v230
    v_add_u32 v115, v115, v231
    s_cmp_gt_u32 s83, 64
    s_cbranch_scc1 K2_OVF
    s_mov_b64 exec, s[40:41]
    ds_write2st64_b32 v104, v88, v152 offset0:38 offset1:122
    s_mov_b64 exec, s[42:43]
    ds_write2st64_b32 v105, v89, v153 offset0:38 offset1:122
    s_mov_b64 exec, s[44:45]
    ds_write2st64_b32 v106, v90, v154 offset0:38 offset1:122
    s_mov_b64 exec, s[46:47]
    ds_write2st64_b32 v107, v92, v155 offset0:38 offset1:122
    s_mov_b64 exec, s[48:49]
    ds_write2st64_b32 v108, v93, v156 offset0:38 offset1:122
    s_mov_b64 exec, s[50:51]
    ds_write2st64_b32 v109, v94, v157 offset0:38 offset1:122
    s_mov_b64 exec, s[52:53]
    ds_write2st64_b32 v110, v96, v158 offset0:38 offset1:122
    s_mov_b64 exec, s[54:55]
    ds_write2st64_b32 v111, v97, v159 offset0:38 offset1:122
    s_mov_b64 exec, s[56:57]
    ds_write2st64_b32 v112, v98, v160 offset0:38 offset1:122
    s_mov_b64 exec, s[58:59]
    ds_write2st64_b32 v113, v100, v161 offset0:38 offset1:122
    s_mov_b64 exec, s[60:61]
    ds_write2st64_b32 v114, v101, v162 offset0:38 offset1:122
    s_mov_b64 exec, s[62:63]
    ds_write2st64_b32 v115, v102, v163 offset0:38 offset1:122
    s_mov_b64 exec, -1
K2_PADS0:
    s_add_u32 s10, s37, 2
    s_cmp_gt_u32 s73, s10
    s_cselect_b32 s1, s3, 0
    s_waitcnt lgkmcnt(0)
    s_barrier
    s_bitcmp1_b32 s1, 0
    s_cbranch_scc1 K2_EARLY
    s_waitcnt vmcnt(0)
    s_branch K2_LATE0
K2_EARLY:
    ds_read_b128 v[236:239], v247
    ds_read_b32 v240, v251
    ds_read_u8 v250, v249
    s_waitcnt lgkmcnt(1)
    s_add_u32 m0, s74, 0
    v_mad_u32_u16 v236, v236, s75, v241 op_sel:[1,0,0,0]
    buffer_load_dwordx4 v236, s[16:19], 0 offen lds
    s_add_u32 m0, s74, 1040
    v_mad_u32_u16 v237, v237, s75, v241 op_sel:[1,0,0,0]
    buffer_load_dwordx4 v237, s[16:19], 0 offen lds
    s_add_u32 m0, s74, 2080
    v_mad_u32_u16 v238, v238, s75, v241 op_sel:[1,0,0,0]
    buffer_load_dwordx4 v238, s[16:19], 0 offen lds
    s_add_u32 m0, s74, 3120
    v_mad_u32_u16 v239, v239, s75, v241 op_sel:[1,0,0,0]
    buffer_load_dwordx4 v239, s[16:19], 0 offen lds
    s_add_u32 m0, s74, 4160
    v_add_u32 v240, v240, v242
    buffer_load_dwordx4 v240, s[20:23], 0 offen lds
K2_LATE0:
    s_waitcnt vmcnt(5)
    s_cmp_lg_u32 s97, 0
    s_cbranch_scc1 K2_XT2
K2_XT2R:
    ds_read_b128 v[152:155], v235 offset:0
    ds_read_b128 v[156:159], v235 offset:16
    ds_read_b128 v[160:163], v235 offset:32
    ds_read_b128 v[164:167], v235 offset:48
    v_add_u32 v172, 8192, v172
    ds_read_b128 v[88:91], v172 offset:52736
    ds_read_b128 v[92:95], v172 offset:53760
    ds_read_b128 v[96:99], v172 offset:54784
    ds_read_b128 v[100:103], v172 offset:55808
    ds_read_b128 v[104:107], v172 offset:56832
    ds_read_b128 v[108:111], v172 offset:57856
    ds_read_b128 v[112:115], v172 offset:58880
    ds_read_b128 v[116:119], v172 offset:59904
    s_mov_b32 s10, 0x358637bd
    s_mov_b32 s11, s10
    v_mfma_f32_32x32x16_bf16 v[136:151], v[180:183], v[180:183], 0
    v_mov_b64 v[120:121], s[10:11]
    v_mov_b64 v[122:123], s[10:11]
    v_mov_b64 v[124:125], s[10:11]
    v_mov_b64 v[126:127], s[10:11]
    v_mov_b64 v[128:129], s[10:11]
    v_mov_b64 v[130:131], s[10:11]
    v_mov_b64 v[132:133], s[10:11]
    v_mov_b64 v[134:135], s[10:11]
    s_waitcnt lgkmcnt(7)
    v_mfma_f32_32x32x16_bf16 v[188:203], v[152:155], v[88:91], 0
    s_waitcnt lgkmcnt(6)
    v_mfma_f32_32x32x16_bf16 v[188:203], v[156:159], v[92:95], v[188:203]
    s_waitcnt lgkmcnt(5)
    v_mfma_f32_32x32x16_bf16 v[188:203], v[160:163], v[96:99], v[188:203]
    s_waitcnt lgkmcnt(4)
    v_mfma_f32_32x32x16_bf16 v[188:203], v[164:167], v[100:103], v[188:203]
    s_waitcnt lgkmcnt(3)
    v_mfma_f32_32x32x16_bf16 v[204:219], v[152:155], v[104:107], 0
    s_waitcnt lgkmcnt(2)
    v_mfma_f32_32x32x16_bf16 v[204:219], v[156:159], v[108:111], v[204:219]
    s_waitcnt lgkmcnt(1)
    v_mfma_f32_32x32x16_bf16 v[204:219], v[160:163], v[112:115], v[204:219]
    s_waitcnt lgkmcnt(0)
    v_mfma_f32_32x32x16_bf16 v[204:219], v[164:167], v[116:119], v[204:219]
    v_mfma_f32_32x32x16_bf16 v[104:119], v[180:183], v[180:183], 0
    v_mov_b64 v[88:89], s[10:11]
    v_mov_b64 v[90:91], s[10:11]
    v_mov_b64 v[92:93], s[10:11]
    v_mov_b64 v[94:95], s[10:11]
    v_mov_b64 v[96:97], s[10:11]
    v_mov_b64 v[98:99], s[10:11]
    v_mov_b64 v[100:101], s[10:11]
    v_mov_b64 v[102:103], s[10:11]
    s_mov_b32 s10, 0xbfb8aa3b
    v_mul_f32 v188, s10, v188
    v_mul_f32 v189, s10, v189
    v_mul_f32 v190, s10, v190
    v_mul_f32 v191, s10, v191
    v_mul_f32 v192, s10, v192
    v_mul_f32 v193, s10, v193
    v_mul_f32 v194, s10, v194
    v_mul_f32 v195, s10, v195
    v_mul_f32 v196, s10, v196
    v_mul_f32 v197, s10, v197
    v_mul_f32 v198, s10, v198
    v_mul_f32 v199, s10, v199
    v_mul_f32 v200, s10, v200
    v_mul_f32 v201, s10, v201
    v_mul_f32 v202, s10, v202
    v_mul_f32 v203, s10, v203
    v_mul_f32 v204, s10, v204
    v_mul_f32 v205, s10, v205
    v_mul_f32 v206, s10, v206
    v_mul_f32 v207, s10, v207
    v_mul_f32 v208, s10, v208
    v_mul_f32 v209, s10, v209
    v_mul_f32 v210, s10, v210
    v_mul_f32 v211, s10, v211
    v_mul_f32 v212, s10, v212
    v_mul_f32 v213, s10, v213
    v_mul_f32 v214, s10, v214
    v_mul_f32 v215, s10, v215
    v_mul_f32 v216, s10, v216
    v_mul_f32 v217, s10, v217
    v_mul_f32 v218, s10, v218
    v_mul_f32 v219, s10, v219
    v_cvt_pk_bf16_f32 v72, v188, v189
    v_cvt_pk_bf16_f32 v73, v190, v191
    v_cvt_pk_bf16_f32 v74, v192, v193
    v_cvt_pk_bf16_f32 v75, v194, v195
    v_cvt_pk_bf16_f32 v76, v196, v197
    v_cvt_pk_bf16_f32 v77, v198, v199
    v_cvt_pk_bf16_f32 v78, v200, v201
    v_cvt_pk_bf16_f32 v79, v202, v203
    v_cvt_pk_bf16_f32 v80, v204, v205
    v_cvt_pk_bf16_f32 v81, v206, v207
    v_cvt_pk_bf16_f32 v82, v208, v209
    v_cvt_pk_bf16_f32 v83, v210, v211
    v_cvt_pk_bf16_f32 v84, v212, v213
    v_cvt_pk_bf16_f32 v85, v214, v215
    v_cvt_pk_bf16_f32 v86, v216, v217
    v_cvt_pk_bf16_f32 v87, v218, v219
    s_mov_b32 s79, -1
    s_mov_b64 s[84:85], 0
    s_mov_b32 s81, 0
    s_mov_b32 s82, 0
    s_cmp_lg_u32 s80, 0
    s_cselect_b32 s78, 1, 0
    s_bitcmp1_b32 s1, 0
    s_cbranch_scc1 K2_HAD0
    s_barrier
    s_cmp_eq_u32 s83, 0
    s_cbranch_scc1 K2_NEy
    s_lshl_b32 s10, s3, 2
    v_mov_b32 v178, s10
    ds_read_b32 v178, v178 offset:2112
    s_waitcnt lgkmcnt(0)
    v_readfirstlane_b32 s15, v178
    s_nop 3
    s_sub_u32 s73, s15, s76
    s_add_u32 s73, s73, 127
    s_lshr_b32 s73, s73, 7
    s_sub_i32 s38, s73, 1
K2_NEy:
K2_GO:
    ds_read_b128 v[236:239], v247
    ds_read_b32 v240, v251
    ds_read_u8 v250, v249
    s_waitcnt lgkmcnt(1)
    s_add_u32 m0, s74, 0
    v_mad_u32_u16 v236, v236, s75, v241 op_sel:[1,0,0,0]
    buffer_load_dwordx4 v236, s[16:19], 0 offen lds
    s_add_u32 m0, s74, 1040
    v_mad_u32_u16 v237, v237, s75, v241 op_sel:[1,0,0,0]
    buffer_load_dwordx4 v237, s[16:19], 0 offen lds
    s_add_u32 m0, s74, 2080
    v_mad_u32_u16 v238, v238, s75, v241 op_sel:[1,0,0,0]
    buffer_load_dwordx4 v238, s[16:19], 0 offen lds
    s_add_u32 m0, s74, 3120
    v_mad_u32_u16 v239, v239, s75, v241 op_sel:[1,0,0,0]
    buffer_load_dwordx4 v239, s[16:19], 0 offen lds
    s_add_u32 m0, s74, 4160
    v_add_u32 v240, v240, v242
    buffer_load_dwordx4 v240, s[20:23], 0 offen lds
K2_HAD0:
    s_waitcnt lgkmcnt(0)
    v_lshl_add_u32 v250, v250, 6, v245
    ds_read_b128 v[236:239], v247 offset:128
    ds_read_b32 v240, v251 offset:128
    ds_read_b128 v[172:175], v250 offset:7424
    ds_read_b32 v176, v250 offset:7440
    v_mfma_f32_32x32x16_bf16 v[204:219], v[180:183], v[180:183], 0
    s_waitcnt vmcnt(0)
    ds_read_b128 v[168:171], v244
    ds_read_b128 v[152:155], v243 offset:0
    ds_read_b128 v[156:159], v243 offset:16
    ds_read_b128 v[160:163], v243 offset:32
    ds_read_b128 v[164:167], v243 offset:48
    s_waitcnt lgkmcnt(0)
    s_add_u32 m0, s74, 0
    v_mad_u32_u16 v236, v236, s75, v241 op_sel:[1,0,0,0]
    buffer_load_dwordx4 v236, s[16:19], 0 offen lds
    s_add_u32 m0, s74, 1040
    v_mad_u32_u16 v237, v237, s75, v241 op_sel:[1,0,0,0]
    buffer_load_dwordx4 v237, s[16:19], 0 offen lds
    s_add_u32 m0, s74, 2080
    v_mad_u32_u16 v238, v238, s75, v241 op_sel:[1,0,0,0]
    buffer_load_dwordx4 v238, s[16:19], 0 offen lds
    s_add_u32 m0, s74, 3120
    v_mad_u32_u16 v239, v239, s75, v241 op_sel:[1,0,0,0]
    buffer_load_dwordx4 v239, s[16:19], 0 offen lds
    s_add_u32 m0, s74, 4160
    v_add_u32 v240, v240, v242
    buffer_load_dwordx4 v240, s[20:23], 0 offen lds
    s_cmp_lt_i32 s37, 0
    s_cbranch_scc1 K2_B1
    s_barrier
    s_bitcmp1_b32 s1, 0
    s_cselect_b32 s37, s37, -1
    s_cbranch_scc0 K2_B1
    s_cmp_eq_u32 s83, 0
    s_cbranch_scc1 K2_NEo
    s_lshl_b32 s10, s3, 2
    v_mov_b32 v178, s10
    ds_read_b32 v178, v178 offset:2112
    s_waitcnt lgkmcnt(0)
    v_readfirstlane_b32 s15, v178
    s_nop 3
    s_sub_u32 s73, s15, s76
    s_add_u32 s73, s73, 127
    s_lshr_b32 s73, s73, 7
    s_sub_i32 s38, s73, 1
K2_NEo:
K2_B1:
    s_cmp_lg_u32 s73, 0
    s_cbranch_scc1 K2_NZ
    s_waitcnt vmcnt(0)
    s_branch K2_DONE
K2_NZ:
    v_mfma_f32_32x32x16_bf16 v[188:203], v[168:171], v[64:67], 0
    v_mfma_f32_32x32x16_bf16 v[188:203], v[152:155], v[0:3], v[188:203]
    v_mfma_f32_32x32x16_bf16 v[188:203], v[156:159], v[4:7], v[188:203]
    v_mfma_f32_32x32x16_bf16 v[188:203], v[160:163], v[8:11], v[188:203]
    v_mfma_f32_32x32x16_bf16 v[188:203], v[164:167], v[12:15], v[188:203]
    s_nop 9
    v_smfmac_f32_32x32x32_bf16 v[188:203], v[172:175], v[72:79], v176
    s_mov_b32 s72, 0
    s_sub_u32 s10, s73, 1
    s_bitcmp1_b32 s3, 0
    s_cselect_b32 s6, s6, s10
    s_setprio 3
    s_mov_b32 s87, s73
    s_cmp_gt_i32 s4, s72
    s_cselect_b32 s10, s4, s87
    s_min_u32 s87, s87, s10
    s_cmp_gt_i32 s5, s72
    s_cselect_b32 s10, s5, s87
    s_min_u32 s87, s87, s10
    s_cmp_gt_i32 s6, s72
    s_cselect_b32 s10, s6, s87
    s_min_u32 s87, s87, s10
    s_cmp_gt_i32 s37, s72
    s_cselect_b32 s10, s37, s87
    s_min_u32 s87, s87, s10
    s_cmp_gt_i32 s38, s72
    s_cselect_b32 s10, s38, s87
    s_min_u32 s87, s87, s10
.p2align 6
K2_LOOP:
    v_smfmac_f32_32x32x32_bf16 v[136:151], v[180:183], v[204:211], v177
    ds_read_u8 v236, v248 offset:0
    ds_read_u8 v237, v248 offset:16
    ds_read_u8 v238, v248 offset:64
    ds_read_u8 v239, v248 offset:80
    ds_read_u8 v250, v249 offset:128
    v_exp_f32 v188, v188
    v_exp_f32 v189, v189
    v_exp_f32 v190, v190
    v_add_f32 v188, 1.0, v188
    v_smfmac_f32_32x32x32_bf16 v[136:151], v[184:187], v[212:219], v177
    v_exp_f32 v191, v191
    v_add_f32 v189, 1.0, v189
    v_exp_f32 v192, v192
    v_add_f32 v190, 1.0, v190
    v_rcp_f32 v188, v188
    v_mfma_f32_32x32x16_bf16 v[220:235], v[168:171], v[68:71], 0
    v_exp_f32 v193, v193
    v_add_f32 v191, 1.0, v191
    v_rcp_f32 v189, v189
    v_exp_f32 v194, v194
    v_mfma_f32_32x32x16_bf16 v[204:219], v[152:155], v[32:35], 0
    v_add_f32 v192, 1.0, v192
    v_rcp_f32 v190, v190
    v_exp_f32 v195, v195
    v_mfma_f32_32x32x16_bf16 v[204:219], v[156:159], v[36:39], v[204:219]
    s_waitcnt lgkmcnt(0)
    v_lshl_add_u32 v236, v236, 6, v246
    v_lshl_add_u32 v237, v237, 6, v246
    v_lshl_add_u32 v238, v238, 6, v246
    v_lshl_add_u32 v239, v239, 6, v246
    v_lshl_add_u32 v250, v250, 6, v245
    v_add_f32 v193, 1.0, v193
    v_rcp_f32 v191, v191
    v_exp_f32 v196, v196
    v_add_f32 v194, 1.0, v194
    v_rcp_f32 v192, v192
    v_smfmac_f32_32x32x32_bf16 v[220:235], v[172:175], v[80:87], v176
    ds_read_b64_tr_b16 v[180:181], v236
    ds_read_b64_tr_b16 v[182:183], v237
    ds_read_b64_tr_b16 v[184:185], v238
    ds_read_b64_tr_b16 v[186:187], v239
    ds_read_b128 v[172:175], v250 offset:7424
    ds_read_b32 v176, v250 offset:7440
    v_exp_f32 v197, v197
    v_add_f32 v195, 1.0, v195
    v_rcp_f32 v193, v193
    v_exp_f32 v198, v198
    v_mfma_f32_32x32x16_bf16 v[204:219], v[160:163], v[40:43], v[204:219]
    v_add_f32 v196, 1.0, v196
    v_rcp_f32 v194, v194
    v_exp_f32 v199, v199
    v_add_f32 v197, 1.0, v197
    v_mfma_f32_32x32x16_bf16 v[204:219], v[164:167], v[44:47], v[204:219]
    v_rcp_f32 v195, v195
    v_exp_f32 v200, v200
    v_add_f32 v198, 1.0, v198
    v_rcp_f32 v196, v196
    v_mfma_f32_32x32x16_bf16 v[220:235], v[152:155], v[16:19], v[220:235]
    ds_read_b128 v[236:239], v247 offset:256
    ds_read_b32 v240, v251 offset:256
    s_add_u32 s72, s72, 1
    v_exp_f32 v201, v201
    v_add_f32 v199, 1.0, v199
    v_rcp_f32 v197, v197
    v_exp_f32 v202, v202
    v_mfma_f32_32x32x16_bf16 v[220:235], v[156:159], v[20:23], v[220:235]
    v_add_f32 v200, 1.0, v200
    v_rcp_f32 v198, v198
    v_exp_f32 v203, v203
    v_add_f32 v201, 1.0, v201
    v_mfma_f32_32x32x16_bf16 v[220:235], v[160:163], v[24:27], v[220:235]
    v_rcp_f32 v199, v199
    v_add_f32 v202, 1.0, v202
    v_rcp_f32 v200, v200
    v_add_f32 v203, 1.0, v203
    v_rcp_f32 v201, v201
    v_mfma_f32_32x32x16_bf16 v[220:235], v[164:167], v[28:31], v[220:235]
    v_rcp_f32 v202, v202
    v_rcp_f32 v203, v203
    v_mul_f32 v204, v188, v204
    v_mul_f32 v205, v189, v205
    s_waitcnt lgkmcnt(0)
    v_smfmac_f32_32x32x32_bf16 v[88:103], v[180:183], v[188:195], v177
    v_mul_f32 v206, v190, v206
    v_mul_f32 v207, v191, v207
    v_mul_f32 v208, v192, v208
    v_mul_f32 v209, v193, v209
    v_mul_f32 v210, v194, v210
    v_mul_f32 v211, v195, v211
    v_mul_f32 v212, v196, v212
    v_smfmac_f32_32x32x32_bf16 v[88:103], v[184:187], v[196:203], v177
    v_mul_f32 v213, v197, v213
    v_mul_f32 v214, v198, v214
    v_mul_f32 v215, v199, v215
    v_mul_f32 v216, v200, v216
    v_mul_f32 v217, v201, v217
    v_mul_f32 v218, v202, v218
    v_mul_f32 v219, v203, v219
    v_smfmac_f32_32x32x32_bf16 v[104:119], v[180:183], v[204:211], v177
    s_waitcnt vmcnt(0)
    ds_read_b128 v[168:171], v244
    v_exp_f32 v220, v220
    v_exp_f32 v221, v221
    v_exp_f32 v222, v222
    v_add_f32 v220, 1.0, v220
    v_smfmac_f32_32x32x32_bf16 v[104:119], v[184:187], v[212:219], v177
    v_exp_f32 v223, v223
    v_add_f32 v221, 1.0, v221
    v_exp_f32 v224, v224
    v_add_f32 v222, 1.0, v222
    v_rcp_f32 v220, v220
    s_waitcnt lgkmcnt(0)
    v_mfma_f32_32x32x16_bf16 v[188:203], v[168:171], v[64:67], 0
    v_exp_f32 v225, v225
    v_add_f32 v223, 1.0, v223
    v_rcp_f32 v221, v221
    v_exp_f32 v226, v226
    v_mfma_f32_32x32x16_bf16 v[204:219], v[152:155], v[48:51], 0
    ds_read_b128 v[152:155], v243 offset:0
    v_add_f32 v224, 1.0, v224
    v_rcp_f32 v222, v222
    v_exp_f32 v227, v227
    v_mfma_f32_32x32x16_bf16 v[204:219], v[156:159], v[52:55], v[204:219]
    ds_read_b128 v[156:159], v243 offset:16
    v_add_f32 v225, 1.0, v225
    v_rcp_f32 v223, v223
    v_exp_f32 v228, v228
    v_add_f32 v226, 1.0, v226
    v_rcp_f32 v224, v224
    v_smfmac_f32_32x32x32_bf16 v[188:203], v[172:175], v[72:79], v176
    v_exp_f32 v229, v229
    v_add_f32 v227, 1.0, v227
    v_rcp_f32 v225, v225
    v_exp_f32 v230, v230
    v_mfma_f32_32x32x16_bf16 v[204:219], v[160:163], v[56:59], v[204:219]
    ds_read_b128 v[160:163], v243 offset:32
    v_add_f32 v228, 1.0, v228
    v_rcp_f32 v226, v226
    v_exp_f32 v231, v231
    v_add_f32 v229, 1.0, v229
    v_mfma_f32_32x32x16_bf16 v[204:219], v[164:167], v[60:63], v[204:219]
    ds_read_b128 v[164:167], v243 offset:48
    v_rcp_f32 v227, v227
    v_exp_f32 v232, v232
    v_add_f32 v230, 1.0, v230
    v_rcp_f32 v228, v228
    s_waitcnt lgkmcnt(3)
    v_mfma_f32_32x32x16_bf16 v[188:203], v[152:155], v[0:3], v[188:203]
    v_exp_f32 v233, v233
    v_add_f32 v231, 1.0, v231
    v_rcp_f32 v229, v229
    v_exp_f32 v234, v234
    s_waitcnt lgkmcnt(2)
    v_mfma_f32_32x32x16_bf16 v[188:203], v[156:159], v[4:7], v[188:203]
    v_add_f32 v232, 1.0, v232
    v_rcp_f32 v230, v230
    v_exp_f32 v235, v235
    v_add_f32 v233, 1.0, v233
    s_waitcnt lgkmcnt(1)
    v_mfma_f32_32x32x16_bf16 v[188:203], v[160:163], v[8:11], v[188:203]
    v_rcp_f32 v231, v231
    v_add_f32 v234, 1.0, v234
    v_rcp_f32 v232, v232
    v_add_f32 v235, 1.0, v235
    v_rcp_f32 v233, v233
    s_waitcnt lgkmcnt(0)
    v_mfma_f32_32x32x16_bf16 v[188:203], v[164:167], v[12:15], v[188:203]
    s_cmp_lt_i32 s72, s38
    s_cbranch_scc0 K2_ND_0
    s_add_u32 m0, s74, 0
    v_mad_u32_u16 v236, v236, s75, v241 op_sel:[1,0,0,0]
    buffer_load_dwordx4 v236, s[16:19], 0 offen lds
    s_add_u32 m0, s74, 1040
    v_mad_u32_u16 v237, v237, s75, v241 op_sel:[1,0,0,0]
    buffer_load_dwordx4 v237, s[16:19], 0 offen lds
    s_add_u32 m0, s74, 2080
    v_mad_u32_u16 v238, v238, s75, v241 op_sel:[1,0,0,0]
    buffer_load_dwordx4 v238, s[16:19], 0 offen lds
    s_add_u32 m0, s74, 3120
    v_mad_u32_u16 v239, v239, s75, v241 op_sel:[1,0,0,0]
    buffer_load_dwordx4 v239, s[16:19], 0 offen lds
    s_add_u32 m0, s74, 4160
    v_add_u32 v240, v240, v242
    buffer_load_dwordx4 v240, s[20:23], 0 offen lds
K2_ND_0:
    v_rcp_f32 v234, v234
    v_rcp_f32 v235, v235
    v_mul_f32 v204, v220, v204
    v_mul_f32 v205, v221, v205
    v_smfmac_f32_32x32x32_bf16 v[120:135], v[180:183], v[220:227], v177
    v_mul_f32 v206, v222, v206
    v_mul_f32 v207, v223, v207
    v_mul_f32 v208, v224, v208
    v_mul_f32 v209, v225, v209
    v_mul_f32 v210, v226, v210
    v_mul_f32 v211, v227, v211
    v_mul_f32 v212, v228, v212
    v_smfmac_f32_32x32x32_bf16 v[120:135], v[184:187], v[228:235], v177
    v_mul_f32 v213, v229, v213
    v_mul_f32 v214, v230, v214
    v_mul_f32 v215, v231, v215
    v_mul_f32 v216, v232, v216
    v_mul_f32 v217, v233, v217
    v_mul_f32 v218, v234, v218
    v_mul_f32 v219, v235, v219
    s_cmp_ge_u32 s72, s87
    s_cbranch_scc1 K2_EV0
K2_EVR0:
    v_smfmac_f32_32x32x32_bf16 v[136:151], v[180:183], v[204:211], v177
    ds_read_u8 v236, v248 offset:128
    ds_read_u8 v237, v248 offset:144
    ds_read_u8 v238, v248 offset:192
    ds_read_u8 v239, v248 offset:208
    ds_read_u8 v250, v249 offset:256
    v_exp_f32 v188, v188
    v_exp_f32 v189, v189
    v_exp_f32 v190, v190
    v_add_f32 v188, 1.0, v188
    v_smfmac_f32_32x32x32_bf16 v[136:151], v[184:187], v[212:219], v177
    v_exp_f32 v191, v191
    v_add_f32 v189, 1.0, v189
    v_exp_f32 v192, v192
    v_add_f32 v190, 1.0, v190
    v_rcp_f32 v188, v188
    v_mfma_f32_32x32x16_bf16 v[220:235], v[168:171], v[68:71], 0
    v_exp_f32 v193, v193
    v_add_f32 v191, 1.0, v191
    v_rcp_f32 v189, v189
    v_exp_f32 v194, v194
    v_mfma_f32_32x32x16_bf16 v[204:219], v[152:155], v[32:35], 0
    v_add_f32 v192, 1.0, v192
    v_rcp_f32 v190, v190
    v_exp_f32 v195, v195
    v_mfma_f32_32x32x16_bf16 v[204:219], v[156:159], v[36:39], v[204:219]
    s_waitcnt lgkmcnt(0)
    v_lshl_add_u32 v236, v236, 6, v246
    v_lshl_add_u32 v237, v237, 6, v246
    v_lshl_add_u32 v238, v238, 6, v246
    v_lshl_add_u32 v239, v239, 6, v246
    v_lshl_add_u32 v250, v250, 6, v245
    v_add_f32 v193, 1.0, v193
    v_rcp_f32 v191, v191
    v_exp_f32 v196, v196
    v_add_f32 v194, 1.0, v194
    v_rcp_f32 v192, v192
    v_smfmac_f32_32x32x32_bf16 v[220:235], v[172:175], v[80:87], v176
    ds_read_b64_tr_b16 v[180:181], v236
    ds_read_b64_tr_b16 v[182:183], v237
    ds_read_b64_tr_b16 v[184:185], v238
    ds_read_b64_tr_b16 v[186:187], v239
    ds_read_b128 v[172:175], v250 offset:7424
    ds_read_b32 v176, v250 offset:7440
    v_exp_f32 v197, v197
    v_add_f32 v195, 1.0, v195
    v_rcp_f32 v193, v193
    v_exp_f32 v198, v198
    v_mfma_f32_32x32x16_bf16 v[204:219], v[160:163], v[40:43], v[204:219]
    v_add_f32 v196, 1.0, v196
    v_rcp_f32 v194, v194
    v_exp_f32 v199, v199
    v_add_f32 v197, 1.0, v197
    v_mfma_f32_32x32x16_bf16 v[204:219], v[164:167], v[44:47], v[204:219]
    v_rcp_f32 v195, v195
    v_exp_f32 v200, v200
    v_add_f32 v198, 1.0, v198
    v_rcp_f32 v196, v196
    v_mfma_f32_32x32x16_bf16 v[220:235], v[152:155], v[16:19], v[220:235]
    ds_read_b128 v[236:239], v247 offset:384
    ds_read_b32 v240, v251 offset:384
    s_add_u32 s72, s72, 1
    v_exp_f32 v201, v201
    v_add_f32 v199, 1.0, v199
    v_rcp_f32 v197, v197
    v_exp_f32 v202, v202
    v_mfma_f32_32x32x16_bf16 v[220:235], v[156:159], v[20:23], v[220:235]
    v_add_f32 v200, 1.0, v200
    v_rcp_f32 v198, v198
    v_exp_f32 v203, v203
    v_add_f32 v201, 1.0, v201
    v_mfma_f32_32x32x16_bf16 v[220:235], v[160:163], v[24:27], v[220:235]
    v_rcp_f32 v199, v199
    v_add_f32 v202, 1.0, v202
    v_rcp_f32 v200, v200
    v_add_f32 v203, 1.0, v203
    v_rcp_f32 v201, v201
    v_mfma_f32_32x32x16_bf16 v[220:235], v[164:167], v[28:31], v[220:235]
    v_rcp_f32 v202, v202
    v_rcp_f32 v203, v203
    v_mul_f32 v204, v188, v204
    v_mul_f32 v205, v189, v205
    s_waitcnt lgkmcnt(0)
    v_smfmac_f32_32x32x32_bf16 v[88:103], v[180:183], v[188:195], v177
    v_mul_f32 v206, v190, v206
    v_mul_f32 v207, v191, v207
    v_mul_f32 v208, v192, v208
    v_mul_f32 v209, v193, v209
    v_mul_f32 v210, v194, v210
    v_mul_f32 v211, v195, v211
    v_mul_f32 v212, v196, v212
    v_smfmac_f32_32x32x32_bf16 v[88:103], v[184:187], v[196:203], v177
    v_mul_f32 v213, v197, v213
    v_mul_f32 v214, v198, v214
    v_mul_f32 v215, v199, v215
    v_mul_f32 v216, v200, v216
    v_mul_f32 v217, v201, v217
    v_mul_f32 v218, v202, v218
    v_mul_f32 v219, v203, v219
    v_smfmac_f32_32x32x32_bf16 v[104:119], v[180:183], v[204:211], v177
    s_waitcnt vmcnt(0)
    ds_read_b128 v[168:171], v244
    v_exp_f32 v220, v220
    v_exp_f32 v221, v221
    v_exp_f32 v222, v222
    v_add_f32 v220, 1.0, v220
    v_smfmac_f32_32x32x32_bf16 v[104:119], v[184:187], v[212:219], v177
    v_exp_f32 v223, v223
    v_add_f32 v221, 1.0, v221
    v_exp_f32 v224, v224
    v_add_f32 v222, 1.0, v222
    v_rcp_f32 v220, v220
    s_waitcnt lgkmcnt(0)
    v_mfma_f32_32x32x16_bf16 v[188:203], v[168:171], v[64:67], 0
    v_exp_f32 v225, v225
    v_add_f32 v223, 1.0, v223
    v_rcp_f32 v221, v221
    v_exp_f32 v226, v226
    v_mfma_f32_32x32x16_bf16 v[204:219], v[152:155], v[48:51], 0
    ds_read_b128 v[152:155], v243 offset:0
    v_add_f32 v224, 1.0, v224
    v_rcp_f32 v222, v222
    v_exp_f32 v227, v227
    v_mfma_f32_32x32x16_bf16 v[204:219], v[156:159], v[52:55], v[204:219]
    ds_read_b128 v[156:159], v243 offset:16
    v_add_f32 v225, 1.0, v225
    v_rcp_f32 v223, v223
    v_exp_f32 v228, v228
    v_add_f32 v226, 1.0, v226
    v_rcp_f32 v224, v224
    v_smfmac_f32_32x32x32_bf16 v[188:203], v[172:175], v[72:79], v176
    v_exp_f32 v229, v229
    v_add_f32 v227, 1.0, v227
    v_rcp_f32 v225, v225
    v_exp_f32 v230, v230
    v_mfma_f32_32x32x16_bf16 v[204:219], v[160:163], v[56:59], v[204:219]
    ds_read_b128 v[160:163], v243 offset:32
    v_add_f32 v228, 1.0, v228
    v_rcp_f32 v226, v226
    v_exp_f32 v231, v231
    v_add_f32 v229, 1.0, v229
    v_mfma_f32_32x32x16_bf16 v[204:219], v[164:167], v[60:63], v[204:219]
    ds_read_b128 v[164:167], v243 offset:48
    v_rcp_f32 v227, v227
    v_exp_f32 v232, v232
    v_add_f32 v230, 1.0, v230
    v_rcp_f32 v228, v228
    s_waitcnt lgkmcnt(3)
    v_mfma_f32_32x32x16_bf16 v[188:203], v[152:155], v[0:3], v[188:203]
    v_exp_f32 v233, v233
    v_add_f32 v231, 1.0, v231
    v_rcp_f32 v229, v229
    v_exp_f32 v234, v234
    s_waitcnt lgkmcnt(2)
    v_mfma_f32_32x32x16_bf16 v[188:203], v[156:159], v[4:7], v[188:203]
    v_add_f32 v232, 1.0, v232
    v_rcp_f32 v230, v230
    v_exp_f32 v235, v235
    v_add_f32 v233, 1.0, v233
    s_waitcnt lgkmcnt(1)
    v_mfma_f32_32x32x16_bf16 v[188:203], v[160:163], v[8:11], v[188:203]
    v_rcp_f32 v231, v231
    v_add_f32 v234, 1.0, v234
    v_rcp_f32 v232, v232
    v_add_f32 v235, 1.0, v235
    v_rcp_f32 v233, v233
    s_waitcnt lgkmcnt(0)
    v_mfma_f32_32x32x16_bf16 v[188:203], v[164:167], v[12:15], v[188:203]
    s_cmp_lt_i32 s72, s38
    s_cbranch_scc0 K2_ND_1
    s_add_u32 m0, s74, 0
    v_mad_u32_u16 v236, v236, s75, v241 op_sel:[1,0,0,0]
    buffer_load_dwordx4 v236, s[16:19], 0 offen lds
    s_add_u32 m0, s74, 1040
    v_mad_u32_u16 v237, v237, s75, v241 op_sel:[1,0,0,0]
    buffer_load_dwordx4 v237, s[16:19], 0 offen lds
    s_add_u32 m0, s74, 2080
    v_mad_u32_u16 v238, v238, s75, v241 op_sel:[1,0,0,0]
    buffer_load_dwordx4 v238, s[16:19], 0 offen lds
    s_add_u32 m0, s74, 3120
    v_mad_u32_u16 v239, v239, s75, v241 op_sel:[1,0,0,0]
    buffer_load_dwordx4 v239, s[16:19], 0 offen lds
    s_add_u32 m0, s74, 4160
    v_add_u32 v240, v240, v242
    buffer_load_dwordx4 v240, s[20:23], 0 offen lds
K2_ND_1:
    v_rcp_f32 v234, v234
    v_rcp_f32 v235, v235
    v_mul_f32 v204, v220, v204
    v_mul_f32 v205, v221, v205
    v_smfmac_f32_32x32x32_bf16 v[120:135], v[180:183], v[220:227], v177
    v_mul_f32 v206, v222, v206
    v_mul_f32 v207, v223, v207
    v_mul_f32 v208, v224, v208
    v_mul_f32 v209, v225, v209
    v_mul_f32 v210, v226, v210
    v_mul_f32 v211, v227, v211
    v_mul_f32 v212, v228, v212
    v_smfmac_f32_32x32x32_bf16 v[120:135], v[184:187], v[228:235], v177
    v_mul_f32 v213, v229, v213
    v_mul_f32 v214, v230, v214
    v_mul_f32 v215, v231, v215
    v_mul_f32 v216, v232, v216
    v_mul_f32 v217, v233, v217
    v_mul_f32 v218, v234, v218
    v_mul_f32 v219, v235, v219
    v_add_u32 v247, 0x100, v247
    v_add_u32 v249, 0x100, v249
    v_add_u32 v251, 0x100, v251
    v_add_u32 v248, 0x100, v248
    s_cmp_lt_u32 s72, s87
    s_cbranch_scc1 K2_LOOP
    s_cmp_ge_u32 s72, s73
    s_cbranch_scc1 K2_TAIL
    s_cmp_lg_u32 s72, s37
    s_cbranch_scc1 K2_SB1
    s_barrier
    s_mov_b32 s37, -1
K2_SB1:
    s_cmp_lg_u32 s72, s4
    s_cbranch_scc1 K2_PR1_0
    s_setprio 2
K2_PR1_0:
    s_cmp_lg_u32 s72, s5
    s_cbranch_scc1 K2_PR1_1
    s_setprio 1
K2_PR1_1:
    s_cmp_lg_u32 s72, s6
    s_cbranch_scc1 K2_PR1_2
    s_setprio 0
K2_PR1_2:
    s_cmp_eq_u32 s72, s38
    s_cbranch_scc1 K2_LT1
    s_mov_b32 s87, s73
    s_cmp_gt_i32 s4, s72
    s_cselect_b32 s10, s4, s87
    s_min_u32 s87, s87, s10
    s_cmp_gt_i32 s5, s72
    s_cselect_b32 s10, s5, s87
    s_min_u32 s87, s87, s10
    s_cmp_gt_i32 s6, s72
    s_cselect_b32 s10, s6, s87
    s_min_u32 s87, s87, s10
    s_cmp_gt_i32 s37, s72
    s_cselect_b32 s10, s37, s87
    s_min_u32 s87, s87, s10
    s_cmp_gt_i32 s38, s72
    s_cselect_b32 s10, s38, s87
    s_min_u32 s87, s87, s10
    s_branch K2_LOOP
K2_EV0:
    s_cmp_ge_u32 s72, s73
    s_cbranch_scc1 K2_TAIL
    s_cmp_lg_u32 s72, s37
    s_cbranch_scc1 K2_SB0
    s_barrier
    s_mov_b32 s37, -1
K2_SB0:
    s_cmp_lg_u32 s72, s4
    s_cbranch_scc1 K2_PR0_0
    s_setprio 2
K2_PR0_0:
    s_cmp_lg_u32 s72, s5
    s_cbranch_scc1 K2_PR0_1
    s_setprio 1
K2_PR0_1:
    s_cmp_lg_u32 s72, s6
    s_cbranch_scc1 K2_PR0_2
    s_setprio 0
K2_PR0_2:
    s_cmp_eq_u32 s72, s38
    s_cbranch_scc1 K2_LT0
    s_mov_b32 s87, s73
    s_cmp_gt_i32 s4, s72
    s_cselect_b32 s10, s4, s87
    s_min_u32 s87, s87, s10
    s_cmp_gt_i32 s5, s72
    s_cselect_b32 s10, s5, s87
    s_min_u32 s87, s87, s10
    s_cmp_gt_i32 s6, s72
    s_cselect_b32 s10, s6, s87
    s_min_u32 s87, s87, s10
    s_cmp_gt_i32 s37, s72
    s_cselect_b32 s10, s37, s87
    s_min_u32 s87, s87, s10
    s_cmp_gt_i32 s38, s72
    s_cselect_b32 s10, s38, s87
    s_min_u32 s87, s87, s10
    s_branch K2_EVR0
K2_LT0:
    v_add_u32 v248, 128, v248
K2_LT1:
    s_sub_u32 s10, s15, s76
    s_sub_u32 s10, s10, 4
    s_and_b32 s10, s10, 127
    s_cmp_lt_u32 s10, 32
    s_cbranch_scc1 K2_LG1
    s_cmp_lt_u32 s10, 64
    s_cbranch_scc1 K2_LG2
    s_cmp_lt_u32 s10, 96
    s_cbranch_scc1 K2_LG3
    v_smfmac_f32_32x32x32_bf16 v[136:151], v[180:183], v[204:211], v177
    ds_read_u8 v236, v248 offset:0
    ds_read_u8 v237, v248 offset:16
    ds_read_u8 v238, v248 offset:64
    ds_read_u8 v239, v248 offset:80
    v_exp_f32 v188, v188
    v_exp_f32 v189, v189
    v_exp_f32 v190, v190
    v_add_f32 v188, 1.0, v188
    v_smfmac_f32_32x32x32_bf16 v[136:151], v[184:187], v[212:219], v177
    v_exp_f32 v191, v191
    v_add_f32 v189, 1.0, v189
    v_exp_f32 v192, v192
    v_add_f32 v190, 1.0, v190
    v_rcp_f32 v188, v188
    v_mfma_f32_32x32x16_bf16 v[220:235], v[168:171], v[68:71], 0
    v_exp_f32 v193, v193
    v_add_f32 v191, 1.0, v191
    v_rcp_f32 v189, v189
    v_exp_f32 v194, v194
    v_mfma_f32_32x32x16_bf16 v[204:219], v[152:155], v[32:35], 0
    v_add_f32 v192, 1.0, v192
    v_rcp_f32 v190, v190
    v_exp_f32 v195, v195
    v_mfma_f32_32x32x16_bf16 v[204:219], v[156:159], v[36:39], v[204:219]
    s_waitcnt lgkmcnt(0)
    v_lshl_add_u32 v236, v236, 6, v246
    v_lshl_add_u32 v237, v237, 6, v246
    v_lshl_add_u32 v238, v238, 6, v246
    v_lshl_add_u32 v239, v239, 6, v246
    v_add_f32 v193, 1.0, v193
    v_rcp_f32 v191, v191
    v_exp_f32 v196, v196
    v_add_f32 v194, 1.0, v194
    v_rcp_f32 v192, v192
    v_smfmac_f32_32x32x32_bf16 v[220:235], v[172:175], v[80:87], v176
    ds_read_b64_tr_b16 v[180:181], v236
    ds_read_b64_tr_b16 v[182:183], v237
    ds_read_b64_tr_b16 v[184:185], v238
    ds_read_b64_tr_b16 v[186:187], v239
    v_exp_f32 v197, v197
    v_add_f32 v195, 1.0, v195
    v_rcp_f32 v193, v193
    v_exp_f32 v198, v198
    v_mfma_f32_32x32x16_bf16 v[204:219], v[160:163], v[40:43], v[204:219]
    v_add_f32 v196, 1.0, v196
    v_rcp_f32 v194, v194
    v_exp_f32 v199, v199
    v_add_f32 v197, 1.0, v197
    v_mfma_f32_32x32x16_bf16 v[204:219], v[164:167], v[44:47], v[204:219]
    v_rcp_f32 v195, v195
    v_exp_f32 v200, v200
    v_add_f32 v198, 1.0, v198
    v_rcp_f32 v196, v196
    v_mfma_f32_32x32x16_bf16 v[220:235], v[152:155], v[16:19], v[220:235]
    v_exp_f32 v201, v201
    v_add_f32 v199, 1.0, v199
    v_rcp_f32 v197, v197
    v_exp_f32 v202, v202
    v_mfma_f32_32x32x16_bf16 v[220:235], v[156:159], v[20:23], v[220:235]
    v_add_f32 v200, 1.0, v200
    v_rcp_f32 v198, v198
    v_exp_f32 v203, v203
    v_add_f32 v201, 1.0, v201
    v_mfma_f32_32x32x16_bf16 v[220:235], v[160:163], v[24:27], v[220:235]
    v_rcp_f32 v199, v199
    v_add_f32 v202, 1.0, v202
    v_rcp_f32 v200, v200
    v_add_f32 v203, 1.0, v203
    v_rcp_f32 v201, v201
    v_mfma_f32_32x32x16_bf16 v[220:235], v[164:167], v[28:31], v[220:235]
    v_rcp_f32 v202, v202
    v_rcp_f32 v203, v203
    v_mul_f32 v204, v188, v204
    v_mul_f32 v205, v189, v205
    s_waitcnt lgkmcnt(0)
    v_smfmac_f32_32x32x32_bf16 v[88:103], v[180:183], v[188:195], v177
    v_mul_f32 v206, v190, v206
    v_mul_f32 v207, v191, v207
    v_mul_f32 v208, v192, v208
    v_mul_f32 v209, v193, v209
    v_mul_f32 v210, v194, v210
    v_mul_f32 v211, v195, v211
    v_mul_f32 v212, v196, v212
    v_smfmac_f32_32x32x32_bf16 v[88:103], v[184:187], v[196:203], v177
    v_mul_f32 v213, v197, v213
    v_mul_f32 v214, v198, v214
    v_mul_f32 v215, v199, v215
    v_mul_f32 v216, v200, v216
    v_mul_f32 v217, v201, v217
    v_mul_f32 v218, v202, v218
    v_mul_f32 v219, v203, v219
    v_smfmac_f32_32x32x32_bf16 v[104:119], v[180:183], v[204:211], v177
    v_exp_f32 v220, v220
    v_exp_f32 v221, v221
    v_exp_f32 v222, v222
    v_add_f32 v220, 1.0, v220
    v_exp_f32 v223, v223
    v_smfmac_f32_32x32x32_bf16 v[104:119], v[184:187], v[212:219], v177
    v_add_f32 v221, 1.0, v221
    v_exp_f32 v224, v224
    v_add_f32 v222, 1.0, v222
    v_rcp_f32 v220, v220
    v_exp_f32 v225, v225
    v_add_f32 v223, 1.0, v223
    v_mfma_f32_32x32x16_bf16 v[204:219], v[152:155], v[48:51], 0
    v_rcp_f32 v221, v221
    v_exp_f32 v226, v226
    v_add_f32 v224, 1.0, v224
    v_rcp_f32 v222, v222
    v_exp_f32 v227, v227
    v_mfma_f32_32x32x16_bf16 v[204:219], v[156:159], v[52:55], v[204:219]
    v_add_f32 v225, 1.0, v225
    v_rcp_f32 v223, v223
    v_exp_f32 v228, v228
    v_add_f32 v226, 1.0, v226
    v_rcp_f32 v224, v224
    v_exp_f32 v229, v229
    v_mfma_f32_32x32x16_bf16 v[204:219], v[160:163], v[56:59], v[204:219]
    v_add_f32 v227, 1.0, v227
    v_rcp_f32 v225, v225
    v_exp_f32 v230, v230
    v_add_f32 v228, 1.0, v228
    v_rcp_f32 v226, v226
    v_mfma_f32_32x32x16_bf16 v[204:219], v[164:167], v[60:63], v[204:219]
    v_exp_f32 v231, v231
    v_add_f32 v229, 1.0, v229
    v_rcp_f32 v227, v227
    v_exp_f32 v232, v232
    v_add_f32 v230, 1.0, v230
    v_rcp_f32 v228, v228
    v_exp_f32 v233, v233
    v_add_f32 v231, 1.0, v231
    v_rcp_f32 v229, v229
    v_exp_f32 v234, v234
    v_add_f32 v232, 1.0, v232
    v_rcp_f32 v230, v230
    v_exp_f32 v235, v235
    v_add_f32 v233, 1.0, v233
    v_rcp_f32 v231, v231
    v_add_f32 v234, 1.0, v234
    v_rcp_f32 v232, v232
    v_add_f32 v235, 1.0, v235
    v_rcp_f32 v233, v233
    v_rcp_f32 v234, v234
    v_rcp_f32 v235, v235
    v_mul_f32 v204, v220, v204
    v_mul_f32 v205, v221, v205
    v_smfmac_f32_32x32x32_bf16 v[120:135], v[180:183], v[220:227], v177
    v_mul_f32 v206, v222, v206
    v_mul_f32 v207, v223, v207
    v_mul_f32 v208, v224, v208
    v_mul_f32 v209, v225, v209
    v_mul_f32 v210, v226, v210
    v_mul_f32 v211, v227, v211
    v_mul_f32 v212, v228, v212
    v_smfmac_f32_32x32x32_bf16 v[120:135], v[184:187], v[228:235], v177
    v_mul_f32 v213, v229, v213
    v_mul_f32 v214, v230, v214
    v_mul_f32 v215, v231, v215
    v_mul_f32 v216, v232, v216
    v_mul_f32 v217, v233, v217
    v_mul_f32 v218, v234, v218
    v_mul_f32 v219, v235, v219
    v_smfmac_f32_32x32x32_bf16 v[136:151], v[180:183], v[204:211], v177
    s_nop 0
    v_smfmac_f32_32x32x32_bf16 v[136:151], v[184:187], v[212:219], v177
    s_branch K2_DONE
K2_LG3:
    v_smfmac_f32_32x32x32_bf16 v[136:151], v[180:183], v[204:211], v177
    ds_read_u8 v236, v248 offset:0
    ds_read_u8 v237, v248 offset:16
    ds_read_u8 v238, v248 offset:64
    ds_read_u8 v239, v248 offset:80
    v_exp_f32 v188, v188
    v_exp_f32 v189, v189
    v_exp_f32 v190, v190
    v_smfmac_f32_32x32x32_bf16 v[136:151], v[184:187], v[212:219], v177
    v_add_f32 v188, 1.0, v188
    v_exp_f32 v191, v191
    v_add_f32 v189, 1.0, v189
    v_exp_f32 v192, v192
    v_mfma_f32_32x32x16_bf16 v[220:235], v[168:171], v[68:71], 0
    v_add_f32 v190, 1.0, v190
    v_rcp_f32 v188, v188
    v_exp_f32 v193, v193
    v_mfma_f32_32x32x16_bf16 v[204:219], v[152:155], v[32:35], 0
    v_add_f32 v191, 1.0, v191
    v_rcp_f32 v189, v189
    v_exp_f32 v194, v194
    v_mfma_f32_32x32x16_bf16 v[204:219], v[156:159], v[36:39], v[204:219]
    s_waitcnt lgkmcnt(0)
    v_lshl_add_u32 v236, v236, 6, v246
    v_lshl_add_u32 v237, v237, 6, v246
    v_lshl_add_u32 v238, v238, 6, v246
    v_lshl_add_u32 v239, v239, 6, v246
    v_add_f32 v192, 1.0, v192
    v_rcp_f32 v190, v190
    v_exp_f32 v195, v195
    v_smfmac_f32_32x32x32_bf16 v[220:235], v[172:175], v[80:87], v176
    ds_read_b64_tr_b16 v[180:181], v236
    ds_read_b64_tr_b16 v[182:183], v237
    ds_read_b64_tr_b16 v[184:185], v238
    ds_read_b64_tr_b16 v[186:187], v239
    v_add_f32 v193, 1.0, v193
    v_rcp_f32 v191, v191
    v_exp_f32 v196, v196
    v_mfma_f32_32x32x16_bf16 v[204:219], v[160:163], v[40:43], v[204:219]
    v_add_f32 v194, 1.0, v194
    v_rcp_f32 v192, v192
    v_exp_f32 v197, v197
    v_mfma_f32_32x32x16_bf16 v[204:219], v[164:167], v[44:47], v[204:219]
    v_add_f32 v195, 1.0, v195
    v_rcp_f32 v193, v193
    v_exp_f32 v198, v198
    v_mfma_f32_32x32x16_bf16 v[220:235], v[152:155], v[16:19], v[220:235]
    v_add_f32 v196, 1.0, v196
    v_rcp_f32 v194, v194
    v_exp_f32 v199, v199
    v_mfma_f32_32x32x16_bf16 v[220:235], v[156:159], v[20:23], v[220:235]
    v_add_f32 v197, 1.0, v197
    v_rcp_f32 v195, v195
    v_add_f32 v198, 1.0, v198
    v_mfma_f32_32x32x16_bf16 v[220:235], v[160:163], v[24:27], v[220:235]
    v_rcp_f32 v196, v196
    v_add_f32 v199, 1.0, v199
    v_rcp_f32 v197, v197
    v_mfma_f32_32x32x16_bf16 v[220:235], v[164:167], v[28:31], v[220:235]
    v_rcp_f32 v198, v198
    v_rcp_f32 v199, v199
    v_mul_f32 v204, v188, v204
    v_mul_f32 v205, v189, v205
    s_waitcnt lgkmcnt(0)
    v_smfmac_f32_32x32x32_bf16 v[88:103], v[180:183], v[188:195], v177
    v_mul_f32 v206, v190, v206
    v_mul_f32 v207, v191, v207
    v_mul_f32 v208, v192, v208
    v_mul_f32 v209, v193, v209
    v_mul_f32 v210, v194, v210
    v_smfmac_f32_32x32x32_bf16 v[88:103], v[184:187], v[196:203], v177
    v_mul_f32 v211, v195, v211
    v_mul_f32 v212, v196, v212
    v_mul_f32 v213, v197, v213
    v_mul_f32 v214, v198, v214
    v_mul_f32 v215, v199, v215
    v_smfmac_f32_32x32x32_bf16 v[104:119], v[180:183], v[204:211], v177
    v_exp_f32 v220, v220
    v_exp_f32 v221, v221
    v_exp_f32 v222, v222
    v_add_f32 v220, 1.0, v220
    v_smfmac_f32_32x32x32_bf16 v[104:119], v[184:187], v[212:219], v177
    v_exp_f32 v223, v223
    v_add_f32 v221, 1.0, v221
    v_exp_f32 v224, v224
    v_add_f32 v222, 1.0, v222
    v_rcp_f32 v220, v220
    v_mfma_f32_32x32x16_bf16 v[204:219], v[152:155], v[48:51], 0
    v_exp_f32 v225, v225
    v_add_f32 v223, 1.0, v223
    v_rcp_f32 v221, v221
    v_exp_f32 v226, v226
    v_mfma_f32_32x32x16_bf16 v[204:219], v[156:159], v[52:55], v[204:219]
    v_add_f32 v224, 1.0, v224
    v_rcp_f32 v222, v222
    v_exp_f32 v227, v227
    v_mfma_f32_32x32x16_bf16 v[204:219], v[160:163], v[56:59], v[204:219]
    v_add_f32 v225, 1.0, v225
    v_rcp_f32 v223, v223
    v_exp_f32 v228, v228
    v_add_f32 v226, 1.0, v226
    v_rcp_f32 v224, v224
    v_mfma_f32_32x32x16_bf16 v[204:219], v[164:167], v[60:63], v[204:219]
    v_exp_f32 v229, v229
    v_add_f32 v227, 1.0, v227
    v_rcp_f32 v225, v225
    v_exp_f32 v230, v230
    v_add_f32 v228, 1.0, v228
    v_rcp_f32 v226, v226
    v_exp_f32 v231, v231
    v_add_f32 v229, 1.0, v229
    v_rcp_f32 v227, v227
    v_add_f32 v230, 1.0, v230
    v_rcp_f32 v228, v228
    v_add_f32 v231, 1.0, v231
    v_rcp_f32 v229, v229
    v_rcp_f32 v230, v230
    v_rcp_f32 v231, v231
    v_mul_f32 v204, v220, v204
    v_mul_f32 v205, v221, v205
    v_smfmac_f32_32x32x32_bf16 v[120:135], v[180:183], v[220:227], v177
    v_mul_f32 v206, v222, v206
    v_mul_f32 v207, v223, v207
    v_mul_f32 v208, v224, v208
    v_mul_f32 v209, v225, v209
    v_mul_f32 v210, v226, v210
    v_smfmac_f32_32x32x32_bf16 v[120:135], v[184:187], v[228:235], v177
    v_mul_f32 v211, v227, v211
    v_mul_f32 v212, v228, v212
    v_mul_f32 v213, v229, v213
    v_mul_f32 v214, v230, v214
    v_mul_f32 v215, v231, v215
    v_smfmac_f32_32x32x32_bf16 v[136:151], v[180:183], v[204:211], v177
    s_nop 0
    v_smfmac_f32_32x32x32_bf16 v[136:151], v[184:187], v[212:219], v177
    s_branch K2_DONE
K2_LG2:
    v_smfmac_f32_32x32x32_bf16 v[136:151], v[180:183], v[204:211], v177
    ds_read_u8 v236, v248 offset:0
    ds_read_u8 v237, v248 offset:16
    ds_read_u8 v238, v248 offset:64
    ds_read_u8 v239, v248 offset:80
    v_exp_f32 v188, v188
    v_exp_f32 v189, v189
    v_smfmac_f32_32x32x32_bf16 v[136:151], v[184:187], v[212:219], v177
    v_exp_f32 v190, v190
    v_add_f32 v188, 1.0, v188
    v_mfma_f32_32x32x16_bf16 v[220:235], v[168:171], v[68:71], 0
    v_exp_f32 v191, v191
    v_add_f32 v189, 1.0, v189
    v_exp_f32 v192, v192
    v_mfma_f32_32x32x16_bf16 v[204:219], v[152:155], v[32:35], 0
    v_add_f32 v190, 1.0, v190
    v_rcp_f32 v188, v188
    v_mfma_f32_32x32x16_bf16 v[204:219], v[156:159], v[36:39], v[204:219]
    s_waitcnt lgkmcnt(0)
    v_lshl_add_u32 v236, v236, 6, v246
    v_lshl_add_u32 v237, v237, 6, v246
    v_lshl_add_u32 v238, v238, 6, v246
    v_lshl_add_u32 v239, v239, 6, v246
    v_exp_f32 v193, v193
    v_smfmac_f32_32x32x32_bf16 v[220:235], v[172:175], v[80:87], v176
    ds_read_b64_tr_b16 v[180:181], v236
    ds_read_b64_tr_b16 v[182:183], v237
    ds_read_b64_tr_b16 v[184:185], v238
    ds_read_b64_tr_b16 v[186:187], v239
    v_add_f32 v191, 1.0, v191
    v_rcp_f32 v189, v189
    v_exp_f32 v194, v194
    v_mfma_f32_32x32x16_bf16 v[204:219], v[160:163], v[40:43], v[204:219]
    v_add_f32 v192, 1.0, v192
    v_rcp_f32 v190, v190
    v_mfma_f32_32x32x16_bf16 v[204:219], v[164:167], v[44:47], v[204:219]
    v_exp_f32 v195, v195
    v_mfma_f32_32x32x16_bf16 v[220:235], v[152:155], v[16:19], v[220:235]
    v_add_f32 v193, 1.0, v193
    v_rcp_f32 v191, v191
    v_add_f32 v194, 1.0, v194
    v_mfma_f32_32x32x16_bf16 v[220:235], v[156:159], v[20:23], v[220:235]
    v_rcp_f32 v192, v192
    v_add_f32 v195, 1.0, v195
    v_mfma_f32_32x32x16_bf16 v[220:235], v[160:163], v[24:27], v[220:235]
    v_rcp_f32 v193, v193
    v_rcp_f32 v194, v194
    v_mfma_f32_32x32x16_bf16 v[220:235], v[164:167], v[28:31], v[220:235]
    v_rcp_f32 v195, v195
    v_mul_f32 v204, v188, v204
    v_mul_f32 v205, v189, v205
    v_mul_f32 v206, v190, v206
    s_waitcnt lgkmcnt(0)
    v_smfmac_f32_32x32x32_bf16 v[88:103], v[180:183], v[188:195], v177
    v_mul_f32 v207, v191, v207
    v_mul_f32 v208, v192, v208
    v_mul_f32 v209, v193, v209
    v_mul_f32 v210, v194, v210
    v_mul_f32 v211, v195, v211
    s_nop 1
    v_smfmac_f32_32x32x32_bf16 v[104:119], v[180:183], v[204:211], v177
    v_exp_f32 v220, v220
    v_exp_f32 v221, v221
    v_exp_f32 v222, v222
    v_mfma_f32_32x32x16_bf16 v[204:219], v[152:155], v[48:51], 0
    v_add_f32 v220, 1.0, v220
    v_exp_f32 v223, v223
    v_add_f32 v221, 1.0, v221
    v_mfma_f32_32x32x16_bf16 v[204:219], v[156:159], v[52:55], v[204:219]
    v_exp_f32 v224, v224
    v_add_f32 v222, 1.0, v222
    v_rcp_f32 v220, v220
    v_mfma_f32_32x32x16_bf16 v[204:219], v[160:163], v[56:59], v[204:219]
    v_exp_f32 v225, v225
    v_add_f32 v223, 1.0, v223
    v_rcp_f32 v221, v221
    v_mfma_f32_32x32x16_bf16 v[204:219], v[164:167], v[60:63], v[204:219]
    v_exp_f32 v226, v226
    v_add_f32 v224, 1.0, v224
    v_rcp_f32 v222, v222
    v_exp_f32 v227, v227
    v_add_f32 v225, 1.0, v225
    v_rcp_f32 v223, v223
    v_add_f32 v226, 1.0, v226
    v_rcp_f32 v224, v224
    v_add_f32 v227, 1.0, v227
    v_rcp_f32 v225, v225
    v_rcp_f32 v226, v226
    v_rcp_f32 v227, v227
    v_mul_f32 v204, v220, v204
    v_mul_f32 v205, v221, v205
    v_mul_f32 v206, v222, v206
    v_smfmac_f32_32x32x32_bf16 v[120:135], v[180:183], v[220:227], v177
    v_mul_f32 v207, v223, v207
    v_mul_f32 v208, v224, v208
    v_mul_f32 v209, v225, v209
    v_mul_f32 v210, v226, v210
    v_mul_f32 v211, v227, v211
    s_nop 1
    v_smfmac_f32_32x32x32_bf16 v[136:151], v[180:183], v[204:211], v177
    s_branch K2_DONE
K2_LG1:
    v_smfmac_f32_32x32x32_bf16 v[136:151], v[180:183], v[204:211], v177
    ds_read_u8 v236, v248 offset:0
    ds_read_u8 v237, v248 offset:16
    ds_read_u8 v238, v248 offset:64
    ds_read_u8 v239, v248 offset:80
    v_exp_f32 v188, v188
    v_smfmac_f32_32x32x32_bf16 v[136:151], v[184:187], v[212:219], v177
    v_exp_f32 v189, v189
    v_mfma_f32_32x32x16_bf16 v[220:235], v[168:171], v[68:71], 0
    v_exp_f32 v190, v190
    v_mfma_f32_32x32x16_bf16 v[204:219], v[152:155], v[32:35], 0
    v_add_f32 v188, 1.0, v188
    v_mfma_f32_32x32x16_bf16 v[204:219], v[156:159], v[36:39], v[204:219]
    s_waitcnt lgkmcnt(0)
    v_lshl_add_u32 v236, v236, 6, v246
    v_lshl_add_u32 v237, v237, 6, v246
    v_lshl_add_u32 v238, v238, 6, v246
    v_lshl_add_u32 v239, v239, 6, v246
    v_exp_f32 v191, v191
    v_smfmac_f32_32x32x32_bf16 v[220:235], v[172:175], v[80:87], v176
    ds_read_b64_tr_b16 v[180:181], v236
    ds_read_b64_tr_b16 v[182:183], v237
    ds_read_b64_tr_b16 v[184:185], v238
    ds_read_b64_tr_b16 v[186:187], v239
    v_add_f32 v189, 1.0, v189
    v_add_f32 v190, 1.0, v190
    v_mfma_f32_32x32x16_bf16 v[204:219], v[160:163], v[40:43], v[204:219]
    v_rcp_f32 v188, v188
    v_mfma_f32_32x32x16_bf16 v[204:219], v[164:167], v[44:47], v[204:219]
    v_add_f32 v191, 1.0, v191
    v_mfma_f32_32x32x16_bf16 v[220:235], v[152:155], v[16:19], v[220:235]
    v_rcp_f32 v189, v189
    v_mfma_f32_32x32x16_bf16 v[220:235], v[156:159], v[20:23], v[220:235]
    v_rcp_f32 v190, v190
    v_mfma_f32_32x32x16_bf16 v[220:235], v[160:163], v[24:27], v[220:235]
    v_rcp_f32 v191, v191
    v_mfma_f32_32x32x16_bf16 v[220:235], v[164:167], v[28:31], v[220:235]
    s_nop 3
    v_mul_f32 v204, v188, v204
    v_mul_f32 v205, v189, v205
    s_waitcnt lgkmcnt(0)
    v_smfmac_f32_32x32x32_bf16 v[88:103], v[180:183], v[188:195], v177
    v_mul_f32 v206, v190, v206
    v_mul_f32 v207, v191, v207
    s_nop 1
    v_smfmac_f32_32x32x32_bf16 v[104:119], v[180:183], v[204:211], v177
    v_exp_f32 v220, v220
    v_exp_f32 v221, v221
    v_mfma_f32_32x32x16_bf16 v[204:219], v[152:155], v[48:51], 0
    v_exp_f32 v222, v222
    v_mfma_f32_32x32x16_bf16 v[204:219], v[156:159], v[52:55], v[204:219]
    v_add_f32 v220, 1.0, v220
    v_exp_f32 v223, v223
    v_mfma_f32_32x32x16_bf16 v[204:219], v[160:163], v[56:59], v[204:219]
    v_add_f32 v221, 1.0, v221
    v_mfma_f32_32x32x16_bf16 v[204:219], v[164:167], v[60:63], v[204:219]
    v_add_f32 v222, 1.0, v222
    v_rcp_f32 v220, v220
    v_add_f32 v223, 1.0, v223
    v_rcp_f32 v221, v221
    v_rcp_f32 v222, v222
    v_rcp_f32 v223, v223
    s_nop 5
    v_mul_f32 v204, v220, v204
    v_mul_f32 v205, v221, v205
    v_smfmac_f32_32x32x32_bf16 v[120:135], v[180:183], v[220:227], v177
    v_mul_f32 v206, v222, v206
    v_mul_f32 v207, v223, v207
    s_nop 1
    v_smfmac_f32_32x32x32_bf16 v[136:151], v[180:183], v[204:211], v177
    s_branch K2_DONE
K2_TAIL:
    v_smfmac_f32_32x32x32_bf16 v[136:151], v[180:183], v[204:211], v177
    v_smfmac_f32_32x32x32_bf16 v[136:151], v[184:187], v[212:219], v177
K2_DONE:
    s_cmp_lg_u32 s78, 0
    s_cbranch_scc1 K2_SLOW
K2_EPI:
    v_lshlrev_b32 v252, 4, v254
    ds_read_b128 v[152:155], v253 offset:0
    ds_read_b128 v[156:159], v253 offset:16
    ds_read_b128 v[160:163], v253 offset:32
    ds_read_b128 v[164:167], v253 offset:48
    ds_read_b128 v[0:3], v252 offset:52736
    ds_read_b128 v[4:7], v252 offset:53760
    ds_read_b128 v[8:11], v252 offset:54784
    ds_read_b128 v[12:15], v252 offset:55808
    ds_read_b128 v[16:19], v252 offset:56832
    ds_read_b128 v[20:23], v252 offset:57856
    ds_read_b128 v[24:27], v252 offset:58880
    ds_read_b128 v[28:31], v252 offset:59904
    v_and_b32 v237, 31, v254
    v_and_b32 v245, 32, v254
    v_mul_u32_u24 v246, 144, v237
    v_lshrrev_b32 v238, 2, v245
    v_lshl_add_u32 v237, v237, 6, v238
    ds_read2_b64 v[180:183], v237 offset0:0 offset1:2
    ds_read2_b64 v[184:187], v237 offset0:4 offset1:6
    s_waitcnt lgkmcnt(10)
    v_lshlrev_b32 v32, 16, v152
    v_and_b32 v33, 0xffff0000, v152
    v_lshlrev_b32 v34, 16, v153
    v_and_b32 v35, 0xffff0000, v153
    v_lshlrev_b32 v36, 16, v154
    v_and_b32 v37, 0xffff0000, v154
    v_lshlrev_b32 v38, 16, v155
    v_and_b32 v39, 0xffff0000, v155
    v_lshlrev_b32 v40, 16, v156
    v_and_b32 v41, 0xffff0000, v156
    v_lshlrev_b32 v42, 16, v157
    v_and_b32 v43, 0xffff0000, v157
    v_lshlrev_b32 v44, 16, v158
    v_and_b32 v45, 0xffff0000, v158
    v_lshlrev_b32 v46, 16, v159
    v_and_b32 v47, 0xffff0000, v159
    v_lshlrev_b32 v48, 16, v160
    v_and_b32 v49, 0xffff0000, v160
    v_lshlrev_b32 v50, 16, v161
    v_and_b32 v51, 0xffff0000, v161
    v_lshlrev_b32 v52, 16, v162
    v_and_b32 v53, 0xffff0000, v162
    v_lshlrev_b32 v54, 16, v163
    v_and_b32 v55, 0xffff0000, v163
    v_lshlrev_b32 v56, 16, v164
    v_and_b32 v57, 0xffff0000, v164
    v_lshlrev_b32 v58, 16, v165
    v_and_b32 v59, 0xffff0000, v165
    v_lshlrev_b32 v60, 16, v166
    v_and_b32 v61, 0xffff0000, v166
    v_lshlrev_b32 v62, 16, v167
    v_and_b32 v63, 0xffff0000, v167
    v_lshl_add_u32 v253, v245, 1, v246
    v_add_u32 v253, s74, v253
    s_sub_u32 s10, s13, s96
    s_mul_i32 s10, s10, 144
    s_add_u32 s10, s10, s74
    v_lshrrev_b32 v236, 3, v254
    v_lshl_add_u32 v236, v236, 4, v252
    v_add_u32 v236, s10, v236
    s_mul_i32 s10, s12, 196
    s_add_u32 s11, s10, s14
    s_add_u32 s10, s10, s13
    s_min_u32 s11, s11, 50000
    s_min_u32 s10, s10, 50000
    s_sub_u32 s11, s11, s10
    s_lshl_b32 s10, s10, 7
    s_add_u32 s28, s28, s10
    s_addc_u32 s29, s29, 0
    s_lshl_b32 s30, s11, 7
    s_waitcnt lgkmcnt(9)
    v_mfma_f32_32x32x16_bf16 v[188:203], v[0:3], v[152:155], v[32:47]
    v_rcp_f32 v88, v88
    v_rcp_f32 v89, v89
    v_rcp_f32 v90, v90
    v_rcp_f32 v91, v91
    s_waitcnt lgkmcnt(8)
    v_mfma_f32_32x32x16_bf16 v[188:203], v[4:7], v[156:159], v[188:203]
    v_rcp_f32 v92, v92
    v_rcp_f32 v93, v93
    v_rcp_f32 v94, v94
    v_rcp_f32 v95, v95
    s_waitcnt lgkmcnt(7)
    v_mfma_f32_32x32x16_bf16 v[188:203], v[8:11], v[160:163], v[188:203]
    v_rcp_f32 v96, v96
    v_rcp_f32 v97, v97
    v_rcp_f32 v98, v98
    v_rcp_f32 v99, v99
    s_waitcnt lgkmcnt(6)
    v_mfma_f32_32x32x16_bf16 v[188:203], v[12:15], v[164:167], v[188:203]
    v_rcp_f32 v100, v100
    v_rcp_f32 v101, v101
    v_rcp_f32 v102, v102
    v_rcp_f32 v103, v103
    s_waitcnt lgkmcnt(5)
    v_mfma_f32_32x32x16_bf16 v[204:219], v[16:19], v[152:155], v[48:63]
    v_rcp_f32 v120, v120
    v_rcp_f32 v121, v121
    v_rcp_f32 v122, v122
    v_rcp_f32 v123, v123
    s_waitcnt lgkmcnt(4)
    v_mfma_f32_32x32x16_bf16 v[204:219], v[20:23], v[156:159], v[204:219]
    v_rcp_f32 v124, v124
    v_rcp_f32 v125, v125
    v_rcp_f32 v126, v126
    v_rcp_f32 v127, v127
    s_waitcnt lgkmcnt(3)
    v_mfma_f32_32x32x16_bf16 v[204:219], v[24:27], v[160:163], v[204:219]
    v_rcp_f32 v128, v128
    v_rcp_f32 v129, v129
    v_rcp_f32 v130, v130
    v_rcp_f32 v131, v131
    s_waitcnt lgkmcnt(2)
    v_mfma_f32_32x32x16_bf16 v[204:219], v[28:31], v[164:167], v[204:219]
    v_rcp_f32 v132, v132
    v_rcp_f32 v133, v133
    v_rcp_f32 v134, v134
    v_rcp_f32 v135, v135
    s_waitcnt lgkmcnt(0)
    v_mul_f32 v104, v104, v88
    v_mul_f32 v105, v105, v89
    v_mul_f32 v106, v106, v90
    v_mul_f32 v107, v107, v91
    v_mul_f32 v108, v108, v92
    v_mul_f32 v109, v109, v93
    v_mul_f32 v110, v110, v94
    v_mul_f32 v111, v111, v95
    v_mul_f32 v112, v112, v96
    v_mul_f32 v113, v113, v97
    v_mul_f32 v114, v114, v98
    v_mul_f32 v115, v115, v99
    v_mul_f32 v116, v116, v100
    v_mul_f32 v117, v117, v101
    v_mul_f32 v118, v118, v102
    v_mul_f32 v119, v119, v103
    v_cvt_pk_bf16_f32 v88, v104, v105
    v_cvt_pk_bf16_f32 v89, v106, v107
    v_cvt_pk_bf16_f32 v90, v108, v109
    v_cvt_pk_bf16_f32 v91, v110, v111
    v_cvt_pk_bf16_f32 v92, v112, v113
    v_cvt_pk_bf16_f32 v93, v114, v115
    v_cvt_pk_bf16_f32 v94, v116, v117
    v_cvt_pk_bf16_f32 v95, v118, v119
    v_mfma_f32_32x32x16_bf16 v[188:203], v[88:91], v[180:183], v[188:203]
    s_nop 0
    v_mfma_f32_32x32x16_bf16 v[188:203], v[92:95], v[184:187], v[188:203]
    v_mul_f32 v136, v136, v120
    v_mul_f32 v137, v137, v121
    v_mul_f32 v138, v138, v122
    v_mul_f32 v139, v139, v123
    v_mul_f32 v140, v140, v124
    v_mul_f32 v141, v141, v125
    v_mul_f32 v142, v142, v126
    v_mul_f32 v143, v143, v127
    v_mul_f32 v144, v144, v128
    v_mul_f32 v145, v145, v129
    v_mul_f32 v146, v146, v130
    v_mul_f32 v147, v147, v131
    v_mul_f32 v148, v148, v132
    v_mul_f32 v149, v149, v133
    v_mul_f32 v150, v150, v134
    v_mul_f32 v151, v151, v135
    v_cvt_pk_bf16_f32 v120, v136, v137
    v_cvt_pk_bf16_f32 v121, v138, v139
    v_cvt_pk_bf16_f32 v122, v140, v141
    v_cvt_pk_bf16_f32 v123, v142, v143
    v_cvt_pk_bf16_f32 v124, v144, v145
    v_cvt_pk_bf16_f32 v125, v146, v147
    v_cvt_pk_bf16_f32 v126, v148, v149
    v_cvt_pk_bf16_f32 v127, v150, v151
    v_mfma_f32_32x32x16_bf16 v[204:219], v[120:123], v[180:183], v[204:219]
    s_nop 0
    v_mfma_f32_32x32x16_bf16 v[204:219], v[124:127], v[184:187], v[204:219]
    v_max_f32 v188, v188, v32
    v_max_f32 v189, v189, v33
    v_max_f32 v190, v190, v34
    v_max_f32 v191, v191, v35
    v_max_f32 v192, v192, v36
    v_max_f32 v193, v193, v37
    v_max_f32 v194, v194, v38
    v_max_f32 v195, v195, v39
    v_cvt_pk_bf16_f32 v220, v188, v189
    v_cvt_pk_bf16_f32 v221, v190, v191
    v_cvt_pk_bf16_f32 v222, v192, v193
    v_cvt_pk_bf16_f32 v223, v194, v195
    ds_write_b128 v253, v[220:223] offset:0
    v_max_f32 v196, v196, v40
    v_max_f32 v197, v197, v41
    v_max_f32 v198, v198, v42
    v_max_f32 v199, v199, v43
    v_max_f32 v200, v200, v44
    v_max_f32 v201, v201, v45
    v_max_f32 v202, v202, v46
    v_max_f32 v203, v203, v47
    v_cvt_pk_bf16_f32 v224, v196, v197
    v_cvt_pk_bf16_f32 v225, v198, v199
    v_cvt_pk_bf16_f32 v226, v200, v201
    v_cvt_pk_bf16_f32 v227, v202, v203
    ds_write_b128 v253, v[224:227] offset:16
    v_max_f32 v204, v204, v48
    v_max_f32 v205, v205, v49
    v_max_f32 v206, v206, v50
    v_max_f32 v207, v207, v51
    v_max_f32 v208, v208, v52
    v_max_f32 v209, v209, v53
    v_max_f32 v210, v210, v54
    v_max_f32 v211, v211, v55
    v_cvt_pk_bf16_f32 v228, v204, v205
    v_cvt_pk_bf16_f32 v229, v206, v207
    v_cvt_pk_bf16_f32 v230, v208, v209
    v_cvt_pk_bf16_f32 v231, v210, v211
    ds_write_b128 v253, v[228:231] offset:32
    v_max_f32 v212, v212, v56
    v_max_f32 v213, v213, v57
    v_max_f32 v214, v214, v58
    v_max_f32 v215, v215, v59
    v_max_f32 v216, v216, v60
    v_max_f32 v217, v217, v61
    v_max_f32 v218, v218, v62
    v_max_f32 v219, v219, v63
    v_cvt_pk_bf16_f32 v232, v212, v213
    v_cvt_pk_bf16_f32 v233, v214, v215
    v_cvt_pk_bf16_f32 v234, v216, v217
    v_cvt_pk_bf16_f32 v235, v218, v219
    ds_write_b128 v253, v[232:235] offset:48
    ds_read_b128 v[152:155], v236 offset:0
    ds_read_b128 v[156:159], v236 offset:1152
    ds_read_b128 v[160:163], v236 offset:2304
    ds_read_b128 v[164:167], v236 offset:3456
    s_waitcnt lgkmcnt(3)
    buffer_store_dwordx4 v[152:155], v252, s[28:31], 0 offen offset:0 sc1
    s_waitcnt lgkmcnt(2)
    buffer_store_dwordx4 v[156:159], v252, s[28:31], 0 offen offset:1024 sc1
    s_waitcnt lgkmcnt(1)
    buffer_store_dwordx4 v[160:163], v252, s[28:31], 0 offen offset:2048 sc1
    s_waitcnt lgkmcnt(0)
    buffer_store_dwordx4 v[164:167], v252, s[28:31], 0 offen offset:3072 sc1
    s_add_u32 s10, s2, s7
    s_cmp_lg_u32 s10, 0
    s_cbranch_scc1 K2_NOEP
    v_mov_b32 v188, 24117248
    v_mov_b32 v189, s100
    buffer_store_dword v189, v188, s[24:27], 0 offen sc1
K2_NOEP:
K2_END:
    s_endpgm
K2_RETRY0:
    s_sub_u32 s101, s101, 1
    s_cbranch_scc1 K2_END
    s_waitcnt vmcnt(0)
    v_bitop3_b32 v188, v91, s36, v214 bitop3:0x28
    s_nop 1
    v_or_b32_dpp v188, v188, v188 quad_perm:[1,0,3,2] row_mask:0xf bank_mask:0xf
    s_nop 1
    v_or_b32_dpp v188, v188, v188 quad_perm:[2,3,0,1] row_mask:0xf bank_mask:0xf
    s_nop 1
    v_or_b32_dpp v188, v188, v188 row_half_mirror row_mask:0xf bank_mask:0xf
    v_cmp_ne_u32 vcc, 0, v188
    s_and_b64 exec, exec, vcc
    s_cbranch_execz K2_RT00
    buffer_load_dwordx4 v[88:91], v189, s[32:35], 0 offen sc1
K2_RT00:
    s_mov_b64 exec, -1
    v_bitop3_b32 v188, v95, s36, v214 bitop3:0x28
    s_nop 1
    v_or_b32_dpp v188, v188, v188 quad_perm:[1,0,3,2] row_mask:0xf bank_mask:0xf
    s_nop 1
    v_or_b32_dpp v188, v188, v188 quad_perm:[2,3,0,1] row_mask:0xf bank_mask:0xf
    s_nop 1
    v_or_b32_dpp v188, v188, v188 row_half_mirror row_mask:0xf bank_mask:0xf
    v_cmp_ne_u32 vcc, 0, v188
    s_and_b64 exec, exec, vcc
    s_cbranch_execz K2_RT01
    buffer_load_dwordx4 v[92:95], v189, s[32:35], s79 offen sc1
K2_RT01:
    s_mov_b64 exec, -1
    v_bitop3_b32 v188, v99, s36, v214 bitop3:0x28
    s_nop 1
    v_or_b32_dpp v188, v188, v188 quad_perm:[1,0,3,2] row_mask:0xf bank_mask:0xf
    s_nop 1
    v_or_b32_dpp v188, v188, v188 quad_perm:[2,3,0,1] row_mask:0xf bank_mask:0xf
    s_nop 1
    v_or_b32_dpp v188, v188, v188 row_half_mirror row_mask:0xf bank_mask:0xf
    v_cmp_ne_u32 vcc, 0, v188
    s_and_b64 exec, exec, vcc
    s_cbranch_execz K2_RT02
    buffer_load_dwordx4 v[96:99], v189, s[32:35], s80 offen sc1
K2_RT02:
    s_mov_b64 exec, -1
    v_bitop3_b32 v188, v103, s36, v214 bitop3:0x28
    s_nop 1
    v_or_b32_dpp v188, v188, v188 quad_perm:[1,0,3,2] row_mask:0xf bank_mask:0xf
    s_nop 1
    v_or_b32_dpp v188, v188, v188 quad_perm:[2,3,0,1] row_mask:0xf bank_mask:0xf
    s_nop 1
    v_or_b32_dpp v188, v188, v188 row_half_mirror row_mask:0xf bank_mask:0xf
    v_cmp_ne_u32 vcc, 0, v188
    s_and_b64 exec, exec, vcc
    s_cbranch_execz K2_RT03
    buffer_load_dwordx4 v[100:103], v189, s[32:35], s81 offen sc1
K2_RT03:
    s_mov_b64 exec, -1
    s_waitcnt vmcnt(0)
    s_branch K2_CHK0
K2_RETRY1:
    s_sub_u32 s101, s101, 1
    s_cbranch_scc1 K2_END
    s_waitcnt vmcnt(0)
    v_bitop3_b32 v188, v95, s36, v214 bitop3:0x28
    s_nop 1
    v_or_b32_dpp v188, v188, v188 quad_perm:[1,0,3,2] row_mask:0xf bank_mask:0xf
    s_nop 1
    v_or_b32_dpp v188, v188, v188 quad_perm:[2,3,0,1] row_mask:0xf bank_mask:0xf
    s_nop 1
    v_or_b32_dpp v188, v188, v188 row_half_mirror row_mask:0xf bank_mask:0xf
    v_cmp_ne_u32 vcc, 0, v188
    s_and_b64 exec, exec, vcc
    s_cbranch_execz K2_RT11
    buffer_load_dwordx4 v[92:95], v189, s[32:35], s79 offen sc1
K2_RT11:
    s_mov_b64 exec, -1
    v_bitop3_b32 v188, v99, s36, v214 bitop3:0x28
    s_nop 1
    v_or_b32_dpp v188, v188, v188 quad_perm:[1,0,3,2] row_mask:0xf bank_mask:0xf
    s_nop 1
    v_or_b32_dpp v188, v188, v188 quad_perm:[2,3,0,1] row_mask:0xf bank_mask:0xf
    s_nop 1
    v_or_b32_dpp v188, v188, v188 row_half_mirror row_mask:0xf bank_mask:0xf
    v_cmp_ne_u32 vcc, 0, v188
    s_and_b64 exec, exec, vcc
    s_cbranch_execz K2_RT12
    buffer_load_dwordx4 v[96:99], v189, s[32:35], s80 offen sc1
K2_RT12:
    s_mov_b64 exec, -1
    v_bitop3_b32 v188, v103, s36, v214 bitop3:0x28
    s_nop 1
    v_or_b32_dpp v188, v188, v188 quad_perm:[1,0,3,2] row_mask:0xf bank_mask:0xf
    s_nop 1
    v_or_b32_dpp v188, v188, v188 quad_perm:[2,3,0,1] row_mask:0xf bank_mask:0xf
    s_nop 1
    v_or_b32_dpp v188, v188, v188 row_half_mirror row_mask:0xf bank_mask:0xf
    v_cmp_ne_u32 vcc, 0, v188
    s_and_b64 exec, exec, vcc
    s_cbranch_execz K2_RT13
    buffer_load_dwordx4 v[100:103], v189, s[32:35], s81 offen sc1
K2_RT13:
    s_mov_b64 exec, -1
    s_waitcnt vmcnt(0)
    s_branch K2_CHK1
K2_RETRY2:
    s_sub_u32 s101, s101, 1
    s_cbranch_scc1 K2_END
    s_waitcnt vmcnt(0)
    v_bitop3_b32 v188, v99, s36, v214 bitop3:0x28
    s_nop 1
    v_or_b32_dpp v188, v188, v188 quad_perm:[1,0,3,2] row_mask:0xf bank_mask:0xf
    s_nop 1
    v_or_b32_dpp v188, v188, v188 quad_perm:[2,3,0,1] row_mask:0xf bank_mask:0xf
    s_nop 1
    v_or_b32_dpp v188, v188, v188 row_half_mirror row_mask:0xf bank_mask:0xf
    v_cmp_ne_u32 vcc, 0, v188
    s_and_b64 exec, exec, vcc
    s_cbranch_execz K2_RT22
    buffer_load_dwordx4 v[96:99], v189, s[32:35], s80 offen sc1
K2_RT22:
    s_mov_b64 exec, -1
    v_bitop3_b32 v188, v103, s36, v214 bitop3:0x28
    s_nop 1
    v_or_b32_dpp v188, v188, v188 quad_perm:[1,0,3,2] row_mask:0xf bank_mask:0xf
    s_nop 1
    v_or_b32_dpp v188, v188, v188 quad_perm:[2,3,0,1] row_mask:0xf bank_mask:0xf
    s_nop 1
    v_or_b32_dpp v188, v188, v188 row_half_mirror row_mask:0xf bank_mask:0xf
    v_cmp_ne_u32 vcc, 0, v188
    s_and_b64 exec, exec, vcc
    s_cbranch_execz K2_RT23
    buffer_load_dwordx4 v[100:103], v189, s[32:35], s81 offen sc1
K2_RT23:
    s_mov_b64 exec, -1
    s_waitcnt vmcnt(0)
    s_branch K2_CHK2
K2_RETRY3:
    s_sub_u32 s101, s101, 1
    s_cbranch_scc1 K2_END
    s_waitcnt vmcnt(0)
    v_bitop3_b32 v188, v103, s36, v214 bitop3:0x28
    s_nop 1
    v_or_b32_dpp v188, v188, v188 quad_perm:[1,0,3,2] row_mask:0xf bank_mask:0xf
    s_nop 1
    v_or_b32_dpp v188, v188, v188 quad_perm:[2,3,0,1] row_mask:0xf bank_mask:0xf
    s_nop 1
    v_or_b32_dpp v188, v188, v188 row_half_mirror row_mask:0xf bank_mask:0xf
    v_cmp_ne_u32 vcc, 0, v188
    s_and_b64 exec, exec, vcc
    s_cbranch_execz K2_RT33
    buffer_load_dwordx4 v[100:103], v189, s[32:35], s81 offen sc1
K2_RT33:
    s_mov_b64 exec, -1
    s_waitcnt vmcnt(0)
    s_branch K2_CHK3
K1_EXT:
    s_mov_b32 s14, 0x0f0f0f0f
    s_mov_b32 s15, s14
    ds_read_b32 v104, v6 offset:32
    ds_read_b128 v[8:11], v3 offset:128
    ds_read_b32 v105, v6 offset:3360
    ds_read_b128 v[16:19], v3 offset:13440
    ds_read_b32 v106, v6 offset:6688
    ds_read_b128 v[24:27], v3 offset:26752
    ds_read_b32 v107, v6 offset:10016
    ds_read_b128 v[32:35], v3 offset:40064
    s_waitcnt lgkmcnt(0)
    v_cmp_le_u32 vcc, 553648128, v108
    v_and_or_b32 v11, v104, v15, v108
    s_and_b64 exec, vcc, s[14:15]
    s_cbranch_execz K1_EX0
    buffer_store_dwordx4 v[8:11], v4, s[32:35], s10 offen sc1
K1_EX0:
    s_mov_b64 exec, -1
    s_add_u32 s10, s10, 2105344
    v_cmp_le_u32 vcc, 553648128, v109
    v_and_or_b32 v19, v105, v15, v109
    s_and_b64 exec, vcc, s[14:15]
    s_cbranch_execz K1_EX1
    buffer_store_dwordx4 v[16:19], v4, s[32:35], s10 offen sc1
K1_EX1:
    s_mov_b64 exec, -1
    s_add_u32 s10, s10, 2105344
    v_cmp_le_u32 vcc, 553648128, v110
    v_and_or_b32 v27, v106, v15, v110
    s_and_b64 exec, vcc, s[14:15]
    s_cbranch_execz K1_EX2
    buffer_store_dwordx4 v[24:27], v4, s[32:35], s10 offen sc1
K1_EX2:
    s_mov_b64 exec, -1
    s_add_u32 s10, s10, 2105344
    v_cmp_le_u32 vcc, 553648128, v111
    v_and_or_b32 v35, v107, v15, v111
    s_and_b64 exec, vcc, s[14:15]
    s_cbranch_execz K1_EX3
    buffer_store_dwordx4 v[32:35], v4, s[32:35], s10 offen sc1
K1_EX3:
    s_mov_b64 exec, -1
    s_add_u32 s10, s10, 2105344
    s_branch K1_EXTR
K1_OVF:
    v_lshrrev_b32 v72, 16, v112
    v_lshrrev_b32 v76, 18, v112
    v_sub_u32 v72, v72, v76
    v_lshrrev_b32 v73, 16, v113
    v_lshrrev_b32 v76, 18, v113
    v_sub_u32 v73, v73, v76
    v_lshrrev_b32 v74, 16, v114
    v_lshrrev_b32 v76, 18, v114
    v_sub_u32 v74, v74, v76
    v_lshrrev_b32 v75, 16, v115
    v_lshrrev_b32 v76, 18, v115
    v_sub_u32 v75, v75, v76
    v_add_u32 v77, v72, v73
    v_add_u32 v78, v77, v74
    v_add_u32 v79, v78, v75
    v_mov_b32 v1, v79
    s_nop 1
    v_add_u32_dpp v1, v1, v1 row_shr:1 row_mask:0xf bank_mask:0xf bound_ctrl:0
    s_nop 1
    v_add_u32_dpp v1, v1, v1 row_shr:2 row_mask:0xf bank_mask:0xf bound_ctrl:0
    s_nop 1
    v_add_u32_dpp v1, v1, v1 row_shr:4 row_mask:0xf bank_mask:0xf bound_ctrl:0
    s_nop 1
    v_add_u32_dpp v1, v1, v1 row_shr:8 row_mask:0xf bank_mask:0xf bound_ctrl:0
    s_nop 1
    v_add_u32_dpp v1, v1, v1 row_bcast:15 row_mask:0xa bank_mask:0xf
    s_nop 1
    v_add_u32_dpp v1, v1, v1 row_bcast:31 row_mask:0xc bank_mask:0xf
    s_nop 0
    v_sub_u32 v76, v1, v79
    v_add_u32 v79, v76, v78
    v_add_u32 v78, v76, v77
    v_add_u32 v77, v76, v72
    v_lshl_or_b32 v76, v72, 16, v76
    v_lshl_or_b32 v77, v73, 16, v77
    v_lshl_or_b32 v78, v74, 16, v78
    v_lshl_or_b32 v79, v75, 16, v79
    s_waitcnt lgkmcnt(0)
    ds_write_b128 v172, v[76:79] offset:52736
    v_min_u32 v108, 255, v108
    v_min_u32 v109, 255, v109
    v_min_u32 v110, 255, v110
    v_min_u32 v111, 255, v111
    s_lshl_b32 s15, s12, 2
    s_add_u32 s15, s15, 23068672
    s_add_u32 s64, s8, s15
    s_addc_u32 s65, s9, 0
    s_mov_b32 s66, 262144
    s_mov_b32 s67, 0x20000
    v_lshlrev_b32 v1, 12, v254
    buffer_store_dword v76, v1, s[64:67], 0 offen offset:0 sc1
    buffer_store_dword v77, v1, s[64:67], 0 offen offset:1024 sc1
    buffer_store_dword v78, v1, s[64:67], 0 offen offset:2048 sc1
    buffer_store_dword v79, v1, s[64:67], 0 offen offset:3072 sc1
    s_add_u32 s15, s13, 17825792
    s_add_u32 s64, s8, s15
    s_addc_u32 s65, s9, 0
    s_mov_b32 s66, 12500
    s_mov_b32 s67, 0x20000
    s_lshr_b32 s15, s13, 2
    s_add_u32 s15, s15, 22020096
    s_add_u32 s68, s8, s15
    s_addc_u32 s69, s9, 0
    s_mov_b32 s70, 3125
    s_mov_b32 s71, 0x20000
    v_cndmask_b32 v30, v24, v30, s[78:79]
    v_cndmask_b32 v38, 0, v38, s[78:79]
    ds_read_u16 v40, v24 offset:50736
    ds_read_u16 v41, v25 offset:50736
    ds_read_u16 v42, v26 offset:50736
    ds_read_u16 v43, v27 offset:50736
    ds_read_u16 v44, v28 offset:50736
    ds_read_u16 v45, v29 offset:50736
    ds_read_u16 v46, v30 offset:50736
    s_waitcnt lgkmcnt(0)
    v_lshrrev_b32 v1, 2, v32
    v_sub_u32 v1, v32, v1
    v_add_u32 v40, v40, v1
    v_cmp_le_u32 vcc, 48, v32
    v_lshlrev_b32 v48, 2, v40
    s_and_saveexec_b64 s[14:15], vcc
    s_cbranch_execz K1_OV3_0
    buffer_store_byte v23, v40, s[68:71], 0 offen sc1
    buffer_store_dword v16, v48, s[64:67], 0 offen sc1
K1_OV3_0:
    s_mov_b64 exec, -1
    v_lshrrev_b32 v1, 2, v33
    v_sub_u32 v1, v33, v1
    v_add_u32 v41, v41, v1
    v_cmp_le_u32 vcc, 48, v33
    v_lshlrev_b32 v49, 2, v41
    s_and_saveexec_b64 s[14:15], vcc
    s_cbranch_execz K1_OV3_1
    buffer_store_byte v23, v41, s[68:71], 0 offen sc1
    buffer_store_dword v17, v49, s[64:67], 0 offen sc1
K1_OV3_1:
    s_mov_b64 exec, -1
    v_lshrrev_b32 v1, 2, v34
    v_sub_u32 v1, v34, v1
    v_add_u32 v42, v42, v1
    v_cmp_le_u32 vcc, 48, v34
    v_lshlrev_b32 v50, 2, v42
    s_and_saveexec_b64 s[14:15], vcc
    s_cbranch_execz K1_OV3_2
    buffer_store_byte v23, v42, s[68:71], 0 offen sc1
    buffer_store_dword v18, v50, s[64:67], 0 offen sc1
K1_OV3_2:
    s_mov_b64 exec, -1
    v_lshrrev_b32 v1, 2, v35
    v_sub_u32 v1, v35, v1
    v_add_u32 v43, v43, v1
    v_cmp_le_u32 vcc, 48, v35
    v_lshlrev_b32 v51, 2, v43
    s_and_saveexec_b64 s[14:15], vcc
    s_cbranch_execz K1_OV3_3
    buffer_store_byte v23, v43, s[68:71], 0 offen sc1
    buffer_store_dword v19, v51, s[64:67], 0 offen sc1
K1_OV3_3:
    s_mov_b64 exec, -1
    v_lshrrev_b32 v1, 2, v36
    v_sub_u32 v1, v36, v1
    v_add_u32 v44, v44, v1
    v_cmp_le_u32 vcc, 48, v36
    v_lshlrev_b32 v52, 2, v44
    s_and_saveexec_b64 s[14:15], vcc
    s_cbranch_execz K1_OV3_4
    buffer_store_byte v31, v44, s[68:71], 0 offen sc1
    buffer_store_dword v20, v52, s[64:67], 0 offen sc1
K1_OV3_4:
    s_mov_b64 exec, -1
    v_lshrrev_b32 v1, 2, v37
    v_sub_u32 v1, v37, v1
    v_add_u32 v45, v45, v1
    v_cmp_le_u32 vcc, 48, v37
    v_lshlrev_b32 v53, 2, v45
    s_and_saveexec_b64 s[14:15], vcc
    s_cbranch_execz K1_OV3_5
    buffer_store_byte v31, v45, s[68:71], 0 offen sc1
    buffer_store_dword v21, v53, s[64:67], 0 offen sc1
K1_OV3_5:
    s_mov_b64 exec, -1
    v_lshrrev_b32 v1, 2, v38
    v_sub_u32 v1, v38, v1
    v_add_u32 v46, v46, v1
    v_cmp_le_u32 vcc, 48, v38
    v_lshlrev_b32 v54, 2, v46
    s_and_saveexec_b64 s[14:15], vcc
    s_cbranch_execz K1_OV3_6
    buffer_store_byte v39, v46, s[68:71], 0 offen sc1
    buffer_store_dword v22, v54, s[64:67], 0 offen sc1
K1_OV3_6:
    s_mov_b64 exec, -1
    s_waitcnt vmcnt(0)
    s_barrier
    s_branch K1_OUT
K2_XT1:
    s_mov_b32 s97, 1
    v_cmp_le_u32 vcc, 822083584, v188
    v_mov_b32 v166, 2180
    s_cbranch_vccz K2_XT1A
    ds_write_b32 v166, v171
K2_XT1A:
    s_mov_b32 s10, 0xf0f0f0f0
    s_mov_b32 s11, s10
    v_and_b32 v166, 12, v168
    v_add_u32 v166, 32, v166
    v_and_b32 v164, 64, v189
    v_mul_u32_u24 v164, 127, v164
    v_add_u32 v164, v164, v189
    v_add_u32 v165, 16384, v164
    v_mov_b32 v167, 0x7ffffff0
    v_cndmask_b32 v204, v91, v95, s[10:11]
    v_cndmask_b32 v206, v208, v209, s[10:11]
    v_cmp_le_u32 vcc, 553648128, v204
    v_sub_u32_sdwa v204, v204, v166 dst_sel:DWORD dst_unused:UNUSED_PAD src0_sel:BYTE_3 src1_sel:DWORD
    s_nop 0
    v_cndmask_b32 v164, v167, v164, vcc
    v_cndmask_b32 v205, v99, v103, s[10:11]
    v_cndmask_b32 v207, v210, v211, s[10:11]
    v_cmp_le_u32 vcc, 553648128, v205
    v_sub_u32_sdwa v205, v205, v166 dst_sel:DWORD dst_unused:UNUSED_PAD src0_sel:BYTE_3 src1_sel:DWORD
    s_nop 0
    v_cndmask_b32 v165, v167, v165, vcc
    s_add_u32 s32, s32, 8421376
    s_addc_u32 s33, s33, 0
    buffer_load_dwordx4 v[132:135], v164, s[32:35], 0 offen sc1
    buffer_load_dwordx4 v[136:139], v165, s[32:35], 0 offen sc1
    v_med3_i32 v166, v204, 0, 3
    v_med3_i32 v167, v205, 0, 3
    v_add_u32 v166, v166, v167
    v_mov_b32 v167, 2176
    v_cmpx_lt_u32 vcc, 0, v166
    ds_add_u32 v167, v166
    s_mov_b64 exec, -1
    s_branch K2_XT1R
K2_XT2:
K2_XVa:
    s_mov_b64 s[10:11], 0
    v_bitop3_b32 v166, v135, s36, v214 bitop3:0x28
    v_cmp_ne_u32 s[86:87], 0, v166
    v_cmp_gt_u32 vcc, 0x7ffffff0, v164
    s_and_b64 vcc, vcc, s[86:87]
    s_or_b64 s[10:11], s[10:11], vcc
    v_bitop3_b32 v166, v139, s36, v214 bitop3:0x28
    v_cmp_ne_u32 s[86:87], 0, v166
    v_cmp_gt_u32 vcc, 0x7ffffff0, v165
    s_and_b64 vcc, vcc, s[86:87]
    s_or_b64 s[10:11], s[10:11], vcc
    s_cbranch_scc0 K2_XWa
    s_sub_u32 s101, s101, 1
    s_cbranch_scc1 K2_END
    buffer_load_dwordx4 v[132:135], v164, s[32:35], 0 offen sc1
    buffer_load_dwordx4 v[136:139], v165, s[32:35], 0 offen sc1
    s_waitcnt vmcnt(0)
    s_branch K2_XVa
K2_XWa:
    v_and_b32 v140, 255, v132
    v_lshlrev_b32 v140, 2, v140
    ds_read_b32 v140, v140 offset:6400
    v_and_b32 v141, 255, v133
    v_lshlrev_b32 v141, 2, v141
    ds_read_b32 v141, v141 offset:6400
    v_and_b32 v142, 255, v134
    v_lshlrev_b32 v142, 2, v142
    ds_read_b32 v142, v142 offset:6400
    v_and_b32 v135, 0x0f0f0f, v135
    v_and_b32 v143, 255, v136
    v_lshlrev_b32 v143, 2, v143
    ds_read_b32 v143, v143 offset:6400
    v_and_b32 v144, 255, v137
    v_lshlrev_b32 v144, 2, v144
    ds_read_b32 v144, v144 offset:6400
    v_and_b32 v145, 255, v138
    v_lshlrev_b32 v145, 2, v145
    ds_read_b32 v145, v145 offset:6400
    v_and_b32 v139, 0x0f0f0f, v139
    s_waitcnt lgkmcnt(0)
    v_perm_b32 v146, v135, v132, s64
    v_lshl_add_u32 v146, v146, 5, v206
    v_cmpx_lt_i32 vcc, 0, v204
    ds_add_rtn_u32 v140, v140, v171 offset:2112
    s_mov_b64 exec, -1
    v_perm_b32 v147, v135, v133, s65
    v_lshl_add_u32 v147, v147, 5, v206
    v_cmpx_lt_i32 vcc, 1, v204
    ds_add_rtn_u32 v141, v141, v171 offset:2112
    s_mov_b64 exec, -1
    v_perm_b32 v148, v135, v134, s66
    v_lshl_add_u32 v148, v148, 5, v206
    v_cmpx_lt_i32 vcc, 2, v204
    ds_add_rtn_u32 v142, v142, v171 offset:2112
    s_mov_b64 exec, -1
    v_perm_b32 v149, v139, v136, s64
    v_lshl_add_u32 v149, v149, 5, v207
    v_cmpx_lt_i32 vcc, 0, v205
    ds_add_rtn_u32 v143, v143, v171 offset:2112
    s_mov_b64 exec, -1
    v_perm_b32 v150, v139, v137, s65
    v_lshl_add_u32 v150, v150, 5, v207
    v_cmpx_lt_i32 vcc, 1, v205
    ds_add_rtn_u32 v144, v144, v171 offset:2112
    s_mov_b64 exec, -1
    v_perm_b32 v151, v139, v138, s66
    v_lshl_add_u32 v151, v151, 5, v207
    v_cmpx_lt_i32 vcc, 2, v205
    ds_add_rtn_u32 v145, v145, v171 offset:2112
    s_mov_b64 exec, -1
    s_waitcnt lgkmcnt(0)
    v_cmpx_lt_i32 vcc, 0, v204
    ds_write2st64_b32 v140, v132, v146 offset0:0 offset1:84
    s_mov_b64 exec, -1
    v_cmpx_lt_i32 vcc, 1, v204
    ds_write2st64_b32 v141, v133, v147 offset0:0 offset1:84
    s_mov_b64 exec, -1
    v_cmpx_lt_i32 vcc, 2, v204
    ds_write2st64_b32 v142, v134, v148 offset0:0 offset1:84
    s_mov_b64 exec, -1
    v_cmpx_lt_i32 vcc, 0, v205
    ds_write2st64_b32 v143, v136, v149 offset0:0 offset1:84
    s_mov_b64 exec, -1
    v_cmpx_lt_i32 vcc, 1, v205
    ds_write2st64_b32 v144, v137, v150 offset0:0 offset1:84
    s_mov_b64 exec, -1
    v_cmpx_lt_i32 vcc, 2, v205
    ds_write2st64_b32 v145, v138, v151 offset0:0 offset1:84
    s_mov_b64 exec, -1
    s_waitcnt lgkmcnt(0)
    s_branch K2_XT2R
K2_OVF:
    s_mov_b32 s80, 1
    s_mov_b32 s83, 0
    s_mov_b32 s77, 0
    s_mov_b32 s15, s76
    v_mov_b32 v190, 0xffff0000
    v_or_b32 v189, s39, v190
    v_mov_b32 v190, 0x7fffff00
    v_lshl_add_u32 v188, v254, 2, s15
    s_sub_u32 s73, s15, s76
    ds_write2st64_b32 v188, v189, v190 offset0:0 offset1:84
    ds_write2st64_b32 v188, v189, v190 offset0:1 offset1:85
    s_add_u32 s73, s73, 127
    s_lshr_b32 s73, s73, 7
    s_sub_i32 s38, s73, 1
    s_cmp_eq_u32 s97, 0
    s_cbranch_scc1 K2_PADS0
    s_mov_b32 s97, 0
    s_waitcnt vmcnt(0)
K2_XVb:
    s_mov_b64 s[10:11], 0
    v_bitop3_b32 v166, v135, s36, v214 bitop3:0x28
    v_cmp_ne_u32 s[86:87], 0, v166
    v_cmp_gt_u32 vcc, 0x7ffffff0, v164
    s_and_b64 vcc, vcc, s[86:87]
    s_or_b64 s[10:11], s[10:11], vcc
    v_bitop3_b32 v166, v139, s36, v214 bitop3:0x28
    v_cmp_ne_u32 s[86:87], 0, v166
    v_cmp_gt_u32 vcc, 0x7ffffff0, v165
    s_and_b64 vcc, vcc, s[86:87]
    s_or_b64 s[10:11], s[10:11], vcc
    s_cbranch_scc0 K2_XWb
    s_sub_u32 s101, s101, 1
    s_cbranch_scc1 K2_END
    buffer_load_dwordx4 v[132:135], v164, s[32:35], 0 offen sc1
    buffer_load_dwordx4 v[136:139], v165, s[32:35], 0 offen sc1
    s_waitcnt vmcnt(0)
    s_branch K2_XVb
K2_XWb:
    s_branch K2_PADS0
K2_SLOW:
    s_add_u32 s81, s81, 448
    s_cmp_lt_u32 s81, s82
    s_cbranch_scc1 K2_BATCH
K2_FIND:
    s_cmp_lg_u64 s[84:85], 0
    s_cbranch_scc1 K2_GOT
    s_add_u32 s79, s79, 1
    s_cmp_ge_u32 s79, 4
    s_cbranch_scc1 K2_EPI
    s_mul_i32 s10, s12, 32896
    s_lshl_b32 s11, s79, 13
    s_add_u32 s10, s10, s11
    v_lshlrev_b32 v252, 7, v254
    buffer_load_ubyte v252, v252, s[24:27], s10 offen offset:15 sc1
    s_waitcnt vmcnt(0)
    v_cmp_lt_u32 s[84:85], s77, v252
    s_nop 3
    s_branch K2_FIND
K2_GOT:
    s_ff1_i32_b64 s10, s[84:85]
    s_bitset0_b64 s[84:85], s10
    s_lshl_b32 s11, s79, 6
    s_add_u32 s80, s10, s11
    s_mul_i32 s10, s12, 32896
    s_lshl_b32 s11, s80, 7
    s_add_u32 s10, s10, s11
    s_lshl_b32 s11, s12, 8
    s_add_u32 s11, s11, s80
    s_lshl_b32 s11, s11, 2
    s_add_u32 s11, s11, 23068672
    v_mov_b32 v188, 0
    buffer_load_ubyte v189, v188, s[24:27], s10 offen offset:15 sc1
    buffer_load_dword v190, v188, s[24:27], s11 offen sc1
    s_waitcnt vmcnt(0)
    v_readfirstlane_b32 s10, v189
    v_readfirstlane_b32 s11, v190
    s_nop 3
    s_and_b32 s83, s11, 0xffff
    s_lshr_b32 s11, s11, 16
    s_lshr_b32 s82, s10, 2
    s_sub_u32 s82, s10, s82
    s_cmp_gt_u32 s10, 48
    s_cselect_b32 s82, s11, s82
    s_lshr_b32 s10, s77, 2
    s_sub_u32 s81, s77, s10
K2_BATCH:
    s_barrier
    v_and_b32 v188, 7, v254
    v_mul_u32_u24 v189, 2688, v188
    v_add_u32 v189, 9728, v189
    v_lshlrev_b32 v188, 2, v188
    ds_write_b32 v188, v189 offset:2112
    v_add_u32 v188, s81, v255
    s_mul_i32 s10, s12, 32896
    s_lshl_b32 s11, s80, 7
    s_add_u32 s10, s10, s11
    v_mul_u32_u24 v190, 87382, v188
    v_lshrrev_b32 v190, 16, v190
    v_lshl_add_u32 v189, v190, 2, s10
    v_add_u32 v191, 8421248, v189
    v_cmp_lt_u32 vcc, 31, v190
    s_mul_i32 s11, s80, 3125
    s_add_u32 s11, s11, s83
    v_cndmask_b32 v189, v189, v191, vcc
    v_or_b32 v191, 12, v189
    v_and_b32 v192, 3, v190
    v_add_u32 v191, v191, v192
    v_cmp_le_u32 vcc, 48, v190
    v_add_u32 v190, s11, v188
    v_add_u32 v192, 22020096, v190
    v_cndmask_b32 v191, v191, v192, vcc
    v_lshlrev_b32 v190, 2, v190
    v_add_u32 v190, 17825792, v190
    v_cndmask_b32 v189, v189, v190, vcc
    s_add_u32 s10, s81, 448
    s_min_u32 s10, s10, s82
    v_cmp_gt_u32 vcc, s10, v188
    v_mov_b32 v190, 0x7ffffff0
    s_mul_i32 s86, s80, 100000
    v_cndmask_b32 v189, v190, v189, vcc
    v_cndmask_b32 v191, v190, v191, vcc
    buffer_load_dword v189, v189, s[24:27], 0 offen sc1
    buffer_load_ubyte v191, v191, s[24:27], 0 offen sc1
    s_waitcnt lgkmcnt(0)
    s_barrier
    s_and_saveexec_b64 s[10:11], vcc
    s_waitcnt vmcnt(0)
    v_and_b32 v188, 255, v189
    v_lshlrev_b32 v188, 2, v188
    ds_read_b32 v188, v188 offset:6400
    v_bfe_u32 v190, v189, 8, 8
    v_and_b32 v191, 15, v191
    v_lshl_or_b32 v191, v191, 8, v190
    v_mov_b32 v190, 4
    v_lshl_add_u32 v191, v191, 5, s86
    s_waitcnt lgkmcnt(0)
    ds_add_rtn_u32 v188, v188, v190 offset:2112
    s_waitcnt lgkmcnt(0)
    ds_write2st64_b32 v188, v189, v191 offset0:0 offset1:84
    s_mov_b64 exec, -1
    s_waitcnt lgkmcnt(0)
    s_barrier
    s_lshl_b32 s10, s3, 2
    v_mov_b32 v188, s10
    ds_read_b32 v188, v188 offset:2112
    v_mov_b32 v180, 0
    v_mov_b32 v181, 0
    v_mov_b32 v182, 0
    v_mov_b32 v183, 0
    v_mov_b32 v184, 0
    v_mov_b32 v185, 0
    v_mov_b32 v186, 0
    v_mov_b32 v187, 0
    v_lshrrev_b32 v189, 3, v254
    v_lshl_add_u32 v247, v189, 4, s76
    v_and_b32 v189, 31, v254
    v_lshl_add_u32 v249, v189, 2, s76
    v_lshrrev_b32 v190, 1, v254
    v_lshl_add_u32 v251, v190, 2, s76
    v_add_u32 v251, 21504, v251
    v_and_b32 v189, 44, v254
    v_add_u32 v248, s76, v189
    s_waitcnt lgkmcnt(0)
    v_readfirstlane_b32 s15, v188
    s_nop 3
    v_mov_b32 v190, 0xffff0000
    v_or_b32 v189, s39, v190
    v_mov_b32 v190, 0x7fffff00
    v_lshl_add_u32 v188, v254, 2, s15
    s_sub_u32 s73, s15, s76
    ds_write2st64_b32 v188, v189, v190 offset0:0 offset1:84
    ds_write2st64_b32 v188, v189, v190 offset0:1 offset1:85
    s_add_u32 s73, s73, 127
    s_lshr_b32 s73, s73, 7
    s_sub_i32 s38, s73, 1
K2_LAST:
    s_branch K2_GO
.section .rodata,"a"
.p2align 6
.amdhsa_kernel standalone__edge_featured_mpnn_gatedgcn__graph_kernel
  .amdhsa_next_free_vgpr 256
  .amdhsa_next_free_sgpr 102
  .amdhsa_accum_offset 256
  .amdhsa_group_segment_fixed_size 0
  .amdhsa_kernarg_size 96
  .amdhsa_user_sgpr_count 2
  .amdhsa_user_sgpr_kernarg_segment_ptr 1
  .amdhsa_system_sgpr_workgroup_id_x 1
.end_amdhsa_kernel
```

```asm
; @launch grid=(256,1,1) block=(512,1,1) lds=157696
.amdgcn_target "amdgcn-amd-amdhsa--gfx950"
.text
.globl standalone__edge_featured_mpnn_gatedgcn__graph_kernel
.p2align 8
.type standalone__edge_featured_mpnn_gatedgcn__graph_kernel,@function
standalone__edge_featured_mpnn_gatedgcn__graph_kernel:
    s_cmp_ge_u32 s2, 256
    s_cbranch_scc1 K2_END
    s_load_dwordx4 s[44:47], s[0:1], 16
    s_load_dwordx2 s[8:9], s[0:1], 88
    s_load_dwordx4 s[40:43], s[0:1], 0
    s_load_dwordx8 s[48:55], s[0:1], 32
    s_load_dwordx4 s[56:59], s[0:1], 64
    s_getpc_b64 s[86:87]
K2_PC:
    v_lshlrev_b32 v252, 7, v0
    v_min_u32 v252, K2_LAST-K2_PC, v252
    v_cmp_gt_u32 vcc, 192, v0
    s_cbranch_vccz K2_NOCPF
    global_load_dword v253, v252, s[86:87]
K2_NOCPF:
    v_mov_b32 v255, v0
    v_lshrrev_b32 v188, 6, v0
    v_and_b32 v254, 63, v0
    v_readfirstlane_b32 s7, v188
    s_and_b32 s10, s2, 7
    s_lshr_b32 s11, s2, 3
    s_lshl_b32 s10, s10, 5
    s_add_u32 s12, s10, s11
    s_mul_i32 s13, s12, 12500
    v_lshlrev_b32 v189, 4, v0
    v_lshlrev_b32 v1, 3, v0
    v_lshlrev_b32 v2, 2, v0
    v_mov_b32 v3, 0
    v_and_b32 v4, 0x3fc, v2
    ds_write_b32 v4, v3 offset:6400
    s_and_b32 s10, s7, 3
    s_lshr_b32 s3, s7, 2
    s_lshl1_add_u32 s3, s10, s3
    s_xor_b32 s3, s3, 1
    s_movk_i32 s14, 8192
    s_movk_i32 s15, 12288
    s_waitcnt lgkmcnt(0)
    s_add_u32 s64, s46, s13
    s_addc_u32 s65, s47, 0
    s_mov_b32 s66, 12500
    s_mov_b32 s67, 0x20000
    s_add_u32 s68, s44, s13
    s_addc_u32 s69, s45, 0
    s_mov_b32 s70, 12500
    s_mov_b32 s71, 0x20000
    buffer_load_dwordx4 v[8:11], v189, s[64:67], 0 offen nt
    buffer_load_dwordx2 v[12:13], v1, s[64:67], s14 offen nt
    buffer_load_dword v14, v2, s[64:67], s15 offen nt
    s_barrier
    buffer_load_dwordx4 v[16:19], v189, s[68:71], 0 offen nt
    buffer_load_dwordx2 v[20:21], v1, s[68:71], s14 offen nt
    buffer_load_dword v22, v2, s[68:71], s15 offen nt
    s_add_u32 s10, s8, 24117248
    s_addc_u32 s11, s9, 0
    s_load_dword s100, s[10:11], 0
    v_lshrrev_b32 v1, 3, v0
    v_lshlrev_b32 v170, 2, v1
    v_and_b32 v197, 7, v0
    v_and_b32 v5, 16, v0
    v_lshlrev_b32 v5, 1, v5
    v_xor_b32 v5, v5, v189
    v_lshlrev_b32 v172, 4, v254
    v_and_b32 v241, 16, v254
    v_lshlrev_b32 v241, 2, v241
    v_xor_b32 v234, v241, v172
    v_and_b32 v241, 0x70, v234
    s_mov_b32 s16, s40
    s_mov_b32 s17, s41
    s_mov_b32 s18, 6400000
    s_mov_b32 s19, 0x20000
    s_mov_b32 s60, 85599
    s_mov_b32 s61, 4294967100
    s_movk_i32 s62, 2000
    v_mov_b32 v7, 87382
    s_mov_b32 s10, 0
    v_lshl_add_u32 v56, v254, 10, s10
    v_add_u32 v57, 256, v56
    v_add_u32 v58, 512, v56
    v_add_u32 v59, 768, v56
    v_and_b32 v60, 127, v255
    v_lshl_add_u32 v60, v60, 9, s10
    v_add_u32 v61, 256, v60
    v_lshl_add_u32 v62, v254, 8, s10
    v_lshrrev_b32 v23, 6, v255
    v_lshrrev_b32 v31, 7, v255
    v_add_u32 v31, 8, v31
    v_mov_b32 v39, 12
    v_cmp_gt_u32 s[78:79], 53, v255
    s_mov_b32 s11, 32896
    v_lshlrev_b32 v3, 4, v197
    v_mad_u32_u24 v4, v1, s11, v3
    v_mul_u32_u24 v6, 52, v1
    v_lshl_add_u32 v6, v197, 2, v6
    v_lshlrev_b32 v3, 2, v6
    v_add_u32 v3, 104448, v3
    v_add_u32 v6, 91136, v6
    v_mov_b32 v214, 0xf0f0f0
    v_mov_b32 v15, 0x0f0f0f
    s_waitcnt vmcnt(3)
    v_mul_u32_u24 v48, s60, v8
    v_mul_u32_u24 v49, s60, v9
    v_mul_u32_u24 v50, s60, v10
    v_mul_u32_u24 v51, s60, v11
    v_mul_u32_u24 v52, s60, v12
    v_mul_u32_u24 v53, s60, v13
    v_lshrrev_b32 v48, 24, v48
    v_lshrrev_b32 v49, 24, v49
    v_lshrrev_b32 v50, 24, v50
    v_lshrrev_b32 v51, 24, v51
    v_lshrrev_b32 v52, 24, v52
    v_lshrrev_b32 v53, 24, v53
    v_lshl_add_u32 v24, v48, 2, s62
    ds_add_rtn_u32 v32, v24, v7 offset:4400
    v_lshl_add_u32 v25, v49, 2, s62
    ds_add_rtn_u32 v33, v25, v7 offset:4400
    v_lshl_add_u32 v26, v50, 2, s62
    ds_add_rtn_u32 v34, v26, v7 offset:4400
    v_lshl_add_u32 v27, v51, 2, s62
    ds_add_rtn_u32 v35, v27, v7 offset:4400
    v_lshl_add_u32 v28, v52, 2, s62
    ds_add_rtn_u32 v36, v28, v7 offset:4400
    v_lshl_add_u32 v29, v53, 2, s62
    ds_add_rtn_u32 v37, v29, v7 offset:4400
    v_mad_i32_i24 v8, v48, s61, v8
    v_or_b32 v8, v8, v56
    v_mad_i32_i24 v9, v49, s61, v9
    v_or_b32 v9, v9, v57
    v_mad_i32_i24 v10, v50, s61, v10
    v_or_b32 v10, v10, v58
    v_mad_i32_i24 v11, v51, s61, v11
    v_or_b32 v11, v11, v59
    v_mad_i32_i24 v12, v52, s61, v12
    v_or_b32 v12, v12, v60
    v_mad_i32_i24 v13, v53, s61, v13
    v_or_b32 v13, v13, v61
    s_waitcnt lgkmcnt(5)
    v_lshrrev_b32 v32, 16, v32
    v_min_u32 v40, 48, v32
    v_mad_u32_u24 v40, v24, 13, v40
    v_lshlrev_b32 v48, 2, v40
    ds_write_b8 v40, v23 offset:65136
    s_waitcnt lgkmcnt(5)
    v_lshrrev_b32 v33, 16, v33
    v_min_u32 v41, 48, v33
    v_mad_u32_u24 v41, v25, 13, v41
    v_lshlrev_b32 v49, 2, v41
    ds_write_b8 v41, v23 offset:65136
    s_waitcnt lgkmcnt(5)
    v_lshrrev_b32 v34, 16, v34
    v_min_u32 v42, 48, v34
    v_mad_u32_u24 v42, v26, 13, v42
    v_lshlrev_b32 v50, 2, v42
    ds_write_b8 v42, v23 offset:65136
    s_waitcnt lgkmcnt(5)
    v_lshrrev_b32 v35, 16, v35
    v_min_u32 v43, 48, v35
    v_mad_u32_u24 v43, v27, 13, v43
    v_lshlrev_b32 v51, 2, v43
    ds_write_b8 v43, v23 offset:65136
    s_waitcnt lgkmcnt(5)
    v_lshrrev_b32 v36, 16, v36
    v_min_u32 v44, 48, v36
    v_mad_u32_u24 v44, v28, 13, v44
    v_lshlrev_b32 v52, 2, v44
    ds_write_b8 v44, v31 offset:65136
    s_waitcnt lgkmcnt(5)
    v_lshrrev_b32 v37, 16, v37
    v_min_u32 v45, 48, v37
    v_mad_u32_u24 v45, v29, 13, v45
    v_lshlrev_b32 v53, 2, v45
    ds_write_b8 v45, v31 offset:65136
    s_cmp_lg_u32 s7, 0
    s_cbranch_scc1 K1_NO7
    s_mov_b64 exec, s[78:79]
    s_waitcnt lgkmcnt(0)
    v_mul_u32_u24 v54, s60, v14
    v_lshrrev_b32 v54, 24, v54
    v_lshl_add_u32 v30, v54, 2, s62
    ds_add_rtn_u32 v38, v30, v7 offset:4400
    v_mad_i32_i24 v14, v54, s61, v14
    v_or_b32 v14, v14, v62
    s_waitcnt lgkmcnt(0)
    v_lshrrev_b32 v38, 16, v38
    v_min_u32 v46, 48, v38
    v_mad_u32_u24 v46, v30, 13, v46
    v_lshlrev_b32 v54, 2, v46
    ds_write_b8 v46, v39 offset:65136
    s_waitcnt vmcnt(0)
    v_lshl_add_u32 v22, v22, 16, v14
    ds_write_b32 v54, v22 offset:448
    s_mov_b64 exec, -1
K1_NO7:
    s_mov_b32 s64, s50
    s_mov_b32 s65, s51
    s_mov_b32 s66, 8192
    s_mov_b32 s67, 0x20000
    buffer_load_dwordx4 v[64:67], v5, s[64:67], 0 offen
    s_mov_b32 s68, s52
    s_mov_b32 s69, s53
    s_mov_b32 s70, 2048
    s_mov_b32 s71, 0x20000
    buffer_load_dwordx4 v[68:71], v5, s[68:71], 0 offen
    s_lshl_b32 s10, s7, 10
    s_mov_b32 s64, s48
    s_mov_b32 s65, s49
    s_add_u32 m0, s10, 34304
    s_nop 0
    buffer_load_dwordx4 v5, s[64:67], 0 offen lds
    s_mov_b32 s64, s56
    s_mov_b32 s65, s57
    s_add_u32 m0, s10, 26112
    s_nop 0
    buffer_load_dwordx4 v5, s[64:67], 0 offen lds
    s_mov_b32 s64, s54
    s_mov_b32 s65, s55
    s_add_u32 m0, s10, 9728
    s_nop 0
    buffer_load_dwordx4 v5, s[64:67], 0 offen lds
    s_waitcnt vmcnt(5)
    v_lshl_add_u32 v16, v16, 16, v8
    ds_write_b32 v48, v16 offset:448
    v_lshl_add_u32 v17, v17, 16, v9
    ds_write_b32 v49, v17 offset:448
    v_lshl_add_u32 v18, v18, 16, v10
    ds_write_b32 v50, v18 offset:448
    v_lshl_add_u32 v19, v19, 16, v11
    ds_write_b32 v51, v19 offset:448
    v_lshl_add_u32 v20, v20, 16, v12
    ds_write_b32 v52, v20 offset:448
    v_lshl_add_u32 v21, v21, 16, v13
    ds_write_b32 v53, v21 offset:448
    s_lshl_b32 s15, s12, 7
    s_add_u32 s32, s8, s15
    s_addc_u32 s33, s9, 0
    s_mov_b32 s34, 16809984
    s_mov_b32 s35, 0x20000
    s_waitcnt lgkmcnt(0)
    s_add_u32 s100, s100, 1
    s_and_b32 s10, s100, 15
    s_and_b32 s11, s100, 0xf0
    s_mul_i32 s36, s10, 0x1010
    s_lshl_b32 s11, s11, 16
    s_xor_b32 s36, s36, 0xf000
    s_or_b32 s36, s36, s11
    s_mov_b32 s101, 300000
    s_barrier
    ds_read_b128 v[112:115], v172 offset:6400
    ds_read_u16 v108, v170 offset:6402
    ds_read_b32 v104, v6 offset:0
    ds_read_b128 v[88:91], v3 offset:0
    ds_read_u16 v109, v170 offset:6658
    ds_read_b32 v105, v6 offset:3328
    ds_read_b128 v[92:95], v3 offset:13312
    ds_read_u16 v110, v170 offset:6914
    ds_read_b32 v106, v6 offset:6656
    ds_read_b128 v[96:99], v3 offset:26624
    ds_read_u16 v111, v170 offset:7170
    ds_read_b32 v107, v6 offset:9984
    ds_read_b128 v[100:103], v3 offset:39936
    s_waitcnt lgkmcnt(12)
    v_max3_u32 v1, v112, v113, v114
    v_max_u32 v1, v1, v115
    v_cmp_le_u32 vcc, 3211264, v1
    s_mov_b32 s10, 0
    s_cbranch_vccnz K1_OVF
K1_OUT:
    s_waitcnt lgkmcnt(9)
    v_lshl_or_b32 v108, v108, 24, s36
    v_and_or_b32 v91, v104, v15, v108
    buffer_store_dwordx4 v[88:91], v4, s[32:35], s10 offen sc1
    s_add_u32 s10, s10, 2105344
    s_waitcnt lgkmcnt(6)
    v_lshl_or_b32 v109, v109, 24, s36
    v_and_or_b32 v95, v105, v15, v109
    buffer_store_dwordx4 v[92:95], v4, s[32:35], s10 offen sc1
    s_add_u32 s10, s10, 2105344
    s_waitcnt lgkmcnt(3)
    v_lshl_or_b32 v110, v110, 24, s36
    v_and_or_b32 v99, v106, v15, v110
    buffer_store_dwordx4 v[96:99], v4, s[32:35], s10 offen sc1
    s_add_u32 s10, s10, 2105344
    s_waitcnt lgkmcnt(0)
    v_lshl_or_b32 v111, v111, 24, s36
    v_and_or_b32 v103, v107, v15, v111
    buffer_store_dwordx4 v[100:103], v4, s[32:35], s10 offen sc1
    s_add_u32 s10, s10, 2105344
    v_max3_u32 v1, v108, v109, v110
    v_max_u32 v1, v1, v111
    v_cmp_le_u32 vcc, 553648128, v1
    s_cbranch_vccnz K1_EXT
K1_EXTR:
    s_lshr_b32 s10, s3, 1
    s_mul_i32 s10, s10, 49
    s_bitcmp1_b32 s3, 0
    s_cselect_b32 s72, 20, -4
    s_cselect_b32 s73, 28, 3
    s_cselect_b32 s84, 45, 20
    s_add_i32 s72, s72, s10
    s_add_i32 s73, s73, s10
    s_add_i32 s84, s84, s10
    s_add_i32 s85, s72, 32
    s_max_i32 s96, s72, 0
    s_cmp_eq_u32 s3, 7
    s_cselect_b32 s84, 196, s84
    s_cselect_b32 s85, 196, s85
    v_lshrrev_b32 v193, 5, v254
    s_mov_b32 s20, s42
    s_mov_b32 s21, s43
    s_mov_b32 s22, 25600000
    s_mov_b32 s23, 0x20000
    s_mov_b32 s28, s58
    s_mov_b32 s29, s59
    s_mov_b32 s30, 6400000
    s_mov_b32 s31, 0x20000
    s_mov_b32 s24, s8
    s_mov_b32 s25, s9
    s_mov_b32 s26, 24117376
    s_mov_b32 s27, 0x20000
    v_lshrrev_b32 v194, 5, v255
    v_and_b32 v195, 15, v255
    v_cmp_eq_u32 vcc, v194, v195
    v_and_b32 v194, 16, v255
    v_mov_b32 v195, 0x3f80
    v_lshlrev_b32 v195, v194, v195
    v_cndmask_b32 v195, 0, v195, vcc
    v_lshlrev_b32 v194, 2, v255
    v_mov_b32 v196, 0
    ds_write_b32 v194, v195
    v_bfe_u32 v195, v255, 3, 1
    v_and_b32 v201, 7, v255
    v_lshl_add_u32 v195, v195, 2, v201
    v_lshrrev_b32 v200, 6, v255
    v_cmp_eq_u32 vcc, v195, v200
    v_bfe_u32 v200, v255, 4, 2
    v_mov_b32 v195, 0x3f80
    v_cndmask_b32 v195, 0, v195, vcc
    v_cmp_lt_u32 vcc, 3, v201
    v_mul_u32_u24 v200, 0x5555, v200
    v_and_b32 v201, 60, v194
    v_cndmask_b32 v195, v195, v200, vcc
    ds_write_b32 v194, v195 offset:7424
    ds_write_b32 v201, v196 offset:9472
    ds_write_b32 v194, v196 offset:2048
    ds_write2st64_b32 v194, v196, v196 offset0:9 offset1:17
    s_movk_i32 s75, 128
    s_mul_i32 s74, s3, 5184
    s_add_u32 s74, s74, 102400
    s_movk_i32 s77, 48
    s_add_u32 s39, s96, 32
    s_lshl_b32 s11, s96, 6
    s_mov_b32 s97, 0
    v_bfe_u32 v194, v254, 4, 1
    v_and_b32 v242, 1, v254
    v_lshlrev_b32 v242, 4, v242
    v_lshlrev_b32 v245, 5, v193
    v_subrev_u32 v245, s11, v245
    v_and_b32 v195, 3, v254
    v_lshlrev_b32 v195, 3, v195
    v_lshl_add_u32 v246, v194, 5, v195
    v_subrev_u32 v246, s11, v246
    v_mul_u32_u24 v196, 130, v195
    v_and_b32 v194, 28, v254
    v_lshl_add_u32 v196, v194, 5, v196
    v_bfe_u32 v194, v254, 3, 1
    v_xor_b32 v194, v194, v193
    v_lshl_add_u32 v196, v194, 6, v196
    v_add_u32 v243, s74, v196
    v_and_b32 v194, 31, v254
    v_lshl_add_u32 v194, v194, 1, v193
    v_lshl_add_u32 v244, v194, 4, s74
    v_add_u32 v244, 4160, v244
    s_mul_i32 s76, s3, 2688
    s_add_u32 s76, s76, 9728
    v_lshrrev_b32 v194, 3, v254
    v_lshl_add_u32 v247, v194, 4, s76
    v_and_b32 v194, 31, v254
    v_lshl_add_u32 v249, v194, 2, s76
    v_lshrrev_b32 v195, 1, v254
    v_lshl_add_u32 v251, v195, 2, s76
    v_add_u32 v251, 21504, v251
    v_and_b32 v194, 44, v254
    v_add_u32 v248, s76, v194
    s_mul_i32 s10, s7, 4160
    s_add_u32 s10, s10, 69120
    v_and_b32 v202, 31, v254
    v_bfe_u32 v194, v202, 1, 1
    v_xor_b32 v194, v194, v193
    v_lshlrev_b32 v194, 6, v194
    v_lshl_add_u32 v194, v202, 7, v194
    v_lshrrev_b32 v202, 3, v202
    v_lshl_add_u32 v202, v202, 4, v194
    v_add_u32 v202, s10, v202
    v_lshrrev_b32 v194, 1, v254
    v_xor_b32 v194, v194, v254
    v_and_b32 v194, 4, v194
    v_mul_u32_u24 v194, 3, v194
    v_xor_b32 v194, v194, v254
    v_and_b32 v235, 31, v194
    v_bfe_u32 v195, v235, 1, 1
    v_xor_b32 v195, v195, v193
    v_lshlrev_b32 v195, 6, v195
    v_lshl_add_u32 v195, v235, 7, v195
    v_lshrrev_b32 v235, 3, v235
    v_lshl_add_u32 v235, v235, 4, v195
    v_add_u32 v235, s10, v235
    v_mov_b32 v177, 0xdddd
    v_lshlrev_b32 v168, 2, v197
    v_mul_u32_u24 v208, 25000, v170
    v_add_u32 v209, 6400000, v208
    v_add_u32 v210, 12800000, v208
    v_add_u32 v211, 19200000, v208
    v_mov_b32 v171, 4
    v_mov_b32 v169, 1
    v_and_b32 v199, 31, v254
    v_add_u32 v199, s96, v199
    v_lshlrev_b32 v200, 4, v199
    v_lshl_add_u32 v200, v193, 3, v200
    v_mov_b64 v[180:181], 0
    v_mov_b64 v[182:183], 0
    v_mov_b64 v[184:185], 0
    v_mov_b64 v[186:187], 0
    s_lshl_b32 s15, s3, 2
    v_mov_b32 v212, s15
    v_lshlrev_b32 v213, 2, v199
    s_mul_i32 s10, s12, 32896
    s_add_u32 s32, s8, s10
    s_addc_u32 s33, s9, 0
    s_mov_b32 s34, 32768
    s_mov_b32 s35, 0x20000
    s_movk_i32 s79, 8192
    s_movk_i32 s80, 16384
    s_movk_i32 s81, 24576
    s_mov_b32 s10, 0xbfb8aa3b
    s_waitcnt vmcnt(7)
    v_lshlrev_b32 v72, 16, v64
    v_and_b32 v73, 0xffff0000, v64
    v_lshlrev_b32 v74, 16, v65
    v_and_b32 v75, 0xffff0000, v65
    v_lshlrev_b32 v76, 16, v66
    v_and_b32 v77, 0xffff0000, v66
    v_lshlrev_b32 v78, 16, v67
    v_and_b32 v79, 0xffff0000, v67
    v_lshlrev_b32 v80, 16, v68
    v_and_b32 v81, 0xffff0000, v68
    v_lshlrev_b32 v82, 16, v69
    v_and_b32 v83, 0xffff0000, v69
    v_lshlrev_b32 v84, 16, v70
    v_and_b32 v85, 0xffff0000, v70
    v_lshlrev_b32 v86, 16, v71
    v_and_b32 v87, 0xffff0000, v71
    v_mul_f32 v72, s10, v72
    v_mul_f32 v73, s10, v73
    v_mul_f32 v74, s10, v74
    v_mul_f32 v75, s10, v75
    v_mul_f32 v76, s10, v76
    v_mul_f32 v77, s10, v77
    v_mul_f32 v78, s10, v78
    v_mul_f32 v79, s10, v79
    v_mul_f32 v80, s10, v80
    v_mul_f32 v81, s10, v81
    v_mul_f32 v82, s10, v82
    v_mul_f32 v83, s10, v83
    v_mul_f32 v84, s10, v84
    v_mul_f32 v85, s10, v85
    v_mul_f32 v86, s10, v86
    v_mul_f32 v87, s10, v87
    v_cvt_pk_bf16_f32 v64, v72, v73
    v_cvt_pk_bf16_f32 v65, v74, v75
    v_cvt_pk_bf16_f32 v66, v76, v77
    v_cvt_pk_bf16_f32 v67, v78, v79
    v_cvt_pk_bf16_f32 v68, v80, v81
    v_cvt_pk_bf16_f32 v69, v82, v83
    v_cvt_pk_bf16_f32 v70, v84, v85
    v_cvt_pk_bf16_f32 v71, v86, v87
    ds_write_b128 v189, v[64:67] offset:17920
    s_cmp_ge_u32 s7, 2
    s_cbranch_scc1 K1_NOWC
    ds_write_b128 v189, v[68:71] offset:42496
K1_NOWC:
    v_bfe_u32 v173, v254, 2, 2
    v_lshlrev_b32 v173, 7, v173
    v_lshl_add_u32 v173, v242, 2, v173
    v_and_b32 v174, 16, v254
    v_and_b32 v175, 2, v254
    v_lshl_add_u32 v174, v175, 2, v174
    v_and_b32 v175, 8, v254
    v_lshl_add_u32 v174, v175, 2, v174
    v_add_u32 v173, v173, v174
    v_lshl_add_u32 v175, v193, 10, v173
    v_lshl_add_u32 v173, v193, 12, v173
    v_xor_b32 v174, 32, v173
    v_xor_b32 v176, 32, v175
    s_lshl_b32 s10, s7, 10
    s_and_b32 s11, s7, 4
    s_mul_i32 s11, s11, -1016
    s_add_u32 s11, s11, s10
    v_xor_b32 v252, s11, v173
    s_waitcnt vmcnt(0) lgkmcnt(0)
    s_barrier
    ds_read_b64_tr_b16 v[72:73], v252 offset:9728
    ds_read_b64_tr_b16 v[76:77], v252 offset:34304
    ds_read_b64_tr_b16 v[74:75], v252 offset:10240
    ds_read_b64_tr_b16 v[78:79], v252 offset:34816
    v_add_u32 v252, s10, v172
    ds_read_b64_tr_b16 v[0:1], v173 offset:17920
    ds_read_b64_tr_b16 v[2:3], v173 offset:18432
    ds_read_b64_tr_b16 v[4:5], v173 offset:18944
    ds_read_b64_tr_b16 v[6:7], v173 offset:19456
    ds_read_b64_tr_b16 v[8:9], v173 offset:19968
    ds_read_b64_tr_b16 v[10:11], v173 offset:20480
    ds_read_b64_tr_b16 v[12:13], v173 offset:20992
    ds_read_b64_tr_b16 v[14:15], v173 offset:21504
    s_waitcnt lgkmcnt(8)
    ds_write_b128 v252, v[72:75] offset:52736
    s_mov_b32 s10, 0xbfb8aa3b
    v_lshlrev_b32 v80, 16, v76
    v_and_b32 v81, 0xffff0000, v76
    v_lshlrev_b32 v82, 16, v77
    v_and_b32 v83, 0xffff0000, v77
    v_lshlrev_b32 v84, 16, v78
    v_and_b32 v85, 0xffff0000, v78
    v_lshlrev_b32 v86, 16, v79
    v_and_b32 v87, 0xffff0000, v79
    v_mul_f32 v80, s10, v80
    v_mul_f32 v81, s10, v81
    v_mul_f32 v82, s10, v82
    v_mul_f32 v83, s10, v83
    v_mul_f32 v84, s10, v84
    v_mul_f32 v85, s10, v85
    v_mul_f32 v86, s10, v86
    v_mul_f32 v87, s10, v87
    v_cvt_pk_bf16_f32 v76, v80, v81
    v_cvt_pk_bf16_f32 v77, v82, v83
    v_cvt_pk_bf16_f32 v78, v84, v85
    v_cvt_pk_bf16_f32 v79, v86, v87
    ds_write_b128 v252, v[76:79] offset:60928
    v_and_b32 v188, 3, v254
    v_lshlrev_b32 v190, 4, v188
    v_mul_u32_u24 v188, 5376, v188
    v_add_u32 v188, 2688, v188
    ds_write_b16 v190, v188 offset:6338
    s_waitcnt lgkmcnt(8)
    ds_read_b64_tr_b16 v[16:17], v174 offset:17920
    ds_read_b64_tr_b16 v[18:19], v174 offset:18432
    ds_read_b64_tr_b16 v[20:21], v174 offset:18944
    ds_read_b64_tr_b16 v[22:23], v174 offset:19456
    ds_read_b64_tr_b16 v[24:25], v174 offset:19968
    ds_read_b64_tr_b16 v[26:27], v174 offset:20480
    s_waitcnt lgkmcnt(8)
    ds_read_b64_tr_b16 v[28:29], v174 offset:20992
    ds_read_b64_tr_b16 v[30:31], v174 offset:21504
    ds_read_b64_tr_b16 v[64:65], v175 offset:42496
    ds_read_b64_tr_b16 v[66:67], v175 offset:43008
    ds_read_b64_tr_b16 v[68:69], v176 offset:42496
    ds_read_b64_tr_b16 v[70:71], v176 offset:43008
    s_waitcnt lgkmcnt(8)
    ds_read_b64_tr_b16 v[32:33], v173 offset:26112
    ds_read_b64_tr_b16 v[34:35], v173 offset:26624
    ds_read_b64_tr_b16 v[36:37], v173 offset:27136
    ds_read_b64_tr_b16 v[38:39], v173 offset:27648
    ds_read_b64_tr_b16 v[40:41], v173 offset:28160
    ds_read_b64_tr_b16 v[42:43], v173 offset:28672
    s_waitcnt lgkmcnt(8)
    ds_read_b64_tr_b16 v[44:45], v173 offset:29184
    ds_read_b64_tr_b16 v[46:47], v173 offset:29696
    ds_read_b64_tr_b16 v[48:49], v174 offset:26112
    ds_read_b64_tr_b16 v[50:51], v174 offset:26624
    ds_read_b64_tr_b16 v[52:53], v174 offset:27136
    ds_read_b64_tr_b16 v[54:55], v174 offset:27648
    s_waitcnt lgkmcnt(8)
    ds_read_b64_tr_b16 v[56:57], v174 offset:28160
    ds_read_b64_tr_b16 v[58:59], v174 offset:28672
    ds_read_b64_tr_b16 v[60:61], v174 offset:29184
    ds_read_b64_tr_b16 v[62:63], v174 offset:29696
    s_mov_b32 s5, 85899
    s_lshr_b32 s6, s12, 5
    s_mul_i32 s6, s6, 538758528
    s_sub_u32 s6, s6, 0
    buffer_load_dwordx4 v[88:91], v189, s[32:35], 0 offen sc1
    buffer_load_dwordx4 v[92:95], v189, s[32:35], s79 offen sc1
    buffer_load_dwordx4 v[96:99], v189, s[32:35], s80 offen sc1
    buffer_load_dwordx4 v[100:103], v189, s[32:35], s81 offen sc1
    s_mov_b32 s64, 0xc0c0401
    s_mov_b32 s65, 0xc0c0501
    s_mov_b32 s66, 0xc0c0601
    s_mov_b32 s67, 0x05040100
    s_movk_i32 s4, 1338
    s_movk_i32 s13, 4032
    s_movk_i32 s14, 16056
    s_waitcnt lgkmcnt(0)
    s_barrier
K2_CHK0:
    s_waitcnt vmcnt(3)
    v_bitop3_b32 v188, v91, s36, v214 bitop3:0x28
    v_cmp_ne_u32 vcc, 0, v188
    v_sub_u32_sdwa v188, v91, v168 dst_sel:DWORD dst_unused:UNUSED_PAD src0_sel:BYTE_3 src1_sel:DWORD
    v_mul_u32_u24_sdwa v104, s5, v88 dst_sel:DWORD dst_unused:UNUSED_PAD src0_sel:DWORD src1_sel:WORD_1
    v_mul_u32_u24_sdwa v105, s5, v89 dst_sel:DWORD dst_unused:UNUSED_PAD src0_sel:DWORD src1_sel:WORD_1
    v_mul_u32_u24_sdwa v106, s5, v90 dst_sel:DWORD dst_unused:UNUSED_PAD src0_sel:DWORD src1_sel:WORD_1
    s_cbranch_vccnz K2_RETRY0
    v_cmp_lt_i32 s[40:41], 0, v188
    v_cmp_lt_i32 s[42:43], 1, v188
    v_cmp_lt_i32 s[44:45], 2, v188
    v_subrev_u32 v104, s6, v104
    v_subrev_u32 v105, s6, v105
    v_subrev_u32 v106, s6, v106
    v_alignbit_b32 v104, v88, v104, 28
    v_alignbit_b32 v105, v89, v105, 28
    v_alignbit_b32 v106, v90, v106, 28
    v_and_b32 v104, 0xffc, v104
    v_and_b32 v105, 0xffc, v105
    v_and_b32 v106, 0xffc, v106
    v_mul_u32_u24_sdwa v116, s4, v88 dst_sel:DWORD dst_unused:UNUSED_PAD src0_sel:DWORD src1_sel:BYTE_0
    v_mul_u32_u24_sdwa v117, s4, v89 dst_sel:DWORD dst_unused:UNUSED_PAD src0_sel:DWORD src1_sel:BYTE_0
    v_mul_u32_u24_sdwa v118, s4, v90 dst_sel:DWORD dst_unused:UNUSED_PAD src0_sel:DWORD src1_sel:BYTE_0
    v_subrev_u32 v116, 40140, v116
    v_subrev_u32 v117, 40140, v117
    v_subrev_u32 v118, 40140, v118
    v_cmp_gt_u16 s[68:69], s14, v116
    v_cmp_gt_u16 s[70:71], s14, v117
    v_cmp_gt_u16 s[86:87], s14, v118
    v_lshrrev_b32 v116, 16, v116
    v_lshrrev_b32 v117, 16, v117
    v_lshrrev_b32 v118, 16, v118
    v_lshl_add_u32 v116, v116, 4, s13
    v_lshl_add_u32 v117, v117, 4, s13
    v_lshl_add_u32 v118, v118, 4, s13
    v_cndmask_b32 v104, v104, v116, s[68:69]
    v_cndmask_b32 v105, v105, v117, s[70:71]
    v_cndmask_b32 v106, v106, v118, s[86:87]
    s_mov_b64 exec, s[40:41]
    ds_add_rtn_u32 v220, v104, v171 offset:2304
    s_mov_b64 exec, s[42:43]
    ds_add_rtn_u32 v221, v105, v171 offset:2304
    s_mov_b64 exec, s[44:45]
    ds_add_rtn_u32 v222, v106, v171 offset:2304
    s_mov_b64 exec, -1
    v_and_b32 v119, 0x0f0f0f, v91
    v_perm_b32 v152, v119, v88, s64
    s_and_b64 s[68:69], s[68:69], s[40:41]
    v_lshl_add_u32 v152, v152, 5, v208
    s_andn2_b64 s[40:41], s[40:41], s[68:69]
    v_perm_b32 v153, v119, v89, s65
    s_and_b64 s[70:71], s[70:71], s[42:43]
    v_lshl_add_u32 v153, v153, 5, v208
    s_andn2_b64 s[42:43], s[42:43], s[70:71]
    v_perm_b32 v154, v119, v90, s66
    s_and_b64 s[86:87], s[86:87], s[44:45]
    v_lshl_add_u32 v154, v154, 5, v208
    s_andn2_b64 s[44:45], s[44:45], s[86:87]
K2_CHK1:
    s_waitcnt vmcnt(2)
    v_bitop3_b32 v188, v95, s36, v214 bitop3:0x28
    v_cmp_ne_u32 vcc, 0, v188
    v_sub_u32_sdwa v188, v95, v168 dst_sel:DWORD dst_unused:UNUSED_PAD src0_sel:BYTE_3 src1_sel:DWORD
    v_mul_u32_u24_sdwa v107, s5, v92 dst_sel:DWORD dst_unused:UNUSED_PAD src0_sel:DWORD src1_sel:WORD_1
    v_mul_u32_u24_sdwa v108, s5, v93 dst_sel:DWORD dst_unused:UNUSED_PAD src0_sel:DWORD src1_sel:WORD_1
    v_mul_u32_u24_sdwa v109, s5, v94 dst_sel:DWORD dst_unused:UNUSED_PAD src0_sel:DWORD src1_sel:WORD_1
    s_cbranch_vccnz K2_RETRY1
    v_cmp_lt_i32 s[46:47], 0, v188
    v_cmp_lt_i32 s[48:49], 1, v188
    v_cmp_lt_i32 s[50:51], 2, v188
    v_subrev_u32 v107, s6, v107
    v_subrev_u32 v108, s6, v108
    v_subrev_u32 v109, s6, v109
    v_alignbit_b32 v107, v92, v107, 28
    v_alignbit_b32 v108, v93, v108, 28
    v_alignbit_b32 v109, v94, v109, 28
    v_and_b32 v107, 0xffc, v107
    v_and_b32 v108, 0xffc, v108
    v_and_b32 v109, 0xffc, v109
    s_mov_b64 exec, s[46:47]
    ds_add_rtn_u32 v223, v107, v171 offset:2304
    s_mov_b64 exec, s[48:49]
    ds_add_rtn_u32 v224, v108, v171 offset:2304
    s_mov_b64 exec, s[50:51]
    ds_add_rtn_u32 v225, v109, v171 offset:2304
    s_mov_b64 exec, -1
    s_waitcnt lgkmcnt(0)
    v_min_u16 v116, 2176, v220
    v_add_u32_sdwa v116, v116, v220 dst_sel:DWORD dst_unused:UNUSED_PAD src0_sel:WORD_0 src1_sel:WORD_1
    v_min_u16 v117, 2176, v221
    v_add_u32_sdwa v117, v117, v221 dst_sel:DWORD dst_unused:UNUSED_PAD src0_sel:WORD_0 src1_sel:WORD_1
    v_min_u16 v118, 2176, v222
    v_add_u32_sdwa v118, v118, v222 dst_sel:DWORD dst_unused:UNUSED_PAD src0_sel:WORD_0 src1_sel:WORD_1
    s_mov_b64 exec, s[68:69]
    ds_write2st64_b32 v116, v88, v152 offset0:38 offset1:122
    s_mov_b64 exec, s[70:71]
    ds_write2st64_b32 v117, v89, v153 offset0:38 offset1:122
    s_mov_b64 exec, s[86:87]
    ds_write2st64_b32 v118, v90, v154 offset0:38 offset1:122
    s_mov_b64 exec, -1
K2_CHK2:
    s_waitcnt vmcnt(1)
    v_bitop3_b32 v188, v99, s36, v214 bitop3:0x28
    v_cmp_ne_u32 vcc, 0, v188
    v_sub_u32_sdwa v188, v99, v168 dst_sel:DWORD dst_unused:UNUSED_PAD src0_sel:BYTE_3 src1_sel:DWORD
    v_mul_u32_u24_sdwa v110, s5, v96 dst_sel:DWORD dst_unused:UNUSED_PAD src0_sel:DWORD src1_sel:WORD_1
    v_mul_u32_u24_sdwa v111, s5, v97 dst_sel:DWORD dst_unused:UNUSED_PAD src0_sel:DWORD src1_sel:WORD_1
    v_mul_u32_u24_sdwa v112, s5, v98 dst_sel:DWORD dst_unused:UNUSED_PAD src0_sel:DWORD src1_sel:WORD_1
    s_cbranch_vccnz K2_RETRY2
    v_cmp_lt_i32 s[52:53], 0, v188
    v_cmp_lt_i32 s[54:55], 1, v188
    v_cmp_lt_i32 s[56:57], 2, v188
    v_subrev_u32 v110, s6, v110
    v_subrev_u32 v111, s6, v111
    v_subrev_u32 v112, s6, v112
    v_alignbit_b32 v110, v96, v110, 28
    v_alignbit_b32 v111, v97, v111, 28
    v_alignbit_b32 v112, v98, v112, 28
    v_and_b32 v110, 0xffc, v110
    v_and_b32 v111, 0xffc, v111
    v_and_b32 v112, 0xffc, v112
    s_mov_b64 exec, s[52:53]
    ds_add_rtn_u32 v226, v110, v171 offset:2304
    s_mov_b64 exec, s[54:55]
    ds_add_rtn_u32 v227, v111, v171 offset:2304
    s_mov_b64 exec, s[56:57]
    ds_add_rtn_u32 v228, v112, v171 offset:2304
    s_mov_b64 exec, -1
K2_CHK3:
    s_waitcnt vmcnt(0)
    v_bitop3_b32 v188, v103, s36, v214 bitop3:0x28
    v_cmp_ne_u32 vcc, 0, v188
    v_sub_u32_sdwa v188, v103, v168 dst_sel:DWORD dst_unused:UNUSED_PAD src0_sel:BYTE_3 src1_sel:DWORD
    v_mul_u32_u24_sdwa v113, s5, v100 dst_sel:DWORD dst_unused:UNUSED_PAD src0_sel:DWORD src1_sel:WORD_1
    v_mul_u32_u24_sdwa v114, s5, v101 dst_sel:DWORD dst_unused:UNUSED_PAD src0_sel:DWORD src1_sel:WORD_1
    v_mul_u32_u24_sdwa v115, s5, v102 dst_sel:DWORD dst_unused:UNUSED_PAD src0_sel:DWORD src1_sel:WORD_1
    s_cbranch_vccnz K2_RETRY3
    v_cmp_lt_i32 s[58:59], 0, v188
    v_cmp_lt_i32 s[60:61], 1, v188
    v_cmp_lt_i32 s[62:63], 2, v188
    v_subrev_u32 v113, s6, v113
    v_subrev_u32 v114, s6, v114
    v_subrev_u32 v115, s6, v115
    v_alignbit_b32 v113, v100, v113, 28
    v_alignbit_b32 v114, v101, v114, 28
    v_alignbit_b32 v115, v102, v115, 28
    v_and_b32 v113, 0xffc, v113
    v_and_b32 v114, 0xffc, v114
    v_and_b32 v115, 0xffc, v115
    s_mov_b64 exec, s[58:59]
    ds_add_rtn_u32 v229, v113, v171 offset:2304
    s_mov_b64 exec, s[60:61]
    ds_add_rtn_u32 v230, v114, v171 offset:2304
    s_mov_b64 exec, s[62:63]
    ds_add_rtn_u32 v231, v115, v171 offset:2304
    s_mov_b64 exec, -1
    v_max3_u32 v188, v91, v95, v99
    v_max_u32 v188, v188, v103
    v_cmp_le_u32 vcc, 553648128, v188
    s_cbranch_vccnz K2_XT1
K2_XT1R:
    s_lshr_b32 s4, s3, 1
    s_add_u32 s4, s4, 60
    s_waitcnt lgkmcnt(0)
    s_barrier
    ds_read_b128 v[128:131], v172 offset:5376
    ds_read_b128 v[236:239], v247
    ds_read_b32 v240, v251
    ds_read_u8 v250, v249
    ds_read_b128 v[116:119], v172 offset:2304
    ds_read_b128 v[120:123], v172 offset:3328
    ds_read_b128 v[124:127], v172 offset:4352
    ds_read_b64 v[194:195], v200 offset:2304
    s_bitcmp1_b32 s3, 0
    s_cbranch_scc0 K2_NOX1
    s_mul_i32 s10, s12, 196
    s_add_u32 s10, s10, s96
    s_lshl_b32 s10, s10, 7
    s_mul_i32 s11, s7, 4160
    s_add_u32 m0, s11, 69120
    s_add_u32 s86, s10, 0
    buffer_load_dwordx4 v234, s[16:19], s86 offen lds
    s_add_u32 m0, s11, 70160
    s_add_u32 s86, s10, 1024
    buffer_load_dwordx4 v234, s[16:19], s86 offen lds
    s_add_u32 m0, s11, 71200
    s_add_u32 s86, s10, 2048
    buffer_load_dwordx4 v234, s[16:19], s86 offen lds
    s_add_u32 m0, s11, 72240
    s_add_u32 s86, s10, 3072
    buffer_load_dwordx4 v234, s[16:19], s86 offen lds
K2_NOX1:
    s_waitcnt lgkmcnt(5)
    v_readlane_b32 s68, v128, s4
    v_and_b32 v95, 0x0f0f0f, v95
    v_and_b32 v99, 0x0f0f0f, v99
    s_and_b32 s68, s68, 0xffff
    s_bitcmp1_b32 s3, 0
    s_cselect_b32 s68, s68, 0
    s_cmp_ge_u32 s68, 128
    s_cselect_b32 s69, 1, 0
    s_cbranch_scc0 K2_NOQ
    s_add_u32 m0, s74, 0
    v_mad_u32_u16 v236, v236, s75, v241 op_sel:[1,0,0,0]
    buffer_load_dwordx4 v236, s[16:19], 0 offen lds
    s_add_u32 m0, s74, 1040
    v_mad_u32_u16 v237, v237, s75, v241 op_sel:[1,0,0,0]
    buffer_load_dwordx4 v237, s[16:19], 0 offen lds
    s_add_u32 m0, s74, 2080
    v_mad_u32_u16 v238, v238, s75, v241 op_sel:[1,0,0,0]
    buffer_load_dwordx4 v238, s[16:19], 0 offen lds
    s_add_u32 m0, s74, 3120
    v_mad_u32_u16 v239, v239, s75, v241 op_sel:[1,0,0,0]
    buffer_load_dwordx4 v239, s[16:19], 0 offen lds
    s_add_u32 m0, s74, 4160
    v_add_u32 v240, v240, v242
    buffer_load_dwordx4 v240, s[20:23], 0 offen lds
K2_NOQ:
    v_add_u32_sdwa v191, v128, v129 dst_sel:DWORD dst_unused:UNUSED_PAD src0_sel:WORD_0 src1_sel:WORD_0
    v_add_u32_sdwa v128, v130, v131 dst_sel:DWORD dst_unused:UNUSED_PAD src0_sel:WORD_0 src1_sel:WORD_0
    v_add_u32 v191, v191, v128
    s_waitcnt lgkmcnt(3)
    v_add_u32_sdwa v188, v116, v117 dst_sel:DWORD dst_unused:UNUSED_PAD src0_sel:WORD_0 src1_sel:WORD_0
    v_add_u32_sdwa v116, v118, v119 dst_sel:DWORD dst_unused:UNUSED_PAD src0_sel:WORD_0 src1_sel:WORD_0
    v_add_u32 v188, v188, v116
    s_waitcnt lgkmcnt(2)
    v_add_u32_sdwa v189, v120, v121 dst_sel:DWORD dst_unused:UNUSED_PAD src0_sel:WORD_0 src1_sel:WORD_0
    v_add_u32_sdwa v120, v122, v123 dst_sel:DWORD dst_unused:UNUSED_PAD src0_sel:WORD_0 src1_sel:WORD_0
    v_add_u32 v189, v189, v120
    s_waitcnt lgkmcnt(1)
    v_add_u32_sdwa v190, v124, v125 dst_sel:DWORD dst_unused:UNUSED_PAD src0_sel:WORD_0 src1_sel:WORD_0
    v_add_u32_sdwa v124, v126, v127 dst_sel:DWORD dst_unused:UNUSED_PAD src0_sel:WORD_0 src1_sel:WORD_0
    v_add_u32 v190, v190, v124
    v_lshl_or_b32 v192, v189, 16, v188
    v_lshl_or_b32 v193, v191, 16, v190
    s_waitcnt lgkmcnt(0)
    v_perm_b32 v198, v195, v194, s67
    v_add_u32_dpp v192, v192, v192 row_shr:1 row_mask:0xf bank_mask:0xf bound_ctrl:0
    v_add_u32_dpp v193, v193, v193 row_shr:1 row_mask:0xf bank_mask:0xf bound_ctrl:0
    v_and_b32 v103, 0x0f0f0f, v103
    v_add_u32_dpp v192, v192, v192 row_shr:2 row_mask:0xf bank_mask:0xf bound_ctrl:0
    v_add_u32_dpp v193, v193, v193 row_shr:2 row_mask:0xf bank_mask:0xf bound_ctrl:0
    v_perm_b32 v155, v95, v92, s64
    v_add_u32_dpp v192, v192, v192 row_shr:4 row_mask:0xf bank_mask:0xf bound_ctrl:0
    v_add_u32_dpp v193, v193, v193 row_shr:4 row_mask:0xf bank_mask:0xf bound_ctrl:0
    v_perm_b32 v156, v95, v93, s65
    v_add_u32_dpp v192, v192, v192 row_shr:8 row_mask:0xf bank_mask:0xf bound_ctrl:0
    v_add_u32_dpp v193, v193, v193 row_shr:8 row_mask:0xf bank_mask:0xf bound_ctrl:0
    v_perm_b32 v157, v95, v94, s66
    v_add_u32_dpp v192, v192, v192 row_bcast:15 row_mask:0xa bank_mask:0xf
    v_add_u32_dpp v193, v193, v193 row_bcast:15 row_mask:0xa bank_mask:0xf
    v_perm_b32 v158, v99, v96, s64
    v_add_u32_dpp v192, v192, v192 row_bcast:31 row_mask:0xc bank_mask:0xf
    v_add_u32_dpp v193, v193, v193 row_bcast:31 row_mask:0xc bank_mask:0xf
    v_perm_b32 v159, v99, v97, s65
    s_sub_u32 s4, s4, 1
    v_readlane_b32 s10, v192, 63
    v_readlane_b32 s11, v193, 63
    v_readlane_b32 s14, v193, 59
    v_readlane_b32 s86, v193, s4
    v_lshlrev_b32_sdwa v116, v169, v192 dst_sel:DWORD dst_unused:UNUSED_PAD src0_sel:DWORD src1_sel:WORD_0
    v_sub_u32 v188, v116, v188
    v_lshlrev_b32_sdwa v117, v169, v192 dst_sel:DWORD dst_unused:UNUSED_PAD src0_sel:DWORD src1_sel:WORD_1
    v_sub_u32 v189, v117, v189
    v_lshlrev_b32_sdwa v118, v169, v193 dst_sel:DWORD dst_unused:UNUSED_PAD src0_sel:DWORD src1_sel:WORD_0
    v_sub_u32 v190, v118, v190
    s_and_b32 s4, s10, 0xffff
    s_lshr_b32 s10, s10, 16
    s_add_u32 s5, s4, s10
    s_and_b32 s10, s11, 0xffff
    s_add_u32 s10, s5, s10
    s_lshr_b32 s11, s11, 16
    s_add_u32 s10, s10, s11
    s_lshr_b32 s14, s14, 16
    s_lshr_b32 s86, s86, 16
    s_sub_u32 s6, s86, s14
    s_lshl_b32 s6, s6, 1
    v_lshl_add_u32 v189, s4, 1, v189
    v_lshl_add_u32 v190, s5, 1, v190
    s_sub_i32 s37, 12864, s10
    s_ashr_i32 s37, s37, 7
    s_max_i32 s37, s37, 1
    s_min_i32 s37, s37, 4
    s_lshr_b32 s11, s10, 5
    s_add_u32 s11, s11, 16
    s_and_b32 s11, s11, -32
    s_cmp_ge_i32 s37, 1
    s_cselect_b32 s13, 42, 10
    s_sub_i32 s11, s11, s13
    s_lshl_b32 s11, s11, 3
    s_lshr_b32 s10, s10, 1
    s_lshr_b32 s13, s3, 1
    s_mul_i32 s13, s13, s10
    s_sub_i32 s13, s13, s6
    s_sub_i32 s10, s10, s68
    s_sub_i32 s10, s10, s68
    s_add_i32 s11, s11, s13
    s_add_i32 s10, s10, s13
    s_bitcmp1_b32 s3, 0
    s_cselect_b32 s15, s11, s13
    s_cselect_b32 s10, s10, s11
    s_mov_b32 s13, 0
    s_mov_b32 s14, 0
    v_cmp_gt_i32 vcc, s15, v188
    v_cmp_gt_i32 s[86:87], s10, v188
    s_bcnt1_i32_b64 s11, vcc
    s_add_u32 s13, s13, s11
    s_bcnt1_i32_b64 s11, s[86:87]
    s_add_u32 s14, s14, s11
    v_cmp_gt_i32 vcc, s15, v189
    v_cmp_gt_i32 s[86:87], s10, v189
    s_bcnt1_i32_b64 s11, vcc
    s_add_u32 s13, s13, s11
    s_bcnt1_i32_b64 s11, s[86:87]
    s_add_u32 s14, s14, s11
    v_cmp_gt_i32 vcc, s15, v190
    v_cmp_gt_i32 s[86:87], s10, v190
    s_bcnt1_i32_b64 s11, vcc
    s_add_u32 s13, s13, s11
    s_bcnt1_i32_b64 s11, s[86:87]
    s_add_u32 s14, s14, s11
    s_max_i32 s13, s13, s72
    s_min_i32 s13, s13, s73
    s_max_i32 s14, s14, s84
    s_min_i32 s14, s14, s85
    v_cmp_le_u32 vcc, s13, v199
    v_cmp_gt_u32 s[10:11], s14, v199
    s_nop 0
    s_and_b64 vcc, vcc, s[10:11]
    v_cndmask_b32 v198, 0, v198, vcc
    v_mov_b32 v196, v198
    v_perm_b32 v160, v99, v98, s66
    v_perm_b32 v161, v103, v100, s64
    v_add_u32_dpp v196, v196, v196 row_shr:1 row_mask:0xf bank_mask:0xf bound_ctrl:0
    v_perm_b32 v162, v103, v101, s65
    v_perm_b32 v163, v103, v102, s66
    v_add_u32_dpp v196, v196, v196 row_shr:2 row_mask:0xf bank_mask:0xf bound_ctrl:0
    v_lshl_add_u32 v155, v155, 5, v209
    v_lshl_add_u32 v156, v156, 5, v209
    v_add_u32_dpp v196, v196, v196 row_shr:4 row_mask:0xf bank_mask:0xf bound_ctrl:0
    v_lshl_add_u32 v157, v157, 5, v209
    v_lshl_add_u32 v158, v158, 5, v210
    v_add_u32_dpp v196, v196, v196 row_shr:8 row_mask:0xf bank_mask:0xf bound_ctrl:0
    v_lshl_add_u32 v159, v159, 5, v210
    v_lshl_add_u32 v160, v160, 5, v210
    v_add_u32_dpp v196, v196, v196 row_bcast:15 row_mask:0xa bank_mask:0xf
    v_lshl_add_u32 v161, v161, 5, v211
    v_lshl_add_u32 v162, v162, 5, v211
    v_lshl_add_u32 v163, v163, 5, v211
    s_sub_u32 s86, s76, 9728
    s_add_u32 s86, s86, s68
    v_readlane_b32 s10, v196, 31
    v_readlane_b32 s11, v196, 63
    v_sub_u32 v196, v196, v198
    v_mov_b32 v253, v202
    s_and_b32 s4, s10, 0xffff
    s_lshr_b32 s10, s10, 16
    s_add_u32 s5, s4, s10
    s_and_b32 s10, s11, 0xffff
    s_add_u32 s6, s5, s10
    s_lshr_b32 s11, s11, 16
    s_add_u32 s15, s6, s11
    s_lshl_b32 s10, s4, 16
    s_pack_ll_b32_b16 s11, s5, s6
    s_pack_ll_b32_b16 s86, s86, s86
    s_add_u32 s10, s10, s86
    s_add_u32 s11, s11, s86
    s_mov_b32 exec_lo, vcc_lo
    s_mov_b32 exec_hi, 0
    v_add_u32 v196, s10, v196
    s_mov_b32 exec_lo, 0
    s_mov_b32 exec_hi, vcc_hi
    v_add_u32 v196, s11, v196
    s_mov_b64 exec, vcc
    ds_write_b16 v200, v196 offset:2306
    ds_write_b16_d16_hi v200, v196 offset:2310
    ds_write_b32 v213, v212 offset:6400
    s_mov_b64 exec, -1
    v_mov_b32 v197, 2176
    s_add_u32 s15, s15, s68
    s_add_u32 s68, s68, 64
    s_cmp_le_u32 s15, 2176
    s_cbranch_scc1 K2_LFIT
    ds_write_b32 v197, v197
    s_mov_b32 s15, 0
K2_LFIT:
    s_add_u32 s15, s15, s76
    s_add_i32 s4, s4, s68
    s_lshr_b32 s4, s4, 7
    s_add_i32 s5, s5, s68
    s_lshr_b32 s5, s5, 7
    s_add_i32 s6, s6, s68
    s_lshr_b32 s6, s6, 7
    v_mov_b32 v190, 0xffff0000
    v_or_b32 v189, s39, v190
    v_mov_b32 v190, 0x7fffff00
    v_lshl_add_u32 v188, v254, 2, s15
    s_sub_u32 s73, s15, s76
    ds_write2st64_b32 v188, v189, v190 offset0:0 offset1:84
    ds_write2st64_b32 v188, v189, v190 offset0:1 offset1:85
    s_add_u32 s73, s73, 127
    s_lshr_b32 s73, s73, 7
    s_sub_i32 s38, s73, 1
    v_mov_b32 v188, s15
    ds_write_b32 v212, v188 offset:2112
    s_waitcnt lgkmcnt(0)
    s_barrier
    ds_read_b64 v[194:195], v197
    s_mov_b64 exec, s[40:41]
    ds_read_u16 v104, v104 offset:2306
    s_mov_b64 exec, s[42:43]
    ds_read_u16 v105, v105 offset:2306
    s_mov_b64 exec, s[44:45]
    ds_read_u16 v106, v106 offset:2306
    s_mov_b64 exec, s[46:47]
    ds_read_u16 v107, v107 offset:2306
    s_mov_b64 exec, s[48:49]
    ds_read_u16 v108, v108 offset:2306
    s_mov_b64 exec, s[50:51]
    ds_read_u16 v109, v109 offset:2306
    s_mov_b64 exec, s[52:53]
    ds_read_u16 v110, v110 offset:2306
    s_mov_b64 exec, s[54:55]
    ds_read_u16 v111, v111 offset:2306
    s_mov_b64 exec, s[56:57]
    ds_read_u16 v112, v112 offset:2306
    s_mov_b64 exec, s[58:59]
    ds_read_u16 v113, v113 offset:2306
    s_mov_b64 exec, s[60:61]
    ds_read_u16 v114, v114 offset:2306
    s_mov_b64 exec, s[62:63]
    ds_read_u16 v115, v115 offset:2306
    s_mov_b64 exec, -1
    s_waitcnt lgkmcnt(0)
    v_readfirstlane_b32 s83, v194
    v_readfirstlane_b32 s80, v195
    v_add_u32 v104, v104, v220
    v_add_u32 v105, v105, v221
    v_add_u32 v106, v106, v222
    v_add_u32 v107, v107, v223
    v_add_u32 v108, v108, v224
    v_add_u32 v109, v109, v225
    v_add_u32 v110, v110, v226
    v_add_u32 v111, v111, v227
    v_add_u32 v112, v112, v228
    v_add_u32 v113, v113, v229
    v_add_u32 v114, v114, v230
    v_add_u32 v115, v115, v231
    s_cmp_gt_u32 s83, 64
    s_cbranch_scc1 K2_OVF
    s_mov_b64 exec, s[40:41]
    ds_write2st64_b32 v104, v88, v152 offset0:38 offset1:122
    s_mov_b64 exec, s[42:43]
    ds_write2st64_b32 v105, v89, v153 offset0:38 offset1:122
    s_mov_b64 exec, s[44:45]
    ds_write2st64_b32 v106, v90, v154 offset0:38 offset1:122
    s_mov_b64 exec, s[46:47]
    ds_write2st64_b32 v107, v92, v155 offset0:38 offset1:122
    s_mov_b64 exec, s[48:49]
    ds_write2st64_b32 v108, v93, v156 offset0:38 offset1:122
    s_mov_b64 exec, s[50:51]
    ds_write2st64_b32 v109, v94, v157 offset0:38 offset1:122
    s_mov_b64 exec, s[52:53]
    ds_write2st64_b32 v110, v96, v158 offset0:38 offset1:122
    s_mov_b64 exec, s[54:55]
    ds_write2st64_b32 v111, v97, v159 offset0:38 offset1:122
    s_mov_b64 exec, s[56:57]
    ds_write2st64_b32 v112, v98, v160 offset0:38 offset1:122
    s_mov_b64 exec, s[58:59]
    ds_write2st64_b32 v113, v100, v161 offset0:38 offset1:122
    s_mov_b64 exec, s[60:61]
    ds_write2st64_b32 v114, v101, v162 offset0:38 offset1:122
    s_mov_b64 exec, s[62:63]
    ds_write2st64_b32 v115, v102, v163 offset0:38 offset1:122
    s_mov_b64 exec, -1
K2_PADS0:
    s_add_u32 s10, s37, 2
    s_cmp_gt_u32 s73, s10
    s_cselect_b32 s1, s3, 0
    s_mov_b32 s79, -1
    s_mov_b64 s[84:85], 0
    s_mov_b32 s81, 0
    s_mov_b32 s82, 0
    s_cmp_lg_u32 s80, 0
    s_cselect_b32 s78, 1, 0
    s_and_b32 s69, s69, s1
    s_cmp_gt_u32 s69, s97
    s_cbranch_scc0 K2_SIDE
    s_waitcnt vmcnt(5) lgkmcnt(0)
    ds_read_b128 v[152:155], v235 offset:0
    ds_read_b128 v[156:159], v235 offset:16
    ds_read_b128 v[160:163], v235 offset:32
    ds_read_b128 v[164:167], v235 offset:48
    v_add_u32 v172, 8192, v172
    ds_read_b128 v[88:91], v172 offset:52736
    ds_read_b128 v[92:95], v172 offset:53760
    ds_read_b128 v[96:99], v172 offset:54784
    ds_read_b128 v[100:103], v172 offset:55808
    ds_read_b128 v[104:107], v172 offset:56832
    ds_read_b128 v[108:111], v172 offset:57856
    ds_read_b128 v[112:115], v172 offset:58880
    ds_read_b128 v[116:119], v172 offset:59904
    s_mov_b32 s10, 0x358637bd
    s_mov_b32 s11, s10
    v_mfma_f32_32x32x16_bf16 v[136:151], v[180:183], v[180:183], 0
    v_mov_b64 v[120:121], s[10:11]
    v_mov_b64 v[122:123], s[10:11]
    v_mov_b64 v[124:125], s[10:11]
    v_mov_b64 v[126:127], s[10:11]
    v_mov_b64 v[128:129], s[10:11]
    v_mov_b64 v[130:131], s[10:11]
    v_mov_b64 v[132:133], s[10:11]
    v_mov_b64 v[134:135], s[10:11]
    s_waitcnt lgkmcnt(7)
    v_mfma_f32_32x32x16_bf16 v[188:203], v[152:155], v[88:91], 0
    s_waitcnt lgkmcnt(6)
    v_mfma_f32_32x32x16_bf16 v[188:203], v[156:159], v[92:95], v[188:203]
    s_waitcnt lgkmcnt(5)
    v_mfma_f32_32x32x16_bf16 v[188:203], v[160:163], v[96:99], v[188:203]
    s_waitcnt lgkmcnt(4)
    v_mfma_f32_32x32x16_bf16 v[188:203], v[164:167], v[100:103], v[188:203]
    s_waitcnt lgkmcnt(3)
    v_mfma_f32_32x32x16_bf16 v[204:219], v[152:155], v[104:107], 0
    s_waitcnt lgkmcnt(2)
    v_mfma_f32_32x32x16_bf16 v[204:219], v[156:159], v[108:111], v[204:219]
    s_waitcnt lgkmcnt(1)
    v_mfma_f32_32x32x16_bf16 v[204:219], v[160:163], v[112:115], v[204:219]
    s_waitcnt lgkmcnt(0)
    v_mfma_f32_32x32x16_bf16 v[204:219], v[164:167], v[116:119], v[204:219]
    s_barrier
    v_mfma_f32_32x32x16_bf16 v[104:119], v[180:183], v[180:183], 0
    s_mov_b32 s10, 0x358637bd
    s_mov_b32 s11, s10
    v_mov_b64 v[88:89], s[10:11]
    v_mov_b64 v[90:91], s[10:11]
    v_mov_b64 v[92:93], s[10:11]
    v_mov_b64 v[94:95], s[10:11]
    v_mov_b64 v[96:97], s[10:11]
    v_mov_b64 v[98:99], s[10:11]
    v_mov_b64 v[100:101], s[10:11]
    v_mov_b64 v[102:103], s[10:11]
    v_cvt_pk_bf16_f32 v72, v188, v189
    v_cvt_pk_bf16_f32 v73, v190, v191
    v_cvt_pk_bf16_f32 v74, v192, v193
    v_cvt_pk_bf16_f32 v75, v194, v195
    v_cvt_pk_bf16_f32 v76, v196, v197
    v_cvt_pk_bf16_f32 v77, v198, v199
    v_cvt_pk_bf16_f32 v78, v200, v201
    v_cvt_pk_bf16_f32 v79, v202, v203
    v_cvt_pk_bf16_f32 v80, v204, v205
    v_cvt_pk_bf16_f32 v81, v206, v207
    v_cvt_pk_bf16_f32 v82, v208, v209
    v_cvt_pk_bf16_f32 v83, v210, v211
    v_cvt_pk_bf16_f32 v84, v212, v213
    v_cvt_pk_bf16_f32 v85, v214, v215
    v_cvt_pk_bf16_f32 v86, v216, v217
    v_cvt_pk_bf16_f32 v87, v218, v219
    s_branch K2_HAD0
K2_SIDE:
    s_bitcmp1_b32 s3, 0
    s_cbranch_scc1 K2_NOX2
    s_mul_i32 s10, s12, 196
    s_add_u32 s10, s10, s96
    s_lshl_b32 s10, s10, 7
    s_mul_i32 s11, s7, 4160
    s_add_u32 m0, s11, 69120
    s_add_u32 s86, s10, 0
    buffer_load_dwordx4 v234, s[16:19], s86 offen lds
    s_add_u32 m0, s11, 70160
    s_add_u32 s86, s10, 1024
    buffer_load_dwordx4 v234, s[16:19], s86 offen lds
    s_add_u32 m0, s11, 71200
    s_add_u32 s86, s10, 2048
    buffer_load_dwordx4 v234, s[16:19], s86 offen lds
    s_add_u32 m0, s11, 72240
    s_add_u32 s86, s10, 3072
    buffer_load_dwordx4 v234, s[16:19], s86 offen lds
K2_NOX2:
    s_waitcnt vmcnt(5) lgkmcnt(0)
    s_barrier
    s_cmp_lg_u32 s69, 0
    s_cbranch_scc1 K2_SIDE1
    s_waitcnt vmcnt(4)
    s_bitcmp1_b32 s3, 0
    s_cbranch_scc0 K2_SIDE1
    s_waitcnt vmcnt(0)
    s_bitcmp1_b32 s1, 0
    s_cbranch_scc0 K2_SIDE1
    ds_read_b128 v[236:239], v247
    ds_read_b32 v240, v251
    ds_read_u8 v250, v249
    s_waitcnt lgkmcnt(1)
    s_add_u32 m0, s74, 0
    v_mad_u32_u16 v236, v236, s75, v241 op_sel:[1,0,0,0]
    buffer_load_dwordx4 v236, s[16:19], 0 offen lds
    s_add_u32 m0, s74, 1040
    v_mad_u32_u16 v237, v237, s75, v241 op_sel:[1,0,0,0]
    buffer_load_dwordx4 v237, s[16:19], 0 offen lds
    s_add_u32 m0, s74, 2080
    v_mad_u32_u16 v238, v238, s75, v241 op_sel:[1,0,0,0]
    buffer_load_dwordx4 v238, s[16:19], 0 offen lds
    s_add_u32 m0, s74, 3120
    v_mad_u32_u16 v239, v239, s75, v241 op_sel:[1,0,0,0]
    buffer_load_dwordx4 v239, s[16:19], 0 offen lds
    s_add_u32 m0, s74, 4160
    v_add_u32 v240, v240, v242
    buffer_load_dwordx4 v240, s[20:23], 0 offen lds
K2_SIDE1:
    s_cmp_lg_u32 s97, 0
    s_cbranch_scc1 K2_XT2
K2_XT2R:
    s_bitcmp1_b32 s1, 0
    s_cbranch_scc1 K2_SIDE2
    s_barrier
    s_cmp_eq_u32 s83, 0
    s_cbranch_scc1 K2_NEy
    s_lshl_b32 s10, s3, 2
    v_mov_b32 v178, s10
    ds_read_b32 v178, v178 offset:2112
    s_waitcnt lgkmcnt(0)
    v_readfirstlane_b32 s15, v178
    s_nop 3
    s_sub_u32 s73, s15, s76
    s_add_u32 s73, s73, 127
    s_lshr_b32 s73, s73, 7
    s_sub_i32 s38, s73, 1
K2_NEy:
    ds_read_b128 v[236:239], v247
    ds_read_b32 v240, v251
    ds_read_u8 v250, v249
    s_waitcnt lgkmcnt(1)
    s_add_u32 m0, s74, 0
    v_mad_u32_u16 v236, v236, s75, v241 op_sel:[1,0,0,0]
    buffer_load_dwordx4 v236, s[16:19], 0 offen lds
    s_add_u32 m0, s74, 1040
    v_mad_u32_u16 v237, v237, s75, v241 op_sel:[1,0,0,0]
    buffer_load_dwordx4 v237, s[16:19], 0 offen lds
    s_add_u32 m0, s74, 2080
    v_mad_u32_u16 v238, v238, s75, v241 op_sel:[1,0,0,0]
    buffer_load_dwordx4 v238, s[16:19], 0 offen lds
    s_add_u32 m0, s74, 3120
    v_mad_u32_u16 v239, v239, s75, v241 op_sel:[1,0,0,0]
    buffer_load_dwordx4 v239, s[16:19], 0 offen lds
    s_add_u32 m0, s74, 4160
    v_add_u32 v240, v240, v242
    buffer_load_dwordx4 v240, s[20:23], 0 offen lds
K2_SIDE2:
    s_waitcnt vmcnt(5) lgkmcnt(0)
    ds_read_b128 v[152:155], v235 offset:0
    ds_read_b128 v[156:159], v235 offset:16
    ds_read_b128 v[160:163], v235 offset:32
    ds_read_b128 v[164:167], v235 offset:48
    v_add_u32 v172, 8192, v172
    ds_read_b128 v[88:91], v172 offset:52736
    ds_read_b128 v[92:95], v172 offset:53760
    ds_read_b128 v[96:99], v172 offset:54784
    ds_read_b128 v[100:103], v172 offset:55808
    ds_read_b128 v[104:107], v172 offset:56832
    ds_read_b128 v[108:111], v172 offset:57856
    ds_read_b128 v[112:115], v172 offset:58880
    ds_read_b128 v[116:119], v172 offset:59904
    s_mov_b32 s10, 0x358637bd
    s_mov_b32 s11, s10
    v_mfma_f32_32x32x16_bf16 v[136:151], v[180:183], v[180:183], 0
    v_mov_b64 v[120:121], s[10:11]
    v_mov_b64 v[122:123], s[10:11]
    v_mov_b64 v[124:125], s[10:11]
    v_mov_b64 v[126:127], s[10:11]
    v_mov_b64 v[128:129], s[10:11]
    v_mov_b64 v[130:131], s[10:11]
    v_mov_b64 v[132:133], s[10:11]
    v_mov_b64 v[134:135], s[10:11]
    s_waitcnt lgkmcnt(7)
    v_mfma_f32_32x32x16_bf16 v[188:203], v[152:155], v[88:91], 0
    s_waitcnt lgkmcnt(6)
    v_mfma_f32_32x32x16_bf16 v[188:203], v[156:159], v[92:95], v[188:203]
    s_waitcnt lgkmcnt(5)
    v_mfma_f32_32x32x16_bf16 v[188:203], v[160:163], v[96:99], v[188:203]
    s_waitcnt lgkmcnt(4)
    v_mfma_f32_32x32x16_bf16 v[188:203], v[164:167], v[100:103], v[188:203]
    s_waitcnt lgkmcnt(3)
    v_mfma_f32_32x32x16_bf16 v[204:219], v[152:155], v[104:107], 0
    s_waitcnt lgkmcnt(2)
    v_mfma_f32_32x32x16_bf16 v[204:219], v[156:159], v[108:111], v[204:219]
    s_waitcnt lgkmcnt(1)
    v_mfma_f32_32x32x16_bf16 v[204:219], v[160:163], v[112:115], v[204:219]
    s_waitcnt lgkmcnt(0)
    v_mfma_f32_32x32x16_bf16 v[204:219], v[164:167], v[116:119], v[204:219]
    v_mfma_f32_32x32x16_bf16 v[104:119], v[180:183], v[180:183], 0
    s_mov_b32 s10, 0x358637bd
    s_mov_b32 s11, s10
    v_mov_b64 v[88:89], s[10:11]
    v_mov_b64 v[90:91], s[10:11]
    v_mov_b64 v[92:93], s[10:11]
    v_mov_b64 v[94:95], s[10:11]
    v_mov_b64 v[96:97], s[10:11]
    v_mov_b64 v[98:99], s[10:11]
    v_mov_b64 v[100:101], s[10:11]
    v_mov_b64 v[102:103], s[10:11]
    v_cvt_pk_bf16_f32 v72, v188, v189
    v_cvt_pk_bf16_f32 v73, v190, v191
    v_cvt_pk_bf16_f32 v74, v192, v193
    v_cvt_pk_bf16_f32 v75, v194, v195
    v_cvt_pk_bf16_f32 v76, v196, v197
    v_cvt_pk_bf16_f32 v77, v198, v199
    v_cvt_pk_bf16_f32 v78, v200, v201
    v_cvt_pk_bf16_f32 v79, v202, v203
    v_cvt_pk_bf16_f32 v80, v204, v205
    v_cvt_pk_bf16_f32 v81, v206, v207
    v_cvt_pk_bf16_f32 v82, v208, v209
    v_cvt_pk_bf16_f32 v83, v210, v211
    v_cvt_pk_bf16_f32 v84, v212, v213
    v_cvt_pk_bf16_f32 v85, v214, v215
    v_cvt_pk_bf16_f32 v86, v216, v217
    v_cvt_pk_bf16_f32 v87, v218, v219
    s_branch K2_HAD0
K2_GO:
    ds_read_b128 v[236:239], v247
    ds_read_b32 v240, v251
    ds_read_u8 v250, v249
    s_waitcnt lgkmcnt(1)
    s_add_u32 m0, s74, 0
    v_mad_u32_u16 v236, v236, s75, v241 op_sel:[1,0,0,0]
    buffer_load_dwordx4 v236, s[16:19], 0 offen lds
    s_add_u32 m0, s74, 1040
    v_mad_u32_u16 v237, v237, s75, v241 op_sel:[1,0,0,0]
    buffer_load_dwordx4 v237, s[16:19], 0 offen lds
    s_add_u32 m0, s74, 2080
    v_mad_u32_u16 v238, v238, s75, v241 op_sel:[1,0,0,0]
    buffer_load_dwordx4 v238, s[16:19], 0 offen lds
    s_add_u32 m0, s74, 3120
    v_mad_u32_u16 v239, v239, s75, v241 op_sel:[1,0,0,0]
    buffer_load_dwordx4 v239, s[16:19], 0 offen lds
    s_add_u32 m0, s74, 4160
    v_add_u32 v240, v240, v242
    buffer_load_dwordx4 v240, s[20:23], 0 offen lds
K2_HAD0:
    s_waitcnt lgkmcnt(0)
    v_lshl_add_u32 v250, v250, 6, v245
    ds_read_b128 v[236:239], v247 offset:128
    ds_read_b32 v240, v251 offset:128
    ds_read_b128 v[172:175], v250 offset:7424
    ds_read_b32 v176, v250 offset:7440
    v_mfma_f32_32x32x16_bf16 v[204:219], v[180:183], v[180:183], 0
    s_waitcnt vmcnt(0)
    ds_read_b128 v[168:171], v244
    ds_read_b128 v[152:155], v243 offset:0
    ds_read_b128 v[156:159], v243 offset:16
    ds_read_b128 v[160:163], v243 offset:32
    ds_read_b128 v[164:167], v243 offset:48
    s_waitcnt lgkmcnt(0)
    s_add_u32 m0, s74, 0
    v_mad_u32_u16 v236, v236, s75, v241 op_sel:[1,0,0,0]
    buffer_load_dwordx4 v236, s[16:19], 0 offen lds
    s_add_u32 m0, s74, 1040
    v_mad_u32_u16 v237, v237, s75, v241 op_sel:[1,0,0,0]
    buffer_load_dwordx4 v237, s[16:19], 0 offen lds
    s_add_u32 m0, s74, 2080
    v_mad_u32_u16 v238, v238, s75, v241 op_sel:[1,0,0,0]
    buffer_load_dwordx4 v238, s[16:19], 0 offen lds
    s_add_u32 m0, s74, 3120
    v_mad_u32_u16 v239, v239, s75, v241 op_sel:[1,0,0,0]
    buffer_load_dwordx4 v239, s[16:19], 0 offen lds
    s_add_u32 m0, s74, 4160
    v_add_u32 v240, v240, v242
    buffer_load_dwordx4 v240, s[20:23], 0 offen lds
    s_cmp_lt_i32 s37, 0
    s_cbranch_scc1 K2_B1
    s_barrier
    s_bitcmp1_b32 s1, 0
    s_cselect_b32 s37, s37, -1
    s_cbranch_scc0 K2_B1
    s_cmp_eq_u32 s83, 0
    s_cbranch_scc1 K2_NEo
    s_lshl_b32 s10, s3, 2
    v_mov_b32 v178, s10
    ds_read_b32 v178, v178 offset:2112
    s_waitcnt lgkmcnt(0)
    v_readfirstlane_b32 s15, v178
    s_nop 3
    s_sub_u32 s73, s15, s76
    s_add_u32 s73, s73, 127
    s_lshr_b32 s73, s73, 7
    s_sub_i32 s38, s73, 1
K2_NEo:
K2_B1:
    s_cmp_lg_u32 s73, 0
    s_cbranch_scc1 K2_NZ
    s_waitcnt vmcnt(0)
    s_branch K2_DONE
K2_NZ:
    v_mfma_f32_32x32x16_bf16 v[188:203], v[168:171], v[64:67], 0
    v_mfma_f32_32x32x16_bf16 v[188:203], v[152:155], v[0:3], v[188:203]
    v_mfma_f32_32x32x16_bf16 v[188:203], v[156:159], v[4:7], v[188:203]
    v_mfma_f32_32x32x16_bf16 v[188:203], v[160:163], v[8:11], v[188:203]
    v_mfma_f32_32x32x16_bf16 v[188:203], v[164:167], v[12:15], v[188:203]
    s_nop 9
    v_smfmac_f32_32x32x32_bf16 v[188:203], v[172:175], v[72:79], v176
    s_mov_b32 s72, 0
    s_sub_u32 s10, s73, 1
    s_bitcmp1_b32 s3, 0
    s_cselect_b32 s6, s6, s10
    s_setprio 3
    s_mov_b32 s87, s73
    s_cmp_gt_i32 s4, s72
    s_cselect_b32 s10, s4, s87
    s_min_u32 s87, s87, s10
    s_cmp_gt_i32 s5, s72
    s_cselect_b32 s10, s5, s87
    s_min_u32 s87, s87, s10
    s_cmp_gt_i32 s6, s72
    s_cselect_b32 s10, s6, s87
    s_min_u32 s87, s87, s10
    s_cmp_gt_i32 s37, s72
    s_cselect_b32 s10, s37, s87
    s_min_u32 s87, s87, s10
    s_cmp_gt_i32 s38, s72
    s_cselect_b32 s10, s38, s87
    s_min_u32 s87, s87, s10
.p2align 6
K2_LOOP:
    v_smfmac_f32_32x32x32_bf16 v[136:151], v[180:183], v[204:211], v177
    ds_read_u8 v236, v248 offset:0
    ds_read_u8 v237, v248 offset:16
    ds_read_u8 v238, v248 offset:64
    ds_read_u8 v239, v248 offset:80
    ds_read_u8 v250, v249 offset:128
    v_exp_f32 v188, v188
    v_exp_f32 v189, v189
    v_exp_f32 v190, v190
    v_add_f32 v188, 1.0, v188
    v_smfmac_f32_32x32x32_bf16 v[136:151], v[184:187], v[212:219], v177
    v_exp_f32 v191, v191
    v_add_f32 v189, 1.0, v189
    v_exp_f32 v192, v192
    v_add_f32 v190, 1.0, v190
    v_rcp_f32 v188, v188
    v_mfma_f32_32x32x16_bf16 v[220:235], v[168:171], v[68:71], 0
    v_exp_f32 v193, v193
    v_add_f32 v191, 1.0, v191
    v_rcp_f32 v189, v189
    v_exp_f32 v194, v194
    v_mfma_f32_32x32x16_bf16 v[204:219], v[152:155], v[32:35], 0
    v_add_f32 v192, 1.0, v192
    v_rcp_f32 v190, v190
    v_exp_f32 v195, v195
    v_mfma_f32_32x32x16_bf16 v[204:219], v[156:159], v[36:39], v[204:219]
    s_waitcnt lgkmcnt(0)
    v_lshl_add_u32 v236, v236, 6, v246
    v_lshl_add_u32 v237, v237, 6, v246
    v_lshl_add_u32 v238, v238, 6, v246
    v_lshl_add_u32 v239, v239, 6, v246
    v_lshl_add_u32 v250, v250, 6, v245
    v_add_f32 v193, 1.0, v193
    v_rcp_f32 v191, v191
    v_exp_f32 v196, v196
    v_add_f32 v194, 1.0, v194
    v_rcp_f32 v192, v192
    v_smfmac_f32_32x32x32_bf16 v[220:235], v[172:175], v[80:87], v176
    ds_read_b64_tr_b16 v[180:181], v236
    ds_read_b64_tr_b16 v[182:183], v237
    ds_read_b64_tr_b16 v[184:185], v238
    ds_read_b64_tr_b16 v[186:187], v239
    ds_read_b128 v[172:175], v250 offset:7424
    ds_read_b32 v176, v250 offset:7440
    v_exp_f32 v197, v197
    v_add_f32 v195, 1.0, v195
    v_rcp_f32 v193, v193
    v_exp_f32 v198, v198
    v_mfma_f32_32x32x16_bf16 v[204:219], v[160:163], v[40:43], v[204:219]
    v_add_f32 v196, 1.0, v196
    v_rcp_f32 v194, v194
    v_exp_f32 v199, v199
    v_add_f32 v197, 1.0, v197
    v_mfma_f32_32x32x16_bf16 v[204:219], v[164:167], v[44:47], v[204:219]
    v_rcp_f32 v195, v195
    v_exp_f32 v200, v200
    v_add_f32 v198, 1.0, v198
    v_rcp_f32 v196, v196
    v_mfma_f32_32x32x16_bf16 v[220:235], v[152:155], v[16:19], v[220:235]
    ds_read_b128 v[236:239], v247 offset:256
    ds_read_b32 v240, v251 offset:256
    s_add_u32 s72, s72, 1
    v_exp_f32 v201, v201
    v_add_f32 v199, 1.0, v199
    v_rcp_f32 v197, v197
    v_exp_f32 v202, v202
    v_mfma_f32_32x32x16_bf16 v[220:235], v[156:159], v[20:23], v[220:235]
    v_add_f32 v200, 1.0, v200
    v_rcp_f32 v198, v198
    v_exp_f32 v203, v203
    v_add_f32 v201, 1.0, v201
    v_mfma_f32_32x32x16_bf16 v[220:235], v[160:163], v[24:27], v[220:235]
    v_rcp_f32 v199, v199
    v_add_f32 v202, 1.0, v202
    v_rcp_f32 v200, v200
    v_add_f32 v203, 1.0, v203
    v_rcp_f32 v201, v201
    v_mfma_f32_32x32x16_bf16 v[220:235], v[164:167], v[28:31], v[220:235]
    v_rcp_f32 v202, v202
    v_rcp_f32 v203, v203
    v_mul_f32 v204, v188, v204
    v_mul_f32 v205, v189, v205
    s_waitcnt lgkmcnt(0)
    v_smfmac_f32_32x32x32_bf16 v[88:103], v[180:183], v[188:195], v177
    v_mul_f32 v206, v190, v206
    v_mul_f32 v207, v191, v207
    v_mul_f32 v208, v192, v208
    v_mul_f32 v209, v193, v209
    v_mul_f32 v210, v194, v210
    v_mul_f32 v211, v195, v211
    v_mul_f32 v212, v196, v212
    v_smfmac_f32_32x32x32_bf16 v[88:103], v[184:187], v[196:203], v177
    v_mul_f32 v213, v197, v213
    v_mul_f32 v214, v198, v214
    v_mul_f32 v215, v199, v215
    v_mul_f32 v216, v200, v216
    v_mul_f32 v217, v201, v217
    v_mul_f32 v218, v202, v218
    v_mul_f32 v219, v203, v219
    v_smfmac_f32_32x32x32_bf16 v[104:119], v[180:183], v[204:211], v177
    s_waitcnt vmcnt(0)
    ds_read_b128 v[168:171], v244
    v_exp_f32 v220, v220
    v_exp_f32 v221, v221
    v_exp_f32 v222, v222
    v_add_f32 v220, 1.0, v220
    v_smfmac_f32_32x32x32_bf16 v[104:119], v[184:187], v[212:219], v177
    v_exp_f32 v223, v223
    v_add_f32 v221, 1.0, v221
    v_exp_f32 v224, v224
    v_add_f32 v222, 1.0, v222
    v_rcp_f32 v220, v220
    s_waitcnt lgkmcnt(0)
    v_mfma_f32_32x32x16_bf16 v[188:203], v[168:171], v[64:67], 0
    v_exp_f32 v225, v225
    v_add_f32 v223, 1.0, v223
    v_rcp_f32 v221, v221
    v_exp_f32 v226, v226
    v_mfma_f32_32x32x16_bf16 v[204:219], v[152:155], v[48:51], 0
    ds_read_b128 v[152:155], v243 offset:0
    v_add_f32 v224, 1.0, v224
    v_rcp_f32 v222, v222
    v_exp_f32 v227, v227
    v_mfma_f32_32x32x16_bf16 v[204:219], v[156:159], v[52:55], v[204:219]
    ds_read_b128 v[156:159], v243 offset:16
    v_add_f32 v225, 1.0, v225
    v_rcp_f32 v223, v223
    v_exp_f32 v228, v228
    v_add_f32 v226, 1.0, v226
    v_rcp_f32 v224, v224
    v_smfmac_f32_32x32x32_bf16 v[188:203], v[172:175], v[72:79], v176
    v_exp_f32 v229, v229
    v_add_f32 v227, 1.0, v227
    v_rcp_f32 v225, v225
    v_exp_f32 v230, v230
    v_mfma_f32_32x32x16_bf16 v[204:219], v[160:163], v[56:59], v[204:219]
    ds_read_b128 v[160:163], v243 offset:32
    v_add_f32 v228, 1.0, v228
    v_rcp_f32 v226, v226
    v_exp_f32 v231, v231
    v_add_f32 v229, 1.0, v229
    v_mfma_f32_32x32x16_bf16 v[204:219], v[164:167], v[60:63], v[204:219]
    ds_read_b128 v[164:167], v243 offset:48
    v_rcp_f32 v227, v227
    v_exp_f32 v232, v232
    v_add_f32 v230, 1.0, v230
    v_rcp_f32 v228, v228
    s_waitcnt lgkmcnt(3)
    v_mfma_f32_32x32x16_bf16 v[188:203], v[152:155], v[0:3], v[188:203]
    v_exp_f32 v233, v233
    v_add_f32 v231, 1.0, v231
    v_rcp_f32 v229, v229
    v_exp_f32 v234, v234
    s_waitcnt lgkmcnt(2)
    v_mfma_f32_32x32x16_bf16 v[188:203], v[156:159], v[4:7], v[188:203]
    v_add_f32 v232, 1.0, v232
    v_rcp_f32 v230, v230
    v_exp_f32 v235, v235
    v_add_f32 v233, 1.0, v233
    s_waitcnt lgkmcnt(1)
    v_mfma_f32_32x32x16_bf16 v[188:203], v[160:163], v[8:11], v[188:203]
    v_rcp_f32 v231, v231
    v_add_f32 v234, 1.0, v234
    v_rcp_f32 v232, v232
    v_add_f32 v235, 1.0, v235
    v_rcp_f32 v233, v233
    s_waitcnt lgkmcnt(0)
    v_mfma_f32_32x32x16_bf16 v[188:203], v[164:167], v[12:15], v[188:203]
    s_cmp_lt_i32 s72, s38
    s_cbranch_scc0 K2_ND_0
    s_add_u32 m0, s74, 0
    v_mad_u32_u16 v236, v236, s75, v241 op_sel:[1,0,0,0]
    buffer_load_dwordx4 v236, s[16:19], 0 offen lds
    s_add_u32 m0, s74, 1040
    v_mad_u32_u16 v237, v237, s75, v241 op_sel:[1,0,0,0]
    buffer_load_dwordx4 v237, s[16:19], 0 offen lds
    s_add_u32 m0, s74, 2080
    v_mad_u32_u16 v238, v238, s75, v241 op_sel:[1,0,0,0]
    buffer_load_dwordx4 v238, s[16:19], 0 offen lds
    s_add_u32 m0, s74, 3120
    v_mad_u32_u16 v239, v239, s75, v241 op_sel:[1,0,0,0]
    buffer_load_dwordx4 v239, s[16:19], 0 offen lds
    s_add_u32 m0, s74, 4160
    v_add_u32 v240, v240, v242
    buffer_load_dwordx4 v240, s[20:23], 0 offen lds
K2_ND_0:
    v_rcp_f32 v234, v234
    v_rcp_f32 v235, v235
    v_mul_f32 v204, v220, v204
    v_mul_f32 v205, v221, v205
    v_smfmac_f32_32x32x32_bf16 v[120:135], v[180:183], v[220:227], v177
    v_mul_f32 v206, v222, v206
    v_mul_f32 v207, v223, v207
    v_mul_f32 v208, v224, v208
    v_mul_f32 v209, v225, v209
    v_mul_f32 v210, v226, v210
    v_mul_f32 v211, v227, v211
    v_mul_f32 v212, v228, v212
    v_smfmac_f32_32x32x32_bf16 v[120:135], v[184:187], v[228:235], v177
    v_mul_f32 v213, v229, v213
    v_mul_f32 v214, v230, v214
    v_mul_f32 v215, v231, v215
    v_mul_f32 v216, v232, v216
    v_mul_f32 v217, v233, v217
    v_mul_f32 v218, v234, v218
    v_mul_f32 v219, v235, v219
    s_cmp_ge_u32 s72, s87
    s_cbranch_scc1 K2_EV0
K2_EVR0:
    v_smfmac_f32_32x32x32_bf16 v[136:151], v[180:183], v[204:211], v177
    ds_read_u8 v236, v248 offset:128
    ds_read_u8 v237, v248 offset:144
    ds_read_u8 v238, v248 offset:192
    ds_read_u8 v239, v248 offset:208
    ds_read_u8 v250, v249 offset:256
    v_exp_f32 v188, v188
    v_exp_f32 v189, v189
    v_exp_f32 v190, v190
    v_add_f32 v188, 1.0, v188
    v_smfmac_f32_32x32x32_bf16 v[136:151], v[184:187], v[212:219], v177
    v_exp_f32 v191, v191
    v_add_f32 v189, 1.0, v189
    v_exp_f32 v192, v192
    v_add_f32 v190, 1.0, v190
    v_rcp_f32 v188, v188
    v_mfma_f32_32x32x16_bf16 v[220:235], v[168:171], v[68:71], 0
    v_exp_f32 v193, v193
    v_add_f32 v191, 1.0, v191
    v_rcp_f32 v189, v189
    v_exp_f32 v194, v194
    v_mfma_f32_32x32x16_bf16 v[204:219], v[152:155], v[32:35], 0
    v_add_f32 v192, 1.0, v192
    v_rcp_f32 v190, v190
    v_exp_f32 v195, v195
    v_mfma_f32_32x32x16_bf16 v[204:219], v[156:159], v[36:39], v[204:219]
    s_waitcnt lgkmcnt(0)
    v_lshl_add_u32 v236, v236, 6, v246
    v_lshl_add_u32 v237, v237, 6, v246
    v_lshl_add_u32 v238, v238, 6, v246
    v_lshl_add_u32 v239, v239, 6, v246
    v_lshl_add_u32 v250, v250, 6, v245
    v_add_f32 v193, 1.0, v193
    v_rcp_f32 v191, v191
    v_exp_f32 v196, v196
    v_add_f32 v194, 1.0, v194
    v_rcp_f32 v192, v192
    v_smfmac_f32_32x32x32_bf16 v[220:235], v[172:175], v[80:87], v176
    ds_read_b64_tr_b16 v[180:181], v236
    ds_read_b64_tr_b16 v[182:183], v237
    ds_read_b64_tr_b16 v[184:185], v238
    ds_read_b64_tr_b16 v[186:187], v239
    ds_read_b128 v[172:175], v250 offset:7424
    ds_read_b32 v176, v250 offset:7440
    v_exp_f32 v197, v197
    v_add_f32 v195, 1.0, v195
    v_rcp_f32 v193, v193
    v_exp_f32 v198, v198
    v_mfma_f32_32x32x16_bf16 v[204:219], v[160:163], v[40:43], v[204:219]
    v_add_f32 v196, 1.0, v196
    v_rcp_f32 v194, v194
    v_exp_f32 v199, v199
    v_add_f32 v197, 1.0, v197
    v_mfma_f32_32x32x16_bf16 v[204:219], v[164:167], v[44:47], v[204:219]
    v_rcp_f32 v195, v195
    v_exp_f32 v200, v200
    v_add_f32 v198, 1.0, v198
    v_rcp_f32 v196, v196
    v_mfma_f32_32x32x16_bf16 v[220:235], v[152:155], v[16:19], v[220:235]
    ds_read_b128 v[236:239], v247 offset:384
    ds_read_b32 v240, v251 offset:384
    s_add_u32 s72, s72, 1
    v_exp_f32 v201, v201
    v_add_f32 v199, 1.0, v199
    v_rcp_f32 v197, v197
    v_exp_f32 v202, v202
    v_mfma_f32_32x32x16_bf16 v[220:235], v[156:159], v[20:23], v[220:235]
    v_add_f32 v200, 1.0, v200
    v_rcp_f32 v198, v198
    v_exp_f32 v203, v203
    v_add_f32 v201, 1.0, v201
    v_mfma_f32_32x32x16_bf16 v[220:235], v[160:163], v[24:27], v[220:235]
    v_rcp_f32 v199, v199
    v_add_f32 v202, 1.0, v202
    v_rcp_f32 v200, v200
    v_add_f32 v203, 1.0, v203
    v_rcp_f32 v201, v201
    v_mfma_f32_32x32x16_bf16 v[220:235], v[164:167], v[28:31], v[220:235]
    v_rcp_f32 v202, v202
    v_rcp_f32 v203, v203
    v_mul_f32 v204, v188, v204
    v_mul_f32 v205, v189, v205
    s_waitcnt lgkmcnt(0)
    v_smfmac_f32_32x32x32_bf16 v[88:103], v[180:183], v[188:195], v177
    v_mul_f32 v206, v190, v206
    v_mul_f32 v207, v191, v207
    v_mul_f32 v208, v192, v208
    v_mul_f32 v209, v193, v209
    v_mul_f32 v210, v194, v210
    v_mul_f32 v211, v195, v211
    v_mul_f32 v212, v196, v212
    v_smfmac_f32_32x32x32_bf16 v[88:103], v[184:187], v[196:203], v177
    v_mul_f32 v213, v197, v213
    v_mul_f32 v214, v198, v214
    v_mul_f32 v215, v199, v215
    v_mul_f32 v216, v200, v216
    v_mul_f32 v217, v201, v217
    v_mul_f32 v218, v202, v218
    v_mul_f32 v219, v203, v219
    v_smfmac_f32_32x32x32_bf16 v[104:119], v[180:183], v[204:211], v177
    s_waitcnt vmcnt(0)
    ds_read_b128 v[168:171], v244
    v_exp_f32 v220, v220
    v_exp_f32 v221, v221
    v_exp_f32 v222, v222
    v_add_f32 v220, 1.0, v220
    v_smfmac_f32_32x32x32_bf16 v[104:119], v[184:187], v[212:219], v177
    v_exp_f32 v223, v223
    v_add_f32 v221, 1.0, v221
    v_exp_f32 v224, v224
    v_add_f32 v222, 1.0, v222
    v_rcp_f32 v220, v220
    s_waitcnt lgkmcnt(0)
    v_mfma_f32_32x32x16_bf16 v[188:203], v[168:171], v[64:67], 0
    v_exp_f32 v225, v225
    v_add_f32 v223, 1.0, v223
    v_rcp_f32 v221, v221
    v_exp_f32 v226, v226
    v_mfma_f32_32x32x16_bf16 v[204:219], v[152:155], v[48:51], 0
    ds_read_b128 v[152:155], v243 offset:0
    v_add_f32 v224, 1.0, v224
    v_rcp_f32 v222, v222
    v_exp_f32 v227, v227
    v_mfma_f32_32x32x16_bf16 v[204:219], v[156:159], v[52:55], v[204:219]
    ds_read_b128 v[156:159], v243 offset:16
    v_add_f32 v225, 1.0, v225
    v_rcp_f32 v223, v223
    v_exp_f32 v228, v228
    v_add_f32 v226, 1.0, v226
    v_rcp_f32 v224, v224
    v_smfmac_f32_32x32x32_bf16 v[188:203], v[172:175], v[72:79], v176
    v_exp_f32 v229, v229
    v_add_f32 v227, 1.0, v227
    v_rcp_f32 v225, v225
    v_exp_f32 v230, v230
    v_mfma_f32_32x32x16_bf16 v[204:219], v[160:163], v[56:59], v[204:219]
    ds_read_b128 v[160:163], v243 offset:32
    v_add_f32 v228, 1.0, v228
    v_rcp_f32 v226, v226
    v_exp_f32 v231, v231
    v_add_f32 v229, 1.0, v229
    v_mfma_f32_32x32x16_bf16 v[204:219], v[164:167], v[60:63], v[204:219]
    ds_read_b128 v[164:167], v243 offset:48
    v_rcp_f32 v227, v227
    v_exp_f32 v232, v232
    v_add_f32 v230, 1.0, v230
    v_rcp_f32 v228, v228
    s_waitcnt lgkmcnt(3)
    v_mfma_f32_32x32x16_bf16 v[188:203], v[152:155], v[0:3], v[188:203]
    v_exp_f32 v233, v233
    v_add_f32 v231, 1.0, v231
    v_rcp_f32 v229, v229
    v_exp_f32 v234, v234
    s_waitcnt lgkmcnt(2)
    v_mfma_f32_32x32x16_bf16 v[188:203], v[156:159], v[4:7], v[188:203]
    v_add_f32 v232, 1.0, v232
    v_rcp_f32 v230, v230
    v_exp_f32 v235, v235
    v_add_f32 v233, 1.0, v233
    s_waitcnt lgkmcnt(1)
    v_mfma_f32_32x32x16_bf16 v[188:203], v[160:163], v[8:11], v[188:203]
    v_rcp_f32 v231, v231
    v_add_f32 v234, 1.0, v234
    v_rcp_f32 v232, v232
    v_add_f32 v235, 1.0, v235
    v_rcp_f32 v233, v233
    s_waitcnt lgkmcnt(0)
    v_mfma_f32_32x32x16_bf16 v[188:203], v[164:167], v[12:15], v[188:203]
    s_cmp_lt_i32 s72, s38
    s_cbranch_scc0 K2_ND_1
    s_add_u32 m0, s74, 0
    v_mad_u32_u16 v236, v236, s75, v241 op_sel:[1,0,0,0]
    buffer_load_dwordx4 v236, s[16:19], 0 offen lds
    s_add_u32 m0, s74, 1040
    v_mad_u32_u16 v237, v237, s75, v241 op_sel:[1,0,0,0]
    buffer_load_dwordx4 v237, s[16:19], 0 offen lds
    s_add_u32 m0, s74, 2080
    v_mad_u32_u16 v238, v238, s75, v241 op_sel:[1,0,0,0]
    buffer_load_dwordx4 v238, s[16:19], 0 offen lds
    s_add_u32 m0, s74, 3120
    v_mad_u32_u16 v239, v239, s75, v241 op_sel:[1,0,0,0]
    buffer_load_dwordx4 v239, s[16:19], 0 offen lds
    s_add_u32 m0, s74, 4160
    v_add_u32 v240, v240, v242
    buffer_load_dwordx4 v240, s[20:23], 0 offen lds
K2_ND_1:
    v_rcp_f32 v234, v234
    v_rcp_f32 v235, v235
    v_mul_f32 v204, v220, v204
    v_mul_f32 v205, v221, v205
    v_smfmac_f32_32x32x32_bf16 v[120:135], v[180:183], v[220:227], v177
    v_mul_f32 v206, v222, v206
    v_mul_f32 v207, v223, v207
    v_mul_f32 v208, v224, v208
    v_mul_f32 v209, v225, v209
    v_mul_f32 v210, v226, v210
    v_mul_f32 v211, v227, v211
    v_mul_f32 v212, v228, v212
    v_smfmac_f32_32x32x32_bf16 v[120:135], v[184:187], v[228:235], v177
    v_mul_f32 v213, v229, v213
    v_mul_f32 v214, v230, v214
    v_mul_f32 v215, v231, v215
    v_mul_f32 v216, v232, v216
    v_mul_f32 v217, v233, v217
    v_mul_f32 v218, v234, v218
    v_mul_f32 v219, v235, v219
    v_add_u32 v247, 0x100, v247
    v_add_u32 v249, 0x100, v249
    v_add_u32 v251, 0x100, v251
    v_add_u32 v248, 0x100, v248
    s_cmp_lt_u32 s72, s87
    s_cbranch_scc1 K2_LOOP
    s_cmp_ge_u32 s72, s73
    s_cbranch_scc1 K2_TAIL
    s_cmp_lg_u32 s72, s37
    s_cbranch_scc1 K2_SB1
    s_barrier
    s_mov_b32 s37, -1
K2_SB1:
    s_cmp_lg_u32 s72, s4
    s_cbranch_scc1 K2_PR1_0
    s_setprio 2
K2_PR1_0:
    s_cmp_lg_u32 s72, s5
    s_cbranch_scc1 K2_PR1_1
    s_setprio 1
K2_PR1_1:
    s_cmp_lg_u32 s72, s6
    s_cbranch_scc1 K2_PR1_2
    s_setprio 0
K2_PR1_2:
    s_cmp_eq_u32 s72, s38
    s_cbranch_scc1 K2_LT1
    s_mov_b32 s87, s73
    s_cmp_gt_i32 s4, s72
    s_cselect_b32 s10, s4, s87
    s_min_u32 s87, s87, s10
    s_cmp_gt_i32 s5, s72
    s_cselect_b32 s10, s5, s87
    s_min_u32 s87, s87, s10
    s_cmp_gt_i32 s6, s72
    s_cselect_b32 s10, s6, s87
    s_min_u32 s87, s87, s10
    s_cmp_gt_i32 s37, s72
    s_cselect_b32 s10, s37, s87
    s_min_u32 s87, s87, s10
    s_cmp_gt_i32 s38, s72
    s_cselect_b32 s10, s38, s87
    s_min_u32 s87, s87, s10
    s_branch K2_LOOP
K2_EV0:
    s_cmp_ge_u32 s72, s73
    s_cbranch_scc1 K2_TAIL
    s_cmp_lg_u32 s72, s37
    s_cbranch_scc1 K2_SB0
    s_barrier
    s_mov_b32 s37, -1
K2_SB0:
    s_cmp_lg_u32 s72, s4
    s_cbranch_scc1 K2_PR0_0
    s_setprio 2
K2_PR0_0:
    s_cmp_lg_u32 s72, s5
    s_cbranch_scc1 K2_PR0_1
    s_setprio 1
K2_PR0_1:
    s_cmp_lg_u32 s72, s6
    s_cbranch_scc1 K2_PR0_2
    s_setprio 0
K2_PR0_2:
    s_cmp_eq_u32 s72, s38
    s_cbranch_scc1 K2_LT0
    s_mov_b32 s87, s73
    s_cmp_gt_i32 s4, s72
    s_cselect_b32 s10, s4, s87
    s_min_u32 s87, s87, s10
    s_cmp_gt_i32 s5, s72
    s_cselect_b32 s10, s5, s87
    s_min_u32 s87, s87, s10
    s_cmp_gt_i32 s6, s72
    s_cselect_b32 s10, s6, s87
    s_min_u32 s87, s87, s10
    s_cmp_gt_i32 s37, s72
    s_cselect_b32 s10, s37, s87
    s_min_u32 s87, s87, s10
    s_cmp_gt_i32 s38, s72
    s_cselect_b32 s10, s38, s87
    s_min_u32 s87, s87, s10
    s_branch K2_EVR0
K2_LT0:
    v_add_u32 v248, 128, v248
K2_LT1:
    s_sub_u32 s10, s15, s76
    s_sub_u32 s10, s10, 4
    s_and_b32 s10, s10, 127
    s_cmp_lt_u32 s10, 32
    s_cbranch_scc1 K2_LG1
    s_cmp_lt_u32 s10, 64
    s_cbranch_scc1 K2_LG2
    s_cmp_lt_u32 s10, 96
    s_cbranch_scc1 K2_LG3
    v_smfmac_f32_32x32x32_bf16 v[136:151], v[180:183], v[204:211], v177
    ds_read_u8 v236, v248 offset:0
    ds_read_u8 v237, v248 offset:16
    ds_read_u8 v238, v248 offset:64
    ds_read_u8 v239, v248 offset:80
    v_exp_f32 v188, v188
    v_exp_f32 v189, v189
    v_exp_f32 v190, v190
    v_add_f32 v188, 1.0, v188
    v_smfmac_f32_32x32x32_bf16 v[136:151], v[184:187], v[212:219], v177
    v_exp_f32 v191, v191
    v_add_f32 v189, 1.0, v189
    v_exp_f32 v192, v192
    v_add_f32 v190, 1.0, v190
    v_rcp_f32 v188, v188
    v_mfma_f32_32x32x16_bf16 v[220:235], v[168:171], v[68:71], 0
    v_exp_f32 v193, v193
    v_add_f32 v191, 1.0, v191
    v_rcp_f32 v189, v189
    v_exp_f32 v194, v194
    v_mfma_f32_32x32x16_bf16 v[204:219], v[152:155], v[32:35], 0
    v_add_f32 v192, 1.0, v192
    v_rcp_f32 v190, v190
    v_exp_f32 v195, v195
    v_mfma_f32_32x32x16_bf16 v[204:219], v[156:159], v[36:39], v[204:219]
    s_waitcnt lgkmcnt(0)
    v_lshl_add_u32 v236, v236, 6, v246
    v_lshl_add_u32 v237, v237, 6, v246
    v_lshl_add_u32 v238, v238, 6, v246
    v_lshl_add_u32 v239, v239, 6, v246
    v_add_f32 v193, 1.0, v193
    v_rcp_f32 v191, v191
    v_exp_f32 v196, v196
    v_add_f32 v194, 1.0, v194
    v_rcp_f32 v192, v192
    v_smfmac_f32_32x32x32_bf16 v[220:235], v[172:175], v[80:87], v176
    ds_read_b64_tr_b16 v[180:181], v236
    ds_read_b64_tr_b16 v[182:183], v237
    ds_read_b64_tr_b16 v[184:185], v238
    ds_read_b64_tr_b16 v[186:187], v239
    v_exp_f32 v197, v197
    v_add_f32 v195, 1.0, v195
    v_rcp_f32 v193, v193
    v_exp_f32 v198, v198
    v_mfma_f32_32x32x16_bf16 v[204:219], v[160:163], v[40:43], v[204:219]
    v_add_f32 v196, 1.0, v196
    v_rcp_f32 v194, v194
    v_exp_f32 v199, v199
    v_add_f32 v197, 1.0, v197
    v_mfma_f32_32x32x16_bf16 v[204:219], v[164:167], v[44:47], v[204:219]
    v_rcp_f32 v195, v195
    v_exp_f32 v200, v200
    v_add_f32 v198, 1.0, v198
    v_rcp_f32 v196, v196
    v_mfma_f32_32x32x16_bf16 v[220:235], v[152:155], v[16:19], v[220:235]
    v_exp_f32 v201, v201
    v_add_f32 v199, 1.0, v199
    v_rcp_f32 v197, v197
    v_exp_f32 v202, v202
    v_mfma_f32_32x32x16_bf16 v[220:235], v[156:159], v[20:23], v[220:235]
    v_add_f32 v200, 1.0, v200
    v_rcp_f32 v198, v198
    v_exp_f32 v203, v203
    v_add_f32 v201, 1.0, v201
    v_mfma_f32_32x32x16_bf16 v[220:235], v[160:163], v[24:27], v[220:235]
    v_rcp_f32 v199, v199
    v_add_f32 v202, 1.0, v202
    v_rcp_f32 v200, v200
    v_add_f32 v203, 1.0, v203
    v_rcp_f32 v201, v201
    v_mfma_f32_32x32x16_bf16 v[220:235], v[164:167], v[28:31], v[220:235]
    v_rcp_f32 v202, v202
    v_rcp_f32 v203, v203
    v_mul_f32 v204, v188, v204
    v_mul_f32 v205, v189, v205
    s_waitcnt lgkmcnt(0)
    v_smfmac_f32_32x32x32_bf16 v[88:103], v[180:183], v[188:195], v177
    v_mul_f32 v206, v190, v206
    v_mul_f32 v207, v191, v207
    v_mul_f32 v208, v192, v208
    v_mul_f32 v209, v193, v209
    v_mul_f32 v210, v194, v210
    v_mul_f32 v211, v195, v211
    v_mul_f32 v212, v196, v212
    v_smfmac_f32_32x32x32_bf16 v[88:103], v[184:187], v[196:203], v177
    v_mul_f32 v213, v197, v213
    v_mul_f32 v214, v198, v214
    v_mul_f32 v215, v199, v215
    v_mul_f32 v216, v200, v216
    v_mul_f32 v217, v201, v217
    v_mul_f32 v218, v202, v218
    v_mul_f32 v219, v203, v219
    v_smfmac_f32_32x32x32_bf16 v[104:119], v[180:183], v[204:211], v177
    v_exp_f32 v220, v220
    v_exp_f32 v221, v221
    v_exp_f32 v222, v222
    v_add_f32 v220, 1.0, v220
    v_exp_f32 v223, v223
    v_smfmac_f32_32x32x32_bf16 v[104:119], v[184:187], v[212:219], v177
    v_add_f32 v221, 1.0, v221
    v_exp_f32 v224, v224
    v_add_f32 v222, 1.0, v222
    v_rcp_f32 v220, v220
    v_exp_f32 v225, v225
    v_add_f32 v223, 1.0, v223
    v_mfma_f32_32x32x16_bf16 v[204:219], v[152:155], v[48:51], 0
    v_rcp_f32 v221, v221
    v_exp_f32 v226, v226
    v_add_f32 v224, 1.0, v224
    v_rcp_f32 v222, v222
    v_exp_f32 v227, v227
    v_mfma_f32_32x32x16_bf16 v[204:219], v[156:159], v[52:55], v[204:219]
    v_add_f32 v225, 1.0, v225
    v_rcp_f32 v223, v223
    v_exp_f32 v228, v228
    v_add_f32 v226, 1.0, v226
    v_rcp_f32 v224, v224
    v_exp_f32 v229, v229
    v_mfma_f32_32x32x16_bf16 v[204:219], v[160:163], v[56:59], v[204:219]
    v_add_f32 v227, 1.0, v227
    v_rcp_f32 v225, v225
    v_exp_f32 v230, v230
    v_add_f32 v228, 1.0, v228
    v_rcp_f32 v226, v226
    v_mfma_f32_32x32x16_bf16 v[204:219], v[164:167], v[60:63], v[204:219]
    v_exp_f32 v231, v231
    v_add_f32 v229, 1.0, v229
    v_rcp_f32 v227, v227
    v_exp_f32 v232, v232
    v_add_f32 v230, 1.0, v230
    v_rcp_f32 v228, v228
    v_exp_f32 v233, v233
    v_add_f32 v231, 1.0, v231
    v_rcp_f32 v229, v229
    v_exp_f32 v234, v234
    v_add_f32 v232, 1.0, v232
    v_rcp_f32 v230, v230
    v_exp_f32 v235, v235
    v_add_f32 v233, 1.0, v233
    v_rcp_f32 v231, v231
    v_add_f32 v234, 1.0, v234
    v_rcp_f32 v232, v232
    v_add_f32 v235, 1.0, v235
    v_rcp_f32 v233, v233
    v_rcp_f32 v234, v234
    v_rcp_f32 v235, v235
    v_mul_f32 v204, v220, v204
    v_mul_f32 v205, v221, v205
    v_smfmac_f32_32x32x32_bf16 v[120:135], v[180:183], v[220:227], v177
    v_mul_f32 v206, v222, v206
    v_mul_f32 v207, v223, v207
    v_mul_f32 v208, v224, v208
    v_mul_f32 v209, v225, v209
    v_mul_f32 v210, v226, v210
    v_mul_f32 v211, v227, v211
    v_mul_f32 v212, v228, v212
    v_smfmac_f32_32x32x32_bf16 v[120:135], v[184:187], v[228:235], v177
    v_mul_f32 v213, v229, v213
    v_mul_f32 v214, v230, v214
    v_mul_f32 v215, v231, v215
    v_mul_f32 v216, v232, v216
    v_mul_f32 v217, v233, v217
    v_mul_f32 v218, v234, v218
    v_mul_f32 v219, v235, v219
    v_smfmac_f32_32x32x32_bf16 v[136:151], v[180:183], v[204:211], v177
    s_nop 0
    v_smfmac_f32_32x32x32_bf16 v[136:151], v[184:187], v[212:219], v177
    s_branch K2_DONE
K2_LG3:
    v_smfmac_f32_32x32x32_bf16 v[136:151], v[180:183], v[204:211], v177
    ds_read_u8 v236, v248 offset:0
    ds_read_u8 v237, v248 offset:16
    ds_read_u8 v238, v248 offset:64
    ds_read_u8 v239, v248 offset:80
    v_exp_f32 v188, v188
    v_exp_f32 v189, v189
    v_exp_f32 v190, v190
    v_smfmac_f32_32x32x32_bf16 v[136:151], v[184:187], v[212:219], v177
    v_add_f32 v188, 1.0, v188
    v_exp_f32 v191, v191
    v_add_f32 v189, 1.0, v189
    v_exp_f32 v192, v192
    v_mfma_f32_32x32x16_bf16 v[220:235], v[168:171], v[68:71], 0
    v_add_f32 v190, 1.0, v190
    v_rcp_f32 v188, v188
    v_exp_f32 v193, v193
    v_mfma_f32_32x32x16_bf16 v[204:219], v[152:155], v[32:35], 0
    v_add_f32 v191, 1.0, v191
    v_rcp_f32 v189, v189
    v_exp_f32 v194, v194
    v_mfma_f32_32x32x16_bf16 v[204:219], v[156:159], v[36:39], v[204:219]
    s_waitcnt lgkmcnt(0)
    v_lshl_add_u32 v236, v236, 6, v246
    v_lshl_add_u32 v237, v237, 6, v246
    v_lshl_add_u32 v238, v238, 6, v246
    v_lshl_add_u32 v239, v239, 6, v246
    v_add_f32 v192, 1.0, v192
    v_rcp_f32 v190, v190
    v_exp_f32 v195, v195
    v_smfmac_f32_32x32x32_bf16 v[220:235], v[172:175], v[80:87], v176
    ds_read_b64_tr_b16 v[180:181], v236
    ds_read_b64_tr_b16 v[182:183], v237
    ds_read_b64_tr_b16 v[184:185], v238
    ds_read_b64_tr_b16 v[186:187], v239
    v_add_f32 v193, 1.0, v193
    v_rcp_f32 v191, v191
    v_exp_f32 v196, v196
    v_mfma_f32_32x32x16_bf16 v[204:219], v[160:163], v[40:43], v[204:219]
    v_add_f32 v194, 1.0, v194
    v_rcp_f32 v192, v192
    v_exp_f32 v197, v197
    v_mfma_f32_32x32x16_bf16 v[204:219], v[164:167], v[44:47], v[204:219]
    v_add_f32 v195, 1.0, v195
    v_rcp_f32 v193, v193
    v_exp_f32 v198, v198
    v_mfma_f32_32x32x16_bf16 v[220:235], v[152:155], v[16:19], v[220:235]
    v_add_f32 v196, 1.0, v196
    v_rcp_f32 v194, v194
    v_exp_f32 v199, v199
    v_mfma_f32_32x32x16_bf16 v[220:235], v[156:159], v[20:23], v[220:235]
    v_add_f32 v197, 1.0, v197
    v_rcp_f32 v195, v195
    v_add_f32 v198, 1.0, v198
    v_mfma_f32_32x32x16_bf16 v[220:235], v[160:163], v[24:27], v[220:235]
    v_rcp_f32 v196, v196
    v_add_f32 v199, 1.0, v199
    v_rcp_f32 v197, v197
    v_mfma_f32_32x32x16_bf16 v[220:235], v[164:167], v[28:31], v[220:235]
    v_rcp_f32 v198, v198
    v_rcp_f32 v199, v199
    v_mul_f32 v204, v188, v204
    v_mul_f32 v205, v189, v205
    s_waitcnt lgkmcnt(0)
    v_smfmac_f32_32x32x32_bf16 v[88:103], v[180:183], v[188:195], v177
    v_mul_f32 v206, v190, v206
    v_mul_f32 v207, v191, v207
    v_mul_f32 v208, v192, v208
    v_mul_f32 v209, v193, v209
    v_mul_f32 v210, v194, v210
    v_smfmac_f32_32x32x32_bf16 v[88:103], v[184:187], v[196:203], v177
    v_mul_f32 v211, v195, v211
    v_mul_f32 v212, v196, v212
    v_mul_f32 v213, v197, v213
    v_mul_f32 v214, v198, v214
    v_mul_f32 v215, v199, v215
    v_smfmac_f32_32x32x32_bf16 v[104:119], v[180:183], v[204:211], v177
    v_exp_f32 v220, v220
    v_exp_f32 v221, v221
    v_exp_f32 v222, v222
    v_add_f32 v220, 1.0, v220
    v_smfmac_f32_32x32x32_bf16 v[104:119], v[184:187], v[212:219], v177
    v_exp_f32 v223, v223
    v_add_f32 v221, 1.0, v221
    v_exp_f32 v224, v224
    v_add_f32 v222, 1.0, v222
    v_rcp_f32 v220, v220
    v_mfma_f32_32x32x16_bf16 v[204:219], v[152:155], v[48:51], 0
    v_exp_f32 v225, v225
    v_add_f32 v223, 1.0, v223
    v_rcp_f32 v221, v221
    v_exp_f32 v226, v226
    v_mfma_f32_32x32x16_bf16 v[204:219], v[156:159], v[52:55], v[204:219]
    v_add_f32 v224, 1.0, v224
    v_rcp_f32 v222, v222
    v_exp_f32 v227, v227
    v_mfma_f32_32x32x16_bf16 v[204:219], v[160:163], v[56:59], v[204:219]
    v_add_f32 v225, 1.0, v225
    v_rcp_f32 v223, v223
    v_exp_f32 v228, v228
    v_add_f32 v226, 1.0, v226
    v_rcp_f32 v224, v224
    v_mfma_f32_32x32x16_bf16 v[204:219], v[164:167], v[60:63], v[204:219]
    v_exp_f32 v229, v229
    v_add_f32 v227, 1.0, v227
    v_rcp_f32 v225, v225
    v_exp_f32 v230, v230
    v_add_f32 v228, 1.0, v228
    v_rcp_f32 v226, v226
    v_exp_f32 v231, v231
    v_add_f32 v229, 1.0, v229
    v_rcp_f32 v227, v227
    v_add_f32 v230, 1.0, v230
    v_rcp_f32 v228, v228
    v_add_f32 v231, 1.0, v231
    v_rcp_f32 v229, v229
    v_rcp_f32 v230, v230
    v_rcp_f32 v231, v231
    v_mul_f32 v204, v220, v204
    v_mul_f32 v205, v221, v205
    v_smfmac_f32_32x32x32_bf16 v[120:135], v[180:183], v[220:227], v177
    v_mul_f32 v206, v222, v206
    v_mul_f32 v207, v223, v207
    v_mul_f32 v208, v224, v208
    v_mul_f32 v209, v225, v209
    v_mul_f32 v210, v226, v210
    v_smfmac_f32_32x32x32_bf16 v[120:135], v[184:187], v[228:235], v177
    v_mul_f32 v211, v227, v211
    v_mul_f32 v212, v228, v212
    v_mul_f32 v213, v229, v213
    v_mul_f32 v214, v230, v214
    v_mul_f32 v215, v231, v215
    v_smfmac_f32_32x32x32_bf16 v[136:151], v[180:183], v[204:211], v177
    s_nop 0
    v_smfmac_f32_32x32x32_bf16 v[136:151], v[184:187], v[212:219], v177
    s_branch K2_DONE
K2_LG2:
    v_smfmac_f32_32x32x32_bf16 v[136:151], v[180:183], v[204:211], v177
    ds_read_u8 v236, v248 offset:0
    ds_read_u8 v237, v248 offset:16
    ds_read_u8 v238, v248 offset:64
    ds_read_u8 v239, v248 offset:80
    v_exp_f32 v188, v188
    v_exp_f32 v189, v189
    v_smfmac_f32_32x32x32_bf16 v[136:151], v[184:187], v[212:219], v177
    v_exp_f32 v190, v190
    v_add_f32 v188, 1.0, v188
    v_mfma_f32_32x32x16_bf16 v[220:235], v[168:171], v[68:71], 0
    v_exp_f32 v191, v191
    v_add_f32 v189, 1.0, v189
    v_exp_f32 v192, v192
    v_mfma_f32_32x32x16_bf16 v[204:219], v[152:155], v[32:35], 0
    v_add_f32 v190, 1.0, v190
    v_rcp_f32 v188, v188
    v_mfma_f32_32x32x16_bf16 v[204:219], v[156:159], v[36:39], v[204:219]
    s_waitcnt lgkmcnt(0)
    v_lshl_add_u32 v236, v236, 6, v246
    v_lshl_add_u32 v237, v237, 6, v246
    v_lshl_add_u32 v238, v238, 6, v246
    v_lshl_add_u32 v239, v239, 6, v246
    v_exp_f32 v193, v193
    v_smfmac_f32_32x32x32_bf16 v[220:235], v[172:175], v[80:87], v176
    ds_read_b64_tr_b16 v[180:181], v236
    ds_read_b64_tr_b16 v[182:183], v237
    ds_read_b64_tr_b16 v[184:185], v238
    ds_read_b64_tr_b16 v[186:187], v239
    v_add_f32 v191, 1.0, v191
    v_rcp_f32 v189, v189
    v_exp_f32 v194, v194
    v_mfma_f32_32x32x16_bf16 v[204:219], v[160:163], v[40:43], v[204:219]
    v_add_f32 v192, 1.0, v192
    v_rcp_f32 v190, v190
    v_mfma_f32_32x32x16_bf16 v[204:219], v[164:167], v[44:47], v[204:219]
    v_exp_f32 v195, v195
    v_mfma_f32_32x32x16_bf16 v[220:235], v[152:155], v[16:19], v[220:235]
    v_add_f32 v193, 1.0, v193
    v_rcp_f32 v191, v191
    v_add_f32 v194, 1.0, v194
    v_mfma_f32_32x32x16_bf16 v[220:235], v[156:159], v[20:23], v[220:235]
    v_rcp_f32 v192, v192
    v_add_f32 v195, 1.0, v195
    v_mfma_f32_32x32x16_bf16 v[220:235], v[160:163], v[24:27], v[220:235]
    v_rcp_f32 v193, v193
    v_rcp_f32 v194, v194
    v_mfma_f32_32x32x16_bf16 v[220:235], v[164:167], v[28:31], v[220:235]
    v_rcp_f32 v195, v195
    v_mul_f32 v204, v188, v204
    v_mul_f32 v205, v189, v205
    v_mul_f32 v206, v190, v206
    s_waitcnt lgkmcnt(0)
    v_smfmac_f32_32x32x32_bf16 v[88:103], v[180:183], v[188:195], v177
    v_mul_f32 v207, v191, v207
    v_mul_f32 v208, v192, v208
    v_mul_f32 v209, v193, v209
    v_mul_f32 v210, v194, v210
    v_mul_f32 v211, v195, v211
    s_nop 1
    v_smfmac_f32_32x32x32_bf16 v[104:119], v[180:183], v[204:211], v177
    v_exp_f32 v220, v220
    v_exp_f32 v221, v221
    v_exp_f32 v222, v222
    v_mfma_f32_32x32x16_bf16 v[204:219], v[152:155], v[48:51], 0
    v_add_f32 v220, 1.0, v220
    v_exp_f32 v223, v223
    v_add_f32 v221, 1.0, v221
    v_mfma_f32_32x32x16_bf16 v[204:219], v[156:159], v[52:55], v[204:219]
    v_exp_f32 v224, v224
    v_add_f32 v222, 1.0, v222
    v_rcp_f32 v220, v220
    v_mfma_f32_32x32x16_bf16 v[204:219], v[160:163], v[56:59], v[204:219]
    v_exp_f32 v225, v225
    v_add_f32 v223, 1.0, v223
    v_rcp_f32 v221, v221
    v_mfma_f32_32x32x16_bf16 v[204:219], v[164:167], v[60:63], v[204:219]
    v_exp_f32 v226, v226
    v_add_f32 v224, 1.0, v224
    v_rcp_f32 v222, v222
    v_exp_f32 v227, v227
    v_add_f32 v225, 1.0, v225
    v_rcp_f32 v223, v223
    v_add_f32 v226, 1.0, v226
    v_rcp_f32 v224, v224
    v_add_f32 v227, 1.0, v227
    v_rcp_f32 v225, v225
    v_rcp_f32 v226, v226
    v_rcp_f32 v227, v227
    v_mul_f32 v204, v220, v204
    v_mul_f32 v205, v221, v205
    v_mul_f32 v206, v222, v206
    v_smfmac_f32_32x32x32_bf16 v[120:135], v[180:183], v[220:227], v177
    v_mul_f32 v207, v223, v207
    v_mul_f32 v208, v224, v208
    v_mul_f32 v209, v225, v209
    v_mul_f32 v210, v226, v210
    v_mul_f32 v211, v227, v211
    s_nop 1
    v_smfmac_f32_32x32x32_bf16 v[136:151], v[180:183], v[204:211], v177
    s_branch K2_DONE
K2_LG1:
    v_smfmac_f32_32x32x32_bf16 v[136:151], v[180:183], v[204:211], v177
    ds_read_u8 v236, v248 offset:0
    ds_read_u8 v237, v248 offset:16
    ds_read_u8 v238, v248 offset:64
    ds_read_u8 v239, v248 offset:80
    v_exp_f32 v188, v188
    v_smfmac_f32_32x32x32_bf16 v[136:151], v[184:187], v[212:219], v177
    v_exp_f32 v189, v189
    v_mfma_f32_32x32x16_bf16 v[220:235], v[168:171], v[68:71], 0
    v_exp_f32 v190, v190
    v_mfma_f32_32x32x16_bf16 v[204:219], v[152:155], v[32:35], 0
    v_add_f32 v188, 1.0, v188
    v_mfma_f32_32x32x16_bf16 v[204:219], v[156:159], v[36:39], v[204:219]
    s_waitcnt lgkmcnt(0)
    v_lshl_add_u32 v236, v236, 6, v246
    v_lshl_add_u32 v237, v237, 6, v246
    v_lshl_add_u32 v238, v238, 6, v246
    v_lshl_add_u32 v239, v239, 6, v246
    v_exp_f32 v191, v191
    v_smfmac_f32_32x32x32_bf16 v[220:235], v[172:175], v[80:87], v176
    ds_read_b64_tr_b16 v[180:181], v236
    ds_read_b64_tr_b16 v[182:183], v237
    ds_read_b64_tr_b16 v[184:185], v238
    ds_read_b64_tr_b16 v[186:187], v239
    v_add_f32 v189, 1.0, v189
    v_add_f32 v190, 1.0, v190
    v_mfma_f32_32x32x16_bf16 v[204:219], v[160:163], v[40:43], v[204:219]
    v_rcp_f32 v188, v188
    v_mfma_f32_32x32x16_bf16 v[204:219], v[164:167], v[44:47], v[204:219]
    v_add_f32 v191, 1.0, v191
    v_mfma_f32_32x32x16_bf16 v[220:235], v[152:155], v[16:19], v[220:235]
    v_rcp_f32 v189, v189
    v_mfma_f32_32x32x16_bf16 v[220:235], v[156:159], v[20:23], v[220:235]
    v_rcp_f32 v190, v190
    v_mfma_f32_32x32x16_bf16 v[220:235], v[160:163], v[24:27], v[220:235]
    v_rcp_f32 v191, v191
    v_mfma_f32_32x32x16_bf16 v[220:235], v[164:167], v[28:31], v[220:235]
    s_nop 3
    v_mul_f32 v204, v188, v204
    v_mul_f32 v205, v189, v205
    s_waitcnt lgkmcnt(0)
    v_smfmac_f32_32x32x32_bf16 v[88:103], v[180:183], v[188:195], v177
    v_mul_f32 v206, v190, v206
    v_mul_f32 v207, v191, v207
    s_nop 1
    v_smfmac_f32_32x32x32_bf16 v[104:119], v[180:183], v[204:211], v177
    v_exp_f32 v220, v220
    v_exp_f32 v221, v221
    v_mfma_f32_32x32x16_bf16 v[204:219], v[152:155], v[48:51], 0
    v_exp_f32 v222, v222
    v_mfma_f32_32x32x16_bf16 v[204:219], v[156:159], v[52:55], v[204:219]
    v_add_f32 v220, 1.0, v220
    v_exp_f32 v223, v223
    v_mfma_f32_32x32x16_bf16 v[204:219], v[160:163], v[56:59], v[204:219]
    v_add_f32 v221, 1.0, v221
    v_mfma_f32_32x32x16_bf16 v[204:219], v[164:167], v[60:63], v[204:219]
    v_add_f32 v222, 1.0, v222
    v_rcp_f32 v220, v220
    v_add_f32 v223, 1.0, v223
    v_rcp_f32 v221, v221
    v_rcp_f32 v222, v222
    v_rcp_f32 v223, v223
    s_nop 5
    v_mul_f32 v204, v220, v204
    v_mul_f32 v205, v221, v205
    v_smfmac_f32_32x32x32_bf16 v[120:135], v[180:183], v[220:227], v177
    v_mul_f32 v206, v222, v206
    v_mul_f32 v207, v223, v207
    s_nop 1
    v_smfmac_f32_32x32x32_bf16 v[136:151], v[180:183], v[204:211], v177
    s_branch K2_DONE
K2_TAIL:
    v_smfmac_f32_32x32x32_bf16 v[136:151], v[180:183], v[204:211], v177
    v_smfmac_f32_32x32x32_bf16 v[136:151], v[184:187], v[212:219], v177
K2_DONE:
    s_cmp_lg_u32 s78, 0
    s_cbranch_scc1 K2_SLOW
K2_EPI:
    v_lshlrev_b32 v252, 4, v254
    ds_read_b128 v[152:155], v253 offset:0
    ds_read_b128 v[156:159], v253 offset:16
    ds_read_b128 v[160:163], v253 offset:32
    ds_read_b128 v[164:167], v253 offset:48
    ds_read_b128 v[0:3], v252 offset:52736
    ds_read_b128 v[4:7], v252 offset:53760
    ds_read_b128 v[8:11], v252 offset:54784
    ds_read_b128 v[12:15], v252 offset:55808
    ds_read_b128 v[16:19], v252 offset:56832
    ds_read_b128 v[20:23], v252 offset:57856
    ds_read_b128 v[24:27], v252 offset:58880
    ds_read_b128 v[28:31], v252 offset:59904
    v_and_b32 v237, 31, v254
    v_and_b32 v245, 32, v254
    v_mul_u32_u24 v246, 144, v237
    v_lshrrev_b32 v238, 2, v245
    v_lshl_add_u32 v237, v237, 6, v238
    ds_read2_b64 v[180:183], v237 offset0:0 offset1:2
    ds_read2_b64 v[184:187], v237 offset0:4 offset1:6
    s_waitcnt lgkmcnt(10)
    v_lshlrev_b32 v32, 16, v152
    v_and_b32 v33, 0xffff0000, v152
    v_lshlrev_b32 v34, 16, v153
    v_and_b32 v35, 0xffff0000, v153
    v_lshlrev_b32 v36, 16, v154
    v_and_b32 v37, 0xffff0000, v154
    v_lshlrev_b32 v38, 16, v155
    v_and_b32 v39, 0xffff0000, v155
    v_lshlrev_b32 v40, 16, v156
    v_and_b32 v41, 0xffff0000, v156
    v_lshlrev_b32 v42, 16, v157
    v_and_b32 v43, 0xffff0000, v157
    v_lshlrev_b32 v44, 16, v158
    v_and_b32 v45, 0xffff0000, v158
    v_lshlrev_b32 v46, 16, v159
    v_and_b32 v47, 0xffff0000, v159
    v_lshlrev_b32 v48, 16, v160
    v_and_b32 v49, 0xffff0000, v160
    v_lshlrev_b32 v50, 16, v161
    v_and_b32 v51, 0xffff0000, v161
    v_lshlrev_b32 v52, 16, v162
    v_and_b32 v53, 0xffff0000, v162
    v_lshlrev_b32 v54, 16, v163
    v_and_b32 v55, 0xffff0000, v163
    v_lshlrev_b32 v56, 16, v164
    v_and_b32 v57, 0xffff0000, v164
    v_lshlrev_b32 v58, 16, v165
    v_and_b32 v59, 0xffff0000, v165
    v_lshlrev_b32 v60, 16, v166
    v_and_b32 v61, 0xffff0000, v166
    v_lshlrev_b32 v62, 16, v167
    v_and_b32 v63, 0xffff0000, v167
    v_lshl_add_u32 v253, v245, 1, v246
    v_add_u32 v253, s74, v253
    s_sub_u32 s10, s13, s96
    s_mul_i32 s10, s10, 144
    s_add_u32 s10, s10, s74
    v_lshrrev_b32 v236, 3, v254
    v_lshl_add_u32 v236, v236, 4, v252
    v_add_u32 v236, s10, v236
    s_mul_i32 s10, s12, 196
    s_add_u32 s11, s10, s14
    s_add_u32 s10, s10, s13
    s_min_u32 s11, s11, 50000
    s_min_u32 s10, s10, 50000
    s_sub_u32 s11, s11, s10
    s_lshl_b32 s10, s10, 7
    s_add_u32 s28, s28, s10
    s_addc_u32 s29, s29, 0
    s_lshl_b32 s30, s11, 7
    s_waitcnt lgkmcnt(9)
    v_mfma_f32_32x32x16_bf16 v[188:203], v[0:3], v[152:155], v[32:47]
    v_rcp_f32 v88, v88
    v_rcp_f32 v89, v89
    v_rcp_f32 v90, v90
    v_rcp_f32 v91, v91
    s_waitcnt lgkmcnt(8)
    v_mfma_f32_32x32x16_bf16 v[188:203], v[4:7], v[156:159], v[188:203]
    v_rcp_f32 v92, v92
    v_rcp_f32 v93, v93
    v_rcp_f32 v94, v94
    v_rcp_f32 v95, v95
    s_waitcnt lgkmcnt(7)
    v_mfma_f32_32x32x16_bf16 v[188:203], v[8:11], v[160:163], v[188:203]
    v_rcp_f32 v96, v96
    v_rcp_f32 v97, v97
    v_rcp_f32 v98, v98
    v_rcp_f32 v99, v99
    s_waitcnt lgkmcnt(6)
    v_mfma_f32_32x32x16_bf16 v[188:203], v[12:15], v[164:167], v[188:203]
    v_rcp_f32 v100, v100
    v_rcp_f32 v101, v101
    v_rcp_f32 v102, v102
    v_rcp_f32 v103, v103
    s_waitcnt lgkmcnt(5)
    v_mfma_f32_32x32x16_bf16 v[204:219], v[16:19], v[152:155], v[48:63]
    v_rcp_f32 v120, v120
    v_rcp_f32 v121, v121
    v_rcp_f32 v122, v122
    v_rcp_f32 v123, v123
    s_waitcnt lgkmcnt(4)
    v_mfma_f32_32x32x16_bf16 v[204:219], v[20:23], v[156:159], v[204:219]
    v_rcp_f32 v124, v124
    v_rcp_f32 v125, v125
    v_rcp_f32 v126, v126
    v_rcp_f32 v127, v127
    s_waitcnt lgkmcnt(3)
    v_mfma_f32_32x32x16_bf16 v[204:219], v[24:27], v[160:163], v[204:219]
    v_rcp_f32 v128, v128
    v_rcp_f32 v129, v129
    v_rcp_f32 v130, v130
    v_rcp_f32 v131, v131
    s_waitcnt lgkmcnt(2)
    v_mfma_f32_32x32x16_bf16 v[204:219], v[28:31], v[164:167], v[204:219]
    v_rcp_f32 v132, v132
    v_rcp_f32 v133, v133
    v_rcp_f32 v134, v134
    v_rcp_f32 v135, v135
    s_waitcnt lgkmcnt(0)
    v_mul_f32 v104, v104, v88
    v_mul_f32 v105, v105, v89
    v_mul_f32 v106, v106, v90
    v_mul_f32 v107, v107, v91
    v_mul_f32 v108, v108, v92
    v_mul_f32 v109, v109, v93
    v_mul_f32 v110, v110, v94
    v_mul_f32 v111, v111, v95
    v_mul_f32 v112, v112, v96
    v_mul_f32 v113, v113, v97
    v_mul_f32 v114, v114, v98
    v_mul_f32 v115, v115, v99
    v_mul_f32 v116, v116, v100
    v_mul_f32 v117, v117, v101
    v_mul_f32 v118, v118, v102
    v_mul_f32 v119, v119, v103
    v_cvt_pk_bf16_f32 v88, v104, v105
    v_cvt_pk_bf16_f32 v89, v106, v107
    v_cvt_pk_bf16_f32 v90, v108, v109
    v_cvt_pk_bf16_f32 v91, v110, v111
    v_cvt_pk_bf16_f32 v92, v112, v113
    v_cvt_pk_bf16_f32 v93, v114, v115
    v_cvt_pk_bf16_f32 v94, v116, v117
    v_cvt_pk_bf16_f32 v95, v118, v119
    v_mfma_f32_32x32x16_bf16 v[188:203], v[88:91], v[180:183], v[188:203]
    s_nop 0
    v_mfma_f32_32x32x16_bf16 v[188:203], v[92:95], v[184:187], v[188:203]
    v_mul_f32 v136, v136, v120
    v_mul_f32 v137, v137, v121
    v_mul_f32 v138, v138, v122
    v_mul_f32 v139, v139, v123
    v_mul_f32 v140, v140, v124
    v_mul_f32 v141, v141, v125
    v_mul_f32 v142, v142, v126
    v_mul_f32 v143, v143, v127
    v_mul_f32 v144, v144, v128
    v_mul_f32 v145, v145, v129
    v_mul_f32 v146, v146, v130
    v_mul_f32 v147, v147, v131
    v_mul_f32 v148, v148, v132
    v_mul_f32 v149, v149, v133
    v_mul_f32 v150, v150, v134
    v_mul_f32 v151, v151, v135
    v_cvt_pk_bf16_f32 v120, v136, v137
    v_cvt_pk_bf16_f32 v121, v138, v139
    v_cvt_pk_bf16_f32 v122, v140, v141
    v_cvt_pk_bf16_f32 v123, v142, v143
    v_cvt_pk_bf16_f32 v124, v144, v145
    v_cvt_pk_bf16_f32 v125, v146, v147
    v_cvt_pk_bf16_f32 v126, v148, v149
    v_cvt_pk_bf16_f32 v127, v150, v151
    v_mfma_f32_32x32x16_bf16 v[204:219], v[120:123], v[180:183], v[204:219]
    s_nop 0
    v_mfma_f32_32x32x16_bf16 v[204:219], v[124:127], v[184:187], v[204:219]
    v_max_f32 v188, v188, v32
    v_max_f32 v189, v189, v33
    v_max_f32 v190, v190, v34
    v_max_f32 v191, v191, v35
    v_max_f32 v192, v192, v36
    v_max_f32 v193, v193, v37
    v_max_f32 v194, v194, v38
    v_max_f32 v195, v195, v39
    v_cvt_pk_bf16_f32 v220, v188, v189
    v_cvt_pk_bf16_f32 v221, v190, v191
    v_cvt_pk_bf16_f32 v222, v192, v193
    v_cvt_pk_bf16_f32 v223, v194, v195
    ds_write_b128 v253, v[220:223] offset:0
    v_max_f32 v196, v196, v40
    v_max_f32 v197, v197, v41
    v_max_f32 v198, v198, v42
    v_max_f32 v199, v199, v43
    v_max_f32 v200, v200, v44
    v_max_f32 v201, v201, v45
    v_max_f32 v202, v202, v46
    v_max_f32 v203, v203, v47
    v_cvt_pk_bf16_f32 v224, v196, v197
    v_cvt_pk_bf16_f32 v225, v198, v199
    v_cvt_pk_bf16_f32 v226, v200, v201
    v_cvt_pk_bf16_f32 v227, v202, v203
    ds_write_b128 v253, v[224:227] offset:16
    v_max_f32 v204, v204, v48
    v_max_f32 v205, v205, v49
    v_max_f32 v206, v206, v50
    v_max_f32 v207, v207, v51
    v_max_f32 v208, v208, v52
    v_max_f32 v209, v209, v53
    v_max_f32 v210, v210, v54
    v_max_f32 v211, v211, v55
    v_cvt_pk_bf16_f32 v228, v204, v205
    v_cvt_pk_bf16_f32 v229, v206, v207
    v_cvt_pk_bf16_f32 v230, v208, v209
    v_cvt_pk_bf16_f32 v231, v210, v211
    ds_write_b128 v253, v[228:231] offset:32
    v_max_f32 v212, v212, v56
    v_max_f32 v213, v213, v57
    v_max_f32 v214, v214, v58
    v_max_f32 v215, v215, v59
    v_max_f32 v216, v216, v60
    v_max_f32 v217, v217, v61
    v_max_f32 v218, v218, v62
    v_max_f32 v219, v219, v63
    v_cvt_pk_bf16_f32 v232, v212, v213
    v_cvt_pk_bf16_f32 v233, v214, v215
    v_cvt_pk_bf16_f32 v234, v216, v217
    v_cvt_pk_bf16_f32 v235, v218, v219
    ds_write_b128 v253, v[232:235] offset:48
    ds_read_b128 v[152:155], v236 offset:0
    ds_read_b128 v[156:159], v236 offset:1152
    ds_read_b128 v[160:163], v236 offset:2304
    ds_read_b128 v[164:167], v236 offset:3456
    s_waitcnt lgkmcnt(3)
    buffer_store_dwordx4 v[152:155], v252, s[28:31], 0 offen offset:0 sc1
    s_waitcnt lgkmcnt(2)
    buffer_store_dwordx4 v[156:159], v252, s[28:31], 0 offen offset:1024 sc1
    s_waitcnt lgkmcnt(1)
    buffer_store_dwordx4 v[160:163], v252, s[28:31], 0 offen offset:2048 sc1
    s_waitcnt lgkmcnt(0)
    buffer_store_dwordx4 v[164:167], v252, s[28:31], 0 offen offset:3072 sc1
    s_add_u32 s10, s2, s7
    s_cmp_lg_u32 s10, 0
    s_cbranch_scc1 K2_NOEP
    v_mov_b32 v188, 24117248
    v_mov_b32 v189, s100
    buffer_store_dword v189, v188, s[24:27], 0 offen sc1
K2_NOEP:
K2_END:
    s_endpgm
K2_RETRY0:
    s_sub_u32 s101, s101, 1
    s_cbranch_scc1 K2_END
    s_waitcnt vmcnt(0)
    v_bitop3_b32 v188, v91, s36, v214 bitop3:0x28
    s_nop 1
    v_or_b32_dpp v188, v188, v188 quad_perm:[1,0,3,2] row_mask:0xf bank_mask:0xf
    s_nop 1
    v_or_b32_dpp v188, v188, v188 quad_perm:[2,3,0,1] row_mask:0xf bank_mask:0xf
    s_nop 1
    v_or_b32_dpp v188, v188, v188 row_half_mirror row_mask:0xf bank_mask:0xf
    v_cmp_ne_u32 vcc, 0, v188
    s_and_b64 exec, exec, vcc
    s_cbranch_execz K2_RT00
    buffer_load_dwordx4 v[88:91], v189, s[32:35], 0 offen sc1
K2_RT00:
    s_mov_b64 exec, -1
    v_bitop3_b32 v188, v95, s36, v214 bitop3:0x28
    s_nop 1
    v_or_b32_dpp v188, v188, v188 quad_perm:[1,0,3,2] row_mask:0xf bank_mask:0xf
    s_nop 1
    v_or_b32_dpp v188, v188, v188 quad_perm:[2,3,0,1] row_mask:0xf bank_mask:0xf
    s_nop 1
    v_or_b32_dpp v188, v188, v188 row_half_mirror row_mask:0xf bank_mask:0xf
    v_cmp_ne_u32 vcc, 0, v188
    s_and_b64 exec, exec, vcc
    s_cbranch_execz K2_RT01
    buffer_load_dwordx4 v[92:95], v189, s[32:35], s79 offen sc1
K2_RT01:
    s_mov_b64 exec, -1
    v_bitop3_b32 v188, v99, s36, v214 bitop3:0x28
    s_nop 1
    v_or_b32_dpp v188, v188, v188 quad_perm:[1,0,3,2] row_mask:0xf bank_mask:0xf
    s_nop 1
    v_or_b32_dpp v188, v188, v188 quad_perm:[2,3,0,1] row_mask:0xf bank_mask:0xf
    s_nop 1
    v_or_b32_dpp v188, v188, v188 row_half_mirror row_mask:0xf bank_mask:0xf
    v_cmp_ne_u32 vcc, 0, v188
    s_and_b64 exec, exec, vcc
    s_cbranch_execz K2_RT02
    buffer_load_dwordx4 v[96:99], v189, s[32:35], s80 offen sc1
K2_RT02:
    s_mov_b64 exec, -1
    v_bitop3_b32 v188, v103, s36, v214 bitop3:0x28
    s_nop 1
    v_or_b32_dpp v188, v188, v188 quad_perm:[1,0,3,2] row_mask:0xf bank_mask:0xf
    s_nop 1
    v_or_b32_dpp v188, v188, v188 quad_perm:[2,3,0,1] row_mask:0xf bank_mask:0xf
    s_nop 1
    v_or_b32_dpp v188, v188, v188 row_half_mirror row_mask:0xf bank_mask:0xf
    v_cmp_ne_u32 vcc, 0, v188
    s_and_b64 exec, exec, vcc
    s_cbranch_execz K2_RT03
    buffer_load_dwordx4 v[100:103], v189, s[32:35], s81 offen sc1
K2_RT03:
    s_mov_b64 exec, -1
    s_waitcnt vmcnt(0)
    s_branch K2_CHK0
K2_RETRY1:
    s_sub_u32 s101, s101, 1
    s_cbranch_scc1 K2_END
    s_waitcnt vmcnt(0)
    v_bitop3_b32 v188, v95, s36, v214 bitop3:0x28
    s_nop 1
    v_or_b32_dpp v188, v188, v188 quad_perm:[1,0,3,2] row_mask:0xf bank_mask:0xf
    s_nop 1
    v_or_b32_dpp v188, v188, v188 quad_perm:[2,3,0,1] row_mask:0xf bank_mask:0xf
    s_nop 1
    v_or_b32_dpp v188, v188, v188 row_half_mirror row_mask:0xf bank_mask:0xf
    v_cmp_ne_u32 vcc, 0, v188
    s_and_b64 exec, exec, vcc
    s_cbranch_execz K2_RT11
    buffer_load_dwordx4 v[92:95], v189, s[32:35], s79 offen sc1
K2_RT11:
    s_mov_b64 exec, -1
    v_bitop3_b32 v188, v99, s36, v214 bitop3:0x28
    s_nop 1
    v_or_b32_dpp v188, v188, v188 quad_perm:[1,0,3,2] row_mask:0xf bank_mask:0xf
    s_nop 1
    v_or_b32_dpp v188, v188, v188 quad_perm:[2,3,0,1] row_mask:0xf bank_mask:0xf
    s_nop 1
    v_or_b32_dpp v188, v188, v188 row_half_mirror row_mask:0xf bank_mask:0xf
    v_cmp_ne_u32 vcc, 0, v188
    s_and_b64 exec, exec, vcc
    s_cbranch_execz K2_RT12
    buffer_load_dwordx4 v[96:99], v189, s[32:35], s80 offen sc1
K2_RT12:
    s_mov_b64 exec, -1
    v_bitop3_b32 v188, v103, s36, v214 bitop3:0x28
    s_nop 1
    v_or_b32_dpp v188, v188, v188 quad_perm:[1,0,3,2] row_mask:0xf bank_mask:0xf
    s_nop 1
    v_or_b32_dpp v188, v188, v188 quad_perm:[2,3,0,1] row_mask:0xf bank_mask:0xf
    s_nop 1
    v_or_b32_dpp v188, v188, v188 row_half_mirror row_mask:0xf bank_mask:0xf
    v_cmp_ne_u32 vcc, 0, v188
    s_and_b64 exec, exec, vcc
    s_cbranch_execz K2_RT13
    buffer_load_dwordx4 v[100:103], v189, s[32:35], s81 offen sc1
K2_RT13:
    s_mov_b64 exec, -1
    s_waitcnt vmcnt(0)
    s_branch K2_CHK1
K2_RETRY2:
    s_sub_u32 s101, s101, 1
    s_cbranch_scc1 K2_END
    s_waitcnt vmcnt(0)
    v_bitop3_b32 v188, v99, s36, v214 bitop3:0x28
    s_nop 1
    v_or_b32_dpp v188, v188, v188 quad_perm:[1,0,3,2] row_mask:0xf bank_mask:0xf
    s_nop 1
    v_or_b32_dpp v188, v188, v188 quad_perm:[2,3,0,1] row_mask:0xf bank_mask:0xf
    s_nop 1
    v_or_b32_dpp v188, v188, v188 row_half_mirror row_mask:0xf bank_mask:0xf
    v_cmp_ne_u32 vcc, 0, v188
    s_and_b64 exec, exec, vcc
    s_cbranch_execz K2_RT22
    buffer_load_dwordx4 v[96:99], v189, s[32:35], s80 offen sc1
K2_RT22:
    s_mov_b64 exec, -1
    v_bitop3_b32 v188, v103, s36, v214 bitop3:0x28
    s_nop 1
    v_or_b32_dpp v188, v188, v188 quad_perm:[1,0,3,2] row_mask:0xf bank_mask:0xf
    s_nop 1
    v_or_b32_dpp v188, v188, v188 quad_perm:[2,3,0,1] row_mask:0xf bank_mask:0xf
    s_nop 1
    v_or_b32_dpp v188, v188, v188 row_half_mirror row_mask:0xf bank_mask:0xf
    v_cmp_ne_u32 vcc, 0, v188
    s_and_b64 exec, exec, vcc
    s_cbranch_execz K2_RT23
    buffer_load_dwordx4 v[100:103], v189, s[32:35], s81 offen sc1
K2_RT23:
    s_mov_b64 exec, -1
    s_waitcnt vmcnt(0)
    s_branch K2_CHK2
K2_RETRY3:
    s_sub_u32 s101, s101, 1
    s_cbranch_scc1 K2_END
    s_waitcnt vmcnt(0)
    v_bitop3_b32 v188, v103, s36, v214 bitop3:0x28
    s_nop 1
    v_or_b32_dpp v188, v188, v188 quad_perm:[1,0,3,2] row_mask:0xf bank_mask:0xf
    s_nop 1
    v_or_b32_dpp v188, v188, v188 quad_perm:[2,3,0,1] row_mask:0xf bank_mask:0xf
    s_nop 1
    v_or_b32_dpp v188, v188, v188 row_half_mirror row_mask:0xf bank_mask:0xf
    v_cmp_ne_u32 vcc, 0, v188
    s_and_b64 exec, exec, vcc
    s_cbranch_execz K2_RT33
    buffer_load_dwordx4 v[100:103], v189, s[32:35], s81 offen sc1
K2_RT33:
    s_mov_b64 exec, -1
    s_waitcnt vmcnt(0)
    s_branch K2_CHK3
K1_EXT:
    s_mov_b32 s14, 0x0f0f0f0f
    s_mov_b32 s15, s14
    ds_read_b32 v104, v6 offset:32
    ds_read_b128 v[8:11], v3 offset:128
    ds_read_b32 v105, v6 offset:3360
    ds_read_b128 v[16:19], v3 offset:13440
    ds_read_b32 v106, v6 offset:6688
    ds_read_b128 v[24:27], v3 offset:26752
    ds_read_b32 v107, v6 offset:10016
    ds_read_b128 v[32:35], v3 offset:40064
    s_waitcnt lgkmcnt(0)
    v_cmp_le_u32 vcc, 553648128, v108
    v_and_or_b32 v11, v104, v15, v108
    s_and_b64 exec, vcc, s[14:15]
    s_cbranch_execz K1_EX0
    buffer_store_dwordx4 v[8:11], v4, s[32:35], s10 offen sc1
K1_EX0:
    s_mov_b64 exec, -1
    s_add_u32 s10, s10, 2105344
    v_cmp_le_u32 vcc, 553648128, v109
    v_and_or_b32 v19, v105, v15, v109
    s_and_b64 exec, vcc, s[14:15]
    s_cbranch_execz K1_EX1
    buffer_store_dwordx4 v[16:19], v4, s[32:35], s10 offen sc1
K1_EX1:
    s_mov_b64 exec, -1
    s_add_u32 s10, s10, 2105344
    v_cmp_le_u32 vcc, 553648128, v110
    v_and_or_b32 v27, v106, v15, v110
    s_and_b64 exec, vcc, s[14:15]
    s_cbranch_execz K1_EX2
    buffer_store_dwordx4 v[24:27], v4, s[32:35], s10 offen sc1
K1_EX2:
    s_mov_b64 exec, -1
    s_add_u32 s10, s10, 2105344
    v_cmp_le_u32 vcc, 553648128, v111
    v_and_or_b32 v35, v107, v15, v111
    s_and_b64 exec, vcc, s[14:15]
    s_cbranch_execz K1_EX3
    buffer_store_dwordx4 v[32:35], v4, s[32:35], s10 offen sc1
K1_EX3:
    s_mov_b64 exec, -1
    s_add_u32 s10, s10, 2105344
    s_branch K1_EXTR
K1_OVF:
    v_lshrrev_b32 v72, 16, v112
    v_lshrrev_b32 v76, 18, v112
    v_sub_u32 v72, v72, v76
    v_lshrrev_b32 v73, 16, v113
    v_lshrrev_b32 v76, 18, v113
    v_sub_u32 v73, v73, v76
    v_lshrrev_b32 v74, 16, v114
    v_lshrrev_b32 v76, 18, v114
    v_sub_u32 v74, v74, v76
    v_lshrrev_b32 v75, 16, v115
    v_lshrrev_b32 v76, 18, v115
    v_sub_u32 v75, v75, v76
    v_add_u32 v77, v72, v73
    v_add_u32 v78, v77, v74
    v_add_u32 v79, v78, v75
    v_mov_b32 v1, v79
    s_nop 1
    v_add_u32_dpp v1, v1, v1 row_shr:1 row_mask:0xf bank_mask:0xf bound_ctrl:0
    s_nop 1
    v_add_u32_dpp v1, v1, v1 row_shr:2 row_mask:0xf bank_mask:0xf bound_ctrl:0
    s_nop 1
    v_add_u32_dpp v1, v1, v1 row_shr:4 row_mask:0xf bank_mask:0xf bound_ctrl:0
    s_nop 1
    v_add_u32_dpp v1, v1, v1 row_shr:8 row_mask:0xf bank_mask:0xf bound_ctrl:0
    s_nop 1
    v_add_u32_dpp v1, v1, v1 row_bcast:15 row_mask:0xa bank_mask:0xf
    s_nop 1
    v_add_u32_dpp v1, v1, v1 row_bcast:31 row_mask:0xc bank_mask:0xf
    s_nop 0
    v_sub_u32 v76, v1, v79
    v_add_u32 v79, v76, v78
    v_add_u32 v78, v76, v77
    v_add_u32 v77, v76, v72
    v_lshl_or_b32 v76, v72, 16, v76
    v_lshl_or_b32 v77, v73, 16, v77
    v_lshl_or_b32 v78, v74, 16, v78
    v_lshl_or_b32 v79, v75, 16, v79
    s_waitcnt lgkmcnt(0)
    ds_write_b128 v172, v[76:79] offset:52736
    v_min_u32 v108, 255, v108
    v_min_u32 v109, 255, v109
    v_min_u32 v110, 255, v110
    v_min_u32 v111, 255, v111
    s_lshl_b32 s15, s12, 2
    s_add_u32 s15, s15, 23068672
    s_add_u32 s64, s8, s15
    s_addc_u32 s65, s9, 0
    s_mov_b32 s66, 262144
    s_mov_b32 s67, 0x20000
    v_lshlrev_b32 v1, 12, v254
    buffer_store_dword v76, v1, s[64:67], 0 offen offset:0 sc1
    buffer_store_dword v77, v1, s[64:67], 0 offen offset:1024 sc1
    buffer_store_dword v78, v1, s[64:67], 0 offen offset:2048 sc1
    buffer_store_dword v79, v1, s[64:67], 0 offen offset:3072 sc1
    s_add_u32 s15, s13, 17825792
    s_add_u32 s64, s8, s15
    s_addc_u32 s65, s9, 0
    s_mov_b32 s66, 12500
    s_mov_b32 s67, 0x20000
    s_lshr_b32 s15, s13, 2
    s_add_u32 s15, s15, 22020096
    s_add_u32 s68, s8, s15
    s_addc_u32 s69, s9, 0
    s_mov_b32 s70, 3125
    s_mov_b32 s71, 0x20000
    v_cndmask_b32 v30, v24, v30, s[78:79]
    v_cndmask_b32 v38, 0, v38, s[78:79]
    ds_read_u16 v40, v24 offset:50736
    ds_read_u16 v41, v25 offset:50736
    ds_read_u16 v42, v26 offset:50736
    ds_read_u16 v43, v27 offset:50736
    ds_read_u16 v44, v28 offset:50736
    ds_read_u16 v45, v29 offset:50736
    ds_read_u16 v46, v30 offset:50736
    s_waitcnt lgkmcnt(0)
    v_lshrrev_b32 v1, 2, v32
    v_sub_u32 v1, v32, v1
    v_add_u32 v40, v40, v1
    v_cmp_le_u32 vcc, 48, v32
    v_lshlrev_b32 v48, 2, v40
    s_and_saveexec_b64 s[14:15], vcc
    s_cbranch_execz K1_OV3_0
    buffer_store_byte v23, v40, s[68:71], 0 offen sc1
    buffer_store_dword v16, v48, s[64:67], 0 offen sc1
K1_OV3_0:
    s_mov_b64 exec, -1
    v_lshrrev_b32 v1, 2, v33
    v_sub_u32 v1, v33, v1
    v_add_u32 v41, v41, v1
    v_cmp_le_u32 vcc, 48, v33
    v_lshlrev_b32 v49, 2, v41
    s_and_saveexec_b64 s[14:15], vcc
    s_cbranch_execz K1_OV3_1
    buffer_store_byte v23, v41, s[68:71], 0 offen sc1
    buffer_store_dword v17, v49, s[64:67], 0 offen sc1
K1_OV3_1:
    s_mov_b64 exec, -1
    v_lshrrev_b32 v1, 2, v34
    v_sub_u32 v1, v34, v1
    v_add_u32 v42, v42, v1
    v_cmp_le_u32 vcc, 48, v34
    v_lshlrev_b32 v50, 2, v42
    s_and_saveexec_b64 s[14:15], vcc
    s_cbranch_execz K1_OV3_2
    buffer_store_byte v23, v42, s[68:71], 0 offen sc1
    buffer_store_dword v18, v50, s[64:67], 0 offen sc1
K1_OV3_2:
    s_mov_b64 exec, -1
    v_lshrrev_b32 v1, 2, v35
    v_sub_u32 v1, v35, v1
    v_add_u32 v43, v43, v1
    v_cmp_le_u32 vcc, 48, v35
    v_lshlrev_b32 v51, 2, v43
    s_and_saveexec_b64 s[14:15], vcc
    s_cbranch_execz K1_OV3_3
    buffer_store_byte v23, v43, s[68:71], 0 offen sc1
    buffer_store_dword v19, v51, s[64:67], 0 offen sc1
K1_OV3_3:
    s_mov_b64 exec, -1
    v_lshrrev_b32 v1, 2, v36
    v_sub_u32 v1, v36, v1
    v_add_u32 v44, v44, v1
    v_cmp_le_u32 vcc, 48, v36
    v_lshlrev_b32 v52, 2, v44
    s_and_saveexec_b64 s[14:15], vcc
    s_cbranch_execz K1_OV3_4
    buffer_store_byte v31, v44, s[68:71], 0 offen sc1
    buffer_store_dword v20, v52, s[64:67], 0 offen sc1
K1_OV3_4:
    s_mov_b64 exec, -1
    v_lshrrev_b32 v1, 2, v37
    v_sub_u32 v1, v37, v1
    v_add_u32 v45, v45, v1
    v_cmp_le_u32 vcc, 48, v37
    v_lshlrev_b32 v53, 2, v45
    s_and_saveexec_b64 s[14:15], vcc
    s_cbranch_execz K1_OV3_5
    buffer_store_byte v31, v45, s[68:71], 0 offen sc1
    buffer_store_dword v21, v53, s[64:67], 0 offen sc1
K1_OV3_5:
    s_mov_b64 exec, -1
    v_lshrrev_b32 v1, 2, v38
    v_sub_u32 v1, v38, v1
    v_add_u32 v46, v46, v1
    v_cmp_le_u32 vcc, 48, v38
    v_lshlrev_b32 v54, 2, v46
    s_and_saveexec_b64 s[14:15], vcc
    s_cbranch_execz K1_OV3_6
    buffer_store_byte v39, v46, s[68:71], 0 offen sc1
    buffer_store_dword v22, v54, s[64:67], 0 offen sc1
K1_OV3_6:
    s_mov_b64 exec, -1
    s_waitcnt vmcnt(0)
    s_barrier
    s_branch K1_OUT
K2_XT1:
    s_mov_b32 s97, 1
    v_cmp_le_u32 vcc, 822083584, v188
    v_mov_b32 v166, 2180
    s_cbranch_vccz K2_XT1A
    ds_write_b32 v166, v171
K2_XT1A:
    s_mov_b32 s10, 0xf0f0f0f0
    s_mov_b32 s11, s10
    v_and_b32 v166, 12, v168
    v_add_u32 v166, 32, v166
    v_and_b32 v164, 64, v189
    v_mul_u32_u24 v164, 127, v164
    v_add_u32 v164, v164, v189
    v_add_u32 v165, 16384, v164
    v_mov_b32 v167, 0x7ffffff0
    v_cndmask_b32 v204, v91, v95, s[10:11]
    v_cndmask_b32 v206, v208, v209, s[10:11]
    v_cmp_le_u32 vcc, 553648128, v204
    v_sub_u32_sdwa v204, v204, v166 dst_sel:DWORD dst_unused:UNUSED_PAD src0_sel:BYTE_3 src1_sel:DWORD
    s_nop 0
    v_cndmask_b32 v164, v167, v164, vcc
    v_cndmask_b32 v205, v99, v103, s[10:11]
    v_cndmask_b32 v207, v210, v211, s[10:11]
    v_cmp_le_u32 vcc, 553648128, v205
    v_sub_u32_sdwa v205, v205, v166 dst_sel:DWORD dst_unused:UNUSED_PAD src0_sel:BYTE_3 src1_sel:DWORD
    s_nop 0
    v_cndmask_b32 v165, v167, v165, vcc
    s_add_u32 s32, s32, 8421376
    s_addc_u32 s33, s33, 0
    buffer_load_dwordx4 v[132:135], v164, s[32:35], 0 offen sc1
    buffer_load_dwordx4 v[136:139], v165, s[32:35], 0 offen sc1
    v_med3_i32 v166, v204, 0, 3
    v_med3_i32 v167, v205, 0, 3
    v_add_u32 v166, v166, v167
    v_mov_b32 v167, 2176
    v_cmpx_lt_u32 vcc, 0, v166
    ds_add_u32 v167, v166
    s_mov_b64 exec, -1
    s_branch K2_XT1R
K2_XT2:
K2_XVa:
    s_mov_b64 s[10:11], 0
    v_bitop3_b32 v166, v135, s36, v214 bitop3:0x28
    v_cmp_ne_u32 s[86:87], 0, v166
    v_cmp_gt_u32 vcc, 0x7ffffff0, v164
    s_and_b64 vcc, vcc, s[86:87]
    s_or_b64 s[10:11], s[10:11], vcc
    v_bitop3_b32 v166, v139, s36, v214 bitop3:0x28
    v_cmp_ne_u32 s[86:87], 0, v166
    v_cmp_gt_u32 vcc, 0x7ffffff0, v165
    s_and_b64 vcc, vcc, s[86:87]
    s_or_b64 s[10:11], s[10:11], vcc
    s_cbranch_scc0 K2_XWa
    s_sub_u32 s101, s101, 1
    s_cbranch_scc1 K2_END
    buffer_load_dwordx4 v[132:135], v164, s[32:35], 0 offen sc1
    buffer_load_dwordx4 v[136:139], v165, s[32:35], 0 offen sc1
    s_waitcnt vmcnt(0)
    s_branch K2_XVa
K2_XWa:
    v_and_b32 v140, 255, v132
    v_lshlrev_b32 v140, 2, v140
    ds_read_b32 v140, v140 offset:6400
    v_and_b32 v141, 255, v133
    v_lshlrev_b32 v141, 2, v141
    ds_read_b32 v141, v141 offset:6400
    v_and_b32 v142, 255, v134
    v_lshlrev_b32 v142, 2, v142
    ds_read_b32 v142, v142 offset:6400
    v_and_b32 v135, 0x0f0f0f, v135
    v_and_b32 v143, 255, v136
    v_lshlrev_b32 v143, 2, v143
    ds_read_b32 v143, v143 offset:6400
    v_and_b32 v144, 255, v137
    v_lshlrev_b32 v144, 2, v144
    ds_read_b32 v144, v144 offset:6400
    v_and_b32 v145, 255, v138
    v_lshlrev_b32 v145, 2, v145
    ds_read_b32 v145, v145 offset:6400
    v_and_b32 v139, 0x0f0f0f, v139
    s_waitcnt lgkmcnt(0)
    v_perm_b32 v146, v135, v132, s64
    v_lshl_add_u32 v146, v146, 5, v206
    v_cmpx_lt_i32 vcc, 0, v204
    ds_add_rtn_u32 v140, v140, v171 offset:2112
    s_mov_b64 exec, -1
    v_perm_b32 v147, v135, v133, s65
    v_lshl_add_u32 v147, v147, 5, v206
    v_cmpx_lt_i32 vcc, 1, v204
    ds_add_rtn_u32 v141, v141, v171 offset:2112
    s_mov_b64 exec, -1
    v_perm_b32 v148, v135, v134, s66
    v_lshl_add_u32 v148, v148, 5, v206
    v_cmpx_lt_i32 vcc, 2, v204
    ds_add_rtn_u32 v142, v142, v171 offset:2112
    s_mov_b64 exec, -1
    v_perm_b32 v149, v139, v136, s64
    v_lshl_add_u32 v149, v149, 5, v207
    v_cmpx_lt_i32 vcc, 0, v205
    ds_add_rtn_u32 v143, v143, v171 offset:2112
    s_mov_b64 exec, -1
    v_perm_b32 v150, v139, v137, s65
    v_lshl_add_u32 v150, v150, 5, v207
    v_cmpx_lt_i32 vcc, 1, v205
    ds_add_rtn_u32 v144, v144, v171 offset:2112
    s_mov_b64 exec, -1
    v_perm_b32 v151, v139, v138, s66
    v_lshl_add_u32 v151, v151, 5, v207
    v_cmpx_lt_i32 vcc, 2, v205
    ds_add_rtn_u32 v145, v145, v171 offset:2112
    s_mov_b64 exec, -1
    s_waitcnt lgkmcnt(0)
    v_cmpx_lt_i32 vcc, 0, v204
    ds_write2st64_b32 v140, v132, v146 offset0:0 offset1:84
    s_mov_b64 exec, -1
    v_cmpx_lt_i32 vcc, 1, v204
    ds_write2st64_b32 v141, v133, v147 offset0:0 offset1:84
    s_mov_b64 exec, -1
    v_cmpx_lt_i32 vcc, 2, v204
    ds_write2st64_b32 v142, v134, v148 offset0:0 offset1:84
    s_mov_b64 exec, -1
    v_cmpx_lt_i32 vcc, 0, v205
    ds_write2st64_b32 v143, v136, v149 offset0:0 offset1:84
    s_mov_b64 exec, -1
    v_cmpx_lt_i32 vcc, 1, v205
    ds_write2st64_b32 v144, v137, v150 offset0:0 offset1:84
    s_mov_b64 exec, -1
    v_cmpx_lt_i32 vcc, 2, v205
    ds_write2st64_b32 v145, v138, v151 offset0:0 offset1:84
    s_mov_b64 exec, -1
    s_waitcnt lgkmcnt(0)
    s_branch K2_XT2R
K2_OVF:
    s_mov_b32 s80, 1
    s_mov_b32 s83, 0
    s_mov_b32 s77, 0
    s_mov_b32 s15, s76
    v_mov_b32 v190, 0xffff0000
    v_or_b32 v189, s39, v190
    v_mov_b32 v190, 0x7fffff00
    v_lshl_add_u32 v188, v254, 2, s15
    s_sub_u32 s73, s15, s76
    ds_write2st64_b32 v188, v189, v190 offset0:0 offset1:84
    ds_write2st64_b32 v188, v189, v190 offset0:1 offset1:85
    s_add_u32 s73, s73, 127
    s_lshr_b32 s73, s73, 7
    s_sub_i32 s38, s73, 1
    s_cmp_eq_u32 s97, 0
    s_cbranch_scc1 K2_PADS0
    s_mov_b32 s97, 0
    s_waitcnt vmcnt(0)
K2_XVb:
    s_mov_b64 s[10:11], 0
    v_bitop3_b32 v166, v135, s36, v214 bitop3:0x28
    v_cmp_ne_u32 s[86:87], 0, v166
    v_cmp_gt_u32 vcc, 0x7ffffff0, v164
    s_and_b64 vcc, vcc, s[86:87]
    s_or_b64 s[10:11], s[10:11], vcc
    v_bitop3_b32 v166, v139, s36, v214 bitop3:0x28
    v_cmp_ne_u32 s[86:87], 0, v166
    v_cmp_gt_u32 vcc, 0x7ffffff0, v165
    s_and_b64 vcc, vcc, s[86:87]
    s_or_b64 s[10:11], s[10:11], vcc
    s_cbranch_scc0 K2_XWb
    s_sub_u32 s101, s101, 1
    s_cbranch_scc1 K2_END
    buffer_load_dwordx4 v[132:135], v164, s[32:35], 0 offen sc1
    buffer_load_dwordx4 v[136:139], v165, s[32:35], 0 offen sc1
    s_waitcnt vmcnt(0)
    s_branch K2_XVb
K2_XWb:
    s_branch K2_PADS0
K2_SLOW:
    s_add_u32 s81, s81, 448
    s_cmp_lt_u32 s81, s82
    s_cbranch_scc1 K2_BATCH
K2_FIND:
    s_cmp_lg_u64 s[84:85], 0
    s_cbranch_scc1 K2_GOT
    s_add_u32 s79, s79, 1
    s_cmp_ge_u32 s79, 4
    s_cbranch_scc1 K2_EPI
    s_mul_i32 s10, s12, 32896
    s_lshl_b32 s11, s79, 13
    s_add_u32 s10, s10, s11
    v_lshlrev_b32 v252, 7, v254
    buffer_load_ubyte v252, v252, s[24:27], s10 offen offset:15 sc1
    s_waitcnt vmcnt(0)
    v_cmp_lt_u32 s[84:85], s77, v252
    s_nop 3
    s_branch K2_FIND
K2_GOT:
    s_ff1_i32_b64 s10, s[84:85]
    s_bitset0_b64 s[84:85], s10
    s_lshl_b32 s11, s79, 6
    s_add_u32 s80, s10, s11
    s_mul_i32 s10, s12, 32896
    s_lshl_b32 s11, s80, 7
    s_add_u32 s10, s10, s11
    s_lshl_b32 s11, s12, 8
    s_add_u32 s11, s11, s80
    s_lshl_b32 s11, s11, 2
    s_add_u32 s11, s11, 23068672
    v_mov_b32 v188, 0
    buffer_load_ubyte v189, v188, s[24:27], s10 offen offset:15 sc1
    buffer_load_dword v190, v188, s[24:27], s11 offen sc1
    s_waitcnt vmcnt(0)
    v_readfirstlane_b32 s10, v189
    v_readfirstlane_b32 s11, v190
    s_nop 3
    s_and_b32 s83, s11, 0xffff
    s_lshr_b32 s11, s11, 16
    s_lshr_b32 s82, s10, 2
    s_sub_u32 s82, s10, s82
    s_cmp_gt_u32 s10, 48
    s_cselect_b32 s82, s11, s82
    s_lshr_b32 s10, s77, 2
    s_sub_u32 s81, s77, s10
K2_BATCH:
    s_barrier
    v_and_b32 v188, 7, v254
    v_mul_u32_u24 v189, 2688, v188
    v_add_u32 v189, 9728, v189
    v_lshlrev_b32 v188, 2, v188
    ds_write_b32 v188, v189 offset:2112
    v_add_u32 v188, s81, v255
    s_mul_i32 s10, s12, 32896
    s_lshl_b32 s11, s80, 7
    s_add_u32 s10, s10, s11
    v_mul_u32_u24 v190, 87382, v188
    v_lshrrev_b32 v190, 16, v190
    v_lshl_add_u32 v189, v190, 2, s10
    v_add_u32 v191, 8421248, v189
    v_cmp_lt_u32 vcc, 31, v190
    s_mul_i32 s11, s80, 3125
    s_add_u32 s11, s11, s83
    v_cndmask_b32 v189, v189, v191, vcc
    v_or_b32 v191, 12, v189
    v_and_b32 v192, 3, v190
    v_add_u32 v191, v191, v192
    v_cmp_le_u32 vcc, 48, v190
    v_add_u32 v190, s11, v188
    v_add_u32 v192, 22020096, v190
    v_cndmask_b32 v191, v191, v192, vcc
    v_lshlrev_b32 v190, 2, v190
    v_add_u32 v190, 17825792, v190
    v_cndmask_b32 v189, v189, v190, vcc
    s_add_u32 s10, s81, 448
    s_min_u32 s10, s10, s82
    v_cmp_gt_u32 vcc, s10, v188
    v_mov_b32 v190, 0x7ffffff0
    s_mul_i32 s86, s80, 100000
    v_cndmask_b32 v189, v190, v189, vcc
    v_cndmask_b32 v191, v190, v191, vcc
    buffer_load_dword v189, v189, s[24:27], 0 offen sc1
    buffer_load_ubyte v191, v191, s[24:27], 0 offen sc1
    s_waitcnt lgkmcnt(0)
    s_barrier
    s_and_saveexec_b64 s[10:11], vcc
    s_waitcnt vmcnt(0)
    v_and_b32 v188, 255, v189
    v_lshlrev_b32 v188, 2, v188
    ds_read_b32 v188, v188 offset:6400
    v_bfe_u32 v190, v189, 8, 8
    v_and_b32 v191, 15, v191
    v_lshl_or_b32 v191, v191, 8, v190
    v_mov_b32 v190, 4
    v_lshl_add_u32 v191, v191, 5, s86
    s_waitcnt lgkmcnt(0)
    ds_add_rtn_u32 v188, v188, v190 offset:2112
    s_waitcnt lgkmcnt(0)
    ds_write2st64_b32 v188, v189, v191 offset0:0 offset1:84
    s_mov_b64 exec, -1
    s_waitcnt lgkmcnt(0)
    s_barrier
    s_lshl_b32 s10, s3, 2
    v_mov_b32 v188, s10
    ds_read_b32 v188, v188 offset:2112
    v_mov_b32 v180, 0
    v_mov_b32 v181, 0
    v_mov_b32 v182, 0
    v_mov_b32 v183, 0
    v_mov_b32 v184, 0
    v_mov_b32 v185, 0
    v_mov_b32 v186, 0
    v_mov_b32 v187, 0
    v_lshrrev_b32 v189, 3, v254
    v_lshl_add_u32 v247, v189, 4, s76
    v_and_b32 v189, 31, v254
    v_lshl_add_u32 v249, v189, 2, s76
    v_lshrrev_b32 v190, 1, v254
    v_lshl_add_u32 v251, v190, 2, s76
    v_add_u32 v251, 21504, v251
    v_and_b32 v189, 44, v254
    v_add_u32 v248, s76, v189
    s_waitcnt lgkmcnt(0)
    v_readfirstlane_b32 s15, v188
    s_nop 3
    v_mov_b32 v190, 0xffff0000
    v_or_b32 v189, s39, v190
    v_mov_b32 v190, 0x7fffff00
    v_lshl_add_u32 v188, v254, 2, s15
    s_sub_u32 s73, s15, s76
    ds_write2st64_b32 v188, v189, v190 offset0:0 offset1:84
    ds_write2st64_b32 v188, v189, v190 offset0:1 offset1:85
    s_add_u32 s73, s73, 127
    s_lshr_b32 s73, s73, 7
    s_sub_i32 s38, s73, 1
K2_LAST:
    s_branch K2_GO
.section .rodata,"a"
.p2align 6
.amdhsa_kernel standalone__edge_featured_mpnn_gatedgcn__graph_kernel
  .amdhsa_next_free_vgpr 256
  .amdhsa_next_free_sgpr 102
  .amdhsa_accum_offset 256
  .amdhsa_group_segment_fixed_size 0
  .amdhsa_kernarg_size 96
  .amdhsa_user_sgpr_count 2
  .amdhsa_user_sgpr_kernarg_segment_ptr 1
  .amdhsa_system_sgpr_workgroup_id_x 1
.end_amdhsa_kernel
```

```asm
; @launch grid=(256,1,1) block=(512,1,1) lds=157696
.amdgcn_target "amdgcn-amd-amdhsa--gfx950"
.text
.globl standalone__edge_featured_mpnn_gatedgcn__graph_kernel
.p2align 8
.type standalone__edge_featured_mpnn_gatedgcn__graph_kernel,@function
standalone__edge_featured_mpnn_gatedgcn__graph_kernel:
    s_cmp_ge_u32 s2, 256
    s_cbranch_scc1 K2_END
    s_load_dwordx4 s[44:47], s[0:1], 16
    s_load_dwordx2 s[8:9], s[0:1], 88
    s_load_dwordx4 s[40:43], s[0:1], 0
    s_load_dwordx8 s[48:55], s[0:1], 32
    s_load_dwordx4 s[56:59], s[0:1], 64
    s_getpc_b64 s[86:87]
K2_PC:
    v_lshlrev_b32 v252, 7, v0
    v_min_u32 v252, K2_LAST-K2_PC, v252
    v_cmp_gt_u32 vcc, 192, v0
    s_cbranch_vccz K2_NOCPF
    global_load_dword v253, v252, s[86:87]
K2_NOCPF:
    v_mov_b32 v255, v0
    v_lshrrev_b32 v188, 6, v0
    v_and_b32 v254, 63, v0
    v_readfirstlane_b32 s7, v188
    s_and_b32 s10, s2, 7
    s_lshr_b32 s11, s2, 3
    s_lshl_b32 s10, s10, 5
    s_add_u32 s12, s10, s11
    s_mul_i32 s13, s12, 12500
    v_lshlrev_b32 v189, 4, v0
    v_lshlrev_b32 v1, 3, v0
    v_lshlrev_b32 v2, 2, v0
    v_mov_b32 v3, 0
    v_and_b32 v4, 0x3fc, v2
    ds_write_b32 v4, v3 offset:6400
    s_and_b32 s10, s7, 3
    s_lshr_b32 s3, s7, 2
    s_lshl1_add_u32 s3, s10, s3
    s_xor_b32 s3, s3, 1
    s_movk_i32 s14, 8192
    s_movk_i32 s15, 12288
    s_waitcnt lgkmcnt(0)
    s_add_u32 s64, s46, s13
    s_addc_u32 s65, s47, 0
    s_mov_b32 s66, 12500
    s_mov_b32 s67, 0x20000
    s_add_u32 s68, s44, s13
    s_addc_u32 s69, s45, 0
    s_mov_b32 s70, 12500
    s_mov_b32 s71, 0x20000
    buffer_load_dwordx4 v[8:11], v189, s[64:67], 0 offen nt
    buffer_load_dwordx2 v[12:13], v1, s[64:67], s14 offen nt
    buffer_load_dword v14, v2, s[64:67], s15 offen nt
    s_barrier
    buffer_load_dwordx4 v[16:19], v189, s[68:71], 0 offen nt
    buffer_load_dwordx2 v[20:21], v1, s[68:71], s14 offen nt
    buffer_load_dword v22, v2, s[68:71], s15 offen nt
    s_add_u32 s10, s8, 24117248
    s_addc_u32 s11, s9, 0
    s_load_dword s100, s[10:11], 0
    v_lshrrev_b32 v1, 3, v0
    v_lshlrev_b32 v170, 2, v1
    v_and_b32 v197, 7, v0
    v_and_b32 v5, 16, v0
    v_lshlrev_b32 v5, 1, v5
    v_xor_b32 v5, v5, v189
    v_lshlrev_b32 v172, 4, v254
    v_and_b32 v241, 16, v254
    v_lshlrev_b32 v241, 2, v241
    v_xor_b32 v234, v241, v172
    v_and_b32 v241, 0x70, v234
    s_mov_b32 s16, s40
    s_mov_b32 s17, s41
    s_mov_b32 s18, 6400000
    s_mov_b32 s19, 0x20000
    s_mov_b32 s60, 85599
    s_mov_b32 s61, 4294967100
    s_movk_i32 s62, 2000
    v_mov_b32 v7, 87382
    s_mov_b32 s10, 0
    v_lshl_add_u32 v56, v254, 10, s10
    v_add_u32 v57, 256, v56
    v_add_u32 v58, 512, v56
    v_add_u32 v59, 768, v56
    v_and_b32 v60, 127, v255
    v_lshl_add_u32 v60, v60, 9, s10
    v_add_u32 v61, 256, v60
    v_lshl_add_u32 v62, v254, 8, s10
    v_lshrrev_b32 v23, 6, v255
    v_lshrrev_b32 v31, 7, v255
    v_add_u32 v31, 8, v31
    v_mov_b32 v39, 12
    v_cmp_gt_u32 s[78:79], 53, v255
    s_mov_b32 s11, 32896
    v_lshlrev_b32 v3, 4, v197
    v_mad_u32_u24 v4, v1, s11, v3
    v_mul_u32_u24 v6, 52, v1
    v_lshl_add_u32 v6, v197, 2, v6
    v_lshlrev_b32 v3, 2, v6
    v_add_u32 v3, 104448, v3
    v_add_u32 v6, 91136, v6
    v_mov_b32 v214, 0xf0f0f0
    v_mov_b32 v15, 0x0f0f0f
    s_waitcnt vmcnt(3)
    v_mul_u32_u24 v48, s60, v8
    v_mul_u32_u24 v49, s60, v9
    v_mul_u32_u24 v50, s60, v10
    v_mul_u32_u24 v51, s60, v11
    v_mul_u32_u24 v52, s60, v12
    v_mul_u32_u24 v53, s60, v13
    v_lshrrev_b32 v48, 24, v48
    v_lshrrev_b32 v49, 24, v49
    v_lshrrev_b32 v50, 24, v50
    v_lshrrev_b32 v51, 24, v51
    v_lshrrev_b32 v52, 24, v52
    v_lshrrev_b32 v53, 24, v53
    v_lshl_add_u32 v24, v48, 2, s62
    ds_add_rtn_u32 v32, v24, v7 offset:4400
    v_lshl_add_u32 v25, v49, 2, s62
    ds_add_rtn_u32 v33, v25, v7 offset:4400
    v_lshl_add_u32 v26, v50, 2, s62
    ds_add_rtn_u32 v34, v26, v7 offset:4400
    v_lshl_add_u32 v27, v51, 2, s62
    ds_add_rtn_u32 v35, v27, v7 offset:4400
    v_lshl_add_u32 v28, v52, 2, s62
    ds_add_rtn_u32 v36, v28, v7 offset:4400
    v_lshl_add_u32 v29, v53, 2, s62
    ds_add_rtn_u32 v37, v29, v7 offset:4400
    v_mad_i32_i24 v8, v48, s61, v8
    v_or_b32 v8, v8, v56
    v_mad_i32_i24 v9, v49, s61, v9
    v_or_b32 v9, v9, v57
    v_mad_i32_i24 v10, v50, s61, v10
    v_or_b32 v10, v10, v58
    v_mad_i32_i24 v11, v51, s61, v11
    v_or_b32 v11, v11, v59
    v_mad_i32_i24 v12, v52, s61, v12
    v_or_b32 v12, v12, v60
    v_mad_i32_i24 v13, v53, s61, v13
    v_or_b32 v13, v13, v61
    s_waitcnt lgkmcnt(5)
    v_lshrrev_b32 v32, 16, v32
    v_min_u32 v40, 48, v32
    v_mad_u32_u24 v40, v24, 13, v40
    v_lshlrev_b32 v48, 2, v40
    ds_write_b8 v40, v23 offset:65136
    s_waitcnt lgkmcnt(5)
    v_lshrrev_b32 v33, 16, v33
    v_min_u32 v41, 48, v33
    v_mad_u32_u24 v41, v25, 13, v41
    v_lshlrev_b32 v49, 2, v41
    ds_write_b8 v41, v23 offset:65136
    s_waitcnt lgkmcnt(5)
    v_lshrrev_b32 v34, 16, v34
    v_min_u32 v42, 48, v34
    v_mad_u32_u24 v42, v26, 13, v42
    v_lshlrev_b32 v50, 2, v42
    ds_write_b8 v42, v23 offset:65136
    s_waitcnt lgkmcnt(5)
    v_lshrrev_b32 v35, 16, v35
    v_min_u32 v43, 48, v35
    v_mad_u32_u24 v43, v27, 13, v43
    v_lshlrev_b32 v51, 2, v43
    ds_write_b8 v43, v23 offset:65136
    s_waitcnt lgkmcnt(5)
    v_lshrrev_b32 v36, 16, v36
    v_min_u32 v44, 48, v36
    v_mad_u32_u24 v44, v28, 13, v44
    v_lshlrev_b32 v52, 2, v44
    ds_write_b8 v44, v31 offset:65136
    s_waitcnt lgkmcnt(5)
    v_lshrrev_b32 v37, 16, v37
    v_min_u32 v45, 48, v37
    v_mad_u32_u24 v45, v29, 13, v45
    v_lshlrev_b32 v53, 2, v45
    ds_write_b8 v45, v31 offset:65136
    s_cmp_lg_u32 s7, 0
    s_cbranch_scc1 K1_NO7
    s_mov_b64 exec, s[78:79]
    s_waitcnt lgkmcnt(0)
    v_mul_u32_u24 v54, s60, v14
    v_lshrrev_b32 v54, 24, v54
    v_lshl_add_u32 v30, v54, 2, s62
    ds_add_rtn_u32 v38, v30, v7 offset:4400
    v_mad_i32_i24 v14, v54, s61, v14
    v_or_b32 v14, v14, v62
    s_waitcnt lgkmcnt(0)
    v_lshrrev_b32 v38, 16, v38
    v_min_u32 v46, 48, v38
    v_mad_u32_u24 v46, v30, 13, v46
    v_lshlrev_b32 v54, 2, v46
    ds_write_b8 v46, v39 offset:65136
    s_waitcnt vmcnt(0)
    v_lshl_add_u32 v22, v22, 16, v14
    ds_write_b32 v54, v22 offset:448
    s_mov_b64 exec, -1
K1_NO7:
    s_mov_b32 s64, s50
    s_mov_b32 s65, s51
    s_mov_b32 s66, 8192
    s_mov_b32 s67, 0x20000
    buffer_load_dwordx4 v[64:67], v5, s[64:67], 0 offen
    s_mov_b32 s68, s52
    s_mov_b32 s69, s53
    s_mov_b32 s70, 2048
    s_mov_b32 s71, 0x20000
    buffer_load_dwordx4 v[68:71], v5, s[68:71], 0 offen
    s_lshl_b32 s10, s7, 10
    s_mov_b32 s64, s48
    s_mov_b32 s65, s49
    s_add_u32 m0, s10, 34304
    s_nop 0
    buffer_load_dwordx4 v5, s[64:67], 0 offen lds
    s_mov_b32 s64, s56
    s_mov_b32 s65, s57
    s_add_u32 m0, s10, 26112
    s_nop 0
    buffer_load_dwordx4 v5, s[64:67], 0 offen lds
    s_mov_b32 s64, s54
    s_mov_b32 s65, s55
    s_add_u32 m0, s10, 9728
    s_nop 0
    buffer_load_dwordx4 v5, s[64:67], 0 offen lds
    s_waitcnt vmcnt(5)
    v_lshl_add_u32 v16, v16, 16, v8
    ds_write_b32 v48, v16 offset:448
    v_lshl_add_u32 v17, v17, 16, v9
    ds_write_b32 v49, v17 offset:448
    v_lshl_add_u32 v18, v18, 16, v10
    ds_write_b32 v50, v18 offset:448
    v_lshl_add_u32 v19, v19, 16, v11
    ds_write_b32 v51, v19 offset:448
    v_lshl_add_u32 v20, v20, 16, v12
    ds_write_b32 v52, v20 offset:448
    v_lshl_add_u32 v21, v21, 16, v13
    ds_write_b32 v53, v21 offset:448
    s_lshl_b32 s15, s12, 7
    s_add_u32 s32, s8, s15
    s_addc_u32 s33, s9, 0
    s_mov_b32 s34, 16809984
    s_mov_b32 s35, 0x20000
    s_waitcnt lgkmcnt(0)
    s_add_u32 s100, s100, 1
    s_and_b32 s10, s100, 15
    s_and_b32 s11, s100, 0xf0
    s_mul_i32 s36, s10, 0x1010
    s_lshl_b32 s11, s11, 16
    s_xor_b32 s36, s36, 0xf000
    s_or_b32 s36, s36, s11
    s_mov_b32 s101, 300000
    s_barrier
    ds_read_b128 v[112:115], v172 offset:6400
    ds_read_u16 v108, v170 offset:6402
    ds_read_b32 v104, v6 offset:0
    ds_read_b128 v[88:91], v3 offset:0
    ds_read_u16 v109, v170 offset:6658
    ds_read_b32 v105, v6 offset:3328
    ds_read_b128 v[92:95], v3 offset:13312
    ds_read_u16 v110, v170 offset:6914
    ds_read_b32 v106, v6 offset:6656
    ds_read_b128 v[96:99], v3 offset:26624
    ds_read_u16 v111, v170 offset:7170
    ds_read_b32 v107, v6 offset:9984
    ds_read_b128 v[100:103], v3 offset:39936
    s_waitcnt lgkmcnt(12)
    v_max3_u32 v1, v112, v113, v114
    v_max_u32 v1, v1, v115
    v_cmp_le_u32 vcc, 3211264, v1
    s_mov_b32 s10, 0
    s_cbranch_vccnz K1_OVF
K1_OUT:
    s_waitcnt lgkmcnt(9)
    v_lshl_or_b32 v108, v108, 24, s36
    v_and_or_b32 v91, v104, v15, v108
    buffer_store_dwordx4 v[88:91], v4, s[32:35], s10 offen sc1
    s_add_u32 s10, s10, 2105344
    s_waitcnt lgkmcnt(6)
    v_lshl_or_b32 v109, v109, 24, s36
    v_and_or_b32 v95, v105, v15, v109
    buffer_store_dwordx4 v[92:95], v4, s[32:35], s10 offen sc1
    s_add_u32 s10, s10, 2105344
    s_waitcnt lgkmcnt(3)
    v_lshl_or_b32 v110, v110, 24, s36
    v_and_or_b32 v99, v106, v15, v110
    buffer_store_dwordx4 v[96:99], v4, s[32:35], s10 offen sc1
    s_add_u32 s10, s10, 2105344
    s_waitcnt lgkmcnt(0)
    v_lshl_or_b32 v111, v111, 24, s36
    v_and_or_b32 v103, v107, v15, v111
    buffer_store_dwordx4 v[100:103], v4, s[32:35], s10 offen sc1
    s_add_u32 s10, s10, 2105344
    v_max3_u32 v1, v108, v109, v110
    v_max_u32 v1, v1, v111
    v_cmp_le_u32 vcc, 553648128, v1
    s_cbranch_vccnz K1_EXT
K1_EXTR:
    s_lshr_b32 s10, s3, 1
    s_mul_i32 s10, s10, 49
    s_bitcmp1_b32 s3, 0
    s_cselect_b32 s72, 20, -4
    s_cselect_b32 s73, 28, 3
    s_cselect_b32 s84, 45, 20
    s_add_i32 s72, s72, s10
    s_add_i32 s73, s73, s10
    s_add_i32 s84, s84, s10
    s_add_i32 s85, s72, 32
    s_max_i32 s96, s72, 0
    s_cmp_eq_u32 s3, 7
    s_cselect_b32 s84, 196, s84
    s_cselect_b32 s85, 196, s85
    v_lshrrev_b32 v193, 5, v254
    s_mov_b32 s20, s42
    s_mov_b32 s21, s43
    s_mov_b32 s22, 25600000
    s_mov_b32 s23, 0x20000
    s_mov_b32 s28, s58
    s_mov_b32 s29, s59
    s_mov_b32 s30, 6400000
    s_mov_b32 s31, 0x20000
    s_mov_b32 s24, s8
    s_mov_b32 s25, s9
    s_mov_b32 s26, 24117376
    s_mov_b32 s27, 0x20000
    v_lshrrev_b32 v194, 5, v255
    v_and_b32 v195, 15, v255
    v_cmp_eq_u32 vcc, v194, v195
    v_and_b32 v194, 16, v255
    v_mov_b32 v195, 0x3f80
    v_lshlrev_b32 v195, v194, v195
    v_cndmask_b32 v195, 0, v195, vcc
    v_lshlrev_b32 v194, 2, v255
    v_mov_b32 v196, 0
    ds_write_b32 v194, v195
    v_bfe_u32 v195, v255, 3, 1
    v_and_b32 v201, 7, v255
    v_lshl_add_u32 v195, v195, 2, v201
    v_lshrrev_b32 v200, 6, v255
    v_cmp_eq_u32 vcc, v195, v200
    v_bfe_u32 v200, v255, 4, 2
    v_mov_b32 v195, 0x3f80
    v_cndmask_b32 v195, 0, v195, vcc
    v_cmp_lt_u32 vcc, 3, v201
    v_mul_u32_u24 v200, 0x5555, v200
    v_and_b32 v201, 60, v194
    v_cndmask_b32 v195, v195, v200, vcc
    ds_write_b32 v194, v195 offset:7424
    ds_write_b32 v201, v196 offset:9472
    ds_write_b32 v194, v196 offset:2048
    ds_write2st64_b32 v194, v196, v196 offset0:9 offset1:17
    s_movk_i32 s75, 128
    s_mul_i32 s74, s3, 5184
    s_add_u32 s74, s74, 102400
    s_movk_i32 s77, 48
    s_add_u32 s39, s96, 32
    s_lshl_b32 s11, s96, 6
    s_mov_b32 s97, 0
    v_bfe_u32 v194, v254, 4, 1
    v_and_b32 v242, 1, v254
    v_lshlrev_b32 v242, 4, v242
    v_lshlrev_b32 v245, 5, v193
    v_subrev_u32 v245, s11, v245
    v_and_b32 v195, 3, v254
    v_lshlrev_b32 v195, 3, v195
    v_lshl_add_u32 v246, v194, 5, v195
    v_subrev_u32 v246, s11, v246
    v_mul_u32_u24 v196, 130, v195
    v_and_b32 v194, 28, v254
    v_lshl_add_u32 v196, v194, 5, v196
    v_bfe_u32 v194, v254, 3, 1
    v_xor_b32 v194, v194, v193
    v_lshl_add_u32 v196, v194, 6, v196
    v_add_u32 v243, s74, v196
    v_and_b32 v194, 31, v254
    v_lshl_add_u32 v194, v194, 1, v193
    v_lshl_add_u32 v244, v194, 4, s74
    v_add_u32 v244, 4160, v244
    s_mul_i32 s76, s3, 2688
    s_add_u32 s76, s76, 9728
    v_lshrrev_b32 v194, 3, v254
    v_lshl_add_u32 v247, v194, 4, s76
    v_and_b32 v194, 31, v254
    v_lshl_add_u32 v249, v194, 2, s76
    v_lshrrev_b32 v195, 1, v254
    v_lshl_add_u32 v251, v195, 2, s76
    v_add_u32 v251, 21504, v251
    v_and_b32 v194, 44, v254
    v_add_u32 v248, s76, v194
    s_mul_i32 s10, s7, 4160
    s_add_u32 s10, s10, 69120
    v_and_b32 v202, 31, v254
    v_bfe_u32 v194, v202, 1, 1
    v_xor_b32 v194, v194, v193
    v_lshlrev_b32 v194, 6, v194
    v_lshl_add_u32 v194, v202, 7, v194
    v_lshrrev_b32 v202, 3, v202
    v_lshl_add_u32 v202, v202, 4, v194
    v_add_u32 v202, s10, v202
    v_lshrrev_b32 v194, 1, v254
    v_xor_b32 v194, v194, v254
    v_and_b32 v194, 4, v194
    v_mul_u32_u24 v194, 3, v194
    v_xor_b32 v194, v194, v254
    v_and_b32 v235, 31, v194
    v_bfe_u32 v195, v235, 1, 1
    v_xor_b32 v195, v195, v193
    v_lshlrev_b32 v195, 6, v195
    v_lshl_add_u32 v195, v235, 7, v195
    v_lshrrev_b32 v235, 3, v235
    v_lshl_add_u32 v235, v235, 4, v195
    v_add_u32 v235, s10, v235
    v_mov_b32 v177, 0xdddd
    v_lshlrev_b32 v168, 2, v197
    v_mul_u32_u24 v208, 25000, v170
    v_add_u32 v209, 6400000, v208
    v_add_u32 v210, 12800000, v208
    v_add_u32 v211, 19200000, v208
    v_mov_b32 v171, 4
    v_mov_b32 v169, 1
    v_and_b32 v199, 31, v254
    v_add_u32 v199, s96, v199
    v_lshlrev_b32 v200, 4, v199
    v_lshl_add_u32 v200, v193, 3, v200
    v_mov_b64 v[180:181], 0
    v_mov_b64 v[182:183], 0
    v_mov_b64 v[184:185], 0
    v_mov_b64 v[186:187], 0
    s_lshl_b32 s15, s3, 2
    v_mov_b32 v212, s15
    v_lshlrev_b32 v213, 2, v199
    s_mul_i32 s10, s12, 32896
    s_add_u32 s32, s8, s10
    s_addc_u32 s33, s9, 0
    s_mov_b32 s34, 32768
    s_mov_b32 s35, 0x20000
    s_movk_i32 s79, 8192
    s_movk_i32 s80, 16384
    s_movk_i32 s81, 24576
    s_mov_b32 s10, 0xbfb8aa3b
    s_waitcnt vmcnt(7)
    v_lshlrev_b32 v72, 16, v64
    v_and_b32 v73, 0xffff0000, v64
    v_lshlrev_b32 v74, 16, v65
    v_and_b32 v75, 0xffff0000, v65
    v_lshlrev_b32 v76, 16, v66
    v_and_b32 v77, 0xffff0000, v66
    v_lshlrev_b32 v78, 16, v67
    v_and_b32 v79, 0xffff0000, v67
    v_lshlrev_b32 v80, 16, v68
    v_and_b32 v81, 0xffff0000, v68
    v_lshlrev_b32 v82, 16, v69
    v_and_b32 v83, 0xffff0000, v69
    v_lshlrev_b32 v84, 16, v70
    v_and_b32 v85, 0xffff0000, v70
    v_lshlrev_b32 v86, 16, v71
    v_and_b32 v87, 0xffff0000, v71
    v_mul_f32 v72, s10, v72
    v_mul_f32 v73, s10, v73
    v_mul_f32 v74, s10, v74
    v_mul_f32 v75, s10, v75
    v_mul_f32 v76, s10, v76
    v_mul_f32 v77, s10, v77
    v_mul_f32 v78, s10, v78
    v_mul_f32 v79, s10, v79
    v_mul_f32 v80, s10, v80
    v_mul_f32 v81, s10, v81
    v_mul_f32 v82, s10, v82
    v_mul_f32 v83, s10, v83
    v_mul_f32 v84, s10, v84
    v_mul_f32 v85, s10, v85
    v_mul_f32 v86, s10, v86
    v_mul_f32 v87, s10, v87
    v_cvt_pk_bf16_f32 v64, v72, v73
    v_cvt_pk_bf16_f32 v65, v74, v75
    v_cvt_pk_bf16_f32 v66, v76, v77
    v_cvt_pk_bf16_f32 v67, v78, v79
    v_cvt_pk_bf16_f32 v68, v80, v81
    v_cvt_pk_bf16_f32 v69, v82, v83
    v_cvt_pk_bf16_f32 v70, v84, v85
    v_cvt_pk_bf16_f32 v71, v86, v87
    ds_write_b128 v189, v[64:67] offset:17920
    s_cmp_ge_u32 s7, 2
    s_cbranch_scc1 K1_NOWC
    ds_write_b128 v189, v[68:71] offset:42496
K1_NOWC:
    v_bfe_u32 v173, v254, 2, 2
    v_lshlrev_b32 v173, 7, v173
    v_lshl_add_u32 v173, v242, 2, v173
    v_and_b32 v174, 16, v254
    v_and_b32 v175, 2, v254
    v_lshl_add_u32 v174, v175, 2, v174
    v_and_b32 v175, 8, v254
    v_lshl_add_u32 v174, v175, 2, v174
    v_add_u32 v173, v173, v174
    v_lshl_add_u32 v175, v193, 10, v173
    v_lshl_add_u32 v173, v193, 12, v173
    v_xor_b32 v174, 32, v173
    v_xor_b32 v176, 32, v175
    s_lshl_b32 s10, s7, 10
    s_and_b32 s11, s7, 4
    s_mul_i32 s11, s11, -1016
    s_add_u32 s11, s11, s10
    v_xor_b32 v252, s11, v173
    s_waitcnt vmcnt(0) lgkmcnt(0)
    s_barrier
    ds_read_b64_tr_b16 v[72:73], v252 offset:9728
    ds_read_b64_tr_b16 v[76:77], v252 offset:34304
    ds_read_b64_tr_b16 v[74:75], v252 offset:10240
    ds_read_b64_tr_b16 v[78:79], v252 offset:34816
    v_add_u32 v252, s10, v172
    ds_read_b64_tr_b16 v[0:1], v173 offset:17920
    ds_read_b64_tr_b16 v[2:3], v173 offset:18432
    ds_read_b64_tr_b16 v[4:5], v173 offset:18944
    ds_read_b64_tr_b16 v[6:7], v173 offset:19456
    ds_read_b64_tr_b16 v[8:9], v173 offset:19968
    ds_read_b64_tr_b16 v[10:11], v173 offset:20480
    ds_read_b64_tr_b16 v[12:13], v173 offset:20992
    ds_read_b64_tr_b16 v[14:15], v173 offset:21504
    s_waitcnt lgkmcnt(8)
    ds_write_b128 v252, v[72:75] offset:52736
    s_mov_b32 s10, 0xbfb8aa3b
    v_lshlrev_b32 v80, 16, v76
    v_and_b32 v81, 0xffff0000, v76
    v_lshlrev_b32 v82, 16, v77
    v_and_b32 v83, 0xffff0000, v77
    v_lshlrev_b32 v84, 16, v78
    v_and_b32 v85, 0xffff0000, v78
    v_lshlrev_b32 v86, 16, v79
    v_and_b32 v87, 0xffff0000, v79
    v_mul_f32 v80, s10, v80
    v_mul_f32 v81, s10, v81
    v_mul_f32 v82, s10, v82
    v_mul_f32 v83, s10, v83
    v_mul_f32 v84, s10, v84
    v_mul_f32 v85, s10, v85
    v_mul_f32 v86, s10, v86
    v_mul_f32 v87, s10, v87
    v_cvt_pk_bf16_f32 v76, v80, v81
    v_cvt_pk_bf16_f32 v77, v82, v83
    v_cvt_pk_bf16_f32 v78, v84, v85
    v_cvt_pk_bf16_f32 v79, v86, v87
    ds_write_b128 v252, v[76:79] offset:60928
    v_and_b32 v188, 3, v254
    v_lshlrev_b32 v190, 4, v188
    v_mul_u32_u24 v188, 5376, v188
    v_add_u32 v188, 2688, v188
    ds_write_b16 v190, v188 offset:6338
    s_waitcnt lgkmcnt(8)
    ds_read_b64_tr_b16 v[16:17], v174 offset:17920
    ds_read_b64_tr_b16 v[18:19], v174 offset:18432
    ds_read_b64_tr_b16 v[20:21], v174 offset:18944
    ds_read_b64_tr_b16 v[22:23], v174 offset:19456
    ds_read_b64_tr_b16 v[24:25], v174 offset:19968
    ds_read_b64_tr_b16 v[26:27], v174 offset:20480
    s_waitcnt lgkmcnt(8)
    ds_read_b64_tr_b16 v[28:29], v174 offset:20992
    ds_read_b64_tr_b16 v[30:31], v174 offset:21504
    ds_read_b64_tr_b16 v[64:65], v175 offset:42496
    ds_read_b64_tr_b16 v[66:67], v175 offset:43008
    ds_read_b64_tr_b16 v[68:69], v176 offset:42496
    ds_read_b64_tr_b16 v[70:71], v176 offset:43008
    s_waitcnt lgkmcnt(8)
    ds_read_b64_tr_b16 v[32:33], v173 offset:26112
    ds_read_b64_tr_b16 v[34:35], v173 offset:26624
    ds_read_b64_tr_b16 v[36:37], v173 offset:27136
    ds_read_b64_tr_b16 v[38:39], v173 offset:27648
    ds_read_b64_tr_b16 v[40:41], v173 offset:28160
    ds_read_b64_tr_b16 v[42:43], v173 offset:28672
    s_waitcnt lgkmcnt(8)
    ds_read_b64_tr_b16 v[44:45], v173 offset:29184
    ds_read_b64_tr_b16 v[46:47], v173 offset:29696
    ds_read_b64_tr_b16 v[48:49], v174 offset:26112
    ds_read_b64_tr_b16 v[50:51], v174 offset:26624
    ds_read_b64_tr_b16 v[52:53], v174 offset:27136
    ds_read_b64_tr_b16 v[54:55], v174 offset:27648
    s_waitcnt lgkmcnt(8)
    ds_read_b64_tr_b16 v[56:57], v174 offset:28160
    ds_read_b64_tr_b16 v[58:59], v174 offset:28672
    ds_read_b64_tr_b16 v[60:61], v174 offset:29184
    ds_read_b64_tr_b16 v[62:63], v174 offset:29696
    s_mov_b32 s5, 85899
    s_lshr_b32 s6, s12, 5
    s_mul_i32 s6, s6, 538758528
    s_sub_u32 s6, s6, 0
    buffer_load_dwordx4 v[88:91], v189, s[32:35], 0 offen sc1
    buffer_load_dwordx4 v[92:95], v189, s[32:35], s79 offen sc1
    buffer_load_dwordx4 v[96:99], v189, s[32:35], s80 offen sc1
    buffer_load_dwordx4 v[100:103], v189, s[32:35], s81 offen sc1
    s_mov_b32 s64, 0xc0c0401
    s_mov_b32 s65, 0xc0c0501
    s_mov_b32 s66, 0xc0c0601
    s_mov_b32 s67, 0x05040100
    s_movk_i32 s4, 1338
    s_movk_i32 s13, 4032
    s_movk_i32 s14, 16056
    s_waitcnt lgkmcnt(0)
    s_barrier
K2_CHK0:
    s_waitcnt vmcnt(3)
    v_bitop3_b32 v188, v91, s36, v214 bitop3:0x28
    v_cmp_ne_u32 vcc, 0, v188
    v_sub_u32_sdwa v188, v91, v168 dst_sel:DWORD dst_unused:UNUSED_PAD src0_sel:BYTE_3 src1_sel:DWORD
    v_mul_u32_u24_sdwa v104, s5, v88 dst_sel:DWORD dst_unused:UNUSED_PAD src0_sel:DWORD src1_sel:WORD_1
    v_mul_u32_u24_sdwa v105, s5, v89 dst_sel:DWORD dst_unused:UNUSED_PAD src0_sel:DWORD src1_sel:WORD_1
    v_mul_u32_u24_sdwa v106, s5, v90 dst_sel:DWORD dst_unused:UNUSED_PAD src0_sel:DWORD src1_sel:WORD_1
    s_cbranch_vccnz K2_RETRY0
    v_cmp_lt_i32 s[40:41], 0, v188
    v_cmp_lt_i32 s[42:43], 1, v188
    v_cmp_lt_i32 s[44:45], 2, v188
    v_subrev_u32 v104, s6, v104
    v_subrev_u32 v105, s6, v105
    v_subrev_u32 v106, s6, v106
    v_alignbit_b32 v104, v88, v104, 28
    v_alignbit_b32 v105, v89, v105, 28
    v_alignbit_b32 v106, v90, v106, 28
    v_and_b32 v104, 0xffc, v104
    v_and_b32 v105, 0xffc, v105
    v_and_b32 v106, 0xffc, v106
    v_mul_u32_u24_sdwa v116, s4, v88 dst_sel:DWORD dst_unused:UNUSED_PAD src0_sel:DWORD src1_sel:BYTE_0
    v_mul_u32_u24_sdwa v117, s4, v89 dst_sel:DWORD dst_unused:UNUSED_PAD src0_sel:DWORD src1_sel:BYTE_0
    v_mul_u32_u24_sdwa v118, s4, v90 dst_sel:DWORD dst_unused:UNUSED_PAD src0_sel:DWORD src1_sel:BYTE_0
    v_subrev_u32 v116, 40140, v116
    v_subrev_u32 v117, 40140, v117
    v_subrev_u32 v118, 40140, v118
    v_cmp_gt_u16 s[68:69], s14, v116
    v_cmp_gt_u16 s[70:71], s14, v117
    v_cmp_gt_u16 s[86:87], s14, v118
    v_lshrrev_b32 v116, 16, v116
    v_lshrrev_b32 v117, 16, v117
    v_lshrrev_b32 v118, 16, v118
    v_lshl_add_u32 v116, v116, 4, s13
    v_lshl_add_u32 v117, v117, 4, s13
    v_lshl_add_u32 v118, v118, 4, s13
    v_cndmask_b32 v104, v104, v116, s[68:69]
    v_cndmask_b32 v105, v105, v117, s[70:71]
    v_cndmask_b32 v106, v106, v118, s[86:87]
    s_mov_b64 exec, s[40:41]
    ds_add_rtn_u32 v220, v104, v171 offset:2304
    s_mov_b64 exec, s[42:43]
    ds_add_rtn_u32 v221, v105, v171 offset:2304
    s_mov_b64 exec, s[44:45]
    ds_add_rtn_u32 v222, v106, v171 offset:2304
    s_mov_b64 exec, -1
    v_and_b32 v119, 0x0f0f0f, v91
    v_perm_b32 v152, v119, v88, s64
    s_and_b64 s[68:69], s[68:69], s[40:41]
    v_lshl_add_u32 v152, v152, 5, v208
    s_andn2_b64 s[40:41], s[40:41], s[68:69]
    v_perm_b32 v153, v119, v89, s65
    s_and_b64 s[70:71], s[70:71], s[42:43]
    v_lshl_add_u32 v153, v153, 5, v208
    s_andn2_b64 s[42:43], s[42:43], s[70:71]
    v_perm_b32 v154, v119, v90, s66
    s_and_b64 s[86:87], s[86:87], s[44:45]
    v_lshl_add_u32 v154, v154, 5, v208
    s_andn2_b64 s[44:45], s[44:45], s[86:87]
K2_CHK1:
    s_waitcnt vmcnt(2)
    v_bitop3_b32 v188, v95, s36, v214 bitop3:0x28
    v_cmp_ne_u32 vcc, 0, v188
    v_sub_u32_sdwa v188, v95, v168 dst_sel:DWORD dst_unused:UNUSED_PAD src0_sel:BYTE_3 src1_sel:DWORD
    v_mul_u32_u24_sdwa v107, s5, v92 dst_sel:DWORD dst_unused:UNUSED_PAD src0_sel:DWORD src1_sel:WORD_1
    v_mul_u32_u24_sdwa v108, s5, v93 dst_sel:DWORD dst_unused:UNUSED_PAD src0_sel:DWORD src1_sel:WORD_1
    v_mul_u32_u24_sdwa v109, s5, v94 dst_sel:DWORD dst_unused:UNUSED_PAD src0_sel:DWORD src1_sel:WORD_1
    s_cbranch_vccnz K2_RETRY1
    v_cmp_lt_i32 s[46:47], 0, v188
    v_cmp_lt_i32 s[48:49], 1, v188
    v_cmp_lt_i32 s[50:51], 2, v188
    v_subrev_u32 v107, s6, v107
    v_subrev_u32 v108, s6, v108
    v_subrev_u32 v109, s6, v109
    v_alignbit_b32 v107, v92, v107, 28
    v_alignbit_b32 v108, v93, v108, 28
    v_alignbit_b32 v109, v94, v109, 28
    v_and_b32 v107, 0xffc, v107
    v_and_b32 v108, 0xffc, v108
    v_and_b32 v109, 0xffc, v109
    s_mov_b64 exec, s[46:47]
    ds_add_rtn_u32 v223, v107, v171 offset:2304
    s_mov_b64 exec, s[48:49]
    ds_add_rtn_u32 v224, v108, v171 offset:2304
    s_mov_b64 exec, s[50:51]
    ds_add_rtn_u32 v225, v109, v171 offset:2304
    s_mov_b64 exec, -1
    s_waitcnt lgkmcnt(0)
    v_min_u16 v116, 2176, v220
    v_add_u32_sdwa v116, v116, v220 dst_sel:DWORD dst_unused:UNUSED_PAD src0_sel:WORD_0 src1_sel:WORD_1
    v_min_u16 v117, 2176, v221
    v_add_u32_sdwa v117, v117, v221 dst_sel:DWORD dst_unused:UNUSED_PAD src0_sel:WORD_0 src1_sel:WORD_1
    v_min_u16 v118, 2176, v222
    v_add_u32_sdwa v118, v118, v222 dst_sel:DWORD dst_unused:UNUSED_PAD src0_sel:WORD_0 src1_sel:WORD_1
    s_mov_b64 exec, s[68:69]
    ds_write2st64_b32 v116, v88, v152 offset0:38 offset1:122
    s_mov_b64 exec, s[70:71]
    ds_write2st64_b32 v117, v89, v153 offset0:38 offset1:122
    s_mov_b64 exec, s[86:87]
    ds_write2st64_b32 v118, v90, v154 offset0:38 offset1:122
    s_mov_b64 exec, -1
K2_CHK2:
    s_waitcnt vmcnt(1)
    v_bitop3_b32 v188, v99, s36, v214 bitop3:0x28
    v_cmp_ne_u32 vcc, 0, v188
    v_sub_u32_sdwa v188, v99, v168 dst_sel:DWORD dst_unused:UNUSED_PAD src0_sel:BYTE_3 src1_sel:DWORD
    v_mul_u32_u24_sdwa v110, s5, v96 dst_sel:DWORD dst_unused:UNUSED_PAD src0_sel:DWORD src1_sel:WORD_1
    v_mul_u32_u24_sdwa v111, s5, v97 dst_sel:DWORD dst_unused:UNUSED_PAD src0_sel:DWORD src1_sel:WORD_1
    v_mul_u32_u24_sdwa v112, s5, v98 dst_sel:DWORD dst_unused:UNUSED_PAD src0_sel:DWORD src1_sel:WORD_1
    s_cbranch_vccnz K2_RETRY2
    v_cmp_lt_i32 s[52:53], 0, v188
    v_cmp_lt_i32 s[54:55], 1, v188
    v_cmp_lt_i32 s[56:57], 2, v188
    v_subrev_u32 v110, s6, v110
    v_subrev_u32 v111, s6, v111
    v_subrev_u32 v112, s6, v112
    v_alignbit_b32 v110, v96, v110, 28
    v_alignbit_b32 v111, v97, v111, 28
    v_alignbit_b32 v112, v98, v112, 28
    v_and_b32 v110, 0xffc, v110
    v_and_b32 v111, 0xffc, v111
    v_and_b32 v112, 0xffc, v112
    s_mov_b64 exec, s[52:53]
    ds_add_rtn_u32 v226, v110, v171 offset:2304
    s_mov_b64 exec, s[54:55]
    ds_add_rtn_u32 v227, v111, v171 offset:2304
    s_mov_b64 exec, s[56:57]
    ds_add_rtn_u32 v228, v112, v171 offset:2304
    s_mov_b64 exec, -1
K2_CHK3:
    s_waitcnt vmcnt(0)
    v_bitop3_b32 v188, v103, s36, v214 bitop3:0x28
    v_cmp_ne_u32 vcc, 0, v188
    v_sub_u32_sdwa v188, v103, v168 dst_sel:DWORD dst_unused:UNUSED_PAD src0_sel:BYTE_3 src1_sel:DWORD
    v_mul_u32_u24_sdwa v113, s5, v100 dst_sel:DWORD dst_unused:UNUSED_PAD src0_sel:DWORD src1_sel:WORD_1
    v_mul_u32_u24_sdwa v114, s5, v101 dst_sel:DWORD dst_unused:UNUSED_PAD src0_sel:DWORD src1_sel:WORD_1
    v_mul_u32_u24_sdwa v115, s5, v102 dst_sel:DWORD dst_unused:UNUSED_PAD src0_sel:DWORD src1_sel:WORD_1
    s_cbranch_vccnz K2_RETRY3
    v_cmp_lt_i32 s[58:59], 0, v188
    v_cmp_lt_i32 s[60:61], 1, v188
    v_cmp_lt_i32 s[62:63], 2, v188
    v_subrev_u32 v113, s6, v113
    v_subrev_u32 v114, s6, v114
    v_subrev_u32 v115, s6, v115
    v_alignbit_b32 v113, v100, v113, 28
    v_alignbit_b32 v114, v101, v114, 28
    v_alignbit_b32 v115, v102, v115, 28
    v_and_b32 v113, 0xffc, v113
    v_and_b32 v114, 0xffc, v114
    v_and_b32 v115, 0xffc, v115
    s_mov_b64 exec, s[58:59]
    ds_add_rtn_u32 v229, v113, v171 offset:2304
    s_mov_b64 exec, s[60:61]
    ds_add_rtn_u32 v230, v114, v171 offset:2304
    s_mov_b64 exec, s[62:63]
    ds_add_rtn_u32 v231, v115, v171 offset:2304
    s_mov_b64 exec, -1
    v_max3_u32 v188, v91, v95, v99
    v_max_u32 v188, v188, v103
    v_cmp_le_u32 vcc, 553648128, v188
    s_cbranch_vccnz K2_XT1
K2_XT1R:
    s_lshr_b32 s4, s3, 1
    s_add_u32 s4, s4, 60
    s_waitcnt lgkmcnt(0)
    s_barrier
    ds_read_b128 v[128:131], v172 offset:5376
    ds_read_b128 v[236:239], v247
    ds_read_b32 v240, v251
    ds_read_u8 v250, v249
    ds_read_b128 v[116:119], v172 offset:2304
    ds_read_b128 v[120:123], v172 offset:3328
    ds_read_b128 v[124:127], v172 offset:4352
    ds_read_b64 v[194:195], v200 offset:2304
    s_bitcmp1_b32 s3, 0
    s_cbranch_scc0 K2_NOX1
    s_mul_i32 s10, s12, 196
    s_add_u32 s10, s10, s96
    s_lshl_b32 s10, s10, 7
    s_mul_i32 s11, s7, 4160
    s_add_u32 m0, s11, 69120
    s_add_u32 s86, s10, 0
    buffer_load_dwordx4 v234, s[16:19], s86 offen lds
    s_add_u32 m0, s11, 70160
    s_add_u32 s86, s10, 1024
    buffer_load_dwordx4 v234, s[16:19], s86 offen lds
    s_add_u32 m0, s11, 71200
    s_add_u32 s86, s10, 2048
    buffer_load_dwordx4 v234, s[16:19], s86 offen lds
    s_add_u32 m0, s11, 72240
    s_add_u32 s86, s10, 3072
    buffer_load_dwordx4 v234, s[16:19], s86 offen lds
K2_NOX1:
    s_waitcnt lgkmcnt(5)
    v_readlane_b32 s68, v128, s4
    v_and_b32 v95, 0x0f0f0f, v95
    v_and_b32 v99, 0x0f0f0f, v99
    s_and_b32 s68, s68, 0xffff
    s_bitcmp1_b32 s3, 0
    s_cselect_b32 s68, s68, 0
    s_cmp_ge_u32 s68, 128
    s_cselect_b32 s69, 1, 0
    s_cbranch_scc0 K2_NOQ
    s_add_u32 m0, s74, 0
    v_mad_u32_u16 v236, v236, s75, v241 op_sel:[1,0,0,0]
    buffer_load_dwordx4 v236, s[16:19], 0 offen lds
    s_add_u32 m0, s74, 1040
    v_mad_u32_u16 v237, v237, s75, v241 op_sel:[1,0,0,0]
    buffer_load_dwordx4 v237, s[16:19], 0 offen lds
    s_add_u32 m0, s74, 2080
    v_mad_u32_u16 v238, v238, s75, v241 op_sel:[1,0,0,0]
    buffer_load_dwordx4 v238, s[16:19], 0 offen lds
    s_add_u32 m0, s74, 3120
    v_mad_u32_u16 v239, v239, s75, v241 op_sel:[1,0,0,0]
    buffer_load_dwordx4 v239, s[16:19], 0 offen lds
    s_add_u32 m0, s74, 4160
    v_add_u32 v240, v240, v242
    buffer_load_dwordx4 v240, s[20:23], 0 offen lds
K2_NOQ:
    v_add_u32_sdwa v191, v128, v129 dst_sel:DWORD dst_unused:UNUSED_PAD src0_sel:WORD_0 src1_sel:WORD_0
    v_add_u32_sdwa v128, v130, v131 dst_sel:DWORD dst_unused:UNUSED_PAD src0_sel:WORD_0 src1_sel:WORD_0
    v_add_u32 v191, v191, v128
    s_waitcnt lgkmcnt(3)
    v_add_u32_sdwa v188, v116, v117 dst_sel:DWORD dst_unused:UNUSED_PAD src0_sel:WORD_0 src1_sel:WORD_0
    v_add_u32_sdwa v116, v118, v119 dst_sel:DWORD dst_unused:UNUSED_PAD src0_sel:WORD_0 src1_sel:WORD_0
    v_add_u32 v188, v188, v116
    s_waitcnt lgkmcnt(2)
    v_add_u32_sdwa v189, v120, v121 dst_sel:DWORD dst_unused:UNUSED_PAD src0_sel:WORD_0 src1_sel:WORD_0
    v_add_u32_sdwa v120, v122, v123 dst_sel:DWORD dst_unused:UNUSED_PAD src0_sel:WORD_0 src1_sel:WORD_0
    v_add_u32 v189, v189, v120
    s_waitcnt lgkmcnt(1)
    v_add_u32_sdwa v190, v124, v125 dst_sel:DWORD dst_unused:UNUSED_PAD src0_sel:WORD_0 src1_sel:WORD_0
    v_add_u32_sdwa v124, v126, v127 dst_sel:DWORD dst_unused:UNUSED_PAD src0_sel:WORD_0 src1_sel:WORD_0
    v_add_u32 v190, v190, v124
    v_lshl_or_b32 v192, v189, 16, v188
    v_lshl_or_b32 v193, v191, 16, v190
    s_waitcnt lgkmcnt(0)
    v_perm_b32 v198, v195, v194, s67
    v_add_u32_dpp v192, v192, v192 row_shr:1 row_mask:0xf bank_mask:0xf bound_ctrl:0
    v_add_u32_dpp v193, v193, v193 row_shr:1 row_mask:0xf bank_mask:0xf bound_ctrl:0
    v_and_b32 v103, 0x0f0f0f, v103
    v_add_u32_dpp v192, v192, v192 row_shr:2 row_mask:0xf bank_mask:0xf bound_ctrl:0
    v_add_u32_dpp v193, v193, v193 row_shr:2 row_mask:0xf bank_mask:0xf bound_ctrl:0
    v_perm_b32 v155, v95, v92, s64
    v_add_u32_dpp v192, v192, v192 row_shr:4 row_mask:0xf bank_mask:0xf bound_ctrl:0
    v_add_u32_dpp v193, v193, v193 row_shr:4 row_mask:0xf bank_mask:0xf bound_ctrl:0
    v_perm_b32 v156, v95, v93, s65
    v_add_u32_dpp v192, v192, v192 row_shr:8 row_mask:0xf bank_mask:0xf bound_ctrl:0
    v_add_u32_dpp v193, v193, v193 row_shr:8 row_mask:0xf bank_mask:0xf bound_ctrl:0
    v_perm_b32 v157, v95, v94, s66
    v_add_u32_dpp v192, v192, v192 row_bcast:15 row_mask:0xa bank_mask:0xf
    v_add_u32_dpp v193, v193, v193 row_bcast:15 row_mask:0xa bank_mask:0xf
    v_perm_b32 v158, v99, v96, s64
    v_add_u32_dpp v192, v192, v192 row_bcast:31 row_mask:0xc bank_mask:0xf
    v_add_u32_dpp v193, v193, v193 row_bcast:31 row_mask:0xc bank_mask:0xf
    v_perm_b32 v159, v99, v97, s65
    s_sub_u32 s4, s4, 1
    v_readlane_b32 s10, v192, 63
    v_readlane_b32 s11, v193, 63
    v_readlane_b32 s14, v193, 59
    v_readlane_b32 s86, v193, s4
    v_lshlrev_b32_sdwa v116, v169, v192 dst_sel:DWORD dst_unused:UNUSED_PAD src0_sel:DWORD src1_sel:WORD_0
    v_sub_u32 v188, v116, v188
    v_lshlrev_b32_sdwa v117, v169, v192 dst_sel:DWORD dst_unused:UNUSED_PAD src0_sel:DWORD src1_sel:WORD_1
    v_sub_u32 v189, v117, v189
    v_lshlrev_b32_sdwa v118, v169, v193 dst_sel:DWORD dst_unused:UNUSED_PAD src0_sel:DWORD src1_sel:WORD_0
    v_sub_u32 v190, v118, v190
    s_and_b32 s4, s10, 0xffff
    s_lshr_b32 s10, s10, 16
    s_add_u32 s5, s4, s10
    s_and_b32 s10, s11, 0xffff
    s_add_u32 s10, s5, s10
    s_lshr_b32 s11, s11, 16
    s_add_u32 s10, s10, s11
    s_lshr_b32 s14, s14, 16
    s_lshr_b32 s86, s86, 16
    s_sub_u32 s6, s86, s14
    s_lshl_b32 s6, s6, 1
    v_lshl_add_u32 v189, s4, 1, v189
    v_lshl_add_u32 v190, s5, 1, v190
    s_sub_i32 s37, 12864, s10
    s_ashr_i32 s37, s37, 7
    s_max_i32 s37, s37, 1
    s_min_i32 s37, s37, 4
    s_lshr_b32 s11, s10, 5
    s_add_u32 s11, s11, 16
    s_and_b32 s11, s11, -32
    s_cmp_ge_i32 s37, 1
    s_cselect_b32 s13, 42, 10
    s_sub_i32 s11, s11, s13
    s_lshl_b32 s11, s11, 3
    s_lshr_b32 s10, s10, 1
    s_lshr_b32 s13, s3, 1
    s_mul_i32 s13, s13, s10
    s_sub_i32 s13, s13, s6
    s_sub_i32 s10, s10, s68
    s_sub_i32 s10, s10, s68
    s_add_i32 s11, s11, s13
    s_add_i32 s10, s10, s13
    s_bitcmp1_b32 s3, 0
    s_cselect_b32 s15, s11, s13
    s_cselect_b32 s10, s10, s11
    s_mov_b32 s13, 0
    s_mov_b32 s14, 0
    v_cmp_gt_i32 vcc, s15, v188
    v_cmp_gt_i32 s[86:87], s10, v188
    s_bcnt1_i32_b64 s11, vcc
    s_add_u32 s13, s13, s11
    s_bcnt1_i32_b64 s11, s[86:87]
    s_add_u32 s14, s14, s11
    v_cmp_gt_i32 vcc, s15, v189
    v_cmp_gt_i32 s[86:87], s10, v189
    s_bcnt1_i32_b64 s11, vcc
    s_add_u32 s13, s13, s11
    s_bcnt1_i32_b64 s11, s[86:87]
    s_add_u32 s14, s14, s11
    v_cmp_gt_i32 vcc, s15, v190
    v_cmp_gt_i32 s[86:87], s10, v190
    s_bcnt1_i32_b64 s11, vcc
    s_add_u32 s13, s13, s11
    s_bcnt1_i32_b64 s11, s[86:87]
    s_add_u32 s14, s14, s11
    s_max_i32 s13, s13, s72
    s_min_i32 s13, s13, s73
    s_max_i32 s14, s14, s84
    s_min_i32 s14, s14, s85
    v_cmp_le_u32 vcc, s13, v199
    v_cmp_gt_u32 s[10:11], s14, v199
    s_nop 0
    s_and_b64 vcc, vcc, s[10:11]
    v_cndmask_b32 v198, 0, v198, vcc
    v_mov_b32 v196, v198
    v_perm_b32 v160, v99, v98, s66
    v_perm_b32 v161, v103, v100, s64
    v_add_u32_dpp v196, v196, v196 row_shr:1 row_mask:0xf bank_mask:0xf bound_ctrl:0
    v_perm_b32 v162, v103, v101, s65
    v_perm_b32 v163, v103, v102, s66
    v_add_u32_dpp v196, v196, v196 row_shr:2 row_mask:0xf bank_mask:0xf bound_ctrl:0
    v_lshl_add_u32 v155, v155, 5, v209
    v_lshl_add_u32 v156, v156, 5, v209
    v_add_u32_dpp v196, v196, v196 row_shr:4 row_mask:0xf bank_mask:0xf bound_ctrl:0
    v_lshl_add_u32 v157, v157, 5, v209
    v_lshl_add_u32 v158, v158, 5, v210
    v_add_u32_dpp v196, v196, v196 row_shr:8 row_mask:0xf bank_mask:0xf bound_ctrl:0
    v_lshl_add_u32 v159, v159, 5, v210
    v_lshl_add_u32 v160, v160, 5, v210
    v_add_u32_dpp v196, v196, v196 row_bcast:15 row_mask:0xa bank_mask:0xf
    v_lshl_add_u32 v161, v161, 5, v211
    v_lshl_add_u32 v162, v162, 5, v211
    v_lshl_add_u32 v163, v163, 5, v211
    s_sub_u32 s86, s76, 9728
    s_add_u32 s86, s86, s68
    v_readlane_b32 s10, v196, 31
    v_readlane_b32 s11, v196, 63
    v_sub_u32 v196, v196, v198
    v_mov_b32 v253, v202
    s_and_b32 s4, s10, 0xffff
    s_lshr_b32 s10, s10, 16
    s_add_u32 s5, s4, s10
    s_and_b32 s10, s11, 0xffff
    s_add_u32 s6, s5, s10
    s_lshr_b32 s11, s11, 16
    s_add_u32 s15, s6, s11
    s_lshl_b32 s10, s4, 16
    s_pack_ll_b32_b16 s11, s5, s6
    s_pack_ll_b32_b16 s86, s86, s86
    s_add_u32 s10, s10, s86
    s_add_u32 s11, s11, s86
    s_mov_b32 exec_lo, vcc_lo
    s_mov_b32 exec_hi, 0
    v_add_u32 v196, s10, v196
    s_mov_b32 exec_lo, 0
    s_mov_b32 exec_hi, vcc_hi
    v_add_u32 v196, s11, v196
    s_mov_b64 exec, vcc
    ds_write_b16 v200, v196 offset:2306
    ds_write_b16_d16_hi v200, v196 offset:2310
    ds_write_b32 v213, v212 offset:6400
    s_mov_b64 exec, -1
    v_mov_b32 v197, 2176
    s_add_u32 s15, s15, s68
    s_add_u32 s68, s68, 64
    s_cmp_le_u32 s15, 2176
    s_cbranch_scc1 K2_LFIT
    ds_write_b32 v197, v197
    s_mov_b32 s15, 0
K2_LFIT:
    s_add_u32 s15, s15, s76
    s_add_i32 s4, s4, s68
    s_lshr_b32 s4, s4, 7
    s_add_i32 s5, s5, s68
    s_lshr_b32 s5, s5, 7
    s_add_i32 s6, s6, s68
    s_lshr_b32 s6, s6, 7
    v_mov_b32 v190, 0xffff0000
    v_or_b32 v189, s39, v190
    v_mov_b32 v190, 0x7fffff00
    v_lshl_add_u32 v188, v254, 2, s15
    s_sub_u32 s73, s15, s76
    ds_write2st64_b32 v188, v189, v190 offset0:0 offset1:84
    ds_write2st64_b32 v188, v189, v190 offset0:1 offset1:85
    s_add_u32 s73, s73, 127
    s_lshr_b32 s73, s73, 7
    s_sub_i32 s38, s73, 1
    v_mov_b32 v188, s15
    ds_write_b32 v212, v188 offset:2112
    s_waitcnt lgkmcnt(0)
    s_barrier
    ds_read_b64 v[194:195], v197
    s_mov_b64 exec, s[40:41]
    ds_read_u16 v104, v104 offset:2306
    s_mov_b64 exec, s[42:43]
    ds_read_u16 v105, v105 offset:2306
    s_mov_b64 exec, s[44:45]
    ds_read_u16 v106, v106 offset:2306
    s_mov_b64 exec, s[46:47]
    ds_read_u16 v107, v107 offset:2306
    s_mov_b64 exec, s[48:49]
    ds_read_u16 v108, v108 offset:2306
    s_mov_b64 exec, s[50:51]
    ds_read_u16 v109, v109 offset:2306
    s_mov_b64 exec, s[52:53]
    ds_read_u16 v110, v110 offset:2306
    s_mov_b64 exec, s[54:55]
    ds_read_u16 v111, v111 offset:2306
    s_mov_b64 exec, s[56:57]
    ds_read_u16 v112, v112 offset:2306
    s_mov_b64 exec, s[58:59]
    ds_read_u16 v113, v113 offset:2306
    s_mov_b64 exec, s[60:61]
    ds_read_u16 v114, v114 offset:2306
    s_mov_b64 exec, s[62:63]
    ds_read_u16 v115, v115 offset:2306
    s_mov_b64 exec, -1
    s_waitcnt lgkmcnt(0)
    v_readfirstlane_b32 s83, v194
    v_readfirstlane_b32 s80, v195
    v_add_u32 v104, v104, v220
    v_add_u32 v105, v105, v221
    v_add_u32 v106, v106, v222
    v_add_u32 v107, v107, v223
    v_add_u32 v108, v108, v224
    v_add_u32 v109, v109, v225
    v_add_u32 v110, v110, v226
    v_add_u32 v111, v111, v227
    v_add_u32 v112, v112, v228
    v_add_u32 v113, v113, v229
    v_add_u32 v114, v114, v230
    v_add_u32 v115, v115, v231
    s_cmp_gt_u32 s83, 64
    s_cbranch_scc1 K2_OVF
    s_mov_b64 exec, s[40:41]
    ds_write2st64_b32 v104, v88, v152 offset0:38 offset1:122
    s_mov_b64 exec, s[42:43]
    ds_write2st64_b32 v105, v89, v153 offset0:38 offset1:122
    s_mov_b64 exec, s[44:45]
    ds_write2st64_b32 v106, v90, v154 offset0:38 offset1:122
    s_mov_b64 exec, s[46:47]
    ds_write2st64_b32 v107, v92, v155 offset0:38 offset1:122
    s_mov_b64 exec, s[48:49]
    ds_write2st64_b32 v108, v93, v156 offset0:38 offset1:122
    s_mov_b64 exec, s[50:51]
    ds_write2st64_b32 v109, v94, v157 offset0:38 offset1:122
    s_mov_b64 exec, s[52:53]
    ds_write2st64_b32 v110, v96, v158 offset0:38 offset1:122
    s_mov_b64 exec, s[54:55]
    ds_write2st64_b32 v111, v97, v159 offset0:38 offset1:122
    s_mov_b64 exec, s[56:57]
    ds_write2st64_b32 v112, v98, v160 offset0:38 offset1:122
    s_mov_b64 exec, s[58:59]
    ds_write2st64_b32 v113, v100, v161 offset0:38 offset1:122
    s_mov_b64 exec, s[60:61]
    ds_write2st64_b32 v114, v101, v162 offset0:38 offset1:122
    s_mov_b64 exec, s[62:63]
    ds_write2st64_b32 v115, v102, v163 offset0:38 offset1:122
    s_mov_b64 exec, -1
K2_PADS0:
    s_add_u32 s10, s37, 2
    s_cmp_gt_u32 s73, s10
    s_cselect_b32 s1, s3, 0
    s_sub_u32 s10, s13, s96
    s_mul_i32 s10, s10, 144
    s_add_u32 s70, s10, s74
    s_mul_i32 s10, s12, 196
    s_add_u32 s11, s10, s14
    s_add_u32 s10, s10, s13
    s_min_u32 s11, s11, 50000
    s_min_u32 s10, s10, 50000
    s_sub_u32 s11, s11, s10
    s_lshl_b32 s10, s10, 7
    s_add_u32 s28, s28, s10
    s_addc_u32 s29, s29, 0
    s_lshl_b32 s30, s11, 7
    s_mov_b32 s79, -1
    s_mov_b64 s[84:85], 0
    s_mov_b32 s81, 0
    s_mov_b32 s82, 0
    s_cmp_lg_u32 s80, 0
    s_cselect_b32 s78, 1, 0
    s_and_b32 s69, s69, s1
    s_cmp_gt_u32 s69, s97
    s_cbranch_scc0 K2_SIDE
    s_waitcnt vmcnt(5) lgkmcnt(0)
    ds_read_b128 v[152:155], v235 offset:0
    ds_read_b128 v[156:159], v235 offset:16
    ds_read_b128 v[160:163], v235 offset:32
    ds_read_b128 v[164:167], v235 offset:48
    v_add_u32 v172, 8192, v172
    ds_read_b128 v[88:91], v172 offset:52736
    ds_read_b128 v[92:95], v172 offset:53760
    ds_read_b128 v[96:99], v172 offset:54784
    ds_read_b128 v[100:103], v172 offset:55808
    ds_read_b128 v[104:107], v172 offset:56832
    ds_read_b128 v[108:111], v172 offset:57856
    ds_read_b128 v[112:115], v172 offset:58880
    ds_read_b128 v[116:119], v172 offset:59904
    s_mov_b32 s10, 0x358637bd
    s_mov_b32 s11, s10
    v_mfma_f32_32x32x16_bf16 v[136:151], v[180:183], v[180:183], 0
    v_mov_b64 v[120:121], s[10:11]
    v_mov_b64 v[122:123], s[10:11]
    v_mov_b64 v[124:125], s[10:11]
    v_mov_b64 v[126:127], s[10:11]
    v_mov_b64 v[128:129], s[10:11]
    v_mov_b64 v[130:131], s[10:11]
    v_mov_b64 v[132:133], s[10:11]
    v_mov_b64 v[134:135], s[10:11]
    s_waitcnt lgkmcnt(7)
    v_mfma_f32_32x32x16_bf16 v[188:203], v[152:155], v[88:91], 0
    s_waitcnt lgkmcnt(6)
    v_mfma_f32_32x32x16_bf16 v[188:203], v[156:159], v[92:95], v[188:203]
    s_waitcnt lgkmcnt(5)
    v_mfma_f32_32x32x16_bf16 v[188:203], v[160:163], v[96:99], v[188:203]
    s_waitcnt lgkmcnt(4)
    v_mfma_f32_32x32x16_bf16 v[188:203], v[164:167], v[100:103], v[188:203]
    s_waitcnt lgkmcnt(3)
    v_mfma_f32_32x32x16_bf16 v[204:219], v[152:155], v[104:107], 0
    s_waitcnt lgkmcnt(2)
    v_mfma_f32_32x32x16_bf16 v[204:219], v[156:159], v[108:111], v[204:219]
    s_waitcnt lgkmcnt(1)
    v_mfma_f32_32x32x16_bf16 v[204:219], v[160:163], v[112:115], v[204:219]
    s_waitcnt lgkmcnt(0)
    v_mfma_f32_32x32x16_bf16 v[204:219], v[164:167], v[116:119], v[204:219]
    s_barrier
    v_mfma_f32_32x32x16_bf16 v[104:119], v[180:183], v[180:183], 0
    s_mov_b32 s10, 0x358637bd
    s_mov_b32 s11, s10
    v_mov_b64 v[88:89], s[10:11]
    v_mov_b64 v[90:91], s[10:11]
    v_mov_b64 v[92:93], s[10:11]
    v_mov_b64 v[94:95], s[10:11]
    v_mov_b64 v[96:97], s[10:11]
    v_mov_b64 v[98:99], s[10:11]
    v_mov_b64 v[100:101], s[10:11]
    v_mov_b64 v[102:103], s[10:11]
    v_cvt_pk_bf16_f32 v72, v188, v189
    v_cvt_pk_bf16_f32 v73, v190, v191
    v_cvt_pk_bf16_f32 v74, v192, v193
    v_cvt_pk_bf16_f32 v75, v194, v195
    v_cvt_pk_bf16_f32 v76, v196, v197
    v_cvt_pk_bf16_f32 v77, v198, v199
    v_cvt_pk_bf16_f32 v78, v200, v201
    v_cvt_pk_bf16_f32 v79, v202, v203
    v_cvt_pk_bf16_f32 v80, v204, v205
    v_cvt_pk_bf16_f32 v81, v206, v207
    v_cvt_pk_bf16_f32 v82, v208, v209
    v_cvt_pk_bf16_f32 v83, v210, v211
    v_cvt_pk_bf16_f32 v84, v212, v213
    v_cvt_pk_bf16_f32 v85, v214, v215
    v_cvt_pk_bf16_f32 v86, v216, v217
    v_cvt_pk_bf16_f32 v87, v218, v219
    s_branch K2_HAD0
K2_SIDE:
    s_bitcmp1_b32 s3, 0
    s_cbranch_scc1 K2_NOX2
    s_mul_i32 s10, s12, 196
    s_add_u32 s10, s10, s96
    s_lshl_b32 s10, s10, 7
    s_mul_i32 s11, s7, 4160
    s_add_u32 m0, s11, 69120
    s_add_u32 s86, s10, 0
    buffer_load_dwordx4 v234, s[16:19], s86 offen lds
    s_add_u32 m0, s11, 70160
    s_add_u32 s86, s10, 1024
    buffer_load_dwordx4 v234, s[16:19], s86 offen lds
    s_add_u32 m0, s11, 71200
    s_add_u32 s86, s10, 2048
    buffer_load_dwordx4 v234, s[16:19], s86 offen lds
    s_add_u32 m0, s11, 72240
    s_add_u32 s86, s10, 3072
    buffer_load_dwordx4 v234, s[16:19], s86 offen lds
K2_NOX2:
    s_waitcnt vmcnt(5) lgkmcnt(0)
    s_barrier
    s_cmp_lg_u32 s69, 0
    s_cbranch_scc1 K2_SIDE1
    s_waitcnt vmcnt(4)
    s_bitcmp1_b32 s3, 0
    s_cbranch_scc0 K2_SIDE1
    s_waitcnt vmcnt(0)
    s_bitcmp1_b32 s1, 0
    s_cbranch_scc0 K2_SIDE1
    ds_read_b128 v[236:239], v247
    ds_read_b32 v240, v251
    ds_read_u8 v250, v249
    s_waitcnt lgkmcnt(1)
    s_add_u32 m0, s74, 0
    v_mad_u32_u16 v236, v236, s75, v241 op_sel:[1,0,0,0]
    buffer_load_dwordx4 v236, s[16:19], 0 offen lds
    s_add_u32 m0, s74, 1040
    v_mad_u32_u16 v237, v237, s75, v241 op_sel:[1,0,0,0]
    buffer_load_dwordx4 v237, s[16:19], 0 offen lds
    s_add_u32 m0, s74, 2080
    v_mad_u32_u16 v238, v238, s75, v241 op_sel:[1,0,0,0]
    buffer_load_dwordx4 v238, s[16:19], 0 offen lds
    s_add_u32 m0, s74, 3120
    v_mad_u32_u16 v239, v239, s75, v241 op_sel:[1,0,0,0]
    buffer_load_dwordx4 v239, s[16:19], 0 offen lds
    s_add_u32 m0, s74, 4160
    v_add_u32 v240, v240, v242
    buffer_load_dwordx4 v240, s[20:23], 0 offen lds
K2_SIDE1:
    s_cmp_lg_u32 s97, 0
    s_cbranch_scc1 K2_XT2
K2_XT2R:
    s_bitcmp1_b32 s1, 0
    s_cbranch_scc1 K2_SIDE2
    s_barrier
    s_cmp_eq_u32 s83, 0
    s_cbranch_scc1 K2_NEy
    s_lshl_b32 s10, s3, 2
    v_mov_b32 v178, s10
    ds_read_b32 v178, v178 offset:2112
    s_waitcnt lgkmcnt(0)
    v_readfirstlane_b32 s15, v178
    s_nop 3
    s_sub_u32 s73, s15, s76
    s_add_u32 s73, s73, 127
    s_lshr_b32 s73, s73, 7
    s_sub_i32 s38, s73, 1
K2_NEy:
    ds_read_b128 v[236:239], v247
    ds_read_b32 v240, v251
    ds_read_u8 v250, v249
    s_waitcnt lgkmcnt(1)
    s_add_u32 m0, s74, 0
    v_mad_u32_u16 v236, v236, s75, v241 op_sel:[1,0,0,0]
    buffer_load_dwordx4 v236, s[16:19], 0 offen lds
    s_add_u32 m0, s74, 1040
    v_mad_u32_u16 v237, v237, s75, v241 op_sel:[1,0,0,0]
    buffer_load_dwordx4 v237, s[16:19], 0 offen lds
    s_add_u32 m0, s74, 2080
    v_mad_u32_u16 v238, v238, s75, v241 op_sel:[1,0,0,0]
    buffer_load_dwordx4 v238, s[16:19], 0 offen lds
    s_add_u32 m0, s74, 3120
    v_mad_u32_u16 v239, v239, s75, v241 op_sel:[1,0,0,0]
    buffer_load_dwordx4 v239, s[16:19], 0 offen lds
    s_add_u32 m0, s74, 4160
    v_add_u32 v240, v240, v242
    buffer_load_dwordx4 v240, s[20:23], 0 offen lds
K2_SIDE2:
    s_waitcnt vmcnt(5) lgkmcnt(0)
    ds_read_b128 v[152:155], v235 offset:0
    ds_read_b128 v[156:159], v235 offset:16
    ds_read_b128 v[160:163], v235 offset:32
    ds_read_b128 v[164:167], v235 offset:48
    v_add_u32 v172, 8192, v172
    ds_read_b128 v[88:91], v172 offset:52736
    ds_read_b128 v[92:95], v172 offset:53760
    ds_read_b128 v[96:99], v172 offset:54784
    ds_read_b128 v[100:103], v172 offset:55808
    ds_read_b128 v[104:107], v172 offset:56832
    ds_read_b128 v[108:111], v172 offset:57856
    ds_read_b128 v[112:115], v172 offset:58880
    ds_read_b128 v[116:119], v172 offset:59904
    s_mov_b32 s10, 0x358637bd
    s_mov_b32 s11, s10
    v_mfma_f32_32x32x16_bf16 v[136:151], v[180:183], v[180:183], 0
    v_mov_b64 v[120:121], s[10:11]
    v_mov_b64 v[122:123], s[10:11]
    v_mov_b64 v[124:125], s[10:11]
    v_mov_b64 v[126:127], s[10:11]
    v_mov_b64 v[128:129], s[10:11]
    v_mov_b64 v[130:131], s[10:11]
    v_mov_b64 v[132:133], s[10:11]
    v_mov_b64 v[134:135], s[10:11]
    s_waitcnt lgkmcnt(7)
    v_mfma_f32_32x32x16_bf16 v[188:203], v[152:155], v[88:91], 0
    s_waitcnt lgkmcnt(6)
    v_mfma_f32_32x32x16_bf16 v[188:203], v[156:159], v[92:95], v[188:203]
    s_waitcnt lgkmcnt(5)
    v_mfma_f32_32x32x16_bf16 v[188:203], v[160:163], v[96:99], v[188:203]
    s_waitcnt lgkmcnt(4)
    v_mfma_f32_32x32x16_bf16 v[188:203], v[164:167], v[100:103], v[188:203]
    s_waitcnt lgkmcnt(3)
    v_mfma_f32_32x32x16_bf16 v[204:219], v[152:155], v[104:107], 0
    s_waitcnt lgkmcnt(2)
    v_mfma_f32_32x32x16_bf16 v[204:219], v[156:159], v[108:111], v[204:219]
    s_waitcnt lgkmcnt(1)
    v_mfma_f32_32x32x16_bf16 v[204:219], v[160:163], v[112:115], v[204:219]
    s_waitcnt lgkmcnt(0)
    v_mfma_f32_32x32x16_bf16 v[204:219], v[164:167], v[116:119], v[204:219]
    v_mfma_f32_32x32x16_bf16 v[104:119], v[180:183], v[180:183], 0
    s_mov_b32 s10, 0x358637bd
    s_mov_b32 s11, s10
    v_mov_b64 v[88:89], s[10:11]
    v_mov_b64 v[90:91], s[10:11]
    v_mov_b64 v[92:93], s[10:11]
    v_mov_b64 v[94:95], s[10:11]
    v_mov_b64 v[96:97], s[10:11]
    v_mov_b64 v[98:99], s[10:11]
    v_mov_b64 v[100:101], s[10:11]
    v_mov_b64 v[102:103], s[10:11]
    v_cvt_pk_bf16_f32 v72, v188, v189
    v_cvt_pk_bf16_f32 v73, v190, v191
    v_cvt_pk_bf16_f32 v74, v192, v193
    v_cvt_pk_bf16_f32 v75, v194, v195
    v_cvt_pk_bf16_f32 v76, v196, v197
    v_cvt_pk_bf16_f32 v77, v198, v199
    v_cvt_pk_bf16_f32 v78, v200, v201
    v_cvt_pk_bf16_f32 v79, v202, v203
    v_cvt_pk_bf16_f32 v80, v204, v205
    v_cvt_pk_bf16_f32 v81, v206, v207
    v_cvt_pk_bf16_f32 v82, v208, v209
    v_cvt_pk_bf16_f32 v83, v210, v211
    v_cvt_pk_bf16_f32 v84, v212, v213
    v_cvt_pk_bf16_f32 v85, v214, v215
    v_cvt_pk_bf16_f32 v86, v216, v217
    v_cvt_pk_bf16_f32 v87, v218, v219
    s_branch K2_HAD0
K2_GO:
    ds_read_b128 v[236:239], v247
    ds_read_b32 v240, v251
    ds_read_u8 v250, v249
    s_waitcnt lgkmcnt(1)
    s_add_u32 m0, s74, 0
    v_mad_u32_u16 v236, v236, s75, v241 op_sel:[1,0,0,0]
    buffer_load_dwordx4 v236, s[16:19], 0 offen lds
    s_add_u32 m0, s74, 1040
    v_mad_u32_u16 v237, v237, s75, v241 op_sel:[1,0,0,0]
    buffer_load_dwordx4 v237, s[16:19], 0 offen lds
    s_add_u32 m0, s74, 2080
    v_mad_u32_u16 v238, v238, s75, v241 op_sel:[1,0,0,0]
    buffer_load_dwordx4 v238, s[16:19], 0 offen lds
    s_add_u32 m0, s74, 3120
    v_mad_u32_u16 v239, v239, s75, v241 op_sel:[1,0,0,0]
    buffer_load_dwordx4 v239, s[16:19], 0 offen lds
    s_add_u32 m0, s74, 4160
    v_add_u32 v240, v240, v242
    buffer_load_dwordx4 v240, s[20:23], 0 offen lds
K2_HAD0:
    s_waitcnt lgkmcnt(0)
    v_lshl_add_u32 v250, v250, 6, v245
    ds_read_b128 v[236:239], v247 offset:128
    ds_read_b32 v240, v251 offset:128
    ds_read_b128 v[172:175], v250 offset:7424
    ds_read_b32 v176, v250 offset:7440
    v_mfma_f32_32x32x16_bf16 v[204:219], v[180:183], v[180:183], 0
    s_waitcnt vmcnt(0)
    ds_read_b128 v[168:171], v244
    ds_read_b128 v[152:155], v243 offset:0
    ds_read_b128 v[156:159], v243 offset:16
    ds_read_b128 v[160:163], v243 offset:32
    ds_read_b128 v[164:167], v243 offset:48
    s_waitcnt lgkmcnt(0)
    s_add_u32 m0, s74, 0
    v_mad_u32_u16 v236, v236, s75, v241 op_sel:[1,0,0,0]
    buffer_load_dwordx4 v236, s[16:19], 0 offen lds
    s_add_u32 m0, s74, 1040
    v_mad_u32_u16 v237, v237, s75, v241 op_sel:[1,0,0,0]
    buffer_load_dwordx4 v237, s[16:19], 0 offen lds
    s_add_u32 m0, s74, 2080
    v_mad_u32_u16 v238, v238, s75, v241 op_sel:[1,0,0,0]
    buffer_load_dwordx4 v238, s[16:19], 0 offen lds
    s_add_u32 m0, s74, 3120
    v_mad_u32_u16 v239, v239, s75, v241 op_sel:[1,0,0,0]
    buffer_load_dwordx4 v239, s[16:19], 0 offen lds
    s_add_u32 m0, s74, 4160
    v_add_u32 v240, v240, v242
    buffer_load_dwordx4 v240, s[20:23], 0 offen lds
    s_cmp_lt_i32 s37, 0
    s_cbranch_scc1 K2_B1
    s_barrier
    s_bitcmp1_b32 s1, 0
    s_cselect_b32 s37, s37, -1
    s_cbranch_scc0 K2_B1
    s_cmp_eq_u32 s83, 0
    s_cbranch_scc1 K2_NEo
    s_lshl_b32 s10, s3, 2
    v_mov_b32 v178, s10
    ds_read_b32 v178, v178 offset:2112
    s_waitcnt lgkmcnt(0)
    v_readfirstlane_b32 s15, v178
    s_nop 3
    s_sub_u32 s73, s15, s76
    s_add_u32 s73, s73, 127
    s_lshr_b32 s73, s73, 7
    s_sub_i32 s38, s73, 1
K2_NEo:
K2_B1:
    s_cmp_lg_u32 s73, 0
    s_cbranch_scc1 K2_NZ
    s_waitcnt vmcnt(0)
    s_branch K2_DONE
K2_NZ:
    v_mfma_f32_32x32x16_bf16 v[188:203], v[168:171], v[64:67], 0
    v_mfma_f32_32x32x16_bf16 v[188:203], v[152:155], v[0:3], v[188:203]
    v_mfma_f32_32x32x16_bf16 v[188:203], v[156:159], v[4:7], v[188:203]
    v_mfma_f32_32x32x16_bf16 v[188:203], v[160:163], v[8:11], v[188:203]
    v_mfma_f32_32x32x16_bf16 v[188:203], v[164:167], v[12:15], v[188:203]
    s_nop 9
    v_smfmac_f32_32x32x32_bf16 v[188:203], v[172:175], v[72:79], v176
    s_mov_b32 s72, 0
    s_sub_u32 s10, s73, 1
    s_bitcmp1_b32 s3, 0
    s_cselect_b32 s6, s6, s10
    s_setprio 3
    s_mov_b32 s87, s73
    s_cmp_gt_i32 s4, s72
    s_cselect_b32 s10, s4, s87
    s_min_u32 s87, s87, s10
    s_cmp_gt_i32 s5, s72
    s_cselect_b32 s10, s5, s87
    s_min_u32 s87, s87, s10
    s_cmp_gt_i32 s6, s72
    s_cselect_b32 s10, s6, s87
    s_min_u32 s87, s87, s10
    s_cmp_gt_i32 s37, s72
    s_cselect_b32 s10, s37, s87
    s_min_u32 s87, s87, s10
    s_cmp_gt_i32 s38, s72
    s_cselect_b32 s10, s38, s87
    s_min_u32 s87, s87, s10
.p2align 6
K2_LOOP:
    v_smfmac_f32_32x32x32_bf16 v[136:151], v[180:183], v[204:211], v177
    ds_read_u8 v236, v248 offset:0
    ds_read_u8 v237, v248 offset:16
    ds_read_u8 v238, v248 offset:64
    ds_read_u8 v239, v248 offset:80
    ds_read_u8 v250, v249 offset:128
    v_exp_f32 v188, v188
    v_exp_f32 v189, v189
    v_exp_f32 v190, v190
    v_add_f32 v188, 1.0, v188
    v_smfmac_f32_32x32x32_bf16 v[136:151], v[184:187], v[212:219], v177
    v_exp_f32 v191, v191
    v_add_f32 v189, 1.0, v189
    v_exp_f32 v192, v192
    v_add_f32 v190, 1.0, v190
    v_rcp_f32 v188, v188
    v_mfma_f32_32x32x16_bf16 v[220:235], v[168:171], v[68:71], 0
    v_exp_f32 v193, v193
    v_add_f32 v191, 1.0, v191
    v_rcp_f32 v189, v189
    v_exp_f32 v194, v194
    v_mfma_f32_32x32x16_bf16 v[204:219], v[152:155], v[32:35], 0
    v_add_f32 v192, 1.0, v192
    v_rcp_f32 v190, v190
    v_exp_f32 v195, v195
    v_mfma_f32_32x32x16_bf16 v[204:219], v[156:159], v[36:39], v[204:219]
    s_waitcnt lgkmcnt(0)
    v_lshl_add_u32 v236, v236, 6, v246
    v_lshl_add_u32 v237, v237, 6, v246
    v_lshl_add_u32 v238, v238, 6, v246
    v_lshl_add_u32 v239, v239, 6, v246
    v_lshl_add_u32 v250, v250, 6, v245
    v_add_f32 v193, 1.0, v193
    v_rcp_f32 v191, v191
    v_exp_f32 v196, v196
    v_add_f32 v194, 1.0, v194
    v_rcp_f32 v192, v192
    v_smfmac_f32_32x32x32_bf16 v[220:235], v[172:175], v[80:87], v176
    ds_read_b64_tr_b16 v[180:181], v236
    ds_read_b64_tr_b16 v[182:183], v237
    ds_read_b64_tr_b16 v[184:185], v238
    ds_read_b64_tr_b16 v[186:187], v239
    ds_read_b128 v[172:175], v250 offset:7424
    ds_read_b32 v176, v250 offset:7440
    v_exp_f32 v197, v197
    v_add_f32 v195, 1.0, v195
    v_rcp_f32 v193, v193
    v_exp_f32 v198, v198
    v_mfma_f32_32x32x16_bf16 v[204:219], v[160:163], v[40:43], v[204:219]
    v_add_f32 v196, 1.0, v196
    v_rcp_f32 v194, v194
    v_exp_f32 v199, v199
    v_add_f32 v197, 1.0, v197
    v_mfma_f32_32x32x16_bf16 v[204:219], v[164:167], v[44:47], v[204:219]
    v_rcp_f32 v195, v195
    v_exp_f32 v200, v200
    v_add_f32 v198, 1.0, v198
    v_rcp_f32 v196, v196
    v_mfma_f32_32x32x16_bf16 v[220:235], v[152:155], v[16:19], v[220:235]
    ds_read_b128 v[236:239], v247 offset:256
    ds_read_b32 v240, v251 offset:256
    s_add_u32 s72, s72, 1
    v_exp_f32 v201, v201
    v_add_f32 v199, 1.0, v199
    v_rcp_f32 v197, v197
    v_exp_f32 v202, v202
    v_mfma_f32_32x32x16_bf16 v[220:235], v[156:159], v[20:23], v[220:235]
    v_add_f32 v200, 1.0, v200
    v_rcp_f32 v198, v198
    v_exp_f32 v203, v203
    v_add_f32 v201, 1.0, v201
    v_mfma_f32_32x32x16_bf16 v[220:235], v[160:163], v[24:27], v[220:235]
    v_rcp_f32 v199, v199
    v_add_f32 v202, 1.0, v202
    v_rcp_f32 v200, v200
    v_add_f32 v203, 1.0, v203
    v_rcp_f32 v201, v201
    v_mfma_f32_32x32x16_bf16 v[220:235], v[164:167], v[28:31], v[220:235]
    v_rcp_f32 v202, v202
    v_rcp_f32 v203, v203
    v_mul_f32 v204, v188, v204
    v_mul_f32 v205, v189, v205
    s_waitcnt lgkmcnt(0)
    v_smfmac_f32_32x32x32_bf16 v[88:103], v[180:183], v[188:195], v177
    v_mul_f32 v206, v190, v206
    v_mul_f32 v207, v191, v207
    v_mul_f32 v208, v192, v208
    v_mul_f32 v209, v193, v209
    v_mul_f32 v210, v194, v210
    v_mul_f32 v211, v195, v211
    v_mul_f32 v212, v196, v212
    v_smfmac_f32_32x32x32_bf16 v[88:103], v[184:187], v[196:203], v177
    v_mul_f32 v213, v197, v213
    v_mul_f32 v214, v198, v214
    v_mul_f32 v215, v199, v215
    v_mul_f32 v216, v200, v216
    v_mul_f32 v217, v201, v217
    v_mul_f32 v218, v202, v218
    v_mul_f32 v219, v203, v219
    v_smfmac_f32_32x32x32_bf16 v[104:119], v[180:183], v[204:211], v177
    s_waitcnt vmcnt(0)
    ds_read_b128 v[168:171], v244
    v_exp_f32 v220, v220
    v_exp_f32 v221, v221
    v_exp_f32 v222, v222
    v_add_f32 v220, 1.0, v220
    v_smfmac_f32_32x32x32_bf16 v[104:119], v[184:187], v[212:219], v177
    v_exp_f32 v223, v223
    v_add_f32 v221, 1.0, v221
    v_exp_f32 v224, v224
    v_add_f32 v222, 1.0, v222
    v_rcp_f32 v220, v220
    s_waitcnt lgkmcnt(0)
    v_mfma_f32_32x32x16_bf16 v[188:203], v[168:171], v[64:67], 0
    v_exp_f32 v225, v225
    v_add_f32 v223, 1.0, v223
    v_rcp_f32 v221, v221
    v_exp_f32 v226, v226
    v_mfma_f32_32x32x16_bf16 v[204:219], v[152:155], v[48:51], 0
    ds_read_b128 v[152:155], v243 offset:0
    v_add_f32 v224, 1.0, v224
    v_rcp_f32 v222, v222
    v_exp_f32 v227, v227
    v_mfma_f32_32x32x16_bf16 v[204:219], v[156:159], v[52:55], v[204:219]
    ds_read_b128 v[156:159], v243 offset:16
    v_add_f32 v225, 1.0, v225
    v_rcp_f32 v223, v223
    v_exp_f32 v228, v228
    v_add_f32 v226, 1.0, v226
    v_rcp_f32 v224, v224
    v_smfmac_f32_32x32x32_bf16 v[188:203], v[172:175], v[72:79], v176
    v_exp_f32 v229, v229
    v_add_f32 v227, 1.0, v227
    v_rcp_f32 v225, v225
    v_exp_f32 v230, v230
    v_mfma_f32_32x32x16_bf16 v[204:219], v[160:163], v[56:59], v[204:219]
    ds_read_b128 v[160:163], v243 offset:32
    v_add_f32 v228, 1.0, v228
    v_rcp_f32 v226, v226
    v_exp_f32 v231, v231
    v_add_f32 v229, 1.0, v229
    v_mfma_f32_32x32x16_bf16 v[204:219], v[164:167], v[60:63], v[204:219]
    ds_read_b128 v[164:167], v243 offset:48
    v_rcp_f32 v227, v227
    v_exp_f32 v232, v232
    v_add_f32 v230, 1.0, v230
    v_rcp_f32 v228, v228
    s_waitcnt lgkmcnt(3)
    v_mfma_f32_32x32x16_bf16 v[188:203], v[152:155], v[0:3], v[188:203]
    v_exp_f32 v233, v233
    v_add_f32 v231, 1.0, v231
    v_rcp_f32 v229, v229
    v_exp_f32 v234, v234
    s_waitcnt lgkmcnt(2)
    v_mfma_f32_32x32x16_bf16 v[188:203], v[156:159], v[4:7], v[188:203]
    v_add_f32 v232, 1.0, v232
    v_rcp_f32 v230, v230
    v_exp_f32 v235, v235
    v_add_f32 v233, 1.0, v233
    s_waitcnt lgkmcnt(1)
    v_mfma_f32_32x32x16_bf16 v[188:203], v[160:163], v[8:11], v[188:203]
    v_rcp_f32 v231, v231
    v_add_f32 v234, 1.0, v234
    v_rcp_f32 v232, v232
    v_add_f32 v235, 1.0, v235
    v_rcp_f32 v233, v233
    s_waitcnt lgkmcnt(0)
    v_mfma_f32_32x32x16_bf16 v[188:203], v[164:167], v[12:15], v[188:203]
    s_cmp_lt_i32 s72, s38
    s_cbranch_scc0 K2_ND_0
    s_add_u32 m0, s74, 0
    v_mad_u32_u16 v236, v236, s75, v241 op_sel:[1,0,0,0]
    buffer_load_dwordx4 v236, s[16:19], 0 offen lds
    s_add_u32 m0, s74, 1040
    v_mad_u32_u16 v237, v237, s75, v241 op_sel:[1,0,0,0]
    buffer_load_dwordx4 v237, s[16:19], 0 offen lds
    s_add_u32 m0, s74, 2080
    v_mad_u32_u16 v238, v238, s75, v241 op_sel:[1,0,0,0]
    buffer_load_dwordx4 v238, s[16:19], 0 offen lds
    s_add_u32 m0, s74, 3120
    v_mad_u32_u16 v239, v239, s75, v241 op_sel:[1,0,0,0]
    buffer_load_dwordx4 v239, s[16:19], 0 offen lds
    s_add_u32 m0, s74, 4160
    v_add_u32 v240, v240, v242
    buffer_load_dwordx4 v240, s[20:23], 0 offen lds
K2_ND_0:
    v_rcp_f32 v234, v234
    v_rcp_f32 v235, v235
    v_mul_f32 v204, v220, v204
    v_mul_f32 v205, v221, v205
    v_smfmac_f32_32x32x32_bf16 v[120:135], v[180:183], v[220:227], v177
    v_mul_f32 v206, v222, v206
    v_mul_f32 v207, v223, v207
    v_mul_f32 v208, v224, v208
    v_mul_f32 v209, v225, v209
    v_mul_f32 v210, v226, v210
    v_mul_f32 v211, v227, v211
    v_mul_f32 v212, v228, v212
    v_smfmac_f32_32x32x32_bf16 v[120:135], v[184:187], v[228:235], v177
    v_mul_f32 v213, v229, v213
    v_mul_f32 v214, v230, v214
    v_mul_f32 v215, v231, v215
    v_mul_f32 v216, v232, v216
    v_mul_f32 v217, v233, v217
    v_mul_f32 v218, v234, v218
    v_mul_f32 v219, v235, v219
    s_cmp_ge_u32 s72, s87
    s_cbranch_scc1 K2_EV0
K2_EVR0:
    v_smfmac_f32_32x32x32_bf16 v[136:151], v[180:183], v[204:211], v177
    ds_read_u8 v236, v248 offset:128
    ds_read_u8 v237, v248 offset:144
    ds_read_u8 v238, v248 offset:192
    ds_read_u8 v239, v248 offset:208
    ds_read_u8 v250, v249 offset:256
    v_exp_f32 v188, v188
    v_exp_f32 v189, v189
    v_exp_f32 v190, v190
    v_add_f32 v188, 1.0, v188
    v_smfmac_f32_32x32x32_bf16 v[136:151], v[184:187], v[212:219], v177
    v_exp_f32 v191, v191
    v_add_f32 v189, 1.0, v189
    v_exp_f32 v192, v192
    v_add_f32 v190, 1.0, v190
    v_rcp_f32 v188, v188
    v_mfma_f32_32x32x16_bf16 v[220:235], v[168:171], v[68:71], 0
    v_exp_f32 v193, v193
    v_add_f32 v191, 1.0, v191
    v_rcp_f32 v189, v189
    v_exp_f32 v194, v194
    v_mfma_f32_32x32x16_bf16 v[204:219], v[152:155], v[32:35], 0
    v_add_f32 v192, 1.0, v192
    v_rcp_f32 v190, v190
    v_exp_f32 v195, v195
    v_mfma_f32_32x32x16_bf16 v[204:219], v[156:159], v[36:39], v[204:219]
    s_waitcnt lgkmcnt(0)
    v_lshl_add_u32 v236, v236, 6, v246
    v_lshl_add_u32 v237, v237, 6, v246
    v_lshl_add_u32 v238, v238, 6, v246
    v_lshl_add_u32 v239, v239, 6, v246
    v_lshl_add_u32 v250, v250, 6, v245
    v_add_f32 v193, 1.0, v193
    v_rcp_f32 v191, v191
    v_exp_f32 v196, v196
    v_add_f32 v194, 1.0, v194
    v_rcp_f32 v192, v192
    v_smfmac_f32_32x32x32_bf16 v[220:235], v[172:175], v[80:87], v176
    ds_read_b64_tr_b16 v[180:181], v236
    ds_read_b64_tr_b16 v[182:183], v237
    ds_read_b64_tr_b16 v[184:185], v238
    ds_read_b64_tr_b16 v[186:187], v239
    ds_read_b128 v[172:175], v250 offset:7424
    ds_read_b32 v176, v250 offset:7440
    v_exp_f32 v197, v197
    v_add_f32 v195, 1.0, v195
    v_rcp_f32 v193, v193
    v_exp_f32 v198, v198
    v_mfma_f32_32x32x16_bf16 v[204:219], v[160:163], v[40:43], v[204:219]
    v_add_f32 v196, 1.0, v196
    v_rcp_f32 v194, v194
    v_exp_f32 v199, v199
    v_add_f32 v197, 1.0, v197
    v_mfma_f32_32x32x16_bf16 v[204:219], v[164:167], v[44:47], v[204:219]
    v_rcp_f32 v195, v195
    v_exp_f32 v200, v200
    v_add_f32 v198, 1.0, v198
    v_rcp_f32 v196, v196
    v_mfma_f32_32x32x16_bf16 v[220:235], v[152:155], v[16:19], v[220:235]
    ds_read_b128 v[236:239], v247 offset:384
    ds_read_b32 v240, v251 offset:384
    s_add_u32 s72, s72, 1
    v_exp_f32 v201, v201
    v_add_f32 v199, 1.0, v199
    v_rcp_f32 v197, v197
    v_exp_f32 v202, v202
    v_mfma_f32_32x32x16_bf16 v[220:235], v[156:159], v[20:23], v[220:235]
    v_add_f32 v200, 1.0, v200
    v_rcp_f32 v198, v198
    v_exp_f32 v203, v203
    v_add_f32 v201, 1.0, v201
    v_mfma_f32_32x32x16_bf16 v[220:235], v[160:163], v[24:27], v[220:235]
    v_rcp_f32 v199, v199
    v_add_f32 v202, 1.0, v202
    v_rcp_f32 v200, v200
    v_add_f32 v203, 1.0, v203
    v_rcp_f32 v201, v201
    v_mfma_f32_32x32x16_bf16 v[220:235], v[164:167], v[28:31], v[220:235]
    v_rcp_f32 v202, v202
    v_rcp_f32 v203, v203
    v_mul_f32 v204, v188, v204
    v_mul_f32 v205, v189, v205
    s_waitcnt lgkmcnt(0)
    v_smfmac_f32_32x32x32_bf16 v[88:103], v[180:183], v[188:195], v177
    v_mul_f32 v206, v190, v206
    v_mul_f32 v207, v191, v207
    v_mul_f32 v208, v192, v208
    v_mul_f32 v209, v193, v209
    v_mul_f32 v210, v194, v210
    v_mul_f32 v211, v195, v211
    v_mul_f32 v212, v196, v212
    v_smfmac_f32_32x32x32_bf16 v[88:103], v[184:187], v[196:203], v177
    v_mul_f32 v213, v197, v213
    v_mul_f32 v214, v198, v214
    v_mul_f32 v215, v199, v215
    v_mul_f32 v216, v200, v216
    v_mul_f32 v217, v201, v217
    v_mul_f32 v218, v202, v218
    v_mul_f32 v219, v203, v219
    v_smfmac_f32_32x32x32_bf16 v[104:119], v[180:183], v[204:211], v177
    s_waitcnt vmcnt(0)
    ds_read_b128 v[168:171], v244
    v_exp_f32 v220, v220
    v_exp_f32 v221, v221
    v_exp_f32 v222, v222
    v_add_f32 v220, 1.0, v220
    v_smfmac_f32_32x32x32_bf16 v[104:119], v[184:187], v[212:219], v177
    v_exp_f32 v223, v223
    v_add_f32 v221, 1.0, v221
    v_exp_f32 v224, v224
    v_add_f32 v222, 1.0, v222
    v_rcp_f32 v220, v220
    s_waitcnt lgkmcnt(0)
    v_mfma_f32_32x32x16_bf16 v[188:203], v[168:171], v[64:67], 0
    v_exp_f32 v225, v225
    v_add_f32 v223, 1.0, v223
    v_rcp_f32 v221, v221
    v_exp_f32 v226, v226
    v_mfma_f32_32x32x16_bf16 v[204:219], v[152:155], v[48:51], 0
    ds_read_b128 v[152:155], v243 offset:0
    v_add_f32 v224, 1.0, v224
    v_rcp_f32 v222, v222
    v_exp_f32 v227, v227
    v_mfma_f32_32x32x16_bf16 v[204:219], v[156:159], v[52:55], v[204:219]
    ds_read_b128 v[156:159], v243 offset:16
    v_add_f32 v225, 1.0, v225
    v_rcp_f32 v223, v223
    v_exp_f32 v228, v228
    v_add_f32 v226, 1.0, v226
    v_rcp_f32 v224, v224
    v_smfmac_f32_32x32x32_bf16 v[188:203], v[172:175], v[72:79], v176
    v_exp_f32 v229, v229
    v_add_f32 v227, 1.0, v227
    v_rcp_f32 v225, v225
    v_exp_f32 v230, v230
    v_mfma_f32_32x32x16_bf16 v[204:219], v[160:163], v[56:59], v[204:219]
    ds_read_b128 v[160:163], v243 offset:32
    v_add_f32 v228, 1.0, v228
    v_rcp_f32 v226, v226
    v_exp_f32 v231, v231
    v_add_f32 v229, 1.0, v229
    v_mfma_f32_32x32x16_bf16 v[204:219], v[164:167], v[60:63], v[204:219]
    ds_read_b128 v[164:167], v243 offset:48
    v_rcp_f32 v227, v227
    v_exp_f32 v232, v232
    v_add_f32 v230, 1.0, v230
    v_rcp_f32 v228, v228
    s_waitcnt lgkmcnt(3)
    v_mfma_f32_32x32x16_bf16 v[188:203], v[152:155], v[0:3], v[188:203]
    v_exp_f32 v233, v233
    v_add_f32 v231, 1.0, v231
    v_rcp_f32 v229, v229
    v_exp_f32 v234, v234
    s_waitcnt lgkmcnt(2)
    v_mfma_f32_32x32x16_bf16 v[188:203], v[156:159], v[4:7], v[188:203]
    v_add_f32 v232, 1.0, v232
    v_rcp_f32 v230, v230
    v_exp_f32 v235, v235
    v_add_f32 v233, 1.0, v233
    s_waitcnt lgkmcnt(1)
    v_mfma_f32_32x32x16_bf16 v[188:203], v[160:163], v[8:11], v[188:203]
    v_rcp_f32 v231, v231
    v_add_f32 v234, 1.0, v234
    v_rcp_f32 v232, v232
    v_add_f32 v235, 1.0, v235
    v_rcp_f32 v233, v233
    s_waitcnt lgkmcnt(0)
    v_mfma_f32_32x32x16_bf16 v[188:203], v[164:167], v[12:15], v[188:203]
    s_cmp_lt_i32 s72, s38
    s_cbranch_scc0 K2_ND_1
    s_add_u32 m0, s74, 0
    v_mad_u32_u16 v236, v236, s75, v241 op_sel:[1,0,0,0]
    buffer_load_dwordx4 v236, s[16:19], 0 offen lds
    s_add_u32 m0, s74, 1040
    v_mad_u32_u16 v237, v237, s75, v241 op_sel:[1,0,0,0]
    buffer_load_dwordx4 v237, s[16:19], 0 offen lds
    s_add_u32 m0, s74, 2080
    v_mad_u32_u16 v238, v238, s75, v241 op_sel:[1,0,0,0]
    buffer_load_dwordx4 v238, s[16:19], 0 offen lds
    s_add_u32 m0, s74, 3120
    v_mad_u32_u16 v239, v239, s75, v241 op_sel:[1,0,0,0]
    buffer_load_dwordx4 v239, s[16:19], 0 offen lds
    s_add_u32 m0, s74, 4160
    v_add_u32 v240, v240, v242
    buffer_load_dwordx4 v240, s[20:23], 0 offen lds
K2_ND_1:
    v_rcp_f32 v234, v234
    v_rcp_f32 v235, v235
    v_mul_f32 v204, v220, v204
    v_mul_f32 v205, v221, v205
    v_smfmac_f32_32x32x32_bf16 v[120:135], v[180:183], v[220:227], v177
    v_mul_f32 v206, v222, v206
    v_mul_f32 v207, v223, v207
    v_mul_f32 v208, v224, v208
    v_mul_f32 v209, v225, v209
    v_mul_f32 v210, v226, v210
    v_mul_f32 v211, v227, v211
    v_mul_f32 v212, v228, v212
    v_smfmac_f32_32x32x32_bf16 v[120:135], v[184:187], v[228:235], v177
    v_mul_f32 v213, v229, v213
    v_mul_f32 v214, v230, v214
    v_mul_f32 v215, v231, v215
    v_mul_f32 v216, v232, v216
    v_mul_f32 v217, v233, v217
    v_mul_f32 v218, v234, v218
    v_mul_f32 v219, v235, v219
    v_add_u32 v247, 0x100, v247
    v_add_u32 v249, 0x100, v249
    v_add_u32 v251, 0x100, v251
    v_add_u32 v248, 0x100, v248
    s_cmp_lt_u32 s72, s87
    s_cbranch_scc1 K2_LOOP
    s_cmp_ge_u32 s72, s73
    s_cbranch_scc1 K2_TAIL
    s_cmp_lg_u32 s72, s37
    s_cbranch_scc1 K2_SB1
    s_barrier
    s_mov_b32 s37, -1
K2_SB1:
    s_cmp_lg_u32 s72, s4
    s_cbranch_scc1 K2_PR1_0
    s_setprio 2
K2_PR1_0:
    s_cmp_lg_u32 s72, s5
    s_cbranch_scc1 K2_PR1_1
    s_setprio 1
K2_PR1_1:
    s_cmp_lg_u32 s72, s6
    s_cbranch_scc1 K2_PR1_2
    s_setprio 0
K2_PR1_2:
    s_lshl_b32 s10, s78, 8
    s_add_u32 s10, s10, s38
    s_cmp_eq_u32 s72, s10
    s_cbranch_scc1 K2_LT1
    s_mov_b32 s87, s73
    s_cmp_gt_i32 s4, s72
    s_cselect_b32 s10, s4, s87
    s_min_u32 s87, s87, s10
    s_cmp_gt_i32 s5, s72
    s_cselect_b32 s10, s5, s87
    s_min_u32 s87, s87, s10
    s_cmp_gt_i32 s6, s72
    s_cselect_b32 s10, s6, s87
    s_min_u32 s87, s87, s10
    s_cmp_gt_i32 s37, s72
    s_cselect_b32 s10, s37, s87
    s_min_u32 s87, s87, s10
    s_cmp_gt_i32 s38, s72
    s_cselect_b32 s10, s38, s87
    s_min_u32 s87, s87, s10
    s_branch K2_LOOP
K2_EV0:
    s_cmp_ge_u32 s72, s73
    s_cbranch_scc1 K2_TAIL
    s_cmp_lg_u32 s72, s37
    s_cbranch_scc1 K2_SB0
    s_barrier
    s_mov_b32 s37, -1
K2_SB0:
    s_cmp_lg_u32 s72, s4
    s_cbranch_scc1 K2_PR0_0
    s_setprio 2
K2_PR0_0:
    s_cmp_lg_u32 s72, s5
    s_cbranch_scc1 K2_PR0_1
    s_setprio 1
K2_PR0_1:
    s_cmp_lg_u32 s72, s6
    s_cbranch_scc1 K2_PR0_2
    s_setprio 0
K2_PR0_2:
    s_lshl_b32 s10, s78, 8
    s_add_u32 s10, s10, s38
    s_cmp_eq_u32 s72, s10
    s_cbranch_scc1 K2_LT0
    s_mov_b32 s87, s73
    s_cmp_gt_i32 s4, s72
    s_cselect_b32 s10, s4, s87
    s_min_u32 s87, s87, s10
    s_cmp_gt_i32 s5, s72
    s_cselect_b32 s10, s5, s87
    s_min_u32 s87, s87, s10
    s_cmp_gt_i32 s6, s72
    s_cselect_b32 s10, s6, s87
    s_min_u32 s87, s87, s10
    s_cmp_gt_i32 s37, s72
    s_cselect_b32 s10, s37, s87
    s_min_u32 s87, s87, s10
    s_cmp_gt_i32 s38, s72
    s_cselect_b32 s10, s38, s87
    s_min_u32 s87, s87, s10
    s_branch K2_EVR0
K2_LT0:
    v_add_u32 v248, 128, v248
K2_LT1:
    s_sub_u32 s10, s15, s76
    s_sub_u32 s10, s10, 4
    s_and_b32 s10, s10, 127
    s_cmp_lt_u32 s10, 32
    s_cbranch_scc1 K2_LG1
    s_cmp_lt_u32 s10, 64
    s_cbranch_scc1 K2_LG2
    s_cmp_lt_u32 s10, 96
    s_cbranch_scc1 K2_LG3
    v_smfmac_f32_32x32x32_bf16 v[136:151], v[180:183], v[204:211], v177
    ds_read_u8 v236, v248 offset:0
    ds_read_u8 v237, v248 offset:16
    ds_read_u8 v238, v248 offset:64
    ds_read_u8 v239, v248 offset:80
    v_exp_f32 v188, v188
    v_exp_f32 v189, v189
    v_exp_f32 v190, v190
    v_add_f32 v188, 1.0, v188
    v_smfmac_f32_32x32x32_bf16 v[136:151], v[184:187], v[212:219], v177
    v_lshlrev_b32 v252, 4, v254
    v_and_b32 v247, 31, v254
    v_and_b32 v245, 32, v254
    v_mul_u32_u24 v249, 144, v247
    v_lshrrev_b32 v251, 2, v245
    v_lshl_add_u32 v247, v247, 6, v251
    v_lshl_add_u32 v249, v245, 1, v249
    v_add_u32 v249, s74, v249
    v_lshrrev_b32 v251, 3, v254
    v_lshl_add_u32 v251, v251, 4, v252
    v_add_u32 v251, s70, v251
    v_exp_f32 v191, v191
    v_add_f32 v189, 1.0, v189
    v_exp_f32 v192, v192
    v_add_f32 v190, 1.0, v190
    v_rcp_f32 v188, v188
    v_mfma_f32_32x32x16_bf16 v[220:235], v[168:171], v[68:71], 0
    v_exp_f32 v193, v193
    v_add_f32 v191, 1.0, v191
    v_rcp_f32 v189, v189
    v_exp_f32 v194, v194
    v_mfma_f32_32x32x16_bf16 v[204:219], v[152:155], v[32:35], 0
    v_add_f32 v192, 1.0, v192
    v_rcp_f32 v190, v190
    v_exp_f32 v195, v195
    v_mfma_f32_32x32x16_bf16 v[204:219], v[156:159], v[36:39], v[204:219]
    s_waitcnt lgkmcnt(0)
    v_lshl_add_u32 v236, v236, 6, v246
    v_lshl_add_u32 v237, v237, 6, v246
    v_lshl_add_u32 v238, v238, 6, v246
    v_lshl_add_u32 v239, v239, 6, v246
    v_add_f32 v193, 1.0, v193
    v_rcp_f32 v191, v191
    v_exp_f32 v196, v196
    v_add_f32 v194, 1.0, v194
    v_rcp_f32 v192, v192
    v_smfmac_f32_32x32x32_bf16 v[220:235], v[172:175], v[80:87], v176
    ds_read_b64_tr_b16 v[180:181], v236
    ds_read_b64_tr_b16 v[182:183], v237
    ds_read_b64_tr_b16 v[184:185], v238
    ds_read_b64_tr_b16 v[186:187], v239
    v_exp_f32 v197, v197
    v_add_f32 v195, 1.0, v195
    v_rcp_f32 v193, v193
    v_exp_f32 v198, v198
    v_mfma_f32_32x32x16_bf16 v[204:219], v[160:163], v[40:43], v[204:219]
    v_add_f32 v196, 1.0, v196
    v_rcp_f32 v194, v194
    v_exp_f32 v199, v199
    v_add_f32 v197, 1.0, v197
    v_mfma_f32_32x32x16_bf16 v[204:219], v[164:167], v[44:47], v[204:219]
    v_rcp_f32 v195, v195
    v_exp_f32 v200, v200
    v_add_f32 v198, 1.0, v198
    v_rcp_f32 v196, v196
    v_mfma_f32_32x32x16_bf16 v[220:235], v[152:155], v[16:19], v[220:235]
    v_exp_f32 v201, v201
    v_add_f32 v199, 1.0, v199
    v_rcp_f32 v197, v197
    v_exp_f32 v202, v202
    v_mfma_f32_32x32x16_bf16 v[220:235], v[156:159], v[20:23], v[220:235]
    v_add_f32 v200, 1.0, v200
    v_rcp_f32 v198, v198
    v_exp_f32 v203, v203
    v_add_f32 v201, 1.0, v201
    v_mfma_f32_32x32x16_bf16 v[220:235], v[160:163], v[24:27], v[220:235]
    v_rcp_f32 v199, v199
    v_add_f32 v202, 1.0, v202
    v_rcp_f32 v200, v200
    v_add_f32 v203, 1.0, v203
    v_rcp_f32 v201, v201
    v_mfma_f32_32x32x16_bf16 v[220:235], v[164:167], v[28:31], v[220:235]
    ds_read2_b64 v[64:67], v247 offset0:0 offset1:2
    ds_read2_b64 v[68:71], v247 offset0:4 offset1:6
    ds_read_b128 v[0:3], v252 offset:52736
    ds_read_b128 v[4:7], v252 offset:53760
    ds_read_b128 v[8:11], v252 offset:54784
    ds_read_b128 v[12:15], v252 offset:55808
    ds_read_b128 v[16:19], v252 offset:56832
    ds_read_b128 v[20:23], v252 offset:57856
    ds_read_b128 v[24:27], v252 offset:58880
    ds_read_b128 v[28:31], v252 offset:59904
    v_rcp_f32 v202, v202
    v_rcp_f32 v203, v203
    v_mul_f32 v204, v188, v204
    v_mul_f32 v205, v189, v205
    s_waitcnt lgkmcnt(10)
    v_smfmac_f32_32x32x32_bf16 v[88:103], v[180:183], v[188:195], v177
    v_mul_f32 v206, v190, v206
    v_mul_f32 v207, v191, v207
    v_mul_f32 v208, v192, v208
    v_mul_f32 v209, v193, v209
    v_mul_f32 v210, v194, v210
    v_mul_f32 v211, v195, v211
    v_mul_f32 v212, v196, v212
    v_smfmac_f32_32x32x32_bf16 v[88:103], v[184:187], v[196:203], v177
    v_mul_f32 v213, v197, v213
    v_mul_f32 v214, v198, v214
    v_mul_f32 v215, v199, v215
    v_mul_f32 v216, v200, v216
    v_mul_f32 v217, v201, v217
    v_mul_f32 v218, v202, v218
    v_mul_f32 v219, v203, v219
    v_smfmac_f32_32x32x32_bf16 v[104:119], v[180:183], v[204:211], v177
    v_exp_f32 v220, v220
    v_exp_f32 v221, v221
    v_exp_f32 v222, v222
    v_add_f32 v220, 1.0, v220
    v_exp_f32 v223, v223
    v_smfmac_f32_32x32x32_bf16 v[104:119], v[184:187], v[212:219], v177
    v_add_f32 v221, 1.0, v221
    v_exp_f32 v224, v224
    v_add_f32 v222, 1.0, v222
    v_rcp_f32 v220, v220
    v_exp_f32 v225, v225
    v_add_f32 v223, 1.0, v223
    v_mfma_f32_32x32x16_bf16 v[204:219], v[152:155], v[48:51], 0
    ds_read_b128 v[152:155], v253 offset:0
    v_rcp_f32 v221, v221
    v_exp_f32 v226, v226
    v_add_f32 v224, 1.0, v224
    v_rcp_f32 v222, v222
    v_exp_f32 v227, v227
    v_mfma_f32_32x32x16_bf16 v[204:219], v[156:159], v[52:55], v[204:219]
    ds_read_b128 v[156:159], v253 offset:16
    v_add_f32 v225, 1.0, v225
    v_rcp_f32 v223, v223
    v_exp_f32 v228, v228
    v_add_f32 v226, 1.0, v226
    v_rcp_f32 v224, v224
    v_exp_f32 v229, v229
    v_mfma_f32_32x32x16_bf16 v[204:219], v[160:163], v[56:59], v[204:219]
    ds_read_b128 v[160:163], v253 offset:32
    v_add_f32 v227, 1.0, v227
    v_rcp_f32 v225, v225
    v_exp_f32 v230, v230
    v_add_f32 v228, 1.0, v228
    v_rcp_f32 v226, v226
    v_mfma_f32_32x32x16_bf16 v[204:219], v[164:167], v[60:63], v[204:219]
    ds_read_b128 v[164:167], v253 offset:48
    v_exp_f32 v231, v231
    v_add_f32 v229, 1.0, v229
    v_rcp_f32 v227, v227
    v_exp_f32 v232, v232
    v_add_f32 v230, 1.0, v230
    v_rcp_f32 v228, v228
    v_exp_f32 v233, v233
    v_add_f32 v231, 1.0, v231
    v_rcp_f32 v229, v229
    v_exp_f32 v234, v234
    v_add_f32 v232, 1.0, v232
    v_rcp_f32 v230, v230
    v_exp_f32 v235, v235
    v_add_f32 v233, 1.0, v233
    v_rcp_f32 v231, v231
    v_add_f32 v234, 1.0, v234
    v_rcp_f32 v232, v232
    v_add_f32 v235, 1.0, v235
    v_rcp_f32 v233, v233
    v_rcp_f32 v234, v234
    v_rcp_f32 v235, v235
    v_mul_f32 v204, v220, v204
    v_mul_f32 v205, v221, v205
    v_smfmac_f32_32x32x32_bf16 v[120:135], v[180:183], v[220:227], v177
    v_mul_f32 v206, v222, v206
    v_mul_f32 v207, v223, v207
    v_mul_f32 v208, v224, v208
    v_mul_f32 v209, v225, v209
    v_mul_f32 v210, v226, v210
    v_mul_f32 v211, v227, v211
    v_mul_f32 v212, v228, v212
    v_smfmac_f32_32x32x32_bf16 v[120:135], v[184:187], v[228:235], v177
    v_mul_f32 v213, v229, v213
    v_mul_f32 v214, v230, v214
    v_mul_f32 v215, v231, v215
    v_mul_f32 v216, v232, v216
    v_mul_f32 v217, v233, v217
    v_mul_f32 v218, v234, v218
    v_mul_f32 v219, v235, v219
    v_smfmac_f32_32x32x32_bf16 v[136:151], v[180:183], v[204:211], v177
    s_nop 0
    v_smfmac_f32_32x32x32_bf16 v[136:151], v[184:187], v[212:219], v177
    s_branch K2_EPI2
K2_LG3:
    v_smfmac_f32_32x32x32_bf16 v[136:151], v[180:183], v[204:211], v177
    ds_read_u8 v236, v248 offset:0
    ds_read_u8 v237, v248 offset:16
    ds_read_u8 v238, v248 offset:64
    ds_read_u8 v239, v248 offset:80
    v_exp_f32 v188, v188
    v_exp_f32 v189, v189
    v_exp_f32 v190, v190
    v_smfmac_f32_32x32x32_bf16 v[136:151], v[184:187], v[212:219], v177
    v_lshlrev_b32 v252, 4, v254
    v_and_b32 v247, 31, v254
    v_and_b32 v245, 32, v254
    v_mul_u32_u24 v249, 144, v247
    v_lshrrev_b32 v251, 2, v245
    v_lshl_add_u32 v247, v247, 6, v251
    v_lshl_add_u32 v249, v245, 1, v249
    v_add_u32 v249, s74, v249
    v_lshrrev_b32 v251, 3, v254
    v_lshl_add_u32 v251, v251, 4, v252
    v_add_u32 v251, s70, v251
    v_add_f32 v188, 1.0, v188
    v_exp_f32 v191, v191
    v_add_f32 v189, 1.0, v189
    v_exp_f32 v192, v192
    v_mfma_f32_32x32x16_bf16 v[220:235], v[168:171], v[68:71], 0
    v_add_f32 v190, 1.0, v190
    v_rcp_f32 v188, v188
    v_exp_f32 v193, v193
    v_mfma_f32_32x32x16_bf16 v[204:219], v[152:155], v[32:35], 0
    v_add_f32 v191, 1.0, v191
    v_rcp_f32 v189, v189
    v_exp_f32 v194, v194
    v_mfma_f32_32x32x16_bf16 v[204:219], v[156:159], v[36:39], v[204:219]
    s_waitcnt lgkmcnt(0)
    v_lshl_add_u32 v236, v236, 6, v246
    v_lshl_add_u32 v237, v237, 6, v246
    v_lshl_add_u32 v238, v238, 6, v246
    v_lshl_add_u32 v239, v239, 6, v246
    v_add_f32 v192, 1.0, v192
    v_rcp_f32 v190, v190
    v_exp_f32 v195, v195
    v_smfmac_f32_32x32x32_bf16 v[220:235], v[172:175], v[80:87], v176
    ds_read_b64_tr_b16 v[180:181], v236
    ds_read_b64_tr_b16 v[182:183], v237
    ds_read_b64_tr_b16 v[184:185], v238
    ds_read_b64_tr_b16 v[186:187], v239
    v_add_f32 v193, 1.0, v193
    v_rcp_f32 v191, v191
    v_exp_f32 v196, v196
    v_mfma_f32_32x32x16_bf16 v[204:219], v[160:163], v[40:43], v[204:219]
    v_add_f32 v194, 1.0, v194
    v_rcp_f32 v192, v192
    v_exp_f32 v197, v197
    v_mfma_f32_32x32x16_bf16 v[204:219], v[164:167], v[44:47], v[204:219]
    v_add_f32 v195, 1.0, v195
    v_rcp_f32 v193, v193
    v_exp_f32 v198, v198
    v_mfma_f32_32x32x16_bf16 v[220:235], v[152:155], v[16:19], v[220:235]
    v_add_f32 v196, 1.0, v196
    v_rcp_f32 v194, v194
    v_exp_f32 v199, v199
    v_mfma_f32_32x32x16_bf16 v[220:235], v[156:159], v[20:23], v[220:235]
    v_add_f32 v197, 1.0, v197
    v_rcp_f32 v195, v195
    v_add_f32 v198, 1.0, v198
    v_mfma_f32_32x32x16_bf16 v[220:235], v[160:163], v[24:27], v[220:235]
    v_rcp_f32 v196, v196
    v_add_f32 v199, 1.0, v199
    v_rcp_f32 v197, v197
    v_mfma_f32_32x32x16_bf16 v[220:235], v[164:167], v[28:31], v[220:235]
    ds_read2_b64 v[64:67], v247 offset0:0 offset1:2
    ds_read2_b64 v[68:71], v247 offset0:4 offset1:6
    ds_read_b128 v[0:3], v252 offset:52736
    ds_read_b128 v[4:7], v252 offset:53760
    ds_read_b128 v[8:11], v252 offset:54784
    ds_read_b128 v[12:15], v252 offset:55808
    ds_read_b128 v[16:19], v252 offset:56832
    ds_read_b128 v[20:23], v252 offset:57856
    ds_read_b128 v[24:27], v252 offset:58880
    ds_read_b128 v[28:31], v252 offset:59904
    v_rcp_f32 v198, v198
    v_rcp_f32 v199, v199
    v_mul_f32 v204, v188, v204
    v_mul_f32 v205, v189, v205
    s_waitcnt lgkmcnt(10)
    v_smfmac_f32_32x32x32_bf16 v[88:103], v[180:183], v[188:195], v177
    v_mul_f32 v206, v190, v206
    v_mul_f32 v207, v191, v207
    v_mul_f32 v208, v192, v208
    v_mul_f32 v209, v193, v209
    v_mul_f32 v210, v194, v210
    v_smfmac_f32_32x32x32_bf16 v[88:103], v[184:187], v[196:203], v177
    v_mul_f32 v211, v195, v211
    v_mul_f32 v212, v196, v212
    v_mul_f32 v213, v197, v213
    v_mul_f32 v214, v198, v214
    v_mul_f32 v215, v199, v215
    v_smfmac_f32_32x32x32_bf16 v[104:119], v[180:183], v[204:211], v177
    v_exp_f32 v220, v220
    v_exp_f32 v221, v221
    v_exp_f32 v222, v222
    v_add_f32 v220, 1.0, v220
    v_smfmac_f32_32x32x32_bf16 v[104:119], v[184:187], v[212:219], v177
    v_exp_f32 v223, v223
    v_add_f32 v221, 1.0, v221
    v_exp_f32 v224, v224
    v_add_f32 v222, 1.0, v222
    v_rcp_f32 v220, v220
    v_mfma_f32_32x32x16_bf16 v[204:219], v[152:155], v[48:51], 0
    ds_read_b128 v[152:155], v253 offset:0
    v_exp_f32 v225, v225
    v_add_f32 v223, 1.0, v223
    v_rcp_f32 v221, v221
    v_exp_f32 v226, v226
    v_mfma_f32_32x32x16_bf16 v[204:219], v[156:159], v[52:55], v[204:219]
    ds_read_b128 v[156:159], v253 offset:16
    v_add_f32 v224, 1.0, v224
    v_rcp_f32 v222, v222
    v_exp_f32 v227, v227
    v_mfma_f32_32x32x16_bf16 v[204:219], v[160:163], v[56:59], v[204:219]
    ds_read_b128 v[160:163], v253 offset:32
    v_add_f32 v225, 1.0, v225
    v_rcp_f32 v223, v223
    v_exp_f32 v228, v228
    v_add_f32 v226, 1.0, v226
    v_rcp_f32 v224, v224
    v_mfma_f32_32x32x16_bf16 v[204:219], v[164:167], v[60:63], v[204:219]
    ds_read_b128 v[164:167], v253 offset:48
    v_exp_f32 v229, v229
    v_add_f32 v227, 1.0, v227
    v_rcp_f32 v225, v225
    v_exp_f32 v230, v230
    v_add_f32 v228, 1.0, v228
    v_rcp_f32 v226, v226
    v_exp_f32 v231, v231
    v_add_f32 v229, 1.0, v229
    v_rcp_f32 v227, v227
    v_add_f32 v230, 1.0, v230
    v_rcp_f32 v228, v228
    v_add_f32 v231, 1.0, v231
    v_rcp_f32 v229, v229
    v_rcp_f32 v230, v230
    v_rcp_f32 v231, v231
    v_mul_f32 v204, v220, v204
    v_mul_f32 v205, v221, v205
    v_smfmac_f32_32x32x32_bf16 v[120:135], v[180:183], v[220:227], v177
    v_mul_f32 v206, v222, v206
    v_mul_f32 v207, v223, v207
    v_mul_f32 v208, v224, v208
    v_mul_f32 v209, v225, v209
    v_mul_f32 v210, v226, v210
    v_smfmac_f32_32x32x32_bf16 v[120:135], v[184:187], v[228:235], v177
    v_mul_f32 v211, v227, v211
    v_mul_f32 v212, v228, v212
    v_mul_f32 v213, v229, v213
    v_mul_f32 v214, v230, v214
    v_mul_f32 v215, v231, v215
    v_smfmac_f32_32x32x32_bf16 v[136:151], v[180:183], v[204:211], v177
    s_nop 0
    v_smfmac_f32_32x32x32_bf16 v[136:151], v[184:187], v[212:219], v177
    s_branch K2_EPI2
K2_LG2:
    v_smfmac_f32_32x32x32_bf16 v[136:151], v[180:183], v[204:211], v177
    ds_read_u8 v236, v248 offset:0
    ds_read_u8 v237, v248 offset:16
    ds_read_u8 v238, v248 offset:64
    ds_read_u8 v239, v248 offset:80
    v_exp_f32 v188, v188
    v_exp_f32 v189, v189
    v_smfmac_f32_32x32x32_bf16 v[136:151], v[184:187], v[212:219], v177
    v_lshlrev_b32 v252, 4, v254
    v_and_b32 v247, 31, v254
    v_and_b32 v245, 32, v254
    v_mul_u32_u24 v249, 144, v247
    v_lshrrev_b32 v251, 2, v245
    v_lshl_add_u32 v247, v247, 6, v251
    v_lshl_add_u32 v249, v245, 1, v249
    v_add_u32 v249, s74, v249
    v_lshrrev_b32 v251, 3, v254
    v_lshl_add_u32 v251, v251, 4, v252
    v_add_u32 v251, s70, v251
    v_exp_f32 v190, v190
    v_add_f32 v188, 1.0, v188
    v_mfma_f32_32x32x16_bf16 v[220:235], v[168:171], v[68:71], 0
    v_exp_f32 v191, v191
    v_add_f32 v189, 1.0, v189
    v_exp_f32 v192, v192
    v_mfma_f32_32x32x16_bf16 v[204:219], v[152:155], v[32:35], 0
    v_add_f32 v190, 1.0, v190
    v_rcp_f32 v188, v188
    v_mfma_f32_32x32x16_bf16 v[204:219], v[156:159], v[36:39], v[204:219]
    s_waitcnt lgkmcnt(0)
    v_lshl_add_u32 v236, v236, 6, v246
    v_lshl_add_u32 v237, v237, 6, v246
    v_lshl_add_u32 v238, v238, 6, v246
    v_lshl_add_u32 v239, v239, 6, v246
    v_exp_f32 v193, v193
    v_smfmac_f32_32x32x32_bf16 v[220:235], v[172:175], v[80:87], v176
    ds_read_b64_tr_b16 v[180:181], v236
    ds_read_b64_tr_b16 v[182:183], v237
    ds_read_b64_tr_b16 v[184:185], v238
    ds_read_b64_tr_b16 v[186:187], v239
    v_add_f32 v191, 1.0, v191
    v_rcp_f32 v189, v189
    v_exp_f32 v194, v194
    v_mfma_f32_32x32x16_bf16 v[204:219], v[160:163], v[40:43], v[204:219]
    v_add_f32 v192, 1.0, v192
    v_rcp_f32 v190, v190
    v_mfma_f32_32x32x16_bf16 v[204:219], v[164:167], v[44:47], v[204:219]
    v_exp_f32 v195, v195
    v_mfma_f32_32x32x16_bf16 v[220:235], v[152:155], v[16:19], v[220:235]
    v_add_f32 v193, 1.0, v193
    v_rcp_f32 v191, v191
    v_add_f32 v194, 1.0, v194
    v_mfma_f32_32x32x16_bf16 v[220:235], v[156:159], v[20:23], v[220:235]
    v_rcp_f32 v192, v192
    v_add_f32 v195, 1.0, v195
    v_mfma_f32_32x32x16_bf16 v[220:235], v[160:163], v[24:27], v[220:235]
    v_rcp_f32 v193, v193
    v_rcp_f32 v194, v194
    v_mfma_f32_32x32x16_bf16 v[220:235], v[164:167], v[28:31], v[220:235]
    ds_read2_b64 v[64:67], v247 offset0:0 offset1:2
    ds_read2_b64 v[68:71], v247 offset0:4 offset1:6
    ds_read_b128 v[0:3], v252 offset:52736
    ds_read_b128 v[4:7], v252 offset:53760
    ds_read_b128 v[8:11], v252 offset:54784
    ds_read_b128 v[12:15], v252 offset:55808
    ds_read_b128 v[16:19], v252 offset:56832
    ds_read_b128 v[20:23], v252 offset:57856
    ds_read_b128 v[24:27], v252 offset:58880
    ds_read_b128 v[28:31], v252 offset:59904
    v_rcp_f32 v195, v195
    v_mul_f32 v204, v188, v204
    v_mul_f32 v205, v189, v205
    v_mul_f32 v206, v190, v206
    s_waitcnt lgkmcnt(10)
    v_smfmac_f32_32x32x32_bf16 v[88:103], v[180:183], v[188:195], v177
    v_mul_f32 v207, v191, v207
    v_mul_f32 v208, v192, v208
    v_mul_f32 v209, v193, v209
    v_mul_f32 v210, v194, v210
    v_mul_f32 v211, v195, v211
    s_nop 1
    v_smfmac_f32_32x32x32_bf16 v[104:119], v[180:183], v[204:211], v177
    v_exp_f32 v220, v220
    v_exp_f32 v221, v221
    v_exp_f32 v222, v222
    v_mfma_f32_32x32x16_bf16 v[204:219], v[152:155], v[48:51], 0
    ds_read_b128 v[152:155], v253 offset:0
    v_add_f32 v220, 1.0, v220
    v_exp_f32 v223, v223
    v_add_f32 v221, 1.0, v221
    v_mfma_f32_32x32x16_bf16 v[204:219], v[156:159], v[52:55], v[204:219]
    ds_read_b128 v[156:159], v253 offset:16
    v_exp_f32 v224, v224
    v_add_f32 v222, 1.0, v222
    v_rcp_f32 v220, v220
    v_mfma_f32_32x32x16_bf16 v[204:219], v[160:163], v[56:59], v[204:219]
    ds_read_b128 v[160:163], v253 offset:32
    v_exp_f32 v225, v225
    v_add_f32 v223, 1.0, v223
    v_rcp_f32 v221, v221
    v_mfma_f32_32x32x16_bf16 v[204:219], v[164:167], v[60:63], v[204:219]
    ds_read_b128 v[164:167], v253 offset:48
    v_exp_f32 v226, v226
    v_add_f32 v224, 1.0, v224
    v_rcp_f32 v222, v222
    v_exp_f32 v227, v227
    v_add_f32 v225, 1.0, v225
    v_rcp_f32 v223, v223
    v_add_f32 v226, 1.0, v226
    v_rcp_f32 v224, v224
    v_add_f32 v227, 1.0, v227
    v_rcp_f32 v225, v225
    v_rcp_f32 v226, v226
    v_rcp_f32 v227, v227
    v_mul_f32 v204, v220, v204
    v_mul_f32 v205, v221, v205
    v_mul_f32 v206, v222, v206
    v_smfmac_f32_32x32x32_bf16 v[120:135], v[180:183], v[220:227], v177
    v_mul_f32 v207, v223, v207
    v_mul_f32 v208, v224, v208
    v_mul_f32 v209, v225, v209
    v_mul_f32 v210, v226, v210
    v_mul_f32 v211, v227, v211
    s_nop 1
    v_smfmac_f32_32x32x32_bf16 v[136:151], v[180:183], v[204:211], v177
    s_branch K2_EPI2
K2_LG1:
    v_smfmac_f32_32x32x32_bf16 v[136:151], v[180:183], v[204:211], v177
    ds_read_u8 v236, v248 offset:0
    ds_read_u8 v237, v248 offset:16
    ds_read_u8 v238, v248 offset:64
    ds_read_u8 v239, v248 offset:80
    v_exp_f32 v188, v188
    v_smfmac_f32_32x32x32_bf16 v[136:151], v[184:187], v[212:219], v177
    v_lshlrev_b32 v252, 4, v254
    v_and_b32 v247, 31, v254
    v_and_b32 v245, 32, v254
    v_mul_u32_u24 v249, 144, v247
    v_lshrrev_b32 v251, 2, v245
    v_lshl_add_u32 v247, v247, 6, v251
    v_lshl_add_u32 v249, v245, 1, v249
    v_add_u32 v249, s74, v249
    v_lshrrev_b32 v251, 3, v254
    v_lshl_add_u32 v251, v251, 4, v252
    v_add_u32 v251, s70, v251
    v_exp_f32 v189, v189
    v_mfma_f32_32x32x16_bf16 v[220:235], v[168:171], v[68:71], 0
    v_exp_f32 v190, v190
    v_mfma_f32_32x32x16_bf16 v[204:219], v[152:155], v[32:35], 0
    v_add_f32 v188, 1.0, v188
    v_mfma_f32_32x32x16_bf16 v[204:219], v[156:159], v[36:39], v[204:219]
    s_waitcnt lgkmcnt(0)
    v_lshl_add_u32 v236, v236, 6, v246
    v_lshl_add_u32 v237, v237, 6, v246
    v_lshl_add_u32 v238, v238, 6, v246
    v_lshl_add_u32 v239, v239, 6, v246
    v_exp_f32 v191, v191
    v_smfmac_f32_32x32x32_bf16 v[220:235], v[172:175], v[80:87], v176
    ds_read_b64_tr_b16 v[180:181], v236
    ds_read_b64_tr_b16 v[182:183], v237
    ds_read_b64_tr_b16 v[184:185], v238
    ds_read_b64_tr_b16 v[186:187], v239
    v_add_f32 v189, 1.0, v189
    v_add_f32 v190, 1.0, v190
    v_mfma_f32_32x32x16_bf16 v[204:219], v[160:163], v[40:43], v[204:219]
    v_rcp_f32 v188, v188
    v_mfma_f32_32x32x16_bf16 v[204:219], v[164:167], v[44:47], v[204:219]
    v_add_f32 v191, 1.0, v191
    v_mfma_f32_32x32x16_bf16 v[220:235], v[152:155], v[16:19], v[220:235]
    v_rcp_f32 v189, v189
    v_mfma_f32_32x32x16_bf16 v[220:235], v[156:159], v[20:23], v[220:235]
    v_rcp_f32 v190, v190
    v_mfma_f32_32x32x16_bf16 v[220:235], v[160:163], v[24:27], v[220:235]
    v_rcp_f32 v191, v191
    v_mfma_f32_32x32x16_bf16 v[220:235], v[164:167], v[28:31], v[220:235]
    ds_read2_b64 v[64:67], v247 offset0:0 offset1:2
    ds_read2_b64 v[68:71], v247 offset0:4 offset1:6
    ds_read_b128 v[0:3], v252 offset:52736
    ds_read_b128 v[4:7], v252 offset:53760
    ds_read_b128 v[8:11], v252 offset:54784
    ds_read_b128 v[12:15], v252 offset:55808
    ds_read_b128 v[16:19], v252 offset:56832
    ds_read_b128 v[20:23], v252 offset:57856
    ds_read_b128 v[24:27], v252 offset:58880
    ds_read_b128 v[28:31], v252 offset:59904
    v_mul_f32 v204, v188, v204
    v_mul_f32 v205, v189, v205
    s_waitcnt lgkmcnt(10)
    v_smfmac_f32_32x32x32_bf16 v[88:103], v[180:183], v[188:195], v177
    v_mul_f32 v206, v190, v206
    v_mul_f32 v207, v191, v207
    s_nop 1
    v_smfmac_f32_32x32x32_bf16 v[104:119], v[180:183], v[204:211], v177
    v_exp_f32 v220, v220
    v_exp_f32 v221, v221
    v_mfma_f32_32x32x16_bf16 v[204:219], v[152:155], v[48:51], 0
    ds_read_b128 v[152:155], v253 offset:0
    v_exp_f32 v222, v222
    v_mfma_f32_32x32x16_bf16 v[204:219], v[156:159], v[52:55], v[204:219]
    ds_read_b128 v[156:159], v253 offset:16
    v_add_f32 v220, 1.0, v220
    v_exp_f32 v223, v223
    v_mfma_f32_32x32x16_bf16 v[204:219], v[160:163], v[56:59], v[204:219]
    ds_read_b128 v[160:163], v253 offset:32
    v_add_f32 v221, 1.0, v221
    v_mfma_f32_32x32x16_bf16 v[204:219], v[164:167], v[60:63], v[204:219]
    ds_read_b128 v[164:167], v253 offset:48
    v_add_f32 v222, 1.0, v222
    v_rcp_f32 v220, v220
    v_add_f32 v223, 1.0, v223
    v_rcp_f32 v221, v221
    v_rcp_f32 v222, v222
    v_rcp_f32 v223, v223
    s_nop 4
    v_mul_f32 v204, v220, v204
    v_mul_f32 v205, v221, v205
    v_smfmac_f32_32x32x32_bf16 v[120:135], v[180:183], v[220:227], v177
    v_mul_f32 v206, v222, v206
    v_mul_f32 v207, v223, v207
    s_nop 1
    v_smfmac_f32_32x32x32_bf16 v[136:151], v[180:183], v[204:211], v177
    s_branch K2_EPI2
K2_TAIL:
    v_smfmac_f32_32x32x32_bf16 v[136:151], v[180:183], v[204:211], v177
    v_smfmac_f32_32x32x32_bf16 v[136:151], v[184:187], v[212:219], v177
K2_DONE:
    s_cmp_lg_u32 s78, 0
    s_cbranch_scc1 K2_SLOW
K2_EPI:
    v_lshlrev_b32 v252, 4, v254
    v_and_b32 v247, 31, v254
    v_and_b32 v245, 32, v254
    v_mul_u32_u24 v249, 144, v247
    v_lshrrev_b32 v251, 2, v245
    v_lshl_add_u32 v247, v247, 6, v251
    v_lshl_add_u32 v249, v245, 1, v249
    v_add_u32 v249, s74, v249
    v_lshrrev_b32 v251, 3, v254
    v_lshl_add_u32 v251, v251, 4, v252
    v_add_u32 v251, s70, v251
    ds_read2_b64 v[64:67], v247 offset0:0 offset1:2
    ds_read2_b64 v[68:71], v247 offset0:4 offset1:6
    ds_read_b128 v[0:3], v252 offset:52736
    ds_read_b128 v[4:7], v252 offset:53760
    ds_read_b128 v[8:11], v252 offset:54784
    ds_read_b128 v[12:15], v252 offset:55808
    ds_read_b128 v[16:19], v252 offset:56832
    ds_read_b128 v[20:23], v252 offset:57856
    ds_read_b128 v[24:27], v252 offset:58880
    ds_read_b128 v[28:31], v252 offset:59904
    ds_read_b128 v[152:155], v253 offset:0
    ds_read_b128 v[156:159], v253 offset:16
    ds_read_b128 v[160:163], v253 offset:32
    ds_read_b128 v[164:167], v253 offset:48
K2_EPI2:
    s_nop 1
    v_rcp_f32 v88, v88
    v_rcp_f32 v89, v89
    v_rcp_f32 v90, v90
    v_rcp_f32 v91, v91
    v_rcp_f32 v92, v92
    v_rcp_f32 v93, v93
    v_rcp_f32 v94, v94
    v_rcp_f32 v95, v95
    s_waitcnt lgkmcnt(0)
    v_lshlrev_b32 v32, 16, v152
    v_and_b32 v33, 0xffff0000, v152
    v_lshlrev_b32 v34, 16, v153
    v_and_b32 v35, 0xffff0000, v153
    v_lshlrev_b32 v36, 16, v154
    v_and_b32 v37, 0xffff0000, v154
    v_lshlrev_b32 v38, 16, v155
    v_and_b32 v39, 0xffff0000, v155
    v_lshlrev_b32 v40, 16, v156
    v_and_b32 v41, 0xffff0000, v156
    v_lshlrev_b32 v42, 16, v157
    v_and_b32 v43, 0xffff0000, v157
    v_lshlrev_b32 v44, 16, v158
    v_and_b32 v45, 0xffff0000, v158
    v_lshlrev_b32 v46, 16, v159
    v_and_b32 v47, 0xffff0000, v159
    v_rcp_f32 v96, v96
    v_rcp_f32 v97, v97
    v_mfma_f32_32x32x16_bf16 v[188:203], v[0:3], v[152:155], v[32:47]
    v_rcp_f32 v98, v98
    v_rcp_f32 v99, v99
    v_rcp_f32 v100, v100
    v_rcp_f32 v101, v101
    v_rcp_f32 v102, v102
    v_rcp_f32 v103, v103
    v_lshlrev_b32 v48, 16, v160
    v_mfma_f32_32x32x16_bf16 v[188:203], v[4:7], v[156:159], v[188:203]
    v_and_b32 v49, 0xffff0000, v160
    v_lshlrev_b32 v50, 16, v161
    v_and_b32 v51, 0xffff0000, v161
    v_lshlrev_b32 v52, 16, v162
    v_and_b32 v53, 0xffff0000, v162
    v_lshlrev_b32 v54, 16, v163
    v_and_b32 v55, 0xffff0000, v163
    v_mfma_f32_32x32x16_bf16 v[188:203], v[8:11], v[160:163], v[188:203]
    v_lshlrev_b32 v56, 16, v164
    v_and_b32 v57, 0xffff0000, v164
    v_lshlrev_b32 v58, 16, v165
    v_and_b32 v59, 0xffff0000, v165
    v_lshlrev_b32 v60, 16, v166
    v_and_b32 v61, 0xffff0000, v166
    v_lshlrev_b32 v62, 16, v167
    v_mfma_f32_32x32x16_bf16 v[188:203], v[12:15], v[164:167], v[188:203]
    v_and_b32 v63, 0xffff0000, v167
    v_mul_f32 v104, v104, v88
    v_mul_f32 v105, v105, v89
    v_mul_f32 v106, v106, v90
    v_mul_f32 v107, v107, v91
    v_mul_f32 v108, v108, v92
    v_mul_f32 v109, v109, v93
    v_mfma_f32_32x32x16_bf16 v[72:87], v[16:19], v[152:155], v[48:63]
    v_mul_f32 v110, v110, v94
    v_mul_f32 v111, v111, v95
    v_mul_f32 v112, v112, v96
    v_mul_f32 v113, v113, v97
    v_mul_f32 v114, v114, v98
    v_mul_f32 v115, v115, v99
    v_mfma_f32_32x32x16_bf16 v[72:87], v[20:23], v[156:159], v[72:87]
    v_mul_f32 v116, v116, v100
    v_mul_f32 v117, v117, v101
    v_mul_f32 v118, v118, v102
    v_mul_f32 v119, v119, v103
    v_cvt_pk_bf16_f32 v88, v104, v105
    v_cvt_pk_bf16_f32 v89, v106, v107
    v_mfma_f32_32x32x16_bf16 v[72:87], v[24:27], v[160:163], v[72:87]
    v_cvt_pk_bf16_f32 v90, v108, v109
    v_cvt_pk_bf16_f32 v91, v110, v111
    v_cvt_pk_bf16_f32 v92, v112, v113
    v_cvt_pk_bf16_f32 v93, v114, v115
    v_cvt_pk_bf16_f32 v94, v116, v117
    v_cvt_pk_bf16_f32 v95, v118, v119
    v_mfma_f32_32x32x16_bf16 v[72:87], v[28:31], v[164:167], v[72:87]
    v_rcp_f32 v120, v120
    v_rcp_f32 v121, v121
    v_rcp_f32 v122, v122
    v_rcp_f32 v123, v123
    v_rcp_f32 v124, v124
    v_rcp_f32 v125, v125
    v_mfma_f32_32x32x16_bf16 v[188:203], v[88:91], v[64:67], v[188:203]
    v_rcp_f32 v126, v126
    v_rcp_f32 v127, v127
    v_rcp_f32 v128, v128
    v_rcp_f32 v129, v129
    v_rcp_f32 v130, v130
    v_mfma_f32_32x32x16_bf16 v[188:203], v[92:95], v[68:71], v[188:203]
    v_rcp_f32 v131, v131
    v_rcp_f32 v132, v132
    v_rcp_f32 v133, v133
    v_rcp_f32 v134, v134
    v_rcp_f32 v135, v135
    v_mul_f32 v136, v136, v120
    v_mul_f32 v137, v137, v121
    v_mul_f32 v138, v138, v122
    v_mul_f32 v139, v139, v123
    v_mul_f32 v140, v140, v124
    v_mul_f32 v141, v141, v125
    v_mul_f32 v142, v142, v126
    v_mul_f32 v143, v143, v127
    v_mul_f32 v144, v144, v128
    v_mul_f32 v145, v145, v129
    v_mul_f32 v146, v146, v130
    v_mul_f32 v147, v147, v131
    v_mul_f32 v148, v148, v132
    v_mul_f32 v149, v149, v133
    v_mul_f32 v150, v150, v134
    v_mul_f32 v151, v151, v135
    v_cvt_pk_bf16_f32 v120, v136, v137
    v_cvt_pk_bf16_f32 v121, v138, v139
    v_cvt_pk_bf16_f32 v122, v140, v141
    v_cvt_pk_bf16_f32 v123, v142, v143
    v_cvt_pk_bf16_f32 v124, v144, v145
    v_cvt_pk_bf16_f32 v125, v146, v147
    v_cvt_pk_bf16_f32 v126, v148, v149
    v_cvt_pk_bf16_f32 v127, v150, v151
    v_mfma_f32_32x32x16_bf16 v[72:87], v[120:123], v[64:67], v[72:87]
    s_nop 0
    v_mfma_f32_32x32x16_bf16 v[72:87], v[124:127], v[68:71], v[72:87]
    v_max_f32 v188, v188, v32
    v_max_f32 v189, v189, v33
    v_max_f32 v190, v190, v34
    v_max_f32 v191, v191, v35
    v_max_f32 v192, v192, v36
    v_max_f32 v193, v193, v37
    v_max_f32 v194, v194, v38
    v_max_f32 v195, v195, v39
    v_cvt_pk_bf16_f32 v220, v188, v189
    v_cvt_pk_bf16_f32 v221, v190, v191
    v_cvt_pk_bf16_f32 v222, v192, v193
    v_cvt_pk_bf16_f32 v223, v194, v195
    ds_write_b128 v249, v[220:223] offset:0
    v_max_f32 v196, v196, v40
    v_max_f32 v197, v197, v41
    v_max_f32 v198, v198, v42
    v_max_f32 v199, v199, v43
    v_max_f32 v200, v200, v44
    v_max_f32 v201, v201, v45
    v_max_f32 v202, v202, v46
    v_max_f32 v203, v203, v47
    v_cvt_pk_bf16_f32 v224, v196, v197
    v_cvt_pk_bf16_f32 v225, v198, v199
    v_cvt_pk_bf16_f32 v226, v200, v201
    v_cvt_pk_bf16_f32 v227, v202, v203
    ds_write_b128 v249, v[224:227] offset:16
    v_max_f32 v72, v72, v48
    v_max_f32 v73, v73, v49
    v_max_f32 v74, v74, v50
    v_max_f32 v75, v75, v51
    v_max_f32 v76, v76, v52
    v_max_f32 v77, v77, v53
    v_max_f32 v78, v78, v54
    v_max_f32 v79, v79, v55
    v_cvt_pk_bf16_f32 v228, v72, v73
    v_cvt_pk_bf16_f32 v229, v74, v75
    v_cvt_pk_bf16_f32 v230, v76, v77
    v_cvt_pk_bf16_f32 v231, v78, v79
    ds_write_b128 v249, v[228:231] offset:32
    v_max_f32 v80, v80, v56
    v_max_f32 v81, v81, v57
    v_max_f32 v82, v82, v58
    v_max_f32 v83, v83, v59
    v_max_f32 v84, v84, v60
    v_max_f32 v85, v85, v61
    v_max_f32 v86, v86, v62
    v_max_f32 v87, v87, v63
    v_cvt_pk_bf16_f32 v232, v80, v81
    v_cvt_pk_bf16_f32 v233, v82, v83
    v_cvt_pk_bf16_f32 v234, v84, v85
    v_cvt_pk_bf16_f32 v235, v86, v87
    ds_write_b128 v249, v[232:235] offset:48
    ds_read_b128 v[152:155], v251 offset:0
    ds_read_b128 v[156:159], v251 offset:1152
    ds_read_b128 v[160:163], v251 offset:2304
    ds_read_b128 v[164:167], v251 offset:3456
    s_waitcnt lgkmcnt(3)
    buffer_store_dwordx4 v[152:155], v252, s[28:31], 0 offen offset:0 sc1
    s_waitcnt lgkmcnt(2)
    buffer_store_dwordx4 v[156:159], v252, s[28:31], 0 offen offset:1024 sc1
    s_waitcnt lgkmcnt(1)
    buffer_store_dwordx4 v[160:163], v252, s[28:31], 0 offen offset:2048 sc1
    s_waitcnt lgkmcnt(0)
    buffer_store_dwordx4 v[164:167], v252, s[28:31], 0 offen offset:3072 sc1
    s_add_u32 s10, s2, s7
    s_cmp_lg_u32 s10, 0
    s_cbranch_scc1 K2_NOEP
    v_mov_b32 v188, 24117248
    v_mov_b32 v189, s100
    buffer_store_dword v189, v188, s[24:27], 0 offen sc1
K2_NOEP:
K2_END:
    s_endpgm
K2_RETRY0:
    s_sub_u32 s101, s101, 1
    s_cbranch_scc1 K2_END
    s_waitcnt vmcnt(0)
    v_bitop3_b32 v188, v91, s36, v214 bitop3:0x28
    s_nop 1
    v_or_b32_dpp v188, v188, v188 quad_perm:[1,0,3,2] row_mask:0xf bank_mask:0xf
    s_nop 1
    v_or_b32_dpp v188, v188, v188 quad_perm:[2,3,0,1] row_mask:0xf bank_mask:0xf
    s_nop 1
    v_or_b32_dpp v188, v188, v188 row_half_mirror row_mask:0xf bank_mask:0xf
    v_cmp_ne_u32 vcc, 0, v188
    s_and_b64 exec, exec, vcc
    s_cbranch_execz K2_RT00
    buffer_load_dwordx4 v[88:91], v189, s[32:35], 0 offen sc1
K2_RT00:
    s_mov_b64 exec, -1
    v_bitop3_b32 v188, v95, s36, v214 bitop3:0x28
    s_nop 1
    v_or_b32_dpp v188, v188, v188 quad_perm:[1,0,3,2] row_mask:0xf bank_mask:0xf
    s_nop 1
    v_or_b32_dpp v188, v188, v188 quad_perm:[2,3,0,1] row_mask:0xf bank_mask:0xf
    s_nop 1
    v_or_b32_dpp v188, v188, v188 row_half_mirror row_mask:0xf bank_mask:0xf
    v_cmp_ne_u32 vcc, 0, v188
    s_and_b64 exec, exec, vcc
    s_cbranch_execz K2_RT01
    buffer_load_dwordx4 v[92:95], v189, s[32:35], s79 offen sc1
K2_RT01:
    s_mov_b64 exec, -1
    v_bitop3_b32 v188, v99, s36, v214 bitop3:0x28
    s_nop 1
    v_or_b32_dpp v188, v188, v188 quad_perm:[1,0,3,2] row_mask:0xf bank_mask:0xf
    s_nop 1
    v_or_b32_dpp v188, v188, v188 quad_perm:[2,3,0,1] row_mask:0xf bank_mask:0xf
    s_nop 1
    v_or_b32_dpp v188, v188, v188 row_half_mirror row_mask:0xf bank_mask:0xf
    v_cmp_ne_u32 vcc, 0, v188
    s_and_b64 exec, exec, vcc
    s_cbranch_execz K2_RT02
    buffer_load_dwordx4 v[96:99], v189, s[32:35], s80 offen sc1
K2_RT02:
    s_mov_b64 exec, -1
    v_bitop3_b32 v188, v103, s36, v214 bitop3:0x28
    s_nop 1
    v_or_b32_dpp v188, v188, v188 quad_perm:[1,0,3,2] row_mask:0xf bank_mask:0xf
    s_nop 1
    v_or_b32_dpp v188, v188, v188 quad_perm:[2,3,0,1] row_mask:0xf bank_mask:0xf
    s_nop 1
    v_or_b32_dpp v188, v188, v188 row_half_mirror row_mask:0xf bank_mask:0xf
    v_cmp_ne_u32 vcc, 0, v188
    s_and_b64 exec, exec, vcc
    s_cbranch_execz K2_RT03
    buffer_load_dwordx4 v[100:103], v189, s[32:35], s81 offen sc1
K2_RT03:
    s_mov_b64 exec, -1
    s_waitcnt vmcnt(0)
    s_branch K2_CHK0
K2_RETRY1:
    s_sub_u32 s101, s101, 1
    s_cbranch_scc1 K2_END
    s_waitcnt vmcnt(0)
    v_bitop3_b32 v188, v95, s36, v214 bitop3:0x28
    s_nop 1
    v_or_b32_dpp v188, v188, v188 quad_perm:[1,0,3,2] row_mask:0xf bank_mask:0xf
    s_nop 1
    v_or_b32_dpp v188, v188, v188 quad_perm:[2,3,0,1] row_mask:0xf bank_mask:0xf
    s_nop 1
    v_or_b32_dpp v188, v188, v188 row_half_mirror row_mask:0xf bank_mask:0xf
    v_cmp_ne_u32 vcc, 0, v188
    s_and_b64 exec, exec, vcc
    s_cbranch_execz K2_RT11
    buffer_load_dwordx4 v[92:95], v189, s[32:35], s79 offen sc1
K2_RT11:
    s_mov_b64 exec, -1
    v_bitop3_b32 v188, v99, s36, v214 bitop3:0x28
    s_nop 1
    v_or_b32_dpp v188, v188, v188 quad_perm:[1,0,3,2] row_mask:0xf bank_mask:0xf
    s_nop 1
    v_or_b32_dpp v188, v188, v188 quad_perm:[2,3,0,1] row_mask:0xf bank_mask:0xf
    s_nop 1
    v_or_b32_dpp v188, v188, v188 row_half_mirror row_mask:0xf bank_mask:0xf
    v_cmp_ne_u32 vcc, 0, v188
    s_and_b64 exec, exec, vcc
    s_cbranch_execz K2_RT12
    buffer_load_dwordx4 v[96:99], v189, s[32:35], s80 offen sc1
K2_RT12:
    s_mov_b64 exec, -1
    v_bitop3_b32 v188, v103, s36, v214 bitop3:0x28
    s_nop 1
    v_or_b32_dpp v188, v188, v188 quad_perm:[1,0,3,2] row_mask:0xf bank_mask:0xf
    s_nop 1
    v_or_b32_dpp v188, v188, v188 quad_perm:[2,3,0,1] row_mask:0xf bank_mask:0xf
    s_nop 1
    v_or_b32_dpp v188, v188, v188 row_half_mirror row_mask:0xf bank_mask:0xf
    v_cmp_ne_u32 vcc, 0, v188
    s_and_b64 exec, exec, vcc
    s_cbranch_execz K2_RT13
    buffer_load_dwordx4 v[100:103], v189, s[32:35], s81 offen sc1
K2_RT13:
    s_mov_b64 exec, -1
    s_waitcnt vmcnt(0)
    s_branch K2_CHK1
K2_RETRY2:
    s_sub_u32 s101, s101, 1
    s_cbranch_scc1 K2_END
    s_waitcnt vmcnt(0)
    v_bitop3_b32 v188, v99, s36, v214 bitop3:0x28
    s_nop 1
    v_or_b32_dpp v188, v188, v188 quad_perm:[1,0,3,2] row_mask:0xf bank_mask:0xf
    s_nop 1
    v_or_b32_dpp v188, v188, v188 quad_perm:[2,3,0,1] row_mask:0xf bank_mask:0xf
    s_nop 1
    v_or_b32_dpp v188, v188, v188 row_half_mirror row_mask:0xf bank_mask:0xf
    v_cmp_ne_u32 vcc, 0, v188
    s_and_b64 exec, exec, vcc
    s_cbranch_execz K2_RT22
    buffer_load_dwordx4 v[96:99], v189, s[32:35], s80 offen sc1
K2_RT22:
    s_mov_b64 exec, -1
    v_bitop3_b32 v188, v103, s36, v214 bitop3:0x28
    s_nop 1
    v_or_b32_dpp v188, v188, v188 quad_perm:[1,0,3,2] row_mask:0xf bank_mask:0xf
    s_nop 1
    v_or_b32_dpp v188, v188, v188 quad_perm:[2,3,0,1] row_mask:0xf bank_mask:0xf
    s_nop 1
    v_or_b32_dpp v188, v188, v188 row_half_mirror row_mask:0xf bank_mask:0xf
    v_cmp_ne_u32 vcc, 0, v188
    s_and_b64 exec, exec, vcc
    s_cbranch_execz K2_RT23
    buffer_load_dwordx4 v[100:103], v189, s[32:35], s81 offen sc1
K2_RT23:
    s_mov_b64 exec, -1
    s_waitcnt vmcnt(0)
    s_branch K2_CHK2
K2_RETRY3:
    s_sub_u32 s101, s101, 1
    s_cbranch_scc1 K2_END
    s_waitcnt vmcnt(0)
    v_bitop3_b32 v188, v103, s36, v214 bitop3:0x28
    s_nop 1
    v_or_b32_dpp v188, v188, v188 quad_perm:[1,0,3,2] row_mask:0xf bank_mask:0xf
    s_nop 1
    v_or_b32_dpp v188, v188, v188 quad_perm:[2,3,0,1] row_mask:0xf bank_mask:0xf
    s_nop 1
    v_or_b32_dpp v188, v188, v188 row_half_mirror row_mask:0xf bank_mask:0xf
    v_cmp_ne_u32 vcc, 0, v188
    s_and_b64 exec, exec, vcc
    s_cbranch_execz K2_RT33
    buffer_load_dwordx4 v[100:103], v189, s[32:35], s81 offen sc1
K2_RT33:
    s_mov_b64 exec, -1
    s_waitcnt vmcnt(0)
    s_branch K2_CHK3
K1_EXT:
    s_mov_b32 s14, 0x0f0f0f0f
    s_mov_b32 s15, s14
    ds_read_b32 v104, v6 offset:32
    ds_read_b128 v[8:11], v3 offset:128
    ds_read_b32 v105, v6 offset:3360
    ds_read_b128 v[16:19], v3 offset:13440
    ds_read_b32 v106, v6 offset:6688
    ds_read_b128 v[24:27], v3 offset:26752
    ds_read_b32 v107, v6 offset:10016
    ds_read_b128 v[32:35], v3 offset:40064
    s_waitcnt lgkmcnt(0)
    v_cmp_le_u32 vcc, 553648128, v108
    v_and_or_b32 v11, v104, v15, v108
    s_and_b64 exec, vcc, s[14:15]
    s_cbranch_execz K1_EX0
    buffer_store_dwordx4 v[8:11], v4, s[32:35], s10 offen sc1
K1_EX0:
    s_mov_b64 exec, -1
    s_add_u32 s10, s10, 2105344
    v_cmp_le_u32 vcc, 553648128, v109
    v_and_or_b32 v19, v105, v15, v109
    s_and_b64 exec, vcc, s[14:15]
    s_cbranch_execz K1_EX1
    buffer_store_dwordx4 v[16:19], v4, s[32:35], s10 offen sc1
K1_EX1:
    s_mov_b64 exec, -1
    s_add_u32 s10, s10, 2105344
    v_cmp_le_u32 vcc, 553648128, v110
    v_and_or_b32 v27, v106, v15, v110
    s_and_b64 exec, vcc, s[14:15]
    s_cbranch_execz K1_EX2
    buffer_store_dwordx4 v[24:27], v4, s[32:35], s10 offen sc1
K1_EX2:
    s_mov_b64 exec, -1
    s_add_u32 s10, s10, 2105344
    v_cmp_le_u32 vcc, 553648128, v111
    v_and_or_b32 v35, v107, v15, v111
    s_and_b64 exec, vcc, s[14:15]
    s_cbranch_execz K1_EX3
    buffer_store_dwordx4 v[32:35], v4, s[32:35], s10 offen sc1
K1_EX3:
    s_mov_b64 exec, -1
    s_add_u32 s10, s10, 2105344
    s_branch K1_EXTR
K1_OVF:
    v_lshrrev_b32 v72, 16, v112
    v_lshrrev_b32 v76, 18, v112
    v_sub_u32 v72, v72, v76
    v_lshrrev_b32 v73, 16, v113
    v_lshrrev_b32 v76, 18, v113
    v_sub_u32 v73, v73, v76
    v_lshrrev_b32 v74, 16, v114
    v_lshrrev_b32 v76, 18, v114
    v_sub_u32 v74, v74, v76
    v_lshrrev_b32 v75, 16, v115
    v_lshrrev_b32 v76, 18, v115
    v_sub_u32 v75, v75, v76
    v_add_u32 v77, v72, v73
    v_add_u32 v78, v77, v74
    v_add_u32 v79, v78, v75
    v_mov_b32 v1, v79
    s_nop 1
    v_add_u32_dpp v1, v1, v1 row_shr:1 row_mask:0xf bank_mask:0xf bound_ctrl:0
    s_nop 1
    v_add_u32_dpp v1, v1, v1 row_shr:2 row_mask:0xf bank_mask:0xf bound_ctrl:0
    s_nop 1
    v_add_u32_dpp v1, v1, v1 row_shr:4 row_mask:0xf bank_mask:0xf bound_ctrl:0
    s_nop 1
    v_add_u32_dpp v1, v1, v1 row_shr:8 row_mask:0xf bank_mask:0xf bound_ctrl:0
    s_nop 1
    v_add_u32_dpp v1, v1, v1 row_bcast:15 row_mask:0xa bank_mask:0xf
    s_nop 1
    v_add_u32_dpp v1, v1, v1 row_bcast:31 row_mask:0xc bank_mask:0xf
    s_nop 0
    v_sub_u32 v76, v1, v79
    v_add_u32 v79, v76, v78
    v_add_u32 v78, v76, v77
    v_add_u32 v77, v76, v72
    v_lshl_or_b32 v76, v72, 16, v76
    v_lshl_or_b32 v77, v73, 16, v77
    v_lshl_or_b32 v78, v74, 16, v78
    v_lshl_or_b32 v79, v75, 16, v79
    s_waitcnt lgkmcnt(0)
    ds_write_b128 v172, v[76:79] offset:52736
    v_min_u32 v108, 255, v108
    v_min_u32 v109, 255, v109
    v_min_u32 v110, 255, v110
    v_min_u32 v111, 255, v111
    s_lshl_b32 s15, s12, 2
    s_add_u32 s15, s15, 23068672
    s_add_u32 s64, s8, s15
    s_addc_u32 s65, s9, 0
    s_mov_b32 s66, 262144
    s_mov_b32 s67, 0x20000
    v_lshlrev_b32 v1, 12, v254
    buffer_store_dword v76, v1, s[64:67], 0 offen offset:0 sc1
    buffer_store_dword v77, v1, s[64:67], 0 offen offset:1024 sc1
    buffer_store_dword v78, v1, s[64:67], 0 offen offset:2048 sc1
    buffer_store_dword v79, v1, s[64:67], 0 offen offset:3072 sc1
    s_add_u32 s15, s13, 17825792
    s_add_u32 s64, s8, s15
    s_addc_u32 s65, s9, 0
    s_mov_b32 s66, 12500
    s_mov_b32 s67, 0x20000
    s_lshr_b32 s15, s13, 2
    s_add_u32 s15, s15, 22020096
    s_add_u32 s68, s8, s15
    s_addc_u32 s69, s9, 0
    s_mov_b32 s70, 3125
    s_mov_b32 s71, 0x20000
    v_cndmask_b32 v30, v24, v30, s[78:79]
    v_cndmask_b32 v38, 0, v38, s[78:79]
    ds_read_u16 v40, v24 offset:50736
    ds_read_u16 v41, v25 offset:50736
    ds_read_u16 v42, v26 offset:50736
    ds_read_u16 v43, v27 offset:50736
    ds_read_u16 v44, v28 offset:50736
    ds_read_u16 v45, v29 offset:50736
    ds_read_u16 v46, v30 offset:50736
    s_waitcnt lgkmcnt(0)
    v_lshrrev_b32 v1, 2, v32
    v_sub_u32 v1, v32, v1
    v_add_u32 v40, v40, v1
    v_cmp_le_u32 vcc, 48, v32
    v_lshlrev_b32 v48, 2, v40
    s_and_saveexec_b64 s[14:15], vcc
    s_cbranch_execz K1_OV3_0
    buffer_store_byte v23, v40, s[68:71], 0 offen sc1
    buffer_store_dword v16, v48, s[64:67], 0 offen sc1
K1_OV3_0:
    s_mov_b64 exec, -1
    v_lshrrev_b32 v1, 2, v33
    v_sub_u32 v1, v33, v1
    v_add_u32 v41, v41, v1
    v_cmp_le_u32 vcc, 48, v33
    v_lshlrev_b32 v49, 2, v41
    s_and_saveexec_b64 s[14:15], vcc
    s_cbranch_execz K1_OV3_1
    buffer_store_byte v23, v41, s[68:71], 0 offen sc1
    buffer_store_dword v17, v49, s[64:67], 0 offen sc1
K1_OV3_1:
    s_mov_b64 exec, -1
    v_lshrrev_b32 v1, 2, v34
    v_sub_u32 v1, v34, v1
    v_add_u32 v42, v42, v1
    v_cmp_le_u32 vcc, 48, v34
    v_lshlrev_b32 v50, 2, v42
    s_and_saveexec_b64 s[14:15], vcc
    s_cbranch_execz K1_OV3_2
    buffer_store_byte v23, v42, s[68:71], 0 offen sc1
    buffer_store_dword v18, v50, s[64:67], 0 offen sc1
K1_OV3_2:
    s_mov_b64 exec, -1
    v_lshrrev_b32 v1, 2, v35
    v_sub_u32 v1, v35, v1
    v_add_u32 v43, v43, v1
    v_cmp_le_u32 vcc, 48, v35
    v_lshlrev_b32 v51, 2, v43
    s_and_saveexec_b64 s[14:15], vcc
    s_cbranch_execz K1_OV3_3
    buffer_store_byte v23, v43, s[68:71], 0 offen sc1
    buffer_store_dword v19, v51, s[64:67], 0 offen sc1
K1_OV3_3:
    s_mov_b64 exec, -1
    v_lshrrev_b32 v1, 2, v36
    v_sub_u32 v1, v36, v1
    v_add_u32 v44, v44, v1
    v_cmp_le_u32 vcc, 48, v36
    v_lshlrev_b32 v52, 2, v44
    s_and_saveexec_b64 s[14:15], vcc
    s_cbranch_execz K1_OV3_4
    buffer_store_byte v31, v44, s[68:71], 0 offen sc1
    buffer_store_dword v20, v52, s[64:67], 0 offen sc1
K1_OV3_4:
    s_mov_b64 exec, -1
    v_lshrrev_b32 v1, 2, v37
    v_sub_u32 v1, v37, v1
    v_add_u32 v45, v45, v1
    v_cmp_le_u32 vcc, 48, v37
    v_lshlrev_b32 v53, 2, v45
    s_and_saveexec_b64 s[14:15], vcc
    s_cbranch_execz K1_OV3_5
    buffer_store_byte v31, v45, s[68:71], 0 offen sc1
    buffer_store_dword v21, v53, s[64:67], 0 offen sc1
K1_OV3_5:
    s_mov_b64 exec, -1
    v_lshrrev_b32 v1, 2, v38
    v_sub_u32 v1, v38, v1
    v_add_u32 v46, v46, v1
    v_cmp_le_u32 vcc, 48, v38
    v_lshlrev_b32 v54, 2, v46
    s_and_saveexec_b64 s[14:15], vcc
    s_cbranch_execz K1_OV3_6
    buffer_store_byte v39, v46, s[68:71], 0 offen sc1
    buffer_store_dword v22, v54, s[64:67], 0 offen sc1
K1_OV3_6:
    s_mov_b64 exec, -1
    s_waitcnt vmcnt(0)
    s_barrier
    s_branch K1_OUT
K2_XT1:
    s_mov_b32 s97, 1
    v_cmp_le_u32 vcc, 822083584, v188
    v_mov_b32 v166, 2180
    s_cbranch_vccz K2_XT1A
    ds_write_b32 v166, v171
K2_XT1A:
    s_mov_b32 s10, 0xf0f0f0f0
    s_mov_b32 s11, s10
    v_and_b32 v166, 12, v168
    v_add_u32 v166, 32, v166
    v_and_b32 v164, 64, v189
    v_mul_u32_u24 v164, 127, v164
    v_add_u32 v164, v164, v189
    v_add_u32 v165, 16384, v164
    v_mov_b32 v167, 0x7ffffff0
    v_cndmask_b32 v204, v91, v95, s[10:11]
    v_cndmask_b32 v206, v208, v209, s[10:11]
    v_cmp_le_u32 vcc, 553648128, v204
    v_sub_u32_sdwa v204, v204, v166 dst_sel:DWORD dst_unused:UNUSED_PAD src0_sel:BYTE_3 src1_sel:DWORD
    s_nop 0
    v_cndmask_b32 v164, v167, v164, vcc
    v_cndmask_b32 v205, v99, v103, s[10:11]
    v_cndmask_b32 v207, v210, v211, s[10:11]
    v_cmp_le_u32 vcc, 553648128, v205
    v_sub_u32_sdwa v205, v205, v166 dst_sel:DWORD dst_unused:UNUSED_PAD src0_sel:BYTE_3 src1_sel:DWORD
    s_nop 0
    v_cndmask_b32 v165, v167, v165, vcc
    s_add_u32 s32, s32, 8421376
    s_addc_u32 s33, s33, 0
    buffer_load_dwordx4 v[132:135], v164, s[32:35], 0 offen sc1
    buffer_load_dwordx4 v[136:139], v165, s[32:35], 0 offen sc1
    v_med3_i32 v166, v204, 0, 3
    v_med3_i32 v167, v205, 0, 3
    v_add_u32 v166, v166, v167
    v_mov_b32 v167, 2176
    v_cmpx_lt_u32 vcc, 0, v166
    ds_add_u32 v167, v166
    s_mov_b64 exec, -1
    s_branch K2_XT1R
K2_XT2:
K2_XVa:
    s_mov_b64 s[10:11], 0
    v_bitop3_b32 v166, v135, s36, v214 bitop3:0x28
    v_cmp_ne_u32 s[86:87], 0, v166
    v_cmp_gt_u32 vcc, 0x7ffffff0, v164
    s_and_b64 vcc, vcc, s[86:87]
    s_or_b64 s[10:11], s[10:11], vcc
    v_bitop3_b32 v166, v139, s36, v214 bitop3:0x28
    v_cmp_ne_u32 s[86:87], 0, v166
    v_cmp_gt_u32 vcc, 0x7ffffff0, v165
    s_and_b64 vcc, vcc, s[86:87]
    s_or_b64 s[10:11], s[10:11], vcc
    s_cbranch_scc0 K2_XWa
    s_sub_u32 s101, s101, 1
    s_cbranch_scc1 K2_END
    buffer_load_dwordx4 v[132:135], v164, s[32:35], 0 offen sc1
    buffer_load_dwordx4 v[136:139], v165, s[32:35], 0 offen sc1
    s_waitcnt vmcnt(0)
    s_branch K2_XVa
K2_XWa:
    v_and_b32 v140, 255, v132
    v_lshlrev_b32 v140, 2, v140
    ds_read_b32 v140, v140 offset:6400
    v_and_b32 v141, 255, v133
    v_lshlrev_b32 v141, 2, v141
    ds_read_b32 v141, v141 offset:6400
    v_and_b32 v142, 255, v134
    v_lshlrev_b32 v142, 2, v142
    ds_read_b32 v142, v142 offset:6400
    v_and_b32 v135, 0x0f0f0f, v135
    v_and_b32 v143, 255, v136
    v_lshlrev_b32 v143, 2, v143
    ds_read_b32 v143, v143 offset:6400
    v_and_b32 v144, 255, v137
    v_lshlrev_b32 v144, 2, v144
    ds_read_b32 v144, v144 offset:6400
    v_and_b32 v145, 255, v138
    v_lshlrev_b32 v145, 2, v145
    ds_read_b32 v145, v145 offset:6400
    v_and_b32 v139, 0x0f0f0f, v139
    s_waitcnt lgkmcnt(0)
    v_perm_b32 v146, v135, v132, s64
    v_lshl_add_u32 v146, v146, 5, v206
    v_cmpx_lt_i32 vcc, 0, v204
    ds_add_rtn_u32 v140, v140, v171 offset:2112
    s_mov_b64 exec, -1
    v_perm_b32 v147, v135, v133, s65
    v_lshl_add_u32 v147, v147, 5, v206
    v_cmpx_lt_i32 vcc, 1, v204
    ds_add_rtn_u32 v141, v141, v171 offset:2112
    s_mov_b64 exec, -1
    v_perm_b32 v148, v135, v134, s66
    v_lshl_add_u32 v148, v148, 5, v206
    v_cmpx_lt_i32 vcc, 2, v204
    ds_add_rtn_u32 v142, v142, v171 offset:2112
    s_mov_b64 exec, -1
    v_perm_b32 v149, v139, v136, s64
    v_lshl_add_u32 v149, v149, 5, v207
    v_cmpx_lt_i32 vcc, 0, v205
    ds_add_rtn_u32 v143, v143, v171 offset:2112
    s_mov_b64 exec, -1
    v_perm_b32 v150, v139, v137, s65
    v_lshl_add_u32 v150, v150, 5, v207
    v_cmpx_lt_i32 vcc, 1, v205
    ds_add_rtn_u32 v144, v144, v171 offset:2112
    s_mov_b64 exec, -1
    v_perm_b32 v151, v139, v138, s66
    v_lshl_add_u32 v151, v151, 5, v207
    v_cmpx_lt_i32 vcc, 2, v205
    ds_add_rtn_u32 v145, v145, v171 offset:2112
    s_mov_b64 exec, -1
    s_waitcnt lgkmcnt(0)
    v_cmpx_lt_i32 vcc, 0, v204
    ds_write2st64_b32 v140, v132, v146 offset0:0 offset1:84
    s_mov_b64 exec, -1
    v_cmpx_lt_i32 vcc, 1, v204
    ds_write2st64_b32 v141, v133, v147 offset0:0 offset1:84
    s_mov_b64 exec, -1
    v_cmpx_lt_i32 vcc, 2, v204
    ds_write2st64_b32 v142, v134, v148 offset0:0 offset1:84
    s_mov_b64 exec, -1
    v_cmpx_lt_i32 vcc, 0, v205
    ds_write2st64_b32 v143, v136, v149 offset0:0 offset1:84
    s_mov_b64 exec, -1
    v_cmpx_lt_i32 vcc, 1, v205
    ds_write2st64_b32 v144, v137, v150 offset0:0 offset1:84
    s_mov_b64 exec, -1
    v_cmpx_lt_i32 vcc, 2, v205
    ds_write2st64_b32 v145, v138, v151 offset0:0 offset1:84
    s_mov_b64 exec, -1
    s_waitcnt lgkmcnt(0)
    s_branch K2_XT2R
K2_OVF:
    s_mov_b32 s80, 1
    s_mov_b32 s83, 0
    s_mov_b32 s77, 0
    s_mov_b32 s15, s76
    v_mov_b32 v190, 0xffff0000
    v_or_b32 v189, s39, v190
    v_mov_b32 v190, 0x7fffff00
    v_lshl_add_u32 v188, v254, 2, s15
    s_sub_u32 s73, s15, s76
    ds_write2st64_b32 v188, v189, v190 offset0:0 offset1:84
    ds_write2st64_b32 v188, v189, v190 offset0:1 offset1:85
    s_add_u32 s73, s73, 127
    s_lshr_b32 s73, s73, 7
    s_sub_i32 s38, s73, 1
    s_cmp_eq_u32 s97, 0
    s_cbranch_scc1 K2_PADS0
    s_mov_b32 s97, 0
    s_waitcnt vmcnt(0)
K2_XVb:
    s_mov_b64 s[10:11], 0
    v_bitop3_b32 v166, v135, s36, v214 bitop3:0x28
    v_cmp_ne_u32 s[86:87], 0, v166
    v_cmp_gt_u32 vcc, 0x7ffffff0, v164
    s_and_b64 vcc, vcc, s[86:87]
    s_or_b64 s[10:11], s[10:11], vcc
    v_bitop3_b32 v166, v139, s36, v214 bitop3:0x28
    v_cmp_ne_u32 s[86:87], 0, v166
    v_cmp_gt_u32 vcc, 0x7ffffff0, v165
    s_and_b64 vcc, vcc, s[86:87]
    s_or_b64 s[10:11], s[10:11], vcc
    s_cbranch_scc0 K2_XWb
    s_sub_u32 s101, s101, 1
    s_cbranch_scc1 K2_END
    buffer_load_dwordx4 v[132:135], v164, s[32:35], 0 offen sc1
    buffer_load_dwordx4 v[136:139], v165, s[32:35], 0 offen sc1
    s_waitcnt vmcnt(0)
    s_branch K2_XVb
K2_XWb:
    s_branch K2_PADS0
K2_SLOW:
    s_add_u32 s81, s81, 448
    s_cmp_lt_u32 s81, s82
    s_cbranch_scc1 K2_BATCH
K2_FIND:
    s_cmp_lg_u64 s[84:85], 0
    s_cbranch_scc1 K2_GOT
    s_add_u32 s79, s79, 1
    s_cmp_ge_u32 s79, 4
    s_cbranch_scc1 K2_EPI
    s_mul_i32 s10, s12, 32896
    s_lshl_b32 s11, s79, 13
    s_add_u32 s10, s10, s11
    v_lshlrev_b32 v252, 7, v254
    buffer_load_ubyte v252, v252, s[24:27], s10 offen offset:15 sc1
    s_waitcnt vmcnt(0)
    v_cmp_lt_u32 s[84:85], s77, v252
    s_nop 3
    s_branch K2_FIND
K2_GOT:
    s_ff1_i32_b64 s10, s[84:85]
    s_bitset0_b64 s[84:85], s10
    s_lshl_b32 s11, s79, 6
    s_add_u32 s80, s10, s11
    s_mul_i32 s10, s12, 32896
    s_lshl_b32 s11, s80, 7
    s_add_u32 s10, s10, s11
    s_lshl_b32 s11, s12, 8
    s_add_u32 s11, s11, s80
    s_lshl_b32 s11, s11, 2
    s_add_u32 s11, s11, 23068672
    v_mov_b32 v188, 0
    buffer_load_ubyte v189, v188, s[24:27], s10 offen offset:15 sc1
    buffer_load_dword v190, v188, s[24:27], s11 offen sc1
    s_waitcnt vmcnt(0)
    v_readfirstlane_b32 s10, v189
    v_readfirstlane_b32 s11, v190
    s_nop 3
    s_and_b32 s83, s11, 0xffff
    s_lshr_b32 s11, s11, 16
    s_lshr_b32 s82, s10, 2
    s_sub_u32 s82, s10, s82
    s_cmp_gt_u32 s10, 48
    s_cselect_b32 s82, s11, s82
    s_lshr_b32 s10, s77, 2
    s_sub_u32 s81, s77, s10
K2_BATCH:
    s_barrier
    v_and_b32 v188, 7, v254
    v_mul_u32_u24 v189, 2688, v188
    v_add_u32 v189, 9728, v189
    v_lshlrev_b32 v188, 2, v188
    ds_write_b32 v188, v189 offset:2112
    v_add_u32 v188, s81, v255
    s_mul_i32 s10, s12, 32896
    s_lshl_b32 s11, s80, 7
    s_add_u32 s10, s10, s11
    v_mul_u32_u24 v190, 87382, v188
    v_lshrrev_b32 v190, 16, v190
    v_lshl_add_u32 v189, v190, 2, s10
    v_add_u32 v191, 8421248, v189
    v_cmp_lt_u32 vcc, 31, v190
    s_mul_i32 s11, s80, 3125
    s_add_u32 s11, s11, s83
    v_cndmask_b32 v189, v189, v191, vcc
    v_or_b32 v191, 12, v189
    v_and_b32 v192, 3, v190
    v_add_u32 v191, v191, v192
    v_cmp_le_u32 vcc, 48, v190
    v_add_u32 v190, s11, v188
    v_add_u32 v192, 22020096, v190
    v_cndmask_b32 v191, v191, v192, vcc
    v_lshlrev_b32 v190, 2, v190
    v_add_u32 v190, 17825792, v190
    v_cndmask_b32 v189, v189, v190, vcc
    s_add_u32 s10, s81, 448
    s_min_u32 s10, s10, s82
    v_cmp_gt_u32 vcc, s10, v188
    v_mov_b32 v190, 0x7ffffff0
    s_mul_i32 s86, s80, 100000
    v_cndmask_b32 v189, v190, v189, vcc
    v_cndmask_b32 v191, v190, v191, vcc
    buffer_load_dword v189, v189, s[24:27], 0 offen sc1
    buffer_load_ubyte v191, v191, s[24:27], 0 offen sc1
    s_waitcnt lgkmcnt(0)
    s_barrier
    s_and_saveexec_b64 s[10:11], vcc
    s_waitcnt vmcnt(0)
    v_and_b32 v188, 255, v189
    v_lshlrev_b32 v188, 2, v188
    ds_read_b32 v188, v188 offset:6400
    v_bfe_u32 v190, v189, 8, 8
    v_and_b32 v191, 15, v191
    v_lshl_or_b32 v191, v191, 8, v190
    v_mov_b32 v190, 4
    v_lshl_add_u32 v191, v191, 5, s86
    s_waitcnt lgkmcnt(0)
    ds_add_rtn_u32 v188, v188, v190 offset:2112
    s_waitcnt lgkmcnt(0)
    ds_write2st64_b32 v188, v189, v191 offset0:0 offset1:84
    s_mov_b64 exec, -1
    s_waitcnt lgkmcnt(0)
    s_barrier
    s_lshl_b32 s10, s3, 2
    v_mov_b32 v188, s10
    ds_read_b32 v188, v188 offset:2112
    v_mov_b32 v180, 0
    v_mov_b32 v181, 0
    v_mov_b32 v182, 0
    v_mov_b32 v183, 0
    v_mov_b32 v184, 0
    v_mov_b32 v185, 0
    v_mov_b32 v186, 0
    v_mov_b32 v187, 0
    v_lshrrev_b32 v189, 3, v254
    v_lshl_add_u32 v247, v189, 4, s76
    v_and_b32 v189, 31, v254
    v_lshl_add_u32 v249, v189, 2, s76
    v_lshrrev_b32 v190, 1, v254
    v_lshl_add_u32 v251, v190, 2, s76
    v_add_u32 v251, 21504, v251
    v_and_b32 v189, 44, v254
    v_add_u32 v248, s76, v189
    s_waitcnt lgkmcnt(0)
    v_readfirstlane_b32 s15, v188
    s_nop 3
    v_mov_b32 v190, 0xffff0000
    v_or_b32 v189, s39, v190
    v_mov_b32 v190, 0x7fffff00
    v_lshl_add_u32 v188, v254, 2, s15
    s_sub_u32 s73, s15, s76
    ds_write2st64_b32 v188, v189, v190 offset0:0 offset1:84
    ds_write2st64_b32 v188, v189, v190 offset0:1 offset1:85
    s_add_u32 s73, s73, 127
    s_lshr_b32 s73, s73, 7
    s_sub_i32 s38, s73, 1
K2_LAST:
    s_branch K2_GO
.section .rodata,"a"
.p2align 6
.amdhsa_kernel standalone__edge_featured_mpnn_gatedgcn__graph_kernel
  .amdhsa_next_free_vgpr 256
  .amdhsa_next_free_sgpr 102
  .amdhsa_accum_offset 256
  .amdhsa_group_segment_fixed_size 0
  .amdhsa_kernarg_size 96
  .amdhsa_user_sgpr_count 2
  .amdhsa_user_sgpr_kernarg_segment_ptr 1
  .amdhsa_system_sgpr_workgroup_id_x 1
.end_amdhsa_kernel
```

```asm
; @launch grid=(256,1,1) block=(512,1,1) lds=157696
.amdgcn_target "amdgcn-amd-amdhsa--gfx950"
.text
.globl standalone__edge_featured_mpnn_gatedgcn__graph_kernel
.p2align 8
.type standalone__edge_featured_mpnn_gatedgcn__graph_kernel,@function
standalone__edge_featured_mpnn_gatedgcn__graph_kernel:
    s_cmp_ge_u32 s2, 256
    s_cbranch_scc1 K2_END
    s_load_dwordx4 s[44:47], s[0:1], 16
    s_load_dwordx2 s[8:9], s[0:1], 88
    s_load_dwordx4 s[40:43], s[0:1], 0
    s_load_dwordx8 s[48:55], s[0:1], 32
    s_load_dwordx4 s[56:59], s[0:1], 64
    s_getpc_b64 s[86:87]
K2_PC:
    v_lshlrev_b32 v252, 7, v0
    v_min_u32 v252, K2_LAST-K2_PC, v252
    v_cmp_gt_u32 vcc, 192, v0
    s_cbranch_vccz K2_NOCPF
    global_load_dword v253, v252, s[86:87]
K2_NOCPF:
    v_mov_b32 v255, v0
    v_lshrrev_b32 v188, 6, v0
    v_and_b32 v254, 63, v0
    v_readfirstlane_b32 s7, v188
    s_and_b32 s10, s2, 7
    s_lshr_b32 s11, s2, 3
    s_lshl_b32 s10, s10, 5
    s_add_u32 s12, s10, s11
    s_mul_i32 s13, s12, 12500
    v_lshlrev_b32 v189, 4, v0
    v_lshlrev_b32 v1, 3, v0
    v_lshlrev_b32 v2, 2, v0
    v_mov_b32 v3, 0
    v_and_b32 v4, 0x3fc, v2
    ds_write_b32 v4, v3 offset:6400
    s_and_b32 s10, s7, 3
    s_lshr_b32 s3, s7, 2
    s_lshl1_add_u32 s3, s10, s3
    s_xor_b32 s3, s3, 1
    s_movk_i32 s14, 8192
    s_movk_i32 s15, 12288
    s_waitcnt lgkmcnt(0)
    s_add_u32 s64, s46, s13
    s_addc_u32 s65, s47, 0
    s_mov_b32 s66, 12500
    s_mov_b32 s67, 0x20000
    s_add_u32 s68, s44, s13
    s_addc_u32 s69, s45, 0
    s_mov_b32 s70, 12500
    s_mov_b32 s71, 0x20000
    buffer_load_dwordx4 v[8:11], v189, s[64:67], 0 offen nt
    buffer_load_dwordx2 v[12:13], v1, s[64:67], s14 offen nt
    buffer_load_dword v14, v2, s[64:67], s15 offen nt
    s_barrier
    buffer_load_dwordx4 v[16:19], v189, s[68:71], 0 offen nt
    buffer_load_dwordx2 v[20:21], v1, s[68:71], s14 offen nt
    buffer_load_dword v22, v2, s[68:71], s15 offen nt
    s_add_u32 s10, s8, 24117248
    s_addc_u32 s11, s9, 0
    s_load_dword s100, s[10:11], 0
    v_lshrrev_b32 v1, 3, v0
    v_lshlrev_b32 v170, 2, v1
    v_and_b32 v197, 7, v0
    v_and_b32 v5, 16, v0
    v_lshlrev_b32 v5, 1, v5
    v_xor_b32 v5, v5, v189
    v_lshlrev_b32 v172, 4, v254
    v_and_b32 v241, 16, v254
    v_lshlrev_b32 v241, 2, v241
    v_xor_b32 v234, v241, v172
    v_and_b32 v241, 0x70, v234
    s_mov_b32 s16, s40
    s_mov_b32 s17, s41
    s_mov_b32 s18, 6400000
    s_mov_b32 s19, 0x20000
    s_mov_b32 s60, 85599
    s_mov_b32 s61, 4294967100
    s_movk_i32 s62, 2000
    v_mov_b32 v7, 87382
    s_mov_b32 s10, 0
    v_lshl_add_u32 v56, v254, 10, s10
    v_add_u32 v57, 256, v56
    v_add_u32 v58, 512, v56
    v_add_u32 v59, 768, v56
    v_and_b32 v60, 127, v255
    v_lshl_add_u32 v60, v60, 9, s10
    v_add_u32 v61, 256, v60
    v_lshl_add_u32 v62, v254, 8, s10
    v_lshrrev_b32 v23, 6, v255
    v_lshrrev_b32 v31, 7, v255
    v_add_u32 v31, 8, v31
    v_mov_b32 v39, 12
    v_cmp_gt_u32 s[78:79], 53, v255
    s_mov_b32 s11, 32896
    v_lshlrev_b32 v3, 4, v197
    v_mad_u32_u24 v4, v1, s11, v3
    v_mul_u32_u24 v6, 52, v1
    v_lshl_add_u32 v6, v197, 2, v6
    v_lshlrev_b32 v3, 2, v6
    v_add_u32 v3, 104448, v3
    v_add_u32 v6, 91136, v6
    v_mov_b32 v214, 0xf0f0f0
    v_mov_b32 v15, 0x0f0f0f
    s_waitcnt vmcnt(3)
    v_mul_u32_u24 v48, s60, v8
    v_mul_u32_u24 v49, s60, v9
    v_mul_u32_u24 v50, s60, v10
    v_mul_u32_u24 v51, s60, v11
    v_mul_u32_u24 v52, s60, v12
    v_mul_u32_u24 v53, s60, v13
    v_lshrrev_b32 v48, 24, v48
    v_lshrrev_b32 v49, 24, v49
    v_lshrrev_b32 v50, 24, v50
    v_lshrrev_b32 v51, 24, v51
    v_lshrrev_b32 v52, 24, v52
    v_lshrrev_b32 v53, 24, v53
    v_lshl_add_u32 v24, v48, 2, s62
    ds_add_rtn_u32 v32, v24, v7 offset:4400
    v_lshl_add_u32 v25, v49, 2, s62
    ds_add_rtn_u32 v33, v25, v7 offset:4400
    v_lshl_add_u32 v26, v50, 2, s62
    ds_add_rtn_u32 v34, v26, v7 offset:4400
    v_lshl_add_u32 v27, v51, 2, s62
    ds_add_rtn_u32 v35, v27, v7 offset:4400
    v_lshl_add_u32 v28, v52, 2, s62
    ds_add_rtn_u32 v36, v28, v7 offset:4400
    v_lshl_add_u32 v29, v53, 2, s62
    ds_add_rtn_u32 v37, v29, v7 offset:4400
    v_mad_i32_i24 v8, v48, s61, v8
    v_or_b32 v8, v8, v56
    v_mad_i32_i24 v9, v49, s61, v9
    v_or_b32 v9, v9, v57
    v_mad_i32_i24 v10, v50, s61, v10
    v_or_b32 v10, v10, v58
    v_mad_i32_i24 v11, v51, s61, v11
    v_or_b32 v11, v11, v59
    v_mad_i32_i24 v12, v52, s61, v12
    v_or_b32 v12, v12, v60
    v_mad_i32_i24 v13, v53, s61, v13
    v_or_b32 v13, v13, v61
    s_waitcnt lgkmcnt(5)
    v_lshrrev_b32 v32, 16, v32
    v_min_u32 v40, 48, v32
    v_mad_u32_u24 v40, v24, 13, v40
    v_lshlrev_b32 v48, 2, v40
    ds_write_b8 v40, v23 offset:65136
    s_waitcnt lgkmcnt(5)
    v_lshrrev_b32 v33, 16, v33
    v_min_u32 v41, 48, v33
    v_mad_u32_u24 v41, v25, 13, v41
    v_lshlrev_b32 v49, 2, v41
    ds_write_b8 v41, v23 offset:65136
    s_waitcnt lgkmcnt(5)
    v_lshrrev_b32 v34, 16, v34
    v_min_u32 v42, 48, v34
    v_mad_u32_u24 v42, v26, 13, v42
    v_lshlrev_b32 v50, 2, v42
    ds_write_b8 v42, v23 offset:65136
    s_waitcnt lgkmcnt(5)
    v_lshrrev_b32 v35, 16, v35
    v_min_u32 v43, 48, v35
    v_mad_u32_u24 v43, v27, 13, v43
    v_lshlrev_b32 v51, 2, v43
    ds_write_b8 v43, v23 offset:65136
    s_waitcnt lgkmcnt(5)
    v_lshrrev_b32 v36, 16, v36
    v_min_u32 v44, 48, v36
    v_mad_u32_u24 v44, v28, 13, v44
    v_lshlrev_b32 v52, 2, v44
    ds_write_b8 v44, v31 offset:65136
    s_waitcnt lgkmcnt(5)
    v_lshrrev_b32 v37, 16, v37
    v_min_u32 v45, 48, v37
    v_mad_u32_u24 v45, v29, 13, v45
    v_lshlrev_b32 v53, 2, v45
    ds_write_b8 v45, v31 offset:65136
    s_cmp_lg_u32 s7, 0
    s_cbranch_scc1 K1_NO7
    s_mov_b64 exec, s[78:79]
    s_waitcnt lgkmcnt(0)
    v_mul_u32_u24 v54, s60, v14
    v_lshrrev_b32 v54, 24, v54
    v_lshl_add_u32 v30, v54, 2, s62
    ds_add_rtn_u32 v38, v30, v7 offset:4400
    v_mad_i32_i24 v14, v54, s61, v14
    v_or_b32 v14, v14, v62
    s_waitcnt lgkmcnt(0)
    v_lshrrev_b32 v38, 16, v38
    v_min_u32 v46, 48, v38
    v_mad_u32_u24 v46, v30, 13, v46
    v_lshlrev_b32 v54, 2, v46
    ds_write_b8 v46, v39 offset:65136
    s_waitcnt vmcnt(0)
    v_lshl_add_u32 v22, v22, 16, v14
    ds_write_b32 v54, v22 offset:448
    s_mov_b64 exec, -1
K1_NO7:
    s_mov_b32 s64, s50
    s_mov_b32 s65, s51
    s_mov_b32 s66, 8192
    s_mov_b32 s67, 0x20000
    buffer_load_dwordx4 v[64:67], v5, s[64:67], 0 offen
    s_mov_b32 s68, s52
    s_mov_b32 s69, s53
    s_mov_b32 s70, 2048
    s_mov_b32 s71, 0x20000
    buffer_load_dwordx4 v[68:71], v5, s[68:71], 0 offen
    s_lshl_b32 s10, s7, 10
    s_mov_b32 s64, s48
    s_mov_b32 s65, s49
    s_add_u32 m0, s10, 34304
    s_nop 0
    buffer_load_dwordx4 v5, s[64:67], 0 offen lds
    s_mov_b32 s64, s56
    s_mov_b32 s65, s57
    s_add_u32 m0, s10, 26112
    s_nop 0
    buffer_load_dwordx4 v5, s[64:67], 0 offen lds
    s_mov_b32 s64, s54
    s_mov_b32 s65, s55
    s_add_u32 m0, s10, 9728
    s_nop 0
    buffer_load_dwordx4 v5, s[64:67], 0 offen lds
    s_waitcnt vmcnt(5)
    v_lshl_add_u32 v16, v16, 16, v8
    ds_write_b32 v48, v16 offset:448
    v_lshl_add_u32 v17, v17, 16, v9
    ds_write_b32 v49, v17 offset:448
    v_lshl_add_u32 v18, v18, 16, v10
    ds_write_b32 v50, v18 offset:448
    v_lshl_add_u32 v19, v19, 16, v11
    ds_write_b32 v51, v19 offset:448
    v_lshl_add_u32 v20, v20, 16, v12
    ds_write_b32 v52, v20 offset:448
    v_lshl_add_u32 v21, v21, 16, v13
    ds_write_b32 v53, v21 offset:448
    s_lshl_b32 s15, s12, 7
    s_add_u32 s32, s8, s15
    s_addc_u32 s33, s9, 0
    s_mov_b32 s34, 16809984
    s_mov_b32 s35, 0x20000
    s_waitcnt lgkmcnt(0)
    s_add_u32 s100, s100, 1
    s_and_b32 s10, s100, 15
    s_and_b32 s11, s100, 0xf0
    s_mul_i32 s36, s10, 0x1010
    s_lshl_b32 s11, s11, 16
    s_xor_b32 s36, s36, 0xf000
    s_or_b32 s36, s36, s11
    s_mov_b32 s101, 300000
    s_barrier
    ds_read_b128 v[112:115], v172 offset:6400
    ds_read_u16 v108, v170 offset:6402
    ds_read_b32 v104, v6 offset:0
    ds_read_b128 v[88:91], v3 offset:0
    ds_read_u16 v109, v170 offset:6658
    ds_read_b32 v105, v6 offset:3328
    ds_read_b128 v[92:95], v3 offset:13312
    ds_read_u16 v110, v170 offset:6914
    ds_read_b32 v106, v6 offset:6656
    ds_read_b128 v[96:99], v3 offset:26624
    ds_read_u16 v111, v170 offset:7170
    ds_read_b32 v107, v6 offset:9984
    ds_read_b128 v[100:103], v3 offset:39936
    s_waitcnt lgkmcnt(12)
    v_max3_u32 v1, v112, v113, v114
    v_max_u32 v1, v1, v115
    v_cmp_le_u32 vcc, 3211264, v1
    s_mov_b32 s10, 0
    s_cbranch_vccnz K1_OVF
K1_OUT:
    s_waitcnt lgkmcnt(9)
    v_lshl_or_b32 v108, v108, 24, s36
    v_and_or_b32 v91, v104, v15, v108
    buffer_store_dwordx4 v[88:91], v4, s[32:35], s10 offen sc1
    s_add_u32 s10, s10, 2105344
    s_waitcnt lgkmcnt(6)
    v_lshl_or_b32 v109, v109, 24, s36
    v_and_or_b32 v95, v105, v15, v109
    buffer_store_dwordx4 v[92:95], v4, s[32:35], s10 offen sc1
    s_add_u32 s10, s10, 2105344
    s_waitcnt lgkmcnt(3)
    v_lshl_or_b32 v110, v110, 24, s36
    v_and_or_b32 v99, v106, v15, v110
    buffer_store_dwordx4 v[96:99], v4, s[32:35], s10 offen sc1
    s_add_u32 s10, s10, 2105344
    s_waitcnt lgkmcnt(0)
    v_lshl_or_b32 v111, v111, 24, s36
    v_and_or_b32 v103, v107, v15, v111
    buffer_store_dwordx4 v[100:103], v4, s[32:35], s10 offen sc1
    s_add_u32 s10, s10, 2105344
    v_max3_u32 v1, v108, v109, v110
    v_max_u32 v1, v1, v111
    v_cmp_le_u32 vcc, 553648128, v1
    s_cbranch_vccnz K1_EXT
K1_EXTR:
    s_lshr_b32 s10, s3, 1
    s_mul_i32 s10, s10, 49
    s_bitcmp1_b32 s3, 0
    s_cselect_b32 s72, 20, -4
    s_cselect_b32 s73, 28, 3
    s_cselect_b32 s84, 45, 20
    s_add_i32 s72, s72, s10
    s_add_i32 s73, s73, s10
    s_add_i32 s84, s84, s10
    s_add_i32 s85, s72, 32
    s_max_i32 s96, s72, 0
    s_cmp_eq_u32 s3, 7
    s_cselect_b32 s84, 196, s84
    s_cselect_b32 s85, 196, s85
    v_lshrrev_b32 v193, 5, v254
    s_mov_b32 s20, s42
    s_mov_b32 s21, s43
    s_mov_b32 s22, 25600000
    s_mov_b32 s23, 0x20000
    s_mov_b32 s28, s58
    s_mov_b32 s29, s59
    s_mov_b32 s30, 6400000
    s_mov_b32 s31, 0x20000
    s_mov_b32 s24, s8
    s_mov_b32 s25, s9
    s_mov_b32 s26, 24117376
    s_mov_b32 s27, 0x20000
    v_lshrrev_b32 v194, 5, v255
    v_and_b32 v195, 15, v255
    v_cmp_eq_u32 vcc, v194, v195
    v_and_b32 v194, 16, v255
    v_mov_b32 v195, 0x3f80
    v_lshlrev_b32 v195, v194, v195
    v_cndmask_b32 v195, 0, v195, vcc
    v_lshlrev_b32 v194, 2, v255
    v_mov_b32 v196, 0
    ds_write_b32 v194, v195
    v_bfe_u32 v195, v255, 3, 1
    v_and_b32 v201, 7, v255
    v_lshl_add_u32 v195, v195, 2, v201
    v_lshrrev_b32 v200, 6, v255
    v_cmp_eq_u32 vcc, v195, v200
    v_bfe_u32 v200, v255, 4, 2
    v_mov_b32 v195, 0x3f80
    v_cndmask_b32 v195, 0, v195, vcc
    v_cmp_lt_u32 vcc, 3, v201
    v_mul_u32_u24 v200, 0x5555, v200
    v_and_b32 v201, 60, v194
    v_cndmask_b32 v195, v195, v200, vcc
    ds_write_b32 v194, v195 offset:7424
    ds_write_b32 v201, v196 offset:9472
    ds_write_b32 v194, v196 offset:2048
    ds_write2st64_b32 v194, v196, v196 offset0:9 offset1:17
    s_movk_i32 s75, 128
    s_mul_i32 s74, s3, 5184
    s_add_u32 s74, s74, 102400
    s_movk_i32 s77, 48
    s_add_u32 s39, s96, 32
    s_lshl_b32 s11, s96, 6
    s_mov_b32 s97, 0
    v_bfe_u32 v194, v254, 4, 1
    v_and_b32 v242, 1, v254
    v_lshlrev_b32 v242, 4, v242
    v_lshlrev_b32 v245, 5, v193
    v_subrev_u32 v245, s11, v245
    v_and_b32 v195, 3, v254
    v_lshlrev_b32 v195, 3, v195
    v_lshl_add_u32 v246, v194, 5, v195
    v_subrev_u32 v246, s11, v246
    v_mul_u32_u24 v196, 130, v195
    v_and_b32 v194, 28, v254
    v_lshl_add_u32 v196, v194, 5, v196
    v_bfe_u32 v194, v254, 3, 1
    v_xor_b32 v194, v194, v193
    v_lshl_add_u32 v196, v194, 6, v196
    v_add_u32 v243, s74, v196
    v_and_b32 v194, 31, v254
    v_lshl_add_u32 v194, v194, 1, v193
    v_lshl_add_u32 v244, v194, 4, s74
    v_add_u32 v244, 4160, v244
    s_mul_i32 s76, s3, 2688
    s_add_u32 s76, s76, 9728
    v_lshrrev_b32 v194, 3, v254
    v_lshl_add_u32 v247, v194, 4, s76
    v_and_b32 v194, 31, v254
    v_lshl_add_u32 v249, v194, 2, s76
    v_lshrrev_b32 v195, 1, v254
    v_lshl_add_u32 v251, v195, 2, s76
    v_add_u32 v251, 21504, v251
    v_and_b32 v194, 44, v254
    v_add_u32 v248, s76, v194
    s_mul_i32 s10, s7, 4160
    s_add_u32 s10, s10, 69120
    v_and_b32 v202, 31, v254
    v_bfe_u32 v194, v202, 1, 1
    v_xor_b32 v194, v194, v193
    v_lshlrev_b32 v194, 6, v194
    v_lshl_add_u32 v194, v202, 7, v194
    v_lshrrev_b32 v202, 3, v202
    v_lshl_add_u32 v202, v202, 4, v194
    v_add_u32 v202, s10, v202
    v_lshrrev_b32 v194, 1, v254
    v_xor_b32 v194, v194, v254
    v_and_b32 v194, 4, v194
    v_mul_u32_u24 v194, 3, v194
    v_xor_b32 v194, v194, v254
    v_and_b32 v235, 31, v194
    v_bfe_u32 v195, v235, 1, 1
    v_xor_b32 v195, v195, v193
    v_lshlrev_b32 v195, 6, v195
    v_lshl_add_u32 v195, v235, 7, v195
    v_lshrrev_b32 v235, 3, v235
    v_lshl_add_u32 v235, v235, 4, v195
    v_add_u32 v235, s10, v235
    v_mov_b32 v177, 0xdddd
    v_lshlrev_b32 v168, 2, v197
    v_mul_u32_u24 v208, 25000, v170
    v_add_u32 v209, 6400000, v208
    v_add_u32 v210, 12800000, v208
    v_add_u32 v211, 19200000, v208
    v_mov_b32 v171, 4
    v_mov_b32 v169, 1
    v_and_b32 v199, 31, v254
    v_add_u32 v199, s96, v199
    v_lshlrev_b32 v200, 4, v199
    v_lshl_add_u32 v200, v193, 3, v200
    v_mov_b64 v[180:181], 0
    v_mov_b64 v[182:183], 0
    v_mov_b64 v[184:185], 0
    v_mov_b64 v[186:187], 0
    s_lshl_b32 s15, s3, 2
    v_mov_b32 v212, s15
    v_lshlrev_b32 v213, 2, v199
    s_mul_i32 s10, s12, 32896
    s_add_u32 s32, s8, s10
    s_addc_u32 s33, s9, 0
    s_mov_b32 s34, 32768
    s_mov_b32 s35, 0x20000
    s_movk_i32 s79, 8192
    s_movk_i32 s80, 16384
    s_movk_i32 s81, 24576
    s_mov_b32 s10, 0xbfb8aa3b
    s_waitcnt vmcnt(7)
    v_lshlrev_b32 v72, 16, v64
    v_and_b32 v73, 0xffff0000, v64
    v_lshlrev_b32 v74, 16, v65
    v_and_b32 v75, 0xffff0000, v65
    v_lshlrev_b32 v76, 16, v66
    v_and_b32 v77, 0xffff0000, v66
    v_lshlrev_b32 v78, 16, v67
    v_and_b32 v79, 0xffff0000, v67
    v_lshlrev_b32 v80, 16, v68
    v_and_b32 v81, 0xffff0000, v68
    v_lshlrev_b32 v82, 16, v69
    v_and_b32 v83, 0xffff0000, v69
    v_lshlrev_b32 v84, 16, v70
    v_and_b32 v85, 0xffff0000, v70
    v_lshlrev_b32 v86, 16, v71
    v_and_b32 v87, 0xffff0000, v71
    v_mul_f32 v72, s10, v72
    v_mul_f32 v73, s10, v73
    v_mul_f32 v74, s10, v74
    v_mul_f32 v75, s10, v75
    v_mul_f32 v76, s10, v76
    v_mul_f32 v77, s10, v77
    v_mul_f32 v78, s10, v78
    v_mul_f32 v79, s10, v79
    v_mul_f32 v80, s10, v80
    v_mul_f32 v81, s10, v81
    v_mul_f32 v82, s10, v82
    v_mul_f32 v83, s10, v83
    v_mul_f32 v84, s10, v84
    v_mul_f32 v85, s10, v85
    v_mul_f32 v86, s10, v86
    v_mul_f32 v87, s10, v87
    v_cvt_pk_bf16_f32 v64, v72, v73
    v_cvt_pk_bf16_f32 v65, v74, v75
    v_cvt_pk_bf16_f32 v66, v76, v77
    v_cvt_pk_bf16_f32 v67, v78, v79
    v_cvt_pk_bf16_f32 v68, v80, v81
    v_cvt_pk_bf16_f32 v69, v82, v83
    v_cvt_pk_bf16_f32 v70, v84, v85
    v_cvt_pk_bf16_f32 v71, v86, v87
    ds_write_b128 v189, v[64:67] offset:17920
    s_cmp_ge_u32 s7, 2
    s_cbranch_scc1 K1_NOWC
    ds_write_b128 v189, v[68:71] offset:42496
K1_NOWC:
    v_bfe_u32 v173, v254, 2, 2
    v_lshlrev_b32 v173, 7, v173
    v_lshl_add_u32 v173, v242, 2, v173
    v_and_b32 v174, 16, v254
    v_and_b32 v175, 2, v254
    v_lshl_add_u32 v174, v175, 2, v174
    v_and_b32 v175, 8, v254
    v_lshl_add_u32 v174, v175, 2, v174
    v_add_u32 v173, v173, v174
    v_lshl_add_u32 v175, v193, 10, v173
    v_lshl_add_u32 v173, v193, 12, v173
    v_xor_b32 v174, 32, v173
    v_xor_b32 v176, 32, v175
    s_lshl_b32 s10, s7, 10
    s_and_b32 s11, s7, 4
    s_mul_i32 s11, s11, -1016
    s_add_u32 s11, s11, s10
    v_xor_b32 v252, s11, v173
    s_waitcnt vmcnt(0) lgkmcnt(0)
    s_barrier
    buffer_load_dwordx4 v[88:91], v189, s[32:35], 0 offen sc1
    buffer_load_dwordx4 v[92:95], v189, s[32:35], s79 offen sc1
    buffer_load_dwordx4 v[96:99], v189, s[32:35], s80 offen sc1
    buffer_load_dwordx4 v[100:103], v189, s[32:35], s81 offen sc1
    ds_read_b64_tr_b16 v[72:73], v252 offset:9728
    ds_read_b64_tr_b16 v[76:77], v252 offset:34304
    ds_read_b64_tr_b16 v[74:75], v252 offset:10240
    ds_read_b64_tr_b16 v[78:79], v252 offset:34816
    v_add_u32 v252, s10, v172
    ds_read_b64_tr_b16 v[0:1], v173 offset:17920
    ds_read_b64_tr_b16 v[2:3], v173 offset:18432
    ds_read_b64_tr_b16 v[4:5], v173 offset:18944
    ds_read_b64_tr_b16 v[6:7], v173 offset:19456
    ds_read_b64_tr_b16 v[8:9], v173 offset:19968
    ds_read_b64_tr_b16 v[10:11], v173 offset:20480
    ds_read_b64_tr_b16 v[12:13], v173 offset:20992
    ds_read_b64_tr_b16 v[14:15], v173 offset:21504
    s_waitcnt lgkmcnt(8)
    ds_write_b128 v252, v[72:75] offset:52736
    s_mov_b32 s10, 0xbfb8aa3b
    v_lshlrev_b32 v80, 16, v76
    v_and_b32 v81, 0xffff0000, v76
    v_lshlrev_b32 v82, 16, v77
    v_and_b32 v83, 0xffff0000, v77
    v_lshlrev_b32 v84, 16, v78
    v_and_b32 v85, 0xffff0000, v78
    v_lshlrev_b32 v86, 16, v79
    v_and_b32 v87, 0xffff0000, v79
    v_mul_f32 v80, s10, v80
    v_mul_f32 v81, s10, v81
    v_mul_f32 v82, s10, v82
    v_mul_f32 v83, s10, v83
    v_mul_f32 v84, s10, v84
    v_mul_f32 v85, s10, v85
    v_mul_f32 v86, s10, v86
    v_mul_f32 v87, s10, v87
    v_cvt_pk_bf16_f32 v76, v80, v81
    v_cvt_pk_bf16_f32 v77, v82, v83
    v_cvt_pk_bf16_f32 v78, v84, v85
    v_cvt_pk_bf16_f32 v79, v86, v87
    ds_write_b128 v252, v[76:79] offset:60928
    v_and_b32 v188, 3, v254
    v_lshlrev_b32 v190, 4, v188
    v_mul_u32_u24 v188, 5376, v188
    v_add_u32 v188, 2688, v188
    ds_write_b16 v190, v188 offset:6338
    s_waitcnt lgkmcnt(8)
    ds_read_b64_tr_b16 v[16:17], v174 offset:17920
    ds_read_b64_tr_b16 v[18:19], v174 offset:18432
    ds_read_b64_tr_b16 v[20:21], v174 offset:18944
    ds_read_b64_tr_b16 v[22:23], v174 offset:19456
    ds_read_b64_tr_b16 v[24:25], v174 offset:19968
    ds_read_b64_tr_b16 v[26:27], v174 offset:20480
    s_waitcnt lgkmcnt(8)
    ds_read_b64_tr_b16 v[28:29], v174 offset:20992
    ds_read_b64_tr_b16 v[30:31], v174 offset:21504
    ds_read_b64_tr_b16 v[64:65], v175 offset:42496
    ds_read_b64_tr_b16 v[66:67], v175 offset:43008
    ds_read_b64_tr_b16 v[68:69], v176 offset:42496
    ds_read_b64_tr_b16 v[70:71], v176 offset:43008
    s_waitcnt lgkmcnt(8)
    ds_read_b64_tr_b16 v[32:33], v173 offset:26112
    ds_read_b64_tr_b16 v[34:35], v173 offset:26624
    ds_read_b64_tr_b16 v[36:37], v173 offset:27136
    ds_read_b64_tr_b16 v[38:39], v173 offset:27648
    ds_read_b64_tr_b16 v[40:41], v173 offset:28160
    ds_read_b64_tr_b16 v[42:43], v173 offset:28672
    s_waitcnt lgkmcnt(8)
    ds_read_b64_tr_b16 v[44:45], v173 offset:29184
    ds_read_b64_tr_b16 v[46:47], v173 offset:29696
    ds_read_b64_tr_b16 v[48:49], v174 offset:26112
    ds_read_b64_tr_b16 v[50:51], v174 offset:26624
    ds_read_b64_tr_b16 v[52:53], v174 offset:27136
    ds_read_b64_tr_b16 v[54:55], v174 offset:27648
    s_waitcnt lgkmcnt(8)
    ds_read_b64_tr_b16 v[56:57], v174 offset:28160
    ds_read_b64_tr_b16 v[58:59], v174 offset:28672
    ds_read_b64_tr_b16 v[60:61], v174 offset:29184
    ds_read_b64_tr_b16 v[62:63], v174 offset:29696
    s_mov_b32 s5, 85899
    s_lshr_b32 s6, s12, 5
    s_mul_i32 s6, s6, 538758528
    s_sub_u32 s6, s6, 0
    s_mov_b32 s64, 0xc0c0401
    s_mov_b32 s65, 0xc0c0501
    s_mov_b32 s66, 0xc0c0601
    s_mov_b32 s67, 0x05040100
    s_movk_i32 s4, 1338
    s_movk_i32 s13, 4032
    s_movk_i32 s14, 16056
    s_waitcnt lgkmcnt(0)
    s_barrier
K2_CHK0:
    s_waitcnt vmcnt(3)
    v_bitop3_b32 v188, v91, s36, v214 bitop3:0x28
    v_cmp_ne_u32 vcc, 0, v188
    v_sub_u32_sdwa v188, v91, v168 dst_sel:DWORD dst_unused:UNUSED_PAD src0_sel:BYTE_3 src1_sel:DWORD
    v_mul_u32_u24_sdwa v104, s5, v88 dst_sel:DWORD dst_unused:UNUSED_PAD src0_sel:DWORD src1_sel:WORD_1
    v_mul_u32_u24_sdwa v105, s5, v89 dst_sel:DWORD dst_unused:UNUSED_PAD src0_sel:DWORD src1_sel:WORD_1
    v_mul_u32_u24_sdwa v106, s5, v90 dst_sel:DWORD dst_unused:UNUSED_PAD src0_sel:DWORD src1_sel:WORD_1
    s_cbranch_vccnz K2_RETRY0
    v_cmp_lt_i32 s[40:41], 0, v188
    v_cmp_lt_i32 s[42:43], 1, v188
    v_cmp_lt_i32 s[44:45], 2, v188
    v_subrev_u32 v104, s6, v104
    v_subrev_u32 v105, s6, v105
    v_subrev_u32 v106, s6, v106
    v_alignbit_b32 v104, v88, v104, 28
    v_alignbit_b32 v105, v89, v105, 28
    v_alignbit_b32 v106, v90, v106, 28
    v_and_b32 v104, 0xffc, v104
    v_and_b32 v105, 0xffc, v105
    v_and_b32 v106, 0xffc, v106
    v_mul_u32_u24_sdwa v116, s4, v88 dst_sel:DWORD dst_unused:UNUSED_PAD src0_sel:DWORD src1_sel:BYTE_0
    v_mul_u32_u24_sdwa v117, s4, v89 dst_sel:DWORD dst_unused:UNUSED_PAD src0_sel:DWORD src1_sel:BYTE_0
    v_mul_u32_u24_sdwa v118, s4, v90 dst_sel:DWORD dst_unused:UNUSED_PAD src0_sel:DWORD src1_sel:BYTE_0
    v_subrev_u32 v116, 40140, v116
    v_subrev_u32 v117, 40140, v117
    v_subrev_u32 v118, 40140, v118
    v_cmp_gt_u16 s[68:69], s14, v116
    v_cmp_gt_u16 s[70:71], s14, v117
    v_cmp_gt_u16 s[86:87], s14, v118
    v_lshrrev_b32 v116, 16, v116
    v_lshrrev_b32 v117, 16, v117
    v_lshrrev_b32 v118, 16, v118
    v_lshl_add_u32 v116, v116, 4, s13
    v_lshl_add_u32 v117, v117, 4, s13
    v_lshl_add_u32 v118, v118, 4, s13
    v_cndmask_b32 v104, v104, v116, s[68:69]
    v_cndmask_b32 v105, v105, v117, s[70:71]
    v_cndmask_b32 v106, v106, v118, s[86:87]
    s_mov_b64 exec, s[40:41]
    ds_add_rtn_u32 v220, v104, v171 offset:2304
    s_mov_b64 exec, s[42:43]
    ds_add_rtn_u32 v221, v105, v171 offset:2304
    s_mov_b64 exec, s[44:45]
    ds_add_rtn_u32 v222, v106, v171 offset:2304
    s_mov_b64 exec, -1
    v_and_b32 v119, 0x0f0f0f, v91
    v_perm_b32 v152, v119, v88, s64
    s_and_b64 s[68:69], s[68:69], s[40:41]
    v_lshl_add_u32 v152, v152, 5, v208
    s_andn2_b64 s[40:41], s[40:41], s[68:69]
    v_perm_b32 v153, v119, v89, s65
    s_and_b64 s[70:71], s[70:71], s[42:43]
    v_lshl_add_u32 v153, v153, 5, v208
    s_andn2_b64 s[42:43], s[42:43], s[70:71]
    v_perm_b32 v154, v119, v90, s66
    s_and_b64 s[86:87], s[86:87], s[44:45]
    v_lshl_add_u32 v154, v154, 5, v208
    s_andn2_b64 s[44:45], s[44:45], s[86:87]
K2_CHK1:
    s_waitcnt vmcnt(2)
    v_bitop3_b32 v188, v95, s36, v214 bitop3:0x28
    v_cmp_ne_u32 vcc, 0, v188
    v_sub_u32_sdwa v188, v95, v168 dst_sel:DWORD dst_unused:UNUSED_PAD src0_sel:BYTE_3 src1_sel:DWORD
    v_mul_u32_u24_sdwa v107, s5, v92 dst_sel:DWORD dst_unused:UNUSED_PAD src0_sel:DWORD src1_sel:WORD_1
    v_mul_u32_u24_sdwa v108, s5, v93 dst_sel:DWORD dst_unused:UNUSED_PAD src0_sel:DWORD src1_sel:WORD_1
    v_mul_u32_u24_sdwa v109, s5, v94 dst_sel:DWORD dst_unused:UNUSED_PAD src0_sel:DWORD src1_sel:WORD_1
    s_cbranch_vccnz K2_RETRY1
    v_cmp_lt_i32 s[46:47], 0, v188
    v_cmp_lt_i32 s[48:49], 1, v188
    v_cmp_lt_i32 s[50:51], 2, v188
    v_subrev_u32 v107, s6, v107
    v_subrev_u32 v108, s6, v108
    v_subrev_u32 v109, s6, v109
    v_alignbit_b32 v107, v92, v107, 28
    v_alignbit_b32 v108, v93, v108, 28
    v_alignbit_b32 v109, v94, v109, 28
    v_and_b32 v107, 0xffc, v107
    v_and_b32 v108, 0xffc, v108
    v_and_b32 v109, 0xffc, v109
    s_mov_b64 exec, s[46:47]
    ds_add_rtn_u32 v223, v107, v171 offset:2304
    s_mov_b64 exec, s[48:49]
    ds_add_rtn_u32 v224, v108, v171 offset:2304
    s_mov_b64 exec, s[50:51]
    ds_add_rtn_u32 v225, v109, v171 offset:2304
    s_mov_b64 exec, -1
    s_waitcnt lgkmcnt(0)
    v_min_u16 v116, 2176, v220
    v_add_u32_sdwa v116, v116, v220 dst_sel:DWORD dst_unused:UNUSED_PAD src0_sel:WORD_0 src1_sel:WORD_1
    v_min_u16 v117, 2176, v221
    v_add_u32_sdwa v117, v117, v221 dst_sel:DWORD dst_unused:UNUSED_PAD src0_sel:WORD_0 src1_sel:WORD_1
    v_min_u16 v118, 2176, v222
    v_add_u32_sdwa v118, v118, v222 dst_sel:DWORD dst_unused:UNUSED_PAD src0_sel:WORD_0 src1_sel:WORD_1
    s_mov_b64 exec, s[68:69]
    ds_write2st64_b32 v116, v88, v152 offset0:38 offset1:122
    s_mov_b64 exec, s[70:71]
    ds_write2st64_b32 v117, v89, v153 offset0:38 offset1:122
    s_mov_b64 exec, s[86:87]
    ds_write2st64_b32 v118, v90, v154 offset0:38 offset1:122
    s_mov_b64 exec, -1
K2_CHK2:
    s_waitcnt vmcnt(1)
    v_bitop3_b32 v188, v99, s36, v214 bitop3:0x28
    v_cmp_ne_u32 vcc, 0, v188
    v_sub_u32_sdwa v188, v99, v168 dst_sel:DWORD dst_unused:UNUSED_PAD src0_sel:BYTE_3 src1_sel:DWORD
    v_mul_u32_u24_sdwa v110, s5, v96 dst_sel:DWORD dst_unused:UNUSED_PAD src0_sel:DWORD src1_sel:WORD_1
    v_mul_u32_u24_sdwa v111, s5, v97 dst_sel:DWORD dst_unused:UNUSED_PAD src0_sel:DWORD src1_sel:WORD_1
    v_mul_u32_u24_sdwa v112, s5, v98 dst_sel:DWORD dst_unused:UNUSED_PAD src0_sel:DWORD src1_sel:WORD_1
    s_cbranch_vccnz K2_RETRY2
    v_cmp_lt_i32 s[52:53], 0, v188
    v_cmp_lt_i32 s[54:55], 1, v188
    v_cmp_lt_i32 s[56:57], 2, v188
    v_subrev_u32 v110, s6, v110
    v_subrev_u32 v111, s6, v111
    v_subrev_u32 v112, s6, v112
    v_alignbit_b32 v110, v96, v110, 28
    v_alignbit_b32 v111, v97, v111, 28
    v_alignbit_b32 v112, v98, v112, 28
    v_and_b32 v110, 0xffc, v110
    v_and_b32 v111, 0xffc, v111
    v_and_b32 v112, 0xffc, v112
    s_mov_b64 exec, s[52:53]
    ds_add_rtn_u32 v226, v110, v171 offset:2304
    s_mov_b64 exec, s[54:55]
    ds_add_rtn_u32 v227, v111, v171 offset:2304
    s_mov_b64 exec, s[56:57]
    ds_add_rtn_u32 v228, v112, v171 offset:2304
    s_mov_b64 exec, -1
K2_CHK3:
    s_waitcnt vmcnt(0)
    v_bitop3_b32 v188, v103, s36, v214 bitop3:0x28
    v_cmp_ne_u32 vcc, 0, v188
    v_sub_u32_sdwa v188, v103, v168 dst_sel:DWORD dst_unused:UNUSED_PAD src0_sel:BYTE_3 src1_sel:DWORD
    v_mul_u32_u24_sdwa v113, s5, v100 dst_sel:DWORD dst_unused:UNUSED_PAD src0_sel:DWORD src1_sel:WORD_1
    v_mul_u32_u24_sdwa v114, s5, v101 dst_sel:DWORD dst_unused:UNUSED_PAD src0_sel:DWORD src1_sel:WORD_1
    v_mul_u32_u24_sdwa v115, s5, v102 dst_sel:DWORD dst_unused:UNUSED_PAD src0_sel:DWORD src1_sel:WORD_1
    s_cbranch_vccnz K2_RETRY3
    v_cmp_lt_i32 s[58:59], 0, v188
    v_cmp_lt_i32 s[60:61], 1, v188
    v_cmp_lt_i32 s[62:63], 2, v188
    v_subrev_u32 v113, s6, v113
    v_subrev_u32 v114, s6, v114
    v_subrev_u32 v115, s6, v115
    v_alignbit_b32 v113, v100, v113, 28
    v_alignbit_b32 v114, v101, v114, 28
    v_alignbit_b32 v115, v102, v115, 28
    v_and_b32 v113, 0xffc, v113
    v_and_b32 v114, 0xffc, v114
    v_and_b32 v115, 0xffc, v115
    s_mov_b64 exec, s[58:59]
    ds_add_rtn_u32 v229, v113, v171 offset:2304
    s_mov_b64 exec, s[60:61]
    ds_add_rtn_u32 v230, v114, v171 offset:2304
    s_mov_b64 exec, s[62:63]
    ds_add_rtn_u32 v231, v115, v171 offset:2304
    s_mov_b64 exec, -1
    v_max3_u32 v188, v91, v95, v99
    v_max_u32 v188, v188, v103
    v_cmp_le_u32 vcc, 553648128, v188
    s_cbranch_vccnz K2_XT1
K2_XT1R:
    s_lshr_b32 s4, s3, 1
    s_add_u32 s4, s4, 60
    s_waitcnt lgkmcnt(0)
    s_barrier
    ds_read_b128 v[128:131], v172 offset:5376
    ds_read_b128 v[236:239], v247
    ds_read_b32 v240, v251
    ds_read_u8 v250, v249
    ds_read_b128 v[116:119], v172 offset:2304
    ds_read_b128 v[120:123], v172 offset:3328
    ds_read_b128 v[124:127], v172 offset:4352
    ds_read_b64 v[194:195], v200 offset:2304
    s_bitcmp1_b32 s3, 0
    s_cbranch_scc0 K2_NOX1
    s_mul_i32 s10, s12, 196
    s_add_u32 s10, s10, s96
    s_lshl_b32 s10, s10, 7
    s_mul_i32 s11, s7, 4160
    s_add_u32 m0, s11, 69120
    s_add_u32 s86, s10, 0
    buffer_load_dwordx4 v234, s[16:19], s86 offen lds
    s_add_u32 m0, s11, 70160
    s_add_u32 s86, s10, 1024
    buffer_load_dwordx4 v234, s[16:19], s86 offen lds
    s_add_u32 m0, s11, 71200
    s_add_u32 s86, s10, 2048
    buffer_load_dwordx4 v234, s[16:19], s86 offen lds
    s_add_u32 m0, s11, 72240
    s_add_u32 s86, s10, 3072
    buffer_load_dwordx4 v234, s[16:19], s86 offen lds
K2_NOX1:
    s_waitcnt lgkmcnt(5)
    v_readlane_b32 s68, v128, s4
    v_and_b32 v95, 0x0f0f0f, v95
    v_and_b32 v99, 0x0f0f0f, v99
    s_and_b32 s68, s68, 0xffff
    s_bitcmp1_b32 s3, 0
    s_cselect_b32 s68, s68, 0
    s_cmp_ge_u32 s68, 128
    s_cselect_b32 s69, 1, 0
    s_cbranch_scc0 K2_NOQ
    s_add_u32 m0, s74, 0
    v_mad_u32_u16 v236, v236, s75, v241 op_sel:[1,0,0,0]
    buffer_load_dwordx4 v236, s[16:19], 0 offen lds
    s_add_u32 m0, s74, 1040
    v_mad_u32_u16 v237, v237, s75, v241 op_sel:[1,0,0,0]
    buffer_load_dwordx4 v237, s[16:19], 0 offen lds
    s_add_u32 m0, s74, 2080
    v_mad_u32_u16 v238, v238, s75, v241 op_sel:[1,0,0,0]
    buffer_load_dwordx4 v238, s[16:19], 0 offen lds
    s_add_u32 m0, s74, 3120
    v_mad_u32_u16 v239, v239, s75, v241 op_sel:[1,0,0,0]
    buffer_load_dwordx4 v239, s[16:19], 0 offen lds
    s_add_u32 m0, s74, 4160
    v_add_u32 v240, v240, v242
    buffer_load_dwordx4 v240, s[20:23], 0 offen lds
K2_NOQ:
    v_add_u32_sdwa v191, v128, v129 dst_sel:DWORD dst_unused:UNUSED_PAD src0_sel:WORD_0 src1_sel:WORD_0
    v_add_u32_sdwa v128, v130, v131 dst_sel:DWORD dst_unused:UNUSED_PAD src0_sel:WORD_0 src1_sel:WORD_0
    v_add_u32 v191, v191, v128
    s_waitcnt lgkmcnt(3)
    v_add_u32_sdwa v188, v116, v117 dst_sel:DWORD dst_unused:UNUSED_PAD src0_sel:WORD_0 src1_sel:WORD_0
    v_add_u32_sdwa v116, v118, v119 dst_sel:DWORD dst_unused:UNUSED_PAD src0_sel:WORD_0 src1_sel:WORD_0
    v_add_u32 v188, v188, v116
    s_waitcnt lgkmcnt(2)
    v_add_u32_sdwa v189, v120, v121 dst_sel:DWORD dst_unused:UNUSED_PAD src0_sel:WORD_0 src1_sel:WORD_0
    v_add_u32_sdwa v120, v122, v123 dst_sel:DWORD dst_unused:UNUSED_PAD src0_sel:WORD_0 src1_sel:WORD_0
    v_add_u32 v189, v189, v120
    s_waitcnt lgkmcnt(1)
    v_add_u32_sdwa v190, v124, v125 dst_sel:DWORD dst_unused:UNUSED_PAD src0_sel:WORD_0 src1_sel:WORD_0
    v_add_u32_sdwa v124, v126, v127 dst_sel:DWORD dst_unused:UNUSED_PAD src0_sel:WORD_0 src1_sel:WORD_0
    v_add_u32 v190, v190, v124
    v_lshl_or_b32 v192, v189, 16, v188
    v_lshl_or_b32 v193, v191, 16, v190
    s_waitcnt lgkmcnt(0)
    v_perm_b32 v198, v195, v194, s67
    v_add_u32_dpp v192, v192, v192 row_shr:1 row_mask:0xf bank_mask:0xf bound_ctrl:0
    v_add_u32_dpp v193, v193, v193 row_shr:1 row_mask:0xf bank_mask:0xf bound_ctrl:0
    v_and_b32 v103, 0x0f0f0f, v103
    v_add_u32_dpp v192, v192, v192 row_shr:2 row_mask:0xf bank_mask:0xf bound_ctrl:0
    v_add_u32_dpp v193, v193, v193 row_shr:2 row_mask:0xf bank_mask:0xf bound_ctrl:0
    v_perm_b32 v155, v95, v92, s64
    v_add_u32_dpp v192, v192, v192 row_shr:4 row_mask:0xf bank_mask:0xf bound_ctrl:0
    v_add_u32_dpp v193, v193, v193 row_shr:4 row_mask:0xf bank_mask:0xf bound_ctrl:0
    v_perm_b32 v156, v95, v93, s65
    v_add_u32_dpp v192, v192, v192 row_shr:8 row_mask:0xf bank_mask:0xf bound_ctrl:0
    v_add_u32_dpp v193, v193, v193 row_shr:8 row_mask:0xf bank_mask:0xf bound_ctrl:0
    v_perm_b32 v157, v95, v94, s66
    v_add_u32_dpp v192, v192, v192 row_bcast:15 row_mask:0xa bank_mask:0xf
    v_add_u32_dpp v193, v193, v193 row_bcast:15 row_mask:0xa bank_mask:0xf
    v_perm_b32 v158, v99, v96, s64
    v_add_u32_dpp v192, v192, v192 row_bcast:31 row_mask:0xc bank_mask:0xf
    v_add_u32_dpp v193, v193, v193 row_bcast:31 row_mask:0xc bank_mask:0xf
    v_perm_b32 v159, v99, v97, s65
    s_sub_u32 s4, s4, 1
    v_readlane_b32 s10, v192, 63
    v_readlane_b32 s11, v193, 63
    v_readlane_b32 s14, v193, 59
    v_readlane_b32 s86, v193, s4
    v_lshlrev_b32_sdwa v116, v169, v192 dst_sel:DWORD dst_unused:UNUSED_PAD src0_sel:DWORD src1_sel:WORD_0
    v_sub_u32 v188, v116, v188
    v_lshlrev_b32_sdwa v117, v169, v192 dst_sel:DWORD dst_unused:UNUSED_PAD src0_sel:DWORD src1_sel:WORD_1
    v_sub_u32 v189, v117, v189
    v_lshlrev_b32_sdwa v118, v169, v193 dst_sel:DWORD dst_unused:UNUSED_PAD src0_sel:DWORD src1_sel:WORD_0
    v_sub_u32 v190, v118, v190
    s_and_b32 s4, s10, 0xffff
    s_lshr_b32 s10, s10, 16
    s_add_u32 s5, s4, s10
    s_and_b32 s10, s11, 0xffff
    s_add_u32 s10, s5, s10
    s_lshr_b32 s11, s11, 16
    s_add_u32 s10, s10, s11
    s_lshr_b32 s14, s14, 16
    s_lshr_b32 s86, s86, 16
    s_sub_u32 s6, s86, s14
    s_lshl_b32 s6, s6, 1
    v_lshl_add_u32 v189, s4, 1, v189
    v_lshl_add_u32 v190, s5, 1, v190
    s_sub_i32 s37, 12864, s10
    s_ashr_i32 s37, s37, 7
    s_max_i32 s37, s37, 1
    s_min_i32 s37, s37, 4
    s_lshr_b32 s11, s10, 5
    s_add_u32 s11, s11, 16
    s_and_b32 s11, s11, -32
    s_cmp_ge_i32 s37, 1
    s_cselect_b32 s13, 42, 10
    s_sub_i32 s11, s11, s13
    s_lshl_b32 s11, s11, 3
    s_lshr_b32 s10, s10, 1
    s_lshr_b32 s13, s3, 1
    s_mul_i32 s13, s13, s10
    s_sub_i32 s13, s13, s6
    s_sub_i32 s10, s10, s68
    s_sub_i32 s10, s10, s68
    s_add_i32 s11, s11, s13
    s_add_i32 s10, s10, s13
    s_bitcmp1_b32 s3, 0
    s_cselect_b32 s15, s11, s13
    s_cselect_b32 s10, s10, s11
    s_mov_b32 s13, 0
    s_mov_b32 s14, 0
    v_cmp_gt_i32 vcc, s15, v188
    v_cmp_gt_i32 s[86:87], s10, v188
    s_bcnt1_i32_b64 s11, vcc
    s_add_u32 s13, s13, s11
    s_bcnt1_i32_b64 s11, s[86:87]
    s_add_u32 s14, s14, s11
    v_cmp_gt_i32 vcc, s15, v189
    v_cmp_gt_i32 s[86:87], s10, v189
    s_bcnt1_i32_b64 s11, vcc
    s_add_u32 s13, s13, s11
    s_bcnt1_i32_b64 s11, s[86:87]
    s_add_u32 s14, s14, s11
    v_cmp_gt_i32 vcc, s15, v190
    v_cmp_gt_i32 s[86:87], s10, v190
    s_bcnt1_i32_b64 s11, vcc
    s_add_u32 s13, s13, s11
    s_bcnt1_i32_b64 s11, s[86:87]
    s_add_u32 s14, s14, s11
    s_max_i32 s13, s13, s72
    s_min_i32 s13, s13, s73
    s_max_i32 s14, s14, s84
    s_min_i32 s14, s14, s85
    v_cmp_le_u32 vcc, s13, v199
    v_cmp_gt_u32 s[10:11], s14, v199
    s_nop 0
    s_and_b64 vcc, vcc, s[10:11]
    v_cndmask_b32 v198, 0, v198, vcc
    v_mov_b32 v196, v198
    v_perm_b32 v160, v99, v98, s66
    v_perm_b32 v161, v103, v100, s64
    v_add_u32_dpp v196, v196, v196 row_shr:1 row_mask:0xf bank_mask:0xf bound_ctrl:0
    v_perm_b32 v162, v103, v101, s65
    v_perm_b32 v163, v103, v102, s66
    v_add_u32_dpp v196, v196, v196 row_shr:2 row_mask:0xf bank_mask:0xf bound_ctrl:0
    v_lshl_add_u32 v155, v155, 5, v209
    v_lshl_add_u32 v156, v156, 5, v209
    v_add_u32_dpp v196, v196, v196 row_shr:4 row_mask:0xf bank_mask:0xf bound_ctrl:0
    v_lshl_add_u32 v157, v157, 5, v209
    v_lshl_add_u32 v158, v158, 5, v210
    v_add_u32_dpp v196, v196, v196 row_shr:8 row_mask:0xf bank_mask:0xf bound_ctrl:0
    v_lshl_add_u32 v159, v159, 5, v210
    v_lshl_add_u32 v160, v160, 5, v210
    v_add_u32_dpp v196, v196, v196 row_bcast:15 row_mask:0xa bank_mask:0xf
    v_lshl_add_u32 v161, v161, 5, v211
    v_lshl_add_u32 v162, v162, 5, v211
    v_lshl_add_u32 v163, v163, 5, v211
    s_sub_u32 s86, s76, 9728
    s_add_u32 s86, s86, s68
    v_readlane_b32 s10, v196, 31
    v_readlane_b32 s11, v196, 63
    v_sub_u32 v196, v196, v198
    v_mov_b32 v253, v202
    s_and_b32 s4, s10, 0xffff
    s_lshr_b32 s10, s10, 16
    s_add_u32 s5, s4, s10
    s_and_b32 s10, s11, 0xffff
    s_add_u32 s6, s5, s10
    s_lshr_b32 s11, s11, 16
    s_add_u32 s15, s6, s11
    s_lshl_b32 s10, s4, 16
    s_pack_ll_b32_b16 s11, s5, s6
    s_pack_ll_b32_b16 s86, s86, s86
    s_add_u32 s10, s10, s86
    s_add_u32 s11, s11, s86
    s_mov_b32 exec_lo, vcc_lo
    s_mov_b32 exec_hi, 0
    v_add_u32 v196, s10, v196
    s_mov_b32 exec_lo, 0
    s_mov_b32 exec_hi, vcc_hi
    v_add_u32 v196, s11, v196
    s_mov_b64 exec, vcc
    ds_write_b16 v200, v196 offset:2306
    ds_write_b16_d16_hi v200, v196 offset:2310
    ds_write_b32 v213, v212 offset:6400
    s_mov_b64 exec, -1
    v_mov_b32 v197, 2176
    s_add_u32 s15, s15, s68
    s_add_u32 s68, s68, 64
    s_cmp_le_u32 s15, 2176
    s_cbranch_scc1 K2_LFIT
    ds_write_b32 v197, v197
    s_mov_b32 s15, 0
K2_LFIT:
    s_add_u32 s15, s15, s76
    s_add_i32 s4, s4, s68
    s_lshr_b32 s4, s4, 7
    s_add_i32 s5, s5, s68
    s_lshr_b32 s5, s5, 7
    s_add_i32 s6, s6, s68
    s_lshr_b32 s6, s6, 7
    v_mov_b32 v190, 0xffff0000
    v_or_b32 v189, s39, v190
    v_mov_b32 v190, 0x7fffff00
    v_lshl_add_u32 v188, v254, 2, s15
    s_sub_u32 s73, s15, s76
    ds_write2st64_b32 v188, v189, v190 offset0:0 offset1:84
    ds_write2st64_b32 v188, v189, v190 offset0:1 offset1:85
    s_add_u32 s73, s73, 127
    s_lshr_b32 s73, s73, 7
    s_sub_i32 s38, s73, 1
    v_mov_b32 v188, s15
    ds_write_b32 v212, v188 offset:2112
    s_waitcnt lgkmcnt(0)
    s_barrier
    ds_read_b64 v[194:195], v197
    s_mov_b64 exec, s[40:41]
    ds_read_u16 v104, v104 offset:2306
    s_mov_b64 exec, s[42:43]
    ds_read_u16 v105, v105 offset:2306
    s_mov_b64 exec, s[44:45]
    ds_read_u16 v106, v106 offset:2306
    s_mov_b64 exec, s[46:47]
    ds_read_u16 v107, v107 offset:2306
    s_mov_b64 exec, s[48:49]
    ds_read_u16 v108, v108 offset:2306
    s_mov_b64 exec, s[50:51]
    ds_read_u16 v109, v109 offset:2306
    s_mov_b64 exec, s[52:53]
    ds_read_u16 v110, v110 offset:2306
    s_mov_b64 exec, s[54:55]
    ds_read_u16 v111, v111 offset:2306
    s_mov_b64 exec, s[56:57]
    ds_read_u16 v112, v112 offset:2306
    s_mov_b64 exec, s[58:59]
    ds_read_u16 v113, v113 offset:2306
    s_mov_b64 exec, s[60:61]
    ds_read_u16 v114, v114 offset:2306
    s_mov_b64 exec, s[62:63]
    ds_read_u16 v115, v115 offset:2306
    s_mov_b64 exec, -1
    s_waitcnt lgkmcnt(0)
    v_readfirstlane_b32 s83, v194
    v_readfirstlane_b32 s80, v195
    v_add_u32 v104, v104, v220
    v_add_u32 v105, v105, v221
    v_add_u32 v106, v106, v222
    v_add_u32 v107, v107, v223
    v_add_u32 v108, v108, v224
    v_add_u32 v109, v109, v225
    v_add_u32 v110, v110, v226
    v_add_u32 v111, v111, v227
    v_add_u32 v112, v112, v228
    v_add_u32 v113, v113, v229
    v_add_u32 v114, v114, v230
    v_add_u32 v115, v115, v231
    s_cmp_gt_u32 s83, 64
    s_cbranch_scc1 K2_OVF
    s_mov_b64 exec, s[40:41]
    ds_write2st64_b32 v104, v88, v152 offset0:38 offset1:122
    s_mov_b64 exec, s[42:43]
    ds_write2st64_b32 v105, v89, v153 offset0:38 offset1:122
    s_mov_b64 exec, s[44:45]
    ds_write2st64_b32 v106, v90, v154 offset0:38 offset1:122
    s_mov_b64 exec, s[46:47]
    ds_write2st64_b32 v107, v92, v155 offset0:38 offset1:122
    s_mov_b64 exec, s[48:49]
    ds_write2st64_b32 v108, v93, v156 offset0:38 offset1:122
    s_mov_b64 exec, s[50:51]
    ds_write2st64_b32 v109, v94, v157 offset0:38 offset1:122
    s_mov_b64 exec, s[52:53]
    ds_write2st64_b32 v110, v96, v158 offset0:38 offset1:122
    s_mov_b64 exec, s[54:55]
    ds_write2st64_b32 v111, v97, v159 offset0:38 offset1:122
    s_mov_b64 exec, s[56:57]
    ds_write2st64_b32 v112, v98, v160 offset0:38 offset1:122
    s_mov_b64 exec, s[58:59]
    ds_write2st64_b32 v113, v100, v161 offset0:38 offset1:122
    s_mov_b64 exec, s[60:61]
    ds_write2st64_b32 v114, v101, v162 offset0:38 offset1:122
    s_mov_b64 exec, s[62:63]
    ds_write2st64_b32 v115, v102, v163 offset0:38 offset1:122
    s_mov_b64 exec, -1
K2_PADS0:
    s_add_u32 s10, s37, 2
    s_cmp_gt_u32 s73, s10
    s_cselect_b32 s1, s3, 0
    s_sub_u32 s10, s13, s96
    s_mul_i32 s10, s10, 144
    s_add_u32 s70, s10, s74
    s_mul_i32 s10, s12, 196
    s_add_u32 s11, s10, s14
    s_add_u32 s10, s10, s13
    s_min_u32 s11, s11, 50000
    s_min_u32 s10, s10, 50000
    s_sub_u32 s11, s11, s10
    s_lshl_b32 s10, s10, 7
    s_add_u32 s28, s28, s10
    s_addc_u32 s29, s29, 0
    s_lshl_b32 s30, s11, 7
    s_mov_b32 s79, -1
    s_mov_b64 s[84:85], 0
    s_mov_b32 s81, 0
    s_mov_b32 s82, 0
    s_cmp_lg_u32 s80, 0
    s_cselect_b32 s78, 1, 0
    s_and_b32 s69, s69, s1
    s_cmp_gt_u32 s69, s97
    s_cbranch_scc0 K2_SIDE
    s_waitcnt vmcnt(5) lgkmcnt(0)
    ds_read_b128 v[152:155], v235 offset:0
    ds_read_b128 v[156:159], v235 offset:16
    ds_read_b128 v[160:163], v235 offset:32
    ds_read_b128 v[164:167], v235 offset:48
    v_add_u32 v172, 8192, v172
    ds_read_b128 v[88:91], v172 offset:52736
    ds_read_b128 v[92:95], v172 offset:53760
    ds_read_b128 v[96:99], v172 offset:54784
    ds_read_b128 v[100:103], v172 offset:55808
    ds_read_b128 v[104:107], v172 offset:56832
    ds_read_b128 v[108:111], v172 offset:57856
    ds_read_b128 v[112:115], v172 offset:58880
    ds_read_b128 v[116:119], v172 offset:59904
    s_mov_b32 s10, 0x358637bd
    s_mov_b32 s11, s10
    v_mfma_f32_32x32x16_bf16 v[136:151], v[180:183], v[180:183], 0
    v_mov_b64 v[120:121], s[10:11]
    v_mov_b64 v[122:123], s[10:11]
    v_mov_b64 v[124:125], s[10:11]
    v_mov_b64 v[126:127], s[10:11]
    v_mov_b64 v[128:129], s[10:11]
    v_mov_b64 v[130:131], s[10:11]
    v_mov_b64 v[132:133], s[10:11]
    v_mov_b64 v[134:135], s[10:11]
    s_waitcnt lgkmcnt(7)
    v_mfma_f32_32x32x16_bf16 v[188:203], v[152:155], v[88:91], 0
    s_waitcnt lgkmcnt(6)
    v_mfma_f32_32x32x16_bf16 v[188:203], v[156:159], v[92:95], v[188:203]
    s_waitcnt lgkmcnt(5)
    v_mfma_f32_32x32x16_bf16 v[188:203], v[160:163], v[96:99], v[188:203]
    s_waitcnt lgkmcnt(4)
    v_mfma_f32_32x32x16_bf16 v[188:203], v[164:167], v[100:103], v[188:203]
    s_waitcnt lgkmcnt(3)
    v_mfma_f32_32x32x16_bf16 v[204:219], v[152:155], v[104:107], 0
    s_waitcnt lgkmcnt(2)
    v_mfma_f32_32x32x16_bf16 v[204:219], v[156:159], v[108:111], v[204:219]
    s_waitcnt lgkmcnt(1)
    v_mfma_f32_32x32x16_bf16 v[204:219], v[160:163], v[112:115], v[204:219]
    s_waitcnt lgkmcnt(0)
    v_mfma_f32_32x32x16_bf16 v[204:219], v[164:167], v[116:119], v[204:219]
    s_barrier
    v_mfma_f32_32x32x16_bf16 v[104:119], v[180:183], v[180:183], 0
    s_mov_b32 s10, 0x358637bd
    s_mov_b32 s11, s10
    v_mov_b64 v[88:89], s[10:11]
    v_mov_b64 v[90:91], s[10:11]
    v_mov_b64 v[92:93], s[10:11]
    v_mov_b64 v[94:95], s[10:11]
    v_mov_b64 v[96:97], s[10:11]
    v_mov_b64 v[98:99], s[10:11]
    v_mov_b64 v[100:101], s[10:11]
    v_mov_b64 v[102:103], s[10:11]
    v_cvt_pk_bf16_f32 v72, v188, v189
    v_cvt_pk_bf16_f32 v73, v190, v191
    v_cvt_pk_bf16_f32 v74, v192, v193
    v_cvt_pk_bf16_f32 v75, v194, v195
    v_cvt_pk_bf16_f32 v76, v196, v197
    v_cvt_pk_bf16_f32 v77, v198, v199
    v_cvt_pk_bf16_f32 v78, v200, v201
    v_cvt_pk_bf16_f32 v79, v202, v203
    v_cvt_pk_bf16_f32 v80, v204, v205
    v_cvt_pk_bf16_f32 v81, v206, v207
    v_cvt_pk_bf16_f32 v82, v208, v209
    v_cvt_pk_bf16_f32 v83, v210, v211
    v_cvt_pk_bf16_f32 v84, v212, v213
    v_cvt_pk_bf16_f32 v85, v214, v215
    v_cvt_pk_bf16_f32 v86, v216, v217
    v_cvt_pk_bf16_f32 v87, v218, v219
    s_branch K2_HAD0
K2_SIDE:
    s_bitcmp1_b32 s3, 0
    s_cbranch_scc1 K2_NOX2
    s_mul_i32 s10, s12, 196
    s_add_u32 s10, s10, s96
    s_lshl_b32 s10, s10, 7
    s_mul_i32 s11, s7, 4160
    s_add_u32 m0, s11, 69120
    s_add_u32 s86, s10, 0
    buffer_load_dwordx4 v234, s[16:19], s86 offen lds
    s_add_u32 m0, s11, 70160
    s_add_u32 s86, s10, 1024
    buffer_load_dwordx4 v234, s[16:19], s86 offen lds
    s_add_u32 m0, s11, 71200
    s_add_u32 s86, s10, 2048
    buffer_load_dwordx4 v234, s[16:19], s86 offen lds
    s_add_u32 m0, s11, 72240
    s_add_u32 s86, s10, 3072
    buffer_load_dwordx4 v234, s[16:19], s86 offen lds
K2_NOX2:
    s_waitcnt vmcnt(5) lgkmcnt(0)
    s_barrier
    s_cmp_lg_u32 s69, 0
    s_cbranch_scc1 K2_SIDE1
    s_waitcnt vmcnt(4)
    s_bitcmp1_b32 s3, 0
    s_cbranch_scc0 K2_SIDE1
    s_waitcnt vmcnt(0)
    s_bitcmp1_b32 s1, 0
    s_cbranch_scc0 K2_SIDE1
    ds_read_b128 v[236:239], v247
    ds_read_b32 v240, v251
    ds_read_u8 v250, v249
    s_waitcnt lgkmcnt(1)
    s_add_u32 m0, s74, 0
    v_mad_u32_u16 v236, v236, s75, v241 op_sel:[1,0,0,0]
    buffer_load_dwordx4 v236, s[16:19], 0 offen lds
    s_add_u32 m0, s74, 1040
    v_mad_u32_u16 v237, v237, s75, v241 op_sel:[1,0,0,0]
    buffer_load_dwordx4 v237, s[16:19], 0 offen lds
    s_add_u32 m0, s74, 2080
    v_mad_u32_u16 v238, v238, s75, v241 op_sel:[1,0,0,0]
    buffer_load_dwordx4 v238, s[16:19], 0 offen lds
    s_add_u32 m0, s74, 3120
    v_mad_u32_u16 v239, v239, s75, v241 op_sel:[1,0,0,0]
    buffer_load_dwordx4 v239, s[16:19], 0 offen lds
    s_add_u32 m0, s74, 4160
    v_add_u32 v240, v240, v242
    buffer_load_dwordx4 v240, s[20:23], 0 offen lds
K2_SIDE1:
    s_cmp_lg_u32 s97, 0
    s_cbranch_scc1 K2_XT2
K2_XT2R:
    s_bitcmp1_b32 s1, 0
    s_cbranch_scc1 K2_SIDE2
    s_barrier
    s_cmp_eq_u32 s83, 0
    s_cbranch_scc1 K2_NEy
    s_lshl_b32 s10, s3, 2
    v_mov_b32 v178, s10
    ds_read_b32 v178, v178 offset:2112
    s_waitcnt lgkmcnt(0)
    v_readfirstlane_b32 s15, v178
    s_nop 3
    s_sub_u32 s73, s15, s76
    s_add_u32 s73, s73, 127
    s_lshr_b32 s73, s73, 7
    s_sub_i32 s38, s73, 1
K2_NEy:
    ds_read_b128 v[236:239], v247
    ds_read_b32 v240, v251
    ds_read_u8 v250, v249
    s_waitcnt lgkmcnt(1)
    s_add_u32 m0, s74, 0
    v_mad_u32_u16 v236, v236, s75, v241 op_sel:[1,0,0,0]
    buffer_load_dwordx4 v236, s[16:19], 0 offen lds
    s_add_u32 m0, s74, 1040
    v_mad_u32_u16 v237, v237, s75, v241 op_sel:[1,0,0,0]
    buffer_load_dwordx4 v237, s[16:19], 0 offen lds
    s_add_u32 m0, s74, 2080
    v_mad_u32_u16 v238, v238, s75, v241 op_sel:[1,0,0,0]
    buffer_load_dwordx4 v238, s[16:19], 0 offen lds
    s_add_u32 m0, s74, 3120
    v_mad_u32_u16 v239, v239, s75, v241 op_sel:[1,0,0,0]
    buffer_load_dwordx4 v239, s[16:19], 0 offen lds
    s_add_u32 m0, s74, 4160
    v_add_u32 v240, v240, v242
    buffer_load_dwordx4 v240, s[20:23], 0 offen lds
K2_SIDE2:
    s_waitcnt vmcnt(5) lgkmcnt(0)
    ds_read_b128 v[152:155], v235 offset:0
    ds_read_b128 v[156:159], v235 offset:16
    ds_read_b128 v[160:163], v235 offset:32
    ds_read_b128 v[164:167], v235 offset:48
    v_add_u32 v172, 8192, v172
    ds_read_b128 v[88:91], v172 offset:52736
    ds_read_b128 v[92:95], v172 offset:53760
    ds_read_b128 v[96:99], v172 offset:54784
    ds_read_b128 v[100:103], v172 offset:55808
    ds_read_b128 v[104:107], v172 offset:56832
    ds_read_b128 v[108:111], v172 offset:57856
    ds_read_b128 v[112:115], v172 offset:58880
    ds_read_b128 v[116:119], v172 offset:59904
    s_mov_b32 s10, 0x358637bd
    s_mov_b32 s11, s10
    v_mfma_f32_32x32x16_bf16 v[136:151], v[180:183], v[180:183], 0
    v_mov_b64 v[120:121], s[10:11]
    v_mov_b64 v[122:123], s[10:11]
    v_mov_b64 v[124:125], s[10:11]
    v_mov_b64 v[126:127], s[10:11]
    v_mov_b64 v[128:129], s[10:11]
    v_mov_b64 v[130:131], s[10:11]
    v_mov_b64 v[132:133], s[10:11]
    v_mov_b64 v[134:135], s[10:11]
    s_waitcnt lgkmcnt(7)
    v_mfma_f32_32x32x16_bf16 v[188:203], v[152:155], v[88:91], 0
    s_waitcnt lgkmcnt(6)
    v_mfma_f32_32x32x16_bf16 v[188:203], v[156:159], v[92:95], v[188:203]
    s_waitcnt lgkmcnt(5)
    v_mfma_f32_32x32x16_bf16 v[188:203], v[160:163], v[96:99], v[188:203]
    s_waitcnt lgkmcnt(4)
    v_mfma_f32_32x32x16_bf16 v[188:203], v[164:167], v[100:103], v[188:203]
    s_waitcnt lgkmcnt(3)
    v_mfma_f32_32x32x16_bf16 v[204:219], v[152:155], v[104:107], 0
    s_waitcnt lgkmcnt(2)
    v_mfma_f32_32x32x16_bf16 v[204:219], v[156:159], v[108:111], v[204:219]
    s_waitcnt lgkmcnt(1)
    v_mfma_f32_32x32x16_bf16 v[204:219], v[160:163], v[112:115], v[204:219]
    s_waitcnt lgkmcnt(0)
    v_mfma_f32_32x32x16_bf16 v[204:219], v[164:167], v[116:119], v[204:219]
    v_mfma_f32_32x32x16_bf16 v[104:119], v[180:183], v[180:183], 0
    s_mov_b32 s10, 0x358637bd
    s_mov_b32 s11, s10
    v_mov_b64 v[88:89], s[10:11]
    v_mov_b64 v[90:91], s[10:11]
    v_mov_b64 v[92:93], s[10:11]
    v_mov_b64 v[94:95], s[10:11]
    v_mov_b64 v[96:97], s[10:11]
    v_mov_b64 v[98:99], s[10:11]
    v_mov_b64 v[100:101], s[10:11]
    v_mov_b64 v[102:103], s[10:11]
    v_cvt_pk_bf16_f32 v72, v188, v189
    v_cvt_pk_bf16_f32 v73, v190, v191
    v_cvt_pk_bf16_f32 v74, v192, v193
    v_cvt_pk_bf16_f32 v75, v194, v195
    v_cvt_pk_bf16_f32 v76, v196, v197
    v_cvt_pk_bf16_f32 v77, v198, v199
    v_cvt_pk_bf16_f32 v78, v200, v201
    v_cvt_pk_bf16_f32 v79, v202, v203
    v_cvt_pk_bf16_f32 v80, v204, v205
    v_cvt_pk_bf16_f32 v81, v206, v207
    v_cvt_pk_bf16_f32 v82, v208, v209
    v_cvt_pk_bf16_f32 v83, v210, v211
    v_cvt_pk_bf16_f32 v84, v212, v213
    v_cvt_pk_bf16_f32 v85, v214, v215
    v_cvt_pk_bf16_f32 v86, v216, v217
    v_cvt_pk_bf16_f32 v87, v218, v219
    s_branch K2_HAD0
K2_GO:
    ds_read_b128 v[236:239], v247
    ds_read_b32 v240, v251
    ds_read_u8 v250, v249
    s_waitcnt lgkmcnt(1)
    s_add_u32 m0, s74, 0
    v_mad_u32_u16 v236, v236, s75, v241 op_sel:[1,0,0,0]
    buffer_load_dwordx4 v236, s[16:19], 0 offen lds
    s_add_u32 m0, s74, 1040
    v_mad_u32_u16 v237, v237, s75, v241 op_sel:[1,0,0,0]
    buffer_load_dwordx4 v237, s[16:19], 0 offen lds
    s_add_u32 m0, s74, 2080
    v_mad_u32_u16 v238, v238, s75, v241 op_sel:[1,0,0,0]
    buffer_load_dwordx4 v238, s[16:19], 0 offen lds
    s_add_u32 m0, s74, 3120
    v_mad_u32_u16 v239, v239, s75, v241 op_sel:[1,0,0,0]
    buffer_load_dwordx4 v239, s[16:19], 0 offen lds
    s_add_u32 m0, s74, 4160
    v_add_u32 v240, v240, v242
    buffer_load_dwordx4 v240, s[20:23], 0 offen lds
K2_HAD0:
    s_waitcnt lgkmcnt(0)
    v_lshl_add_u32 v250, v250, 6, v245
    ds_read_b128 v[236:239], v247 offset:128
    ds_read_b32 v240, v251 offset:128
    ds_read_b128 v[172:175], v250 offset:7424
    ds_read_b32 v176, v250 offset:7440
    v_mfma_f32_32x32x16_bf16 v[204:219], v[180:183], v[180:183], 0
    s_waitcnt vmcnt(0)
    ds_read_b128 v[168:171], v244
    ds_read_b128 v[152:155], v243 offset:0
    ds_read_b128 v[156:159], v243 offset:16
    ds_read_b128 v[160:163], v243 offset:32
    ds_read_b128 v[164:167], v243 offset:48
    s_waitcnt lgkmcnt(0)
    s_add_u32 m0, s74, 0
    v_mad_u32_u16 v236, v236, s75, v241 op_sel:[1,0,0,0]
    buffer_load_dwordx4 v236, s[16:19], 0 offen lds
    s_add_u32 m0, s74, 1040
    v_mad_u32_u16 v237, v237, s75, v241 op_sel:[1,0,0,0]
    buffer_load_dwordx4 v237, s[16:19], 0 offen lds
    s_add_u32 m0, s74, 2080
    v_mad_u32_u16 v238, v238, s75, v241 op_sel:[1,0,0,0]
    buffer_load_dwordx4 v238, s[16:19], 0 offen lds
    s_add_u32 m0, s74, 3120
    v_mad_u32_u16 v239, v239, s75, v241 op_sel:[1,0,0,0]
    buffer_load_dwordx4 v239, s[16:19], 0 offen lds
    s_add_u32 m0, s74, 4160
    v_add_u32 v240, v240, v242
    buffer_load_dwordx4 v240, s[20:23], 0 offen lds
    s_cmp_lt_i32 s37, 0
    s_cbranch_scc1 K2_B1
    s_barrier
    s_bitcmp1_b32 s1, 0
    s_cselect_b32 s37, s37, -1
    s_cbranch_scc0 K2_B1
    s_cmp_eq_u32 s83, 0
    s_cbranch_scc1 K2_NEo
    s_lshl_b32 s10, s3, 2
    v_mov_b32 v178, s10
    ds_read_b32 v178, v178 offset:2112
    s_waitcnt lgkmcnt(0)
    v_readfirstlane_b32 s15, v178
    s_nop 3
    s_sub_u32 s73, s15, s76
    s_add_u32 s73, s73, 127
    s_lshr_b32 s73, s73, 7
    s_sub_i32 s38, s73, 1
K2_NEo:
K2_B1:
    s_cmp_lg_u32 s73, 0
    s_cbranch_scc1 K2_NZ
    s_waitcnt vmcnt(0)
    s_branch K2_DONE
K2_NZ:
    v_mfma_f32_32x32x16_bf16 v[188:203], v[168:171], v[64:67], 0
    v_mfma_f32_32x32x16_bf16 v[188:203], v[152:155], v[0:3], v[188:203]
    v_mfma_f32_32x32x16_bf16 v[188:203], v[156:159], v[4:7], v[188:203]
    v_mfma_f32_32x32x16_bf16 v[188:203], v[160:163], v[8:11], v[188:203]
    v_mfma_f32_32x32x16_bf16 v[188:203], v[164:167], v[12:15], v[188:203]
    s_nop 9
    v_smfmac_f32_32x32x32_bf16 v[188:203], v[172:175], v[72:79], v176
    s_mov_b32 s72, 0
    s_sub_u32 s10, s73, 1
    s_bitcmp1_b32 s3, 0
    s_cselect_b32 s6, s6, s10
    s_setprio 3
    s_mov_b32 s87, s73
    s_cmp_gt_i32 s4, s72
    s_cselect_b32 s10, s4, s87
    s_min_u32 s87, s87, s10
    s_cmp_gt_i32 s5, s72
    s_cselect_b32 s10, s5, s87
    s_min_u32 s87, s87, s10
    s_cmp_gt_i32 s6, s72
    s_cselect_b32 s10, s6, s87
    s_min_u32 s87, s87, s10
    s_cmp_gt_i32 s37, s72
    s_cselect_b32 s10, s37, s87
    s_min_u32 s87, s87, s10
    s_cmp_gt_i32 s38, s72
    s_cselect_b32 s10, s38, s87
    s_min_u32 s87, s87, s10
.p2align 6
K2_LOOP:
    v_smfmac_f32_32x32x32_bf16 v[136:151], v[180:183], v[204:211], v177
    ds_read_u8 v236, v248 offset:0
    ds_read_u8 v237, v248 offset:16
    ds_read_u8 v238, v248 offset:64
    ds_read_u8 v239, v248 offset:80
    ds_read_u8 v250, v249 offset:128
    v_exp_f32 v188, v188
    v_exp_f32 v189, v189
    v_exp_f32 v190, v190
    v_add_f32 v188, 1.0, v188
    v_smfmac_f32_32x32x32_bf16 v[136:151], v[184:187], v[212:219], v177
    v_exp_f32 v191, v191
    v_add_f32 v189, 1.0, v189
    v_exp_f32 v192, v192
    v_add_f32 v190, 1.0, v190
    v_rcp_f32 v188, v188
    v_mfma_f32_32x32x16_bf16 v[220:235], v[168:171], v[68:71], 0
    v_exp_f32 v193, v193
    v_add_f32 v191, 1.0, v191
    v_rcp_f32 v189, v189
    v_exp_f32 v194, v194
    v_mfma_f32_32x32x16_bf16 v[204:219], v[152:155], v[32:35], 0
    v_add_f32 v192, 1.0, v192
    v_rcp_f32 v190, v190
    v_exp_f32 v195, v195
    v_mfma_f32_32x32x16_bf16 v[204:219], v[156:159], v[36:39], v[204:219]
    s_waitcnt lgkmcnt(0)
    v_lshl_add_u32 v236, v236, 6, v246
    v_lshl_add_u32 v237, v237, 6, v246
    v_lshl_add_u32 v238, v238, 6, v246
    v_lshl_add_u32 v239, v239, 6, v246
    v_lshl_add_u32 v250, v250, 6, v245
    v_add_f32 v193, 1.0, v193
    v_rcp_f32 v191, v191
    v_exp_f32 v196, v196
    v_add_f32 v194, 1.0, v194
    v_rcp_f32 v192, v192
    v_smfmac_f32_32x32x32_bf16 v[220:235], v[172:175], v[80:87], v176
    ds_read_b64_tr_b16 v[180:181], v236
    ds_read_b64_tr_b16 v[182:183], v237
    ds_read_b64_tr_b16 v[184:185], v238
    ds_read_b64_tr_b16 v[186:187], v239
    ds_read_b128 v[172:175], v250 offset:7424
    ds_read_b32 v176, v250 offset:7440
    v_exp_f32 v197, v197
    v_add_f32 v195, 1.0, v195
    v_rcp_f32 v193, v193
    v_exp_f32 v198, v198
    v_mfma_f32_32x32x16_bf16 v[204:219], v[160:163], v[40:43], v[204:219]
    v_add_f32 v196, 1.0, v196
    v_rcp_f32 v194, v194
    v_exp_f32 v199, v199
    v_add_f32 v197, 1.0, v197
    v_mfma_f32_32x32x16_bf16 v[204:219], v[164:167], v[44:47], v[204:219]
    v_rcp_f32 v195, v195
    v_exp_f32 v200, v200
    v_add_f32 v198, 1.0, v198
    v_rcp_f32 v196, v196
    v_mfma_f32_32x32x16_bf16 v[220:235], v[152:155], v[16:19], v[220:235]
    ds_read_b128 v[236:239], v247 offset:256
    ds_read_b32 v240, v251 offset:256
    s_add_u32 s72, s72, 1
    v_exp_f32 v201, v201
    v_add_f32 v199, 1.0, v199
    v_rcp_f32 v197, v197
    v_exp_f32 v202, v202
    v_mfma_f32_32x32x16_bf16 v[220:235], v[156:159], v[20:23], v[220:235]
    v_add_f32 v200, 1.0, v200
    v_rcp_f32 v198, v198
    v_exp_f32 v203, v203
    v_add_f32 v201, 1.0, v201
    v_mfma_f32_32x32x16_bf16 v[220:235], v[160:163], v[24:27], v[220:235]
    v_rcp_f32 v199, v199
    v_add_f32 v202, 1.0, v202
    v_rcp_f32 v200, v200
    v_add_f32 v203, 1.0, v203
    v_rcp_f32 v201, v201
    v_mfma_f32_32x32x16_bf16 v[220:235], v[164:167], v[28:31], v[220:235]
    v_rcp_f32 v202, v202
    v_rcp_f32 v203, v203
    v_mul_f32 v204, v188, v204
    v_mul_f32 v205, v189, v205
    s_waitcnt lgkmcnt(0)
    v_smfmac_f32_32x32x32_bf16 v[88:103], v[180:183], v[188:195], v177
    v_mul_f32 v206, v190, v206
    v_mul_f32 v207, v191, v207
    v_mul_f32 v208, v192, v208
    v_mul_f32 v209, v193, v209
    v_mul_f32 v210, v194, v210
    v_mul_f32 v211, v195, v211
    v_mul_f32 v212, v196, v212
    v_smfmac_f32_32x32x32_bf16 v[88:103], v[184:187], v[196:203], v177
    v_mul_f32 v213, v197, v213
    v_mul_f32 v214, v198, v214
    v_mul_f32 v215, v199, v215
    v_mul_f32 v216, v200, v216
    v_mul_f32 v217, v201, v217
    v_mul_f32 v218, v202, v218
    v_mul_f32 v219, v203, v219
    v_smfmac_f32_32x32x32_bf16 v[104:119], v[180:183], v[204:211], v177
    s_waitcnt vmcnt(0)
    ds_read_b128 v[168:171], v244
    v_exp_f32 v220, v220
    v_exp_f32 v221, v221
    v_exp_f32 v222, v222
    v_add_f32 v220, 1.0, v220
    v_smfmac_f32_32x32x32_bf16 v[104:119], v[184:187], v[212:219], v177
    v_exp_f32 v223, v223
    v_add_f32 v221, 1.0, v221
    v_exp_f32 v224, v224
    v_add_f32 v222, 1.0, v222
    v_rcp_f32 v220, v220
    s_waitcnt lgkmcnt(0)
    v_mfma_f32_32x32x16_bf16 v[188:203], v[168:171], v[64:67], 0
    v_exp_f32 v225, v225
    v_add_f32 v223, 1.0, v223
    v_rcp_f32 v221, v221
    v_exp_f32 v226, v226
    v_mfma_f32_32x32x16_bf16 v[204:219], v[152:155], v[48:51], 0
    ds_read_b128 v[152:155], v243 offset:0
    v_add_f32 v224, 1.0, v224
    v_rcp_f32 v222, v222
    v_exp_f32 v227, v227
    v_mfma_f32_32x32x16_bf16 v[204:219], v[156:159], v[52:55], v[204:219]
    ds_read_b128 v[156:159], v243 offset:16
    v_add_f32 v225, 1.0, v225
    v_rcp_f32 v223, v223
    v_exp_f32 v228, v228
    v_add_f32 v226, 1.0, v226
    v_rcp_f32 v224, v224
    v_smfmac_f32_32x32x32_bf16 v[188:203], v[172:175], v[72:79], v176
    v_exp_f32 v229, v229
    v_add_f32 v227, 1.0, v227
    v_rcp_f32 v225, v225
    v_exp_f32 v230, v230
    v_mfma_f32_32x32x16_bf16 v[204:219], v[160:163], v[56:59], v[204:219]
    ds_read_b128 v[160:163], v243 offset:32
    v_add_f32 v228, 1.0, v228
    v_rcp_f32 v226, v226
    v_exp_f32 v231, v231
    v_add_f32 v229, 1.0, v229
    v_mfma_f32_32x32x16_bf16 v[204:219], v[164:167], v[60:63], v[204:219]
    ds_read_b128 v[164:167], v243 offset:48
    v_rcp_f32 v227, v227
    v_exp_f32 v232, v232
    v_add_f32 v230, 1.0, v230
    v_rcp_f32 v228, v228
    s_waitcnt lgkmcnt(3)
    v_mfma_f32_32x32x16_bf16 v[188:203], v[152:155], v[0:3], v[188:203]
    v_exp_f32 v233, v233
    v_add_f32 v231, 1.0, v231
    v_rcp_f32 v229, v229
    v_exp_f32 v234, v234
    s_waitcnt lgkmcnt(2)
    v_mfma_f32_32x32x16_bf16 v[188:203], v[156:159], v[4:7], v[188:203]
    v_add_f32 v232, 1.0, v232
    v_rcp_f32 v230, v230
    v_exp_f32 v235, v235
    v_add_f32 v233, 1.0, v233
    s_waitcnt lgkmcnt(1)
    v_mfma_f32_32x32x16_bf16 v[188:203], v[160:163], v[8:11], v[188:203]
    v_rcp_f32 v231, v231
    v_add_f32 v234, 1.0, v234
    v_rcp_f32 v232, v232
    v_add_f32 v235, 1.0, v235
    v_rcp_f32 v233, v233
    s_waitcnt lgkmcnt(0)
    v_mfma_f32_32x32x16_bf16 v[188:203], v[164:167], v[12:15], v[188:203]
    s_cmp_lt_i32 s72, s38
    s_cbranch_scc0 K2_ND_0
    s_add_u32 m0, s74, 0
    v_mad_u32_u16 v236, v236, s75, v241 op_sel:[1,0,0,0]
    buffer_load_dwordx4 v236, s[16:19], 0 offen lds
    s_add_u32 m0, s74, 1040
    v_mad_u32_u16 v237, v237, s75, v241 op_sel:[1,0,0,0]
    buffer_load_dwordx4 v237, s[16:19], 0 offen lds
    s_add_u32 m0, s74, 2080
    v_mad_u32_u16 v238, v238, s75, v241 op_sel:[1,0,0,0]
    buffer_load_dwordx4 v238, s[16:19], 0 offen lds
    s_add_u32 m0, s74, 3120
    v_mad_u32_u16 v239, v239, s75, v241 op_sel:[1,0,0,0]
    buffer_load_dwordx4 v239, s[16:19], 0 offen lds
    s_add_u32 m0, s74, 4160
    v_add_u32 v240, v240, v242
    buffer_load_dwordx4 v240, s[20:23], 0 offen lds
K2_ND_0:
    v_rcp_f32 v234, v234
    v_rcp_f32 v235, v235
    v_mul_f32 v204, v220, v204
    v_mul_f32 v205, v221, v205
    v_smfmac_f32_32x32x32_bf16 v[120:135], v[180:183], v[220:227], v177
    v_mul_f32 v206, v222, v206
    v_mul_f32 v207, v223, v207
    v_mul_f32 v208, v224, v208
    v_mul_f32 v209, v225, v209
    v_mul_f32 v210, v226, v210
    v_mul_f32 v211, v227, v211
    v_mul_f32 v212, v228, v212
    v_smfmac_f32_32x32x32_bf16 v[120:135], v[184:187], v[228:235], v177
    v_mul_f32 v213, v229, v213
    v_mul_f32 v214, v230, v214
    v_mul_f32 v215, v231, v215
    v_mul_f32 v216, v232, v216
    v_mul_f32 v217, v233, v217
    v_mul_f32 v218, v234, v218
    v_mul_f32 v219, v235, v219
    s_cmp_ge_u32 s72, s87
    s_cbranch_scc1 K2_EV0
K2_EVR0:
    v_smfmac_f32_32x32x32_bf16 v[136:151], v[180:183], v[204:211], v177
    ds_read_u8 v236, v248 offset:128
    ds_read_u8 v237, v248 offset:144
    ds_read_u8 v238, v248 offset:192
    ds_read_u8 v239, v248 offset:208
    ds_read_u8 v250, v249 offset:256
    v_exp_f32 v188, v188
    v_exp_f32 v189, v189
    v_exp_f32 v190, v190
    v_add_f32 v188, 1.0, v188
    v_smfmac_f32_32x32x32_bf16 v[136:151], v[184:187], v[212:219], v177
    v_exp_f32 v191, v191
    v_add_f32 v189, 1.0, v189
    v_exp_f32 v192, v192
    v_add_f32 v190, 1.0, v190
    v_rcp_f32 v188, v188
    v_mfma_f32_32x32x16_bf16 v[220:235], v[168:171], v[68:71], 0
    v_exp_f32 v193, v193
    v_add_f32 v191, 1.0, v191
    v_rcp_f32 v189, v189
    v_exp_f32 v194, v194
    v_mfma_f32_32x32x16_bf16 v[204:219], v[152:155], v[32:35], 0
    v_add_f32 v192, 1.0, v192
    v_rcp_f32 v190, v190
    v_exp_f32 v195, v195
    v_mfma_f32_32x32x16_bf16 v[204:219], v[156:159], v[36:39], v[204:219]
    s_waitcnt lgkmcnt(0)
    v_lshl_add_u32 v236, v236, 6, v246
    v_lshl_add_u32 v237, v237, 6, v246
    v_lshl_add_u32 v238, v238, 6, v246
    v_lshl_add_u32 v239, v239, 6, v246
    v_lshl_add_u32 v250, v250, 6, v245
    v_add_f32 v193, 1.0, v193
    v_rcp_f32 v191, v191
    v_exp_f32 v196, v196
    v_add_f32 v194, 1.0, v194
    v_rcp_f32 v192, v192
    v_smfmac_f32_32x32x32_bf16 v[220:235], v[172:175], v[80:87], v176
    ds_read_b64_tr_b16 v[180:181], v236
    ds_read_b64_tr_b16 v[182:183], v237
    ds_read_b64_tr_b16 v[184:185], v238
    ds_read_b64_tr_b16 v[186:187], v239
    ds_read_b128 v[172:175], v250 offset:7424
    ds_read_b32 v176, v250 offset:7440
    v_exp_f32 v197, v197
    v_add_f32 v195, 1.0, v195
    v_rcp_f32 v193, v193
    v_exp_f32 v198, v198
    v_mfma_f32_32x32x16_bf16 v[204:219], v[160:163], v[40:43], v[204:219]
    v_add_f32 v196, 1.0, v196
    v_rcp_f32 v194, v194
    v_exp_f32 v199, v199
    v_add_f32 v197, 1.0, v197
    v_mfma_f32_32x32x16_bf16 v[204:219], v[164:167], v[44:47], v[204:219]
    v_rcp_f32 v195, v195
    v_exp_f32 v200, v200
    v_add_f32 v198, 1.0, v198
    v_rcp_f32 v196, v196
    v_mfma_f32_32x32x16_bf16 v[220:235], v[152:155], v[16:19], v[220:235]
    ds_read_b128 v[236:239], v247 offset:384
    ds_read_b32 v240, v251 offset:384
    s_add_u32 s72, s72, 1
    v_exp_f32 v201, v201
    v_add_f32 v199, 1.0, v199
    v_rcp_f32 v197, v197
    v_exp_f32 v202, v202
    v_mfma_f32_32x32x16_bf16 v[220:235], v[156:159], v[20:23], v[220:235]
    v_add_f32 v200, 1.0, v200
    v_rcp_f32 v198, v198
    v_exp_f32 v203, v203
    v_add_f32 v201, 1.0, v201
    v_mfma_f32_32x32x16_bf16 v[220:235], v[160:163], v[24:27], v[220:235]
    v_rcp_f32 v199, v199
    v_add_f32 v202, 1.0, v202
    v_rcp_f32 v200, v200
    v_add_f32 v203, 1.0, v203
    v_rcp_f32 v201, v201
    v_mfma_f32_32x32x16_bf16 v[220:235], v[164:167], v[28:31], v[220:235]
    v_rcp_f32 v202, v202
    v_rcp_f32 v203, v203
    v_mul_f32 v204, v188, v204
    v_mul_f32 v205, v189, v205
    s_waitcnt lgkmcnt(0)
    v_smfmac_f32_32x32x32_bf16 v[88:103], v[180:183], v[188:195], v177
    v_mul_f32 v206, v190, v206
    v_mul_f32 v207, v191, v207
    v_mul_f32 v208, v192, v208
    v_mul_f32 v209, v193, v209
    v_mul_f32 v210, v194, v210
    v_mul_f32 v211, v195, v211
    v_mul_f32 v212, v196, v212
    v_smfmac_f32_32x32x32_bf16 v[88:103], v[184:187], v[196:203], v177
    v_mul_f32 v213, v197, v213
    v_mul_f32 v214, v198, v214
    v_mul_f32 v215, v199, v215
    v_mul_f32 v216, v200, v216
    v_mul_f32 v217, v201, v217
    v_mul_f32 v218, v202, v218
    v_mul_f32 v219, v203, v219
    v_smfmac_f32_32x32x32_bf16 v[104:119], v[180:183], v[204:211], v177
    s_waitcnt vmcnt(0)
    ds_read_b128 v[168:171], v244
    v_exp_f32 v220, v220
    v_exp_f32 v221, v221
    v_exp_f32 v222, v222
    v_add_f32 v220, 1.0, v220
    v_smfmac_f32_32x32x32_bf16 v[104:119], v[184:187], v[212:219], v177
    v_exp_f32 v223, v223
    v_add_f32 v221, 1.0, v221
    v_exp_f32 v224, v224
    v_add_f32 v222, 1.0, v222
    v_rcp_f32 v220, v220
    s_waitcnt lgkmcnt(0)
    v_mfma_f32_32x32x16_bf16 v[188:203], v[168:171], v[64:67], 0
    v_exp_f32 v225, v225
    v_add_f32 v223, 1.0, v223
    v_rcp_f32 v221, v221
    v_exp_f32 v226, v226
    v_mfma_f32_32x32x16_bf16 v[204:219], v[152:155], v[48:51], 0
    ds_read_b128 v[152:155], v243 offset:0
    v_add_f32 v224, 1.0, v224
    v_rcp_f32 v222, v222
    v_exp_f32 v227, v227
    v_mfma_f32_32x32x16_bf16 v[204:219], v[156:159], v[52:55], v[204:219]
    ds_read_b128 v[156:159], v243 offset:16
    v_add_f32 v225, 1.0, v225
    v_rcp_f32 v223, v223
    v_exp_f32 v228, v228
    v_add_f32 v226, 1.0, v226
    v_rcp_f32 v224, v224
    v_smfmac_f32_32x32x32_bf16 v[188:203], v[172:175], v[72:79], v176
    v_exp_f32 v229, v229
    v_add_f32 v227, 1.0, v227
    v_rcp_f32 v225, v225
    v_exp_f32 v230, v230
    v_mfma_f32_32x32x16_bf16 v[204:219], v[160:163], v[56:59], v[204:219]
    ds_read_b128 v[160:163], v243 offset:32
    v_add_f32 v228, 1.0, v228
    v_rcp_f32 v226, v226
    v_exp_f32 v231, v231
    v_add_f32 v229, 1.0, v229
    v_mfma_f32_32x32x16_bf16 v[204:219], v[164:167], v[60:63], v[204:219]
    ds_read_b128 v[164:167], v243 offset:48
    v_rcp_f32 v227, v227
    v_exp_f32 v232, v232
    v_add_f32 v230, 1.0, v230
    v_rcp_f32 v228, v228
    s_waitcnt lgkmcnt(3)
    v_mfma_f32_32x32x16_bf16 v[188:203], v[152:155], v[0:3], v[188:203]
    v_exp_f32 v233, v233
    v_add_f32 v231, 1.0, v231
    v_rcp_f32 v229, v229
    v_exp_f32 v234, v234
    s_waitcnt lgkmcnt(2)
    v_mfma_f32_32x32x16_bf16 v[188:203], v[156:159], v[4:7], v[188:203]
    v_add_f32 v232, 1.0, v232
    v_rcp_f32 v230, v230
    v_exp_f32 v235, v235
    v_add_f32 v233, 1.0, v233
    s_waitcnt lgkmcnt(1)
    v_mfma_f32_32x32x16_bf16 v[188:203], v[160:163], v[8:11], v[188:203]
    v_rcp_f32 v231, v231
    v_add_f32 v234, 1.0, v234
    v_rcp_f32 v232, v232
    v_add_f32 v235, 1.0, v235
    v_rcp_f32 v233, v233
    s_waitcnt lgkmcnt(0)
    v_mfma_f32_32x32x16_bf16 v[188:203], v[164:167], v[12:15], v[188:203]
    s_cmp_lt_i32 s72, s38
    s_cbranch_scc0 K2_ND_1
    s_add_u32 m0, s74, 0
    v_mad_u32_u16 v236, v236, s75, v241 op_sel:[1,0,0,0]
    buffer_load_dwordx4 v236, s[16:19], 0 offen lds
    s_add_u32 m0, s74, 1040
    v_mad_u32_u16 v237, v237, s75, v241 op_sel:[1,0,0,0]
    buffer_load_dwordx4 v237, s[16:19], 0 offen lds
    s_add_u32 m0, s74, 2080
    v_mad_u32_u16 v238, v238, s75, v241 op_sel:[1,0,0,0]
    buffer_load_dwordx4 v238, s[16:19], 0 offen lds
    s_add_u32 m0, s74, 3120
    v_mad_u32_u16 v239, v239, s75, v241 op_sel:[1,0,0,0]
    buffer_load_dwordx4 v239, s[16:19], 0 offen lds
    s_add_u32 m0, s74, 4160
    v_add_u32 v240, v240, v242
    buffer_load_dwordx4 v240, s[20:23], 0 offen lds
K2_ND_1:
    v_rcp_f32 v234, v234
    v_rcp_f32 v235, v235
    v_mul_f32 v204, v220, v204
    v_mul_f32 v205, v221, v205
    v_smfmac_f32_32x32x32_bf16 v[120:135], v[180:183], v[220:227], v177
    v_mul_f32 v206, v222, v206
    v_mul_f32 v207, v223, v207
    v_mul_f32 v208, v224, v208
    v_mul_f32 v209, v225, v209
    v_mul_f32 v210, v226, v210
    v_mul_f32 v211, v227, v211
    v_mul_f32 v212, v228, v212
    v_smfmac_f32_32x32x32_bf16 v[120:135], v[184:187], v[228:235], v177
    v_mul_f32 v213, v229, v213
    v_mul_f32 v214, v230, v214
    v_mul_f32 v215, v231, v215
    v_mul_f32 v216, v232, v216
    v_mul_f32 v217, v233, v217
    v_mul_f32 v218, v234, v218
    v_mul_f32 v219, v235, v219
    v_add_u32 v247, 0x100, v247
    v_add_u32 v249, 0x100, v249
    v_add_u32 v251, 0x100, v251
    v_add_u32 v248, 0x100, v248
    s_cmp_lt_u32 s72, s87
    s_cbranch_scc1 K2_LOOP
    s_cmp_ge_u32 s72, s73
    s_cbranch_scc1 K2_TAIL
    s_cmp_lg_u32 s72, s37
    s_cbranch_scc1 K2_SB1
    s_barrier
    s_mov_b32 s37, -1
K2_SB1:
    s_cmp_lg_u32 s72, s4
    s_cbranch_scc1 K2_PR1_0
    s_setprio 2
K2_PR1_0:
    s_cmp_lg_u32 s72, s5
    s_cbranch_scc1 K2_PR1_1
    s_setprio 1
K2_PR1_1:
    s_cmp_lg_u32 s72, s6
    s_cbranch_scc1 K2_PR1_2
    s_setprio 0
K2_PR1_2:
    s_lshl_b32 s10, s78, 8
    s_add_u32 s10, s10, s38
    s_cmp_eq_u32 s72, s10
    s_cbranch_scc1 K2_LT1
    s_mov_b32 s87, s73
    s_cmp_gt_i32 s4, s72
    s_cselect_b32 s10, s4, s87
    s_min_u32 s87, s87, s10
    s_cmp_gt_i32 s5, s72
    s_cselect_b32 s10, s5, s87
    s_min_u32 s87, s87, s10
    s_cmp_gt_i32 s6, s72
    s_cselect_b32 s10, s6, s87
    s_min_u32 s87, s87, s10
    s_cmp_gt_i32 s37, s72
    s_cselect_b32 s10, s37, s87
    s_min_u32 s87, s87, s10
    s_cmp_gt_i32 s38, s72
    s_cselect_b32 s10, s38, s87
    s_min_u32 s87, s87, s10
    s_branch K2_LOOP
K2_EV0:
    s_cmp_ge_u32 s72, s73
    s_cbranch_scc1 K2_TAIL
    s_cmp_lg_u32 s72, s37
    s_cbranch_scc1 K2_SB0
    s_barrier
    s_mov_b32 s37, -1
K2_SB0:
    s_cmp_lg_u32 s72, s4
    s_cbranch_scc1 K2_PR0_0
    s_setprio 2
K2_PR0_0:
    s_cmp_lg_u32 s72, s5
    s_cbranch_scc1 K2_PR0_1
    s_setprio 1
K2_PR0_1:
    s_cmp_lg_u32 s72, s6
    s_cbranch_scc1 K2_PR0_2
    s_setprio 0
K2_PR0_2:
    s_lshl_b32 s10, s78, 8
    s_add_u32 s10, s10, s38
    s_cmp_eq_u32 s72, s10
    s_cbranch_scc1 K2_LT0
    s_mov_b32 s87, s73
    s_cmp_gt_i32 s4, s72
    s_cselect_b32 s10, s4, s87
    s_min_u32 s87, s87, s10
    s_cmp_gt_i32 s5, s72
    s_cselect_b32 s10, s5, s87
    s_min_u32 s87, s87, s10
    s_cmp_gt_i32 s6, s72
    s_cselect_b32 s10, s6, s87
    s_min_u32 s87, s87, s10
    s_cmp_gt_i32 s37, s72
    s_cselect_b32 s10, s37, s87
    s_min_u32 s87, s87, s10
    s_cmp_gt_i32 s38, s72
    s_cselect_b32 s10, s38, s87
    s_min_u32 s87, s87, s10
    s_branch K2_EVR0
K2_LT0:
    v_add_u32 v248, 128, v248
K2_LT1:
    s_sub_u32 s10, s15, s76
    s_sub_u32 s10, s10, 4
    s_and_b32 s10, s10, 127
    s_cmp_lt_u32 s10, 32
    s_cbranch_scc1 K2_LG1
    s_cmp_lt_u32 s10, 64
    s_cbranch_scc1 K2_LG2
    s_cmp_lt_u32 s10, 96
    s_cbranch_scc1 K2_LG3
    v_smfmac_f32_32x32x32_bf16 v[136:151], v[180:183], v[204:211], v177
    ds_read_u8 v236, v248 offset:0
    ds_read_u8 v237, v248 offset:16
    ds_read_u8 v238, v248 offset:64
    ds_read_u8 v239, v248 offset:80
    v_exp_f32 v188, v188
    v_exp_f32 v189, v189
    v_exp_f32 v190, v190
    v_add_f32 v188, 1.0, v188
    v_smfmac_f32_32x32x32_bf16 v[136:151], v[184:187], v[212:219], v177
    v_lshlrev_b32 v252, 4, v254
    v_and_b32 v247, 31, v254
    v_and_b32 v245, 32, v254
    v_mul_u32_u24 v249, 144, v247
    v_lshrrev_b32 v251, 2, v245
    v_lshl_add_u32 v247, v247, 6, v251
    v_lshl_add_u32 v249, v245, 1, v249
    v_add_u32 v249, s74, v249
    v_lshrrev_b32 v251, 3, v254
    v_lshl_add_u32 v251, v251, 4, v252
    v_add_u32 v251, s70, v251
    v_exp_f32 v191, v191
    v_add_f32 v189, 1.0, v189
    v_exp_f32 v192, v192
    v_add_f32 v190, 1.0, v190
    v_rcp_f32 v188, v188
    v_mfma_f32_32x32x16_bf16 v[220:235], v[168:171], v[68:71], 0
    v_exp_f32 v193, v193
    v_add_f32 v191, 1.0, v191
    v_rcp_f32 v189, v189
    v_exp_f32 v194, v194
    v_mfma_f32_32x32x16_bf16 v[204:219], v[152:155], v[32:35], 0
    v_add_f32 v192, 1.0, v192
    v_rcp_f32 v190, v190
    v_exp_f32 v195, v195
    v_mfma_f32_32x32x16_bf16 v[204:219], v[156:159], v[36:39], v[204:219]
    s_waitcnt lgkmcnt(0)
    v_lshl_add_u32 v236, v236, 6, v246
    v_lshl_add_u32 v237, v237, 6, v246
    v_lshl_add_u32 v238, v238, 6, v246
    v_lshl_add_u32 v239, v239, 6, v246
    v_add_f32 v193, 1.0, v193
    v_rcp_f32 v191, v191
    v_exp_f32 v196, v196
    v_add_f32 v194, 1.0, v194
    v_rcp_f32 v192, v192
    v_smfmac_f32_32x32x32_bf16 v[220:235], v[172:175], v[80:87], v176
    ds_read_b64_tr_b16 v[180:181], v236
    ds_read_b64_tr_b16 v[182:183], v237
    ds_read_b64_tr_b16 v[184:185], v238
    ds_read_b64_tr_b16 v[186:187], v239
    v_exp_f32 v197, v197
    v_add_f32 v195, 1.0, v195
    v_rcp_f32 v193, v193
    v_exp_f32 v198, v198
    v_mfma_f32_32x32x16_bf16 v[204:219], v[160:163], v[40:43], v[204:219]
    v_add_f32 v196, 1.0, v196
    v_rcp_f32 v194, v194
    v_exp_f32 v199, v199
    v_add_f32 v197, 1.0, v197
    v_mfma_f32_32x32x16_bf16 v[204:219], v[164:167], v[44:47], v[204:219]
    v_rcp_f32 v195, v195
    v_exp_f32 v200, v200
    v_add_f32 v198, 1.0, v198
    v_rcp_f32 v196, v196
    v_mfma_f32_32x32x16_bf16 v[220:235], v[152:155], v[16:19], v[220:235]
    v_exp_f32 v201, v201
    v_add_f32 v199, 1.0, v199
    v_rcp_f32 v197, v197
    v_exp_f32 v202, v202
    v_mfma_f32_32x32x16_bf16 v[220:235], v[156:159], v[20:23], v[220:235]
    v_add_f32 v200, 1.0, v200
    v_rcp_f32 v198, v198
    v_exp_f32 v203, v203
    v_add_f32 v201, 1.0, v201
    v_mfma_f32_32x32x16_bf16 v[220:235], v[160:163], v[24:27], v[220:235]
    v_rcp_f32 v199, v199
    v_add_f32 v202, 1.0, v202
    v_rcp_f32 v200, v200
    v_add_f32 v203, 1.0, v203
    v_rcp_f32 v201, v201
    v_mfma_f32_32x32x16_bf16 v[220:235], v[164:167], v[28:31], v[220:235]
    ds_read2_b64 v[64:67], v247 offset0:0 offset1:2
    ds_read2_b64 v[68:71], v247 offset0:4 offset1:6
    ds_read_b128 v[0:3], v252 offset:52736
    ds_read_b128 v[4:7], v252 offset:53760
    ds_read_b128 v[8:11], v252 offset:54784
    ds_read_b128 v[12:15], v252 offset:55808
    ds_read_b128 v[16:19], v252 offset:56832
    ds_read_b128 v[20:23], v252 offset:57856
    ds_read_b128 v[24:27], v252 offset:58880
    ds_read_b128 v[28:31], v252 offset:59904
    v_rcp_f32 v202, v202
    v_rcp_f32 v203, v203
    v_mul_f32 v204, v188, v204
    v_mul_f32 v205, v189, v205
    s_waitcnt lgkmcnt(10)
    v_smfmac_f32_32x32x32_bf16 v[88:103], v[180:183], v[188:195], v177
    v_mul_f32 v206, v190, v206
    v_mul_f32 v207, v191, v207
    v_mul_f32 v208, v192, v208
    v_mul_f32 v209, v193, v209
    v_mul_f32 v210, v194, v210
    v_mul_f32 v211, v195, v211
    v_mul_f32 v212, v196, v212
    v_smfmac_f32_32x32x32_bf16 v[88:103], v[184:187], v[196:203], v177
    v_mul_f32 v213, v197, v213
    v_mul_f32 v214, v198, v214
    v_mul_f32 v215, v199, v215
    v_mul_f32 v216, v200, v216
    v_mul_f32 v217, v201, v217
    v_mul_f32 v218, v202, v218
    v_mul_f32 v219, v203, v219
    v_smfmac_f32_32x32x32_bf16 v[104:119], v[180:183], v[204:211], v177
    v_exp_f32 v220, v220
    v_exp_f32 v221, v221
    v_exp_f32 v222, v222
    v_add_f32 v220, 1.0, v220
    v_exp_f32 v223, v223
    v_smfmac_f32_32x32x32_bf16 v[104:119], v[184:187], v[212:219], v177
    v_add_f32 v221, 1.0, v221
    v_exp_f32 v224, v224
    v_add_f32 v222, 1.0, v222
    v_rcp_f32 v220, v220
    v_exp_f32 v225, v225
    v_add_f32 v223, 1.0, v223
    v_mfma_f32_32x32x16_bf16 v[204:219], v[152:155], v[48:51], 0
    ds_read_b128 v[152:155], v253 offset:0
    v_rcp_f32 v221, v221
    v_exp_f32 v226, v226
    v_add_f32 v224, 1.0, v224
    v_rcp_f32 v222, v222
    v_exp_f32 v227, v227
    v_mfma_f32_32x32x16_bf16 v[204:219], v[156:159], v[52:55], v[204:219]
    ds_read_b128 v[156:159], v253 offset:16
    v_add_f32 v225, 1.0, v225
    v_rcp_f32 v223, v223
    v_exp_f32 v228, v228
    v_add_f32 v226, 1.0, v226
    v_rcp_f32 v224, v224
    v_exp_f32 v229, v229
    v_mfma_f32_32x32x16_bf16 v[204:219], v[160:163], v[56:59], v[204:219]
    ds_read_b128 v[160:163], v253 offset:32
    v_add_f32 v227, 1.0, v227
    v_rcp_f32 v225, v225
    v_exp_f32 v230, v230
    v_add_f32 v228, 1.0, v228
    v_rcp_f32 v226, v226
    v_mfma_f32_32x32x16_bf16 v[204:219], v[164:167], v[60:63], v[204:219]
    ds_read_b128 v[164:167], v253 offset:48
    v_exp_f32 v231, v231
    v_add_f32 v229, 1.0, v229
    v_rcp_f32 v227, v227
    v_exp_f32 v232, v232
    v_add_f32 v230, 1.0, v230
    v_rcp_f32 v228, v228
    v_exp_f32 v233, v233
    v_add_f32 v231, 1.0, v231
    v_rcp_f32 v229, v229
    v_exp_f32 v234, v234
    v_add_f32 v232, 1.0, v232
    v_rcp_f32 v230, v230
    v_exp_f32 v235, v235
    v_add_f32 v233, 1.0, v233
    v_rcp_f32 v231, v231
    v_add_f32 v234, 1.0, v234
    v_rcp_f32 v232, v232
    v_add_f32 v235, 1.0, v235
    v_rcp_f32 v233, v233
    v_rcp_f32 v234, v234
    v_rcp_f32 v235, v235
    v_mul_f32 v204, v220, v204
    v_mul_f32 v205, v221, v205
    v_smfmac_f32_32x32x32_bf16 v[120:135], v[180:183], v[220:227], v177
    v_mul_f32 v206, v222, v206
    v_mul_f32 v207, v223, v207
    v_mul_f32 v208, v224, v208
    v_mul_f32 v209, v225, v209
    v_mul_f32 v210, v226, v210
    v_mul_f32 v211, v227, v211
    v_mul_f32 v212, v228, v212
    v_smfmac_f32_32x32x32_bf16 v[120:135], v[184:187], v[228:235], v177
    v_mul_f32 v213, v229, v213
    v_mul_f32 v214, v230, v214
    v_mul_f32 v215, v231, v215
    v_mul_f32 v216, v232, v216
    v_mul_f32 v217, v233, v217
    v_mul_f32 v218, v234, v218
    v_mul_f32 v219, v235, v219
    v_smfmac_f32_32x32x32_bf16 v[136:151], v[180:183], v[204:211], v177
    s_nop 0
    v_smfmac_f32_32x32x32_bf16 v[136:151], v[184:187], v[212:219], v177
    s_branch K2_EPI2
K2_LG3:
    v_smfmac_f32_32x32x32_bf16 v[136:151], v[180:183], v[204:211], v177
    ds_read_u8 v236, v248 offset:0
    ds_read_u8 v237, v248 offset:16
    ds_read_u8 v238, v248 offset:64
    ds_read_u8 v239, v248 offset:80
    v_exp_f32 v188, v188
    v_exp_f32 v189, v189
    v_exp_f32 v190, v190
    v_smfmac_f32_32x32x32_bf16 v[136:151], v[184:187], v[212:219], v177
    v_lshlrev_b32 v252, 4, v254
    v_and_b32 v247, 31, v254
    v_and_b32 v245, 32, v254
    v_mul_u32_u24 v249, 144, v247
    v_lshrrev_b32 v251, 2, v245
    v_lshl_add_u32 v247, v247, 6, v251
    v_lshl_add_u32 v249, v245, 1, v249
    v_add_u32 v249, s74, v249
    v_lshrrev_b32 v251, 3, v254
    v_lshl_add_u32 v251, v251, 4, v252
    v_add_u32 v251, s70, v251
    v_add_f32 v188, 1.0, v188
    v_exp_f32 v191, v191
    v_add_f32 v189, 1.0, v189
    v_exp_f32 v192, v192
    v_mfma_f32_32x32x16_bf16 v[220:235], v[168:171], v[68:71], 0
    v_add_f32 v190, 1.0, v190
    v_rcp_f32 v188, v188
    v_exp_f32 v193, v193
    v_mfma_f32_32x32x16_bf16 v[204:219], v[152:155], v[32:35], 0
    v_add_f32 v191, 1.0, v191
    v_rcp_f32 v189, v189
    v_exp_f32 v194, v194
    v_mfma_f32_32x32x16_bf16 v[204:219], v[156:159], v[36:39], v[204:219]
    s_waitcnt lgkmcnt(0)
    v_lshl_add_u32 v236, v236, 6, v246
    v_lshl_add_u32 v237, v237, 6, v246
    v_lshl_add_u32 v238, v238, 6, v246
    v_lshl_add_u32 v239, v239, 6, v246
    v_add_f32 v192, 1.0, v192
    v_rcp_f32 v190, v190
    v_exp_f32 v195, v195
    v_smfmac_f32_32x32x32_bf16 v[220:235], v[172:175], v[80:87], v176
    ds_read_b64_tr_b16 v[180:181], v236
    ds_read_b64_tr_b16 v[182:183], v237
    ds_read_b64_tr_b16 v[184:185], v238
    ds_read_b64_tr_b16 v[186:187], v239
    v_add_f32 v193, 1.0, v193
    v_rcp_f32 v191, v191
    v_exp_f32 v196, v196
    v_mfma_f32_32x32x16_bf16 v[204:219], v[160:163], v[40:43], v[204:219]
    v_add_f32 v194, 1.0, v194
    v_rcp_f32 v192, v192
    v_exp_f32 v197, v197
    v_mfma_f32_32x32x16_bf16 v[204:219], v[164:167], v[44:47], v[204:219]
    v_add_f32 v195, 1.0, v195
    v_rcp_f32 v193, v193
    v_exp_f32 v198, v198
    v_mfma_f32_32x32x16_bf16 v[220:235], v[152:155], v[16:19], v[220:235]
    v_add_f32 v196, 1.0, v196
    v_rcp_f32 v194, v194
    v_exp_f32 v199, v199
    v_mfma_f32_32x32x16_bf16 v[220:235], v[156:159], v[20:23], v[220:235]
    v_add_f32 v197, 1.0, v197
    v_rcp_f32 v195, v195
    v_add_f32 v198, 1.0, v198
    v_mfma_f32_32x32x16_bf16 v[220:235], v[160:163], v[24:27], v[220:235]
    v_rcp_f32 v196, v196
    v_add_f32 v199, 1.0, v199
    v_rcp_f32 v197, v197
    v_mfma_f32_32x32x16_bf16 v[220:235], v[164:167], v[28:31], v[220:235]
    ds_read2_b64 v[64:67], v247 offset0:0 offset1:2
    ds_read2_b64 v[68:71], v247 offset0:4 offset1:6
    ds_read_b128 v[0:3], v252 offset:52736
    ds_read_b128 v[4:7], v252 offset:53760
    ds_read_b128 v[8:11], v252 offset:54784
    ds_read_b128 v[12:15], v252 offset:55808
    ds_read_b128 v[16:19], v252 offset:56832
    ds_read_b128 v[20:23], v252 offset:57856
    ds_read_b128 v[24:27], v252 offset:58880
    ds_read_b128 v[28:31], v252 offset:59904
    v_rcp_f32 v198, v198
    v_rcp_f32 v199, v199
    v_mul_f32 v204, v188, v204
    v_mul_f32 v205, v189, v205
    s_waitcnt lgkmcnt(10)
    v_smfmac_f32_32x32x32_bf16 v[88:103], v[180:183], v[188:195], v177
    v_mul_f32 v206, v190, v206
    v_mul_f32 v207, v191, v207
    v_mul_f32 v208, v192, v208
    v_mul_f32 v209, v193, v209
    v_mul_f32 v210, v194, v210
    v_smfmac_f32_32x32x32_bf16 v[88:103], v[184:187], v[196:203], v177
    v_mul_f32 v211, v195, v211
    v_mul_f32 v212, v196, v212
    v_mul_f32 v213, v197, v213
    v_mul_f32 v214, v198, v214
    v_mul_f32 v215, v199, v215
    v_smfmac_f32_32x32x32_bf16 v[104:119], v[180:183], v[204:211], v177
    v_exp_f32 v220, v220
    v_exp_f32 v221, v221
    v_exp_f32 v222, v222
    v_add_f32 v220, 1.0, v220
    v_smfmac_f32_32x32x32_bf16 v[104:119], v[184:187], v[212:219], v177
    v_exp_f32 v223, v223
    v_add_f32 v221, 1.0, v221
    v_exp_f32 v224, v224
    v_add_f32 v222, 1.0, v222
    v_rcp_f32 v220, v220
    v_mfma_f32_32x32x16_bf16 v[204:219], v[152:155], v[48:51], 0
    ds_read_b128 v[152:155], v253 offset:0
    v_exp_f32 v225, v225
    v_add_f32 v223, 1.0, v223
    v_rcp_f32 v221, v221
    v_exp_f32 v226, v226
    v_mfma_f32_32x32x16_bf16 v[204:219], v[156:159], v[52:55], v[204:219]
    ds_read_b128 v[156:159], v253 offset:16
    v_add_f32 v224, 1.0, v224
    v_rcp_f32 v222, v222
    v_exp_f32 v227, v227
    v_mfma_f32_32x32x16_bf16 v[204:219], v[160:163], v[56:59], v[204:219]
    ds_read_b128 v[160:163], v253 offset:32
    v_add_f32 v225, 1.0, v225
    v_rcp_f32 v223, v223
    v_exp_f32 v228, v228
    v_add_f32 v226, 1.0, v226
    v_rcp_f32 v224, v224
    v_mfma_f32_32x32x16_bf16 v[204:219], v[164:167], v[60:63], v[204:219]
    ds_read_b128 v[164:167], v253 offset:48
    v_exp_f32 v229, v229
    v_add_f32 v227, 1.0, v227
    v_rcp_f32 v225, v225
    v_exp_f32 v230, v230
    v_add_f32 v228, 1.0, v228
    v_rcp_f32 v226, v226
    v_exp_f32 v231, v231
    v_add_f32 v229, 1.0, v229
    v_rcp_f32 v227, v227
    v_add_f32 v230, 1.0, v230
    v_rcp_f32 v228, v228
    v_add_f32 v231, 1.0, v231
    v_rcp_f32 v229, v229
    v_rcp_f32 v230, v230
    v_rcp_f32 v231, v231
    v_mul_f32 v204, v220, v204
    v_mul_f32 v205, v221, v205
    v_smfmac_f32_32x32x32_bf16 v[120:135], v[180:183], v[220:227], v177
    v_mul_f32 v206, v222, v206
    v_mul_f32 v207, v223, v207
    v_mul_f32 v208, v224, v208
    v_mul_f32 v209, v225, v209
    v_mul_f32 v210, v226, v210
    v_smfmac_f32_32x32x32_bf16 v[120:135], v[184:187], v[228:235], v177
    v_mul_f32 v211, v227, v211
    v_mul_f32 v212, v228, v212
    v_mul_f32 v213, v229, v213
    v_mul_f32 v214, v230, v214
    v_mul_f32 v215, v231, v215
    v_smfmac_f32_32x32x32_bf16 v[136:151], v[180:183], v[204:211], v177
    s_nop 0
    v_smfmac_f32_32x32x32_bf16 v[136:151], v[184:187], v[212:219], v177
    s_branch K2_EPI2
K2_LG2:
    v_smfmac_f32_32x32x32_bf16 v[136:151], v[180:183], v[204:211], v177
    ds_read_u8 v236, v248 offset:0
    ds_read_u8 v237, v248 offset:16
    ds_read_u8 v238, v248 offset:64
    ds_read_u8 v239, v248 offset:80
    v_exp_f32 v188, v188
    v_exp_f32 v189, v189
    v_smfmac_f32_32x32x32_bf16 v[136:151], v[184:187], v[212:219], v177
    v_lshlrev_b32 v252, 4, v254
    v_and_b32 v247, 31, v254
    v_and_b32 v245, 32, v254
    v_mul_u32_u24 v249, 144, v247
    v_lshrrev_b32 v251, 2, v245
    v_lshl_add_u32 v247, v247, 6, v251
    v_lshl_add_u32 v249, v245, 1, v249
    v_add_u32 v249, s74, v249
    v_lshrrev_b32 v251, 3, v254
    v_lshl_add_u32 v251, v251, 4, v252
    v_add_u32 v251, s70, v251
    v_exp_f32 v190, v190
    v_add_f32 v188, 1.0, v188
    v_mfma_f32_32x32x16_bf16 v[220:235], v[168:171], v[68:71], 0
    v_exp_f32 v191, v191
    v_add_f32 v189, 1.0, v189
    v_exp_f32 v192, v192
    v_mfma_f32_32x32x16_bf16 v[204:219], v[152:155], v[32:35], 0
    v_add_f32 v190, 1.0, v190
    v_rcp_f32 v188, v188
    v_mfma_f32_32x32x16_bf16 v[204:219], v[156:159], v[36:39], v[204:219]
    s_waitcnt lgkmcnt(0)
    v_lshl_add_u32 v236, v236, 6, v246
    v_lshl_add_u32 v237, v237, 6, v246
    v_lshl_add_u32 v238, v238, 6, v246
    v_lshl_add_u32 v239, v239, 6, v246
    v_exp_f32 v193, v193
    v_smfmac_f32_32x32x32_bf16 v[220:235], v[172:175], v[80:87], v176
    ds_read_b64_tr_b16 v[180:181], v236
    ds_read_b64_tr_b16 v[182:183], v237
    ds_read_b64_tr_b16 v[184:185], v238
    ds_read_b64_tr_b16 v[186:187], v239
    v_add_f32 v191, 1.0, v191
    v_rcp_f32 v189, v189
    v_exp_f32 v194, v194
    v_mfma_f32_32x32x16_bf16 v[204:219], v[160:163], v[40:43], v[204:219]
    v_add_f32 v192, 1.0, v192
    v_rcp_f32 v190, v190
    v_mfma_f32_32x32x16_bf16 v[204:219], v[164:167], v[44:47], v[204:219]
    v_exp_f32 v195, v195
    v_mfma_f32_32x32x16_bf16 v[220:235], v[152:155], v[16:19], v[220:235]
    v_add_f32 v193, 1.0, v193
    v_rcp_f32 v191, v191
    v_add_f32 v194, 1.0, v194
    v_mfma_f32_32x32x16_bf16 v[220:235], v[156:159], v[20:23], v[220:235]
    v_rcp_f32 v192, v192
    v_add_f32 v195, 1.0, v195
    v_mfma_f32_32x32x16_bf16 v[220:235], v[160:163], v[24:27], v[220:235]
    v_rcp_f32 v193, v193
    v_rcp_f32 v194, v194
    v_mfma_f32_32x32x16_bf16 v[220:235], v[164:167], v[28:31], v[220:235]
    ds_read2_b64 v[64:67], v247 offset0:0 offset1:2
    ds_read2_b64 v[68:71], v247 offset0:4 offset1:6
    ds_read_b128 v[0:3], v252 offset:52736
    ds_read_b128 v[4:7], v252 offset:53760
    ds_read_b128 v[8:11], v252 offset:54784
    ds_read_b128 v[12:15], v252 offset:55808
    ds_read_b128 v[16:19], v252 offset:56832
    ds_read_b128 v[20:23], v252 offset:57856
    ds_read_b128 v[24:27], v252 offset:58880
    ds_read_b128 v[28:31], v252 offset:59904
    v_rcp_f32 v195, v195
    v_mul_f32 v204, v188, v204
    v_mul_f32 v205, v189, v205
    v_mul_f32 v206, v190, v206
    s_waitcnt lgkmcnt(10)
    v_smfmac_f32_32x32x32_bf16 v[88:103], v[180:183], v[188:195], v177
    v_mul_f32 v207, v191, v207
    v_mul_f32 v208, v192, v208
    v_mul_f32 v209, v193, v209
    v_mul_f32 v210, v194, v210
    v_mul_f32 v211, v195, v211
    s_nop 1
    v_smfmac_f32_32x32x32_bf16 v[104:119], v[180:183], v[204:211], v177
    v_exp_f32 v220, v220
    v_exp_f32 v221, v221
    v_exp_f32 v222, v222
    v_mfma_f32_32x32x16_bf16 v[204:219], v[152:155], v[48:51], 0
    ds_read_b128 v[152:155], v253 offset:0
    v_add_f32 v220, 1.0, v220
    v_exp_f32 v223, v223
    v_add_f32 v221, 1.0, v221
    v_mfma_f32_32x32x16_bf16 v[204:219], v[156:159], v[52:55], v[204:219]
    ds_read_b128 v[156:159], v253 offset:16
    v_exp_f32 v224, v224
    v_add_f32 v222, 1.0, v222
    v_rcp_f32 v220, v220
    v_mfma_f32_32x32x16_bf16 v[204:219], v[160:163], v[56:59], v[204:219]
    ds_read_b128 v[160:163], v253 offset:32
    v_exp_f32 v225, v225
    v_add_f32 v223, 1.0, v223
    v_rcp_f32 v221, v221
    v_mfma_f32_32x32x16_bf16 v[204:219], v[164:167], v[60:63], v[204:219]
    ds_read_b128 v[164:167], v253 offset:48
    v_exp_f32 v226, v226
    v_add_f32 v224, 1.0, v224
    v_rcp_f32 v222, v222
    v_exp_f32 v227, v227
    v_add_f32 v225, 1.0, v225
    v_rcp_f32 v223, v223
    v_add_f32 v226, 1.0, v226
    v_rcp_f32 v224, v224
    v_add_f32 v227, 1.0, v227
    v_rcp_f32 v225, v225
    v_rcp_f32 v226, v226
    v_rcp_f32 v227, v227
    v_mul_f32 v204, v220, v204
    v_mul_f32 v205, v221, v205
    v_mul_f32 v206, v222, v206
    v_smfmac_f32_32x32x32_bf16 v[120:135], v[180:183], v[220:227], v177
    v_mul_f32 v207, v223, v207
    v_mul_f32 v208, v224, v208
    v_mul_f32 v209, v225, v209
    v_mul_f32 v210, v226, v210
    v_mul_f32 v211, v227, v211
    s_nop 1
    v_smfmac_f32_32x32x32_bf16 v[136:151], v[180:183], v[204:211], v177
    s_branch K2_EPI2
K2_LG1:
    v_smfmac_f32_32x32x32_bf16 v[136:151], v[180:183], v[204:211], v177
    ds_read_u8 v236, v248 offset:0
    ds_read_u8 v237, v248 offset:16
    ds_read_u8 v238, v248 offset:64
    ds_read_u8 v239, v248 offset:80
    v_exp_f32 v188, v188
    v_smfmac_f32_32x32x32_bf16 v[136:151], v[184:187], v[212:219], v177
    v_lshlrev_b32 v252, 4, v254
    v_and_b32 v247, 31, v254
    v_and_b32 v245, 32, v254
    v_mul_u32_u24 v249, 144, v247
    v_lshrrev_b32 v251, 2, v245
    v_lshl_add_u32 v247, v247, 6, v251
    v_lshl_add_u32 v249, v245, 1, v249
    v_add_u32 v249, s74, v249
    v_lshrrev_b32 v251, 3, v254
    v_lshl_add_u32 v251, v251, 4, v252
    v_add_u32 v251, s70, v251
    v_exp_f32 v189, v189
    v_mfma_f32_32x32x16_bf16 v[220:235], v[168:171], v[68:71], 0
    v_exp_f32 v190, v190
    v_mfma_f32_32x32x16_bf16 v[204:219], v[152:155], v[32:35], 0
    v_add_f32 v188, 1.0, v188
    v_mfma_f32_32x32x16_bf16 v[204:219], v[156:159], v[36:39], v[204:219]
    s_waitcnt lgkmcnt(0)
    v_lshl_add_u32 v236, v236, 6, v246
    v_lshl_add_u32 v237, v237, 6, v246
    v_lshl_add_u32 v238, v238, 6, v246
    v_lshl_add_u32 v239, v239, 6, v246
    v_exp_f32 v191, v191
    v_smfmac_f32_32x32x32_bf16 v[220:235], v[172:175], v[80:87], v176
    ds_read_b64_tr_b16 v[180:181], v236
    ds_read_b64_tr_b16 v[182:183], v237
    ds_read_b64_tr_b16 v[184:185], v238
    ds_read_b64_tr_b16 v[186:187], v239
    v_add_f32 v189, 1.0, v189
    v_add_f32 v190, 1.0, v190
    v_mfma_f32_32x32x16_bf16 v[204:219], v[160:163], v[40:43], v[204:219]
    v_rcp_f32 v188, v188
    v_mfma_f32_32x32x16_bf16 v[204:219], v[164:167], v[44:47], v[204:219]
    v_add_f32 v191, 1.0, v191
    v_mfma_f32_32x32x16_bf16 v[220:235], v[152:155], v[16:19], v[220:235]
    v_rcp_f32 v189, v189
    v_mfma_f32_32x32x16_bf16 v[220:235], v[156:159], v[20:23], v[220:235]
    v_rcp_f32 v190, v190
    v_mfma_f32_32x32x16_bf16 v[220:235], v[160:163], v[24:27], v[220:235]
    v_rcp_f32 v191, v191
    v_mfma_f32_32x32x16_bf16 v[220:235], v[164:167], v[28:31], v[220:235]
    ds_read2_b64 v[64:67], v247 offset0:0 offset1:2
    ds_read2_b64 v[68:71], v247 offset0:4 offset1:6
    ds_read_b128 v[0:3], v252 offset:52736
    ds_read_b128 v[4:7], v252 offset:53760
    ds_read_b128 v[8:11], v252 offset:54784
    ds_read_b128 v[12:15], v252 offset:55808
    ds_read_b128 v[16:19], v252 offset:56832
    ds_read_b128 v[20:23], v252 offset:57856
    ds_read_b128 v[24:27], v252 offset:58880
    ds_read_b128 v[28:31], v252 offset:59904
    v_mul_f32 v204, v188, v204
    v_mul_f32 v205, v189, v205
    s_waitcnt lgkmcnt(10)
    v_smfmac_f32_32x32x32_bf16 v[88:103], v[180:183], v[188:195], v177
    v_mul_f32 v206, v190, v206
    v_mul_f32 v207, v191, v207
    s_nop 1
    v_smfmac_f32_32x32x32_bf16 v[104:119], v[180:183], v[204:211], v177
    v_exp_f32 v220, v220
    v_exp_f32 v221, v221
    v_mfma_f32_32x32x16_bf16 v[204:219], v[152:155], v[48:51], 0
    ds_read_b128 v[152:155], v253 offset:0
    v_exp_f32 v222, v222
    v_mfma_f32_32x32x16_bf16 v[204:219], v[156:159], v[52:55], v[204:219]
    ds_read_b128 v[156:159], v253 offset:16
    v_add_f32 v220, 1.0, v220
    v_exp_f32 v223, v223
    v_mfma_f32_32x32x16_bf16 v[204:219], v[160:163], v[56:59], v[204:219]
    ds_read_b128 v[160:163], v253 offset:32
    v_add_f32 v221, 1.0, v221
    v_mfma_f32_32x32x16_bf16 v[204:219], v[164:167], v[60:63], v[204:219]
    ds_read_b128 v[164:167], v253 offset:48
    v_add_f32 v222, 1.0, v222
    v_rcp_f32 v220, v220
    v_add_f32 v223, 1.0, v223
    v_rcp_f32 v221, v221
    v_rcp_f32 v222, v222
    v_rcp_f32 v223, v223
    s_nop 4
    v_mul_f32 v204, v220, v204
    v_mul_f32 v205, v221, v205
    v_smfmac_f32_32x32x32_bf16 v[120:135], v[180:183], v[220:227], v177
    v_mul_f32 v206, v222, v206
    v_mul_f32 v207, v223, v207
    s_nop 1
    v_smfmac_f32_32x32x32_bf16 v[136:151], v[180:183], v[204:211], v177
    s_branch K2_EPI2
K2_TAIL:
    v_smfmac_f32_32x32x32_bf16 v[136:151], v[180:183], v[204:211], v177
    v_smfmac_f32_32x32x32_bf16 v[136:151], v[184:187], v[212:219], v177
K2_DONE:
    s_cmp_lg_u32 s78, 0
    s_cbranch_scc1 K2_SLOW
K2_EPI:
    v_lshlrev_b32 v252, 4, v254
    v_and_b32 v247, 31, v254
    v_and_b32 v245, 32, v254
    v_mul_u32_u24 v249, 144, v247
    v_lshrrev_b32 v251, 2, v245
    v_lshl_add_u32 v247, v247, 6, v251
    v_lshl_add_u32 v249, v245, 1, v249
    v_add_u32 v249, s74, v249
    v_lshrrev_b32 v251, 3, v254
    v_lshl_add_u32 v251, v251, 4, v252
    v_add_u32 v251, s70, v251
    ds_read2_b64 v[64:67], v247 offset0:0 offset1:2
    ds_read2_b64 v[68:71], v247 offset0:4 offset1:6
    ds_read_b128 v[0:3], v252 offset:52736
    ds_read_b128 v[4:7], v252 offset:53760
    ds_read_b128 v[8:11], v252 offset:54784
    ds_read_b128 v[12:15], v252 offset:55808
    ds_read_b128 v[16:19], v252 offset:56832
    ds_read_b128 v[20:23], v252 offset:57856
    ds_read_b128 v[24:27], v252 offset:58880
    ds_read_b128 v[28:31], v252 offset:59904
    ds_read_b128 v[152:155], v253 offset:0
    ds_read_b128 v[156:159], v253 offset:16
    ds_read_b128 v[160:163], v253 offset:32
    ds_read_b128 v[164:167], v253 offset:48
K2_EPI2:
    s_nop 1
    v_rcp_f32 v88, v88
    v_rcp_f32 v89, v89
    v_rcp_f32 v90, v90
    v_rcp_f32 v91, v91
    v_rcp_f32 v92, v92
    v_rcp_f32 v93, v93
    v_rcp_f32 v94, v94
    v_rcp_f32 v95, v95
    s_waitcnt lgkmcnt(0)
    v_lshlrev_b32 v32, 16, v152
    v_and_b32 v33, 0xffff0000, v152
    v_lshlrev_b32 v34, 16, v153
    v_and_b32 v35, 0xffff0000, v153
    v_lshlrev_b32 v36, 16, v154
    v_and_b32 v37, 0xffff0000, v154
    v_lshlrev_b32 v38, 16, v155
    v_and_b32 v39, 0xffff0000, v155
    v_lshlrev_b32 v40, 16, v156
    v_and_b32 v41, 0xffff0000, v156
    v_lshlrev_b32 v42, 16, v157
    v_and_b32 v43, 0xffff0000, v157
    v_lshlrev_b32 v44, 16, v158
    v_and_b32 v45, 0xffff0000, v158
    v_lshlrev_b32 v46, 16, v159
    v_and_b32 v47, 0xffff0000, v159
    v_rcp_f32 v96, v96
    v_rcp_f32 v97, v97
    v_mfma_f32_32x32x16_bf16 v[188:203], v[0:3], v[152:155], v[32:47]
    v_rcp_f32 v98, v98
    v_rcp_f32 v99, v99
    v_rcp_f32 v100, v100
    v_rcp_f32 v101, v101
    v_rcp_f32 v102, v102
    v_rcp_f32 v103, v103
    v_lshlrev_b32 v48, 16, v160
    v_mfma_f32_32x32x16_bf16 v[188:203], v[4:7], v[156:159], v[188:203]
    v_and_b32 v49, 0xffff0000, v160
    v_lshlrev_b32 v50, 16, v161
    v_and_b32 v51, 0xffff0000, v161
    v_lshlrev_b32 v52, 16, v162
    v_and_b32 v53, 0xffff0000, v162
    v_lshlrev_b32 v54, 16, v163
    v_and_b32 v55, 0xffff0000, v163
    v_mfma_f32_32x32x16_bf16 v[188:203], v[8:11], v[160:163], v[188:203]
    v_lshlrev_b32 v56, 16, v164
    v_and_b32 v57, 0xffff0000, v164
    v_lshlrev_b32 v58, 16, v165
    v_and_b32 v59, 0xffff0000, v165
    v_lshlrev_b32 v60, 16, v166
    v_and_b32 v61, 0xffff0000, v166
    v_lshlrev_b32 v62, 16, v167
    v_mfma_f32_32x32x16_bf16 v[188:203], v[12:15], v[164:167], v[188:203]
    v_and_b32 v63, 0xffff0000, v167
    v_mul_f32 v104, v104, v88
    v_mul_f32 v105, v105, v89
    v_mul_f32 v106, v106, v90
    v_mul_f32 v107, v107, v91
    v_mul_f32 v108, v108, v92
    v_mul_f32 v109, v109, v93
    v_mfma_f32_32x32x16_bf16 v[72:87], v[16:19], v[152:155], v[48:63]
    v_mul_f32 v110, v110, v94
    v_mul_f32 v111, v111, v95
    v_mul_f32 v112, v112, v96
    v_mul_f32 v113, v113, v97
    v_mul_f32 v114, v114, v98
    v_mul_f32 v115, v115, v99
    v_mfma_f32_32x32x16_bf16 v[72:87], v[20:23], v[156:159], v[72:87]
    v_mul_f32 v116, v116, v100
    v_mul_f32 v117, v117, v101
    v_mul_f32 v118, v118, v102
    v_mul_f32 v119, v119, v103
    v_cvt_pk_bf16_f32 v88, v104, v105
    v_cvt_pk_bf16_f32 v89, v106, v107
    v_mfma_f32_32x32x16_bf16 v[72:87], v[24:27], v[160:163], v[72:87]
    v_cvt_pk_bf16_f32 v90, v108, v109
    v_cvt_pk_bf16_f32 v91, v110, v111
    v_cvt_pk_bf16_f32 v92, v112, v113
    v_cvt_pk_bf16_f32 v93, v114, v115
    v_cvt_pk_bf16_f32 v94, v116, v117
    v_cvt_pk_bf16_f32 v95, v118, v119
    v_mfma_f32_32x32x16_bf16 v[72:87], v[28:31], v[164:167], v[72:87]
    v_rcp_f32 v120, v120
    v_rcp_f32 v121, v121
    v_rcp_f32 v122, v122
    v_rcp_f32 v123, v123
    v_rcp_f32 v124, v124
    v_rcp_f32 v125, v125
    v_mfma_f32_32x32x16_bf16 v[188:203], v[88:91], v[64:67], v[188:203]
    v_rcp_f32 v126, v126
    v_rcp_f32 v127, v127
    v_rcp_f32 v128, v128
    v_rcp_f32 v129, v129
    v_rcp_f32 v130, v130
    v_mfma_f32_32x32x16_bf16 v[188:203], v[92:95], v[68:71], v[188:203]
    v_rcp_f32 v131, v131
    v_rcp_f32 v132, v132
    v_rcp_f32 v133, v133
    v_rcp_f32 v134, v134
    v_rcp_f32 v135, v135
    v_mul_f32 v136, v136, v120
    v_mul_f32 v137, v137, v121
    v_mul_f32 v138, v138, v122
    v_mul_f32 v139, v139, v123
    v_mul_f32 v140, v140, v124
    v_mul_f32 v141, v141, v125
    v_mul_f32 v142, v142, v126
    v_mul_f32 v143, v143, v127
    v_mul_f32 v144, v144, v128
    v_mul_f32 v145, v145, v129
    v_mul_f32 v146, v146, v130
    v_mul_f32 v147, v147, v131
    v_mul_f32 v148, v148, v132
    v_mul_f32 v149, v149, v133
    v_mul_f32 v150, v150, v134
    v_mul_f32 v151, v151, v135
    v_cvt_pk_bf16_f32 v120, v136, v137
    v_cvt_pk_bf16_f32 v121, v138, v139
    v_cvt_pk_bf16_f32 v122, v140, v141
    v_cvt_pk_bf16_f32 v123, v142, v143
    v_cvt_pk_bf16_f32 v124, v144, v145
    v_cvt_pk_bf16_f32 v125, v146, v147
    v_cvt_pk_bf16_f32 v126, v148, v149
    v_cvt_pk_bf16_f32 v127, v150, v151
    v_mfma_f32_32x32x16_bf16 v[72:87], v[120:123], v[64:67], v[72:87]
    s_nop 0
    v_mfma_f32_32x32x16_bf16 v[72:87], v[124:127], v[68:71], v[72:87]
    v_max_f32 v188, v188, v32
    v_max_f32 v189, v189, v33
    v_max_f32 v190, v190, v34
    v_max_f32 v191, v191, v35
    v_max_f32 v192, v192, v36
    v_max_f32 v193, v193, v37
    v_max_f32 v194, v194, v38
    v_max_f32 v195, v195, v39
    v_cvt_pk_bf16_f32 v220, v188, v189
    v_cvt_pk_bf16_f32 v221, v190, v191
    v_cvt_pk_bf16_f32 v222, v192, v193
    v_cvt_pk_bf16_f32 v223, v194, v195
    ds_write_b128 v249, v[220:223] offset:0
    v_max_f32 v196, v196, v40
    v_max_f32 v197, v197, v41
    v_max_f32 v198, v198, v42
    v_max_f32 v199, v199, v43
    v_max_f32 v200, v200, v44
    v_max_f32 v201, v201, v45
    v_max_f32 v202, v202, v46
    v_max_f32 v203, v203, v47
    v_cvt_pk_bf16_f32 v224, v196, v197
    v_cvt_pk_bf16_f32 v225, v198, v199
    v_cvt_pk_bf16_f32 v226, v200, v201
    v_cvt_pk_bf16_f32 v227, v202, v203
    ds_write_b128 v249, v[224:227] offset:16
    v_max_f32 v72, v72, v48
    v_max_f32 v73, v73, v49
    v_max_f32 v74, v74, v50
    v_max_f32 v75, v75, v51
    v_max_f32 v76, v76, v52
    v_max_f32 v77, v77, v53
    v_max_f32 v78, v78, v54
    v_max_f32 v79, v79, v55
    v_cvt_pk_bf16_f32 v228, v72, v73
    v_cvt_pk_bf16_f32 v229, v74, v75
    v_cvt_pk_bf16_f32 v230, v76, v77
    v_cvt_pk_bf16_f32 v231, v78, v79
    ds_write_b128 v249, v[228:231] offset:32
    v_max_f32 v80, v80, v56
    v_max_f32 v81, v81, v57
    v_max_f32 v82, v82, v58
    v_max_f32 v83, v83, v59
    v_max_f32 v84, v84, v60
    v_max_f32 v85, v85, v61
    v_max_f32 v86, v86, v62
    v_max_f32 v87, v87, v63
    v_cvt_pk_bf16_f32 v232, v80, v81
    v_cvt_pk_bf16_f32 v233, v82, v83
    v_cvt_pk_bf16_f32 v234, v84, v85
    v_cvt_pk_bf16_f32 v235, v86, v87
    ds_write_b128 v249, v[232:235] offset:48
    ds_read_b128 v[152:155], v251 offset:0
    ds_read_b128 v[156:159], v251 offset:1152
    ds_read_b128 v[160:163], v251 offset:2304
    ds_read_b128 v[164:167], v251 offset:3456
    s_waitcnt lgkmcnt(3)
    buffer_store_dwordx4 v[152:155], v252, s[28:31], 0 offen offset:0 sc1
    s_waitcnt lgkmcnt(2)
    buffer_store_dwordx4 v[156:159], v252, s[28:31], 0 offen offset:1024 sc1
    s_waitcnt lgkmcnt(1)
    buffer_store_dwordx4 v[160:163], v252, s[28:31], 0 offen offset:2048 sc1
    s_waitcnt lgkmcnt(0)
    buffer_store_dwordx4 v[164:167], v252, s[28:31], 0 offen offset:3072 sc1
    s_add_u32 s10, s2, s7
    s_cmp_lg_u32 s10, 0
    s_cbranch_scc1 K2_NOEP
    v_mov_b32 v188, 24117248
    v_mov_b32 v189, s100
    buffer_store_dword v189, v188, s[24:27], 0 offen sc1
K2_NOEP:
K2_END:
    s_endpgm
K2_RETRY0:
    s_sub_u32 s101, s101, 1
    s_cbranch_scc1 K2_END
    s_waitcnt vmcnt(0)
    v_bitop3_b32 v188, v91, s36, v214 bitop3:0x28
    s_nop 1
    v_or_b32_dpp v188, v188, v188 quad_perm:[1,0,3,2] row_mask:0xf bank_mask:0xf
    s_nop 1
    v_or_b32_dpp v188, v188, v188 quad_perm:[2,3,0,1] row_mask:0xf bank_mask:0xf
    s_nop 1
    v_or_b32_dpp v188, v188, v188 row_half_mirror row_mask:0xf bank_mask:0xf
    v_cmp_ne_u32 vcc, 0, v188
    s_and_b64 exec, exec, vcc
    s_cbranch_execz K2_RT00
    buffer_load_dwordx4 v[88:91], v189, s[32:35], 0 offen sc1
K2_RT00:
    s_mov_b64 exec, -1
    v_bitop3_b32 v188, v95, s36, v214 bitop3:0x28
    s_nop 1
    v_or_b32_dpp v188, v188, v188 quad_perm:[1,0,3,2] row_mask:0xf bank_mask:0xf
    s_nop 1
    v_or_b32_dpp v188, v188, v188 quad_perm:[2,3,0,1] row_mask:0xf bank_mask:0xf
    s_nop 1
    v_or_b32_dpp v188, v188, v188 row_half_mirror row_mask:0xf bank_mask:0xf
    v_cmp_ne_u32 vcc, 0, v188
    s_and_b64 exec, exec, vcc
    s_cbranch_execz K2_RT01
    buffer_load_dwordx4 v[92:95], v189, s[32:35], s79 offen sc1
K2_RT01:
    s_mov_b64 exec, -1
    v_bitop3_b32 v188, v99, s36, v214 bitop3:0x28
    s_nop 1
    v_or_b32_dpp v188, v188, v188 quad_perm:[1,0,3,2] row_mask:0xf bank_mask:0xf
    s_nop 1
    v_or_b32_dpp v188, v188, v188 quad_perm:[2,3,0,1] row_mask:0xf bank_mask:0xf
    s_nop 1
    v_or_b32_dpp v188, v188, v188 row_half_mirror row_mask:0xf bank_mask:0xf
    v_cmp_ne_u32 vcc, 0, v188
    s_and_b64 exec, exec, vcc
    s_cbranch_execz K2_RT02
    buffer_load_dwordx4 v[96:99], v189, s[32:35], s80 offen sc1
K2_RT02:
    s_mov_b64 exec, -1
    v_bitop3_b32 v188, v103, s36, v214 bitop3:0x28
    s_nop 1
    v_or_b32_dpp v188, v188, v188 quad_perm:[1,0,3,2] row_mask:0xf bank_mask:0xf
    s_nop 1
    v_or_b32_dpp v188, v188, v188 quad_perm:[2,3,0,1] row_mask:0xf bank_mask:0xf
    s_nop 1
    v_or_b32_dpp v188, v188, v188 row_half_mirror row_mask:0xf bank_mask:0xf
    v_cmp_ne_u32 vcc, 0, v188
    s_and_b64 exec, exec, vcc
    s_cbranch_execz K2_RT03
    buffer_load_dwordx4 v[100:103], v189, s[32:35], s81 offen sc1
K2_RT03:
    s_mov_b64 exec, -1
    s_waitcnt vmcnt(0)
    s_branch K2_CHK0
K2_RETRY1:
    s_sub_u32 s101, s101, 1
    s_cbranch_scc1 K2_END
    s_waitcnt vmcnt(0)
    v_bitop3_b32 v188, v95, s36, v214 bitop3:0x28
    s_nop 1
    v_or_b32_dpp v188, v188, v188 quad_perm:[1,0,3,2] row_mask:0xf bank_mask:0xf
    s_nop 1
    v_or_b32_dpp v188, v188, v188 quad_perm:[2,3,0,1] row_mask:0xf bank_mask:0xf
    s_nop 1
    v_or_b32_dpp v188, v188, v188 row_half_mirror row_mask:0xf bank_mask:0xf
    v_cmp_ne_u32 vcc, 0, v188
    s_and_b64 exec, exec, vcc
    s_cbranch_execz K2_RT11
    buffer_load_dwordx4 v[92:95], v189, s[32:35], s79 offen sc1
K2_RT11:
    s_mov_b64 exec, -1
    v_bitop3_b32 v188, v99, s36, v214 bitop3:0x28
    s_nop 1
    v_or_b32_dpp v188, v188, v188 quad_perm:[1,0,3,2] row_mask:0xf bank_mask:0xf
    s_nop 1
    v_or_b32_dpp v188, v188, v188 quad_perm:[2,3,0,1] row_mask:0xf bank_mask:0xf
    s_nop 1
    v_or_b32_dpp v188, v188, v188 row_half_mirror row_mask:0xf bank_mask:0xf
    v_cmp_ne_u32 vcc, 0, v188
    s_and_b64 exec, exec, vcc
    s_cbranch_execz K2_RT12
    buffer_load_dwordx4 v[96:99], v189, s[32:35], s80 offen sc1
K2_RT12:
    s_mov_b64 exec, -1
    v_bitop3_b32 v188, v103, s36, v214 bitop3:0x28
    s_nop 1
    v_or_b32_dpp v188, v188, v188 quad_perm:[1,0,3,2] row_mask:0xf bank_mask:0xf
    s_nop 1
    v_or_b32_dpp v188, v188, v188 quad_perm:[2,3,0,1] row_mask:0xf bank_mask:0xf
    s_nop 1
    v_or_b32_dpp v188, v188, v188 row_half_mirror row_mask:0xf bank_mask:0xf
    v_cmp_ne_u32 vcc, 0, v188
    s_and_b64 exec, exec, vcc
    s_cbranch_execz K2_RT13
    buffer_load_dwordx4 v[100:103], v189, s[32:35], s81 offen sc1
K2_RT13:
    s_mov_b64 exec, -1
    s_waitcnt vmcnt(0)
    s_branch K2_CHK1
K2_RETRY2:
    s_sub_u32 s101, s101, 1
    s_cbranch_scc1 K2_END
    s_waitcnt vmcnt(0)
    v_bitop3_b32 v188, v99, s36, v214 bitop3:0x28
    s_nop 1
    v_or_b32_dpp v188, v188, v188 quad_perm:[1,0,3,2] row_mask:0xf bank_mask:0xf
    s_nop 1
    v_or_b32_dpp v188, v188, v188 quad_perm:[2,3,0,1] row_mask:0xf bank_mask:0xf
    s_nop 1
    v_or_b32_dpp v188, v188, v188 row_half_mirror row_mask:0xf bank_mask:0xf
    v_cmp_ne_u32 vcc, 0, v188
    s_and_b64 exec, exec, vcc
    s_cbranch_execz K2_RT22
    buffer_load_dwordx4 v[96:99], v189, s[32:35], s80 offen sc1
K2_RT22:
    s_mov_b64 exec, -1
    v_bitop3_b32 v188, v103, s36, v214 bitop3:0x28
    s_nop 1
    v_or_b32_dpp v188, v188, v188 quad_perm:[1,0,3,2] row_mask:0xf bank_mask:0xf
    s_nop 1
    v_or_b32_dpp v188, v188, v188 quad_perm:[2,3,0,1] row_mask:0xf bank_mask:0xf
    s_nop 1
    v_or_b32_dpp v188, v188, v188 row_half_mirror row_mask:0xf bank_mask:0xf
    v_cmp_ne_u32 vcc, 0, v188
    s_and_b64 exec, exec, vcc
    s_cbranch_execz K2_RT23
    buffer_load_dwordx4 v[100:103], v189, s[32:35], s81 offen sc1
K2_RT23:
    s_mov_b64 exec, -1
    s_waitcnt vmcnt(0)
    s_branch K2_CHK2
K2_RETRY3:
    s_sub_u32 s101, s101, 1
    s_cbranch_scc1 K2_END
    s_waitcnt vmcnt(0)
    v_bitop3_b32 v188, v103, s36, v214 bitop3:0x28
    s_nop 1
    v_or_b32_dpp v188, v188, v188 quad_perm:[1,0,3,2] row_mask:0xf bank_mask:0xf
    s_nop 1
    v_or_b32_dpp v188, v188, v188 quad_perm:[2,3,0,1] row_mask:0xf bank_mask:0xf
    s_nop 1
    v_or_b32_dpp v188, v188, v188 row_half_mirror row_mask:0xf bank_mask:0xf
    v_cmp_ne_u32 vcc, 0, v188
    s_and_b64 exec, exec, vcc
    s_cbranch_execz K2_RT33
    buffer_load_dwordx4 v[100:103], v189, s[32:35], s81 offen sc1
K2_RT33:
    s_mov_b64 exec, -1
    s_waitcnt vmcnt(0)
    s_branch K2_CHK3
K1_EXT:
    s_mov_b32 s14, 0x0f0f0f0f
    s_mov_b32 s15, s14
    ds_read_b32 v104, v6 offset:32
    ds_read_b128 v[8:11], v3 offset:128
    ds_read_b32 v105, v6 offset:3360
    ds_read_b128 v[16:19], v3 offset:13440
    ds_read_b32 v106, v6 offset:6688
    ds_read_b128 v[24:27], v3 offset:26752
    ds_read_b32 v107, v6 offset:10016
    ds_read_b128 v[32:35], v3 offset:40064
    s_waitcnt lgkmcnt(0)
    v_cmp_le_u32 vcc, 553648128, v108
    v_and_or_b32 v11, v104, v15, v108
    s_and_b64 exec, vcc, s[14:15]
    s_cbranch_execz K1_EX0
    buffer_store_dwordx4 v[8:11], v4, s[32:35], s10 offen sc1
K1_EX0:
    s_mov_b64 exec, -1
    s_add_u32 s10, s10, 2105344
    v_cmp_le_u32 vcc, 553648128, v109
    v_and_or_b32 v19, v105, v15, v109
    s_and_b64 exec, vcc, s[14:15]
    s_cbranch_execz K1_EX1
    buffer_store_dwordx4 v[16:19], v4, s[32:35], s10 offen sc1
K1_EX1:
    s_mov_b64 exec, -1
    s_add_u32 s10, s10, 2105344
    v_cmp_le_u32 vcc, 553648128, v110
    v_and_or_b32 v27, v106, v15, v110
    s_and_b64 exec, vcc, s[14:15]
    s_cbranch_execz K1_EX2
    buffer_store_dwordx4 v[24:27], v4, s[32:35], s10 offen sc1
K1_EX2:
    s_mov_b64 exec, -1
    s_add_u32 s10, s10, 2105344
    v_cmp_le_u32 vcc, 553648128, v111
    v_and_or_b32 v35, v107, v15, v111
    s_and_b64 exec, vcc, s[14:15]
    s_cbranch_execz K1_EX3
    buffer_store_dwordx4 v[32:35], v4, s[32:35], s10 offen sc1
K1_EX3:
    s_mov_b64 exec, -1
    s_add_u32 s10, s10, 2105344
    s_branch K1_EXTR
K1_OVF:
    v_lshrrev_b32 v72, 16, v112
    v_lshrrev_b32 v76, 18, v112
    v_sub_u32 v72, v72, v76
    v_lshrrev_b32 v73, 16, v113
    v_lshrrev_b32 v76, 18, v113
    v_sub_u32 v73, v73, v76
    v_lshrrev_b32 v74, 16, v114
    v_lshrrev_b32 v76, 18, v114
    v_sub_u32 v74, v74, v76
    v_lshrrev_b32 v75, 16, v115
    v_lshrrev_b32 v76, 18, v115
    v_sub_u32 v75, v75, v76
    v_add_u32 v77, v72, v73
    v_add_u32 v78, v77, v74
    v_add_u32 v79, v78, v75
    v_mov_b32 v1, v79
    s_nop 1
    v_add_u32_dpp v1, v1, v1 row_shr:1 row_mask:0xf bank_mask:0xf bound_ctrl:0
    s_nop 1
    v_add_u32_dpp v1, v1, v1 row_shr:2 row_mask:0xf bank_mask:0xf bound_ctrl:0
    s_nop 1
    v_add_u32_dpp v1, v1, v1 row_shr:4 row_mask:0xf bank_mask:0xf bound_ctrl:0
    s_nop 1
    v_add_u32_dpp v1, v1, v1 row_shr:8 row_mask:0xf bank_mask:0xf bound_ctrl:0
    s_nop 1
    v_add_u32_dpp v1, v1, v1 row_bcast:15 row_mask:0xa bank_mask:0xf
    s_nop 1
    v_add_u32_dpp v1, v1, v1 row_bcast:31 row_mask:0xc bank_mask:0xf
    s_nop 0
    v_sub_u32 v76, v1, v79
    v_add_u32 v79, v76, v78
    v_add_u32 v78, v76, v77
    v_add_u32 v77, v76, v72
    v_lshl_or_b32 v76, v72, 16, v76
    v_lshl_or_b32 v77, v73, 16, v77
    v_lshl_or_b32 v78, v74, 16, v78
    v_lshl_or_b32 v79, v75, 16, v79
    s_waitcnt lgkmcnt(0)
    ds_write_b128 v172, v[76:79] offset:52736
    v_min_u32 v108, 255, v108
    v_min_u32 v109, 255, v109
    v_min_u32 v110, 255, v110
    v_min_u32 v111, 255, v111
    s_lshl_b32 s15, s12, 2
    s_add_u32 s15, s15, 23068672
    s_add_u32 s64, s8, s15
    s_addc_u32 s65, s9, 0
    s_mov_b32 s66, 262144
    s_mov_b32 s67, 0x20000
    v_lshlrev_b32 v1, 12, v254
    buffer_store_dword v76, v1, s[64:67], 0 offen offset:0 sc1
    buffer_store_dword v77, v1, s[64:67], 0 offen offset:1024 sc1
    buffer_store_dword v78, v1, s[64:67], 0 offen offset:2048 sc1
    buffer_store_dword v79, v1, s[64:67], 0 offen offset:3072 sc1
    s_add_u32 s15, s13, 17825792
    s_add_u32 s64, s8, s15
    s_addc_u32 s65, s9, 0
    s_mov_b32 s66, 12500
    s_mov_b32 s67, 0x20000
    s_lshr_b32 s15, s13, 2
    s_add_u32 s15, s15, 22020096
    s_add_u32 s68, s8, s15
    s_addc_u32 s69, s9, 0
    s_mov_b32 s70, 3125
    s_mov_b32 s71, 0x20000
    v_cndmask_b32 v30, v24, v30, s[78:79]
    v_cndmask_b32 v38, 0, v38, s[78:79]
    ds_read_u16 v40, v24 offset:50736
    ds_read_u16 v41, v25 offset:50736
    ds_read_u16 v42, v26 offset:50736
    ds_read_u16 v43, v27 offset:50736
    ds_read_u16 v44, v28 offset:50736
    ds_read_u16 v45, v29 offset:50736
    ds_read_u16 v46, v30 offset:50736
    s_waitcnt lgkmcnt(0)
    v_lshrrev_b32 v1, 2, v32
    v_sub_u32 v1, v32, v1
    v_add_u32 v40, v40, v1
    v_cmp_le_u32 vcc, 48, v32
    v_lshlrev_b32 v48, 2, v40
    s_and_saveexec_b64 s[14:15], vcc
    s_cbranch_execz K1_OV3_0
    buffer_store_byte v23, v40, s[68:71], 0 offen sc1
    buffer_store_dword v16, v48, s[64:67], 0 offen sc1
K1_OV3_0:
    s_mov_b64 exec, -1
    v_lshrrev_b32 v1, 2, v33
    v_sub_u32 v1, v33, v1
    v_add_u32 v41, v41, v1
    v_cmp_le_u32 vcc, 48, v33
    v_lshlrev_b32 v49, 2, v41
    s_and_saveexec_b64 s[14:15], vcc
    s_cbranch_execz K1_OV3_1
    buffer_store_byte v23, v41, s[68:71], 0 offen sc1
    buffer_store_dword v17, v49, s[64:67], 0 offen sc1
K1_OV3_1:
    s_mov_b64 exec, -1
    v_lshrrev_b32 v1, 2, v34
    v_sub_u32 v1, v34, v1
    v_add_u32 v42, v42, v1
    v_cmp_le_u32 vcc, 48, v34
    v_lshlrev_b32 v50, 2, v42
    s_and_saveexec_b64 s[14:15], vcc
    s_cbranch_execz K1_OV3_2
    buffer_store_byte v23, v42, s[68:71], 0 offen sc1
    buffer_store_dword v18, v50, s[64:67], 0 offen sc1
K1_OV3_2:
    s_mov_b64 exec, -1
    v_lshrrev_b32 v1, 2, v35
    v_sub_u32 v1, v35, v1
    v_add_u32 v43, v43, v1
    v_cmp_le_u32 vcc, 48, v35
    v_lshlrev_b32 v51, 2, v43
    s_and_saveexec_b64 s[14:15], vcc
    s_cbranch_execz K1_OV3_3
    buffer_store_byte v23, v43, s[68:71], 0 offen sc1
    buffer_store_dword v19, v51, s[64:67], 0 offen sc1
K1_OV3_3:
    s_mov_b64 exec, -1
    v_lshrrev_b32 v1, 2, v36
    v_sub_u32 v1, v36, v1
    v_add_u32 v44, v44, v1
    v_cmp_le_u32 vcc, 48, v36
    v_lshlrev_b32 v52, 2, v44
    s_and_saveexec_b64 s[14:15], vcc
    s_cbranch_execz K1_OV3_4
    buffer_store_byte v31, v44, s[68:71], 0 offen sc1
    buffer_store_dword v20, v52, s[64:67], 0 offen sc1
K1_OV3_4:
    s_mov_b64 exec, -1
    v_lshrrev_b32 v1, 2, v37
    v_sub_u32 v1, v37, v1
    v_add_u32 v45, v45, v1
    v_cmp_le_u32 vcc, 48, v37
    v_lshlrev_b32 v53, 2, v45
    s_and_saveexec_b64 s[14:15], vcc
    s_cbranch_execz K1_OV3_5
    buffer_store_byte v31, v45, s[68:71], 0 offen sc1
    buffer_store_dword v21, v53, s[64:67], 0 offen sc1
K1_OV3_5:
    s_mov_b64 exec, -1
    v_lshrrev_b32 v1, 2, v38
    v_sub_u32 v1, v38, v1
    v_add_u32 v46, v46, v1
    v_cmp_le_u32 vcc, 48, v38
    v_lshlrev_b32 v54, 2, v46
    s_and_saveexec_b64 s[14:15], vcc
    s_cbranch_execz K1_OV3_6
    buffer_store_byte v39, v46, s[68:71], 0 offen sc1
    buffer_store_dword v22, v54, s[64:67], 0 offen sc1
K1_OV3_6:
    s_mov_b64 exec, -1
    s_waitcnt vmcnt(0)
    s_barrier
    s_branch K1_OUT
K2_XT1:
    s_mov_b32 s97, 1
    v_cmp_le_u32 vcc, 822083584, v188
    v_mov_b32 v166, 2180
    s_cbranch_vccz K2_XT1A
    ds_write_b32 v166, v171
K2_XT1A:
    s_mov_b32 s10, 0xf0f0f0f0
    s_mov_b32 s11, s10
    v_and_b32 v166, 12, v168
    v_add_u32 v166, 32, v166
    v_and_b32 v164, 64, v189
    v_mul_u32_u24 v164, 127, v164
    v_add_u32 v164, v164, v189
    v_add_u32 v165, 16384, v164
    v_mov_b32 v167, 0x7ffffff0
    v_cndmask_b32 v204, v91, v95, s[10:11]
    v_cndmask_b32 v206, v208, v209, s[10:11]
    v_cmp_le_u32 vcc, 553648128, v204
    v_sub_u32_sdwa v204, v204, v166 dst_sel:DWORD dst_unused:UNUSED_PAD src0_sel:BYTE_3 src1_sel:DWORD
    s_nop 0
    v_cndmask_b32 v164, v167, v164, vcc
    v_cndmask_b32 v205, v99, v103, s[10:11]
    v_cndmask_b32 v207, v210, v211, s[10:11]
    v_cmp_le_u32 vcc, 553648128, v205
    v_sub_u32_sdwa v205, v205, v166 dst_sel:DWORD dst_unused:UNUSED_PAD src0_sel:BYTE_3 src1_sel:DWORD
    s_nop 0
    v_cndmask_b32 v165, v167, v165, vcc
    s_add_u32 s32, s32, 8421376
    s_addc_u32 s33, s33, 0
    buffer_load_dwordx4 v[132:135], v164, s[32:35], 0 offen sc1
    buffer_load_dwordx4 v[136:139], v165, s[32:35], 0 offen sc1
    v_med3_i32 v166, v204, 0, 3
    v_med3_i32 v167, v205, 0, 3
    v_add_u32 v166, v166, v167
    v_mov_b32 v167, 2176
    v_cmpx_lt_u32 vcc, 0, v166
    ds_add_u32 v167, v166
    s_mov_b64 exec, -1
    s_branch K2_XT1R
K2_XT2:
K2_XVa:
    s_mov_b64 s[10:11], 0
    v_bitop3_b32 v166, v135, s36, v214 bitop3:0x28
    v_cmp_ne_u32 s[86:87], 0, v166
    v_cmp_gt_u32 vcc, 0x7ffffff0, v164
    s_and_b64 vcc, vcc, s[86:87]
    s_or_b64 s[10:11], s[10:11], vcc
    v_bitop3_b32 v166, v139, s36, v214 bitop3:0x28
    v_cmp_ne_u32 s[86:87], 0, v166
    v_cmp_gt_u32 vcc, 0x7ffffff0, v165
    s_and_b64 vcc, vcc, s[86:87]
    s_or_b64 s[10:11], s[10:11], vcc
    s_cbranch_scc0 K2_XWa
    s_sub_u32 s101, s101, 1
    s_cbranch_scc1 K2_END
    buffer_load_dwordx4 v[132:135], v164, s[32:35], 0 offen sc1
    buffer_load_dwordx4 v[136:139], v165, s[32:35], 0 offen sc1
    s_waitcnt vmcnt(0)
    s_branch K2_XVa
K2_XWa:
    v_and_b32 v140, 255, v132
    v_lshlrev_b32 v140, 2, v140
    ds_read_b32 v140, v140 offset:6400
    v_and_b32 v141, 255, v133
    v_lshlrev_b32 v141, 2, v141
    ds_read_b32 v141, v141 offset:6400
    v_and_b32 v142, 255, v134
    v_lshlrev_b32 v142, 2, v142
    ds_read_b32 v142, v142 offset:6400
    v_and_b32 v135, 0x0f0f0f, v135
    v_and_b32 v143, 255, v136
    v_lshlrev_b32 v143, 2, v143
    ds_read_b32 v143, v143 offset:6400
    v_and_b32 v144, 255, v137
    v_lshlrev_b32 v144, 2, v144
    ds_read_b32 v144, v144 offset:6400
    v_and_b32 v145, 255, v138
    v_lshlrev_b32 v145, 2, v145
    ds_read_b32 v145, v145 offset:6400
    v_and_b32 v139, 0x0f0f0f, v139
    s_waitcnt lgkmcnt(0)
    v_perm_b32 v146, v135, v132, s64
    v_lshl_add_u32 v146, v146, 5, v206
    v_cmpx_lt_i32 vcc, 0, v204
    ds_add_rtn_u32 v140, v140, v171 offset:2112
    s_mov_b64 exec, -1
    v_perm_b32 v147, v135, v133, s65
    v_lshl_add_u32 v147, v147, 5, v206
    v_cmpx_lt_i32 vcc, 1, v204
    ds_add_rtn_u32 v141, v141, v171 offset:2112
    s_mov_b64 exec, -1
    v_perm_b32 v148, v135, v134, s66
    v_lshl_add_u32 v148, v148, 5, v206
    v_cmpx_lt_i32 vcc, 2, v204
    ds_add_rtn_u32 v142, v142, v171 offset:2112
    s_mov_b64 exec, -1
    v_perm_b32 v149, v139, v136, s64
    v_lshl_add_u32 v149, v149, 5, v207
    v_cmpx_lt_i32 vcc, 0, v205
    ds_add_rtn_u32 v143, v143, v171 offset:2112
    s_mov_b64 exec, -1
    v_perm_b32 v150, v139, v137, s65
    v_lshl_add_u32 v150, v150, 5, v207
    v_cmpx_lt_i32 vcc, 1, v205
    ds_add_rtn_u32 v144, v144, v171 offset:2112
    s_mov_b64 exec, -1
    v_perm_b32 v151, v139, v138, s66
    v_lshl_add_u32 v151, v151, 5, v207
    v_cmpx_lt_i32 vcc, 2, v205
    ds_add_rtn_u32 v145, v145, v171 offset:2112
    s_mov_b64 exec, -1
    s_waitcnt lgkmcnt(0)
    v_cmpx_lt_i32 vcc, 0, v204
    ds_write2st64_b32 v140, v132, v146 offset0:0 offset1:84
    s_mov_b64 exec, -1
    v_cmpx_lt_i32 vcc, 1, v204
    ds_write2st64_b32 v141, v133, v147 offset0:0 offset1:84
    s_mov_b64 exec, -1
    v_cmpx_lt_i32 vcc, 2, v204
    ds_write2st64_b32 v142, v134, v148 offset0:0 offset1:84
    s_mov_b64 exec, -1
    v_cmpx_lt_i32 vcc, 0, v205
    ds_write2st64_b32 v143, v136, v149 offset0:0 offset1:84
    s_mov_b64 exec, -1
    v_cmpx_lt_i32 vcc, 1, v205
    ds_write2st64_b32 v144, v137, v150 offset0:0 offset1:84
    s_mov_b64 exec, -1
    v_cmpx_lt_i32 vcc, 2, v205
    ds_write2st64_b32 v145, v138, v151 offset0:0 offset1:84
    s_mov_b64 exec, -1
    s_waitcnt lgkmcnt(0)
    s_branch K2_XT2R
K2_OVF:
    s_mov_b32 s80, 1
    s_mov_b32 s83, 0
    s_mov_b32 s77, 0
    s_mov_b32 s15, s76
    v_mov_b32 v190, 0xffff0000
    v_or_b32 v189, s39, v190
    v_mov_b32 v190, 0x7fffff00
    v_lshl_add_u32 v188, v254, 2, s15
    s_sub_u32 s73, s15, s76
    ds_write2st64_b32 v188, v189, v190 offset0:0 offset1:84
    ds_write2st64_b32 v188, v189, v190 offset0:1 offset1:85
    s_add_u32 s73, s73, 127
    s_lshr_b32 s73, s73, 7
    s_sub_i32 s38, s73, 1
    s_cmp_eq_u32 s97, 0
    s_cbranch_scc1 K2_PADS0
    s_mov_b32 s97, 0
    s_waitcnt vmcnt(0)
K2_XVb:
    s_mov_b64 s[10:11], 0
    v_bitop3_b32 v166, v135, s36, v214 bitop3:0x28
    v_cmp_ne_u32 s[86:87], 0, v166
    v_cmp_gt_u32 vcc, 0x7ffffff0, v164
    s_and_b64 vcc, vcc, s[86:87]
    s_or_b64 s[10:11], s[10:11], vcc
    v_bitop3_b32 v166, v139, s36, v214 bitop3:0x28
    v_cmp_ne_u32 s[86:87], 0, v166
    v_cmp_gt_u32 vcc, 0x7ffffff0, v165
    s_and_b64 vcc, vcc, s[86:87]
    s_or_b64 s[10:11], s[10:11], vcc
    s_cbranch_scc0 K2_XWb
    s_sub_u32 s101, s101, 1
    s_cbranch_scc1 K2_END
    buffer_load_dwordx4 v[132:135], v164, s[32:35], 0 offen sc1
    buffer_load_dwordx4 v[136:139], v165, s[32:35], 0 offen sc1
    s_waitcnt vmcnt(0)
    s_branch K2_XVb
K2_XWb:
    s_branch K2_PADS0
K2_SLOW:
    s_add_u32 s81, s81, 448
    s_cmp_lt_u32 s81, s82
    s_cbranch_scc1 K2_BATCH
K2_FIND:
    s_cmp_lg_u64 s[84:85], 0
    s_cbranch_scc1 K2_GOT
    s_add_u32 s79, s79, 1
    s_cmp_ge_u32 s79, 4
    s_cbranch_scc1 K2_EPI
    s_mul_i32 s10, s12, 32896
    s_lshl_b32 s11, s79, 13
    s_add_u32 s10, s10, s11
    v_lshlrev_b32 v252, 7, v254
    buffer_load_ubyte v252, v252, s[24:27], s10 offen offset:15 sc1
    s_waitcnt vmcnt(0)
    v_cmp_lt_u32 s[84:85], s77, v252
    s_nop 3
    s_branch K2_FIND
K2_GOT:
    s_ff1_i32_b64 s10, s[84:85]
    s_bitset0_b64 s[84:85], s10
    s_lshl_b32 s11, s79, 6
    s_add_u32 s80, s10, s11
    s_mul_i32 s10, s12, 32896
    s_lshl_b32 s11, s80, 7
    s_add_u32 s10, s10, s11
    s_lshl_b32 s11, s12, 8
    s_add_u32 s11, s11, s80
    s_lshl_b32 s11, s11, 2
    s_add_u32 s11, s11, 23068672
    v_mov_b32 v188, 0
    buffer_load_ubyte v189, v188, s[24:27], s10 offen offset:15 sc1
    buffer_load_dword v190, v188, s[24:27], s11 offen sc1
    s_waitcnt vmcnt(0)
    v_readfirstlane_b32 s10, v189
    v_readfirstlane_b32 s11, v190
    s_nop 3
    s_and_b32 s83, s11, 0xffff
    s_lshr_b32 s11, s11, 16
    s_lshr_b32 s82, s10, 2
    s_sub_u32 s82, s10, s82
    s_cmp_gt_u32 s10, 48
    s_cselect_b32 s82, s11, s82
    s_lshr_b32 s10, s77, 2
    s_sub_u32 s81, s77, s10
K2_BATCH:
    s_barrier
    v_and_b32 v188, 7, v254
    v_mul_u32_u24 v189, 2688, v188
    v_add_u32 v189, 9728, v189
    v_lshlrev_b32 v188, 2, v188
    ds_write_b32 v188, v189 offset:2112
    v_add_u32 v188, s81, v255
    s_mul_i32 s10, s12, 32896
    s_lshl_b32 s11, s80, 7
    s_add_u32 s10, s10, s11
    v_mul_u32_u24 v190, 87382, v188
    v_lshrrev_b32 v190, 16, v190
    v_lshl_add_u32 v189, v190, 2, s10
    v_add_u32 v191, 8421248, v189
    v_cmp_lt_u32 vcc, 31, v190
    s_mul_i32 s11, s80, 3125
    s_add_u32 s11, s11, s83
    v_cndmask_b32 v189, v189, v191, vcc
    v_or_b32 v191, 12, v189
    v_and_b32 v192, 3, v190
    v_add_u32 v191, v191, v192
    v_cmp_le_u32 vcc, 48, v190
    v_add_u32 v190, s11, v188
    v_add_u32 v192, 22020096, v190
    v_cndmask_b32 v191, v191, v192, vcc
    v_lshlrev_b32 v190, 2, v190
    v_add_u32 v190, 17825792, v190
    v_cndmask_b32 v189, v189, v190, vcc
    s_add_u32 s10, s81, 448
    s_min_u32 s10, s10, s82
    v_cmp_gt_u32 vcc, s10, v188
    v_mov_b32 v190, 0x7ffffff0
    s_mul_i32 s86, s80, 100000
    v_cndmask_b32 v189, v190, v189, vcc
    v_cndmask_b32 v191, v190, v191, vcc
    buffer_load_dword v189, v189, s[24:27], 0 offen sc1
    buffer_load_ubyte v191, v191, s[24:27], 0 offen sc1
    s_waitcnt lgkmcnt(0)
    s_barrier
    s_and_saveexec_b64 s[10:11], vcc
    s_waitcnt vmcnt(0)
    v_and_b32 v188, 255, v189
    v_lshlrev_b32 v188, 2, v188
    ds_read_b32 v188, v188 offset:6400
    v_bfe_u32 v190, v189, 8, 8
    v_and_b32 v191, 15, v191
    v_lshl_or_b32 v191, v191, 8, v190
    v_mov_b32 v190, 4
    v_lshl_add_u32 v191, v191, 5, s86
    s_waitcnt lgkmcnt(0)
    ds_add_rtn_u32 v188, v188, v190 offset:2112
    s_waitcnt lgkmcnt(0)
    ds_write2st64_b32 v188, v189, v191 offset0:0 offset1:84
    s_mov_b64 exec, -1
    s_waitcnt lgkmcnt(0)
    s_barrier
    s_lshl_b32 s10, s3, 2
    v_mov_b32 v188, s10
    ds_read_b32 v188, v188 offset:2112
    v_mov_b32 v180, 0
    v_mov_b32 v181, 0
    v_mov_b32 v182, 0
    v_mov_b32 v183, 0
    v_mov_b32 v184, 0
    v_mov_b32 v185, 0
    v_mov_b32 v186, 0
    v_mov_b32 v187, 0
    v_lshrrev_b32 v189, 3, v254
    v_lshl_add_u32 v247, v189, 4, s76
    v_and_b32 v189, 31, v254
    v_lshl_add_u32 v249, v189, 2, s76
    v_lshrrev_b32 v190, 1, v254
    v_lshl_add_u32 v251, v190, 2, s76
    v_add_u32 v251, 21504, v251
    v_and_b32 v189, 44, v254
    v_add_u32 v248, s76, v189
    s_waitcnt lgkmcnt(0)
    v_readfirstlane_b32 s15, v188
    s_nop 3
    v_mov_b32 v190, 0xffff0000
    v_or_b32 v189, s39, v190
    v_mov_b32 v190, 0x7fffff00
    v_lshl_add_u32 v188, v254, 2, s15
    s_sub_u32 s73, s15, s76
    ds_write2st64_b32 v188, v189, v190 offset0:0 offset1:84
    ds_write2st64_b32 v188, v189, v190 offset0:1 offset1:85
    s_add_u32 s73, s73, 127
    s_lshr_b32 s73, s73, 7
    s_sub_i32 s38, s73, 1
K2_LAST:
    s_branch K2_GO
.section .rodata,"a"
.p2align 6
.amdhsa_kernel standalone__edge_featured_mpnn_gatedgcn__graph_kernel
  .amdhsa_next_free_vgpr 256
  .amdhsa_next_free_sgpr 102
  .amdhsa_accum_offset 256
  .amdhsa_group_segment_fixed_size 0
  .amdhsa_kernarg_size 96
  .amdhsa_user_sgpr_count 2
  .amdhsa_user_sgpr_kernarg_segment_ptr 1
  .amdhsa_system_sgpr_workgroup_id_x 1
.end_amdhsa_kernel
```

```asm
; @launch grid=(256,1,1) block=(512,1,1) lds=157696
.amdgcn_target "amdgcn-amd-amdhsa--gfx950"
.text
.globl standalone__edge_featured_mpnn_gatedgcn__graph_kernel
.p2align 8
.type standalone__edge_featured_mpnn_gatedgcn__graph_kernel,@function
standalone__edge_featured_mpnn_gatedgcn__graph_kernel:
    s_cmp_ge_u32 s2, 256
    s_cbranch_scc1 K2_END
    s_load_dwordx4 s[44:47], s[0:1], 16
    s_load_dwordx2 s[8:9], s[0:1], 88
    s_load_dwordx4 s[40:43], s[0:1], 0
    s_load_dwordx8 s[48:55], s[0:1], 32
    s_load_dwordx4 s[56:59], s[0:1], 64
    s_getpc_b64 s[86:87]
K2_PC:
    v_lshlrev_b32 v252, 7, v0
    v_min_u32 v252, K2_LAST-K2_PC, v252
    v_cmp_gt_u32 vcc, 192, v0
    s_cbranch_vccz K2_NOCPF
    global_load_dword v253, v252, s[86:87]
K2_NOCPF:
    v_mov_b32 v255, v0
    v_lshrrev_b32 v188, 6, v0
    v_and_b32 v254, 63, v0
    v_readfirstlane_b32 s7, v188
    s_and_b32 s10, s2, 7
    s_lshr_b32 s11, s2, 3
    s_lshl_b32 s10, s10, 5
    s_add_u32 s12, s10, s11
    s_mul_i32 s13, s12, 12500
    v_lshlrev_b32 v189, 4, v0
    v_lshlrev_b32 v1, 3, v0
    v_lshlrev_b32 v2, 2, v0
    v_mov_b32 v3, 0
    v_and_b32 v4, 0x3fc, v2
    ds_write_b32 v4, v3 offset:6400
    s_and_b32 s10, s7, 3
    s_lshr_b32 s3, s7, 2
    s_lshl1_add_u32 s3, s10, s3
    s_xor_b32 s3, s3, 1
    s_movk_i32 s14, 8192
    s_movk_i32 s15, 12288
    s_waitcnt lgkmcnt(0)
    s_add_u32 s64, s46, s13
    s_addc_u32 s65, s47, 0
    s_mov_b32 s66, 12500
    s_mov_b32 s67, 0x20000
    s_add_u32 s68, s44, s13
    s_addc_u32 s69, s45, 0
    s_mov_b32 s70, 12500
    s_mov_b32 s71, 0x20000
    buffer_load_dwordx4 v[8:11], v189, s[64:67], 0 offen nt
    buffer_load_dwordx2 v[12:13], v1, s[64:67], s14 offen nt
    buffer_load_dword v14, v2, s[64:67], s15 offen nt
    s_barrier
    buffer_load_dwordx4 v[16:19], v189, s[68:71], 0 offen nt
    buffer_load_dwordx2 v[20:21], v1, s[68:71], s14 offen nt
    buffer_load_dword v22, v2, s[68:71], s15 offen nt
    s_add_u32 s10, s8, 24117248
    s_addc_u32 s11, s9, 0
    s_load_dword s100, s[10:11], 0
    v_lshrrev_b32 v1, 3, v0
    v_lshlrev_b32 v170, 2, v1
    v_and_b32 v197, 7, v0
    v_and_b32 v5, 16, v0
    v_lshlrev_b32 v5, 1, v5
    v_xor_b32 v5, v5, v189
    v_lshlrev_b32 v172, 4, v254
    v_and_b32 v241, 16, v254
    v_lshlrev_b32 v241, 2, v241
    v_xor_b32 v234, v241, v172
    v_and_b32 v241, 0x70, v234
    s_mov_b32 s16, s40
    s_mov_b32 s17, s41
    s_mov_b32 s18, 6400000
    s_mov_b32 s19, 0x20000
    s_mov_b32 s60, 85599
    s_mov_b32 s61, 4294967100
    s_movk_i32 s62, 2000
    v_mov_b32 v7, 87382
    s_mov_b32 s10, 0
    v_lshl_add_u32 v56, v254, 10, s10
    v_add_u32 v57, 256, v56
    v_add_u32 v58, 512, v56
    v_add_u32 v59, 768, v56
    v_and_b32 v60, 127, v255
    v_lshl_add_u32 v60, v60, 9, s10
    v_add_u32 v61, 256, v60
    v_lshl_add_u32 v62, v254, 8, s10
    v_lshrrev_b32 v23, 6, v255
    v_lshrrev_b32 v31, 7, v255
    v_add_u32 v31, 8, v31
    v_mov_b32 v39, 12
    v_cmp_gt_u32 s[78:79], 53, v255
    s_mov_b32 s11, 32896
    v_lshlrev_b32 v3, 4, v197
    v_mad_u32_u24 v4, v1, s11, v3
    v_mul_u32_u24 v6, 52, v1
    v_lshl_add_u32 v6, v197, 2, v6
    v_lshlrev_b32 v3, 2, v6
    v_add_u32 v3, 104448, v3
    v_add_u32 v6, 91136, v6
    v_mov_b32 v214, 0xf0f0f0
    v_mov_b32 v15, 0x0f0f0f
    s_waitcnt vmcnt(3)
    v_mul_u32_u24 v48, s60, v8
    v_mul_u32_u24 v49, s60, v9
    v_mul_u32_u24 v50, s60, v10
    v_mul_u32_u24 v51, s60, v11
    v_mul_u32_u24 v52, s60, v12
    v_mul_u32_u24 v53, s60, v13
    v_lshrrev_b32 v48, 24, v48
    v_lshrrev_b32 v49, 24, v49
    v_lshrrev_b32 v50, 24, v50
    v_lshrrev_b32 v51, 24, v51
    v_lshrrev_b32 v52, 24, v52
    v_lshrrev_b32 v53, 24, v53
    v_lshl_add_u32 v24, v48, 2, s62
    ds_add_rtn_u32 v32, v24, v7 offset:4400
    v_lshl_add_u32 v25, v49, 2, s62
    ds_add_rtn_u32 v33, v25, v7 offset:4400
    v_lshl_add_u32 v26, v50, 2, s62
    ds_add_rtn_u32 v34, v26, v7 offset:4400
    v_lshl_add_u32 v27, v51, 2, s62
    ds_add_rtn_u32 v35, v27, v7 offset:4400
    v_lshl_add_u32 v28, v52, 2, s62
    ds_add_rtn_u32 v36, v28, v7 offset:4400
    v_lshl_add_u32 v29, v53, 2, s62
    ds_add_rtn_u32 v37, v29, v7 offset:4400
    v_mad_i32_i24 v8, v48, s61, v8
    v_or_b32 v8, v8, v56
    v_mad_i32_i24 v9, v49, s61, v9
    v_or_b32 v9, v9, v57
    v_mad_i32_i24 v10, v50, s61, v10
    v_or_b32 v10, v10, v58
    v_mad_i32_i24 v11, v51, s61, v11
    v_or_b32 v11, v11, v59
    v_mad_i32_i24 v12, v52, s61, v12
    v_or_b32 v12, v12, v60
    v_mad_i32_i24 v13, v53, s61, v13
    v_or_b32 v13, v13, v61
    s_waitcnt lgkmcnt(5)
    v_lshrrev_b32 v32, 16, v32
    v_min_u32 v40, 48, v32
    v_mad_u32_u24 v40, v24, 13, v40
    v_lshlrev_b32 v48, 2, v40
    ds_write_b8 v40, v23 offset:65136
    s_waitcnt lgkmcnt(5)
    v_lshrrev_b32 v33, 16, v33
    v_min_u32 v41, 48, v33
    v_mad_u32_u24 v41, v25, 13, v41
    v_lshlrev_b32 v49, 2, v41
    ds_write_b8 v41, v23 offset:65136
    s_waitcnt lgkmcnt(5)
    v_lshrrev_b32 v34, 16, v34
    v_min_u32 v42, 48, v34
    v_mad_u32_u24 v42, v26, 13, v42
    v_lshlrev_b32 v50, 2, v42
    ds_write_b8 v42, v23 offset:65136
    s_waitcnt lgkmcnt(5)
    v_lshrrev_b32 v35, 16, v35
    v_min_u32 v43, 48, v35
    v_mad_u32_u24 v43, v27, 13, v43
    v_lshlrev_b32 v51, 2, v43
    ds_write_b8 v43, v23 offset:65136
    s_waitcnt lgkmcnt(5)
    v_lshrrev_b32 v36, 16, v36
    v_min_u32 v44, 48, v36
    v_mad_u32_u24 v44, v28, 13, v44
    v_lshlrev_b32 v52, 2, v44
    ds_write_b8 v44, v31 offset:65136
    s_waitcnt lgkmcnt(5)
    v_lshrrev_b32 v37, 16, v37
    v_min_u32 v45, 48, v37
    v_mad_u32_u24 v45, v29, 13, v45
    v_lshlrev_b32 v53, 2, v45
    ds_write_b8 v45, v31 offset:65136
    s_cmp_lg_u32 s7, 0
    s_cbranch_scc1 K1_NO7
    s_mov_b64 exec, s[78:79]
    s_waitcnt lgkmcnt(0)
    v_mul_u32_u24 v54, s60, v14
    v_lshrrev_b32 v54, 24, v54
    v_lshl_add_u32 v30, v54, 2, s62
    ds_add_rtn_u32 v38, v30, v7 offset:4400
    v_mad_i32_i24 v14, v54, s61, v14
    v_or_b32 v14, v14, v62
    s_waitcnt lgkmcnt(0)
    v_lshrrev_b32 v38, 16, v38
    v_min_u32 v46, 48, v38
    v_mad_u32_u24 v46, v30, 13, v46
    v_lshlrev_b32 v54, 2, v46
    ds_write_b8 v46, v39 offset:65136
    s_waitcnt vmcnt(0)
    v_lshl_add_u32 v22, v22, 16, v14
    ds_write_b32 v54, v22 offset:448
    s_mov_b64 exec, -1
K1_NO7:
    s_mov_b32 s64, s50
    s_mov_b32 s65, s51
    s_mov_b32 s66, 8192
    s_mov_b32 s67, 0x20000
    buffer_load_dwordx4 v[64:67], v5, s[64:67], 0 offen
    s_mov_b32 s68, s52
    s_mov_b32 s69, s53
    s_mov_b32 s70, 2048
    s_mov_b32 s71, 0x20000
    buffer_load_dwordx4 v[68:71], v5, s[68:71], 0 offen
    s_lshl_b32 s10, s7, 10
    s_mov_b32 s64, s48
    s_mov_b32 s65, s49
    s_add_u32 m0, s10, 34304
    s_nop 0
    buffer_load_dwordx4 v5, s[64:67], 0 offen lds
    s_mov_b32 s64, s56
    s_mov_b32 s65, s57
    s_add_u32 m0, s10, 26112
    s_nop 0
    buffer_load_dwordx4 v5, s[64:67], 0 offen lds
    s_mov_b32 s64, s54
    s_mov_b32 s65, s55
    s_add_u32 m0, s10, 9728
    s_nop 0
    buffer_load_dwordx4 v5, s[64:67], 0 offen lds
    s_waitcnt vmcnt(5)
    v_lshl_add_u32 v16, v16, 16, v8
    ds_write_b32 v48, v16 offset:448
    v_lshl_add_u32 v17, v17, 16, v9
    ds_write_b32 v49, v17 offset:448
    v_lshl_add_u32 v18, v18, 16, v10
    ds_write_b32 v50, v18 offset:448
    v_lshl_add_u32 v19, v19, 16, v11
    ds_write_b32 v51, v19 offset:448
    v_lshl_add_u32 v20, v20, 16, v12
    ds_write_b32 v52, v20 offset:448
    v_lshl_add_u32 v21, v21, 16, v13
    ds_write_b32 v53, v21 offset:448
    s_lshl_b32 s15, s12, 7
    s_add_u32 s32, s8, s15
    s_addc_u32 s33, s9, 0
    s_mov_b32 s34, 16809984
    s_mov_b32 s35, 0x20000
    s_waitcnt lgkmcnt(0)
    s_add_u32 s100, s100, 1
    s_and_b32 s10, s100, 15
    s_and_b32 s11, s100, 0xf0
    s_mul_i32 s36, s10, 0x1010
    s_lshl_b32 s11, s11, 16
    s_or_b32 s36, s36, s11
    s_and_b32 s10, s100, 0x700
    s_lshl4_add_u32 s10, s10, 0x8000
    s_xor_b32 s36, s36, s10
    s_mov_b32 s101, 300000
    s_barrier
    ds_read_b128 v[112:115], v172 offset:6400
    ds_read_u16 v108, v170 offset:6402
    ds_read_b32 v104, v6 offset:0
    ds_read_b128 v[88:91], v3 offset:0
    ds_read_u16 v109, v170 offset:6658
    ds_read_b32 v105, v6 offset:3328
    ds_read_b128 v[92:95], v3 offset:13312
    ds_read_u16 v110, v170 offset:6914
    ds_read_b32 v106, v6 offset:6656
    ds_read_b128 v[96:99], v3 offset:26624
    ds_read_u16 v111, v170 offset:7170
    ds_read_b32 v107, v6 offset:9984
    ds_read_b128 v[100:103], v3 offset:39936
    s_waitcnt lgkmcnt(12)
    v_max3_u32 v1, v112, v113, v114
    v_max_u32 v1, v1, v115
    v_cmp_le_u32 vcc, 3211264, v1
    s_mov_b32 s10, 0
    s_cbranch_vccnz K1_OVF
K1_OUT:
    s_waitcnt lgkmcnt(9)
    v_lshl_or_b32 v108, v108, 24, s36
    v_and_or_b32 v91, v104, v15, v108
    buffer_store_dwordx4 v[88:91], v4, s[32:35], s10 offen sc1
    s_add_u32 s10, s10, 2105344
    s_waitcnt lgkmcnt(6)
    v_lshl_or_b32 v109, v109, 24, s36
    v_and_or_b32 v95, v105, v15, v109
    buffer_store_dwordx4 v[92:95], v4, s[32:35], s10 offen sc1
    s_add_u32 s10, s10, 2105344
    s_waitcnt lgkmcnt(3)
    v_lshl_or_b32 v110, v110, 24, s36
    v_and_or_b32 v99, v106, v15, v110
    buffer_store_dwordx4 v[96:99], v4, s[32:35], s10 offen sc1
    s_add_u32 s10, s10, 2105344
    s_waitcnt lgkmcnt(0)
    v_lshl_or_b32 v111, v111, 24, s36
    v_and_or_b32 v103, v107, v15, v111
    buffer_store_dwordx4 v[100:103], v4, s[32:35], s10 offen sc1
    s_add_u32 s10, s10, 2105344
    v_max3_u32 v1, v108, v109, v110
    v_max_u32 v1, v1, v111
    v_cmp_le_u32 vcc, 553648128, v1
    s_cbranch_vccnz K1_EXT
K1_EXTR:
    s_lshr_b32 s10, s3, 1
    s_mul_i32 s10, s10, 49
    s_bitcmp1_b32 s3, 0
    s_cselect_b32 s72, 20, -4
    s_cselect_b32 s73, 28, 3
    s_cselect_b32 s84, 45, 20
    s_add_i32 s72, s72, s10
    s_add_i32 s73, s73, s10
    s_add_i32 s84, s84, s10
    s_add_i32 s85, s72, 32
    s_max_i32 s96, s72, 0
    s_cmp_eq_u32 s3, 7
    s_cselect_b32 s84, 196, s84
    s_cselect_b32 s85, 196, s85
    v_lshrrev_b32 v193, 5, v254
    s_mov_b32 s20, s42
    s_mov_b32 s21, s43
    s_mov_b32 s22, 25600000
    s_mov_b32 s23, 0x20000
    s_mov_b32 s28, s58
    s_mov_b32 s29, s59
    s_mov_b32 s30, 6400000
    s_mov_b32 s31, 0x20000
    s_mov_b32 s24, s8
    s_mov_b32 s25, s9
    s_mov_b32 s26, 24117376
    s_mov_b32 s27, 0x20000
    v_lshrrev_b32 v194, 5, v255
    v_and_b32 v195, 15, v255
    v_cmp_eq_u32 vcc, v194, v195
    v_and_b32 v194, 16, v255
    v_mov_b32 v195, 0x3f80
    v_lshlrev_b32 v195, v194, v195
    v_cndmask_b32 v195, 0, v195, vcc
    v_lshlrev_b32 v194, 2, v255
    v_mov_b32 v196, 0
    ds_write_b32 v194, v195
    v_bfe_u32 v195, v255, 3, 1
    v_and_b32 v201, 7, v255
    v_lshl_add_u32 v195, v195, 2, v201
    v_lshrrev_b32 v200, 6, v255
    v_cmp_eq_u32 vcc, v195, v200
    v_bfe_u32 v200, v255, 4, 2
    v_mov_b32 v195, 0x3f80
    v_cndmask_b32 v195, 0, v195, vcc
    v_cmp_lt_u32 vcc, 3, v201
    v_mul_u32_u24 v200, 0x5555, v200
    v_and_b32 v201, 60, v194
    v_cndmask_b32 v195, v195, v200, vcc
    ds_write_b32 v194, v195 offset:7424
    ds_write_b32 v201, v196 offset:9472
    ds_write_b32 v194, v196 offset:2048
    ds_write2st64_b32 v194, v196, v196 offset0:9 offset1:17
    s_movk_i32 s75, 128
    s_mul_i32 s74, s3, 5184
    s_add_u32 s74, s74, 102400
    s_movk_i32 s77, 48
    s_add_u32 s39, s96, 32
    s_lshl_b32 s11, s96, 6
    s_mov_b32 s97, 0
    v_bfe_u32 v194, v254, 4, 1
    v_and_b32 v242, 1, v254
    v_lshlrev_b32 v242, 4, v242
    v_lshlrev_b32 v245, 5, v193
    v_subrev_u32 v245, s11, v245
    v_and_b32 v195, 3, v254
    v_lshlrev_b32 v195, 3, v195
    v_lshl_add_u32 v246, v194, 5, v195
    v_subrev_u32 v246, s11, v246
    v_mul_u32_u24 v196, 130, v195
    v_and_b32 v194, 28, v254
    v_lshl_add_u32 v196, v194, 5, v196
    v_bfe_u32 v194, v254, 3, 1
    v_xor_b32 v194, v194, v193
    v_lshl_add_u32 v196, v194, 6, v196
    v_add_u32 v243, s74, v196
    v_and_b32 v194, 31, v254
    v_lshl_add_u32 v194, v194, 1, v193
    v_lshl_add_u32 v244, v194, 4, s74
    v_add_u32 v244, 4160, v244
    s_mul_i32 s76, s3, 2688
    s_add_u32 s76, s76, 9728
    v_lshrrev_b32 v194, 3, v254
    v_lshl_add_u32 v247, v194, 4, s76
    v_and_b32 v194, 31, v254
    v_lshl_add_u32 v249, v194, 2, s76
    v_lshrrev_b32 v195, 1, v254
    v_lshl_add_u32 v251, v195, 2, s76
    v_add_u32 v251, 21504, v251
    v_and_b32 v194, 44, v254
    v_add_u32 v248, s76, v194
    s_mul_i32 s10, s7, 4160
    s_add_u32 s10, s10, 69120
    v_and_b32 v202, 31, v254
    v_bfe_u32 v194, v202, 1, 1
    v_xor_b32 v194, v194, v193
    v_lshlrev_b32 v194, 6, v194
    v_lshl_add_u32 v194, v202, 7, v194
    v_lshrrev_b32 v202, 3, v202
    v_lshl_add_u32 v202, v202, 4, v194
    v_add_u32 v202, s10, v202
    v_lshrrev_b32 v194, 1, v254
    v_xor_b32 v194, v194, v254
    v_and_b32 v194, 4, v194
    v_mul_u32_u24 v194, 3, v194
    v_xor_b32 v194, v194, v254
    v_and_b32 v235, 31, v194
    v_bfe_u32 v195, v235, 1, 1
    v_xor_b32 v195, v195, v193
    v_lshlrev_b32 v195, 6, v195
    v_lshl_add_u32 v195, v235, 7, v195
    v_lshrrev_b32 v235, 3, v235
    v_lshl_add_u32 v235, v235, 4, v195
    v_add_u32 v235, s10, v235
    v_mov_b32 v177, 0xdddd
    v_lshlrev_b32 v168, 2, v197
    v_mul_u32_u24 v208, 25000, v170
    v_add_u32 v209, 6400000, v208
    v_add_u32 v210, 12800000, v208
    v_add_u32 v211, 19200000, v208
    v_mov_b32 v171, 4
    v_mov_b32 v169, 1
    v_and_b32 v199, 31, v254
    v_add_u32 v199, s96, v199
    v_lshlrev_b32 v200, 4, v199
    v_lshl_add_u32 v200, v193, 3, v200
    v_mov_b64 v[180:181], 0
    v_mov_b64 v[182:183], 0
    v_mov_b64 v[184:185], 0
    v_mov_b64 v[186:187], 0
    s_lshl_b32 s15, s3, 2
    v_mov_b32 v212, s15
    v_lshlrev_b32 v213, 2, v199
    s_mul_i32 s10, s12, 32896
    s_add_u32 s32, s8, s10
    s_addc_u32 s33, s9, 0
    s_mov_b32 s34, 32768
    s_mov_b32 s35, 0x20000
    s_movk_i32 s79, 8192
    s_movk_i32 s80, 16384
    s_movk_i32 s81, 24576
    s_mov_b32 s10, 0xbfb8aa3b
    s_waitcnt vmcnt(7)
    v_lshlrev_b32 v72, 16, v64
    v_and_b32 v73, 0xffff0000, v64
    v_lshlrev_b32 v74, 16, v65
    v_and_b32 v75, 0xffff0000, v65
    v_lshlrev_b32 v76, 16, v66
    v_and_b32 v77, 0xffff0000, v66
    v_lshlrev_b32 v78, 16, v67
    v_and_b32 v79, 0xffff0000, v67
    v_lshlrev_b32 v80, 16, v68
    v_and_b32 v81, 0xffff0000, v68
    v_lshlrev_b32 v82, 16, v69
    v_and_b32 v83, 0xffff0000, v69
    v_lshlrev_b32 v84, 16, v70
    v_and_b32 v85, 0xffff0000, v70
    v_lshlrev_b32 v86, 16, v71
    v_and_b32 v87, 0xffff0000, v71
    v_mul_f32 v72, s10, v72
    v_mul_f32 v73, s10, v73
    v_mul_f32 v74, s10, v74
    v_mul_f32 v75, s10, v75
    v_mul_f32 v76, s10, v76
    v_mul_f32 v77, s10, v77
    v_mul_f32 v78, s10, v78
    v_mul_f32 v79, s10, v79
    v_mul_f32 v80, s10, v80
    v_mul_f32 v81, s10, v81
    v_mul_f32 v82, s10, v82
    v_mul_f32 v83, s10, v83
    v_mul_f32 v84, s10, v84
    v_mul_f32 v85, s10, v85
    v_mul_f32 v86, s10, v86
    v_mul_f32 v87, s10, v87
    v_cvt_pk_bf16_f32 v64, v72, v73
    v_cvt_pk_bf16_f32 v65, v74, v75
    v_cvt_pk_bf16_f32 v66, v76, v77
    v_cvt_pk_bf16_f32 v67, v78, v79
    v_cvt_pk_bf16_f32 v68, v80, v81
    v_cvt_pk_bf16_f32 v69, v82, v83
    v_cvt_pk_bf16_f32 v70, v84, v85
    v_cvt_pk_bf16_f32 v71, v86, v87
    ds_write_b128 v189, v[64:67] offset:17920
    s_cmp_ge_u32 s7, 2
    s_cbranch_scc1 K1_NOWC
    ds_write_b128 v189, v[68:71] offset:42496
K1_NOWC:
    v_bfe_u32 v173, v254, 2, 2
    v_lshlrev_b32 v173, 7, v173
    v_lshl_add_u32 v173, v242, 2, v173
    v_and_b32 v174, 16, v254
    v_and_b32 v175, 2, v254
    v_lshl_add_u32 v174, v175, 2, v174
    v_and_b32 v175, 8, v254
    v_lshl_add_u32 v174, v175, 2, v174
    v_add_u32 v173, v173, v174
    v_lshl_add_u32 v175, v193, 10, v173
    v_lshl_add_u32 v173, v193, 12, v173
    v_xor_b32 v174, 32, v173
    v_xor_b32 v176, 32, v175
    s_lshl_b32 s10, s7, 10
    s_and_b32 s11, s7, 4
    s_mul_i32 s11, s11, -1016
    s_add_u32 s11, s11, s10
    v_xor_b32 v252, s11, v173
    s_waitcnt vmcnt(0) lgkmcnt(0)
    s_barrier
    buffer_load_dwordx4 v[88:91], v189, s[32:35], 0 offen sc1
    buffer_load_dwordx4 v[92:95], v189, s[32:35], s79 offen sc1
    buffer_load_dwordx4 v[96:99], v189, s[32:35], s80 offen sc1
    buffer_load_dwordx4 v[100:103], v189, s[32:35], s81 offen sc1
    ds_read_b64_tr_b16 v[72:73], v252 offset:9728
    ds_read_b64_tr_b16 v[76:77], v252 offset:34304
    ds_read_b64_tr_b16 v[74:75], v252 offset:10240
    ds_read_b64_tr_b16 v[78:79], v252 offset:34816
    v_add_u32 v252, s10, v172
    ds_read_b64_tr_b16 v[0:1], v173 offset:17920
    ds_read_b64_tr_b16 v[2:3], v173 offset:18432
    ds_read_b64_tr_b16 v[4:5], v173 offset:18944
    ds_read_b64_tr_b16 v[6:7], v173 offset:19456
    ds_read_b64_tr_b16 v[8:9], v173 offset:19968
    ds_read_b64_tr_b16 v[10:11], v173 offset:20480
    ds_read_b64_tr_b16 v[12:13], v173 offset:20992
    ds_read_b64_tr_b16 v[14:15], v173 offset:21504
    s_waitcnt lgkmcnt(8)
    ds_write_b128 v252, v[72:75] offset:52736
    s_mov_b32 s10, 0xbfb8aa3b
    v_lshlrev_b32 v80, 16, v76
    v_and_b32 v81, 0xffff0000, v76
    v_lshlrev_b32 v82, 16, v77
    v_and_b32 v83, 0xffff0000, v77
    v_lshlrev_b32 v84, 16, v78
    v_and_b32 v85, 0xffff0000, v78
    v_lshlrev_b32 v86, 16, v79
    v_and_b32 v87, 0xffff0000, v79
    v_mul_f32 v80, s10, v80
    v_mul_f32 v81, s10, v81
    v_mul_f32 v82, s10, v82
    v_mul_f32 v83, s10, v83
    v_mul_f32 v84, s10, v84
    v_mul_f32 v85, s10, v85
    v_mul_f32 v86, s10, v86
    v_mul_f32 v87, s10, v87
    v_cvt_pk_bf16_f32 v76, v80, v81
    v_cvt_pk_bf16_f32 v77, v82, v83
    v_cvt_pk_bf16_f32 v78, v84, v85
    v_cvt_pk_bf16_f32 v79, v86, v87
    ds_write_b128 v252, v[76:79] offset:60928
    v_and_b32 v188, 3, v254
    v_lshlrev_b32 v190, 4, v188
    v_mul_u32_u24 v188, 5376, v188
    v_add_u32 v188, 2688, v188
    ds_write_b16 v190, v188 offset:6338
    s_waitcnt lgkmcnt(8)
    ds_read_b64_tr_b16 v[16:17], v174 offset:17920
    ds_read_b64_tr_b16 v[18:19], v174 offset:18432
    ds_read_b64_tr_b16 v[20:21], v174 offset:18944
    ds_read_b64_tr_b16 v[22:23], v174 offset:19456
    ds_read_b64_tr_b16 v[24:25], v174 offset:19968
    ds_read_b64_tr_b16 v[26:27], v174 offset:20480
    s_waitcnt lgkmcnt(8)
    ds_read_b64_tr_b16 v[28:29], v174 offset:20992
    ds_read_b64_tr_b16 v[30:31], v174 offset:21504
    ds_read_b64_tr_b16 v[64:65], v175 offset:42496
    ds_read_b64_tr_b16 v[66:67], v175 offset:43008
    ds_read_b64_tr_b16 v[68:69], v176 offset:42496
    ds_read_b64_tr_b16 v[70:71], v176 offset:43008
    s_waitcnt lgkmcnt(8)
    ds_read_b64_tr_b16 v[32:33], v173 offset:26112
    ds_read_b64_tr_b16 v[34:35], v173 offset:26624
    ds_read_b64_tr_b16 v[36:37], v173 offset:27136
    ds_read_b64_tr_b16 v[38:39], v173 offset:27648
    ds_read_b64_tr_b16 v[40:41], v173 offset:28160
    ds_read_b64_tr_b16 v[42:43], v173 offset:28672
    s_waitcnt lgkmcnt(8)
    ds_read_b64_tr_b16 v[44:45], v173 offset:29184
    ds_read_b64_tr_b16 v[46:47], v173 offset:29696
    ds_read_b64_tr_b16 v[48:49], v174 offset:26112
    ds_read_b64_tr_b16 v[50:51], v174 offset:26624
    ds_read_b64_tr_b16 v[52:53], v174 offset:27136
    ds_read_b64_tr_b16 v[54:55], v174 offset:27648
    s_waitcnt lgkmcnt(8)
    ds_read_b64_tr_b16 v[56:57], v174 offset:28160
    ds_read_b64_tr_b16 v[58:59], v174 offset:28672
    ds_read_b64_tr_b16 v[60:61], v174 offset:29184
    ds_read_b64_tr_b16 v[62:63], v174 offset:29696
    s_mov_b32 s5, 85899
    s_lshr_b32 s6, s12, 5
    s_mul_i32 s6, s6, 538758528
    s_sub_u32 s6, s6, 0
    s_lshr_b32 s6, s6, 1
    s_sub_u32 s6, 0, s6
    s_add_u32 s5, s6, 0x40000000
    v_mov_b32 v190, 42949
    s_mov_b32 s64, 0xc0c0401
    s_mov_b32 s65, 0xc0c0501
    s_mov_b32 s66, 0xc0c0601
    s_mov_b32 s67, 0x05040100
    s_movk_i32 s4, 1338
    s_movk_i32 s13, 4032
    s_movk_i32 s14, 16056
    s_waitcnt lgkmcnt(0)
    s_barrier
K2_CHK0:
    s_waitcnt vmcnt(3)
    v_bitop3_b32 v188, v91, s36, v214 bitop3:0x28
    v_cmp_ne_u32 vcc, 0, v188
    v_sub_u32_sdwa v188, v91, v168 dst_sel:DWORD dst_unused:UNUSED_PAD src0_sel:BYTE_3 src1_sel:DWORD
    v_mad_u32_u16 v104, v88, v190, s6 op_sel:[1,0,0,0]
    v_mad_u32_u16 v105, v89, v190, s6 op_sel:[1,0,0,0]
    v_mad_u32_u16 v106, v90, v190, s6 op_sel:[1,0,0,0]
    s_cbranch_vccnz K2_RETRY0
    v_cmp_lt_i32 s[40:41], 0, v188
    v_cmp_lt_i32 s[42:43], 1, v188
    v_cmp_lt_i32 s[44:45], 2, v188
    v_alignbit_b32 v104, v88, v104, 28
    v_alignbit_b32 v105, v89, v105, 28
    v_alignbit_b32 v106, v90, v106, 28
    v_and_b32 v104, 0xff4, v104
    v_and_b32 v105, 0xff4, v105
    v_and_b32 v106, 0xff4, v106
    v_mul_u32_u24_sdwa v116, s4, v88 dst_sel:DWORD dst_unused:UNUSED_PAD src0_sel:DWORD src1_sel:BYTE_0
    v_mul_u32_u24_sdwa v117, s4, v89 dst_sel:DWORD dst_unused:UNUSED_PAD src0_sel:DWORD src1_sel:BYTE_0
    v_mul_u32_u24_sdwa v118, s4, v90 dst_sel:DWORD dst_unused:UNUSED_PAD src0_sel:DWORD src1_sel:BYTE_0
    v_subrev_u32 v116, 40140, v116
    v_subrev_u32 v117, 40140, v117
    v_subrev_u32 v118, 40140, v118
    v_cmp_gt_u16 s[68:69], s14, v116
    v_cmp_gt_u16 s[70:71], s14, v117
    v_cmp_gt_u16 s[86:87], s14, v118
    v_lshrrev_b32 v116, 16, v116
    v_lshrrev_b32 v117, 16, v117
    v_lshrrev_b32 v118, 16, v118
    v_lshl_add_u32 v116, v116, 4, s13
    v_lshl_add_u32 v117, v117, 4, s13
    v_lshl_add_u32 v118, v118, 4, s13
    v_cndmask_b32 v104, v104, v116, s[68:69]
    v_cndmask_b32 v105, v105, v117, s[70:71]
    v_cndmask_b32 v106, v106, v118, s[86:87]
    s_mov_b64 exec, s[40:41]
    ds_add_rtn_u32 v220, v104, v171 offset:2304
    s_mov_b64 exec, s[42:43]
    ds_add_rtn_u32 v221, v105, v171 offset:2304
    s_mov_b64 exec, s[44:45]
    ds_add_rtn_u32 v222, v106, v171 offset:2304
    s_mov_b64 exec, -1
    v_and_b32 v119, 0x0f0f0f, v91
    v_perm_b32 v152, v119, v88, s64
    s_and_b64 s[68:69], s[68:69], s[40:41]
    v_lshl_add_u32 v152, v152, 5, v208
    s_andn2_b64 s[40:41], s[40:41], s[68:69]
    v_perm_b32 v153, v119, v89, s65
    s_and_b64 s[70:71], s[70:71], s[42:43]
    v_lshl_add_u32 v153, v153, 5, v208
    s_andn2_b64 s[42:43], s[42:43], s[70:71]
    v_perm_b32 v154, v119, v90, s66
    s_and_b64 s[86:87], s[86:87], s[44:45]
    v_lshl_add_u32 v154, v154, 5, v208
    s_andn2_b64 s[44:45], s[44:45], s[86:87]
K2_CHK1:
    s_waitcnt vmcnt(2)
    v_bitop3_b32 v188, v95, s36, v214 bitop3:0x28
    v_cmp_ne_u32 vcc, 0, v188
    v_sub_u32_sdwa v188, v95, v168 dst_sel:DWORD dst_unused:UNUSED_PAD src0_sel:BYTE_3 src1_sel:DWORD
    v_mad_u32_u16 v107, v92, v190, s6 op_sel:[1,0,0,0]
    v_mad_u32_u16 v108, v93, v190, s6 op_sel:[1,0,0,0]
    v_mad_u32_u16 v109, v94, v190, s6 op_sel:[1,0,0,0]
    s_cbranch_vccnz K2_RETRY1
    v_cmp_lt_i32 s[46:47], 0, v188
    v_cmp_lt_i32 s[48:49], 1, v188
    v_cmp_lt_i32 s[50:51], 2, v188
    v_alignbit_b32 v107, v92, v107, 28
    v_alignbit_b32 v108, v93, v108, 28
    v_alignbit_b32 v109, v94, v109, 28
    v_and_b32 v107, 0xff4, v107
    v_and_b32 v108, 0xff4, v108
    v_and_b32 v109, 0xff4, v109
    s_mov_b64 exec, s[46:47]
    ds_add_rtn_u32 v223, v107, v171 offset:2304
    s_mov_b64 exec, s[48:49]
    ds_add_rtn_u32 v224, v108, v171 offset:2304
    s_mov_b64 exec, s[50:51]
    ds_add_rtn_u32 v225, v109, v171 offset:2304
    s_mov_b64 exec, -1
    s_waitcnt lgkmcnt(0)
    v_min_u16 v116, 2176, v220
    v_add_u32_sdwa v116, v116, v220 dst_sel:DWORD dst_unused:UNUSED_PAD src0_sel:WORD_0 src1_sel:WORD_1
    v_min_u16 v117, 2176, v221
    v_add_u32_sdwa v117, v117, v221 dst_sel:DWORD dst_unused:UNUSED_PAD src0_sel:WORD_0 src1_sel:WORD_1
    v_min_u16 v118, 2176, v222
    v_add_u32_sdwa v118, v118, v222 dst_sel:DWORD dst_unused:UNUSED_PAD src0_sel:WORD_0 src1_sel:WORD_1
    s_mov_b64 exec, s[68:69]
    ds_write2st64_b32 v116, v88, v152 offset0:38 offset1:122
    s_mov_b64 exec, s[70:71]
    ds_write2st64_b32 v117, v89, v153 offset0:38 offset1:122
    s_mov_b64 exec, s[86:87]
    ds_write2st64_b32 v118, v90, v154 offset0:38 offset1:122
    s_mov_b64 exec, -1
K2_CHK2:
    s_waitcnt vmcnt(1)
    v_bitop3_b32 v188, v99, s36, v214 bitop3:0x28
    v_cmp_ne_u32 vcc, 0, v188
    v_sub_u32_sdwa v188, v99, v168 dst_sel:DWORD dst_unused:UNUSED_PAD src0_sel:BYTE_3 src1_sel:DWORD
    v_mad_u32_u16 v110, v96, v190, s5 op_sel:[1,0,0,0]
    v_mad_u32_u16 v111, v97, v190, s5 op_sel:[1,0,0,0]
    v_mad_u32_u16 v112, v98, v190, s5 op_sel:[1,0,0,0]
    s_cbranch_vccnz K2_RETRY2
    v_cmp_lt_i32 s[52:53], 0, v188
    v_cmp_lt_i32 s[54:55], 1, v188
    v_cmp_lt_i32 s[56:57], 2, v188
    v_alignbit_b32 v110, v96, v110, 28
    v_alignbit_b32 v111, v97, v111, 28
    v_alignbit_b32 v112, v98, v112, 28
    v_and_b32 v110, 0xff4, v110
    v_and_b32 v111, 0xff4, v111
    v_and_b32 v112, 0xff4, v112
    s_mov_b64 exec, s[52:53]
    ds_add_rtn_u32 v226, v110, v171 offset:2312
    s_mov_b64 exec, s[54:55]
    ds_add_rtn_u32 v227, v111, v171 offset:2312
    s_mov_b64 exec, s[56:57]
    ds_add_rtn_u32 v228, v112, v171 offset:2312
    s_mov_b64 exec, -1
K2_CHK3:
    s_waitcnt vmcnt(0)
    v_bitop3_b32 v188, v103, s36, v214 bitop3:0x28
    v_cmp_ne_u32 vcc, 0, v188
    v_sub_u32_sdwa v188, v103, v168 dst_sel:DWORD dst_unused:UNUSED_PAD src0_sel:BYTE_3 src1_sel:DWORD
    v_mad_u32_u16 v113, v100, v190, s5 op_sel:[1,0,0,0]
    v_mad_u32_u16 v114, v101, v190, s5 op_sel:[1,0,0,0]
    v_mad_u32_u16 v115, v102, v190, s5 op_sel:[1,0,0,0]
    s_cbranch_vccnz K2_RETRY3
    v_cmp_lt_i32 s[58:59], 0, v188
    v_cmp_lt_i32 s[60:61], 1, v188
    v_cmp_lt_i32 s[62:63], 2, v188
    v_alignbit_b32 v113, v100, v113, 28
    v_alignbit_b32 v114, v101, v114, 28
    v_alignbit_b32 v115, v102, v115, 28
    v_and_b32 v113, 0xff4, v113
    v_and_b32 v114, 0xff4, v114
    v_and_b32 v115, 0xff4, v115
    s_mov_b64 exec, s[58:59]
    ds_add_rtn_u32 v229, v113, v171 offset:2312
    s_mov_b64 exec, s[60:61]
    ds_add_rtn_u32 v230, v114, v171 offset:2312
    s_mov_b64 exec, s[62:63]
    ds_add_rtn_u32 v231, v115, v171 offset:2312
    s_mov_b64 exec, -1
    v_max3_u32 v188, v91, v95, v99
    v_max_u32 v188, v188, v103
    v_cmp_le_u32 vcc, 553648128, v188
    s_cbranch_vccnz K2_XT1
K2_XT1R:
    s_lshr_b32 s4, s3, 1
    s_add_u32 s4, s4, 60
    s_waitcnt lgkmcnt(0)
    s_barrier
    ds_read_b128 v[128:131], v172 offset:5376
    ds_read_b128 v[236:239], v247
    ds_read_b32 v240, v251
    ds_read_u8 v250, v249
    ds_read_b128 v[116:119], v172 offset:2304
    ds_read_b128 v[120:123], v172 offset:3328
    ds_read_b128 v[124:127], v172 offset:4352
    ds_read_b64 v[194:195], v200 offset:2304
    s_bitcmp1_b32 s3, 0
    s_cbranch_scc0 K2_NOX1
    s_mul_i32 s10, s12, 196
    s_add_u32 s10, s10, s96
    s_lshl_b32 s10, s10, 7
    s_mul_i32 s11, s7, 4160
    s_add_u32 m0, s11, 69120
    s_add_u32 s86, s10, 0
    buffer_load_dwordx4 v234, s[16:19], s86 offen lds
    s_add_u32 m0, s11, 70160
    s_add_u32 s86, s10, 1024
    buffer_load_dwordx4 v234, s[16:19], s86 offen lds
    s_add_u32 m0, s11, 71200
    s_add_u32 s86, s10, 2048
    buffer_load_dwordx4 v234, s[16:19], s86 offen lds
    s_add_u32 m0, s11, 72240
    s_add_u32 s86, s10, 3072
    buffer_load_dwordx4 v234, s[16:19], s86 offen lds
K2_NOX1:
    s_waitcnt lgkmcnt(5)
    v_readlane_b32 s68, v128, s4
    v_and_b32 v95, 0x0f0f0f, v95
    v_and_b32 v99, 0x0f0f0f, v99
    s_and_b32 s68, s68, 0xffff
    s_bitcmp1_b32 s3, 0
    s_cselect_b32 s68, s68, 0
    s_cmp_ge_u32 s68, 128
    s_cselect_b32 s69, 1, 0
    s_cbranch_scc0 K2_NOQ
    s_add_u32 m0, s74, 0
    v_mad_u32_u16 v236, v236, s75, v241 op_sel:[1,0,0,0]
    buffer_load_dwordx4 v236, s[16:19], 0 offen lds
    s_add_u32 m0, s74, 1040
    v_mad_u32_u16 v237, v237, s75, v241 op_sel:[1,0,0,0]
    buffer_load_dwordx4 v237, s[16:19], 0 offen lds
    s_add_u32 m0, s74, 2080
    v_mad_u32_u16 v238, v238, s75, v241 op_sel:[1,0,0,0]
    buffer_load_dwordx4 v238, s[16:19], 0 offen lds
    s_add_u32 m0, s74, 3120
    v_mad_u32_u16 v239, v239, s75, v241 op_sel:[1,0,0,0]
    buffer_load_dwordx4 v239, s[16:19], 0 offen lds
    s_add_u32 m0, s74, 4160
    v_add_u32 v240, v240, v242
    buffer_load_dwordx4 v240, s[20:23], 0 offen lds
K2_NOQ:
    v_add_u32_sdwa v191, v128, v129 dst_sel:DWORD dst_unused:UNUSED_PAD src0_sel:WORD_0 src1_sel:WORD_0
    v_add_u32_sdwa v128, v130, v131 dst_sel:DWORD dst_unused:UNUSED_PAD src0_sel:WORD_0 src1_sel:WORD_0
    v_add_u32 v191, v191, v128
    s_waitcnt lgkmcnt(3)
    v_add_u32_sdwa v188, v116, v117 dst_sel:DWORD dst_unused:UNUSED_PAD src0_sel:WORD_0 src1_sel:WORD_0
    v_add_u32_sdwa v116, v118, v119 dst_sel:DWORD dst_unused:UNUSED_PAD src0_sel:WORD_0 src1_sel:WORD_0
    v_add_u32 v188, v188, v116
    s_waitcnt lgkmcnt(2)
    v_add_u32_sdwa v189, v120, v121 dst_sel:DWORD dst_unused:UNUSED_PAD src0_sel:WORD_0 src1_sel:WORD_0
    v_add_u32_sdwa v120, v122, v123 dst_sel:DWORD dst_unused:UNUSED_PAD src0_sel:WORD_0 src1_sel:WORD_0
    v_add_u32 v189, v189, v120
    s_waitcnt lgkmcnt(1)
    v_add_u32_sdwa v190, v124, v125 dst_sel:DWORD dst_unused:UNUSED_PAD src0_sel:WORD_0 src1_sel:WORD_0
    v_add_u32_sdwa v124, v126, v127 dst_sel:DWORD dst_unused:UNUSED_PAD src0_sel:WORD_0 src1_sel:WORD_0
    v_add_u32 v190, v190, v124
    v_lshl_or_b32 v192, v189, 16, v188
    v_lshl_or_b32 v193, v191, 16, v190
    s_waitcnt lgkmcnt(0)
    v_perm_b32 v198, v195, v194, s67
    v_add_u32_dpp v192, v192, v192 row_shr:1 row_mask:0xf bank_mask:0xf bound_ctrl:0
    v_add_u32_dpp v193, v193, v193 row_shr:1 row_mask:0xf bank_mask:0xf bound_ctrl:0
    v_and_b32 v103, 0x0f0f0f, v103
    v_add_u32_dpp v192, v192, v192 row_shr:2 row_mask:0xf bank_mask:0xf bound_ctrl:0
    v_add_u32_dpp v193, v193, v193 row_shr:2 row_mask:0xf bank_mask:0xf bound_ctrl:0
    v_perm_b32 v155, v95, v92, s64
    v_add_u32_dpp v192, v192, v192 row_shr:4 row_mask:0xf bank_mask:0xf bound_ctrl:0
    v_add_u32_dpp v193, v193, v193 row_shr:4 row_mask:0xf bank_mask:0xf bound_ctrl:0
    v_perm_b32 v156, v95, v93, s65
    v_add_u32_dpp v192, v192, v192 row_shr:8 row_mask:0xf bank_mask:0xf bound_ctrl:0
    v_add_u32_dpp v193, v193, v193 row_shr:8 row_mask:0xf bank_mask:0xf bound_ctrl:0
    v_perm_b32 v157, v95, v94, s66
    v_add_u32_dpp v192, v192, v192 row_bcast:15 row_mask:0xa bank_mask:0xf
    v_add_u32_dpp v193, v193, v193 row_bcast:15 row_mask:0xa bank_mask:0xf
    v_perm_b32 v158, v99, v96, s64
    v_add_u32_dpp v192, v192, v192 row_bcast:31 row_mask:0xc bank_mask:0xf
    v_add_u32_dpp v193, v193, v193 row_bcast:31 row_mask:0xc bank_mask:0xf
    v_perm_b32 v159, v99, v97, s65
    s_sub_u32 s4, s4, 1
    v_readlane_b32 s10, v192, 63
    v_readlane_b32 s11, v193, 63
    v_readlane_b32 s14, v193, 59
    v_readlane_b32 s86, v193, s4
    v_lshlrev_b32_sdwa v116, v169, v192 dst_sel:DWORD dst_unused:UNUSED_PAD src0_sel:DWORD src1_sel:WORD_0
    v_sub_u32 v188, v116, v188
    v_lshlrev_b32_sdwa v117, v169, v192 dst_sel:DWORD dst_unused:UNUSED_PAD src0_sel:DWORD src1_sel:WORD_1
    v_sub_u32 v189, v117, v189
    v_lshlrev_b32_sdwa v118, v169, v193 dst_sel:DWORD dst_unused:UNUSED_PAD src0_sel:DWORD src1_sel:WORD_0
    v_sub_u32 v190, v118, v190
    s_and_b32 s4, s10, 0xffff
    s_lshr_b32 s10, s10, 16
    s_add_u32 s5, s4, s10
    s_and_b32 s10, s11, 0xffff
    s_add_u32 s10, s5, s10
    s_lshr_b32 s11, s11, 16
    s_add_u32 s10, s10, s11
    s_lshr_b32 s14, s14, 16
    s_lshr_b32 s86, s86, 16
    s_sub_u32 s6, s86, s14
    s_lshl_b32 s6, s6, 1
    v_lshl_add_u32 v189, s4, 1, v189
    v_lshl_add_u32 v190, s5, 1, v190
    s_sub_i32 s37, 12800, s10
    s_ashr_i32 s37, s37, 7
    s_max_i32 s37, s37, 1
    s_min_i32 s37, s37, 4
    s_lshr_b32 s11, s10, 5
    s_add_u32 s11, s11, 16
    s_and_b32 s11, s11, -32
    s_cmp_ge_i32 s37, 1
    s_cselect_b32 s13, 42, 10
    s_sub_i32 s11, s11, s13
    s_lshl_b32 s11, s11, 3
    s_lshr_b32 s10, s10, 1
    s_lshr_b32 s13, s3, 1
    s_mul_i32 s13, s13, s10
    s_sub_i32 s13, s13, s6
    s_sub_i32 s10, s10, s68
    s_sub_i32 s10, s10, s68
    s_add_i32 s11, s11, s13
    s_add_i32 s10, s10, s13
    s_bitcmp1_b32 s3, 0
    s_cselect_b32 s15, s11, s13
    s_cselect_b32 s10, s10, s11
    s_mov_b32 s13, 0
    s_mov_b32 s14, 0
    v_cmp_gt_i32 vcc, s15, v188
    v_cmp_gt_i32 s[86:87], s10, v188
    s_bcnt1_i32_b64 s11, vcc
    s_add_u32 s13, s13, s11
    s_bcnt1_i32_b64 s11, s[86:87]
    s_add_u32 s14, s14, s11
    v_cmp_gt_i32 vcc, s15, v189
    v_cmp_gt_i32 s[86:87], s10, v189
    s_bcnt1_i32_b64 s11, vcc
    s_add_u32 s13, s13, s11
    s_bcnt1_i32_b64 s11, s[86:87]
    s_add_u32 s14, s14, s11
    v_cmp_gt_i32 vcc, s15, v190
    v_cmp_gt_i32 s[86:87], s10, v190
    s_bcnt1_i32_b64 s11, vcc
    s_add_u32 s13, s13, s11
    s_bcnt1_i32_b64 s11, s[86:87]
    s_add_u32 s14, s14, s11
    s_max_i32 s13, s13, s72
    s_min_i32 s13, s13, s73
    s_max_i32 s14, s14, s84
    s_min_i32 s14, s14, s85
    v_cmp_le_u32 vcc, s13, v199
    v_cmp_gt_u32 s[10:11], s14, v199
    s_nop 0
    s_and_b64 vcc, vcc, s[10:11]
    v_cndmask_b32 v198, 0, v198, vcc
    v_mov_b32 v196, v198
    v_perm_b32 v160, v99, v98, s66
    v_perm_b32 v161, v103, v100, s64
    v_add_u32_dpp v196, v196, v196 row_shr:1 row_mask:0xf bank_mask:0xf bound_ctrl:0
    v_perm_b32 v162, v103, v101, s65
    v_perm_b32 v163, v103, v102, s66
    v_add_u32_dpp v196, v196, v196 row_shr:2 row_mask:0xf bank_mask:0xf bound_ctrl:0
    v_lshl_add_u32 v155, v155, 5, v209
    v_lshl_add_u32 v156, v156, 5, v209
    v_add_u32_dpp v196, v196, v196 row_shr:4 row_mask:0xf bank_mask:0xf bound_ctrl:0
    v_lshl_add_u32 v157, v157, 5, v209
    v_lshl_add_u32 v158, v158, 5, v210
    v_add_u32_dpp v196, v196, v196 row_shr:8 row_mask:0xf bank_mask:0xf bound_ctrl:0
    v_lshl_add_u32 v159, v159, 5, v210
    v_lshl_add_u32 v160, v160, 5, v210
    v_add_u32_dpp v196, v196, v196 row_bcast:15 row_mask:0xa bank_mask:0xf
    v_lshl_add_u32 v161, v161, 5, v211
    v_lshl_add_u32 v162, v162, 5, v211
    v_lshl_add_u32 v163, v163, 5, v211
    s_sub_u32 s86, s76, 9728
    s_add_u32 s86, s86, s68
    v_readlane_b32 s10, v196, 31
    v_readlane_b32 s11, v196, 63
    v_sub_u32 v196, v196, v198
    v_mov_b32 v253, v202
    s_and_b32 s4, s10, 0xffff
    s_lshr_b32 s10, s10, 16
    s_add_u32 s5, s4, s10
    s_and_b32 s10, s11, 0xffff
    s_add_u32 s6, s5, s10
    s_lshr_b32 s11, s11, 16
    s_add_u32 s15, s6, s11
    s_lshl_b32 s10, s4, 16
    s_pack_ll_b32_b16 s11, s5, s6
    s_pack_ll_b32_b16 s86, s86, s86
    s_add_u32 s10, s10, s86
    s_add_u32 s11, s11, s86
    s_mov_b32 exec_lo, vcc_lo
    s_mov_b32 exec_hi, 0
    v_add_u32 v196, s10, v196
    s_mov_b32 exec_lo, 0
    s_mov_b32 exec_hi, vcc_hi
    v_add_u32 v196, s11, v196
    s_mov_b64 exec, vcc
    ds_write_b16 v200, v196 offset:2306
    ds_write_b16_d16_hi v200, v196 offset:2310
    ds_write_b32 v213, v212 offset:6400
    s_mov_b64 exec, -1
    v_mov_b32 v197, 2176
    s_add_u32 s15, s15, s68
    s_add_u32 s68, s68, 64
    s_cmp_le_u32 s15, 2176
    s_cbranch_scc1 K2_LFIT
    ds_write_b32 v197, v197
    s_mov_b32 s15, 0
K2_LFIT:
    s_add_u32 s15, s15, s76
    s_add_i32 s4, s4, s68
    s_lshr_b32 s4, s4, 7
    s_add_i32 s5, s5, s68
    s_lshr_b32 s5, s5, 7
    s_add_i32 s6, s6, s68
    s_lshr_b32 s6, s6, 7
    v_mov_b32 v190, 0xffff0000
    v_or_b32 v189, s39, v190
    v_mov_b32 v190, 0x7fffff00
    v_lshl_add_u32 v188, v254, 2, s15
    s_sub_u32 s73, s15, s76
    ds_write2st64_b32 v188, v189, v190 offset0:0 offset1:84
    ds_write2st64_b32 v188, v189, v190 offset0:1 offset1:85
    s_add_u32 s73, s73, 127
    s_lshr_b32 s73, s73, 7
    s_sub_i32 s38, s73, 1
    v_mov_b32 v188, s15
    ds_write_b32 v212, v188 offset:2112
    s_waitcnt lgkmcnt(0)
    s_barrier
    ds_read_b64 v[194:195], v197
    s_mov_b64 exec, s[40:41]
    ds_read_u16 v104, v104 offset:2306
    s_mov_b64 exec, s[42:43]
    ds_read_u16 v105, v105 offset:2306
    s_mov_b64 exec, s[44:45]
    ds_read_u16 v106, v106 offset:2306
    s_mov_b64 exec, s[46:47]
    ds_read_u16 v107, v107 offset:2306
    s_mov_b64 exec, s[48:49]
    ds_read_u16 v108, v108 offset:2306
    s_mov_b64 exec, s[50:51]
    ds_read_u16 v109, v109 offset:2306
    s_mov_b64 exec, s[52:53]
    ds_read_u16 v110, v110 offset:2314
    s_mov_b64 exec, s[54:55]
    ds_read_u16 v111, v111 offset:2314
    s_mov_b64 exec, s[56:57]
    ds_read_u16 v112, v112 offset:2314
    s_mov_b64 exec, s[58:59]
    ds_read_u16 v113, v113 offset:2314
    s_mov_b64 exec, s[60:61]
    ds_read_u16 v114, v114 offset:2314
    s_mov_b64 exec, s[62:63]
    ds_read_u16 v115, v115 offset:2314
    s_mov_b64 exec, -1
    s_waitcnt lgkmcnt(0)
    v_readfirstlane_b32 s83, v194
    v_readfirstlane_b32 s80, v195
    v_add_u32 v104, v104, v220
    v_add_u32 v105, v105, v221
    v_add_u32 v106, v106, v222
    v_add_u32 v107, v107, v223
    v_add_u32 v108, v108, v224
    v_add_u32 v109, v109, v225
    v_add_u32 v110, v110, v226
    v_add_u32 v111, v111, v227
    v_add_u32 v112, v112, v228
    v_add_u32 v113, v113, v229
    v_add_u32 v114, v114, v230
    v_add_u32 v115, v115, v231
    s_cmp_gt_u32 s83, 64
    s_cbranch_scc1 K2_OVF
    s_mov_b64 exec, s[40:41]
    ds_write2st64_b32 v104, v88, v152 offset0:38 offset1:122
    s_mov_b64 exec, s[42:43]
    ds_write2st64_b32 v105, v89, v153 offset0:38 offset1:122
    s_mov_b64 exec, s[44:45]
    ds_write2st64_b32 v106, v90, v154 offset0:38 offset1:122
    s_mov_b64 exec, s[46:47]
    ds_write2st64_b32 v107, v92, v155 offset0:38 offset1:122
    s_mov_b64 exec, s[48:49]
    ds_write2st64_b32 v108, v93, v156 offset0:38 offset1:122
    s_mov_b64 exec, s[50:51]
    ds_write2st64_b32 v109, v94, v157 offset0:38 offset1:122
    s_mov_b64 exec, s[52:53]
    ds_write2st64_b32 v110, v96, v158 offset0:38 offset1:122
    s_mov_b64 exec, s[54:55]
    ds_write2st64_b32 v111, v97, v159 offset0:38 offset1:122
    s_mov_b64 exec, s[56:57]
    ds_write2st64_b32 v112, v98, v160 offset0:38 offset1:122
    s_mov_b64 exec, s[58:59]
    ds_write2st64_b32 v113, v100, v161 offset0:38 offset1:122
    s_mov_b64 exec, s[60:61]
    ds_write2st64_b32 v114, v101, v162 offset0:38 offset1:122
    s_mov_b64 exec, s[62:63]
    ds_write2st64_b32 v115, v102, v163 offset0:38 offset1:122
    s_mov_b64 exec, -1
K2_PADS0:
    s_add_u32 s10, s37, 2
    s_cmp_gt_u32 s73, s10
    s_cselect_b32 s1, s3, 0
    s_sub_u32 s10, s13, s96
    s_mul_i32 s10, s10, 144
    s_add_u32 s70, s10, s74
    s_mul_i32 s10, s12, 196
    s_add_u32 s11, s10, s14
    s_add_u32 s10, s10, s13
    s_min_u32 s11, s11, 50000
    s_min_u32 s10, s10, 50000
    s_sub_u32 s11, s11, s10
    s_lshl_b32 s10, s10, 7
    s_add_u32 s28, s28, s10
    s_addc_u32 s29, s29, 0
    s_lshl_b32 s30, s11, 7
    s_mov_b32 s79, -1
    s_mov_b64 s[84:85], 0
    s_mov_b32 s81, 0
    s_mov_b32 s82, 0
    s_cmp_lg_u32 s80, 0
    s_cselect_b32 s78, 1, 0
    s_and_b32 s69, s69, s1
    s_cmp_gt_u32 s69, s97
    s_cbranch_scc0 K2_SIDE
    s_waitcnt vmcnt(5) lgkmcnt(0)
    ds_read_b128 v[152:155], v235 offset:0
    ds_read_b128 v[156:159], v235 offset:16
    ds_read_b128 v[160:163], v235 offset:32
    ds_read_b128 v[164:167], v235 offset:48
    v_add_u32 v172, 8192, v172
    ds_read_b128 v[88:91], v172 offset:52736
    ds_read_b128 v[92:95], v172 offset:53760
    ds_read_b128 v[96:99], v172 offset:54784
    ds_read_b128 v[100:103], v172 offset:55808
    ds_read_b128 v[104:107], v172 offset:56832
    ds_read_b128 v[108:111], v172 offset:57856
    ds_read_b128 v[112:115], v172 offset:58880
    ds_read_b128 v[116:119], v172 offset:59904
    s_mov_b32 s10, 0x358637bd
    s_mov_b32 s11, s10
    v_mfma_f32_32x32x16_bf16 v[136:151], v[180:183], v[180:183], 0
    v_mov_b64 v[120:121], s[10:11]
    v_mov_b64 v[122:123], s[10:11]
    v_mov_b64 v[124:125], s[10:11]
    v_mov_b64 v[126:127], s[10:11]
    v_mov_b64 v[128:129], s[10:11]
    v_mov_b64 v[130:131], s[10:11]
    v_mov_b64 v[132:133], s[10:11]
    v_mov_b64 v[134:135], s[10:11]
    s_waitcnt lgkmcnt(7)
    v_mfma_f32_32x32x16_bf16 v[188:203], v[152:155], v[88:91], 0
    s_waitcnt lgkmcnt(6)
    v_mfma_f32_32x32x16_bf16 v[188:203], v[156:159], v[92:95], v[188:203]
    s_waitcnt lgkmcnt(5)
    v_mfma_f32_32x32x16_bf16 v[188:203], v[160:163], v[96:99], v[188:203]
    s_waitcnt lgkmcnt(4)
    v_mfma_f32_32x32x16_bf16 v[188:203], v[164:167], v[100:103], v[188:203]
    s_waitcnt lgkmcnt(3)
    v_mfma_f32_32x32x16_bf16 v[204:219], v[152:155], v[104:107], 0
    s_waitcnt lgkmcnt(2)
    v_mfma_f32_32x32x16_bf16 v[204:219], v[156:159], v[108:111], v[204:219]
    s_waitcnt lgkmcnt(1)
    v_mfma_f32_32x32x16_bf16 v[204:219], v[160:163], v[112:115], v[204:219]
    s_waitcnt lgkmcnt(0)
    v_mfma_f32_32x32x16_bf16 v[204:219], v[164:167], v[116:119], v[204:219]
    s_barrier
    v_mfma_f32_32x32x16_bf16 v[104:119], v[180:183], v[180:183], 0
    s_mov_b32 s10, 0x358637bd
    s_mov_b32 s11, s10
    v_mov_b64 v[88:89], s[10:11]
    v_mov_b64 v[90:91], s[10:11]
    v_mov_b64 v[92:93], s[10:11]
    v_mov_b64 v[94:95], s[10:11]
    v_mov_b64 v[96:97], s[10:11]
    v_mov_b64 v[98:99], s[10:11]
    v_mov_b64 v[100:101], s[10:11]
    v_mov_b64 v[102:103], s[10:11]
    v_cvt_pk_bf16_f32 v72, v188, v189
    v_cvt_pk_bf16_f32 v73, v190, v191
    v_cvt_pk_bf16_f32 v74, v192, v193
    v_cvt_pk_bf16_f32 v75, v194, v195
    v_cvt_pk_bf16_f32 v76, v196, v197
    v_cvt_pk_bf16_f32 v77, v198, v199
    v_cvt_pk_bf16_f32 v78, v200, v201
    v_cvt_pk_bf16_f32 v79, v202, v203
    v_cvt_pk_bf16_f32 v80, v204, v205
    v_cvt_pk_bf16_f32 v81, v206, v207
    v_cvt_pk_bf16_f32 v82, v208, v209
    v_cvt_pk_bf16_f32 v83, v210, v211
    v_cvt_pk_bf16_f32 v84, v212, v213
    v_cvt_pk_bf16_f32 v85, v214, v215
    v_cvt_pk_bf16_f32 v86, v216, v217
    v_cvt_pk_bf16_f32 v87, v218, v219
    s_branch K2_HAD0
K2_SIDE:
    s_bitcmp1_b32 s3, 0
    s_cbranch_scc1 K2_NOX2
    s_mul_i32 s10, s12, 196
    s_add_u32 s10, s10, s96
    s_lshl_b32 s10, s10, 7
    s_mul_i32 s11, s7, 4160
    s_add_u32 m0, s11, 69120
    s_add_u32 s86, s10, 0
    buffer_load_dwordx4 v234, s[16:19], s86 offen lds
    s_add_u32 m0, s11, 70160
    s_add_u32 s86, s10, 1024
    buffer_load_dwordx4 v234, s[16:19], s86 offen lds
    s_add_u32 m0, s11, 71200
    s_add_u32 s86, s10, 2048
    buffer_load_dwordx4 v234, s[16:19], s86 offen lds
    s_add_u32 m0, s11, 72240
    s_add_u32 s86, s10, 3072
    buffer_load_dwordx4 v234, s[16:19], s86 offen lds
K2_NOX2:
    s_waitcnt vmcnt(5) lgkmcnt(0)
    s_barrier
    s_cmp_lg_u32 s69, 0
    s_cbranch_scc1 K2_SIDE1
    s_waitcnt vmcnt(4)
    s_bitcmp1_b32 s3, 0
    s_cbranch_scc0 K2_SIDE1
    s_waitcnt vmcnt(0)
    s_bitcmp1_b32 s1, 0
    s_cbranch_scc0 K2_SIDE1
    ds_read_b128 v[236:239], v247
    ds_read_b32 v240, v251
    ds_read_u8 v250, v249
    s_waitcnt lgkmcnt(1)
    s_add_u32 m0, s74, 0
    v_mad_u32_u16 v236, v236, s75, v241 op_sel:[1,0,0,0]
    buffer_load_dwordx4 v236, s[16:19], 0 offen lds
    s_add_u32 m0, s74, 1040
    v_mad_u32_u16 v237, v237, s75, v241 op_sel:[1,0,0,0]
    buffer_load_dwordx4 v237, s[16:19], 0 offen lds
    s_add_u32 m0, s74, 2080
    v_mad_u32_u16 v238, v238, s75, v241 op_sel:[1,0,0,0]
    buffer_load_dwordx4 v238, s[16:19], 0 offen lds
    s_add_u32 m0, s74, 3120
    v_mad_u32_u16 v239, v239, s75, v241 op_sel:[1,0,0,0]
    buffer_load_dwordx4 v239, s[16:19], 0 offen lds
    s_add_u32 m0, s74, 4160
    v_add_u32 v240, v240, v242
    buffer_load_dwordx4 v240, s[20:23], 0 offen lds
K2_SIDE1:
    s_cmp_lg_u32 s97, 0
    s_cbranch_scc1 K2_XT2
K2_XT2R:
    s_bitcmp1_b32 s1, 0
    s_cbranch_scc1 K2_SIDE2
    s_barrier
    s_cmp_eq_u32 s83, 0
    s_cbranch_scc1 K2_NEy
    s_lshl_b32 s10, s3, 2
    v_mov_b32 v178, s10
    ds_read_b32 v178, v178 offset:2112
    s_waitcnt lgkmcnt(0)
    v_readfirstlane_b32 s15, v178
    s_nop 3
    s_sub_u32 s73, s15, s76
    s_add_u32 s73, s73, 127
    s_lshr_b32 s73, s73, 7
    s_sub_i32 s38, s73, 1
K2_NEy:
    ds_read_b128 v[236:239], v247
    ds_read_b32 v240, v251
    ds_read_u8 v250, v249
    s_waitcnt lgkmcnt(1)
    s_add_u32 m0, s74, 0
    v_mad_u32_u16 v236, v236, s75, v241 op_sel:[1,0,0,0]
    buffer_load_dwordx4 v236, s[16:19], 0 offen lds
    s_add_u32 m0, s74, 1040
    v_mad_u32_u16 v237, v237, s75, v241 op_sel:[1,0,0,0]
    buffer_load_dwordx4 v237, s[16:19], 0 offen lds
    s_add_u32 m0, s74, 2080
    v_mad_u32_u16 v238, v238, s75, v241 op_sel:[1,0,0,0]
    buffer_load_dwordx4 v238, s[16:19], 0 offen lds
    s_add_u32 m0, s74, 3120
    v_mad_u32_u16 v239, v239, s75, v241 op_sel:[1,0,0,0]
    buffer_load_dwordx4 v239, s[16:19], 0 offen lds
    s_add_u32 m0, s74, 4160
    v_add_u32 v240, v240, v242
    buffer_load_dwordx4 v240, s[20:23], 0 offen lds
K2_SIDE2:
    s_waitcnt vmcnt(5) lgkmcnt(0)
    ds_read_b128 v[152:155], v235 offset:0
    ds_read_b128 v[156:159], v235 offset:16
    ds_read_b128 v[160:163], v235 offset:32
    ds_read_b128 v[164:167], v235 offset:48
    v_add_u32 v172, 8192, v172
    ds_read_b128 v[88:91], v172 offset:52736
    ds_read_b128 v[92:95], v172 offset:53760
    ds_read_b128 v[96:99], v172 offset:54784
    ds_read_b128 v[100:103], v172 offset:55808
    ds_read_b128 v[104:107], v172 offset:56832
    ds_read_b128 v[108:111], v172 offset:57856
    ds_read_b128 v[112:115], v172 offset:58880
    ds_read_b128 v[116:119], v172 offset:59904
    s_mov_b32 s10, 0x358637bd
    s_mov_b32 s11, s10
    v_mfma_f32_32x32x16_bf16 v[136:151], v[180:183], v[180:183], 0
    v_mov_b64 v[120:121], s[10:11]
    v_mov_b64 v[122:123], s[10:11]
    v_mov_b64 v[124:125], s[10:11]
    v_mov_b64 v[126:127], s[10:11]
    v_mov_b64 v[128:129], s[10:11]
    v_mov_b64 v[130:131], s[10:11]
    v_mov_b64 v[132:133], s[10:11]
    v_mov_b64 v[134:135], s[10:11]
    s_waitcnt lgkmcnt(7)
    v_mfma_f32_32x32x16_bf16 v[188:203], v[152:155], v[88:91], 0
    s_waitcnt lgkmcnt(6)
    v_mfma_f32_32x32x16_bf16 v[188:203], v[156:159], v[92:95], v[188:203]
    s_waitcnt lgkmcnt(5)
    v_mfma_f32_32x32x16_bf16 v[188:203], v[160:163], v[96:99], v[188:203]
    s_waitcnt lgkmcnt(4)
    v_mfma_f32_32x32x16_bf16 v[188:203], v[164:167], v[100:103], v[188:203]
    s_waitcnt lgkmcnt(3)
    v_mfma_f32_32x32x16_bf16 v[204:219], v[152:155], v[104:107], 0
    s_waitcnt lgkmcnt(2)
    v_mfma_f32_32x32x16_bf16 v[204:219], v[156:159], v[108:111], v[204:219]
    s_waitcnt lgkmcnt(1)
    v_mfma_f32_32x32x16_bf16 v[204:219], v[160:163], v[112:115], v[204:219]
    s_waitcnt lgkmcnt(0)
    v_mfma_f32_32x32x16_bf16 v[204:219], v[164:167], v[116:119], v[204:219]
    v_mfma_f32_32x32x16_bf16 v[104:119], v[180:183], v[180:183], 0
    s_mov_b32 s10, 0x358637bd
    s_mov_b32 s11, s10
    v_mov_b64 v[88:89], s[10:11]
    v_mov_b64 v[90:91], s[10:11]
    v_mov_b64 v[92:93], s[10:11]
    v_mov_b64 v[94:95], s[10:11]
    v_mov_b64 v[96:97], s[10:11]
    v_mov_b64 v[98:99], s[10:11]
    v_mov_b64 v[100:101], s[10:11]
    v_mov_b64 v[102:103], s[10:11]
    v_cvt_pk_bf16_f32 v72, v188, v189
    v_cvt_pk_bf16_f32 v73, v190, v191
    v_cvt_pk_bf16_f32 v74, v192, v193
    v_cvt_pk_bf16_f32 v75, v194, v195
    v_cvt_pk_bf16_f32 v76, v196, v197
    v_cvt_pk_bf16_f32 v77, v198, v199
    v_cvt_pk_bf16_f32 v78, v200, v201
    v_cvt_pk_bf16_f32 v79, v202, v203
    v_cvt_pk_bf16_f32 v80, v204, v205
    v_cvt_pk_bf16_f32 v81, v206, v207
    v_cvt_pk_bf16_f32 v82, v208, v209
    v_cvt_pk_bf16_f32 v83, v210, v211
    v_cvt_pk_bf16_f32 v84, v212, v213
    v_cvt_pk_bf16_f32 v85, v214, v215
    v_cvt_pk_bf16_f32 v86, v216, v217
    v_cvt_pk_bf16_f32 v87, v218, v219
    s_branch K2_HAD0
K2_GO:
    ds_read_b128 v[236:239], v247
    ds_read_b32 v240, v251
    ds_read_u8 v250, v249
    s_waitcnt lgkmcnt(1)
    s_add_u32 m0, s74, 0
    v_mad_u32_u16 v236, v236, s75, v241 op_sel:[1,0,0,0]
    buffer_load_dwordx4 v236, s[16:19], 0 offen lds
    s_add_u32 m0, s74, 1040
    v_mad_u32_u16 v237, v237, s75, v241 op_sel:[1,0,0,0]
    buffer_load_dwordx4 v237, s[16:19], 0 offen lds
    s_add_u32 m0, s74, 2080
    v_mad_u32_u16 v238, v238, s75, v241 op_sel:[1,0,0,0]
    buffer_load_dwordx4 v238, s[16:19], 0 offen lds
    s_add_u32 m0, s74, 3120
    v_mad_u32_u16 v239, v239, s75, v241 op_sel:[1,0,0,0]
    buffer_load_dwordx4 v239, s[16:19], 0 offen lds
    s_add_u32 m0, s74, 4160
    v_add_u32 v240, v240, v242
    buffer_load_dwordx4 v240, s[20:23], 0 offen lds
K2_HAD0:
    s_waitcnt lgkmcnt(0)
    v_lshl_add_u32 v250, v250, 6, v245
    ds_read_b128 v[236:239], v247 offset:128
    ds_read_b32 v240, v251 offset:128
    ds_read_b128 v[172:175], v250 offset:7424
    ds_read_b32 v176, v250 offset:7440
    v_mfma_f32_32x32x16_bf16 v[204:219], v[180:183], v[180:183], 0
    s_waitcnt vmcnt(0)
    ds_read_b128 v[168:171], v244
    ds_read_b128 v[152:155], v243 offset:0
    ds_read_b128 v[156:159], v243 offset:16
    ds_read_b128 v[160:163], v243 offset:32
    ds_read_b128 v[164:167], v243 offset:48
    s_waitcnt lgkmcnt(0)
    s_add_u32 m0, s74, 0
    v_mad_u32_u16 v236, v236, s75, v241 op_sel:[1,0,0,0]
    buffer_load_dwordx4 v236, s[16:19], 0 offen lds
    s_add_u32 m0, s74, 1040
    v_mad_u32_u16 v237, v237, s75, v241 op_sel:[1,0,0,0]
    buffer_load_dwordx4 v237, s[16:19], 0 offen lds
    s_add_u32 m0, s74, 2080
    v_mad_u32_u16 v238, v238, s75, v241 op_sel:[1,0,0,0]
    buffer_load_dwordx4 v238, s[16:19], 0 offen lds
    s_add_u32 m0, s74, 3120
    v_mad_u32_u16 v239, v239, s75, v241 op_sel:[1,0,0,0]
    buffer_load_dwordx4 v239, s[16:19], 0 offen lds
    s_add_u32 m0, s74, 4160
    v_add_u32 v240, v240, v242
    buffer_load_dwordx4 v240, s[20:23], 0 offen lds
    s_cmp_lt_i32 s37, 0
    s_cbranch_scc1 K2_B1
    s_barrier
    s_bitcmp1_b32 s1, 0
    s_cselect_b32 s37, s37, -1
    s_cbranch_scc0 K2_B1
    s_cmp_eq_u32 s83, 0
    s_cbranch_scc1 K2_NEo
    s_lshl_b32 s10, s3, 2
    v_mov_b32 v178, s10
    ds_read_b32 v178, v178 offset:2112
    s_waitcnt lgkmcnt(0)
    v_readfirstlane_b32 s15, v178
    s_nop 3
    s_sub_u32 s73, s15, s76
    s_add_u32 s73, s73, 127
    s_lshr_b32 s73, s73, 7
    s_sub_i32 s38, s73, 1
K2_NEo:
K2_B1:
    s_cmp_lg_u32 s73, 0
    s_cbranch_scc1 K2_NZ
    s_waitcnt vmcnt(0)
    s_branch K2_DONE
K2_NZ:
    v_mfma_f32_32x32x16_bf16 v[188:203], v[168:171], v[64:67], 0
    v_mfma_f32_32x32x16_bf16 v[188:203], v[152:155], v[0:3], v[188:203]
    v_mfma_f32_32x32x16_bf16 v[188:203], v[156:159], v[4:7], v[188:203]
    v_mfma_f32_32x32x16_bf16 v[188:203], v[160:163], v[8:11], v[188:203]
    v_mfma_f32_32x32x16_bf16 v[188:203], v[164:167], v[12:15], v[188:203]
    s_nop 9
    v_smfmac_f32_32x32x32_bf16 v[188:203], v[172:175], v[72:79], v176
    s_mov_b32 s72, 0
    s_sub_u32 s10, s73, 1
    s_bitcmp1_b32 s3, 0
    s_cselect_b32 s6, s6, s10
    s_setprio 3
    s_mov_b32 s87, s73
    s_cmp_gt_i32 s4, s72
    s_cselect_b32 s10, s4, s87
    s_min_u32 s87, s87, s10
    s_cmp_gt_i32 s5, s72
    s_cselect_b32 s10, s5, s87
    s_min_u32 s87, s87, s10
    s_cmp_gt_i32 s6, s72
    s_cselect_b32 s10, s6, s87
    s_min_u32 s87, s87, s10
    s_cmp_gt_i32 s37, s72
    s_cselect_b32 s10, s37, s87
    s_min_u32 s87, s87, s10
    s_cmp_gt_i32 s38, s72
    s_cselect_b32 s10, s38, s87
    s_min_u32 s87, s87, s10
.p2align 6
K2_LOOP:
    v_smfmac_f32_32x32x32_bf16 v[136:151], v[180:183], v[204:211], v177
    ds_read_u8 v236, v248 offset:0
    ds_read_u8 v237, v248 offset:16
    ds_read_u8 v238, v248 offset:64
    ds_read_u8 v239, v248 offset:80
    ds_read_u8 v250, v249 offset:128
    v_exp_f32 v188, v188
    v_exp_f32 v189, v189
    v_exp_f32 v190, v190
    v_add_f32 v188, 1.0, v188
    v_smfmac_f32_32x32x32_bf16 v[136:151], v[184:187], v[212:219], v177
    v_exp_f32 v191, v191
    v_add_f32 v189, 1.0, v189
    v_exp_f32 v192, v192
    v_add_f32 v190, 1.0, v190
    v_rcp_f32 v188, v188
    v_mfma_f32_32x32x16_bf16 v[220:235], v[168:171], v[68:71], 0
    v_exp_f32 v193, v193
    v_add_f32 v191, 1.0, v191
    v_rcp_f32 v189, v189
    v_exp_f32 v194, v194
    v_mfma_f32_32x32x16_bf16 v[204:219], v[152:155], v[32:35], 0
    v_add_f32 v192, 1.0, v192
    v_rcp_f32 v190, v190
    v_exp_f32 v195, v195
    v_mfma_f32_32x32x16_bf16 v[204:219], v[156:159], v[36:39], v[204:219]
    s_waitcnt lgkmcnt(0)
    v_lshl_add_u32 v236, v236, 6, v246
    v_lshl_add_u32 v237, v237, 6, v246
    v_lshl_add_u32 v238, v238, 6, v246
    v_lshl_add_u32 v239, v239, 6, v246
    v_lshl_add_u32 v250, v250, 6, v245
    v_add_f32 v193, 1.0, v193
    v_rcp_f32 v191, v191
    v_exp_f32 v196, v196
    v_add_f32 v194, 1.0, v194
    v_rcp_f32 v192, v192
    v_smfmac_f32_32x32x32_bf16 v[220:235], v[172:175], v[80:87], v176
    ds_read_b64_tr_b16 v[180:181], v236
    ds_read_b64_tr_b16 v[182:183], v237
    ds_read_b64_tr_b16 v[184:185], v238
    ds_read_b64_tr_b16 v[186:187], v239
    ds_read_b128 v[172:175], v250 offset:7424
    ds_read_b32 v176, v250 offset:7440
    v_exp_f32 v197, v197
    v_add_f32 v195, 1.0, v195
    v_rcp_f32 v193, v193
    v_exp_f32 v198, v198
    v_mfma_f32_32x32x16_bf16 v[204:219], v[160:163], v[40:43], v[204:219]
    v_add_f32 v196, 1.0, v196
    v_rcp_f32 v194, v194
    v_exp_f32 v199, v199
    v_add_f32 v197, 1.0, v197
    v_mfma_f32_32x32x16_bf16 v[204:219], v[164:167], v[44:47], v[204:219]
    v_rcp_f32 v195, v195
    v_exp_f32 v200, v200
    v_add_f32 v198, 1.0, v198
    v_rcp_f32 v196, v196
    v_mfma_f32_32x32x16_bf16 v[220:235], v[152:155], v[16:19], v[220:235]
    ds_read_b128 v[236:239], v247 offset:256
    ds_read_b32 v240, v251 offset:256
    s_add_u32 s72, s72, 1
    v_exp_f32 v201, v201
    v_add_f32 v199, 1.0, v199
    v_rcp_f32 v197, v197
    v_exp_f32 v202, v202
    v_mfma_f32_32x32x16_bf16 v[220:235], v[156:159], v[20:23], v[220:235]
    v_add_f32 v200, 1.0, v200
    v_rcp_f32 v198, v198
    v_exp_f32 v203, v203
    v_add_f32 v201, 1.0, v201
    v_mfma_f32_32x32x16_bf16 v[220:235], v[160:163], v[24:27], v[220:235]
    v_rcp_f32 v199, v199
    v_add_f32 v202, 1.0, v202
    v_rcp_f32 v200, v200
    v_add_f32 v203, 1.0, v203
    v_rcp_f32 v201, v201
    v_mfma_f32_32x32x16_bf16 v[220:235], v[164:167], v[28:31], v[220:235]
    v_rcp_f32 v202, v202
    v_rcp_f32 v203, v203
    v_mul_f32 v204, v188, v204
    v_mul_f32 v205, v189, v205
    s_waitcnt lgkmcnt(0)
    v_smfmac_f32_32x32x32_bf16 v[88:103], v[180:183], v[188:195], v177
    v_mul_f32 v206, v190, v206
    v_mul_f32 v207, v191, v207
    v_mul_f32 v208, v192, v208
    v_mul_f32 v209, v193, v209
    v_mul_f32 v210, v194, v210
    v_mul_f32 v211, v195, v211
    v_mul_f32 v212, v196, v212
    v_smfmac_f32_32x32x32_bf16 v[88:103], v[184:187], v[196:203], v177
    v_mul_f32 v213, v197, v213
    v_mul_f32 v214, v198, v214
    v_mul_f32 v215, v199, v215
    v_mul_f32 v216, v200, v216
    v_mul_f32 v217, v201, v217
    v_mul_f32 v218, v202, v218
    v_mul_f32 v219, v203, v219
    v_smfmac_f32_32x32x32_bf16 v[104:119], v[180:183], v[204:211], v177
    s_waitcnt vmcnt(0)
    ds_read_b128 v[168:171], v244
    v_exp_f32 v220, v220
    v_exp_f32 v221, v221
    v_exp_f32 v222, v222
    v_add_f32 v220, 1.0, v220
    v_smfmac_f32_32x32x32_bf16 v[104:119], v[184:187], v[212:219], v177
    v_exp_f32 v223, v223
    v_add_f32 v221, 1.0, v221
    v_exp_f32 v224, v224
    v_add_f32 v222, 1.0, v222
    v_rcp_f32 v220, v220
    s_waitcnt lgkmcnt(0)
    v_mfma_f32_32x32x16_bf16 v[188:203], v[168:171], v[64:67], 0
    v_exp_f32 v225, v225
    v_add_f32 v223, 1.0, v223
    v_rcp_f32 v221, v221
    v_exp_f32 v226, v226
    v_mfma_f32_32x32x16_bf16 v[204:219], v[152:155], v[48:51], 0
    ds_read_b128 v[152:155], v243 offset:0
    v_add_f32 v224, 1.0, v224
    v_rcp_f32 v222, v222
    v_exp_f32 v227, v227
    v_mfma_f32_32x32x16_bf16 v[204:219], v[156:159], v[52:55], v[204:219]
    ds_read_b128 v[156:159], v243 offset:16
    v_add_f32 v225, 1.0, v225
    v_rcp_f32 v223, v223
    v_exp_f32 v228, v228
    v_add_f32 v226, 1.0, v226
    v_rcp_f32 v224, v224
    v_smfmac_f32_32x32x32_bf16 v[188:203], v[172:175], v[72:79], v176
    v_exp_f32 v229, v229
    v_add_f32 v227, 1.0, v227
    v_rcp_f32 v225, v225
    v_exp_f32 v230, v230
    v_mfma_f32_32x32x16_bf16 v[204:219], v[160:163], v[56:59], v[204:219]
    ds_read_b128 v[160:163], v243 offset:32
    v_add_f32 v228, 1.0, v228
    v_rcp_f32 v226, v226
    v_exp_f32 v231, v231
    v_add_f32 v229, 1.0, v229
    v_mfma_f32_32x32x16_bf16 v[204:219], v[164:167], v[60:63], v[204:219]
    ds_read_b128 v[164:167], v243 offset:48
    v_rcp_f32 v227, v227
    v_exp_f32 v232, v232
    v_add_f32 v230, 1.0, v230
    v_rcp_f32 v228, v228
    s_waitcnt lgkmcnt(3)
    v_mfma_f32_32x32x16_bf16 v[188:203], v[152:155], v[0:3], v[188:203]
    v_exp_f32 v233, v233
    v_add_f32 v231, 1.0, v231
    v_rcp_f32 v229, v229
    v_exp_f32 v234, v234
    s_waitcnt lgkmcnt(2)
    v_mfma_f32_32x32x16_bf16 v[188:203], v[156:159], v[4:7], v[188:203]
    v_add_f32 v232, 1.0, v232
    v_rcp_f32 v230, v230
    v_exp_f32 v235, v235
    v_add_f32 v233, 1.0, v233
    s_waitcnt lgkmcnt(1)
    v_mfma_f32_32x32x16_bf16 v[188:203], v[160:163], v[8:11], v[188:203]
    v_rcp_f32 v231, v231
    v_add_f32 v234, 1.0, v234
    v_rcp_f32 v232, v232
    v_add_f32 v235, 1.0, v235
    v_rcp_f32 v233, v233
    s_waitcnt lgkmcnt(0)
    v_mfma_f32_32x32x16_bf16 v[188:203], v[164:167], v[12:15], v[188:203]
    s_cmp_lt_i32 s72, s38
    s_cbranch_scc0 K2_ND_0
    s_add_u32 m0, s74, 0
    v_mad_u32_u16 v236, v236, s75, v241 op_sel:[1,0,0,0]
    buffer_load_dwordx4 v236, s[16:19], 0 offen lds
    s_add_u32 m0, s74, 1040
    v_mad_u32_u16 v237, v237, s75, v241 op_sel:[1,0,0,0]
    buffer_load_dwordx4 v237, s[16:19], 0 offen lds
    s_add_u32 m0, s74, 2080
    v_mad_u32_u16 v238, v238, s75, v241 op_sel:[1,0,0,0]
    buffer_load_dwordx4 v238, s[16:19], 0 offen lds
    s_add_u32 m0, s74, 3120
    v_mad_u32_u16 v239, v239, s75, v241 op_sel:[1,0,0,0]
    buffer_load_dwordx4 v239, s[16:19], 0 offen lds
    s_add_u32 m0, s74, 4160
    v_add_u32 v240, v240, v242
    buffer_load_dwordx4 v240, s[20:23], 0 offen lds
K2_ND_0:
    v_rcp_f32 v234, v234
    v_rcp_f32 v235, v235
    v_mul_f32 v204, v220, v204
    v_mul_f32 v205, v221, v205
    v_smfmac_f32_32x32x32_bf16 v[120:135], v[180:183], v[220:227], v177
    v_mul_f32 v206, v222, v206
    v_mul_f32 v207, v223, v207
    v_mul_f32 v208, v224, v208
    v_mul_f32 v209, v225, v209
    v_mul_f32 v210, v226, v210
    v_mul_f32 v211, v227, v211
    v_mul_f32 v212, v228, v212
    v_smfmac_f32_32x32x32_bf16 v[120:135], v[184:187], v[228:235], v177
    v_mul_f32 v213, v229, v213
    v_mul_f32 v214, v230, v214
    v_mul_f32 v215, v231, v215
    v_mul_f32 v216, v232, v216
    v_mul_f32 v217, v233, v217
    v_mul_f32 v218, v234, v218
    v_mul_f32 v219, v235, v219
    s_cmp_ge_u32 s72, s87
    s_cbranch_scc1 K2_EV0
K2_EVR0:
    v_smfmac_f32_32x32x32_bf16 v[136:151], v[180:183], v[204:211], v177
    ds_read_u8 v236, v248 offset:128
    ds_read_u8 v237, v248 offset:144
    ds_read_u8 v238, v248 offset:192
    ds_read_u8 v239, v248 offset:208
    ds_read_u8 v250, v249 offset:256
    v_exp_f32 v188, v188
    v_exp_f32 v189, v189
    v_exp_f32 v190, v190
    v_add_f32 v188, 1.0, v188
    v_smfmac_f32_32x32x32_bf16 v[136:151], v[184:187], v[212:219], v177
    v_exp_f32 v191, v191
    v_add_f32 v189, 1.0, v189
    v_exp_f32 v192, v192
    v_add_f32 v190, 1.0, v190
    v_rcp_f32 v188, v188
    v_mfma_f32_32x32x16_bf16 v[220:235], v[168:171], v[68:71], 0
    v_exp_f32 v193, v193
    v_add_f32 v191, 1.0, v191
    v_rcp_f32 v189, v189
    v_exp_f32 v194, v194
    v_mfma_f32_32x32x16_bf16 v[204:219], v[152:155], v[32:35], 0
    v_add_f32 v192, 1.0, v192
    v_rcp_f32 v190, v190
    v_exp_f32 v195, v195
    v_mfma_f32_32x32x16_bf16 v[204:219], v[156:159], v[36:39], v[204:219]
    s_waitcnt lgkmcnt(0)
    v_lshl_add_u32 v236, v236, 6, v246
    v_lshl_add_u32 v237, v237, 6, v246
    v_lshl_add_u32 v238, v238, 6, v246
    v_lshl_add_u32 v239, v239, 6, v246
    v_lshl_add_u32 v250, v250, 6, v245
    v_add_f32 v193, 1.0, v193
    v_rcp_f32 v191, v191
    v_exp_f32 v196, v196
    v_add_f32 v194, 1.0, v194
    v_rcp_f32 v192, v192
    v_smfmac_f32_32x32x32_bf16 v[220:235], v[172:175], v[80:87], v176
    ds_read_b64_tr_b16 v[180:181], v236
    ds_read_b64_tr_b16 v[182:183], v237
    ds_read_b64_tr_b16 v[184:185], v238
    ds_read_b64_tr_b16 v[186:187], v239
    ds_read_b128 v[172:175], v250 offset:7424
    ds_read_b32 v176, v250 offset:7440
    v_exp_f32 v197, v197
    v_add_f32 v195, 1.0, v195
    v_rcp_f32 v193, v193
    v_exp_f32 v198, v198
    v_mfma_f32_32x32x16_bf16 v[204:219], v[160:163], v[40:43], v[204:219]
    v_add_f32 v196, 1.0, v196
    v_rcp_f32 v194, v194
    v_exp_f32 v199, v199
    v_add_f32 v197, 1.0, v197
    v_mfma_f32_32x32x16_bf16 v[204:219], v[164:167], v[44:47], v[204:219]
    v_rcp_f32 v195, v195
    v_exp_f32 v200, v200
    v_add_f32 v198, 1.0, v198
    v_rcp_f32 v196, v196
    v_mfma_f32_32x32x16_bf16 v[220:235], v[152:155], v[16:19], v[220:235]
    ds_read_b128 v[236:239], v247 offset:384
    ds_read_b32 v240, v251 offset:384
    s_add_u32 s72, s72, 1
    v_exp_f32 v201, v201
    v_add_f32 v199, 1.0, v199
    v_rcp_f32 v197, v197
    v_exp_f32 v202, v202
    v_mfma_f32_32x32x16_bf16 v[220:235], v[156:159], v[20:23], v[220:235]
    v_add_f32 v200, 1.0, v200
    v_rcp_f32 v198, v198
    v_exp_f32 v203, v203
    v_add_f32 v201, 1.0, v201
    v_mfma_f32_32x32x16_bf16 v[220:235], v[160:163], v[24:27], v[220:235]
    v_rcp_f32 v199, v199
    v_add_f32 v202, 1.0, v202
    v_rcp_f32 v200, v200
    v_add_f32 v203, 1.0, v203
    v_rcp_f32 v201, v201
    v_mfma_f32_32x32x16_bf16 v[220:235], v[164:167], v[28:31], v[220:235]
    v_rcp_f32 v202, v202
    v_rcp_f32 v203, v203
    v_mul_f32 v204, v188, v204
    v_mul_f32 v205, v189, v205
    s_waitcnt lgkmcnt(0)
    v_smfmac_f32_32x32x32_bf16 v[88:103], v[180:183], v[188:195], v177
    v_mul_f32 v206, v190, v206
    v_mul_f32 v207, v191, v207
    v_mul_f32 v208, v192, v208
    v_mul_f32 v209, v193, v209
    v_mul_f32 v210, v194, v210
    v_mul_f32 v211, v195, v211
    v_mul_f32 v212, v196, v212
    v_smfmac_f32_32x32x32_bf16 v[88:103], v[184:187], v[196:203], v177
    v_mul_f32 v213, v197, v213
    v_mul_f32 v214, v198, v214
    v_mul_f32 v215, v199, v215
    v_mul_f32 v216, v200, v216
    v_mul_f32 v217, v201, v217
    v_mul_f32 v218, v202, v218
    v_mul_f32 v219, v203, v219
    v_smfmac_f32_32x32x32_bf16 v[104:119], v[180:183], v[204:211], v177
    s_waitcnt vmcnt(0)
    ds_read_b128 v[168:171], v244
    v_exp_f32 v220, v220
    v_exp_f32 v221, v221
    v_exp_f32 v222, v222
    v_add_f32 v220, 1.0, v220
    v_smfmac_f32_32x32x32_bf16 v[104:119], v[184:187], v[212:219], v177
    v_exp_f32 v223, v223
    v_add_f32 v221, 1.0, v221
    v_exp_f32 v224, v224
    v_add_f32 v222, 1.0, v222
    v_rcp_f32 v220, v220
    s_waitcnt lgkmcnt(0)
    v_mfma_f32_32x32x16_bf16 v[188:203], v[168:171], v[64:67], 0
    v_exp_f32 v225, v225
    v_add_f32 v223, 1.0, v223
    v_rcp_f32 v221, v221
    v_exp_f32 v226, v226
    v_mfma_f32_32x32x16_bf16 v[204:219], v[152:155], v[48:51], 0
    ds_read_b128 v[152:155], v243 offset:0
    v_add_f32 v224, 1.0, v224
    v_rcp_f32 v222, v222
    v_exp_f32 v227, v227
    v_mfma_f32_32x32x16_bf16 v[204:219], v[156:159], v[52:55], v[204:219]
    ds_read_b128 v[156:159], v243 offset:16
    v_add_f32 v225, 1.0, v225
    v_rcp_f32 v223, v223
    v_exp_f32 v228, v228
    v_add_f32 v226, 1.0, v226
    v_rcp_f32 v224, v224
    v_smfmac_f32_32x32x32_bf16 v[188:203], v[172:175], v[72:79], v176
    v_exp_f32 v229, v229
    v_add_f32 v227, 1.0, v227
    v_rcp_f32 v225, v225
    v_exp_f32 v230, v230
    v_mfma_f32_32x32x16_bf16 v[204:219], v[160:163], v[56:59], v[204:219]
    ds_read_b128 v[160:163], v243 offset:32
    v_add_f32 v228, 1.0, v228
    v_rcp_f32 v226, v226
    v_exp_f32 v231, v231
    v_add_f32 v229, 1.0, v229
    v_mfma_f32_32x32x16_bf16 v[204:219], v[164:167], v[60:63], v[204:219]
    ds_read_b128 v[164:167], v243 offset:48
    v_rcp_f32 v227, v227
    v_exp_f32 v232, v232
    v_add_f32 v230, 1.0, v230
    v_rcp_f32 v228, v228
    s_waitcnt lgkmcnt(3)
    v_mfma_f32_32x32x16_bf16 v[188:203], v[152:155], v[0:3], v[188:203]
    v_exp_f32 v233, v233
    v_add_f32 v231, 1.0, v231
    v_rcp_f32 v229, v229
    v_exp_f32 v234, v234
    s_waitcnt lgkmcnt(2)
    v_mfma_f32_32x32x16_bf16 v[188:203], v[156:159], v[4:7], v[188:203]
    v_add_f32 v232, 1.0, v232
    v_rcp_f32 v230, v230
    v_exp_f32 v235, v235
    v_add_f32 v233, 1.0, v233
    s_waitcnt lgkmcnt(1)
    v_mfma_f32_32x32x16_bf16 v[188:203], v[160:163], v[8:11], v[188:203]
    v_rcp_f32 v231, v231
    v_add_f32 v234, 1.0, v234
    v_rcp_f32 v232, v232
    v_add_f32 v235, 1.0, v235
    v_rcp_f32 v233, v233
    s_waitcnt lgkmcnt(0)
    v_mfma_f32_32x32x16_bf16 v[188:203], v[164:167], v[12:15], v[188:203]
    s_cmp_lt_i32 s72, s38
    s_cbranch_scc0 K2_ND_1
    s_add_u32 m0, s74, 0
    v_mad_u32_u16 v236, v236, s75, v241 op_sel:[1,0,0,0]
    buffer_load_dwordx4 v236, s[16:19], 0 offen lds
    s_add_u32 m0, s74, 1040
    v_mad_u32_u16 v237, v237, s75, v241 op_sel:[1,0,0,0]
    buffer_load_dwordx4 v237, s[16:19], 0 offen lds
    s_add_u32 m0, s74, 2080
    v_mad_u32_u16 v238, v238, s75, v241 op_sel:[1,0,0,0]
    buffer_load_dwordx4 v238, s[16:19], 0 offen lds
    s_add_u32 m0, s74, 3120
    v_mad_u32_u16 v239, v239, s75, v241 op_sel:[1,0,0,0]
    buffer_load_dwordx4 v239, s[16:19], 0 offen lds
    s_add_u32 m0, s74, 4160
    v_add_u32 v240, v240, v242
    buffer_load_dwordx4 v240, s[20:23], 0 offen lds
K2_ND_1:
    v_rcp_f32 v234, v234
    v_rcp_f32 v235, v235
    v_mul_f32 v204, v220, v204
    v_mul_f32 v205, v221, v205
    v_smfmac_f32_32x32x32_bf16 v[120:135], v[180:183], v[220:227], v177
    v_mul_f32 v206, v222, v206
    v_mul_f32 v207, v223, v207
    v_mul_f32 v208, v224, v208
    v_mul_f32 v209, v225, v209
    v_mul_f32 v210, v226, v210
    v_mul_f32 v211, v227, v211
    v_mul_f32 v212, v228, v212
    v_smfmac_f32_32x32x32_bf16 v[120:135], v[184:187], v[228:235], v177
    v_mul_f32 v213, v229, v213
    v_mul_f32 v214, v230, v214
    v_mul_f32 v215, v231, v215
    v_mul_f32 v216, v232, v216
    v_mul_f32 v217, v233, v217
    v_mul_f32 v218, v234, v218
    v_mul_f32 v219, v235, v219
    v_add_u32 v247, 0x100, v247
    v_add_u32 v249, 0x100, v249
    v_add_u32 v251, 0x100, v251
    v_add_u32 v248, 0x100, v248
    s_cmp_lt_u32 s72, s87
    s_cbranch_scc1 K2_LOOP
    s_cmp_ge_u32 s72, s73
    s_cbranch_scc1 K2_TAIL
    s_cmp_lg_u32 s72, s37
    s_cbranch_scc1 K2_SB1
    s_barrier
    s_mov_b32 s37, -1
K2_SB1:
    s_cmp_lg_u32 s72, s4
    s_cbranch_scc1 K2_PR1_0
    s_setprio 2
K2_PR1_0:
    s_cmp_lg_u32 s72, s5
    s_cbranch_scc1 K2_PR1_1
    s_setprio 1
K2_PR1_1:
    s_cmp_lg_u32 s72, s6
    s_cbranch_scc1 K2_PR1_2
    s_setprio 0
K2_PR1_2:
    s_lshl_b32 s10, s78, 8
    s_add_u32 s10, s10, s38
    s_cmp_eq_u32 s72, s10
    s_cbranch_scc1 K2_LT1
    s_mov_b32 s87, s73
    s_cmp_gt_i32 s4, s72
    s_cselect_b32 s10, s4, s87
    s_min_u32 s87, s87, s10
    s_cmp_gt_i32 s5, s72
    s_cselect_b32 s10, s5, s87
    s_min_u32 s87, s87, s10
    s_cmp_gt_i32 s6, s72
    s_cselect_b32 s10, s6, s87
    s_min_u32 s87, s87, s10
    s_cmp_gt_i32 s37, s72
    s_cselect_b32 s10, s37, s87
    s_min_u32 s87, s87, s10
    s_cmp_gt_i32 s38, s72
    s_cselect_b32 s10, s38, s87
    s_min_u32 s87, s87, s10
    s_branch K2_LOOP
K2_EV0:
    s_cmp_ge_u32 s72, s73
    s_cbranch_scc1 K2_TAIL
    s_cmp_lg_u32 s72, s37
    s_cbranch_scc1 K2_SB0
    s_barrier
    s_mov_b32 s37, -1
K2_SB0:
    s_cmp_lg_u32 s72, s4
    s_cbranch_scc1 K2_PR0_0
    s_setprio 2
K2_PR0_0:
    s_cmp_lg_u32 s72, s5
    s_cbranch_scc1 K2_PR0_1
    s_setprio 1
K2_PR0_1:
    s_cmp_lg_u32 s72, s6
    s_cbranch_scc1 K2_PR0_2
    s_setprio 0
K2_PR0_2:
    s_lshl_b32 s10, s78, 8
    s_add_u32 s10, s10, s38
    s_cmp_eq_u32 s72, s10
    s_cbranch_scc1 K2_LT0
    s_mov_b32 s87, s73
    s_cmp_gt_i32 s4, s72
    s_cselect_b32 s10, s4, s87
    s_min_u32 s87, s87, s10
    s_cmp_gt_i32 s5, s72
    s_cselect_b32 s10, s5, s87
    s_min_u32 s87, s87, s10
    s_cmp_gt_i32 s6, s72
    s_cselect_b32 s10, s6, s87
    s_min_u32 s87, s87, s10
    s_cmp_gt_i32 s37, s72
    s_cselect_b32 s10, s37, s87
    s_min_u32 s87, s87, s10
    s_cmp_gt_i32 s38, s72
    s_cselect_b32 s10, s38, s87
    s_min_u32 s87, s87, s10
    s_branch K2_EVR0
K2_LT0:
    v_add_u32 v248, 128, v248
K2_LT1:
    s_sub_u32 s10, s15, s76
    s_sub_u32 s10, s10, 4
    s_and_b32 s10, s10, 127
    s_cmp_lt_u32 s10, 32
    s_cbranch_scc1 K2_LG1
    s_cmp_lt_u32 s10, 64
    s_cbranch_scc1 K2_LG2
    s_cmp_lt_u32 s10, 96
    s_cbranch_scc1 K2_LG3
    v_smfmac_f32_32x32x32_bf16 v[136:151], v[180:183], v[204:211], v177
    ds_read_u8 v236, v248 offset:0
    ds_read_u8 v237, v248 offset:16
    ds_read_u8 v238, v248 offset:64
    ds_read_u8 v239, v248 offset:80
    v_exp_f32 v188, v188
    v_exp_f32 v189, v189
    v_exp_f32 v190, v190
    v_add_f32 v188, 1.0, v188
    v_smfmac_f32_32x32x32_bf16 v[136:151], v[184:187], v[212:219], v177
    v_lshlrev_b32 v252, 4, v254
    v_and_b32 v247, 31, v254
    v_and_b32 v245, 32, v254
    v_mul_u32_u24 v249, 144, v247
    v_lshrrev_b32 v251, 2, v245
    v_lshl_add_u32 v247, v247, 6, v251
    v_lshl_add_u32 v249, v245, 1, v249
    v_add_u32 v249, s74, v249
    v_lshrrev_b32 v251, 3, v254
    v_lshl_add_u32 v251, v251, 4, v252
    v_add_u32 v251, s70, v251
    v_exp_f32 v191, v191
    v_add_f32 v189, 1.0, v189
    v_exp_f32 v192, v192
    v_add_f32 v190, 1.0, v190
    v_rcp_f32 v188, v188
    v_mfma_f32_32x32x16_bf16 v[220:235], v[168:171], v[68:71], 0
    v_exp_f32 v193, v193
    v_add_f32 v191, 1.0, v191
    v_rcp_f32 v189, v189
    v_exp_f32 v194, v194
    v_mfma_f32_32x32x16_bf16 v[204:219], v[152:155], v[32:35], 0
    v_add_f32 v192, 1.0, v192
    v_rcp_f32 v190, v190
    v_exp_f32 v195, v195
    v_mfma_f32_32x32x16_bf16 v[204:219], v[156:159], v[36:39], v[204:219]
    s_waitcnt lgkmcnt(0)
    v_lshl_add_u32 v236, v236, 6, v246
    v_lshl_add_u32 v237, v237, 6, v246
    v_lshl_add_u32 v238, v238, 6, v246
    v_lshl_add_u32 v239, v239, 6, v246
    v_add_f32 v193, 1.0, v193
    v_rcp_f32 v191, v191
    v_exp_f32 v196, v196
    v_add_f32 v194, 1.0, v194
    v_rcp_f32 v192, v192
    v_smfmac_f32_32x32x32_bf16 v[220:235], v[172:175], v[80:87], v176
    ds_read_b64_tr_b16 v[180:181], v236
    ds_read_b64_tr_b16 v[182:183], v237
    ds_read_b64_tr_b16 v[184:185], v238
    ds_read_b64_tr_b16 v[186:187], v239
    v_exp_f32 v197, v197
    v_add_f32 v195, 1.0, v195
    v_rcp_f32 v193, v193
    v_exp_f32 v198, v198
    v_mfma_f32_32x32x16_bf16 v[204:219], v[160:163], v[40:43], v[204:219]
    v_add_f32 v196, 1.0, v196
    v_rcp_f32 v194, v194
    v_exp_f32 v199, v199
    v_add_f32 v197, 1.0, v197
    v_mfma_f32_32x32x16_bf16 v[204:219], v[164:167], v[44:47], v[204:219]
    v_rcp_f32 v195, v195
    v_exp_f32 v200, v200
    v_add_f32 v198, 1.0, v198
    v_rcp_f32 v196, v196
    v_mfma_f32_32x32x16_bf16 v[220:235], v[152:155], v[16:19], v[220:235]
    v_exp_f32 v201, v201
    v_add_f32 v199, 1.0, v199
    v_rcp_f32 v197, v197
    v_exp_f32 v202, v202
    v_mfma_f32_32x32x16_bf16 v[220:235], v[156:159], v[20:23], v[220:235]
    v_add_f32 v200, 1.0, v200
    v_rcp_f32 v198, v198
    v_exp_f32 v203, v203
    v_add_f32 v201, 1.0, v201
    v_mfma_f32_32x32x16_bf16 v[220:235], v[160:163], v[24:27], v[220:235]
    v_rcp_f32 v199, v199
    v_add_f32 v202, 1.0, v202
    v_rcp_f32 v200, v200
    v_add_f32 v203, 1.0, v203
    v_rcp_f32 v201, v201
    v_mfma_f32_32x32x16_bf16 v[220:235], v[164:167], v[28:31], v[220:235]
    ds_read2_b64 v[64:67], v247 offset0:0 offset1:2
    ds_read2_b64 v[68:71], v247 offset0:4 offset1:6
    ds_read_b128 v[0:3], v252 offset:52736
    ds_read_b128 v[4:7], v252 offset:53760
    ds_read_b128 v[8:11], v252 offset:54784
    ds_read_b128 v[12:15], v252 offset:55808
    ds_read_b128 v[16:19], v252 offset:56832
    ds_read_b128 v[20:23], v252 offset:57856
    ds_read_b128 v[24:27], v252 offset:58880
    ds_read_b128 v[28:31], v252 offset:59904
    v_rcp_f32 v202, v202
    v_rcp_f32 v203, v203
    v_mul_f32 v204, v188, v204
    v_mul_f32 v205, v189, v205
    s_waitcnt lgkmcnt(10)
    v_smfmac_f32_32x32x32_bf16 v[88:103], v[180:183], v[188:195], v177
    v_mul_f32 v206, v190, v206
    v_mul_f32 v207, v191, v207
    v_mul_f32 v208, v192, v208
    v_mul_f32 v209, v193, v209
    v_mul_f32 v210, v194, v210
    v_mul_f32 v211, v195, v211
    v_mul_f32 v212, v196, v212
    v_smfmac_f32_32x32x32_bf16 v[88:103], v[184:187], v[196:203], v177
    v_mul_f32 v213, v197, v213
    v_mul_f32 v214, v198, v214
    v_mul_f32 v215, v199, v215
    v_mul_f32 v216, v200, v216
    v_mul_f32 v217, v201, v217
    v_mul_f32 v218, v202, v218
    v_mul_f32 v219, v203, v219
    v_smfmac_f32_32x32x32_bf16 v[104:119], v[180:183], v[204:211], v177
    v_exp_f32 v220, v220
    v_exp_f32 v221, v221
    v_exp_f32 v222, v222
    v_add_f32 v220, 1.0, v220
    v_exp_f32 v223, v223
    v_smfmac_f32_32x32x32_bf16 v[104:119], v[184:187], v[212:219], v177
    v_add_f32 v221, 1.0, v221
    v_exp_f32 v224, v224
    v_add_f32 v222, 1.0, v222
    v_rcp_f32 v220, v220
    v_exp_f32 v225, v225
    v_add_f32 v223, 1.0, v223
    v_mfma_f32_32x32x16_bf16 v[204:219], v[152:155], v[48:51], 0
    ds_read_b128 v[152:155], v253 offset:0
    v_rcp_f32 v221, v221
    v_exp_f32 v226, v226
    v_add_f32 v224, 1.0, v224
    v_rcp_f32 v222, v222
    v_exp_f32 v227, v227
    v_mfma_f32_32x32x16_bf16 v[204:219], v[156:159], v[52:55], v[204:219]
    ds_read_b128 v[156:159], v253 offset:16
    v_add_f32 v225, 1.0, v225
    v_rcp_f32 v223, v223
    v_exp_f32 v228, v228
    v_add_f32 v226, 1.0, v226
    v_rcp_f32 v224, v224
    v_exp_f32 v229, v229
    v_mfma_f32_32x32x16_bf16 v[204:219], v[160:163], v[56:59], v[204:219]
    ds_read_b128 v[160:163], v253 offset:32
    v_add_f32 v227, 1.0, v227
    v_rcp_f32 v225, v225
    v_exp_f32 v230, v230
    v_add_f32 v228, 1.0, v228
    v_rcp_f32 v226, v226
    v_mfma_f32_32x32x16_bf16 v[204:219], v[164:167], v[60:63], v[204:219]
    ds_read_b128 v[164:167], v253 offset:48
    v_exp_f32 v231, v231
    v_add_f32 v229, 1.0, v229
    v_rcp_f32 v227, v227
    v_exp_f32 v232, v232
    v_add_f32 v230, 1.0, v230
    v_rcp_f32 v228, v228
    v_exp_f32 v233, v233
    v_add_f32 v231, 1.0, v231
    v_rcp_f32 v229, v229
    v_exp_f32 v234, v234
    v_add_f32 v232, 1.0, v232
    v_rcp_f32 v230, v230
    v_exp_f32 v235, v235
    v_add_f32 v233, 1.0, v233
    v_rcp_f32 v231, v231
    v_add_f32 v234, 1.0, v234
    v_rcp_f32 v232, v232
    v_add_f32 v235, 1.0, v235
    v_rcp_f32 v233, v233
    v_rcp_f32 v234, v234
    v_rcp_f32 v235, v235
    v_mul_f32 v204, v220, v204
    v_mul_f32 v205, v221, v205
    v_smfmac_f32_32x32x32_bf16 v[120:135], v[180:183], v[220:227], v177
    v_mul_f32 v206, v222, v206
    v_mul_f32 v207, v223, v207
    v_mul_f32 v208, v224, v208
    v_mul_f32 v209, v225, v209
    v_mul_f32 v210, v226, v210
    v_mul_f32 v211, v227, v211
    v_mul_f32 v212, v228, v212
    v_smfmac_f32_32x32x32_bf16 v[120:135], v[184:187], v[228:235], v177
    v_mul_f32 v213, v229, v213
    v_mul_f32 v214, v230, v214
    v_mul_f32 v215, v231, v215
    v_mul_f32 v216, v232, v216
    v_mul_f32 v217, v233, v217
    v_mul_f32 v218, v234, v218
    v_mul_f32 v219, v235, v219
    v_smfmac_f32_32x32x32_bf16 v[136:151], v[180:183], v[204:211], v177
    s_nop 0
    v_smfmac_f32_32x32x32_bf16 v[136:151], v[184:187], v[212:219], v177
    s_branch K2_EPI2
K2_LG3:
    v_smfmac_f32_32x32x32_bf16 v[136:151], v[180:183], v[204:211], v177
    ds_read_u8 v236, v248 offset:0
    ds_read_u8 v237, v248 offset:16
    ds_read_u8 v238, v248 offset:64
    ds_read_u8 v239, v248 offset:80
    v_exp_f32 v188, v188
    v_exp_f32 v189, v189
    v_exp_f32 v190, v190
    v_smfmac_f32_32x32x32_bf16 v[136:151], v[184:187], v[212:219], v177
    v_lshlrev_b32 v252, 4, v254
    v_and_b32 v247, 31, v254
    v_and_b32 v245, 32, v254
    v_mul_u32_u24 v249, 144, v247
    v_lshrrev_b32 v251, 2, v245
    v_lshl_add_u32 v247, v247, 6, v251
    v_lshl_add_u32 v249, v245, 1, v249
    v_add_u32 v249, s74, v249
    v_lshrrev_b32 v251, 3, v254
    v_lshl_add_u32 v251, v251, 4, v252
    v_add_u32 v251, s70, v251
    v_add_f32 v188, 1.0, v188
    v_exp_f32 v191, v191
    v_add_f32 v189, 1.0, v189
    v_exp_f32 v192, v192
    v_mfma_f32_32x32x16_bf16 v[220:235], v[168:171], v[68:71], 0
    v_add_f32 v190, 1.0, v190
    v_rcp_f32 v188, v188
    v_exp_f32 v193, v193
    v_mfma_f32_32x32x16_bf16 v[204:219], v[152:155], v[32:35], 0
    v_add_f32 v191, 1.0, v191
    v_rcp_f32 v189, v189
    v_exp_f32 v194, v194
    v_mfma_f32_32x32x16_bf16 v[204:219], v[156:159], v[36:39], v[204:219]
    s_waitcnt lgkmcnt(0)
    v_lshl_add_u32 v236, v236, 6, v246
    v_lshl_add_u32 v237, v237, 6, v246
    v_lshl_add_u32 v238, v238, 6, v246
    v_lshl_add_u32 v239, v239, 6, v246
    v_add_f32 v192, 1.0, v192
    v_rcp_f32 v190, v190
    v_exp_f32 v195, v195
    v_smfmac_f32_32x32x32_bf16 v[220:235], v[172:175], v[80:87], v176
    ds_read_b64_tr_b16 v[180:181], v236
    ds_read_b64_tr_b16 v[182:183], v237
    ds_read_b64_tr_b16 v[184:185], v238
    ds_read_b64_tr_b16 v[186:187], v239
    v_add_f32 v193, 1.0, v193
    v_rcp_f32 v191, v191
    v_exp_f32 v196, v196
    v_mfma_f32_32x32x16_bf16 v[204:219], v[160:163], v[40:43], v[204:219]
    v_add_f32 v194, 1.0, v194
    v_rcp_f32 v192, v192
    v_exp_f32 v197, v197
    v_mfma_f32_32x32x16_bf16 v[204:219], v[164:167], v[44:47], v[204:219]
    v_add_f32 v195, 1.0, v195
    v_rcp_f32 v193, v193
    v_exp_f32 v198, v198
    v_mfma_f32_32x32x16_bf16 v[220:235], v[152:155], v[16:19], v[220:235]
    v_add_f32 v196, 1.0, v196
    v_rcp_f32 v194, v194
    v_exp_f32 v199, v199
    v_mfma_f32_32x32x16_bf16 v[220:235], v[156:159], v[20:23], v[220:235]
    v_add_f32 v197, 1.0, v197
    v_rcp_f32 v195, v195
    v_add_f32 v198, 1.0, v198
    v_mfma_f32_32x32x16_bf16 v[220:235], v[160:163], v[24:27], v[220:235]
    v_rcp_f32 v196, v196
    v_add_f32 v199, 1.0, v199
    v_rcp_f32 v197, v197
    v_mfma_f32_32x32x16_bf16 v[220:235], v[164:167], v[28:31], v[220:235]
    ds_read2_b64 v[64:67], v247 offset0:0 offset1:2
    ds_read2_b64 v[68:71], v247 offset0:4 offset1:6
    ds_read_b128 v[0:3], v252 offset:52736
    ds_read_b128 v[4:7], v252 offset:53760
    ds_read_b128 v[8:11], v252 offset:54784
    ds_read_b128 v[12:15], v252 offset:55808
    ds_read_b128 v[16:19], v252 offset:56832
    ds_read_b128 v[20:23], v252 offset:57856
    ds_read_b128 v[24:27], v252 offset:58880
    ds_read_b128 v[28:31], v252 offset:59904
    v_rcp_f32 v198, v198
    v_rcp_f32 v199, v199
    v_mul_f32 v204, v188, v204
    v_mul_f32 v205, v189, v205
    s_waitcnt lgkmcnt(10)
    v_smfmac_f32_32x32x32_bf16 v[88:103], v[180:183], v[188:195], v177
    v_mul_f32 v206, v190, v206
    v_mul_f32 v207, v191, v207
    v_mul_f32 v208, v192, v208
    v_mul_f32 v209, v193, v209
    v_mul_f32 v210, v194, v210
    v_smfmac_f32_32x32x32_bf16 v[88:103], v[184:187], v[196:203], v177
    v_mul_f32 v211, v195, v211
    v_mul_f32 v212, v196, v212
    v_mul_f32 v213, v197, v213
    v_mul_f32 v214, v198, v214
    v_mul_f32 v215, v199, v215
    v_smfmac_f32_32x32x32_bf16 v[104:119], v[180:183], v[204:211], v177
    v_exp_f32 v220, v220
    v_exp_f32 v221, v221
    v_exp_f32 v222, v222
    v_add_f32 v220, 1.0, v220
    v_smfmac_f32_32x32x32_bf16 v[104:119], v[184:187], v[212:219], v177
    v_exp_f32 v223, v223
    v_add_f32 v221, 1.0, v221
    v_exp_f32 v224, v224
    v_add_f32 v222, 1.0, v222
    v_rcp_f32 v220, v220
    v_mfma_f32_32x32x16_bf16 v[204:219], v[152:155], v[48:51], 0
    ds_read_b128 v[152:155], v253 offset:0
    v_exp_f32 v225, v225
    v_add_f32 v223, 1.0, v223
    v_rcp_f32 v221, v221
    v_exp_f32 v226, v226
    v_mfma_f32_32x32x16_bf16 v[204:219], v[156:159], v[52:55], v[204:219]
    ds_read_b128 v[156:159], v253 offset:16
    v_add_f32 v224, 1.0, v224
    v_rcp_f32 v222, v222
    v_exp_f32 v227, v227
    v_mfma_f32_32x32x16_bf16 v[204:219], v[160:163], v[56:59], v[204:219]
    ds_read_b128 v[160:163], v253 offset:32
    v_add_f32 v225, 1.0, v225
    v_rcp_f32 v223, v223
    v_exp_f32 v228, v228
    v_add_f32 v226, 1.0, v226
    v_rcp_f32 v224, v224
    v_mfma_f32_32x32x16_bf16 v[204:219], v[164:167], v[60:63], v[204:219]
    ds_read_b128 v[164:167], v253 offset:48
    v_exp_f32 v229, v229
    v_add_f32 v227, 1.0, v227
    v_rcp_f32 v225, v225
    v_exp_f32 v230, v230
    v_add_f32 v228, 1.0, v228
    v_rcp_f32 v226, v226
    v_exp_f32 v231, v231
    v_add_f32 v229, 1.0, v229
    v_rcp_f32 v227, v227
    v_add_f32 v230, 1.0, v230
    v_rcp_f32 v228, v228
    v_add_f32 v231, 1.0, v231
    v_rcp_f32 v229, v229
    v_rcp_f32 v230, v230
    v_rcp_f32 v231, v231
    v_mul_f32 v204, v220, v204
    v_mul_f32 v205, v221, v205
    v_smfmac_f32_32x32x32_bf16 v[120:135], v[180:183], v[220:227], v177
    v_mul_f32 v206, v222, v206
    v_mul_f32 v207, v223, v207
    v_mul_f32 v208, v224, v208
    v_mul_f32 v209, v225, v209
    v_mul_f32 v210, v226, v210
    v_smfmac_f32_32x32x32_bf16 v[120:135], v[184:187], v[228:235], v177
    v_mul_f32 v211, v227, v211
    v_mul_f32 v212, v228, v212
    v_mul_f32 v213, v229, v213
    v_mul_f32 v214, v230, v214
    v_mul_f32 v215, v231, v215
    v_smfmac_f32_32x32x32_bf16 v[136:151], v[180:183], v[204:211], v177
    s_nop 0
    v_smfmac_f32_32x32x32_bf16 v[136:151], v[184:187], v[212:219], v177
    s_branch K2_EPI2
K2_LG2:
    v_smfmac_f32_32x32x32_bf16 v[136:151], v[180:183], v[204:211], v177
    ds_read_u8 v236, v248 offset:0
    ds_read_u8 v237, v248 offset:16
    ds_read_u8 v238, v248 offset:64
    ds_read_u8 v239, v248 offset:80
    v_exp_f32 v188, v188
    v_exp_f32 v189, v189
    v_smfmac_f32_32x32x32_bf16 v[136:151], v[184:187], v[212:219], v177
    v_lshlrev_b32 v252, 4, v254
    v_and_b32 v247, 31, v254
    v_and_b32 v245, 32, v254
    v_mul_u32_u24 v249, 144, v247
    v_lshrrev_b32 v251, 2, v245
    v_lshl_add_u32 v247, v247, 6, v251
    v_lshl_add_u32 v249, v245, 1, v249
    v_add_u32 v249, s74, v249
    v_lshrrev_b32 v251, 3, v254
    v_lshl_add_u32 v251, v251, 4, v252
    v_add_u32 v251, s70, v251
    v_exp_f32 v190, v190
    v_add_f32 v188, 1.0, v188
    v_mfma_f32_32x32x16_bf16 v[220:235], v[168:171], v[68:71], 0
    v_exp_f32 v191, v191
    v_add_f32 v189, 1.0, v189
    v_exp_f32 v192, v192
    v_mfma_f32_32x32x16_bf16 v[204:219], v[152:155], v[32:35], 0
    v_add_f32 v190, 1.0, v190
    v_rcp_f32 v188, v188
    v_mfma_f32_32x32x16_bf16 v[204:219], v[156:159], v[36:39], v[204:219]
    s_waitcnt lgkmcnt(0)
    v_lshl_add_u32 v236, v236, 6, v246
    v_lshl_add_u32 v237, v237, 6, v246
    v_lshl_add_u32 v238, v238, 6, v246
    v_lshl_add_u32 v239, v239, 6, v246
    v_exp_f32 v193, v193
    v_smfmac_f32_32x32x32_bf16 v[220:235], v[172:175], v[80:87], v176
    ds_read_b64_tr_b16 v[180:181], v236
    ds_read_b64_tr_b16 v[182:183], v237
    ds_read_b64_tr_b16 v[184:185], v238
    ds_read_b64_tr_b16 v[186:187], v239
    v_add_f32 v191, 1.0, v191
    v_rcp_f32 v189, v189
    v_exp_f32 v194, v194
    v_mfma_f32_32x32x16_bf16 v[204:219], v[160:163], v[40:43], v[204:219]
    v_add_f32 v192, 1.0, v192
    v_rcp_f32 v190, v190
    v_mfma_f32_32x32x16_bf16 v[204:219], v[164:167], v[44:47], v[204:219]
    v_exp_f32 v195, v195
    v_mfma_f32_32x32x16_bf16 v[220:235], v[152:155], v[16:19], v[220:235]
    v_add_f32 v193, 1.0, v193
    v_rcp_f32 v191, v191
    v_add_f32 v194, 1.0, v194
    v_mfma_f32_32x32x16_bf16 v[220:235], v[156:159], v[20:23], v[220:235]
    v_rcp_f32 v192, v192
    v_add_f32 v195, 1.0, v195
    v_mfma_f32_32x32x16_bf16 v[220:235], v[160:163], v[24:27], v[220:235]
    v_rcp_f32 v193, v193
    v_rcp_f32 v194, v194
    v_mfma_f32_32x32x16_bf16 v[220:235], v[164:167], v[28:31], v[220:235]
    ds_read2_b64 v[64:67], v247 offset0:0 offset1:2
    ds_read2_b64 v[68:71], v247 offset0:4 offset1:6
    ds_read_b128 v[0:3], v252 offset:52736
    ds_read_b128 v[4:7], v252 offset:53760
    ds_read_b128 v[8:11], v252 offset:54784
    ds_read_b128 v[12:15], v252 offset:55808
    ds_read_b128 v[16:19], v252 offset:56832
    ds_read_b128 v[20:23], v252 offset:57856
    ds_read_b128 v[24:27], v252 offset:58880
    ds_read_b128 v[28:31], v252 offset:59904
    v_rcp_f32 v195, v195
    v_mul_f32 v204, v188, v204
    v_mul_f32 v205, v189, v205
    v_mul_f32 v206, v190, v206
    s_waitcnt lgkmcnt(10)
    v_smfmac_f32_32x32x32_bf16 v[88:103], v[180:183], v[188:195], v177
    v_mul_f32 v207, v191, v207
    v_mul_f32 v208, v192, v208
    v_mul_f32 v209, v193, v209
    v_mul_f32 v210, v194, v210
    v_mul_f32 v211, v195, v211
    s_nop 1
    v_smfmac_f32_32x32x32_bf16 v[104:119], v[180:183], v[204:211], v177
    v_exp_f32 v220, v220
    v_exp_f32 v221, v221
    v_exp_f32 v222, v222
    v_mfma_f32_32x32x16_bf16 v[204:219], v[152:155], v[48:51], 0
    ds_read_b128 v[152:155], v253 offset:0
    v_add_f32 v220, 1.0, v220
    v_exp_f32 v223, v223
    v_add_f32 v221, 1.0, v221
    v_mfma_f32_32x32x16_bf16 v[204:219], v[156:159], v[52:55], v[204:219]
    ds_read_b128 v[156:159], v253 offset:16
    v_exp_f32 v224, v224
    v_add_f32 v222, 1.0, v222
    v_rcp_f32 v220, v220
    v_mfma_f32_32x32x16_bf16 v[204:219], v[160:163], v[56:59], v[204:219]
    ds_read_b128 v[160:163], v253 offset:32
    v_exp_f32 v225, v225
    v_add_f32 v223, 1.0, v223
    v_rcp_f32 v221, v221
    v_mfma_f32_32x32x16_bf16 v[204:219], v[164:167], v[60:63], v[204:219]
    ds_read_b128 v[164:167], v253 offset:48
    v_exp_f32 v226, v226
    v_add_f32 v224, 1.0, v224
    v_rcp_f32 v222, v222
    v_exp_f32 v227, v227
    v_add_f32 v225, 1.0, v225
    v_rcp_f32 v223, v223
    v_add_f32 v226, 1.0, v226
    v_rcp_f32 v224, v224
    v_add_f32 v227, 1.0, v227
    v_rcp_f32 v225, v225
    v_rcp_f32 v226, v226
    v_rcp_f32 v227, v227
    v_mul_f32 v204, v220, v204
    v_mul_f32 v205, v221, v205
    v_mul_f32 v206, v222, v206
    v_smfmac_f32_32x32x32_bf16 v[120:135], v[180:183], v[220:227], v177
    v_mul_f32 v207, v223, v207
    v_mul_f32 v208, v224, v208
    v_mul_f32 v209, v225, v209
    v_mul_f32 v210, v226, v210
    v_mul_f32 v211, v227, v211
    s_nop 1
    v_smfmac_f32_32x32x32_bf16 v[136:151], v[180:183], v[204:211], v177
    s_branch K2_EPI2
K2_LG1:
    v_smfmac_f32_32x32x32_bf16 v[136:151], v[180:183], v[204:211], v177
    ds_read_u8 v236, v248 offset:0
    ds_read_u8 v237, v248 offset:16
    ds_read_u8 v238, v248 offset:64
    ds_read_u8 v239, v248 offset:80
    v_exp_f32 v188, v188
    v_smfmac_f32_32x32x32_bf16 v[136:151], v[184:187], v[212:219], v177
    v_lshlrev_b32 v252, 4, v254
    v_and_b32 v247, 31, v254
    v_and_b32 v245, 32, v254
    v_mul_u32_u24 v249, 144, v247
    v_lshrrev_b32 v251, 2, v245
    v_lshl_add_u32 v247, v247, 6, v251
    v_lshl_add_u32 v249, v245, 1, v249
    v_add_u32 v249, s74, v249
    v_lshrrev_b32 v251, 3, v254
    v_lshl_add_u32 v251, v251, 4, v252
    v_add_u32 v251, s70, v251
    v_exp_f32 v189, v189
    v_mfma_f32_32x32x16_bf16 v[220:235], v[168:171], v[68:71], 0
    v_exp_f32 v190, v190
    v_mfma_f32_32x32x16_bf16 v[204:219], v[152:155], v[32:35], 0
    v_add_f32 v188, 1.0, v188
    v_mfma_f32_32x32x16_bf16 v[204:219], v[156:159], v[36:39], v[204:219]
    s_waitcnt lgkmcnt(0)
    v_lshl_add_u32 v236, v236, 6, v246
    v_lshl_add_u32 v237, v237, 6, v246
    v_lshl_add_u32 v238, v238, 6, v246
    v_lshl_add_u32 v239, v239, 6, v246
    v_exp_f32 v191, v191
    v_smfmac_f32_32x32x32_bf16 v[220:235], v[172:175], v[80:87], v176
    ds_read_b64_tr_b16 v[180:181], v236
    ds_read_b64_tr_b16 v[182:183], v237
    ds_read_b64_tr_b16 v[184:185], v238
    ds_read_b64_tr_b16 v[186:187], v239
    v_add_f32 v189, 1.0, v189
    v_add_f32 v190, 1.0, v190
    v_mfma_f32_32x32x16_bf16 v[204:219], v[160:163], v[40:43], v[204:219]
    v_rcp_f32 v188, v188
    v_mfma_f32_32x32x16_bf16 v[204:219], v[164:167], v[44:47], v[204:219]
    v_add_f32 v191, 1.0, v191
    v_mfma_f32_32x32x16_bf16 v[220:235], v[152:155], v[16:19], v[220:235]
    v_rcp_f32 v189, v189
    v_mfma_f32_32x32x16_bf16 v[220:235], v[156:159], v[20:23], v[220:235]
    v_rcp_f32 v190, v190
    v_mfma_f32_32x32x16_bf16 v[220:235], v[160:163], v[24:27], v[220:235]
    v_rcp_f32 v191, v191
    v_mfma_f32_32x32x16_bf16 v[220:235], v[164:167], v[28:31], v[220:235]
    ds_read2_b64 v[64:67], v247 offset0:0 offset1:2
    ds_read2_b64 v[68:71], v247 offset0:4 offset1:6
    ds_read_b128 v[0:3], v252 offset:52736
    ds_read_b128 v[4:7], v252 offset:53760
    ds_read_b128 v[8:11], v252 offset:54784
    ds_read_b128 v[12:15], v252 offset:55808
    ds_read_b128 v[16:19], v252 offset:56832
    ds_read_b128 v[20:23], v252 offset:57856
    ds_read_b128 v[24:27], v252 offset:58880
    ds_read_b128 v[28:31], v252 offset:59904
    v_mul_f32 v204, v188, v204
    v_mul_f32 v205, v189, v205
    s_waitcnt lgkmcnt(10)
    v_smfmac_f32_32x32x32_bf16 v[88:103], v[180:183], v[188:195], v177
    v_mul_f32 v206, v190, v206
    v_mul_f32 v207, v191, v207
    s_nop 1
    v_smfmac_f32_32x32x32_bf16 v[104:119], v[180:183], v[204:211], v177
    v_exp_f32 v220, v220
    v_exp_f32 v221, v221
    v_mfma_f32_32x32x16_bf16 v[204:219], v[152:155], v[48:51], 0
    ds_read_b128 v[152:155], v253 offset:0
    v_exp_f32 v222, v222
    v_mfma_f32_32x32x16_bf16 v[204:219], v[156:159], v[52:55], v[204:219]
    ds_read_b128 v[156:159], v253 offset:16
    v_add_f32 v220, 1.0, v220
    v_exp_f32 v223, v223
    v_mfma_f32_32x32x16_bf16 v[204:219], v[160:163], v[56:59], v[204:219]
    ds_read_b128 v[160:163], v253 offset:32
    v_add_f32 v221, 1.0, v221
    v_mfma_f32_32x32x16_bf16 v[204:219], v[164:167], v[60:63], v[204:219]
    ds_read_b128 v[164:167], v253 offset:48
    v_add_f32 v222, 1.0, v222
    v_rcp_f32 v220, v220
    v_add_f32 v223, 1.0, v223
    v_rcp_f32 v221, v221
    v_rcp_f32 v222, v222
    v_rcp_f32 v223, v223
    s_nop 4
    v_mul_f32 v204, v220, v204
    v_mul_f32 v205, v221, v205
    v_smfmac_f32_32x32x32_bf16 v[120:135], v[180:183], v[220:227], v177
    v_mul_f32 v206, v222, v206
    v_mul_f32 v207, v223, v207
    s_nop 1
    v_smfmac_f32_32x32x32_bf16 v[136:151], v[180:183], v[204:211], v177
    s_branch K2_EPI2
K2_TAIL:
    v_smfmac_f32_32x32x32_bf16 v[136:151], v[180:183], v[204:211], v177
    v_smfmac_f32_32x32x32_bf16 v[136:151], v[184:187], v[212:219], v177
K2_DONE:
    s_cmp_lg_u32 s78, 0
    s_cbranch_scc1 K2_SLOW
K2_EPI:
    v_lshlrev_b32 v252, 4, v254
    v_and_b32 v247, 31, v254
    v_and_b32 v245, 32, v254
    v_mul_u32_u24 v249, 144, v247
    v_lshrrev_b32 v251, 2, v245
    v_lshl_add_u32 v247, v247, 6, v251
    v_lshl_add_u32 v249, v245, 1, v249
    v_add_u32 v249, s74, v249
    v_lshrrev_b32 v251, 3, v254
    v_lshl_add_u32 v251, v251, 4, v252
    v_add_u32 v251, s70, v251
    ds_read2_b64 v[64:67], v247 offset0:0 offset1:2
    ds_read2_b64 v[68:71], v247 offset0:4 offset1:6
    ds_read_b128 v[0:3], v252 offset:52736
    ds_read_b128 v[4:7], v252 offset:53760
    ds_read_b128 v[8:11], v252 offset:54784
    ds_read_b128 v[12:15], v252 offset:55808
    ds_read_b128 v[16:19], v252 offset:56832
    ds_read_b128 v[20:23], v252 offset:57856
    ds_read_b128 v[24:27], v252 offset:58880
    ds_read_b128 v[28:31], v252 offset:59904
    ds_read_b128 v[152:155], v253 offset:0
    ds_read_b128 v[156:159], v253 offset:16
    ds_read_b128 v[160:163], v253 offset:32
    ds_read_b128 v[164:167], v253 offset:48
K2_EPI2:
    s_nop 1
    v_rcp_f32 v88, v88
    v_rcp_f32 v89, v89
    v_rcp_f32 v90, v90
    v_rcp_f32 v91, v91
    v_rcp_f32 v92, v92
    v_rcp_f32 v93, v93
    v_rcp_f32 v94, v94
    v_rcp_f32 v95, v95
    s_waitcnt lgkmcnt(0)
    v_lshlrev_b32 v32, 16, v152
    v_and_b32 v33, 0xffff0000, v152
    v_lshlrev_b32 v34, 16, v153
    v_and_b32 v35, 0xffff0000, v153
    v_lshlrev_b32 v36, 16, v154
    v_and_b32 v37, 0xffff0000, v154
    v_lshlrev_b32 v38, 16, v155
    v_and_b32 v39, 0xffff0000, v155
    v_lshlrev_b32 v40, 16, v156
    v_and_b32 v41, 0xffff0000, v156
    v_lshlrev_b32 v42, 16, v157
    v_and_b32 v43, 0xffff0000, v157
    v_lshlrev_b32 v44, 16, v158
    v_and_b32 v45, 0xffff0000, v158
    v_lshlrev_b32 v46, 16, v159
    v_and_b32 v47, 0xffff0000, v159
    v_rcp_f32 v96, v96
    v_rcp_f32 v97, v97
    v_mfma_f32_32x32x16_bf16 v[188:203], v[0:3], v[152:155], v[32:47]
    v_rcp_f32 v98, v98
    v_rcp_f32 v99, v99
    v_rcp_f32 v100, v100
    v_rcp_f32 v101, v101
    v_rcp_f32 v102, v102
    v_rcp_f32 v103, v103
    v_lshlrev_b32 v48, 16, v160
    v_mfma_f32_32x32x16_bf16 v[188:203], v[4:7], v[156:159], v[188:203]
    v_and_b32 v49, 0xffff0000, v160
    v_lshlrev_b32 v50, 16, v161
    v_and_b32 v51, 0xffff0000, v161
    v_lshlrev_b32 v52, 16, v162
    v_and_b32 v53, 0xffff0000, v162
    v_lshlrev_b32 v54, 16, v163
    v_and_b32 v55, 0xffff0000, v163
    v_mfma_f32_32x32x16_bf16 v[188:203], v[8:11], v[160:163], v[188:203]
    v_lshlrev_b32 v56, 16, v164
    v_and_b32 v57, 0xffff0000, v164
    v_lshlrev_b32 v58, 16, v165
    v_and_b32 v59, 0xffff0000, v165
    v_lshlrev_b32 v60, 16, v166
    v_and_b32 v61, 0xffff0000, v166
    v_lshlrev_b32 v62, 16, v167
    v_mfma_f32_32x32x16_bf16 v[188:203], v[12:15], v[164:167], v[188:203]
    v_and_b32 v63, 0xffff0000, v167
    v_mul_f32 v104, v104, v88
    v_mul_f32 v105, v105, v89
    v_mul_f32 v106, v106, v90
    v_mul_f32 v107, v107, v91
    v_mul_f32 v108, v108, v92
    v_mul_f32 v109, v109, v93
    v_mfma_f32_32x32x16_bf16 v[72:87], v[16:19], v[152:155], v[48:63]
    v_mul_f32 v110, v110, v94
    v_mul_f32 v111, v111, v95
    v_mul_f32 v112, v112, v96
    v_mul_f32 v113, v113, v97
    v_mul_f32 v114, v114, v98
    v_mul_f32 v115, v115, v99
    v_mfma_f32_32x32x16_bf16 v[72:87], v[20:23], v[156:159], v[72:87]
    v_mul_f32 v116, v116, v100
    v_mul_f32 v117, v117, v101
    v_mul_f32 v118, v118, v102
    v_mul_f32 v119, v119, v103
    v_cvt_pk_bf16_f32 v88, v104, v105
    v_cvt_pk_bf16_f32 v89, v106, v107
    v_mfma_f32_32x32x16_bf16 v[72:87], v[24:27], v[160:163], v[72:87]
    v_cvt_pk_bf16_f32 v90, v108, v109
    v_cvt_pk_bf16_f32 v91, v110, v111
    v_cvt_pk_bf16_f32 v92, v112, v113
    v_cvt_pk_bf16_f32 v93, v114, v115
    v_cvt_pk_bf16_f32 v94, v116, v117
    v_cvt_pk_bf16_f32 v95, v118, v119
    v_mfma_f32_32x32x16_bf16 v[72:87], v[28:31], v[164:167], v[72:87]
    v_rcp_f32 v120, v120
    v_rcp_f32 v121, v121
    v_rcp_f32 v122, v122
    v_rcp_f32 v123, v123
    v_rcp_f32 v124, v124
    v_rcp_f32 v125, v125
    v_mfma_f32_32x32x16_bf16 v[188:203], v[88:91], v[64:67], v[188:203]
    v_rcp_f32 v126, v126
    v_rcp_f32 v127, v127
    v_rcp_f32 v128, v128
    v_rcp_f32 v129, v129
    v_rcp_f32 v130, v130
    v_mfma_f32_32x32x16_bf16 v[188:203], v[92:95], v[68:71], v[188:203]
    v_rcp_f32 v131, v131
    v_rcp_f32 v132, v132
    v_rcp_f32 v133, v133
    v_rcp_f32 v134, v134
    v_rcp_f32 v135, v135
    v_mul_f32 v136, v136, v120
    v_mul_f32 v137, v137, v121
    v_mul_f32 v138, v138, v122
    v_mul_f32 v139, v139, v123
    v_mul_f32 v140, v140, v124
    v_mul_f32 v141, v141, v125
    v_mul_f32 v142, v142, v126
    v_mul_f32 v143, v143, v127
    v_mul_f32 v144, v144, v128
    v_mul_f32 v145, v145, v129
    v_mul_f32 v146, v146, v130
    v_mul_f32 v147, v147, v131
    v_mul_f32 v148, v148, v132
    v_mul_f32 v149, v149, v133
    v_mul_f32 v150, v150, v134
    v_mul_f32 v151, v151, v135
    v_cvt_pk_bf16_f32 v120, v136, v137
    v_cvt_pk_bf16_f32 v121, v138, v139
    v_cvt_pk_bf16_f32 v122, v140, v141
    v_cvt_pk_bf16_f32 v123, v142, v143
    v_cvt_pk_bf16_f32 v124, v144, v145
    v_cvt_pk_bf16_f32 v125, v146, v147
    v_cvt_pk_bf16_f32 v126, v148, v149
    v_cvt_pk_bf16_f32 v127, v150, v151
    v_mfma_f32_32x32x16_bf16 v[72:87], v[120:123], v[64:67], v[72:87]
    s_nop 0
    v_mfma_f32_32x32x16_bf16 v[72:87], v[124:127], v[68:71], v[72:87]
    v_max_f32 v188, v188, v32
    v_max_f32 v189, v189, v33
    v_max_f32 v190, v190, v34
    v_max_f32 v191, v191, v35
    v_max_f32 v192, v192, v36
    v_max_f32 v193, v193, v37
    v_max_f32 v194, v194, v38
    v_max_f32 v195, v195, v39
    v_cvt_pk_bf16_f32 v220, v188, v189
    v_cvt_pk_bf16_f32 v221, v190, v191
    v_cvt_pk_bf16_f32 v222, v192, v193
    v_cvt_pk_bf16_f32 v223, v194, v195
    ds_write_b128 v249, v[220:223] offset:0
    v_max_f32 v196, v196, v40
    v_max_f32 v197, v197, v41
    v_max_f32 v198, v198, v42
    v_max_f32 v199, v199, v43
    v_max_f32 v200, v200, v44
    v_max_f32 v201, v201, v45
    v_max_f32 v202, v202, v46
    v_max_f32 v203, v203, v47
    v_cvt_pk_bf16_f32 v224, v196, v197
    v_cvt_pk_bf16_f32 v225, v198, v199
    v_cvt_pk_bf16_f32 v226, v200, v201
    v_cvt_pk_bf16_f32 v227, v202, v203
    ds_write_b128 v249, v[224:227] offset:16
    v_max_f32 v72, v72, v48
    v_max_f32 v73, v73, v49
    v_max_f32 v74, v74, v50
    v_max_f32 v75, v75, v51
    v_max_f32 v76, v76, v52
    v_max_f32 v77, v77, v53
    v_max_f32 v78, v78, v54
    v_max_f32 v79, v79, v55
    v_cvt_pk_bf16_f32 v228, v72, v73
    v_cvt_pk_bf16_f32 v229, v74, v75
    v_cvt_pk_bf16_f32 v230, v76, v77
    v_cvt_pk_bf16_f32 v231, v78, v79
    ds_write_b128 v249, v[228:231] offset:32
    v_max_f32 v80, v80, v56
    v_max_f32 v81, v81, v57
    v_max_f32 v82, v82, v58
    v_max_f32 v83, v83, v59
    v_max_f32 v84, v84, v60
    v_max_f32 v85, v85, v61
    v_max_f32 v86, v86, v62
    v_max_f32 v87, v87, v63
    v_cvt_pk_bf16_f32 v232, v80, v81
    v_cvt_pk_bf16_f32 v233, v82, v83
    v_cvt_pk_bf16_f32 v234, v84, v85
    v_cvt_pk_bf16_f32 v235, v86, v87
    ds_write_b128 v249, v[232:235] offset:48
    ds_read_b128 v[152:155], v251 offset:0
    ds_read_b128 v[156:159], v251 offset:1152
    ds_read_b128 v[160:163], v251 offset:2304
    ds_read_b128 v[164:167], v251 offset:3456
    s_waitcnt lgkmcnt(3)
    buffer_store_dwordx4 v[152:155], v252, s[28:31], 0 offen offset:0 sc1
    s_waitcnt lgkmcnt(2)
    buffer_store_dwordx4 v[156:159], v252, s[28:31], 0 offen offset:1024 sc1
    s_waitcnt lgkmcnt(1)
    buffer_store_dwordx4 v[160:163], v252, s[28:31], 0 offen offset:2048 sc1
    s_waitcnt lgkmcnt(0)
    buffer_store_dwordx4 v[164:167], v252, s[28:31], 0 offen offset:3072 sc1
    s_add_u32 s10, s2, s7
    s_cmp_lg_u32 s10, 0
    s_cbranch_scc1 K2_NOEP
    v_mov_b32 v188, 24117248
    v_mov_b32 v189, s100
    buffer_store_dword v189, v188, s[24:27], 0 offen sc1
K2_NOEP:
K2_END:
    s_endpgm
K2_RETRY0:
    s_sub_u32 s101, s101, 1
    s_cbranch_scc1 K2_END
    s_waitcnt vmcnt(0)
    v_bitop3_b32 v188, v91, s36, v214 bitop3:0x28
    s_nop 1
    v_or_b32_dpp v188, v188, v188 quad_perm:[1,0,3,2] row_mask:0xf bank_mask:0xf
    s_nop 1
    v_or_b32_dpp v188, v188, v188 quad_perm:[2,3,0,1] row_mask:0xf bank_mask:0xf
    s_nop 1
    v_or_b32_dpp v188, v188, v188 row_half_mirror row_mask:0xf bank_mask:0xf
    v_cmp_ne_u32 vcc, 0, v188
    s_and_b64 exec, exec, vcc
    s_cbranch_execz K2_RT00
    buffer_load_dwordx4 v[88:91], v189, s[32:35], 0 offen sc1
K2_RT00:
    s_mov_b64 exec, -1
    v_bitop3_b32 v188, v95, s36, v214 bitop3:0x28
    s_nop 1
    v_or_b32_dpp v188, v188, v188 quad_perm:[1,0,3,2] row_mask:0xf bank_mask:0xf
    s_nop 1
    v_or_b32_dpp v188, v188, v188 quad_perm:[2,3,0,1] row_mask:0xf bank_mask:0xf
    s_nop 1
    v_or_b32_dpp v188, v188, v188 row_half_mirror row_mask:0xf bank_mask:0xf
    v_cmp_ne_u32 vcc, 0, v188
    s_and_b64 exec, exec, vcc
    s_cbranch_execz K2_RT01
    buffer_load_dwordx4 v[92:95], v189, s[32:35], s79 offen sc1
K2_RT01:
    s_mov_b64 exec, -1
    v_bitop3_b32 v188, v99, s36, v214 bitop3:0x28
    s_nop 1
    v_or_b32_dpp v188, v188, v188 quad_perm:[1,0,3,2] row_mask:0xf bank_mask:0xf
    s_nop 1
    v_or_b32_dpp v188, v188, v188 quad_perm:[2,3,0,1] row_mask:0xf bank_mask:0xf
    s_nop 1
    v_or_b32_dpp v188, v188, v188 row_half_mirror row_mask:0xf bank_mask:0xf
    v_cmp_ne_u32 vcc, 0, v188
    s_and_b64 exec, exec, vcc
    s_cbranch_execz K2_RT02
    buffer_load_dwordx4 v[96:99], v189, s[32:35], s80 offen sc1
K2_RT02:
    s_mov_b64 exec, -1
    v_bitop3_b32 v188, v103, s36, v214 bitop3:0x28
    s_nop 1
    v_or_b32_dpp v188, v188, v188 quad_perm:[1,0,3,2] row_mask:0xf bank_mask:0xf
    s_nop 1
    v_or_b32_dpp v188, v188, v188 quad_perm:[2,3,0,1] row_mask:0xf bank_mask:0xf
    s_nop 1
    v_or_b32_dpp v188, v188, v188 row_half_mirror row_mask:0xf bank_mask:0xf
    v_cmp_ne_u32 vcc, 0, v188
    s_and_b64 exec, exec, vcc
    s_cbranch_execz K2_RT03
    buffer_load_dwordx4 v[100:103], v189, s[32:35], s81 offen sc1
K2_RT03:
    s_mov_b64 exec, -1
    s_waitcnt vmcnt(0)
    s_branch K2_CHK0
K2_RETRY1:
    s_sub_u32 s101, s101, 1
    s_cbranch_scc1 K2_END
    s_waitcnt vmcnt(0)
    v_bitop3_b32 v188, v95, s36, v214 bitop3:0x28
    s_nop 1
    v_or_b32_dpp v188, v188, v188 quad_perm:[1,0,3,2] row_mask:0xf bank_mask:0xf
    s_nop 1
    v_or_b32_dpp v188, v188, v188 quad_perm:[2,3,0,1] row_mask:0xf bank_mask:0xf
    s_nop 1
    v_or_b32_dpp v188, v188, v188 row_half_mirror row_mask:0xf bank_mask:0xf
    v_cmp_ne_u32 vcc, 0, v188
    s_and_b64 exec, exec, vcc
    s_cbranch_execz K2_RT11
    buffer_load_dwordx4 v[92:95], v189, s[32:35], s79 offen sc1
K2_RT11:
    s_mov_b64 exec, -1
    v_bitop3_b32 v188, v99, s36, v214 bitop3:0x28
    s_nop 1
    v_or_b32_dpp v188, v188, v188 quad_perm:[1,0,3,2] row_mask:0xf bank_mask:0xf
    s_nop 1
    v_or_b32_dpp v188, v188, v188 quad_perm:[2,3,0,1] row_mask:0xf bank_mask:0xf
    s_nop 1
    v_or_b32_dpp v188, v188, v188 row_half_mirror row_mask:0xf bank_mask:0xf
    v_cmp_ne_u32 vcc, 0, v188
    s_and_b64 exec, exec, vcc
    s_cbranch_execz K2_RT12
    buffer_load_dwordx4 v[96:99], v189, s[32:35], s80 offen sc1
K2_RT12:
    s_mov_b64 exec, -1
    v_bitop3_b32 v188, v103, s36, v214 bitop3:0x28
    s_nop 1
    v_or_b32_dpp v188, v188, v188 quad_perm:[1,0,3,2] row_mask:0xf bank_mask:0xf
    s_nop 1
    v_or_b32_dpp v188, v188, v188 quad_perm:[2,3,0,1] row_mask:0xf bank_mask:0xf
    s_nop 1
    v_or_b32_dpp v188, v188, v188 row_half_mirror row_mask:0xf bank_mask:0xf
    v_cmp_ne_u32 vcc, 0, v188
    s_and_b64 exec, exec, vcc
    s_cbranch_execz K2_RT13
    buffer_load_dwordx4 v[100:103], v189, s[32:35], s81 offen sc1
K2_RT13:
    s_mov_b64 exec, -1
    s_waitcnt vmcnt(0)
    s_branch K2_CHK1
K2_RETRY2:
    s_sub_u32 s101, s101, 1
    s_cbranch_scc1 K2_END
    s_waitcnt vmcnt(0)
    v_bitop3_b32 v188, v99, s36, v214 bitop3:0x28
    s_nop 1
    v_or_b32_dpp v188, v188, v188 quad_perm:[1,0,3,2] row_mask:0xf bank_mask:0xf
    s_nop 1
    v_or_b32_dpp v188, v188, v188 quad_perm:[2,3,0,1] row_mask:0xf bank_mask:0xf
    s_nop 1
    v_or_b32_dpp v188, v188, v188 row_half_mirror row_mask:0xf bank_mask:0xf
    v_cmp_ne_u32 vcc, 0, v188
    s_and_b64 exec, exec, vcc
    s_cbranch_execz K2_RT22
    buffer_load_dwordx4 v[96:99], v189, s[32:35], s80 offen sc1
K2_RT22:
    s_mov_b64 exec, -1
    v_bitop3_b32 v188, v103, s36, v214 bitop3:0x28
    s_nop 1
    v_or_b32_dpp v188, v188, v188 quad_perm:[1,0,3,2] row_mask:0xf bank_mask:0xf
    s_nop 1
    v_or_b32_dpp v188, v188, v188 quad_perm:[2,3,0,1] row_mask:0xf bank_mask:0xf
    s_nop 1
    v_or_b32_dpp v188, v188, v188 row_half_mirror row_mask:0xf bank_mask:0xf
    v_cmp_ne_u32 vcc, 0, v188
    s_and_b64 exec, exec, vcc
    s_cbranch_execz K2_RT23
    buffer_load_dwordx4 v[100:103], v189, s[32:35], s81 offen sc1
K2_RT23:
    s_mov_b64 exec, -1
    s_waitcnt vmcnt(0)
    s_branch K2_CHK2
K2_RETRY3:
    s_sub_u32 s101, s101, 1
    s_cbranch_scc1 K2_END
    s_waitcnt vmcnt(0)
    v_bitop3_b32 v188, v103, s36, v214 bitop3:0x28
    s_nop 1
    v_or_b32_dpp v188, v188, v188 quad_perm:[1,0,3,2] row_mask:0xf bank_mask:0xf
    s_nop 1
    v_or_b32_dpp v188, v188, v188 quad_perm:[2,3,0,1] row_mask:0xf bank_mask:0xf
    s_nop 1
    v_or_b32_dpp v188, v188, v188 row_half_mirror row_mask:0xf bank_mask:0xf
    v_cmp_ne_u32 vcc, 0, v188
    s_and_b64 exec, exec, vcc
    s_cbranch_execz K2_RT33
    buffer_load_dwordx4 v[100:103], v189, s[32:35], s81 offen sc1
K2_RT33:
    s_mov_b64 exec, -1
    s_waitcnt vmcnt(0)
    s_branch K2_CHK3
K1_EXT:
    s_mov_b32 s14, 0x0f0f0f0f
    s_mov_b32 s15, s14
    ds_read_b32 v104, v6 offset:32
    ds_read_b128 v[8:11], v3 offset:128
    ds_read_b32 v105, v6 offset:3360
    ds_read_b128 v[16:19], v3 offset:13440
    ds_read_b32 v106, v6 offset:6688
    ds_read_b128 v[24:27], v3 offset:26752
    ds_read_b32 v107, v6 offset:10016
    ds_read_b128 v[32:35], v3 offset:40064
    s_waitcnt lgkmcnt(0)
    v_cmp_le_u32 vcc, 553648128, v108
    v_and_or_b32 v11, v104, v15, v108
    s_and_b64 exec, vcc, s[14:15]
    s_cbranch_execz K1_EX0
    buffer_store_dwordx4 v[8:11], v4, s[32:35], s10 offen sc1
K1_EX0:
    s_mov_b64 exec, -1
    s_add_u32 s10, s10, 2105344
    v_cmp_le_u32 vcc, 553648128, v109
    v_and_or_b32 v19, v105, v15, v109
    s_and_b64 exec, vcc, s[14:15]
    s_cbranch_execz K1_EX1
    buffer_store_dwordx4 v[16:19], v4, s[32:35], s10 offen sc1
K1_EX1:
    s_mov_b64 exec, -1
    s_add_u32 s10, s10, 2105344
    v_cmp_le_u32 vcc, 553648128, v110
    v_and_or_b32 v27, v106, v15, v110
    s_and_b64 exec, vcc, s[14:15]
    s_cbranch_execz K1_EX2
    buffer_store_dwordx4 v[24:27], v4, s[32:35], s10 offen sc1
K1_EX2:
    s_mov_b64 exec, -1
    s_add_u32 s10, s10, 2105344
    v_cmp_le_u32 vcc, 553648128, v111
    v_and_or_b32 v35, v107, v15, v111
    s_and_b64 exec, vcc, s[14:15]
    s_cbranch_execz K1_EX3
    buffer_store_dwordx4 v[32:35], v4, s[32:35], s10 offen sc1
K1_EX3:
    s_mov_b64 exec, -1
    s_add_u32 s10, s10, 2105344
    s_branch K1_EXTR
K1_OVF:
    v_lshrrev_b32 v72, 16, v112
    v_lshrrev_b32 v76, 18, v112
    v_sub_u32 v72, v72, v76
    v_lshrrev_b32 v73, 16, v113
    v_lshrrev_b32 v76, 18, v113
    v_sub_u32 v73, v73, v76
    v_lshrrev_b32 v74, 16, v114
    v_lshrrev_b32 v76, 18, v114
    v_sub_u32 v74, v74, v76
    v_lshrrev_b32 v75, 16, v115
    v_lshrrev_b32 v76, 18, v115
    v_sub_u32 v75, v75, v76
    v_add_u32 v77, v72, v73
    v_add_u32 v78, v77, v74
    v_add_u32 v79, v78, v75
    v_mov_b32 v1, v79
    s_nop 1
    v_add_u32_dpp v1, v1, v1 row_shr:1 row_mask:0xf bank_mask:0xf bound_ctrl:0
    s_nop 1
    v_add_u32_dpp v1, v1, v1 row_shr:2 row_mask:0xf bank_mask:0xf bound_ctrl:0
    s_nop 1
    v_add_u32_dpp v1, v1, v1 row_shr:4 row_mask:0xf bank_mask:0xf bound_ctrl:0
    s_nop 1
    v_add_u32_dpp v1, v1, v1 row_shr:8 row_mask:0xf bank_mask:0xf bound_ctrl:0
    s_nop 1
    v_add_u32_dpp v1, v1, v1 row_bcast:15 row_mask:0xa bank_mask:0xf
    s_nop 1
    v_add_u32_dpp v1, v1, v1 row_bcast:31 row_mask:0xc bank_mask:0xf
    s_nop 0
    v_sub_u32 v76, v1, v79
    v_add_u32 v79, v76, v78
    v_add_u32 v78, v76, v77
    v_add_u32 v77, v76, v72
    v_lshl_or_b32 v76, v72, 16, v76
    v_lshl_or_b32 v77, v73, 16, v77
    v_lshl_or_b32 v78, v74, 16, v78
    v_lshl_or_b32 v79, v75, 16, v79
    s_waitcnt lgkmcnt(0)
    ds_write_b128 v172, v[76:79] offset:52736
    v_min_u32 v108, 255, v108
    v_min_u32 v109, 255, v109
    v_min_u32 v110, 255, v110
    v_min_u32 v111, 255, v111
    s_lshl_b32 s15, s12, 2
    s_add_u32 s15, s15, 23068672
    s_add_u32 s64, s8, s15
    s_addc_u32 s65, s9, 0
    s_mov_b32 s66, 262144
    s_mov_b32 s67, 0x20000
    v_lshlrev_b32 v1, 12, v254
    buffer_store_dword v76, v1, s[64:67], 0 offen offset:0 sc1
    buffer_store_dword v77, v1, s[64:67], 0 offen offset:1024 sc1
    buffer_store_dword v78, v1, s[64:67], 0 offen offset:2048 sc1
    buffer_store_dword v79, v1, s[64:67], 0 offen offset:3072 sc1
    s_add_u32 s15, s13, 17825792
    s_add_u32 s64, s8, s15
    s_addc_u32 s65, s9, 0
    s_mov_b32 s66, 12500
    s_mov_b32 s67, 0x20000
    s_lshr_b32 s15, s13, 2
    s_add_u32 s15, s15, 22020096
    s_add_u32 s68, s8, s15
    s_addc_u32 s69, s9, 0
    s_mov_b32 s70, 3125
    s_mov_b32 s71, 0x20000
    v_cndmask_b32 v30, v24, v30, s[78:79]
    v_cndmask_b32 v38, 0, v38, s[78:79]
    ds_read_u16 v40, v24 offset:50736
    ds_read_u16 v41, v25 offset:50736
    ds_read_u16 v42, v26 offset:50736
    ds_read_u16 v43, v27 offset:50736
    ds_read_u16 v44, v28 offset:50736
    ds_read_u16 v45, v29 offset:50736
    ds_read_u16 v46, v30 offset:50736
    s_waitcnt lgkmcnt(0)
    v_lshrrev_b32 v1, 2, v32
    v_sub_u32 v1, v32, v1
    v_add_u32 v40, v40, v1
    v_cmp_le_u32 vcc, 48, v32
    v_lshlrev_b32 v48, 2, v40
    s_and_saveexec_b64 s[14:15], vcc
    s_cbranch_execz K1_OV3_0
    buffer_store_byte v23, v40, s[68:71], 0 offen sc1
    buffer_store_dword v16, v48, s[64:67], 0 offen sc1
K1_OV3_0:
    s_mov_b64 exec, -1
    v_lshrrev_b32 v1, 2, v33
    v_sub_u32 v1, v33, v1
    v_add_u32 v41, v41, v1
    v_cmp_le_u32 vcc, 48, v33
    v_lshlrev_b32 v49, 2, v41
    s_and_saveexec_b64 s[14:15], vcc
    s_cbranch_execz K1_OV3_1
    buffer_store_byte v23, v41, s[68:71], 0 offen sc1
    buffer_store_dword v17, v49, s[64:67], 0 offen sc1
K1_OV3_1:
    s_mov_b64 exec, -1
    v_lshrrev_b32 v1, 2, v34
    v_sub_u32 v1, v34, v1
    v_add_u32 v42, v42, v1
    v_cmp_le_u32 vcc, 48, v34
    v_lshlrev_b32 v50, 2, v42
    s_and_saveexec_b64 s[14:15], vcc
    s_cbranch_execz K1_OV3_2
    buffer_store_byte v23, v42, s[68:71], 0 offen sc1
    buffer_store_dword v18, v50, s[64:67], 0 offen sc1
K1_OV3_2:
    s_mov_b64 exec, -1
    v_lshrrev_b32 v1, 2, v35
    v_sub_u32 v1, v35, v1
    v_add_u32 v43, v43, v1
    v_cmp_le_u32 vcc, 48, v35
    v_lshlrev_b32 v51, 2, v43
    s_and_saveexec_b64 s[14:15], vcc
    s_cbranch_execz K1_OV3_3
    buffer_store_byte v23, v43, s[68:71], 0 offen sc1
    buffer_store_dword v19, v51, s[64:67], 0 offen sc1
K1_OV3_3:
    s_mov_b64 exec, -1
    v_lshrrev_b32 v1, 2, v36
    v_sub_u32 v1, v36, v1
    v_add_u32 v44, v44, v1
    v_cmp_le_u32 vcc, 48, v36
    v_lshlrev_b32 v52, 2, v44
    s_and_saveexec_b64 s[14:15], vcc
    s_cbranch_execz K1_OV3_4
    buffer_store_byte v31, v44, s[68:71], 0 offen sc1
    buffer_store_dword v20, v52, s[64:67], 0 offen sc1
K1_OV3_4:
    s_mov_b64 exec, -1
    v_lshrrev_b32 v1, 2, v37
    v_sub_u32 v1, v37, v1
    v_add_u32 v45, v45, v1
    v_cmp_le_u32 vcc, 48, v37
    v_lshlrev_b32 v53, 2, v45
    s_and_saveexec_b64 s[14:15], vcc
    s_cbranch_execz K1_OV3_5
    buffer_store_byte v31, v45, s[68:71], 0 offen sc1
    buffer_store_dword v21, v53, s[64:67], 0 offen sc1
K1_OV3_5:
    s_mov_b64 exec, -1
    v_lshrrev_b32 v1, 2, v38
    v_sub_u32 v1, v38, v1
    v_add_u32 v46, v46, v1
    v_cmp_le_u32 vcc, 48, v38
    v_lshlrev_b32 v54, 2, v46
    s_and_saveexec_b64 s[14:15], vcc
    s_cbranch_execz K1_OV3_6
    buffer_store_byte v39, v46, s[68:71], 0 offen sc1
    buffer_store_dword v22, v54, s[64:67], 0 offen sc1
K1_OV3_6:
    s_mov_b64 exec, -1
    s_waitcnt vmcnt(0)
    s_barrier
    s_branch K1_OUT
K2_XT1:
    s_mov_b32 s97, 1
    v_cmp_le_u32 vcc, 822083584, v188
    v_mov_b32 v166, 2180
    s_cbranch_vccz K2_XT1A
    ds_write_b32 v166, v171
K2_XT1A:
    s_mov_b32 s10, 0xf0f0f0f0
    s_mov_b32 s11, s10
    v_and_b32 v166, 12, v168
    v_add_u32 v166, 32, v166
    v_and_b32 v164, 64, v189
    v_mul_u32_u24 v164, 127, v164
    v_add_u32 v164, v164, v189
    v_add_u32 v165, 16384, v164
    v_mov_b32 v167, 0x7ffffff0
    v_cndmask_b32 v204, v91, v95, s[10:11]
    v_cndmask_b32 v206, v208, v209, s[10:11]
    v_cmp_le_u32 vcc, 553648128, v204
    v_sub_u32_sdwa v204, v204, v166 dst_sel:DWORD dst_unused:UNUSED_PAD src0_sel:BYTE_3 src1_sel:DWORD
    s_nop 0
    v_cndmask_b32 v164, v167, v164, vcc
    v_cndmask_b32 v205, v99, v103, s[10:11]
    v_cndmask_b32 v207, v210, v211, s[10:11]
    v_cmp_le_u32 vcc, 553648128, v205
    v_sub_u32_sdwa v205, v205, v166 dst_sel:DWORD dst_unused:UNUSED_PAD src0_sel:BYTE_3 src1_sel:DWORD
    s_nop 0
    v_cndmask_b32 v165, v167, v165, vcc
    s_add_u32 s32, s32, 8421376
    s_addc_u32 s33, s33, 0
    buffer_load_dwordx4 v[132:135], v164, s[32:35], 0 offen sc1
    buffer_load_dwordx4 v[136:139], v165, s[32:35], 0 offen sc1
    v_med3_i32 v166, v204, 0, 3
    v_med3_i32 v167, v205, 0, 3
    v_add_u32 v166, v166, v167
    v_mov_b32 v167, 2176
    v_cmpx_lt_u32 vcc, 0, v166
    ds_add_u32 v167, v166
    s_mov_b64 exec, -1
    s_branch K2_XT1R
K2_XT2:
K2_XVa:
    s_mov_b64 s[10:11], 0
    v_bitop3_b32 v166, v135, s36, v214 bitop3:0x28
    v_cmp_ne_u32 s[86:87], 0, v166
    v_cmp_gt_u32 vcc, 0x7ffffff0, v164
    s_and_b64 vcc, vcc, s[86:87]
    s_or_b64 s[10:11], s[10:11], vcc
    v_bitop3_b32 v166, v139, s36, v214 bitop3:0x28
    v_cmp_ne_u32 s[86:87], 0, v166
    v_cmp_gt_u32 vcc, 0x7ffffff0, v165
    s_and_b64 vcc, vcc, s[86:87]
    s_or_b64 s[10:11], s[10:11], vcc
    s_cbranch_scc0 K2_XWa
    s_sub_u32 s101, s101, 1
    s_cbranch_scc1 K2_END
    buffer_load_dwordx4 v[132:135], v164, s[32:35], 0 offen sc1
    buffer_load_dwordx4 v[136:139], v165, s[32:35], 0 offen sc1
    s_waitcnt vmcnt(0)
    s_branch K2_XVa
K2_XWa:
    v_and_b32 v140, 255, v132
    v_lshlrev_b32 v140, 2, v140
    ds_read_b32 v140, v140 offset:6400
    v_and_b32 v141, 255, v133
    v_lshlrev_b32 v141, 2, v141
    ds_read_b32 v141, v141 offset:6400
    v_and_b32 v142, 255, v134
    v_lshlrev_b32 v142, 2, v142
    ds_read_b32 v142, v142 offset:6400
    v_and_b32 v135, 0x0f0f0f, v135
    v_and_b32 v143, 255, v136
    v_lshlrev_b32 v143, 2, v143
    ds_read_b32 v143, v143 offset:6400
    v_and_b32 v144, 255, v137
    v_lshlrev_b32 v144, 2, v144
    ds_read_b32 v144, v144 offset:6400
    v_and_b32 v145, 255, v138
    v_lshlrev_b32 v145, 2, v145
    ds_read_b32 v145, v145 offset:6400
    v_and_b32 v139, 0x0f0f0f, v139
    s_waitcnt lgkmcnt(0)
    v_perm_b32 v146, v135, v132, s64
    v_lshl_add_u32 v146, v146, 5, v206
    v_cmpx_lt_i32 vcc, 0, v204
    ds_add_rtn_u32 v140, v140, v171 offset:2112
    s_mov_b64 exec, -1
    v_perm_b32 v147, v135, v133, s65
    v_lshl_add_u32 v147, v147, 5, v206
    v_cmpx_lt_i32 vcc, 1, v204
    ds_add_rtn_u32 v141, v141, v171 offset:2112
    s_mov_b64 exec, -1
    v_perm_b32 v148, v135, v134, s66
    v_lshl_add_u32 v148, v148, 5, v206
    v_cmpx_lt_i32 vcc, 2, v204
    ds_add_rtn_u32 v142, v142, v171 offset:2112
    s_mov_b64 exec, -1
    v_perm_b32 v149, v139, v136, s64
    v_lshl_add_u32 v149, v149, 5, v207
    v_cmpx_lt_i32 vcc, 0, v205
    ds_add_rtn_u32 v143, v143, v171 offset:2112
    s_mov_b64 exec, -1
    v_perm_b32 v150, v139, v137, s65
    v_lshl_add_u32 v150, v150, 5, v207
    v_cmpx_lt_i32 vcc, 1, v205
    ds_add_rtn_u32 v144, v144, v171 offset:2112
    s_mov_b64 exec, -1
    v_perm_b32 v151, v139, v138, s66
    v_lshl_add_u32 v151, v151, 5, v207
    v_cmpx_lt_i32 vcc, 2, v205
    ds_add_rtn_u32 v145, v145, v171 offset:2112
    s_mov_b64 exec, -1
    s_waitcnt lgkmcnt(0)
    v_cmpx_lt_i32 vcc, 0, v204
    ds_write2st64_b32 v140, v132, v146 offset0:0 offset1:84
    s_mov_b64 exec, -1
    v_cmpx_lt_i32 vcc, 1, v204
    ds_write2st64_b32 v141, v133, v147 offset0:0 offset1:84
    s_mov_b64 exec, -1
    v_cmpx_lt_i32 vcc, 2, v204
    ds_write2st64_b32 v142, v134, v148 offset0:0 offset1:84
    s_mov_b64 exec, -1
    v_cmpx_lt_i32 vcc, 0, v205
    ds_write2st64_b32 v143, v136, v149 offset0:0 offset1:84
    s_mov_b64 exec, -1
    v_cmpx_lt_i32 vcc, 1, v205
    ds_write2st64_b32 v144, v137, v150 offset0:0 offset1:84
    s_mov_b64 exec, -1
    v_cmpx_lt_i32 vcc, 2, v205
    ds_write2st64_b32 v145, v138, v151 offset0:0 offset1:84
    s_mov_b64 exec, -1
    s_waitcnt lgkmcnt(0)
    s_branch K2_XT2R
K2_OVF:
    s_mov_b32 s80, 1
    s_mov_b32 s83, 0
    s_mov_b32 s77, 0
    s_mov_b32 s15, s76
    v_mov_b32 v190, 0xffff0000
    v_or_b32 v189, s39, v190
    v_mov_b32 v190, 0x7fffff00
    v_lshl_add_u32 v188, v254, 2, s15
    s_sub_u32 s73, s15, s76
    ds_write2st64_b32 v188, v189, v190 offset0:0 offset1:84
    ds_write2st64_b32 v188, v189, v190 offset0:1 offset1:85
    s_add_u32 s73, s73, 127
    s_lshr_b32 s73, s73, 7
    s_sub_i32 s38, s73, 1
    s_cmp_eq_u32 s97, 0
    s_cbranch_scc1 K2_PADS0
    s_mov_b32 s97, 0
    s_waitcnt vmcnt(0)
K2_XVb:
    s_mov_b64 s[10:11], 0
    v_bitop3_b32 v166, v135, s36, v214 bitop3:0x28
    v_cmp_ne_u32 s[86:87], 0, v166
    v_cmp_gt_u32 vcc, 0x7ffffff0, v164
    s_and_b64 vcc, vcc, s[86:87]
    s_or_b64 s[10:11], s[10:11], vcc
    v_bitop3_b32 v166, v139, s36, v214 bitop3:0x28
    v_cmp_ne_u32 s[86:87], 0, v166
    v_cmp_gt_u32 vcc, 0x7ffffff0, v165
    s_and_b64 vcc, vcc, s[86:87]
    s_or_b64 s[10:11], s[10:11], vcc
    s_cbranch_scc0 K2_XWb
    s_sub_u32 s101, s101, 1
    s_cbranch_scc1 K2_END
    buffer_load_dwordx4 v[132:135], v164, s[32:35], 0 offen sc1
    buffer_load_dwordx4 v[136:139], v165, s[32:35], 0 offen sc1
    s_waitcnt vmcnt(0)
    s_branch K2_XVb
K2_XWb:
    s_branch K2_PADS0
K2_SLOW:
    s_add_u32 s81, s81, 448
    s_cmp_lt_u32 s81, s82
    s_cbranch_scc1 K2_BATCH
K2_FIND:
    s_cmp_lg_u64 s[84:85], 0
    s_cbranch_scc1 K2_GOT
    s_add_u32 s79, s79, 1
    s_cmp_ge_u32 s79, 4
    s_cbranch_scc1 K2_EPI
    s_mul_i32 s10, s12, 32896
    s_lshl_b32 s11, s79, 13
    s_add_u32 s10, s10, s11
    v_lshlrev_b32 v252, 7, v254
    buffer_load_ubyte v252, v252, s[24:27], s10 offen offset:15 sc1
    s_waitcnt vmcnt(0)
    v_cmp_lt_u32 s[84:85], s77, v252
    s_nop 3
    s_branch K2_FIND
K2_GOT:
    s_ff1_i32_b64 s10, s[84:85]
    s_bitset0_b64 s[84:85], s10
    s_lshl_b32 s11, s79, 6
    s_add_u32 s80, s10, s11
    s_mul_i32 s10, s12, 32896
    s_lshl_b32 s11, s80, 7
    s_add_u32 s10, s10, s11
    s_lshl_b32 s11, s12, 8
    s_add_u32 s11, s11, s80
    s_lshl_b32 s11, s11, 2
    s_add_u32 s11, s11, 23068672
    v_mov_b32 v188, 0
    buffer_load_ubyte v189, v188, s[24:27], s10 offen offset:15 sc1
    buffer_load_dword v190, v188, s[24:27], s11 offen sc1
    s_waitcnt vmcnt(0)
    v_readfirstlane_b32 s10, v189
    v_readfirstlane_b32 s11, v190
    s_nop 3
    s_and_b32 s83, s11, 0xffff
    s_lshr_b32 s11, s11, 16
    s_lshr_b32 s82, s10, 2
    s_sub_u32 s82, s10, s82
    s_cmp_gt_u32 s10, 48
    s_cselect_b32 s82, s11, s82
    s_lshr_b32 s10, s77, 2
    s_sub_u32 s81, s77, s10
K2_BATCH:
    s_barrier
    v_and_b32 v188, 7, v254
    v_mul_u32_u24 v189, 2688, v188
    v_add_u32 v189, 9728, v189
    v_lshlrev_b32 v188, 2, v188
    ds_write_b32 v188, v189 offset:2112
    v_add_u32 v188, s81, v255
    s_mul_i32 s10, s12, 32896
    s_lshl_b32 s11, s80, 7
    s_add_u32 s10, s10, s11
    v_mul_u32_u24 v190, 87382, v188
    v_lshrrev_b32 v190, 16, v190
    v_lshl_add_u32 v189, v190, 2, s10
    v_add_u32 v191, 8421248, v189
    v_cmp_lt_u32 vcc, 31, v190
    s_mul_i32 s11, s80, 3125
    s_add_u32 s11, s11, s83
    v_cndmask_b32 v189, v189, v191, vcc
    v_or_b32 v191, 12, v189
    v_and_b32 v192, 3, v190
    v_add_u32 v191, v191, v192
    v_cmp_le_u32 vcc, 48, v190
    v_add_u32 v190, s11, v188
    v_add_u32 v192, 22020096, v190
    v_cndmask_b32 v191, v191, v192, vcc
    v_lshlrev_b32 v190, 2, v190
    v_add_u32 v190, 17825792, v190
    v_cndmask_b32 v189, v189, v190, vcc
    s_add_u32 s10, s81, 448
    s_min_u32 s10, s10, s82
    v_cmp_gt_u32 vcc, s10, v188
    v_mov_b32 v190, 0x7ffffff0
    s_mul_i32 s86, s80, 100000
    v_cndmask_b32 v189, v190, v189, vcc
    v_cndmask_b32 v191, v190, v191, vcc
    buffer_load_dword v189, v189, s[24:27], 0 offen sc1
    buffer_load_ubyte v191, v191, s[24:27], 0 offen sc1
    s_waitcnt lgkmcnt(0)
    s_barrier
    s_and_saveexec_b64 s[10:11], vcc
    s_waitcnt vmcnt(0)
    v_and_b32 v188, 255, v189
    v_lshlrev_b32 v188, 2, v188
    ds_read_b32 v188, v188 offset:6400
    v_bfe_u32 v190, v189, 8, 8
    v_and_b32 v191, 15, v191
    v_lshl_or_b32 v191, v191, 8, v190
    v_mov_b32 v190, 4
    v_lshl_add_u32 v191, v191, 5, s86
    s_waitcnt lgkmcnt(0)
    ds_add_rtn_u32 v188, v188, v190 offset:2112
    s_waitcnt lgkmcnt(0)
    ds_write2st64_b32 v188, v189, v191 offset0:0 offset1:84
    s_mov_b64 exec, -1
    s_waitcnt lgkmcnt(0)
    s_barrier
    s_lshl_b32 s10, s3, 2
    v_mov_b32 v188, s10
    ds_read_b32 v188, v188 offset:2112
    v_mov_b32 v180, 0
    v_mov_b32 v181, 0
    v_mov_b32 v182, 0
    v_mov_b32 v183, 0
    v_mov_b32 v184, 0
    v_mov_b32 v185, 0
    v_mov_b32 v186, 0
    v_mov_b32 v187, 0
    v_lshrrev_b32 v189, 3, v254
    v_lshl_add_u32 v247, v189, 4, s76
    v_and_b32 v189, 31, v254
    v_lshl_add_u32 v249, v189, 2, s76
    v_lshrrev_b32 v190, 1, v254
    v_lshl_add_u32 v251, v190, 2, s76
    v_add_u32 v251, 21504, v251
    v_and_b32 v189, 44, v254
    v_add_u32 v248, s76, v189
    s_waitcnt lgkmcnt(0)
    v_readfirstlane_b32 s15, v188
    s_nop 3
    v_mov_b32 v190, 0xffff0000
    v_or_b32 v189, s39, v190
    v_mov_b32 v190, 0x7fffff00
    v_lshl_add_u32 v188, v254, 2, s15
    s_sub_u32 s73, s15, s76
    ds_write2st64_b32 v188, v189, v190 offset0:0 offset1:84
    ds_write2st64_b32 v188, v189, v190 offset0:1 offset1:85
    s_add_u32 s73, s73, 127
    s_lshr_b32 s73, s73, 7
    s_sub_i32 s38, s73, 1
K2_LAST:
    s_branch K2_GO
.section .rodata,"a"
.p2align 6
.amdhsa_kernel standalone__edge_featured_mpnn_gatedgcn__graph_kernel
  .amdhsa_next_free_vgpr 256
  .amdhsa_next_free_sgpr 102
  .amdhsa_accum_offset 256
  .amdhsa_group_segment_fixed_size 0
  .amdhsa_kernarg_size 96
  .amdhsa_user_sgpr_count 2
  .amdhsa_user_sgpr_kernarg_segment_ptr 1
  .amdhsa_system_sgpr_workgroup_id_x 1
.end_amdhsa_kernel
```

```asm
; @launch grid=(256,1,1) block=(512,1,1) lds=157696
.amdgcn_target "amdgcn-amd-amdhsa--gfx950"
.text
.globl standalone__edge_featured_mpnn_gatedgcn__graph_kernel
.p2align 8
.type standalone__edge_featured_mpnn_gatedgcn__graph_kernel,@function
standalone__edge_featured_mpnn_gatedgcn__graph_kernel:
    s_cmp_ge_u32 s2, 256
    s_cbranch_scc1 K2_END
    s_load_dwordx4 s[44:47], s[0:1], 16
    s_load_dwordx2 s[8:9], s[0:1], 88
    s_load_dwordx4 s[40:43], s[0:1], 0
    s_load_dwordx8 s[48:55], s[0:1], 32
    s_load_dwordx4 s[56:59], s[0:1], 64
    s_getpc_b64 s[86:87]
K2_PC:
    v_lshlrev_b32 v252, 7, v0
    v_min_u32 v252, K2_LAST-K2_PC, v252
    v_cmp_gt_u32 vcc, 192, v0
    s_cbranch_vccz K2_NOCPF
    global_load_dword v253, v252, s[86:87]
K2_NOCPF:
    v_mov_b32 v255, v0
    v_lshrrev_b32 v188, 6, v0
    v_and_b32 v254, 63, v0
    v_readfirstlane_b32 s7, v188
    s_and_b32 s10, s2, 7
    s_lshr_b32 s11, s2, 3
    s_lshl_b32 s10, s10, 5
    s_add_u32 s12, s10, s11
    s_mul_i32 s13, s12, 12500
    v_lshlrev_b32 v189, 4, v0
    v_lshlrev_b32 v1, 3, v0
    v_lshlrev_b32 v2, 2, v0
    v_mov_b32 v3, 0
    v_and_b32 v4, 0x3fc, v2
    ds_write_b32 v4, v3 offset:6400
    s_and_b32 s10, s7, 3
    s_lshr_b32 s3, s7, 2
    s_lshl1_add_u32 s3, s10, s3
    s_xor_b32 s3, s3, 1
    s_movk_i32 s14, 8192
    s_movk_i32 s15, 12288
    s_waitcnt lgkmcnt(0)
    s_add_u32 s64, s46, s13
    s_addc_u32 s65, s47, 0
    s_mov_b32 s66, 12500
    s_mov_b32 s67, 0x20000
    s_add_u32 s68, s44, s13
    s_addc_u32 s69, s45, 0
    s_mov_b32 s70, 12500
    s_mov_b32 s71, 0x20000
    buffer_load_dwordx4 v[8:11], v189, s[64:67], 0 offen nt
    buffer_load_dwordx2 v[12:13], v1, s[64:67], s14 offen nt
    buffer_load_dword v14, v2, s[64:67], s15 offen nt
    s_barrier
    buffer_load_dwordx4 v[16:19], v189, s[68:71], 0 offen nt
    buffer_load_dwordx2 v[20:21], v1, s[68:71], s14 offen nt
    buffer_load_dword v22, v2, s[68:71], s15 offen nt
    s_add_u32 s10, s8, 24117248
    s_addc_u32 s11, s9, 0
    s_load_dword s100, s[10:11], 0
    v_lshrrev_b32 v1, 3, v0
    v_lshlrev_b32 v170, 2, v1
    v_and_b32 v197, 7, v0
    v_and_b32 v5, 16, v0
    v_lshlrev_b32 v5, 1, v5
    v_xor_b32 v5, v5, v189
    v_lshlrev_b32 v172, 4, v254
    v_and_b32 v241, 16, v254
    v_lshlrev_b32 v241, 2, v241
    v_xor_b32 v234, v241, v172
    v_and_b32 v241, 0x70, v234
    s_mov_b32 s16, s40
    s_mov_b32 s17, s41
    s_mov_b32 s18, 6400000
    s_mov_b32 s19, 0x20000
    s_mov_b32 s60, 85599
    s_mov_b32 s61, 4294967100
    s_movk_i32 s62, 2000
    v_mov_b32 v7, 87382
    s_mov_b32 s10, 0
    v_lshl_add_u32 v56, v254, 10, s10
    v_add_u32 v57, 256, v56
    v_add_u32 v58, 512, v56
    v_add_u32 v59, 768, v56
    v_and_b32 v60, 127, v255
    v_lshl_add_u32 v60, v60, 9, s10
    v_add_u32 v61, 256, v60
    v_lshl_add_u32 v62, v254, 8, s10
    v_lshrrev_b32 v23, 6, v255
    v_lshrrev_b32 v31, 7, v255
    v_add_u32 v31, 8, v31
    v_mov_b32 v39, 12
    v_cmp_gt_u32 s[78:79], 53, v255
    s_mov_b32 s11, 32896
    v_lshlrev_b32 v3, 4, v197
    v_mad_u32_u24 v4, v1, s11, v3
    v_mul_u32_u24 v6, 52, v1
    v_lshl_add_u32 v6, v197, 2, v6
    v_lshlrev_b32 v3, 2, v6
    v_add_u32 v3, 104448, v3
    v_add_u32 v6, 91136, v6
    v_mov_b32 v214, 0xf0f0f0
    v_mov_b32 v15, 0x0f0f0f
    s_waitcnt vmcnt(3)
    v_mul_u32_u24 v48, s60, v8
    v_mul_u32_u24 v49, s60, v9
    v_mul_u32_u24 v50, s60, v10
    v_mul_u32_u24 v51, s60, v11
    v_mul_u32_u24 v52, s60, v12
    v_mul_u32_u24 v53, s60, v13
    v_lshrrev_b32 v48, 24, v48
    v_lshrrev_b32 v49, 24, v49
    v_lshrrev_b32 v50, 24, v50
    v_lshrrev_b32 v51, 24, v51
    v_lshrrev_b32 v52, 24, v52
    v_lshrrev_b32 v53, 24, v53
    v_lshl_add_u32 v24, v48, 2, s62
    ds_add_rtn_u32 v32, v24, v7 offset:4400
    v_lshl_add_u32 v25, v49, 2, s62
    ds_add_rtn_u32 v33, v25, v7 offset:4400
    v_lshl_add_u32 v26, v50, 2, s62
    ds_add_rtn_u32 v34, v26, v7 offset:4400
    v_lshl_add_u32 v27, v51, 2, s62
    ds_add_rtn_u32 v35, v27, v7 offset:4400
    v_lshl_add_u32 v28, v52, 2, s62
    ds_add_rtn_u32 v36, v28, v7 offset:4400
    v_lshl_add_u32 v29, v53, 2, s62
    ds_add_rtn_u32 v37, v29, v7 offset:4400
    v_mad_i32_i24 v8, v48, s61, v8
    v_or_b32 v8, v8, v56
    v_mad_i32_i24 v9, v49, s61, v9
    v_or_b32 v9, v9, v57
    v_mad_i32_i24 v10, v50, s61, v10
    v_or_b32 v10, v10, v58
    v_mad_i32_i24 v11, v51, s61, v11
    v_or_b32 v11, v11, v59
    v_mad_i32_i24 v12, v52, s61, v12
    v_or_b32 v12, v12, v60
    v_mad_i32_i24 v13, v53, s61, v13
    v_or_b32 v13, v13, v61
    s_waitcnt lgkmcnt(5)
    v_lshrrev_b32 v32, 16, v32
    v_min_u32 v40, 48, v32
    v_mad_u32_u24 v40, v24, 13, v40
    v_lshlrev_b32 v48, 2, v40
    ds_write_b8 v40, v23 offset:65136
    s_waitcnt lgkmcnt(5)
    v_lshrrev_b32 v33, 16, v33
    v_min_u32 v41, 48, v33
    v_mad_u32_u24 v41, v25, 13, v41
    v_lshlrev_b32 v49, 2, v41
    ds_write_b8 v41, v23 offset:65136
    s_waitcnt lgkmcnt(5)
    v_lshrrev_b32 v34, 16, v34
    v_min_u32 v42, 48, v34
    v_mad_u32_u24 v42, v26, 13, v42
    v_lshlrev_b32 v50, 2, v42
    ds_write_b8 v42, v23 offset:65136
    s_waitcnt lgkmcnt(5)
    v_lshrrev_b32 v35, 16, v35
    v_min_u32 v43, 48, v35
    v_mad_u32_u24 v43, v27, 13, v43
    v_lshlrev_b32 v51, 2, v43
    ds_write_b8 v43, v23 offset:65136
    s_waitcnt lgkmcnt(5)
    v_lshrrev_b32 v36, 16, v36
    v_min_u32 v44, 48, v36
    v_mad_u32_u24 v44, v28, 13, v44
    v_lshlrev_b32 v52, 2, v44
    ds_write_b8 v44, v31 offset:65136
    s_waitcnt lgkmcnt(5)
    v_lshrrev_b32 v37, 16, v37
    v_min_u32 v45, 48, v37
    v_mad_u32_u24 v45, v29, 13, v45
    v_lshlrev_b32 v53, 2, v45
    ds_write_b8 v45, v31 offset:65136
    s_cmp_lg_u32 s7, 0
    s_cbranch_scc1 K1_NO7
    s_mov_b64 exec, s[78:79]
    s_waitcnt lgkmcnt(0)
    v_mul_u32_u24 v54, s60, v14
    v_lshrrev_b32 v54, 24, v54
    v_lshl_add_u32 v30, v54, 2, s62
    ds_add_rtn_u32 v38, v30, v7 offset:4400
    v_mad_i32_i24 v14, v54, s61, v14
    v_or_b32 v14, v14, v62
    s_waitcnt lgkmcnt(0)
    v_lshrrev_b32 v38, 16, v38
    v_min_u32 v46, 48, v38
    v_mad_u32_u24 v46, v30, 13, v46
    v_lshlrev_b32 v54, 2, v46
    ds_write_b8 v46, v39 offset:65136
    s_waitcnt vmcnt(0)
    v_lshl_add_u32 v22, v22, 16, v14
    ds_write_b32 v54, v22 offset:448
    s_mov_b64 exec, -1
K1_NO7:
    s_mov_b32 s64, s50
    s_mov_b32 s65, s51
    s_mov_b32 s66, 8192
    s_mov_b32 s67, 0x20000
    buffer_load_dwordx4 v[64:67], v5, s[64:67], 0 offen
    s_mov_b32 s68, s52
    s_mov_b32 s69, s53
    s_mov_b32 s70, 2048
    s_mov_b32 s71, 0x20000
    buffer_load_dwordx4 v[68:71], v5, s[68:71], 0 offen
    s_lshl_b32 s10, s7, 10
    s_mov_b32 s64, s48
    s_mov_b32 s65, s49
    s_add_u32 m0, s10, 34304
    s_nop 0
    buffer_load_dwordx4 v5, s[64:67], 0 offen lds
    s_mov_b32 s64, s56
    s_mov_b32 s65, s57
    s_add_u32 m0, s10, 26112
    s_nop 0
    buffer_load_dwordx4 v5, s[64:67], 0 offen lds
    s_mov_b32 s64, s54
    s_mov_b32 s65, s55
    s_add_u32 m0, s10, 9728
    s_nop 0
    buffer_load_dwordx4 v5, s[64:67], 0 offen lds
    s_waitcnt vmcnt(5)
    v_lshl_add_u32 v16, v16, 16, v8
    ds_write_b32 v48, v16 offset:448
    v_lshl_add_u32 v17, v17, 16, v9
    ds_write_b32 v49, v17 offset:448
    v_lshl_add_u32 v18, v18, 16, v10
    ds_write_b32 v50, v18 offset:448
    v_lshl_add_u32 v19, v19, 16, v11
    ds_write_b32 v51, v19 offset:448
    v_lshl_add_u32 v20, v20, 16, v12
    ds_write_b32 v52, v20 offset:448
    v_lshl_add_u32 v21, v21, 16, v13
    ds_write_b32 v53, v21 offset:448
    s_lshl_b32 s15, s12, 7
    s_add_u32 s32, s8, s15
    s_addc_u32 s33, s9, 0
    s_mov_b32 s34, 16809984
    s_mov_b32 s35, 0x20000
    s_waitcnt lgkmcnt(0)
    s_add_u32 s100, s100, 1
    s_and_b32 s10, s100, 15
    s_and_b32 s11, s100, 0xf0
    s_mul_i32 s36, s10, 0x1010
    s_lshl_b32 s11, s11, 16
    s_or_b32 s36, s36, s11
    s_and_b32 s10, s100, 0x700
    s_lshl4_add_u32 s10, s10, 0x8000
    s_xor_b32 s36, s36, s10
    s_mov_b32 s101, 300000
    s_barrier
    ds_read_b128 v[112:115], v172 offset:6400
    ds_read_u16 v108, v170 offset:6402
    ds_read_b32 v104, v6 offset:0
    ds_read_b128 v[88:91], v3 offset:0
    ds_read_u16 v109, v170 offset:6658
    ds_read_b32 v105, v6 offset:3328
    ds_read_b128 v[92:95], v3 offset:13312
    ds_read_u16 v110, v170 offset:6914
    ds_read_b32 v106, v6 offset:6656
    ds_read_b128 v[96:99], v3 offset:26624
    ds_read_u16 v111, v170 offset:7170
    ds_read_b32 v107, v6 offset:9984
    ds_read_b128 v[100:103], v3 offset:39936
    s_waitcnt lgkmcnt(12)
    v_max3_u32 v1, v112, v113, v114
    v_max_u32 v1, v1, v115
    v_cmp_le_u32 vcc, 3211264, v1
    s_mov_b32 s10, 0
    s_cbranch_vccnz K1_OVF
K1_OUT:
    s_waitcnt lgkmcnt(9)
    v_lshl_or_b32 v108, v108, 24, s36
    v_and_or_b32 v91, v104, v15, v108
    buffer_store_dwordx4 v[88:91], v4, s[32:35], s10 offen sc1
    s_add_u32 s10, s10, 2105344
    s_waitcnt lgkmcnt(6)
    v_lshl_or_b32 v109, v109, 24, s36
    v_and_or_b32 v95, v105, v15, v109
    buffer_store_dwordx4 v[92:95], v4, s[32:35], s10 offen sc1
    s_add_u32 s10, s10, 2105344
    s_waitcnt lgkmcnt(3)
    v_lshl_or_b32 v110, v110, 24, s36
    v_and_or_b32 v99, v106, v15, v110
    buffer_store_dwordx4 v[96:99], v4, s[32:35], s10 offen sc1
    s_add_u32 s10, s10, 2105344
    s_waitcnt lgkmcnt(0)
    v_lshl_or_b32 v111, v111, 24, s36
    v_and_or_b32 v103, v107, v15, v111
    buffer_store_dwordx4 v[100:103], v4, s[32:35], s10 offen sc1
    s_add_u32 s10, s10, 2105344
    v_max3_u32 v1, v108, v109, v110
    v_max_u32 v1, v1, v111
    v_cmp_le_u32 vcc, 553648128, v1
    s_cbranch_vccnz K1_EXT
K1_EXTR:
    s_lshr_b32 s10, s3, 1
    s_mul_i32 s10, s10, 49
    s_bitcmp1_b32 s3, 0
    s_cselect_b32 s72, 20, -4
    s_cselect_b32 s73, 28, 3
    s_cselect_b32 s84, 45, 20
    s_add_i32 s72, s72, s10
    s_add_i32 s73, s73, s10
    s_add_i32 s84, s84, s10
    s_add_i32 s85, s72, 32
    s_max_i32 s96, s72, 0
    s_cmp_eq_u32 s3, 7
    s_cselect_b32 s84, 196, s84
    s_cselect_b32 s85, 196, s85
    v_lshrrev_b32 v193, 5, v254
    s_mov_b32 s20, s42
    s_mov_b32 s21, s43
    s_mov_b32 s22, 25600000
    s_mov_b32 s23, 0x20000
    s_mov_b32 s28, s58
    s_mov_b32 s29, s59
    s_mov_b32 s30, 6400000
    s_mov_b32 s31, 0x20000
    s_mov_b32 s24, s8
    s_mov_b32 s25, s9
    s_mov_b32 s26, 24117376
    s_mov_b32 s27, 0x20000
    v_lshrrev_b32 v194, 5, v255
    v_and_b32 v195, 15, v255
    v_cmp_eq_u32 vcc, v194, v195
    v_and_b32 v194, 16, v255
    v_mov_b32 v195, 0x3f80
    v_lshlrev_b32 v195, v194, v195
    v_cndmask_b32 v195, 0, v195, vcc
    v_lshlrev_b32 v194, 2, v255
    v_mov_b32 v196, 0
    ds_write_b32 v194, v195
    v_bfe_u32 v195, v255, 3, 1
    v_and_b32 v201, 7, v255
    v_lshl_add_u32 v195, v195, 2, v201
    v_lshrrev_b32 v200, 6, v255
    v_cmp_eq_u32 vcc, v195, v200
    v_bfe_u32 v200, v255, 4, 2
    v_mov_b32 v195, 0x3f80
    v_cndmask_b32 v195, 0, v195, vcc
    v_cmp_lt_u32 vcc, 3, v201
    v_mul_u32_u24 v200, 0x5555, v200
    v_and_b32 v201, 60, v194
    v_cndmask_b32 v195, v195, v200, vcc
    ds_write_b32 v194, v195 offset:7424
    ds_write_b32 v201, v196 offset:9472
    ds_write_b32 v194, v196 offset:2048
    ds_write2st64_b32 v194, v196, v196 offset0:9 offset1:17
    s_movk_i32 s75, 128
    s_mul_i32 s74, s3, 5184
    s_add_u32 s74, s74, 102400
    s_movk_i32 s77, 48
    s_add_u32 s39, s96, 32
    s_lshl_b32 s11, s96, 6
    s_mov_b32 s97, 0
    v_bfe_u32 v194, v254, 4, 1
    v_and_b32 v242, 1, v254
    v_lshlrev_b32 v242, 4, v242
    v_lshlrev_b32 v245, 5, v193
    v_subrev_u32 v245, s11, v245
    v_and_b32 v195, 3, v254
    v_lshlrev_b32 v195, 3, v195
    v_lshl_add_u32 v246, v194, 5, v195
    v_subrev_u32 v246, s11, v246
    v_mul_u32_u24 v196, 130, v195
    v_and_b32 v194, 28, v254
    v_lshl_add_u32 v196, v194, 5, v196
    v_bfe_u32 v194, v254, 3, 1
    v_xor_b32 v194, v194, v193
    v_lshl_add_u32 v196, v194, 6, v196
    v_add_u32 v243, s74, v196
    v_and_b32 v194, 31, v254
    v_lshl_add_u32 v194, v194, 1, v193
    v_lshl_add_u32 v244, v194, 4, s74
    v_add_u32 v244, 4160, v244
    s_mul_i32 s76, s3, 2688
    s_add_u32 s76, s76, 9728
    v_lshrrev_b32 v194, 3, v254
    v_lshl_add_u32 v247, v194, 4, s76
    v_and_b32 v194, 31, v254
    v_lshl_add_u32 v249, v194, 2, s76
    v_lshrrev_b32 v195, 1, v254
    v_lshl_add_u32 v251, v195, 2, s76
    v_add_u32 v251, 21504, v251
    v_and_b32 v194, 44, v254
    v_add_u32 v248, s76, v194
    s_mul_i32 s10, s7, 4160
    s_add_u32 s10, s10, 69120
    v_and_b32 v202, 31, v254
    v_bfe_u32 v194, v202, 1, 1
    v_xor_b32 v194, v194, v193
    v_lshlrev_b32 v194, 6, v194
    v_lshl_add_u32 v194, v202, 7, v194
    v_lshrrev_b32 v202, 3, v202
    v_lshl_add_u32 v202, v202, 4, v194
    v_add_u32 v202, s10, v202
    v_lshrrev_b32 v194, 1, v254
    v_xor_b32 v194, v194, v254
    v_and_b32 v194, 4, v194
    v_mul_u32_u24 v194, 3, v194
    v_xor_b32 v194, v194, v254
    v_and_b32 v235, 31, v194
    v_bfe_u32 v195, v235, 1, 1
    v_xor_b32 v195, v195, v193
    v_lshlrev_b32 v195, 6, v195
    v_lshl_add_u32 v195, v235, 7, v195
    v_lshrrev_b32 v235, 3, v235
    v_lshl_add_u32 v235, v235, 4, v195
    v_add_u32 v235, s10, v235
    v_mov_b32 v177, 0xdddd
    v_lshlrev_b32 v168, 2, v197
    v_mul_u32_u24 v208, 25000, v170
    v_add_u32 v209, 6400000, v208
    v_add_u32 v210, 12800000, v208
    v_add_u32 v211, 19200000, v208
    v_mov_b32 v171, 4
    v_mov_b32 v169, 1
    v_and_b32 v199, 31, v254
    v_add_u32 v199, s96, v199
    v_lshlrev_b32 v200, 4, v199
    v_lshl_add_u32 v200, v193, 3, v200
    v_mov_b64 v[180:181], 0
    v_mov_b64 v[182:183], 0
    v_mov_b64 v[184:185], 0
    v_mov_b64 v[186:187], 0
    s_lshl_b32 s15, s3, 2
    v_mov_b32 v212, s15
    v_lshlrev_b32 v213, 2, v199
    s_mul_i32 s10, s12, 32896
    s_add_u32 s32, s8, s10
    s_addc_u32 s33, s9, 0
    s_mov_b32 s34, 32768
    s_mov_b32 s35, 0x20000
    s_movk_i32 s79, 8192
    s_movk_i32 s80, 16384
    s_movk_i32 s81, 24576
    s_mov_b32 s10, 0xbfb8aa3b
    s_waitcnt vmcnt(7)
    v_lshlrev_b32 v72, 16, v64
    v_and_b32 v73, 0xffff0000, v64
    v_lshlrev_b32 v74, 16, v65
    v_and_b32 v75, 0xffff0000, v65
    v_lshlrev_b32 v76, 16, v66
    v_and_b32 v77, 0xffff0000, v66
    v_lshlrev_b32 v78, 16, v67
    v_and_b32 v79, 0xffff0000, v67
    v_lshlrev_b32 v80, 16, v68
    v_and_b32 v81, 0xffff0000, v68
    v_lshlrev_b32 v82, 16, v69
    v_and_b32 v83, 0xffff0000, v69
    v_lshlrev_b32 v84, 16, v70
    v_and_b32 v85, 0xffff0000, v70
    v_lshlrev_b32 v86, 16, v71
    v_and_b32 v87, 0xffff0000, v71
    v_mul_f32 v72, s10, v72
    v_mul_f32 v73, s10, v73
    v_mul_f32 v74, s10, v74
    v_mul_f32 v75, s10, v75
    v_mul_f32 v76, s10, v76
    v_mul_f32 v77, s10, v77
    v_mul_f32 v78, s10, v78
    v_mul_f32 v79, s10, v79
    v_mul_f32 v80, s10, v80
    v_mul_f32 v81, s10, v81
    v_mul_f32 v82, s10, v82
    v_mul_f32 v83, s10, v83
    v_mul_f32 v84, s10, v84
    v_mul_f32 v85, s10, v85
    v_mul_f32 v86, s10, v86
    v_mul_f32 v87, s10, v87
    v_cvt_pk_bf16_f32 v64, v72, v73
    v_cvt_pk_bf16_f32 v65, v74, v75
    v_cvt_pk_bf16_f32 v66, v76, v77
    v_cvt_pk_bf16_f32 v67, v78, v79
    v_cvt_pk_bf16_f32 v68, v80, v81
    v_cvt_pk_bf16_f32 v69, v82, v83
    v_cvt_pk_bf16_f32 v70, v84, v85
    v_cvt_pk_bf16_f32 v71, v86, v87
    ds_write_b128 v189, v[64:67] offset:17920
    s_cmp_ge_u32 s7, 2
    s_cbranch_scc1 K1_NOWC
    ds_write_b128 v189, v[68:71] offset:42496
K1_NOWC:
    v_bfe_u32 v173, v254, 2, 2
    v_lshlrev_b32 v173, 7, v173
    v_lshl_add_u32 v173, v242, 2, v173
    v_and_b32 v174, 16, v254
    v_and_b32 v175, 2, v254
    v_lshl_add_u32 v174, v175, 2, v174
    v_and_b32 v175, 8, v254
    v_lshl_add_u32 v174, v175, 2, v174
    v_add_u32 v173, v173, v174
    v_lshl_add_u32 v175, v193, 10, v173
    v_lshl_add_u32 v173, v193, 12, v173
    v_xor_b32 v174, 32, v173
    v_xor_b32 v176, 32, v175
    s_lshl_b32 s10, s7, 10
    s_and_b32 s11, s7, 4
    s_mul_i32 s11, s11, -1016
    s_add_u32 s11, s11, s10
    v_xor_b32 v252, s11, v173
    s_waitcnt vmcnt(0) lgkmcnt(0)
    s_barrier
    buffer_load_dwordx4 v[88:91], v189, s[32:35], 0 offen sc1
    buffer_load_dwordx4 v[92:95], v189, s[32:35], s79 offen sc1
    buffer_load_dwordx4 v[96:99], v189, s[32:35], s80 offen sc1
    buffer_load_dwordx4 v[100:103], v189, s[32:35], s81 offen sc1
    ds_read_b64_tr_b16 v[72:73], v252 offset:9728
    ds_read_b64_tr_b16 v[76:77], v252 offset:34304
    ds_read_b64_tr_b16 v[74:75], v252 offset:10240
    ds_read_b64_tr_b16 v[78:79], v252 offset:34816
    v_add_u32 v252, s10, v172
    ds_read_b64_tr_b16 v[0:1], v173 offset:17920
    ds_read_b64_tr_b16 v[2:3], v173 offset:18432
    ds_read_b64_tr_b16 v[4:5], v173 offset:18944
    ds_read_b64_tr_b16 v[6:7], v173 offset:19456
    ds_read_b64_tr_b16 v[8:9], v173 offset:19968
    ds_read_b64_tr_b16 v[10:11], v173 offset:20480
    ds_read_b64_tr_b16 v[12:13], v173 offset:20992
    ds_read_b64_tr_b16 v[14:15], v173 offset:21504
    s_waitcnt lgkmcnt(8)
    ds_write_b128 v252, v[72:75] offset:52736
    s_mov_b32 s10, 0xbfb8aa3b
    v_lshlrev_b32 v80, 16, v76
    v_and_b32 v81, 0xffff0000, v76
    v_lshlrev_b32 v82, 16, v77
    v_and_b32 v83, 0xffff0000, v77
    v_lshlrev_b32 v84, 16, v78
    v_and_b32 v85, 0xffff0000, v78
    v_lshlrev_b32 v86, 16, v79
    v_and_b32 v87, 0xffff0000, v79
    v_mul_f32 v80, s10, v80
    v_mul_f32 v81, s10, v81
    v_mul_f32 v82, s10, v82
    v_mul_f32 v83, s10, v83
    v_mul_f32 v84, s10, v84
    v_mul_f32 v85, s10, v85
    v_mul_f32 v86, s10, v86
    v_mul_f32 v87, s10, v87
    v_cvt_pk_bf16_f32 v76, v80, v81
    v_cvt_pk_bf16_f32 v77, v82, v83
    v_cvt_pk_bf16_f32 v78, v84, v85
    v_cvt_pk_bf16_f32 v79, v86, v87
    ds_write_b128 v252, v[76:79] offset:60928
    v_and_b32 v188, 3, v254
    v_lshlrev_b32 v190, 4, v188
    v_mul_u32_u24 v188, 5376, v188
    v_add_u32 v188, 2688, v188
    ds_write_b16 v190, v188 offset:6338
    s_waitcnt lgkmcnt(8)
    ds_read_b64_tr_b16 v[16:17], v174 offset:17920
    ds_read_b64_tr_b16 v[18:19], v174 offset:18432
    ds_read_b64_tr_b16 v[20:21], v174 offset:18944
    ds_read_b64_tr_b16 v[22:23], v174 offset:19456
    ds_read_b64_tr_b16 v[24:25], v174 offset:19968
    ds_read_b64_tr_b16 v[26:27], v174 offset:20480
    s_waitcnt lgkmcnt(8)
    ds_read_b64_tr_b16 v[28:29], v174 offset:20992
    ds_read_b64_tr_b16 v[30:31], v174 offset:21504
    ds_read_b64_tr_b16 v[64:65], v175 offset:42496
    ds_read_b64_tr_b16 v[66:67], v175 offset:43008
    ds_read_b64_tr_b16 v[68:69], v176 offset:42496
    ds_read_b64_tr_b16 v[70:71], v176 offset:43008
    s_waitcnt lgkmcnt(8)
    ds_read_b64_tr_b16 v[32:33], v173 offset:26112
    ds_read_b64_tr_b16 v[34:35], v173 offset:26624
    ds_read_b64_tr_b16 v[36:37], v173 offset:27136
    ds_read_b64_tr_b16 v[38:39], v173 offset:27648
    ds_read_b64_tr_b16 v[40:41], v173 offset:28160
    ds_read_b64_tr_b16 v[42:43], v173 offset:28672
    s_waitcnt lgkmcnt(8)
    ds_read_b64_tr_b16 v[44:45], v173 offset:29184
    ds_read_b64_tr_b16 v[46:47], v173 offset:29696
    ds_read_b64_tr_b16 v[48:49], v174 offset:26112
    ds_read_b64_tr_b16 v[50:51], v174 offset:26624
    ds_read_b64_tr_b16 v[52:53], v174 offset:27136
    ds_read_b64_tr_b16 v[54:55], v174 offset:27648
    s_waitcnt lgkmcnt(8)
    ds_read_b64_tr_b16 v[56:57], v174 offset:28160
    ds_read_b64_tr_b16 v[58:59], v174 offset:28672
    ds_read_b64_tr_b16 v[60:61], v174 offset:29184
    ds_read_b64_tr_b16 v[62:63], v174 offset:29696
    s_mov_b32 s5, 85899
    s_lshr_b32 s6, s12, 5
    s_mul_i32 s6, s6, 538758528
    s_sub_u32 s6, s6, 0
    s_mov_b32 s64, 0xc0c0401
    s_mov_b32 s65, 0xc0c0501
    s_mov_b32 s66, 0xc0c0601
    s_mov_b32 s67, 0x05040100
    s_movk_i32 s4, 1338
    s_movk_i32 s13, 4032
    s_movk_i32 s14, 16056
    s_waitcnt lgkmcnt(0)
    s_barrier
K2_CHK0:
    s_waitcnt vmcnt(3)
    v_bitop3_b32 v188, v91, s36, v214 bitop3:0x28
    v_cmp_ne_u32 vcc, 0, v188
    v_sub_u32_sdwa v188, v91, v168 dst_sel:DWORD dst_unused:UNUSED_PAD src0_sel:BYTE_3 src1_sel:DWORD
    v_mul_u32_u24_sdwa v104, s5, v88 dst_sel:DWORD dst_unused:UNUSED_PAD src0_sel:DWORD src1_sel:WORD_1
    v_mul_u32_u24_sdwa v105, s5, v89 dst_sel:DWORD dst_unused:UNUSED_PAD src0_sel:DWORD src1_sel:WORD_1
    v_mul_u32_u24_sdwa v106, s5, v90 dst_sel:DWORD dst_unused:UNUSED_PAD src0_sel:DWORD src1_sel:WORD_1
    s_cbranch_vccnz K2_RETRY0
    v_cmp_lt_i32 s[40:41], 0, v188
    v_cmp_lt_i32 s[42:43], 1, v188
    v_cmp_lt_i32 s[44:45], 2, v188
    v_subrev_u32 v104, s6, v104
    v_subrev_u32 v105, s6, v105
    v_subrev_u32 v106, s6, v106
    v_alignbit_b32 v104, v88, v104, 28
    v_alignbit_b32 v105, v89, v105, 28
    v_alignbit_b32 v106, v90, v106, 28
    v_and_b32 v104, 0xffc, v104
    v_and_b32 v105, 0xffc, v105
    v_and_b32 v106, 0xffc, v106
    v_mul_u32_u24_sdwa v116, s4, v88 dst_sel:DWORD dst_unused:UNUSED_PAD src0_sel:DWORD src1_sel:BYTE_0
    v_mul_u32_u24_sdwa v117, s4, v89 dst_sel:DWORD dst_unused:UNUSED_PAD src0_sel:DWORD src1_sel:BYTE_0
    v_mul_u32_u24_sdwa v118, s4, v90 dst_sel:DWORD dst_unused:UNUSED_PAD src0_sel:DWORD src1_sel:BYTE_0
    v_subrev_u32 v116, 40140, v116
    v_subrev_u32 v117, 40140, v117
    v_subrev_u32 v118, 40140, v118
    v_cmp_gt_u16 s[68:69], s14, v116
    v_cmp_gt_u16 s[70:71], s14, v117
    v_cmp_gt_u16 s[86:87], s14, v118
    v_lshrrev_b32 v116, 16, v116
    v_lshrrev_b32 v117, 16, v117
    v_lshrrev_b32 v118, 16, v118
    v_lshl_add_u32 v116, v116, 4, s13
    v_lshl_add_u32 v117, v117, 4, s13
    v_lshl_add_u32 v118, v118, 4, s13
    v_cndmask_b32 v104, v104, v116, s[68:69]
    v_cndmask_b32 v105, v105, v117, s[70:71]
    v_cndmask_b32 v106, v106, v118, s[86:87]
    s_mov_b64 exec, s[40:41]
    ds_add_rtn_u32 v220, v104, v171 offset:2304
    s_mov_b64 exec, s[42:43]
    ds_add_rtn_u32 v221, v105, v171 offset:2304
    s_mov_b64 exec, s[44:45]
    ds_add_rtn_u32 v222, v106, v171 offset:2304
    s_mov_b64 exec, -1
    v_and_b32 v119, 0x0f0f0f, v91
    v_perm_b32 v152, v119, v88, s64
    s_and_b64 s[68:69], s[68:69], s[40:41]
    v_lshl_add_u32 v152, v152, 5, v208
    s_andn2_b64 s[40:41], s[40:41], s[68:69]
    v_perm_b32 v153, v119, v89, s65
    s_and_b64 s[70:71], s[70:71], s[42:43]
    v_lshl_add_u32 v153, v153, 5, v208
    s_andn2_b64 s[42:43], s[42:43], s[70:71]
    v_perm_b32 v154, v119, v90, s66
    s_and_b64 s[86:87], s[86:87], s[44:45]
    v_lshl_add_u32 v154, v154, 5, v208
    s_andn2_b64 s[44:45], s[44:45], s[86:87]
K2_CHK1:
    s_waitcnt vmcnt(2)
    v_bitop3_b32 v188, v95, s36, v214 bitop3:0x28
    v_cmp_ne_u32 vcc, 0, v188
    v_sub_u32_sdwa v188, v95, v168 dst_sel:DWORD dst_unused:UNUSED_PAD src0_sel:BYTE_3 src1_sel:DWORD
    v_mul_u32_u24_sdwa v107, s5, v92 dst_sel:DWORD dst_unused:UNUSED_PAD src0_sel:DWORD src1_sel:WORD_1
    v_mul_u32_u24_sdwa v108, s5, v93 dst_sel:DWORD dst_unused:UNUSED_PAD src0_sel:DWORD src1_sel:WORD_1
    v_mul_u32_u24_sdwa v109, s5, v94 dst_sel:DWORD dst_unused:UNUSED_PAD src0_sel:DWORD src1_sel:WORD_1
    s_cbranch_vccnz K2_RETRY1
    v_cmp_lt_i32 s[46:47], 0, v188
    v_cmp_lt_i32 s[48:49], 1, v188
    v_cmp_lt_i32 s[50:51], 2, v188
    v_subrev_u32 v107, s6, v107
    v_subrev_u32 v108, s6, v108
    v_subrev_u32 v109, s6, v109
    v_alignbit_b32 v107, v92, v107, 28
    v_alignbit_b32 v108, v93, v108, 28
    v_alignbit_b32 v109, v94, v109, 28
    v_and_b32 v107, 0xffc, v107
    v_and_b32 v108, 0xffc, v108
    v_and_b32 v109, 0xffc, v109
    s_mov_b64 exec, s[46:47]
    ds_add_rtn_u32 v223, v107, v171 offset:2304
    s_mov_b64 exec, s[48:49]
    ds_add_rtn_u32 v224, v108, v171 offset:2304
    s_mov_b64 exec, s[50:51]
    ds_add_rtn_u32 v225, v109, v171 offset:2304
    s_mov_b64 exec, -1
    s_waitcnt lgkmcnt(0)
    v_min_u16 v116, 2176, v220
    v_add_u32_sdwa v116, v116, v220 dst_sel:DWORD dst_unused:UNUSED_PAD src0_sel:WORD_0 src1_sel:WORD_1
    v_min_u16 v117, 2176, v221
    v_add_u32_sdwa v117, v117, v221 dst_sel:DWORD dst_unused:UNUSED_PAD src0_sel:WORD_0 src1_sel:WORD_1
    v_min_u16 v118, 2176, v222
    v_add_u32_sdwa v118, v118, v222 dst_sel:DWORD dst_unused:UNUSED_PAD src0_sel:WORD_0 src1_sel:WORD_1
    s_mov_b64 exec, s[68:69]
    ds_write2st64_b32 v116, v88, v152 offset0:38 offset1:122
    s_mov_b64 exec, s[70:71]
    ds_write2st64_b32 v117, v89, v153 offset0:38 offset1:122
    s_mov_b64 exec, s[86:87]
    ds_write2st64_b32 v118, v90, v154 offset0:38 offset1:122
    s_mov_b64 exec, -1
K2_CHK2:
    s_waitcnt vmcnt(1)
    v_bitop3_b32 v188, v99, s36, v214 bitop3:0x28
    v_cmp_ne_u32 vcc, 0, v188
    v_sub_u32_sdwa v188, v99, v168 dst_sel:DWORD dst_unused:UNUSED_PAD src0_sel:BYTE_3 src1_sel:DWORD
    v_mul_u32_u24_sdwa v110, s5, v96 dst_sel:DWORD dst_unused:UNUSED_PAD src0_sel:DWORD src1_sel:WORD_1
    v_mul_u32_u24_sdwa v111, s5, v97 dst_sel:DWORD dst_unused:UNUSED_PAD src0_sel:DWORD src1_sel:WORD_1
    v_mul_u32_u24_sdwa v112, s5, v98 dst_sel:DWORD dst_unused:UNUSED_PAD src0_sel:DWORD src1_sel:WORD_1
    s_cbranch_vccnz K2_RETRY2
    v_cmp_lt_i32 s[52:53], 0, v188
    v_cmp_lt_i32 s[54:55], 1, v188
    v_cmp_lt_i32 s[56:57], 2, v188
    v_subrev_u32 v110, s6, v110
    v_subrev_u32 v111, s6, v111
    v_subrev_u32 v112, s6, v112
    v_alignbit_b32 v110, v96, v110, 28
    v_alignbit_b32 v111, v97, v111, 28
    v_alignbit_b32 v112, v98, v112, 28
    v_and_b32 v110, 0xffc, v110
    v_and_b32 v111, 0xffc, v111
    v_and_b32 v112, 0xffc, v112
    s_mov_b64 exec, s[52:53]
    ds_add_rtn_u32 v226, v110, v171 offset:2304
    s_mov_b64 exec, s[54:55]
    ds_add_rtn_u32 v227, v111, v171 offset:2304
    s_mov_b64 exec, s[56:57]
    ds_add_rtn_u32 v228, v112, v171 offset:2304
    s_mov_b64 exec, -1
K2_CHK3:
    s_waitcnt vmcnt(0)
    v_bitop3_b32 v188, v103, s36, v214 bitop3:0x28
    v_cmp_ne_u32 vcc, 0, v188
    v_sub_u32_sdwa v188, v103, v168 dst_sel:DWORD dst_unused:UNUSED_PAD src0_sel:BYTE_3 src1_sel:DWORD
    v_mul_u32_u24_sdwa v113, s5, v100 dst_sel:DWORD dst_unused:UNUSED_PAD src0_sel:DWORD src1_sel:WORD_1
    v_mul_u32_u24_sdwa v114, s5, v101 dst_sel:DWORD dst_unused:UNUSED_PAD src0_sel:DWORD src1_sel:WORD_1
    v_mul_u32_u24_sdwa v115, s5, v102 dst_sel:DWORD dst_unused:UNUSED_PAD src0_sel:DWORD src1_sel:WORD_1
    s_cbranch_vccnz K2_RETRY3
    v_cmp_lt_i32 s[58:59], 0, v188
    v_cmp_lt_i32 s[60:61], 1, v188
    v_cmp_lt_i32 s[62:63], 2, v188
    v_subrev_u32 v113, s6, v113
    v_subrev_u32 v114, s6, v114
    v_subrev_u32 v115, s6, v115
    v_alignbit_b32 v113, v100, v113, 28
    v_alignbit_b32 v114, v101, v114, 28
    v_alignbit_b32 v115, v102, v115, 28
    v_and_b32 v113, 0xffc, v113
    v_and_b32 v114, 0xffc, v114
    v_and_b32 v115, 0xffc, v115
    s_mov_b64 exec, s[58:59]
    ds_add_rtn_u32 v229, v113, v171 offset:2304
    s_mov_b64 exec, s[60:61]
    ds_add_rtn_u32 v230, v114, v171 offset:2304
    s_mov_b64 exec, s[62:63]
    ds_add_rtn_u32 v231, v115, v171 offset:2304
    s_mov_b64 exec, -1
    v_max3_u32 v188, v91, v95, v99
    v_max_u32 v188, v188, v103
    v_cmp_le_u32 vcc, 553648128, v188
    s_cbranch_vccnz K2_XT1
K2_XT1R:
    s_lshr_b32 s4, s3, 1
    s_add_u32 s4, s4, 60
    s_waitcnt lgkmcnt(0)
    s_barrier
    ds_read_b128 v[128:131], v172 offset:5376
    ds_read_b128 v[236:239], v247
    ds_read_b32 v240, v251
    ds_read_u8 v250, v249
    ds_read_b128 v[116:119], v172 offset:2304
    ds_read_b128 v[120:123], v172 offset:3328
    ds_read_b128 v[124:127], v172 offset:4352
    ds_read_b64 v[194:195], v200 offset:2304
    s_bitcmp1_b32 s3, 0
    s_cbranch_scc0 K2_NOX1
    s_mul_i32 s10, s12, 196
    s_add_u32 s10, s10, s96
    s_lshl_b32 s10, s10, 7
    s_mul_i32 s11, s7, 4160
    s_add_u32 m0, s11, 69120
    s_add_u32 s86, s10, 0
    buffer_load_dwordx4 v234, s[16:19], s86 offen lds
    s_add_u32 m0, s11, 70160
    s_add_u32 s86, s10, 1024
    buffer_load_dwordx4 v234, s[16:19], s86 offen lds
    s_add_u32 m0, s11, 71200
    s_add_u32 s86, s10, 2048
    buffer_load_dwordx4 v234, s[16:19], s86 offen lds
    s_add_u32 m0, s11, 72240
    s_add_u32 s86, s10, 3072
    buffer_load_dwordx4 v234, s[16:19], s86 offen lds
K2_NOX1:
    s_waitcnt lgkmcnt(5)
    v_readlane_b32 s68, v128, s4
    v_and_b32 v95, 0x0f0f0f, v95
    v_and_b32 v99, 0x0f0f0f, v99
    s_and_b32 s68, s68, 0xffff
    s_bitcmp1_b32 s3, 0
    s_cselect_b32 s68, s68, 0
    s_cmp_ge_u32 s68, 128
    s_cselect_b32 s69, 1, 0
    s_cbranch_scc0 K2_NOQ
    s_add_u32 m0, s74, 0
    v_mad_u32_u16 v236, v236, s75, v241 op_sel:[1,0,0,0]
    buffer_load_dwordx4 v236, s[16:19], 0 offen lds
    s_add_u32 m0, s74, 1040
    v_mad_u32_u16 v237, v237, s75, v241 op_sel:[1,0,0,0]
    buffer_load_dwordx4 v237, s[16:19], 0 offen lds
    s_add_u32 m0, s74, 2080
    v_mad_u32_u16 v238, v238, s75, v241 op_sel:[1,0,0,0]
    buffer_load_dwordx4 v238, s[16:19], 0 offen lds
    s_add_u32 m0, s74, 3120
    v_mad_u32_u16 v239, v239, s75, v241 op_sel:[1,0,0,0]
    buffer_load_dwordx4 v239, s[16:19], 0 offen lds
    s_add_u32 m0, s74, 4160
    v_add_u32 v240, v240, v242
    buffer_load_dwordx4 v240, s[20:23], 0 offen lds
K2_NOQ:
    v_add_u32_sdwa v191, v128, v129 dst_sel:DWORD dst_unused:UNUSED_PAD src0_sel:WORD_0 src1_sel:WORD_0
    v_add_u32_sdwa v128, v130, v131 dst_sel:DWORD dst_unused:UNUSED_PAD src0_sel:WORD_0 src1_sel:WORD_0
    v_add_u32 v191, v191, v128
    s_waitcnt lgkmcnt(3)
    v_add_u32_sdwa v188, v116, v117 dst_sel:DWORD dst_unused:UNUSED_PAD src0_sel:WORD_0 src1_sel:WORD_0
    v_add_u32_sdwa v116, v118, v119 dst_sel:DWORD dst_unused:UNUSED_PAD src0_sel:WORD_0 src1_sel:WORD_0
    v_add_u32 v188, v188, v116
    s_waitcnt lgkmcnt(2)
    v_add_u32_sdwa v189, v120, v121 dst_sel:DWORD dst_unused:UNUSED_PAD src0_sel:WORD_0 src1_sel:WORD_0
    v_add_u32_sdwa v120, v122, v123 dst_sel:DWORD dst_unused:UNUSED_PAD src0_sel:WORD_0 src1_sel:WORD_0
    v_add_u32 v189, v189, v120
    s_waitcnt lgkmcnt(1)
    v_add_u32_sdwa v190, v124, v125 dst_sel:DWORD dst_unused:UNUSED_PAD src0_sel:WORD_0 src1_sel:WORD_0
    v_add_u32_sdwa v124, v126, v127 dst_sel:DWORD dst_unused:UNUSED_PAD src0_sel:WORD_0 src1_sel:WORD_0
    v_add_u32 v190, v190, v124
    v_lshl_or_b32 v192, v189, 16, v188
    v_lshl_or_b32 v193, v191, 16, v190
    s_waitcnt lgkmcnt(0)
    v_perm_b32 v198, v195, v194, s67
    v_add_u32_dpp v192, v192, v192 row_shr:1 row_mask:0xf bank_mask:0xf bound_ctrl:0
    v_add_u32_dpp v193, v193, v193 row_shr:1 row_mask:0xf bank_mask:0xf bound_ctrl:0
    v_and_b32 v103, 0x0f0f0f, v103
    v_add_u32_dpp v192, v192, v192 row_shr:2 row_mask:0xf bank_mask:0xf bound_ctrl:0
    v_add_u32_dpp v193, v193, v193 row_shr:2 row_mask:0xf bank_mask:0xf bound_ctrl:0
    v_perm_b32 v155, v95, v92, s64
    v_add_u32_dpp v192, v192, v192 row_shr:4 row_mask:0xf bank_mask:0xf bound_ctrl:0
    v_add_u32_dpp v193, v193, v193 row_shr:4 row_mask:0xf bank_mask:0xf bound_ctrl:0
    v_perm_b32 v156, v95, v93, s65
    v_add_u32_dpp v192, v192, v192 row_shr:8 row_mask:0xf bank_mask:0xf bound_ctrl:0
    v_add_u32_dpp v193, v193, v193 row_shr:8 row_mask:0xf bank_mask:0xf bound_ctrl:0
    v_perm_b32 v157, v95, v94, s66
    v_add_u32_dpp v192, v192, v192 row_bcast:15 row_mask:0xa bank_mask:0xf
    v_add_u32_dpp v193, v193, v193 row_bcast:15 row_mask:0xa bank_mask:0xf
    v_perm_b32 v158, v99, v96, s64
    v_add_u32_dpp v192, v192, v192 row_bcast:31 row_mask:0xc bank_mask:0xf
    v_add_u32_dpp v193, v193, v193 row_bcast:31 row_mask:0xc bank_mask:0xf
    v_perm_b32 v159, v99, v97, s65
    s_sub_u32 s4, s4, 1
    v_readlane_b32 s10, v192, 63
    v_readlane_b32 s11, v193, 63
    v_readlane_b32 s14, v193, 59
    v_readlane_b32 s86, v193, s4
    v_lshlrev_b32_sdwa v116, v169, v192 dst_sel:DWORD dst_unused:UNUSED_PAD src0_sel:DWORD src1_sel:WORD_0
    v_sub_u32 v188, v116, v188
    v_lshlrev_b32_sdwa v117, v169, v192 dst_sel:DWORD dst_unused:UNUSED_PAD src0_sel:DWORD src1_sel:WORD_1
    v_sub_u32 v189, v117, v189
    v_lshlrev_b32_sdwa v118, v169, v193 dst_sel:DWORD dst_unused:UNUSED_PAD src0_sel:DWORD src1_sel:WORD_0
    v_sub_u32 v190, v118, v190
    s_and_b32 s4, s10, 0xffff
    s_lshr_b32 s10, s10, 16
    s_add_u32 s5, s4, s10
    s_and_b32 s10, s11, 0xffff
    s_add_u32 s10, s5, s10
    s_lshr_b32 s11, s11, 16
    s_add_u32 s10, s10, s11
    s_lshr_b32 s14, s14, 16
    s_lshr_b32 s86, s86, 16
    s_sub_u32 s6, s86, s14
    s_lshl_b32 s6, s6, 1
    v_lshl_add_u32 v189, s4, 1, v189
    v_lshl_add_u32 v190, s5, 1, v190
    s_sub_i32 s37, 12864, s10
    s_ashr_i32 s37, s37, 7
    s_max_i32 s37, s37, 1
    s_min_i32 s37, s37, 4
    s_lshr_b32 s11, s10, 5
    s_add_u32 s11, s11, 16
    s_and_b32 s11, s11, -32
    s_cmp_ge_i32 s37, 1
    s_cselect_b32 s13, 42, 10
    s_sub_i32 s11, s11, s13
    s_lshl_b32 s11, s11, 3
    s_lshr_b32 s10, s10, 1
    s_lshr_b32 s13, s3, 1
    s_mul_i32 s13, s13, s10
    s_sub_i32 s13, s13, s6
    s_sub_i32 s10, s10, s68
    s_sub_i32 s10, s10, s68
    s_add_i32 s11, s11, s13
    s_add_i32 s10, s10, s13
    s_bitcmp1_b32 s3, 0
    s_cselect_b32 s15, s11, s13
    s_cselect_b32 s10, s10, s11
    s_mov_b32 s13, 0
    s_mov_b32 s14, 0
    v_cmp_gt_i32 vcc, s15, v188
    v_cmp_gt_i32 s[86:87], s10, v188
    s_bcnt1_i32_b64 s11, vcc
    s_add_u32 s13, s13, s11
    s_bcnt1_i32_b64 s11, s[86:87]
    s_add_u32 s14, s14, s11
    v_cmp_gt_i32 vcc, s15, v189
    v_cmp_gt_i32 s[86:87], s10, v189
    s_bcnt1_i32_b64 s11, vcc
    s_add_u32 s13, s13, s11
    s_bcnt1_i32_b64 s11, s[86:87]
    s_add_u32 s14, s14, s11
    v_cmp_gt_i32 vcc, s15, v190
    v_cmp_gt_i32 s[86:87], s10, v190
    s_bcnt1_i32_b64 s11, vcc
    s_add_u32 s13, s13, s11
    s_bcnt1_i32_b64 s11, s[86:87]
    s_add_u32 s14, s14, s11
    s_max_i32 s13, s13, s72
    s_min_i32 s13, s13, s73
    s_max_i32 s14, s14, s84
    s_min_i32 s14, s14, s85
    v_cmp_le_u32 vcc, s13, v199
    v_cmp_gt_u32 s[10:11], s14, v199
    s_nop 0
    s_and_b64 vcc, vcc, s[10:11]
    v_cndmask_b32 v198, 0, v198, vcc
    v_mov_b32 v196, v198
    v_perm_b32 v160, v99, v98, s66
    v_perm_b32 v161, v103, v100, s64
    v_add_u32_dpp v196, v196, v196 row_shr:1 row_mask:0xf bank_mask:0xf bound_ctrl:0
    v_perm_b32 v162, v103, v101, s65
    v_perm_b32 v163, v103, v102, s66
    v_add_u32_dpp v196, v196, v196 row_shr:2 row_mask:0xf bank_mask:0xf bound_ctrl:0
    v_lshl_add_u32 v155, v155, 5, v209
    v_lshl_add_u32 v156, v156, 5, v209
    v_add_u32_dpp v196, v196, v196 row_shr:4 row_mask:0xf bank_mask:0xf bound_ctrl:0
    v_lshl_add_u32 v157, v157, 5, v209
    v_lshl_add_u32 v158, v158, 5, v210
    v_add_u32_dpp v196, v196, v196 row_shr:8 row_mask:0xf bank_mask:0xf bound_ctrl:0
    v_lshl_add_u32 v159, v159, 5, v210
    v_lshl_add_u32 v160, v160, 5, v210
    v_add_u32_dpp v196, v196, v196 row_bcast:15 row_mask:0xa bank_mask:0xf
    v_lshl_add_u32 v161, v161, 5, v211
    v_lshl_add_u32 v162, v162, 5, v211
    v_lshl_add_u32 v163, v163, 5, v211
    s_sub_u32 s86, s76, 9728
    s_add_u32 s86, s86, s68
    v_readlane_b32 s10, v196, 31
    v_readlane_b32 s11, v196, 63
    v_sub_u32 v196, v196, v198
    v_mov_b32 v253, v202
    s_and_b32 s4, s10, 0xffff
    s_lshr_b32 s10, s10, 16
    s_add_u32 s5, s4, s10
    s_and_b32 s10, s11, 0xffff
    s_add_u32 s6, s5, s10
    s_lshr_b32 s11, s11, 16
    s_add_u32 s15, s6, s11
    s_lshl_b32 s10, s4, 16
    s_pack_ll_b32_b16 s11, s5, s6
    s_pack_ll_b32_b16 s86, s86, s86
    s_add_u32 s10, s10, s86
    s_add_u32 s11, s11, s86
    s_mov_b32 exec_lo, vcc_lo
    s_mov_b32 exec_hi, 0
    v_add_u32 v196, s10, v196
    s_mov_b32 exec_lo, 0
    s_mov_b32 exec_hi, vcc_hi
    v_add_u32 v196, s11, v196
    s_mov_b64 exec, vcc
    ds_write_b16 v200, v196 offset:2306
    ds_write_b16_d16_hi v200, v196 offset:2310
    ds_write_b32 v213, v212 offset:6400
    s_mov_b64 exec, -1
    v_mov_b32 v197, 2176
    s_add_u32 s15, s15, s68
    s_add_u32 s68, s68, 64
    s_cmp_le_u32 s15, 2176
    s_cbranch_scc1 K2_LFIT
    ds_write_b32 v197, v197
    s_mov_b32 s15, 0
K2_LFIT:
    s_add_u32 s15, s15, s76
    s_add_i32 s4, s4, s68
    s_lshr_b32 s4, s4, 7
    s_add_i32 s5, s5, s68
    s_lshr_b32 s5, s5, 7
    s_add_i32 s6, s6, s68
    s_lshr_b32 s6, s6, 7
    v_mov_b32 v190, 0xffff0000
    v_or_b32 v189, s39, v190
    v_mov_b32 v190, 0x7fffff00
    v_lshl_add_u32 v188, v254, 2, s15
    s_sub_u32 s73, s15, s76
    ds_write2st64_b32 v188, v189, v190 offset0:0 offset1:84
    ds_write2st64_b32 v188, v189, v190 offset0:1 offset1:85
    s_add_u32 s73, s73, 127
    s_lshr_b32 s73, s73, 7
    s_sub_i32 s38, s73, 1
    v_mov_b32 v188, s15
    ds_write_b32 v212, v188 offset:2112
    s_waitcnt lgkmcnt(0)
    s_barrier
    ds_read_b64 v[194:195], v197
    s_mov_b64 exec, s[40:41]
    ds_read_u16 v104, v104 offset:2306
    s_mov_b64 exec, s[42:43]
    ds_read_u16 v105, v105 offset:2306
    s_mov_b64 exec, s[44:45]
    ds_read_u16 v106, v106 offset:2306
    s_mov_b64 exec, s[46:47]
    ds_read_u16 v107, v107 offset:2306
    s_mov_b64 exec, s[48:49]
    ds_read_u16 v108, v108 offset:2306
    s_mov_b64 exec, s[50:51]
    ds_read_u16 v109, v109 offset:2306
    s_mov_b64 exec, s[52:53]
    ds_read_u16 v110, v110 offset:2306
    s_mov_b64 exec, s[54:55]
    ds_read_u16 v111, v111 offset:2306
    s_mov_b64 exec, s[56:57]
    ds_read_u16 v112, v112 offset:2306
    s_mov_b64 exec, s[58:59]
    ds_read_u16 v113, v113 offset:2306
    s_mov_b64 exec, s[60:61]
    ds_read_u16 v114, v114 offset:2306
    s_mov_b64 exec, s[62:63]
    ds_read_u16 v115, v115 offset:2306
    s_mov_b64 exec, -1
    s_waitcnt lgkmcnt(0)
    v_readfirstlane_b32 s83, v194
    v_readfirstlane_b32 s80, v195
    v_add_u32 v104, v104, v220
    v_add_u32 v105, v105, v221
    v_add_u32 v106, v106, v222
    v_add_u32 v107, v107, v223
    v_add_u32 v108, v108, v224
    v_add_u32 v109, v109, v225
    v_add_u32 v110, v110, v226
    v_add_u32 v111, v111, v227
    v_add_u32 v112, v112, v228
    v_add_u32 v113, v113, v229
    v_add_u32 v114, v114, v230
    v_add_u32 v115, v115, v231
    s_cmp_gt_u32 s83, 64
    s_cbranch_scc1 K2_OVF
    s_mov_b64 exec, s[40:41]
    ds_write2st64_b32 v104, v88, v152 offset0:38 offset1:122
    s_mov_b64 exec, s[42:43]
    ds_write2st64_b32 v105, v89, v153 offset0:38 offset1:122
    s_mov_b64 exec, s[44:45]
    ds_write2st64_b32 v106, v90, v154 offset0:38 offset1:122
    s_mov_b64 exec, s[46:47]
    ds_write2st64_b32 v107, v92, v155 offset0:38 offset1:122
    s_mov_b64 exec, s[48:49]
    ds_write2st64_b32 v108, v93, v156 offset0:38 offset1:122
    s_mov_b64 exec, s[50:51]
    ds_write2st64_b32 v109, v94, v157 offset0:38 offset1:122
    s_mov_b64 exec, s[52:53]
    ds_write2st64_b32 v110, v96, v158 offset0:38 offset1:122
    s_mov_b64 exec, s[54:55]
    ds_write2st64_b32 v111, v97, v159 offset0:38 offset1:122
    s_mov_b64 exec, s[56:57]
    ds_write2st64_b32 v112, v98, v160 offset0:38 offset1:122
    s_mov_b64 exec, s[58:59]
    ds_write2st64_b32 v113, v100, v161 offset0:38 offset1:122
    s_mov_b64 exec, s[60:61]
    ds_write2st64_b32 v114, v101, v162 offset0:38 offset1:122
    s_mov_b64 exec, s[62:63]
    ds_write2st64_b32 v115, v102, v163 offset0:38 offset1:122
    s_mov_b64 exec, -1
K2_PADS0:
    s_add_u32 s10, s37, 2
    s_cmp_gt_u32 s73, s10
    s_cselect_b32 s1, s3, 0
    s_sub_u32 s10, s13, s96
    s_mul_i32 s10, s10, 144
    s_add_u32 s70, s10, s74
    s_mul_i32 s10, s12, 196
    s_add_u32 s11, s10, s14
    s_add_u32 s10, s10, s13
    s_min_u32 s11, s11, 50000
    s_min_u32 s10, s10, 50000
    s_sub_u32 s11, s11, s10
    s_lshl_b32 s10, s10, 7
    s_add_u32 s28, s28, s10
    s_addc_u32 s29, s29, 0
    s_lshl_b32 s30, s11, 7
    s_mov_b32 s79, -1
    s_mov_b64 s[84:85], 0
    s_mov_b32 s81, 0
    s_mov_b32 s82, 0
    s_cmp_lg_u32 s80, 0
    s_cselect_b32 s78, 1, 0
    s_and_b32 s69, s69, s1
    s_cmp_gt_u32 s69, s97
    s_cbranch_scc0 K2_SIDE
    s_waitcnt vmcnt(5) lgkmcnt(0)
    ds_read_b128 v[152:155], v235 offset:0
    ds_read_b128 v[156:159], v235 offset:16
    ds_read_b128 v[160:163], v235 offset:32
    ds_read_b128 v[164:167], v235 offset:48
    v_add_u32 v172, 8192, v172
    ds_read_b128 v[88:91], v172 offset:52736
    ds_read_b128 v[92:95], v172 offset:53760
    ds_read_b128 v[96:99], v172 offset:54784
    ds_read_b128 v[100:103], v172 offset:55808
    ds_read_b128 v[104:107], v172 offset:56832
    ds_read_b128 v[108:111], v172 offset:57856
    ds_read_b128 v[112:115], v172 offset:58880
    ds_read_b128 v[116:119], v172 offset:59904
    s_mov_b32 s10, 0x358637bd
    s_mov_b32 s11, s10
    v_mfma_f32_32x32x16_bf16 v[136:151], v[180:183], v[180:183], 0
    v_mov_b64 v[120:121], s[10:11]
    v_mov_b64 v[122:123], s[10:11]
    v_mov_b64 v[124:125], s[10:11]
    v_mov_b64 v[126:127], s[10:11]
    v_mov_b64 v[128:129], s[10:11]
    v_mov_b64 v[130:131], s[10:11]
    v_mov_b64 v[132:133], s[10:11]
    v_mov_b64 v[134:135], s[10:11]
    s_waitcnt lgkmcnt(7)
    v_mfma_f32_32x32x16_bf16 v[188:203], v[152:155], v[88:91], 0
    s_waitcnt lgkmcnt(6)
    v_mfma_f32_32x32x16_bf16 v[188:203], v[156:159], v[92:95], v[188:203]
    s_waitcnt lgkmcnt(5)
    v_mfma_f32_32x32x16_bf16 v[188:203], v[160:163], v[96:99], v[188:203]
    s_waitcnt lgkmcnt(4)
    v_mfma_f32_32x32x16_bf16 v[188:203], v[164:167], v[100:103], v[188:203]
    s_waitcnt lgkmcnt(3)
    v_mfma_f32_32x32x16_bf16 v[204:219], v[152:155], v[104:107], 0
    s_waitcnt lgkmcnt(2)
    v_mfma_f32_32x32x16_bf16 v[204:219], v[156:159], v[108:111], v[204:219]
    s_waitcnt lgkmcnt(1)
    v_mfma_f32_32x32x16_bf16 v[204:219], v[160:163], v[112:115], v[204:219]
    s_waitcnt lgkmcnt(0)
    v_mfma_f32_32x32x16_bf16 v[204:219], v[164:167], v[116:119], v[204:219]
    s_barrier
    v_mfma_f32_32x32x16_bf16 v[104:119], v[180:183], v[180:183], 0
    s_mov_b32 s10, 0x358637bd
    s_mov_b32 s11, s10
    v_mov_b64 v[88:89], s[10:11]
    v_mov_b64 v[90:91], s[10:11]
    v_mov_b64 v[92:93], s[10:11]
    v_mov_b64 v[94:95], s[10:11]
    v_mov_b64 v[96:97], s[10:11]
    v_mov_b64 v[98:99], s[10:11]
    v_mov_b64 v[100:101], s[10:11]
    v_mov_b64 v[102:103], s[10:11]
    v_cvt_pk_bf16_f32 v72, v188, v189
    v_cvt_pk_bf16_f32 v73, v190, v191
    v_cvt_pk_bf16_f32 v74, v192, v193
    v_cvt_pk_bf16_f32 v75, v194, v195
    v_cvt_pk_bf16_f32 v76, v196, v197
    v_cvt_pk_bf16_f32 v77, v198, v199
    v_cvt_pk_bf16_f32 v78, v200, v201
    v_cvt_pk_bf16_f32 v79, v202, v203
    v_cvt_pk_bf16_f32 v80, v204, v205
    v_cvt_pk_bf16_f32 v81, v206, v207
    v_cvt_pk_bf16_f32 v82, v208, v209
    v_cvt_pk_bf16_f32 v83, v210, v211
    v_cvt_pk_bf16_f32 v84, v212, v213
    v_cvt_pk_bf16_f32 v85, v214, v215
    v_cvt_pk_bf16_f32 v86, v216, v217
    v_cvt_pk_bf16_f32 v87, v218, v219
    s_branch K2_HAD0
K2_SIDE:
    s_bitcmp1_b32 s3, 0
    s_cbranch_scc1 K2_NOX2
    s_mul_i32 s10, s12, 196
    s_add_u32 s10, s10, s96
    s_lshl_b32 s10, s10, 7
    s_mul_i32 s11, s7, 4160
    s_add_u32 m0, s11, 69120
    s_add_u32 s86, s10, 0
    buffer_load_dwordx4 v234, s[16:19], s86 offen lds
    s_add_u32 m0, s11, 70160
    s_add_u32 s86, s10, 1024
    buffer_load_dwordx4 v234, s[16:19], s86 offen lds
    s_add_u32 m0, s11, 71200
    s_add_u32 s86, s10, 2048
    buffer_load_dwordx4 v234, s[16:19], s86 offen lds
    s_add_u32 m0, s11, 72240
    s_add_u32 s86, s10, 3072
    buffer_load_dwordx4 v234, s[16:19], s86 offen lds
K2_NOX2:
    s_waitcnt vmcnt(5) lgkmcnt(0)
    s_barrier
    s_cmp_lg_u32 s69, 0
    s_cbranch_scc1 K2_SIDE1
    s_waitcnt vmcnt(4)
    s_bitcmp1_b32 s3, 0
    s_cbranch_scc0 K2_SIDE1
    s_waitcnt vmcnt(0)
    s_bitcmp1_b32 s1, 0
    s_cbranch_scc0 K2_SIDE1
    ds_read_b128 v[236:239], v247
    ds_read_b32 v240, v251
    ds_read_u8 v250, v249
    s_waitcnt lgkmcnt(1)
    s_add_u32 m0, s74, 0
    v_mad_u32_u16 v236, v236, s75, v241 op_sel:[1,0,0,0]
    buffer_load_dwordx4 v236, s[16:19], 0 offen lds
    s_add_u32 m0, s74, 1040
    v_mad_u32_u16 v237, v237, s75, v241 op_sel:[1,0,0,0]
    buffer_load_dwordx4 v237, s[16:19], 0 offen lds
    s_add_u32 m0, s74, 2080
    v_mad_u32_u16 v238, v238, s75, v241 op_sel:[1,0,0,0]
    buffer_load_dwordx4 v238, s[16:19], 0 offen lds
    s_add_u32 m0, s74, 3120
    v_mad_u32_u16 v239, v239, s75, v241 op_sel:[1,0,0,0]
    buffer_load_dwordx4 v239, s[16:19], 0 offen lds
    s_add_u32 m0, s74, 4160
    v_add_u32 v240, v240, v242
    buffer_load_dwordx4 v240, s[20:23], 0 offen lds
K2_SIDE1:
    s_cmp_lg_u32 s97, 0
    s_cbranch_scc1 K2_XT2
K2_XT2R:
    s_bitcmp1_b32 s1, 0
    s_cbranch_scc1 K2_SIDE2
    s_barrier
    s_cmp_eq_u32 s83, 0
    s_cbranch_scc1 K2_NEy
    s_lshl_b32 s10, s3, 2
    v_mov_b32 v178, s10
    ds_read_b32 v178, v178 offset:2112
    s_waitcnt lgkmcnt(0)
    v_readfirstlane_b32 s15, v178
    s_nop 3
    s_sub_u32 s73, s15, s76
    s_add_u32 s73, s73, 127
    s_lshr_b32 s73, s73, 7
    s_sub_i32 s38, s73, 1
K2_NEy:
    ds_read_b128 v[236:239], v247
    ds_read_b32 v240, v251
    ds_read_u8 v250, v249
    s_waitcnt lgkmcnt(1)
    s_add_u32 m0, s74, 0
    v_mad_u32_u16 v236, v236, s75, v241 op_sel:[1,0,0,0]
    buffer_load_dwordx4 v236, s[16:19], 0 offen lds
    s_add_u32 m0, s74, 1040
    v_mad_u32_u16 v237, v237, s75, v241 op_sel:[1,0,0,0]
    buffer_load_dwordx4 v237, s[16:19], 0 offen lds
    s_add_u32 m0, s74, 2080
    v_mad_u32_u16 v238, v238, s75, v241 op_sel:[1,0,0,0]
    buffer_load_dwordx4 v238, s[16:19], 0 offen lds
    s_add_u32 m0, s74, 3120
    v_mad_u32_u16 v239, v239, s75, v241 op_sel:[1,0,0,0]
    buffer_load_dwordx4 v239, s[16:19], 0 offen lds
    s_add_u32 m0, s74, 4160
    v_add_u32 v240, v240, v242
    buffer_load_dwordx4 v240, s[20:23], 0 offen lds
K2_SIDE2:
    s_waitcnt vmcnt(5) lgkmcnt(0)
    ds_read_b128 v[152:155], v235 offset:0
    ds_read_b128 v[156:159], v235 offset:16
    ds_read_b128 v[160:163], v235 offset:32
    ds_read_b128 v[164:167], v235 offset:48
    v_add_u32 v172, 8192, v172
    ds_read_b128 v[88:91], v172 offset:52736
    ds_read_b128 v[92:95], v172 offset:53760
    ds_read_b128 v[96:99], v172 offset:54784
    ds_read_b128 v[100:103], v172 offset:55808
    ds_read_b128 v[104:107], v172 offset:56832
    ds_read_b128 v[108:111], v172 offset:57856
    ds_read_b128 v[112:115], v172 offset:58880
    ds_read_b128 v[116:119], v172 offset:59904
    s_mov_b32 s10, 0x358637bd
    s_mov_b32 s11, s10
    v_mfma_f32_32x32x16_bf16 v[136:151], v[180:183], v[180:183], 0
    v_mov_b64 v[120:121], s[10:11]
    v_mov_b64 v[122:123], s[10:11]
    v_mov_b64 v[124:125], s[10:11]
    v_mov_b64 v[126:127], s[10:11]
    v_mov_b64 v[128:129], s[10:11]
    v_mov_b64 v[130:131], s[10:11]
    v_mov_b64 v[132:133], s[10:11]
    v_mov_b64 v[134:135], s[10:11]
    s_waitcnt lgkmcnt(7)
    v_mfma_f32_32x32x16_bf16 v[188:203], v[152:155], v[88:91], 0
    s_waitcnt lgkmcnt(6)
    v_mfma_f32_32x32x16_bf16 v[188:203], v[156:159], v[92:95], v[188:203]
    s_waitcnt lgkmcnt(5)
    v_mfma_f32_32x32x16_bf16 v[188:203], v[160:163], v[96:99], v[188:203]
    s_waitcnt lgkmcnt(4)
    v_mfma_f32_32x32x16_bf16 v[188:203], v[164:167], v[100:103], v[188:203]
    s_waitcnt lgkmcnt(3)
    v_mfma_f32_32x32x16_bf16 v[204:219], v[152:155], v[104:107], 0
    s_waitcnt lgkmcnt(2)
    v_mfma_f32_32x32x16_bf16 v[204:219], v[156:159], v[108:111], v[204:219]
    s_waitcnt lgkmcnt(1)
    v_mfma_f32_32x32x16_bf16 v[204:219], v[160:163], v[112:115], v[204:219]
    s_waitcnt lgkmcnt(0)
    v_mfma_f32_32x32x16_bf16 v[204:219], v[164:167], v[116:119], v[204:219]
    v_mfma_f32_32x32x16_bf16 v[104:119], v[180:183], v[180:183], 0
    s_mov_b32 s10, 0x358637bd
    s_mov_b32 s11, s10
    v_mov_b64 v[88:89], s[10:11]
    v_mov_b64 v[90:91], s[10:11]
    v_mov_b64 v[92:93], s[10:11]
    v_mov_b64 v[94:95], s[10:11]
    v_mov_b64 v[96:97], s[10:11]
    v_mov_b64 v[98:99], s[10:11]
    v_mov_b64 v[100:101], s[10:11]
    v_mov_b64 v[102:103], s[10:11]
    v_cvt_pk_bf16_f32 v72, v188, v189
    v_cvt_pk_bf16_f32 v73, v190, v191
    v_cvt_pk_bf16_f32 v74, v192, v193
    v_cvt_pk_bf16_f32 v75, v194, v195
    v_cvt_pk_bf16_f32 v76, v196, v197
    v_cvt_pk_bf16_f32 v77, v198, v199
    v_cvt_pk_bf16_f32 v78, v200, v201
    v_cvt_pk_bf16_f32 v79, v202, v203
    v_cvt_pk_bf16_f32 v80, v204, v205
    v_cvt_pk_bf16_f32 v81, v206, v207
    v_cvt_pk_bf16_f32 v82, v208, v209
    v_cvt_pk_bf16_f32 v83, v210, v211
    v_cvt_pk_bf16_f32 v84, v212, v213
    v_cvt_pk_bf16_f32 v85, v214, v215
    v_cvt_pk_bf16_f32 v86, v216, v217
    v_cvt_pk_bf16_f32 v87, v218, v219
    s_branch K2_HAD0
K2_GO:
    ds_read_b128 v[236:239], v247
    ds_read_b32 v240, v251
    ds_read_u8 v250, v249
    s_waitcnt lgkmcnt(1)
    s_add_u32 m0, s74, 0
    v_mad_u32_u16 v236, v236, s75, v241 op_sel:[1,0,0,0]
    buffer_load_dwordx4 v236, s[16:19], 0 offen lds
    s_add_u32 m0, s74, 1040
    v_mad_u32_u16 v237, v237, s75, v241 op_sel:[1,0,0,0]
    buffer_load_dwordx4 v237, s[16:19], 0 offen lds
    s_add_u32 m0, s74, 2080
    v_mad_u32_u16 v238, v238, s75, v241 op_sel:[1,0,0,0]
    buffer_load_dwordx4 v238, s[16:19], 0 offen lds
    s_add_u32 m0, s74, 3120
    v_mad_u32_u16 v239, v239, s75, v241 op_sel:[1,0,0,0]
    buffer_load_dwordx4 v239, s[16:19], 0 offen lds
    s_add_u32 m0, s74, 4160
    v_add_u32 v240, v240, v242
    buffer_load_dwordx4 v240, s[20:23], 0 offen lds
K2_HAD0:
    s_waitcnt lgkmcnt(0)
    v_lshl_add_u32 v250, v250, 6, v245
    ds_read_b128 v[236:239], v247 offset:128
    ds_read_b32 v240, v251 offset:128
    ds_read_b128 v[172:175], v250 offset:7424
    ds_read_b32 v176, v250 offset:7440
    v_mfma_f32_32x32x16_bf16 v[204:219], v[180:183], v[180:183], 0
    s_waitcnt vmcnt(0)
    ds_read_b128 v[168:171], v244
    ds_read_b128 v[152:155], v243 offset:0
    ds_read_b128 v[156:159], v243 offset:16
    ds_read_b128 v[160:163], v243 offset:32
    ds_read_b128 v[164:167], v243 offset:48
    s_waitcnt lgkmcnt(0)
    s_add_u32 m0, s74, 0
    v_mad_u32_u16 v236, v236, s75, v241 op_sel:[1,0,0,0]
    buffer_load_dwordx4 v236, s[16:19], 0 offen lds
    s_add_u32 m0, s74, 1040
    v_mad_u32_u16 v237, v237, s75, v241 op_sel:[1,0,0,0]
    buffer_load_dwordx4 v237, s[16:19], 0 offen lds
    s_add_u32 m0, s74, 2080
    v_mad_u32_u16 v238, v238, s75, v241 op_sel:[1,0,0,0]
    buffer_load_dwordx4 v238, s[16:19], 0 offen lds
    s_add_u32 m0, s74, 3120
    v_mad_u32_u16 v239, v239, s75, v241 op_sel:[1,0,0,0]
    buffer_load_dwordx4 v239, s[16:19], 0 offen lds
    s_add_u32 m0, s74, 4160
    v_add_u32 v240, v240, v242
    buffer_load_dwordx4 v240, s[20:23], 0 offen lds
    s_cmp_lt_i32 s37, 0
    s_cbranch_scc1 K2_B1
    s_barrier
    s_bitcmp1_b32 s1, 0
    s_cselect_b32 s37, s37, -1
    s_cbranch_scc0 K2_B1
    s_cmp_eq_u32 s83, 0
    s_cbranch_scc1 K2_NEo
    s_lshl_b32 s10, s3, 2
    v_mov_b32 v178, s10
    ds_read_b32 v178, v178 offset:2112
    s_waitcnt lgkmcnt(0)
    v_readfirstlane_b32 s15, v178
    s_nop 3
    s_sub_u32 s73, s15, s76
    s_add_u32 s73, s73, 127
    s_lshr_b32 s73, s73, 7
    s_sub_i32 s38, s73, 1
K2_NEo:
K2_B1:
    s_cmp_lg_u32 s73, 0
    s_cbranch_scc1 K2_NZ
    s_waitcnt vmcnt(0)
    s_branch K2_DONE
K2_NZ:
    v_mfma_f32_32x32x16_bf16 v[188:203], v[168:171], v[64:67], 0
    v_mfma_f32_32x32x16_bf16 v[188:203], v[152:155], v[0:3], v[188:203]
    v_mfma_f32_32x32x16_bf16 v[188:203], v[156:159], v[4:7], v[188:203]
    v_mfma_f32_32x32x16_bf16 v[188:203], v[160:163], v[8:11], v[188:203]
    v_mfma_f32_32x32x16_bf16 v[188:203], v[164:167], v[12:15], v[188:203]
    s_nop 9
    v_smfmac_f32_32x32x32_bf16 v[188:203], v[172:175], v[72:79], v176
    s_mov_b32 s72, 0
    s_sub_u32 s10, s73, 1
    s_bitcmp1_b32 s3, 0
    s_cselect_b32 s6, s6, s10
    s_setprio 3
    s_mov_b32 s87, s73
    s_cmp_gt_i32 s4, s72
    s_cselect_b32 s10, s4, s87
    s_min_u32 s87, s87, s10
    s_cmp_gt_i32 s5, s72
    s_cselect_b32 s10, s5, s87
    s_min_u32 s87, s87, s10
    s_cmp_gt_i32 s6, s72
    s_cselect_b32 s10, s6, s87
    s_min_u32 s87, s87, s10
    s_cmp_gt_i32 s37, s72
    s_cselect_b32 s10, s37, s87
    s_min_u32 s87, s87, s10
    s_cmp_gt_i32 s38, s72
    s_cselect_b32 s10, s38, s87
    s_min_u32 s87, s87, s10
.p2align 6
K2_LOOP:
    v_smfmac_f32_32x32x32_bf16 v[136:151], v[180:183], v[204:211], v177
    ds_read_u8 v236, v248 offset:0
    ds_read_u8 v237, v248 offset:16
    ds_read_u8 v238, v248 offset:64
    ds_read_u8 v239, v248 offset:80
    ds_read_u8 v250, v249 offset:128
    v_exp_f32 v188, v188
    v_exp_f32 v189, v189
    v_exp_f32 v190, v190
    v_add_f32 v188, 1.0, v188
    v_smfmac_f32_32x32x32_bf16 v[136:151], v[184:187], v[212:219], v177
    v_exp_f32 v191, v191
    v_add_f32 v189, 1.0, v189
    v_exp_f32 v192, v192
    v_add_f32 v190, 1.0, v190
    v_rcp_f32 v188, v188
    v_mfma_f32_32x32x16_bf16 v[220:235], v[168:171], v[68:71], 0
    v_exp_f32 v193, v193
    v_add_f32 v191, 1.0, v191
    v_rcp_f32 v189, v189
    v_exp_f32 v194, v194
    v_mfma_f32_32x32x16_bf16 v[204:219], v[152:155], v[32:35], 0
    v_add_f32 v192, 1.0, v192
    v_rcp_f32 v190, v190
    v_exp_f32 v195, v195
    v_mfma_f32_32x32x16_bf16 v[204:219], v[156:159], v[36:39], v[204:219]
    s_waitcnt lgkmcnt(0)
    v_lshl_add_u32 v236, v236, 6, v246
    v_lshl_add_u32 v237, v237, 6, v246
    v_lshl_add_u32 v238, v238, 6, v246
    v_lshl_add_u32 v239, v239, 6, v246
    v_lshl_add_u32 v250, v250, 6, v245
    v_add_f32 v193, 1.0, v193
    v_rcp_f32 v191, v191
    v_exp_f32 v196, v196
    v_add_f32 v194, 1.0, v194
    v_rcp_f32 v192, v192
    v_smfmac_f32_32x32x32_bf16 v[220:235], v[172:175], v[80:87], v176
    ds_read_b64_tr_b16 v[180:181], v236
    ds_read_b64_tr_b16 v[182:183], v237
    ds_read_b64_tr_b16 v[184:185], v238
    ds_read_b64_tr_b16 v[186:187], v239
    ds_read_b128 v[172:175], v250 offset:7424
    ds_read_b32 v176, v250 offset:7440
    v_exp_f32 v197, v197
    v_add_f32 v195, 1.0, v195
    v_rcp_f32 v193, v193
    v_exp_f32 v198, v198
    v_mfma_f32_32x32x16_bf16 v[204:219], v[160:163], v[40:43], v[204:219]
    v_add_f32 v196, 1.0, v196
    v_rcp_f32 v194, v194
    v_exp_f32 v199, v199
    v_add_f32 v197, 1.0, v197
    v_mfma_f32_32x32x16_bf16 v[204:219], v[164:167], v[44:47], v[204:219]
    v_rcp_f32 v195, v195
    v_exp_f32 v200, v200
    v_add_f32 v198, 1.0, v198
    v_rcp_f32 v196, v196
    v_mfma_f32_32x32x16_bf16 v[220:235], v[152:155], v[16:19], v[220:235]
    ds_read_b128 v[236:239], v247 offset:256
    ds_read_b32 v240, v251 offset:256
    s_add_u32 s72, s72, 1
    v_exp_f32 v201, v201
    v_add_f32 v199, 1.0, v199
    v_rcp_f32 v197, v197
    v_exp_f32 v202, v202
    v_mfma_f32_32x32x16_bf16 v[220:235], v[156:159], v[20:23], v[220:235]
    v_add_f32 v200, 1.0, v200
    v_rcp_f32 v198, v198
    v_exp_f32 v203, v203
    v_add_f32 v201, 1.0, v201
    v_mfma_f32_32x32x16_bf16 v[220:235], v[160:163], v[24:27], v[220:235]
    v_rcp_f32 v199, v199
    v_add_f32 v202, 1.0, v202
    v_rcp_f32 v200, v200
    v_add_f32 v203, 1.0, v203
    v_rcp_f32 v201, v201
    v_mfma_f32_32x32x16_bf16 v[220:235], v[164:167], v[28:31], v[220:235]
    v_rcp_f32 v202, v202
    v_rcp_f32 v203, v203
    v_mul_f32 v204, v188, v204
    v_mul_f32 v205, v189, v205
    s_waitcnt lgkmcnt(0)
    v_smfmac_f32_32x32x32_bf16 v[88:103], v[180:183], v[188:195], v177
    v_mul_f32 v206, v190, v206
    v_mul_f32 v207, v191, v207
    v_mul_f32 v208, v192, v208
    v_mul_f32 v209, v193, v209
    v_mul_f32 v210, v194, v210
    v_mul_f32 v211, v195, v211
    v_mul_f32 v212, v196, v212
    v_smfmac_f32_32x32x32_bf16 v[88:103], v[184:187], v[196:203], v177
    v_mul_f32 v213, v197, v213
    v_mul_f32 v214, v198, v214
    v_mul_f32 v215, v199, v215
    v_mul_f32 v216, v200, v216
    v_mul_f32 v217, v201, v217
    v_mul_f32 v218, v202, v218
    v_mul_f32 v219, v203, v219
    v_smfmac_f32_32x32x32_bf16 v[104:119], v[180:183], v[204:211], v177
    s_waitcnt vmcnt(0)
    ds_read_b128 v[168:171], v244
    v_exp_f32 v220, v220
    v_exp_f32 v221, v221
    v_exp_f32 v222, v222
    v_add_f32 v220, 1.0, v220
    v_smfmac_f32_32x32x32_bf16 v[104:119], v[184:187], v[212:219], v177
    v_exp_f32 v223, v223
    v_add_f32 v221, 1.0, v221
    v_exp_f32 v224, v224
    v_add_f32 v222, 1.0, v222
    v_rcp_f32 v220, v220
    s_waitcnt lgkmcnt(0)
    v_mfma_f32_32x32x16_bf16 v[188:203], v[168:171], v[64:67], 0
    v_exp_f32 v225, v225
    v_add_f32 v223, 1.0, v223
    v_rcp_f32 v221, v221
    v_exp_f32 v226, v226
    v_mfma_f32_32x32x16_bf16 v[204:219], v[152:155], v[48:51], 0
    ds_read_b128 v[152:155], v243 offset:0
    v_add_f32 v224, 1.0, v224
    v_rcp_f32 v222, v222
    v_exp_f32 v227, v227
    v_mfma_f32_32x32x16_bf16 v[204:219], v[156:159], v[52:55], v[204:219]
    ds_read_b128 v[156:159], v243 offset:16
    v_add_f32 v225, 1.0, v225
    v_rcp_f32 v223, v223
    v_exp_f32 v228, v228
    v_add_f32 v226, 1.0, v226
    v_rcp_f32 v224, v224
    v_smfmac_f32_32x32x32_bf16 v[188:203], v[172:175], v[72:79], v176
    v_exp_f32 v229, v229
    v_add_f32 v227, 1.0, v227
    v_rcp_f32 v225, v225
    v_exp_f32 v230, v230
    v_mfma_f32_32x32x16_bf16 v[204:219], v[160:163], v[56:59], v[204:219]
    ds_read_b128 v[160:163], v243 offset:32
    v_add_f32 v228, 1.0, v228
    v_rcp_f32 v226, v226
    v_exp_f32 v231, v231
    v_add_f32 v229, 1.0, v229
    v_mfma_f32_32x32x16_bf16 v[204:219], v[164:167], v[60:63], v[204:219]
    ds_read_b128 v[164:167], v243 offset:48
    v_rcp_f32 v227, v227
    v_exp_f32 v232, v232
    v_add_f32 v230, 1.0, v230
    v_rcp_f32 v228, v228
    s_waitcnt lgkmcnt(3)
    v_mfma_f32_32x32x16_bf16 v[188:203], v[152:155], v[0:3], v[188:203]
    v_exp_f32 v233, v233
    v_add_f32 v231, 1.0, v231
    v_rcp_f32 v229, v229
    v_exp_f32 v234, v234
    s_waitcnt lgkmcnt(2)
    v_mfma_f32_32x32x16_bf16 v[188:203], v[156:159], v[4:7], v[188:203]
    v_add_f32 v232, 1.0, v232
    v_rcp_f32 v230, v230
    v_exp_f32 v235, v235
    v_add_f32 v233, 1.0, v233
    s_waitcnt lgkmcnt(1)
    v_mfma_f32_32x32x16_bf16 v[188:203], v[160:163], v[8:11], v[188:203]
    v_rcp_f32 v231, v231
    v_add_f32 v234, 1.0, v234
    v_rcp_f32 v232, v232
    v_add_f32 v235, 1.0, v235
    v_rcp_f32 v233, v233
    s_waitcnt lgkmcnt(0)
    v_mfma_f32_32x32x16_bf16 v[188:203], v[164:167], v[12:15], v[188:203]
    s_cmp_lt_i32 s72, s38
    s_cbranch_scc0 K2_ND_0
    s_add_u32 m0, s74, 0
    v_mad_u32_u16 v236, v236, s75, v241 op_sel:[1,0,0,0]
    buffer_load_dwordx4 v236, s[16:19], 0 offen lds
    s_add_u32 m0, s74, 1040
    v_mad_u32_u16 v237, v237, s75, v241 op_sel:[1,0,0,0]
    buffer_load_dwordx4 v237, s[16:19], 0 offen lds
    s_add_u32 m0, s74, 2080
    v_mad_u32_u16 v238, v238, s75, v241 op_sel:[1,0,0,0]
    buffer_load_dwordx4 v238, s[16:19], 0 offen lds
    s_add_u32 m0, s74, 3120
    v_mad_u32_u16 v239, v239, s75, v241 op_sel:[1,0,0,0]
    buffer_load_dwordx4 v239, s[16:19], 0 offen lds
    s_add_u32 m0, s74, 4160
    v_add_u32 v240, v240, v242
    buffer_load_dwordx4 v240, s[20:23], 0 offen lds
K2_ND_0:
    v_rcp_f32 v234, v234
    v_rcp_f32 v235, v235
    v_mul_f32 v204, v220, v204
    v_mul_f32 v205, v221, v205
    v_smfmac_f32_32x32x32_bf16 v[120:135], v[180:183], v[220:227], v177
    v_mul_f32 v206, v222, v206
    v_mul_f32 v207, v223, v207
    v_mul_f32 v208, v224, v208
    v_mul_f32 v209, v225, v209
    v_mul_f32 v210, v226, v210
    v_mul_f32 v211, v227, v211
    v_mul_f32 v212, v228, v212
    v_smfmac_f32_32x32x32_bf16 v[120:135], v[184:187], v[228:235], v177
    v_mul_f32 v213, v229, v213
    v_mul_f32 v214, v230, v214
    v_mul_f32 v215, v231, v215
    v_mul_f32 v216, v232, v216
    v_mul_f32 v217, v233, v217
    v_mul_f32 v218, v234, v218
    v_mul_f32 v219, v235, v219
    s_cmp_ge_u32 s72, s87
    s_cbranch_scc1 K2_EV0
K2_EVR0:
    v_smfmac_f32_32x32x32_bf16 v[136:151], v[180:183], v[204:211], v177
    ds_read_u8 v236, v248 offset:128
    ds_read_u8 v237, v248 offset:144
    ds_read_u8 v238, v248 offset:192
    ds_read_u8 v239, v248 offset:208
    ds_read_u8 v250, v249 offset:256
    v_exp_f32 v188, v188
    v_exp_f32 v189, v189
    v_exp_f32 v190, v190
    v_add_f32 v188, 1.0, v188
    v_smfmac_f32_32x32x32_bf16 v[136:151], v[184:187], v[212:219], v177
    v_exp_f32 v191, v191
    v_add_f32 v189, 1.0, v189
    v_exp_f32 v192, v192
    v_add_f32 v190, 1.0, v190
    v_rcp_f32 v188, v188
    v_mfma_f32_32x32x16_bf16 v[220:235], v[168:171], v[68:71], 0
    v_exp_f32 v193, v193
    v_add_f32 v191, 1.0, v191
    v_rcp_f32 v189, v189
    v_exp_f32 v194, v194
    v_mfma_f32_32x32x16_bf16 v[204:219], v[152:155], v[32:35], 0
    v_add_f32 v192, 1.0, v192
    v_rcp_f32 v190, v190
    v_exp_f32 v195, v195
    v_mfma_f32_32x32x16_bf16 v[204:219], v[156:159], v[36:39], v[204:219]
    s_waitcnt lgkmcnt(0)
    v_lshl_add_u32 v236, v236, 6, v246
    v_lshl_add_u32 v237, v237, 6, v246
    v_lshl_add_u32 v238, v238, 6, v246
    v_lshl_add_u32 v239, v239, 6, v246
    v_lshl_add_u32 v250, v250, 6, v245
    v_add_f32 v193, 1.0, v193
    v_rcp_f32 v191, v191
    v_exp_f32 v196, v196
    v_add_f32 v194, 1.0, v194
    v_rcp_f32 v192, v192
    v_smfmac_f32_32x32x32_bf16 v[220:235], v[172:175], v[80:87], v176
    ds_read_b64_tr_b16 v[180:181], v236
    ds_read_b64_tr_b16 v[182:183], v237
    ds_read_b64_tr_b16 v[184:185], v238
    ds_read_b64_tr_b16 v[186:187], v239
    ds_read_b128 v[172:175], v250 offset:7424
    ds_read_b32 v176, v250 offset:7440
    v_exp_f32 v197, v197
    v_add_f32 v195, 1.0, v195
    v_rcp_f32 v193, v193
    v_exp_f32 v198, v198
    v_mfma_f32_32x32x16_bf16 v[204:219], v[160:163], v[40:43], v[204:219]
    v_add_f32 v196, 1.0, v196
    v_rcp_f32 v194, v194
    v_exp_f32 v199, v199
    v_add_f32 v197, 1.0, v197
    v_mfma_f32_32x32x16_bf16 v[204:219], v[164:167], v[44:47], v[204:219]
    v_rcp_f32 v195, v195
    v_exp_f32 v200, v200
    v_add_f32 v198, 1.0, v198
    v_rcp_f32 v196, v196
    v_mfma_f32_32x32x16_bf16 v[220:235], v[152:155], v[16:19], v[220:235]
    ds_read_b128 v[236:239], v247 offset:384
    ds_read_b32 v240, v251 offset:384
    s_add_u32 s72, s72, 1
    v_exp_f32 v201, v201
    v_add_f32 v199, 1.0, v199
    v_rcp_f32 v197, v197
    v_exp_f32 v202, v202
    v_mfma_f32_32x32x16_bf16 v[220:235], v[156:159], v[20:23], v[220:235]
    v_add_f32 v200, 1.0, v200
    v_rcp_f32 v198, v198
    v_exp_f32 v203, v203
    v_add_f32 v201, 1.0, v201
    v_mfma_f32_32x32x16_bf16 v[220:235], v[160:163], v[24:27], v[220:235]
    v_rcp_f32 v199, v199
    v_add_f32 v202, 1.0, v202
    v_rcp_f32 v200, v200
    v_add_f32 v203, 1.0, v203
    v_rcp_f32 v201, v201
    v_mfma_f32_32x32x16_bf16 v[220:235], v[164:167], v[28:31], v[220:235]
    v_rcp_f32 v202, v202
    v_rcp_f32 v203, v203
    v_mul_f32 v204, v188, v204
    v_mul_f32 v205, v189, v205
    s_waitcnt lgkmcnt(0)
    v_smfmac_f32_32x32x32_bf16 v[88:103], v[180:183], v[188:195], v177
    v_mul_f32 v206, v190, v206
    v_mul_f32 v207, v191, v207
    v_mul_f32 v208, v192, v208
    v_mul_f32 v209, v193, v209
    v_mul_f32 v210, v194, v210
    v_mul_f32 v211, v195, v211
    v_mul_f32 v212, v196, v212
    v_smfmac_f32_32x32x32_bf16 v[88:103], v[184:187], v[196:203], v177
    v_mul_f32 v213, v197, v213
    v_mul_f32 v214, v198, v214
    v_mul_f32 v215, v199, v215
    v_mul_f32 v216, v200, v216
    v_mul_f32 v217, v201, v217
    v_mul_f32 v218, v202, v218
    v_mul_f32 v219, v203, v219
    v_smfmac_f32_32x32x32_bf16 v[104:119], v[180:183], v[204:211], v177
    s_waitcnt vmcnt(0)
    ds_read_b128 v[168:171], v244
    v_exp_f32 v220, v220
    v_exp_f32 v221, v221
    v_exp_f32 v222, v222
    v_add_f32 v220, 1.0, v220
    v_smfmac_f32_32x32x32_bf16 v[104:119], v[184:187], v[212:219], v177
    v_exp_f32 v223, v223
    v_add_f32 v221, 1.0, v221
    v_exp_f32 v224, v224
    v_add_f32 v222, 1.0, v222
    v_rcp_f32 v220, v220
    s_waitcnt lgkmcnt(0)
    v_mfma_f32_32x32x16_bf16 v[188:203], v[168:171], v[64:67], 0
    v_exp_f32 v225, v225
    v_add_f32 v223, 1.0, v223
    v_rcp_f32 v221, v221
    v_exp_f32 v226, v226
    v_mfma_f32_32x32x16_bf16 v[204:219], v[152:155], v[48:51], 0
    ds_read_b128 v[152:155], v243 offset:0
    v_add_f32 v224, 1.0, v224
    v_rcp_f32 v222, v222
    v_exp_f32 v227, v227
    v_mfma_f32_32x32x16_bf16 v[204:219], v[156:159], v[52:55], v[204:219]
    ds_read_b128 v[156:159], v243 offset:16
    v_add_f32 v225, 1.0, v225
    v_rcp_f32 v223, v223
    v_exp_f32 v228, v228
    v_add_f32 v226, 1.0, v226
    v_rcp_f32 v224, v224
    v_smfmac_f32_32x32x32_bf16 v[188:203], v[172:175], v[72:79], v176
    v_exp_f32 v229, v229
    v_add_f32 v227, 1.0, v227
    v_rcp_f32 v225, v225
    v_exp_f32 v230, v230
    v_mfma_f32_32x32x16_bf16 v[204:219], v[160:163], v[56:59], v[204:219]
    ds_read_b128 v[160:163], v243 offset:32
    v_add_f32 v228, 1.0, v228
    v_rcp_f32 v226, v226
    v_exp_f32 v231, v231
    v_add_f32 v229, 1.0, v229
    v_mfma_f32_32x32x16_bf16 v[204:219], v[164:167], v[60:63], v[204:219]
    ds_read_b128 v[164:167], v243 offset:48
    v_rcp_f32 v227, v227
    v_exp_f32 v232, v232
    v_add_f32 v230, 1.0, v230
    v_rcp_f32 v228, v228
    s_waitcnt lgkmcnt(3)
    v_mfma_f32_32x32x16_bf16 v[188:203], v[152:155], v[0:3], v[188:203]
    v_exp_f32 v233, v233
    v_add_f32 v231, 1.0, v231
    v_rcp_f32 v229, v229
    v_exp_f32 v234, v234
    s_waitcnt lgkmcnt(2)
    v_mfma_f32_32x32x16_bf16 v[188:203], v[156:159], v[4:7], v[188:203]
    v_add_f32 v232, 1.0, v232
    v_rcp_f32 v230, v230
    v_exp_f32 v235, v235
    v_add_f32 v233, 1.0, v233
    s_waitcnt lgkmcnt(1)
    v_mfma_f32_32x32x16_bf16 v[188:203], v[160:163], v[8:11], v[188:203]
    v_rcp_f32 v231, v231
    v_add_f32 v234, 1.0, v234
    v_rcp_f32 v232, v232
    v_add_f32 v235, 1.0, v235
    v_rcp_f32 v233, v233
    s_waitcnt lgkmcnt(0)
    v_mfma_f32_32x32x16_bf16 v[188:203], v[164:167], v[12:15], v[188:203]
    s_cmp_lt_i32 s72, s38
    s_cbranch_scc0 K2_ND_1
    s_add_u32 m0, s74, 0
    v_mad_u32_u16 v236, v236, s75, v241 op_sel:[1,0,0,0]
    buffer_load_dwordx4 v236, s[16:19], 0 offen lds
    s_add_u32 m0, s74, 1040
    v_mad_u32_u16 v237, v237, s75, v241 op_sel:[1,0,0,0]
    buffer_load_dwordx4 v237, s[16:19], 0 offen lds
    s_add_u32 m0, s74, 2080
    v_mad_u32_u16 v238, v238, s75, v241 op_sel:[1,0,0,0]
    buffer_load_dwordx4 v238, s[16:19], 0 offen lds
    s_add_u32 m0, s74, 3120
    v_mad_u32_u16 v239, v239, s75, v241 op_sel:[1,0,0,0]
    buffer_load_dwordx4 v239, s[16:19], 0 offen lds
    s_add_u32 m0, s74, 4160
    v_add_u32 v240, v240, v242
    buffer_load_dwordx4 v240, s[20:23], 0 offen lds
K2_ND_1:
    v_rcp_f32 v234, v234
    v_rcp_f32 v235, v235
    v_mul_f32 v204, v220, v204
    v_mul_f32 v205, v221, v205
    v_smfmac_f32_32x32x32_bf16 v[120:135], v[180:183], v[220:227], v177
    v_mul_f32 v206, v222, v206
    v_mul_f32 v207, v223, v207
    v_mul_f32 v208, v224, v208
    v_mul_f32 v209, v225, v209
    v_mul_f32 v210, v226, v210
    v_mul_f32 v211, v227, v211
    v_mul_f32 v212, v228, v212
    v_smfmac_f32_32x32x32_bf16 v[120:135], v[184:187], v[228:235], v177
    v_mul_f32 v213, v229, v213
    v_mul_f32 v214, v230, v214
    v_mul_f32 v215, v231, v215
    v_mul_f32 v216, v232, v216
    v_mul_f32 v217, v233, v217
    v_mul_f32 v218, v234, v218
    v_mul_f32 v219, v235, v219
    v_add_u32 v247, 0x100, v247
    v_add_u32 v249, 0x100, v249
    v_add_u32 v251, 0x100, v251
    v_add_u32 v248, 0x100, v248
    s_cmp_lt_u32 s72, s87
    s_cbranch_scc1 K2_LOOP
    s_cmp_ge_u32 s72, s73
    s_cbranch_scc1 K2_TAIL
    s_cmp_lg_u32 s72, s37
    s_cbranch_scc1 K2_SB1
    s_barrier
    s_mov_b32 s37, -1
K2_SB1:
    s_cmp_lg_u32 s72, s4
    s_cbranch_scc1 K2_PR1_0
    s_setprio 2
K2_PR1_0:
    s_cmp_lg_u32 s72, s5
    s_cbranch_scc1 K2_PR1_1
    s_setprio 1
K2_PR1_1:
    s_cmp_lg_u32 s72, s6
    s_cbranch_scc1 K2_PR1_2
    s_setprio 0
K2_PR1_2:
    s_lshl_b32 s10, s78, 8
    s_add_u32 s10, s10, s38
    s_cmp_eq_u32 s72, s10
    s_cbranch_scc1 K2_LT1
    s_mov_b32 s87, s73
    s_cmp_gt_i32 s4, s72
    s_cselect_b32 s10, s4, s87
    s_min_u32 s87, s87, s10
    s_cmp_gt_i32 s5, s72
    s_cselect_b32 s10, s5, s87
    s_min_u32 s87, s87, s10
    s_cmp_gt_i32 s6, s72
    s_cselect_b32 s10, s6, s87
    s_min_u32 s87, s87, s10
    s_cmp_gt_i32 s37, s72
    s_cselect_b32 s10, s37, s87
    s_min_u32 s87, s87, s10
    s_cmp_gt_i32 s38, s72
    s_cselect_b32 s10, s38, s87
    s_min_u32 s87, s87, s10
    s_branch K2_LOOP
K2_EV0:
    s_cmp_ge_u32 s72, s73
    s_cbranch_scc1 K2_TAIL
    s_cmp_lg_u32 s72, s37
    s_cbranch_scc1 K2_SB0
    s_barrier
    s_mov_b32 s37, -1
K2_SB0:
    s_cmp_lg_u32 s72, s4
    s_cbranch_scc1 K2_PR0_0
    s_setprio 2
K2_PR0_0:
    s_cmp_lg_u32 s72, s5
    s_cbranch_scc1 K2_PR0_1
    s_setprio 1
K2_PR0_1:
    s_cmp_lg_u32 s72, s6
    s_cbranch_scc1 K2_PR0_2
    s_setprio 0
K2_PR0_2:
    s_lshl_b32 s10, s78, 8
    s_add_u32 s10, s10, s38
    s_cmp_eq_u32 s72, s10
    s_cbranch_scc1 K2_LT0
    s_mov_b32 s87, s73
    s_cmp_gt_i32 s4, s72
    s_cselect_b32 s10, s4, s87
    s_min_u32 s87, s87, s10
    s_cmp_gt_i32 s5, s72
    s_cselect_b32 s10, s5, s87
    s_min_u32 s87, s87, s10
    s_cmp_gt_i32 s6, s72
    s_cselect_b32 s10, s6, s87
    s_min_u32 s87, s87, s10
    s_cmp_gt_i32 s37, s72
    s_cselect_b32 s10, s37, s87
    s_min_u32 s87, s87, s10
    s_cmp_gt_i32 s38, s72
    s_cselect_b32 s10, s38, s87
    s_min_u32 s87, s87, s10
    s_branch K2_EVR0
K2_LT0:
    v_add_u32 v248, 128, v248
K2_LT1:
    s_sub_u32 s10, s15, s76
    s_sub_u32 s10, s10, 4
    s_and_b32 s10, s10, 127
    s_cmp_lt_u32 s10, 32
    s_cbranch_scc1 K2_LG1
    s_cmp_lt_u32 s10, 64
    s_cbranch_scc1 K2_LG2
    s_cmp_lt_u32 s10, 96
    s_cbranch_scc1 K2_LG3
    v_smfmac_f32_32x32x32_bf16 v[136:151], v[180:183], v[204:211], v177
    ds_read_u8 v236, v248 offset:0
    ds_read_u8 v237, v248 offset:16
    ds_read_u8 v238, v248 offset:64
    ds_read_u8 v239, v248 offset:80
    v_exp_f32 v188, v188
    v_exp_f32 v189, v189
    v_exp_f32 v190, v190
    v_add_f32 v188, 1.0, v188
    v_smfmac_f32_32x32x32_bf16 v[136:151], v[184:187], v[212:219], v177
    v_lshlrev_b32 v252, 4, v254
    v_and_b32 v247, 31, v254
    v_and_b32 v245, 32, v254
    v_mul_u32_u24 v249, 144, v247
    v_lshrrev_b32 v251, 2, v245
    v_lshl_add_u32 v247, v247, 6, v251
    v_lshl_add_u32 v249, v245, 1, v249
    v_add_u32 v249, s74, v249
    v_lshrrev_b32 v251, 3, v254
    v_lshl_add_u32 v251, v251, 4, v252
    v_add_u32 v251, s70, v251
    v_exp_f32 v191, v191
    v_add_f32 v189, 1.0, v189
    v_exp_f32 v192, v192
    v_add_f32 v190, 1.0, v190
    v_rcp_f32 v188, v188
    v_mfma_f32_32x32x16_bf16 v[220:235], v[168:171], v[68:71], 0
    v_exp_f32 v193, v193
    v_add_f32 v191, 1.0, v191
    v_rcp_f32 v189, v189
    v_exp_f32 v194, v194
    v_mfma_f32_32x32x16_bf16 v[204:219], v[152:155], v[32:35], 0
    v_add_f32 v192, 1.0, v192
    v_rcp_f32 v190, v190
    v_exp_f32 v195, v195
    v_mfma_f32_32x32x16_bf16 v[204:219], v[156:159], v[36:39], v[204:219]
    s_waitcnt lgkmcnt(0)
    v_lshl_add_u32 v236, v236, 6, v246
    v_lshl_add_u32 v237, v237, 6, v246
    v_lshl_add_u32 v238, v238, 6, v246
    v_lshl_add_u32 v239, v239, 6, v246
    v_add_f32 v193, 1.0, v193
    v_rcp_f32 v191, v191
    v_exp_f32 v196, v196
    v_add_f32 v194, 1.0, v194
    v_rcp_f32 v192, v192
    v_smfmac_f32_32x32x32_bf16 v[220:235], v[172:175], v[80:87], v176
    ds_read_b64_tr_b16 v[180:181], v236
    ds_read_b64_tr_b16 v[182:183], v237
    ds_read_b64_tr_b16 v[184:185], v238
    ds_read_b64_tr_b16 v[186:187], v239
    v_exp_f32 v197, v197
    v_add_f32 v195, 1.0, v195
    v_rcp_f32 v193, v193
    v_exp_f32 v198, v198
    v_mfma_f32_32x32x16_bf16 v[204:219], v[160:163], v[40:43], v[204:219]
    v_add_f32 v196, 1.0, v196
    v_rcp_f32 v194, v194
    v_exp_f32 v199, v199
    v_add_f32 v197, 1.0, v197
    v_mfma_f32_32x32x16_bf16 v[204:219], v[164:167], v[44:47], v[204:219]
    v_rcp_f32 v195, v195
    v_exp_f32 v200, v200
    v_add_f32 v198, 1.0, v198
    v_rcp_f32 v196, v196
    v_mfma_f32_32x32x16_bf16 v[220:235], v[152:155], v[16:19], v[220:235]
    v_exp_f32 v201, v201
    v_add_f32 v199, 1.0, v199
    v_rcp_f32 v197, v197
    v_exp_f32 v202, v202
    v_mfma_f32_32x32x16_bf16 v[220:235], v[156:159], v[20:23], v[220:235]
    v_add_f32 v200, 1.0, v200
    v_rcp_f32 v198, v198
    v_exp_f32 v203, v203
    v_add_f32 v201, 1.0, v201
    v_mfma_f32_32x32x16_bf16 v[220:235], v[160:163], v[24:27], v[220:235]
    v_rcp_f32 v199, v199
    v_add_f32 v202, 1.0, v202
    v_rcp_f32 v200, v200
    v_add_f32 v203, 1.0, v203
    v_rcp_f32 v201, v201
    v_mfma_f32_32x32x16_bf16 v[220:235], v[164:167], v[28:31], v[220:235]
    ds_read2_b64 v[64:67], v247 offset0:0 offset1:2
    ds_read2_b64 v[68:71], v247 offset0:4 offset1:6
    ds_read_b128 v[0:3], v252 offset:52736
    ds_read_b128 v[4:7], v252 offset:53760
    ds_read_b128 v[8:11], v252 offset:54784
    ds_read_b128 v[12:15], v252 offset:55808
    ds_read_b128 v[16:19], v252 offset:56832
    ds_read_b128 v[20:23], v252 offset:57856
    ds_read_b128 v[24:27], v252 offset:58880
    ds_read_b128 v[28:31], v252 offset:59904
    v_rcp_f32 v202, v202
    v_rcp_f32 v203, v203
    v_mul_f32 v204, v188, v204
    v_mul_f32 v205, v189, v205
    s_waitcnt lgkmcnt(10)
    v_smfmac_f32_32x32x32_bf16 v[88:103], v[180:183], v[188:195], v177
    v_mul_f32 v206, v190, v206
    v_mul_f32 v207, v191, v207
    v_mul_f32 v208, v192, v208
    v_mul_f32 v209, v193, v209
    v_mul_f32 v210, v194, v210
    v_mul_f32 v211, v195, v211
    v_mul_f32 v212, v196, v212
    v_smfmac_f32_32x32x32_bf16 v[88:103], v[184:187], v[196:203], v177
    v_mul_f32 v213, v197, v213
    v_mul_f32 v214, v198, v214
    v_mul_f32 v215, v199, v215
    v_mul_f32 v216, v200, v216
    v_mul_f32 v217, v201, v217
    v_mul_f32 v218, v202, v218
    v_mul_f32 v219, v203, v219
    v_smfmac_f32_32x32x32_bf16 v[104:119], v[180:183], v[204:211], v177
    v_exp_f32 v220, v220
    v_exp_f32 v221, v221
    v_exp_f32 v222, v222
    v_add_f32 v220, 1.0, v220
    v_exp_f32 v223, v223
    v_smfmac_f32_32x32x32_bf16 v[104:119], v[184:187], v[212:219], v177
    v_add_f32 v221, 1.0, v221
    v_exp_f32 v224, v224
    v_add_f32 v222, 1.0, v222
    v_rcp_f32 v220, v220
    v_exp_f32 v225, v225
    v_add_f32 v223, 1.0, v223
    v_mfma_f32_32x32x16_bf16 v[204:219], v[152:155], v[48:51], 0
    ds_read_b128 v[152:155], v253 offset:0
    v_rcp_f32 v221, v221
    v_exp_f32 v226, v226
    v_add_f32 v224, 1.0, v224
    v_rcp_f32 v222, v222
    v_exp_f32 v227, v227
    v_mfma_f32_32x32x16_bf16 v[204:219], v[156:159], v[52:55], v[204:219]
    ds_read_b128 v[156:159], v253 offset:16
    v_add_f32 v225, 1.0, v225
    v_rcp_f32 v223, v223
    v_exp_f32 v228, v228
    v_add_f32 v226, 1.0, v226
    v_rcp_f32 v224, v224
    v_exp_f32 v229, v229
    v_mfma_f32_32x32x16_bf16 v[204:219], v[160:163], v[56:59], v[204:219]
    ds_read_b128 v[160:163], v253 offset:32
    v_add_f32 v227, 1.0, v227
    v_rcp_f32 v225, v225
    v_exp_f32 v230, v230
    v_add_f32 v228, 1.0, v228
    v_rcp_f32 v226, v226
    v_mfma_f32_32x32x16_bf16 v[204:219], v[164:167], v[60:63], v[204:219]
    ds_read_b128 v[164:167], v253 offset:48
    v_exp_f32 v231, v231
    v_add_f32 v229, 1.0, v229
    v_rcp_f32 v227, v227
    v_exp_f32 v232, v232
    v_add_f32 v230, 1.0, v230
    v_rcp_f32 v228, v228
    v_exp_f32 v233, v233
    v_add_f32 v231, 1.0, v231
    v_rcp_f32 v229, v229
    v_exp_f32 v234, v234
    v_add_f32 v232, 1.0, v232
    v_rcp_f32 v230, v230
    v_exp_f32 v235, v235
    v_add_f32 v233, 1.0, v233
    v_rcp_f32 v231, v231
    v_add_f32 v234, 1.0, v234
    v_rcp_f32 v232, v232
    v_add_f32 v235, 1.0, v235
    v_rcp_f32 v233, v233
    v_rcp_f32 v234, v234
    v_rcp_f32 v235, v235
    v_mul_f32 v204, v220, v204
    v_mul_f32 v205, v221, v205
    v_smfmac_f32_32x32x32_bf16 v[120:135], v[180:183], v[220:227], v177
    v_mul_f32 v206, v222, v206
    v_mul_f32 v207, v223, v207
    v_mul_f32 v208, v224, v208
    v_mul_f32 v209, v225, v209
    v_mul_f32 v210, v226, v210
    v_mul_f32 v211, v227, v211
    v_mul_f32 v212, v228, v212
    v_smfmac_f32_32x32x32_bf16 v[120:135], v[184:187], v[228:235], v177
    v_mul_f32 v213, v229, v213
    v_mul_f32 v214, v230, v214
    v_mul_f32 v215, v231, v215
    v_mul_f32 v216, v232, v216
    v_mul_f32 v217, v233, v217
    v_mul_f32 v218, v234, v218
    v_mul_f32 v219, v235, v219
    v_smfmac_f32_32x32x32_bf16 v[136:151], v[180:183], v[204:211], v177
    s_nop 0
    v_smfmac_f32_32x32x32_bf16 v[136:151], v[184:187], v[212:219], v177
    s_branch K2_EPI2
K2_LG3:
    v_smfmac_f32_32x32x32_bf16 v[136:151], v[180:183], v[204:211], v177
    ds_read_u8 v236, v248 offset:0
    ds_read_u8 v237, v248 offset:16
    ds_read_u8 v238, v248 offset:64
    ds_read_u8 v239, v248 offset:80
    v_exp_f32 v188, v188
    v_exp_f32 v189, v189
    v_exp_f32 v190, v190
    v_smfmac_f32_32x32x32_bf16 v[136:151], v[184:187], v[212:219], v177
    v_lshlrev_b32 v252, 4, v254
    v_and_b32 v247, 31, v254
    v_and_b32 v245, 32, v254
    v_mul_u32_u24 v249, 144, v247
    v_lshrrev_b32 v251, 2, v245
    v_lshl_add_u32 v247, v247, 6, v251
    v_lshl_add_u32 v249, v245, 1, v249
    v_add_u32 v249, s74, v249
    v_lshrrev_b32 v251, 3, v254
    v_lshl_add_u32 v251, v251, 4, v252
    v_add_u32 v251, s70, v251
    v_add_f32 v188, 1.0, v188
    v_exp_f32 v191, v191
    v_add_f32 v189, 1.0, v189
    v_exp_f32 v192, v192
    v_mfma_f32_32x32x16_bf16 v[220:235], v[168:171], v[68:71], 0
    v_add_f32 v190, 1.0, v190
    v_rcp_f32 v188, v188
    v_exp_f32 v193, v193
    v_mfma_f32_32x32x16_bf16 v[204:219], v[152:155], v[32:35], 0
    v_add_f32 v191, 1.0, v191
    v_rcp_f32 v189, v189
    v_exp_f32 v194, v194
    v_mfma_f32_32x32x16_bf16 v[204:219], v[156:159], v[36:39], v[204:219]
    s_waitcnt lgkmcnt(0)
    v_lshl_add_u32 v236, v236, 6, v246
    v_lshl_add_u32 v237, v237, 6, v246
    v_lshl_add_u32 v238, v238, 6, v246
    v_lshl_add_u32 v239, v239, 6, v246
    v_add_f32 v192, 1.0, v192
    v_rcp_f32 v190, v190
    v_exp_f32 v195, v195
    v_smfmac_f32_32x32x32_bf16 v[220:235], v[172:175], v[80:87], v176
    ds_read_b64_tr_b16 v[180:181], v236
    ds_read_b64_tr_b16 v[182:183], v237
    ds_read_b64_tr_b16 v[184:185], v238
    ds_read_b64_tr_b16 v[186:187], v239
    v_add_f32 v193, 1.0, v193
    v_rcp_f32 v191, v191
    v_exp_f32 v196, v196
    v_mfma_f32_32x32x16_bf16 v[204:219], v[160:163], v[40:43], v[204:219]
    v_add_f32 v194, 1.0, v194
    v_rcp_f32 v192, v192
    v_exp_f32 v197, v197
    v_mfma_f32_32x32x16_bf16 v[204:219], v[164:167], v[44:47], v[204:219]
    v_add_f32 v195, 1.0, v195
    v_rcp_f32 v193, v193
    v_exp_f32 v198, v198
    v_mfma_f32_32x32x16_bf16 v[220:235], v[152:155], v[16:19], v[220:235]
    v_add_f32 v196, 1.0, v196
    v_rcp_f32 v194, v194
    v_exp_f32 v199, v199
    v_mfma_f32_32x32x16_bf16 v[220:235], v[156:159], v[20:23], v[220:235]
    v_add_f32 v197, 1.0, v197
    v_rcp_f32 v195, v195
    v_add_f32 v198, 1.0, v198
    v_mfma_f32_32x32x16_bf16 v[220:235], v[160:163], v[24:27], v[220:235]
    v_rcp_f32 v196, v196
    v_add_f32 v199, 1.0, v199
    v_rcp_f32 v197, v197
    v_mfma_f32_32x32x16_bf16 v[220:235], v[164:167], v[28:31], v[220:235]
    ds_read2_b64 v[64:67], v247 offset0:0 offset1:2
    ds_read2_b64 v[68:71], v247 offset0:4 offset1:6
    ds_read_b128 v[0:3], v252 offset:52736
    ds_read_b128 v[4:7], v252 offset:53760
    ds_read_b128 v[8:11], v252 offset:54784
    ds_read_b128 v[12:15], v252 offset:55808
    ds_read_b128 v[16:19], v252 offset:56832
    ds_read_b128 v[20:23], v252 offset:57856
    ds_read_b128 v[24:27], v252 offset:58880
    ds_read_b128 v[28:31], v252 offset:59904
    v_rcp_f32 v198, v198
    v_rcp_f32 v199, v199
    v_mul_f32 v204, v188, v204
    v_mul_f32 v205, v189, v205
    s_waitcnt lgkmcnt(10)
    v_smfmac_f32_32x32x32_bf16 v[88:103], v[180:183], v[188:195], v177
    v_mul_f32 v206, v190, v206
    v_mul_f32 v207, v191, v207
    v_mul_f32 v208, v192, v208
    v_mul_f32 v209, v193, v209
    v_mul_f32 v210, v194, v210
    v_smfmac_f32_32x32x32_bf16 v[88:103], v[184:187], v[196:203], v177
    v_mul_f32 v211, v195, v211
    v_mul_f32 v212, v196, v212
    v_mul_f32 v213, v197, v213
    v_mul_f32 v214, v198, v214
    v_mul_f32 v215, v199, v215
    v_smfmac_f32_32x32x32_bf16 v[104:119], v[180:183], v[204:211], v177
    v_exp_f32 v220, v220
    v_exp_f32 v221, v221
    v_exp_f32 v222, v222
    v_add_f32 v220, 1.0, v220
    v_smfmac_f32_32x32x32_bf16 v[104:119], v[184:187], v[212:219], v177
    v_exp_f32 v223, v223
    v_add_f32 v221, 1.0, v221
    v_exp_f32 v224, v224
    v_add_f32 v222, 1.0, v222
    v_rcp_f32 v220, v220
    v_mfma_f32_32x32x16_bf16 v[204:219], v[152:155], v[48:51], 0
    ds_read_b128 v[152:155], v253 offset:0
    v_exp_f32 v225, v225
    v_add_f32 v223, 1.0, v223
    v_rcp_f32 v221, v221
    v_exp_f32 v226, v226
    v_mfma_f32_32x32x16_bf16 v[204:219], v[156:159], v[52:55], v[204:219]
    ds_read_b128 v[156:159], v253 offset:16
    v_add_f32 v224, 1.0, v224
    v_rcp_f32 v222, v222
    v_exp_f32 v227, v227
    v_mfma_f32_32x32x16_bf16 v[204:219], v[160:163], v[56:59], v[204:219]
    ds_read_b128 v[160:163], v253 offset:32
    v_add_f32 v225, 1.0, v225
    v_rcp_f32 v223, v223
    v_exp_f32 v228, v228
    v_add_f32 v226, 1.0, v226
    v_rcp_f32 v224, v224
    v_mfma_f32_32x32x16_bf16 v[204:219], v[164:167], v[60:63], v[204:219]
    ds_read_b128 v[164:167], v253 offset:48
    v_exp_f32 v229, v229
    v_add_f32 v227, 1.0, v227
    v_rcp_f32 v225, v225
    v_exp_f32 v230, v230
    v_add_f32 v228, 1.0, v228
    v_rcp_f32 v226, v226
    v_exp_f32 v231, v231
    v_add_f32 v229, 1.0, v229
    v_rcp_f32 v227, v227
    v_add_f32 v230, 1.0, v230
    v_rcp_f32 v228, v228
    v_add_f32 v231, 1.0, v231
    v_rcp_f32 v229, v229
    v_rcp_f32 v230, v230
    v_rcp_f32 v231, v231
    v_mul_f32 v204, v220, v204
    v_mul_f32 v205, v221, v205
    v_smfmac_f32_32x32x32_bf16 v[120:135], v[180:183], v[220:227], v177
    v_mul_f32 v206, v222, v206
    v_mul_f32 v207, v223, v207
    v_mul_f32 v208, v224, v208
    v_mul_f32 v209, v225, v209
    v_mul_f32 v210, v226, v210
    v_smfmac_f32_32x32x32_bf16 v[120:135], v[184:187], v[228:235], v177
    v_mul_f32 v211, v227, v211
    v_mul_f32 v212, v228, v212
    v_mul_f32 v213, v229, v213
    v_mul_f32 v214, v230, v214
    v_mul_f32 v215, v231, v215
    v_smfmac_f32_32x32x32_bf16 v[136:151], v[180:183], v[204:211], v177
    s_nop 0
    v_smfmac_f32_32x32x32_bf16 v[136:151], v[184:187], v[212:219], v177
    s_branch K2_EPI2
K2_LG2:
    v_smfmac_f32_32x32x32_bf16 v[136:151], v[180:183], v[204:211], v177
    ds_read_u8 v236, v248 offset:0
    ds_read_u8 v237, v248 offset:16
    ds_read_u8 v238, v248 offset:64
    ds_read_u8 v239, v248 offset:80
    v_exp_f32 v188, v188
    v_exp_f32 v189, v189
    v_smfmac_f32_32x32x32_bf16 v[136:151], v[184:187], v[212:219], v177
    v_lshlrev_b32 v252, 4, v254
    v_and_b32 v247, 31, v254
    v_and_b32 v245, 32, v254
    v_mul_u32_u24 v249, 144, v247
    v_lshrrev_b32 v251, 2, v245
    v_lshl_add_u32 v247, v247, 6, v251
    v_lshl_add_u32 v249, v245, 1, v249
    v_add_u32 v249, s74, v249
    v_lshrrev_b32 v251, 3, v254
    v_lshl_add_u32 v251, v251, 4, v252
    v_add_u32 v251, s70, v251
    v_exp_f32 v190, v190
    v_add_f32 v188, 1.0, v188
    v_mfma_f32_32x32x16_bf16 v[220:235], v[168:171], v[68:71], 0
    v_exp_f32 v191, v191
    v_add_f32 v189, 1.0, v189
    v_exp_f32 v192, v192
    v_mfma_f32_32x32x16_bf16 v[204:219], v[152:155], v[32:35], 0
    v_add_f32 v190, 1.0, v190
    v_rcp_f32 v188, v188
    v_mfma_f32_32x32x16_bf16 v[204:219], v[156:159], v[36:39], v[204:219]
    s_waitcnt lgkmcnt(0)
    v_lshl_add_u32 v236, v236, 6, v246
    v_lshl_add_u32 v237, v237, 6, v246
    v_lshl_add_u32 v238, v238, 6, v246
    v_lshl_add_u32 v239, v239, 6, v246
    v_exp_f32 v193, v193
    v_smfmac_f32_32x32x32_bf16 v[220:235], v[172:175], v[80:87], v176
    ds_read_b64_tr_b16 v[180:181], v236
    ds_read_b64_tr_b16 v[182:183], v237
    ds_read_b64_tr_b16 v[184:185], v238
    ds_read_b64_tr_b16 v[186:187], v239
    v_add_f32 v191, 1.0, v191
    v_rcp_f32 v189, v189
    v_exp_f32 v194, v194
    v_mfma_f32_32x32x16_bf16 v[204:219], v[160:163], v[40:43], v[204:219]
    v_add_f32 v192, 1.0, v192
    v_rcp_f32 v190, v190
    v_mfma_f32_32x32x16_bf16 v[204:219], v[164:167], v[44:47], v[204:219]
    v_exp_f32 v195, v195
    v_mfma_f32_32x32x16_bf16 v[220:235], v[152:155], v[16:19], v[220:235]
    v_add_f32 v193, 1.0, v193
    v_rcp_f32 v191, v191
    v_add_f32 v194, 1.0, v194
    v_mfma_f32_32x32x16_bf16 v[220:235], v[156:159], v[20:23], v[220:235]
    v_rcp_f32 v192, v192
    v_add_f32 v195, 1.0, v195
    v_mfma_f32_32x32x16_bf16 v[220:235], v[160:163], v[24:27], v[220:235]
    v_rcp_f32 v193, v193
    v_rcp_f32 v194, v194
    v_mfma_f32_32x32x16_bf16 v[220:235], v[164:167], v[28:31], v[220:235]
    ds_read2_b64 v[64:67], v247 offset0:0 offset1:2
    ds_read2_b64 v[68:71], v247 offset0:4 offset1:6
    ds_read_b128 v[0:3], v252 offset:52736
    ds_read_b128 v[4:7], v252 offset:53760
    ds_read_b128 v[8:11], v252 offset:54784
    ds_read_b128 v[12:15], v252 offset:55808
    ds_read_b128 v[16:19], v252 offset:56832
    ds_read_b128 v[20:23], v252 offset:57856
    ds_read_b128 v[24:27], v252 offset:58880
    ds_read_b128 v[28:31], v252 offset:59904
    v_rcp_f32 v195, v195
    v_mul_f32 v204, v188, v204
    v_mul_f32 v205, v189, v205
    v_mul_f32 v206, v190, v206
    s_waitcnt lgkmcnt(10)
    v_smfmac_f32_32x32x32_bf16 v[88:103], v[180:183], v[188:195], v177
    v_mul_f32 v207, v191, v207
    v_mul_f32 v208, v192, v208
    v_mul_f32 v209, v193, v209
    v_mul_f32 v210, v194, v210
    v_mul_f32 v211, v195, v211
    s_nop 1
    v_smfmac_f32_32x32x32_bf16 v[104:119], v[180:183], v[204:211], v177
    v_exp_f32 v220, v220
    v_exp_f32 v221, v221
    v_exp_f32 v222, v222
    v_mfma_f32_32x32x16_bf16 v[204:219], v[152:155], v[48:51], 0
    ds_read_b128 v[152:155], v253 offset:0
    v_add_f32 v220, 1.0, v220
    v_exp_f32 v223, v223
    v_add_f32 v221, 1.0, v221
    v_mfma_f32_32x32x16_bf16 v[204:219], v[156:159], v[52:55], v[204:219]
    ds_read_b128 v[156:159], v253 offset:16
    v_exp_f32 v224, v224
    v_add_f32 v222, 1.0, v222
    v_rcp_f32 v220, v220
    v_mfma_f32_32x32x16_bf16 v[204:219], v[160:163], v[56:59], v[204:219]
    ds_read_b128 v[160:163], v253 offset:32
    v_exp_f32 v225, v225
    v_add_f32 v223, 1.0, v223
    v_rcp_f32 v221, v221
    v_mfma_f32_32x32x16_bf16 v[204:219], v[164:167], v[60:63], v[204:219]
    ds_read_b128 v[164:167], v253 offset:48
    v_exp_f32 v226, v226
    v_add_f32 v224, 1.0, v224
    v_rcp_f32 v222, v222
    v_exp_f32 v227, v227
    v_add_f32 v225, 1.0, v225
    v_rcp_f32 v223, v223
    v_add_f32 v226, 1.0, v226
    v_rcp_f32 v224, v224
    v_add_f32 v227, 1.0, v227
    v_rcp_f32 v225, v225
    v_rcp_f32 v226, v226
    v_rcp_f32 v227, v227
    v_mul_f32 v204, v220, v204
    v_mul_f32 v205, v221, v205
    v_mul_f32 v206, v222, v206
    v_smfmac_f32_32x32x32_bf16 v[120:135], v[180:183], v[220:227], v177
    v_mul_f32 v207, v223, v207
    v_mul_f32 v208, v224, v208
    v_mul_f32 v209, v225, v209
    v_mul_f32 v210, v226, v210
    v_mul_f32 v211, v227, v211
    s_nop 1
    v_smfmac_f32_32x32x32_bf16 v[136:151], v[180:183], v[204:211], v177
    s_branch K2_EPI2
K2_LG1:
    v_smfmac_f32_32x32x32_bf16 v[136:151], v[180:183], v[204:211], v177
    ds_read_u8 v236, v248 offset:0
    ds_read_u8 v237, v248 offset:16
    ds_read_u8 v238, v248 offset:64
    ds_read_u8 v239, v248 offset:80
    v_exp_f32 v188, v188
    v_smfmac_f32_32x32x32_bf16 v[136:151], v[184:187], v[212:219], v177
    v_lshlrev_b32 v252, 4, v254
    v_and_b32 v247, 31, v254
    v_and_b32 v245, 32, v254
    v_mul_u32_u24 v249, 144, v247
    v_lshrrev_b32 v251, 2, v245
    v_lshl_add_u32 v247, v247, 6, v251
    v_lshl_add_u32 v249, v245, 1, v249
    v_add_u32 v249, s74, v249
    v_lshrrev_b32 v251, 3, v254
    v_lshl_add_u32 v251, v251, 4, v252
    v_add_u32 v251, s70, v251
    v_exp_f32 v189, v189
    v_mfma_f32_32x32x16_bf16 v[220:235], v[168:171], v[68:71], 0
    v_exp_f32 v190, v190
    v_mfma_f32_32x32x16_bf16 v[204:219], v[152:155], v[32:35], 0
    v_add_f32 v188, 1.0, v188
    v_mfma_f32_32x32x16_bf16 v[204:219], v[156:159], v[36:39], v[204:219]
    s_waitcnt lgkmcnt(0)
    v_lshl_add_u32 v236, v236, 6, v246
    v_lshl_add_u32 v237, v237, 6, v246
    v_lshl_add_u32 v238, v238, 6, v246
    v_lshl_add_u32 v239, v239, 6, v246
    v_exp_f32 v191, v191
    v_smfmac_f32_32x32x32_bf16 v[220:235], v[172:175], v[80:87], v176
    ds_read_b64_tr_b16 v[180:181], v236
    ds_read_b64_tr_b16 v[182:183], v237
    ds_read_b64_tr_b16 v[184:185], v238
    ds_read_b64_tr_b16 v[186:187], v239
    v_add_f32 v189, 1.0, v189
    v_add_f32 v190, 1.0, v190
    v_mfma_f32_32x32x16_bf16 v[204:219], v[160:163], v[40:43], v[204:219]
    v_rcp_f32 v188, v188
    v_mfma_f32_32x32x16_bf16 v[204:219], v[164:167], v[44:47], v[204:219]
    v_add_f32 v191, 1.0, v191
    v_mfma_f32_32x32x16_bf16 v[220:235], v[152:155], v[16:19], v[220:235]
    v_rcp_f32 v189, v189
    v_mfma_f32_32x32x16_bf16 v[220:235], v[156:159], v[20:23], v[220:235]
    v_rcp_f32 v190, v190
    v_mfma_f32_32x32x16_bf16 v[220:235], v[160:163], v[24:27], v[220:235]
    v_rcp_f32 v191, v191
    v_mfma_f32_32x32x16_bf16 v[220:235], v[164:167], v[28:31], v[220:235]
    ds_read2_b64 v[64:67], v247 offset0:0 offset1:2
    ds_read2_b64 v[68:71], v247 offset0:4 offset1:6
    ds_read_b128 v[0:3], v252 offset:52736
    ds_read_b128 v[4:7], v252 offset:53760
    ds_read_b128 v[8:11], v252 offset:54784
    ds_read_b128 v[12:15], v252 offset:55808
    ds_read_b128 v[16:19], v252 offset:56832
    ds_read_b128 v[20:23], v252 offset:57856
    ds_read_b128 v[24:27], v252 offset:58880
    ds_read_b128 v[28:31], v252 offset:59904
    v_mul_f32 v204, v188, v204
    v_mul_f32 v205, v189, v205
    s_waitcnt lgkmcnt(10)
    v_smfmac_f32_32x32x32_bf16 v[88:103], v[180:183], v[188:195], v177
    v_mul_f32 v206, v190, v206
    v_mul_f32 v207, v191, v207
    s_nop 1
    v_smfmac_f32_32x32x32_bf16 v[104:119], v[180:183], v[204:211], v177
    v_exp_f32 v220, v220
    v_exp_f32 v221, v221
    v_mfma_f32_32x32x16_bf16 v[204:219], v[152:155], v[48:51], 0
    ds_read_b128 v[152:155], v253 offset:0
    v_exp_f32 v222, v222
    v_mfma_f32_32x32x16_bf16 v[204:219], v[156:159], v[52:55], v[204:219]
    ds_read_b128 v[156:159], v253 offset:16
    v_add_f32 v220, 1.0, v220
    v_exp_f32 v223, v223
    v_mfma_f32_32x32x16_bf16 v[204:219], v[160:163], v[56:59], v[204:219]
    ds_read_b128 v[160:163], v253 offset:32
    v_add_f32 v221, 1.0, v221
    v_mfma_f32_32x32x16_bf16 v[204:219], v[164:167], v[60:63], v[204:219]
    ds_read_b128 v[164:167], v253 offset:48
    v_add_f32 v222, 1.0, v222
    v_rcp_f32 v220, v220
    v_add_f32 v223, 1.0, v223
    v_rcp_f32 v221, v221
    v_rcp_f32 v222, v222
    v_rcp_f32 v223, v223
    s_nop 4
    v_mul_f32 v204, v220, v204
    v_mul_f32 v205, v221, v205
    v_smfmac_f32_32x32x32_bf16 v[120:135], v[180:183], v[220:227], v177
    v_mul_f32 v206, v222, v206
    v_mul_f32 v207, v223, v207
    s_nop 1
    v_smfmac_f32_32x32x32_bf16 v[136:151], v[180:183], v[204:211], v177
    s_branch K2_EPI2
K2_TAIL:
    v_smfmac_f32_32x32x32_bf16 v[136:151], v[180:183], v[204:211], v177
    v_smfmac_f32_32x32x32_bf16 v[136:151], v[184:187], v[212:219], v177
K2_DONE:
    s_cmp_lg_u32 s78, 0
    s_cbranch_scc1 K2_SLOW
K2_EPI:
    v_lshlrev_b32 v252, 4, v254
    v_and_b32 v247, 31, v254
    v_and_b32 v245, 32, v254
    v_mul_u32_u24 v249, 144, v247
    v_lshrrev_b32 v251, 2, v245
    v_lshl_add_u32 v247, v247, 6, v251
    v_lshl_add_u32 v249, v245, 1, v249
    v_add_u32 v249, s74, v249
    v_lshrrev_b32 v251, 3, v254
    v_lshl_add_u32 v251, v251, 4, v252
    v_add_u32 v251, s70, v251
    ds_read2_b64 v[64:67], v247 offset0:0 offset1:2
    ds_read2_b64 v[68:71], v247 offset0:4 offset1:6
    ds_read_b128 v[0:3], v252 offset:52736
    ds_read_b128 v[4:7], v252 offset:53760
    ds_read_b128 v[8:11], v252 offset:54784
    ds_read_b128 v[12:15], v252 offset:55808
    ds_read_b128 v[16:19], v252 offset:56832
    ds_read_b128 v[20:23], v252 offset:57856
    ds_read_b128 v[24:27], v252 offset:58880
    ds_read_b128 v[28:31], v252 offset:59904
    ds_read_b128 v[152:155], v253 offset:0
    ds_read_b128 v[156:159], v253 offset:16
    ds_read_b128 v[160:163], v253 offset:32
    ds_read_b128 v[164:167], v253 offset:48
K2_EPI2:
    s_nop 1
    v_rcp_f32 v88, v88
    v_rcp_f32 v89, v89
    v_rcp_f32 v90, v90
    v_rcp_f32 v91, v91
    v_rcp_f32 v92, v92
    v_rcp_f32 v93, v93
    v_rcp_f32 v94, v94
    v_rcp_f32 v95, v95
    s_waitcnt lgkmcnt(0)
    v_lshlrev_b32 v32, 16, v152
    v_and_b32 v33, 0xffff0000, v152
    v_lshlrev_b32 v34, 16, v153
    v_and_b32 v35, 0xffff0000, v153
    v_lshlrev_b32 v36, 16, v154
    v_and_b32 v37, 0xffff0000, v154
    v_lshlrev_b32 v38, 16, v155
    v_and_b32 v39, 0xffff0000, v155
    v_lshlrev_b32 v40, 16, v156
    v_and_b32 v41, 0xffff0000, v156
    v_lshlrev_b32 v42, 16, v157
    v_and_b32 v43, 0xffff0000, v157
    v_lshlrev_b32 v44, 16, v158
    v_and_b32 v45, 0xffff0000, v158
    v_lshlrev_b32 v46, 16, v159
    v_and_b32 v47, 0xffff0000, v159
    v_rcp_f32 v96, v96
    v_rcp_f32 v97, v97
    v_mfma_f32_32x32x16_bf16 v[188:203], v[0:3], v[152:155], v[32:47]
    v_rcp_f32 v98, v98
    v_rcp_f32 v99, v99
    v_rcp_f32 v100, v100
    v_rcp_f32 v101, v101
    v_rcp_f32 v102, v102
    v_rcp_f32 v103, v103
    v_lshlrev_b32 v48, 16, v160
    v_mfma_f32_32x32x16_bf16 v[188:203], v[4:7], v[156:159], v[188:203]
    v_and_b32 v49, 0xffff0000, v160
    v_lshlrev_b32 v50, 16, v161
    v_and_b32 v51, 0xffff0000, v161
    v_lshlrev_b32 v52, 16, v162
    v_and_b32 v53, 0xffff0000, v162
    v_lshlrev_b32 v54, 16, v163
    v_and_b32 v55, 0xffff0000, v163
    v_mfma_f32_32x32x16_bf16 v[188:203], v[8:11], v[160:163], v[188:203]
    v_lshlrev_b32 v56, 16, v164
    v_and_b32 v57, 0xffff0000, v164
    v_lshlrev_b32 v58, 16, v165
    v_and_b32 v59, 0xffff0000, v165
    v_lshlrev_b32 v60, 16, v166
    v_and_b32 v61, 0xffff0000, v166
    v_lshlrev_b32 v62, 16, v167
    v_mfma_f32_32x32x16_bf16 v[188:203], v[12:15], v[164:167], v[188:203]
    v_and_b32 v63, 0xffff0000, v167
    v_mul_f32 v104, v104, v88
    v_mul_f32 v105, v105, v89
    v_mul_f32 v106, v106, v90
    v_mul_f32 v107, v107, v91
    v_mul_f32 v108, v108, v92
    v_mul_f32 v109, v109, v93
    v_mfma_f32_32x32x16_bf16 v[72:87], v[16:19], v[152:155], v[48:63]
    v_mul_f32 v110, v110, v94
    v_mul_f32 v111, v111, v95
    v_mul_f32 v112, v112, v96
    v_mul_f32 v113, v113, v97
    v_mul_f32 v114, v114, v98
    v_mul_f32 v115, v115, v99
    v_mfma_f32_32x32x16_bf16 v[72:87], v[20:23], v[156:159], v[72:87]
    v_mul_f32 v116, v116, v100
    v_mul_f32 v117, v117, v101
    v_mul_f32 v118, v118, v102
    v_mul_f32 v119, v119, v103
    v_cvt_pk_bf16_f32 v88, v104, v105
    v_cvt_pk_bf16_f32 v89, v106, v107
    v_mfma_f32_32x32x16_bf16 v[72:87], v[24:27], v[160:163], v[72:87]
    v_cvt_pk_bf16_f32 v90, v108, v109
    v_cvt_pk_bf16_f32 v91, v110, v111
    v_cvt_pk_bf16_f32 v92, v112, v113
    v_cvt_pk_bf16_f32 v93, v114, v115
    v_cvt_pk_bf16_f32 v94, v116, v117
    v_cvt_pk_bf16_f32 v95, v118, v119
    v_mfma_f32_32x32x16_bf16 v[72:87], v[28:31], v[164:167], v[72:87]
    v_rcp_f32 v120, v120
    v_rcp_f32 v121, v121
    v_rcp_f32 v122, v122
    v_rcp_f32 v123, v123
    v_rcp_f32 v124, v124
    v_rcp_f32 v125, v125
    v_mfma_f32_32x32x16_bf16 v[188:203], v[88:91], v[64:67], v[188:203]
    v_rcp_f32 v126, v126
    v_rcp_f32 v127, v127
    v_rcp_f32 v128, v128
    v_rcp_f32 v129, v129
    v_rcp_f32 v130, v130
    v_mfma_f32_32x32x16_bf16 v[188:203], v[92:95], v[68:71], v[188:203]
    v_rcp_f32 v131, v131
    v_rcp_f32 v132, v132
    v_rcp_f32 v133, v133
    v_rcp_f32 v134, v134
    v_rcp_f32 v135, v135
    v_mul_f32 v136, v136, v120
    v_mul_f32 v137, v137, v121
    v_mul_f32 v138, v138, v122
    v_mul_f32 v139, v139, v123
    v_mul_f32 v140, v140, v124
    v_mul_f32 v141, v141, v125
    v_mul_f32 v142, v142, v126
    v_mul_f32 v143, v143, v127
    v_mul_f32 v144, v144, v128
    v_mul_f32 v145, v145, v129
    v_mul_f32 v146, v146, v130
    v_mul_f32 v147, v147, v131
    v_mul_f32 v148, v148, v132
    v_mul_f32 v149, v149, v133
    v_mul_f32 v150, v150, v134
    v_mul_f32 v151, v151, v135
    v_cvt_pk_bf16_f32 v120, v136, v137
    v_cvt_pk_bf16_f32 v121, v138, v139
    v_cvt_pk_bf16_f32 v122, v140, v141
    v_cvt_pk_bf16_f32 v123, v142, v143
    v_cvt_pk_bf16_f32 v124, v144, v145
    v_cvt_pk_bf16_f32 v125, v146, v147
    v_cvt_pk_bf16_f32 v126, v148, v149
    v_cvt_pk_bf16_f32 v127, v150, v151
    v_mfma_f32_32x32x16_bf16 v[72:87], v[120:123], v[64:67], v[72:87]
    s_nop 0
    v_mfma_f32_32x32x16_bf16 v[72:87], v[124:127], v[68:71], v[72:87]
    v_max_f32 v188, v188, v32
    v_max_f32 v189, v189, v33
    v_max_f32 v190, v190, v34
    v_max_f32 v191, v191, v35
    v_max_f32 v192, v192, v36
    v_max_f32 v193, v193, v37
    v_max_f32 v194, v194, v38
    v_max_f32 v195, v195, v39
    v_cvt_pk_bf16_f32 v220, v188, v189
    v_cvt_pk_bf16_f32 v221, v190, v191
    v_cvt_pk_bf16_f32 v222, v192, v193
    v_cvt_pk_bf16_f32 v223, v194, v195
    ds_write_b128 v249, v[220:223] offset:0
    v_max_f32 v196, v196, v40
    v_max_f32 v197, v197, v41
    v_max_f32 v198, v198, v42
    v_max_f32 v199, v199, v43
    v_max_f32 v200, v200, v44
    v_max_f32 v201, v201, v45
    v_max_f32 v202, v202, v46
    v_max_f32 v203, v203, v47
    v_cvt_pk_bf16_f32 v224, v196, v197
    v_cvt_pk_bf16_f32 v225, v198, v199
    v_cvt_pk_bf16_f32 v226, v200, v201
    v_cvt_pk_bf16_f32 v227, v202, v203
    ds_write_b128 v249, v[224:227] offset:16
    v_max_f32 v72, v72, v48
    v_max_f32 v73, v73, v49
    v_max_f32 v74, v74, v50
    v_max_f32 v75, v75, v51
    v_max_f32 v76, v76, v52
    v_max_f32 v77, v77, v53
    v_max_f32 v78, v78, v54
    v_max_f32 v79, v79, v55
    v_cvt_pk_bf16_f32 v228, v72, v73
    v_cvt_pk_bf16_f32 v229, v74, v75
    v_cvt_pk_bf16_f32 v230, v76, v77
    v_cvt_pk_bf16_f32 v231, v78, v79
    ds_write_b128 v249, v[228:231] offset:32
    v_max_f32 v80, v80, v56
    v_max_f32 v81, v81, v57
    v_max_f32 v82, v82, v58
    v_max_f32 v83, v83, v59
    v_max_f32 v84, v84, v60
    v_max_f32 v85, v85, v61
    v_max_f32 v86, v86, v62
    v_max_f32 v87, v87, v63
    v_cvt_pk_bf16_f32 v232, v80, v81
    v_cvt_pk_bf16_f32 v233, v82, v83
    v_cvt_pk_bf16_f32 v234, v84, v85
    v_cvt_pk_bf16_f32 v235, v86, v87
    ds_write_b128 v249, v[232:235] offset:48
    ds_read_b128 v[152:155], v251 offset:0
    ds_read_b128 v[156:159], v251 offset:1152
    ds_read_b128 v[160:163], v251 offset:2304
    ds_read_b128 v[164:167], v251 offset:3456
    s_waitcnt lgkmcnt(3)
    buffer_store_dwordx4 v[152:155], v252, s[28:31], 0 offen offset:0 sc1
    s_waitcnt lgkmcnt(2)
    buffer_store_dwordx4 v[156:159], v252, s[28:31], 0 offen offset:1024 sc1
    s_waitcnt lgkmcnt(1)
    buffer_store_dwordx4 v[160:163], v252, s[28:31], 0 offen offset:2048 sc1
    s_waitcnt lgkmcnt(0)
    buffer_store_dwordx4 v[164:167], v252, s[28:31], 0 offen offset:3072 sc1
    s_add_u32 s10, s2, s7
    s_cmp_lg_u32 s10, 0
    s_cbranch_scc1 K2_NOEP
    v_mov_b32 v188, 24117248
    v_mov_b32 v189, s100
    buffer_store_dword v189, v188, s[24:27], 0 offen sc1
K2_NOEP:
K2_END:
    s_endpgm
K2_RETRY0:
    s_sub_u32 s101, s101, 1
    s_cbranch_scc1 K2_END
    s_waitcnt vmcnt(0)
    v_bitop3_b32 v188, v91, s36, v214 bitop3:0x28
    s_nop 1
    v_or_b32_dpp v188, v188, v188 quad_perm:[1,0,3,2] row_mask:0xf bank_mask:0xf
    s_nop 1
    v_or_b32_dpp v188, v188, v188 quad_perm:[2,3,0,1] row_mask:0xf bank_mask:0xf
    s_nop 1
    v_or_b32_dpp v188, v188, v188 row_half_mirror row_mask:0xf bank_mask:0xf
    v_cmp_ne_u32 vcc, 0, v188
    s_and_b64 exec, exec, vcc
    s_cbranch_execz K2_RT00
    buffer_load_dwordx4 v[88:91], v189, s[32:35], 0 offen sc1
K2_RT00:
    s_mov_b64 exec, -1
    v_bitop3_b32 v188, v95, s36, v214 bitop3:0x28
    s_nop 1
    v_or_b32_dpp v188, v188, v188 quad_perm:[1,0,3,2] row_mask:0xf bank_mask:0xf
    s_nop 1
    v_or_b32_dpp v188, v188, v188 quad_perm:[2,3,0,1] row_mask:0xf bank_mask:0xf
    s_nop 1
    v_or_b32_dpp v188, v188, v188 row_half_mirror row_mask:0xf bank_mask:0xf
    v_cmp_ne_u32 vcc, 0, v188
    s_and_b64 exec, exec, vcc
    s_cbranch_execz K2_RT01
    buffer_load_dwordx4 v[92:95], v189, s[32:35], s79 offen sc1
K2_RT01:
    s_mov_b64 exec, -1
    v_bitop3_b32 v188, v99, s36, v214 bitop3:0x28
    s_nop 1
    v_or_b32_dpp v188, v188, v188 quad_perm:[1,0,3,2] row_mask:0xf bank_mask:0xf
    s_nop 1
    v_or_b32_dpp v188, v188, v188 quad_perm:[2,3,0,1] row_mask:0xf bank_mask:0xf
    s_nop 1
    v_or_b32_dpp v188, v188, v188 row_half_mirror row_mask:0xf bank_mask:0xf
    v_cmp_ne_u32 vcc, 0, v188
    s_and_b64 exec, exec, vcc
    s_cbranch_execz K2_RT02
    buffer_load_dwordx4 v[96:99], v189, s[32:35], s80 offen sc1
K2_RT02:
    s_mov_b64 exec, -1
    v_bitop3_b32 v188, v103, s36, v214 bitop3:0x28
    s_nop 1
    v_or_b32_dpp v188, v188, v188 quad_perm:[1,0,3,2] row_mask:0xf bank_mask:0xf
    s_nop 1
    v_or_b32_dpp v188, v188, v188 quad_perm:[2,3,0,1] row_mask:0xf bank_mask:0xf
    s_nop 1
    v_or_b32_dpp v188, v188, v188 row_half_mirror row_mask:0xf bank_mask:0xf
    v_cmp_ne_u32 vcc, 0, v188
    s_and_b64 exec, exec, vcc
    s_cbranch_execz K2_RT03
    buffer_load_dwordx4 v[100:103], v189, s[32:35], s81 offen sc1
K2_RT03:
    s_mov_b64 exec, -1
    s_waitcnt vmcnt(0)
    s_branch K2_CHK0
K2_RETRY1:
    s_sub_u32 s101, s101, 1
    s_cbranch_scc1 K2_END
    s_waitcnt vmcnt(0)
    v_bitop3_b32 v188, v95, s36, v214 bitop3:0x28
    s_nop 1
    v_or_b32_dpp v188, v188, v188 quad_perm:[1,0,3,2] row_mask:0xf bank_mask:0xf
    s_nop 1
    v_or_b32_dpp v188, v188, v188 quad_perm:[2,3,0,1] row_mask:0xf bank_mask:0xf
    s_nop 1
    v_or_b32_dpp v188, v188, v188 row_half_mirror row_mask:0xf bank_mask:0xf
    v_cmp_ne_u32 vcc, 0, v188
    s_and_b64 exec, exec, vcc
    s_cbranch_execz K2_RT11
    buffer_load_dwordx4 v[92:95], v189, s[32:35], s79 offen sc1
K2_RT11:
    s_mov_b64 exec, -1
    v_bitop3_b32 v188, v99, s36, v214 bitop3:0x28
    s_nop 1
    v_or_b32_dpp v188, v188, v188 quad_perm:[1,0,3,2] row_mask:0xf bank_mask:0xf
    s_nop 1
    v_or_b32_dpp v188, v188, v188 quad_perm:[2,3,0,1] row_mask:0xf bank_mask:0xf
    s_nop 1
    v_or_b32_dpp v188, v188, v188 row_half_mirror row_mask:0xf bank_mask:0xf
    v_cmp_ne_u32 vcc, 0, v188
    s_and_b64 exec, exec, vcc
    s_cbranch_execz K2_RT12
    buffer_load_dwordx4 v[96:99], v189, s[32:35], s80 offen sc1
K2_RT12:
    s_mov_b64 exec, -1
    v_bitop3_b32 v188, v103, s36, v214 bitop3:0x28
    s_nop 1
    v_or_b32_dpp v188, v188, v188 quad_perm:[1,0,3,2] row_mask:0xf bank_mask:0xf
    s_nop 1
    v_or_b32_dpp v188, v188, v188 quad_perm:[2,3,0,1] row_mask:0xf bank_mask:0xf
    s_nop 1
    v_or_b32_dpp v188, v188, v188 row_half_mirror row_mask:0xf bank_mask:0xf
    v_cmp_ne_u32 vcc, 0, v188
    s_and_b64 exec, exec, vcc
    s_cbranch_execz K2_RT13
    buffer_load_dwordx4 v[100:103], v189, s[32:35], s81 offen sc1
K2_RT13:
    s_mov_b64 exec, -1
    s_waitcnt vmcnt(0)
    s_branch K2_CHK1
K2_RETRY2:
    s_sub_u32 s101, s101, 1
    s_cbranch_scc1 K2_END
    s_waitcnt vmcnt(0)
    v_bitop3_b32 v188, v99, s36, v214 bitop3:0x28
    s_nop 1
    v_or_b32_dpp v188, v188, v188 quad_perm:[1,0,3,2] row_mask:0xf bank_mask:0xf
    s_nop 1
    v_or_b32_dpp v188, v188, v188 quad_perm:[2,3,0,1] row_mask:0xf bank_mask:0xf
    s_nop 1
    v_or_b32_dpp v188, v188, v188 row_half_mirror row_mask:0xf bank_mask:0xf
    v_cmp_ne_u32 vcc, 0, v188
    s_and_b64 exec, exec, vcc
    s_cbranch_execz K2_RT22
    buffer_load_dwordx4 v[96:99], v189, s[32:35], s80 offen sc1
K2_RT22:
    s_mov_b64 exec, -1
    v_bitop3_b32 v188, v103, s36, v214 bitop3:0x28
    s_nop 1
    v_or_b32_dpp v188, v188, v188 quad_perm:[1,0,3,2] row_mask:0xf bank_mask:0xf
    s_nop 1
    v_or_b32_dpp v188, v188, v188 quad_perm:[2,3,0,1] row_mask:0xf bank_mask:0xf
    s_nop 1
    v_or_b32_dpp v188, v188, v188 row_half_mirror row_mask:0xf bank_mask:0xf
    v_cmp_ne_u32 vcc, 0, v188
    s_and_b64 exec, exec, vcc
    s_cbranch_execz K2_RT23
    buffer_load_dwordx4 v[100:103], v189, s[32:35], s81 offen sc1
K2_RT23:
    s_mov_b64 exec, -1
    s_waitcnt vmcnt(0)
    s_branch K2_CHK2
K2_RETRY3:
    s_sub_u32 s101, s101, 1
    s_cbranch_scc1 K2_END
    s_waitcnt vmcnt(0)
    v_bitop3_b32 v188, v103, s36, v214 bitop3:0x28
    s_nop 1
    v_or_b32_dpp v188, v188, v188 quad_perm:[1,0,3,2] row_mask:0xf bank_mask:0xf
    s_nop 1
    v_or_b32_dpp v188, v188, v188 quad_perm:[2,3,0,1] row_mask:0xf bank_mask:0xf
    s_nop 1
    v_or_b32_dpp v188, v188, v188 row_half_mirror row_mask:0xf bank_mask:0xf
    v_cmp_ne_u32 vcc, 0, v188
    s_and_b64 exec, exec, vcc
    s_cbranch_execz K2_RT33
    buffer_load_dwordx4 v[100:103], v189, s[32:35], s81 offen sc1
K2_RT33:
    s_mov_b64 exec, -1
    s_waitcnt vmcnt(0)
    s_branch K2_CHK3
K1_EXT:
    s_mov_b32 s14, 0x0f0f0f0f
    s_mov_b32 s15, s14
    ds_read_b32 v104, v6 offset:32
    ds_read_b128 v[8:11], v3 offset:128
    ds_read_b32 v105, v6 offset:3360
    ds_read_b128 v[16:19], v3 offset:13440
    ds_read_b32 v106, v6 offset:6688
    ds_read_b128 v[24:27], v3 offset:26752
    ds_read_b32 v107, v6 offset:10016
    ds_read_b128 v[32:35], v3 offset:40064
    s_waitcnt lgkmcnt(0)
    v_cmp_le_u32 vcc, 553648128, v108
    v_and_or_b32 v11, v104, v15, v108
    s_and_b64 exec, vcc, s[14:15]
    s_cbranch_execz K1_EX0
    buffer_store_dwordx4 v[8:11], v4, s[32:35], s10 offen sc1
K1_EX0:
    s_mov_b64 exec, -1
    s_add_u32 s10, s10, 2105344
    v_cmp_le_u32 vcc, 553648128, v109
    v_and_or_b32 v19, v105, v15, v109
    s_and_b64 exec, vcc, s[14:15]
    s_cbranch_execz K1_EX1
    buffer_store_dwordx4 v[16:19], v4, s[32:35], s10 offen sc1
K1_EX1:
    s_mov_b64 exec, -1
    s_add_u32 s10, s10, 2105344
    v_cmp_le_u32 vcc, 553648128, v110
    v_and_or_b32 v27, v106, v15, v110
    s_and_b64 exec, vcc, s[14:15]
    s_cbranch_execz K1_EX2
    buffer_store_dwordx4 v[24:27], v4, s[32:35], s10 offen sc1
K1_EX2:
    s_mov_b64 exec, -1
    s_add_u32 s10, s10, 2105344
    v_cmp_le_u32 vcc, 553648128, v111
    v_and_or_b32 v35, v107, v15, v111
    s_and_b64 exec, vcc, s[14:15]
    s_cbranch_execz K1_EX3
    buffer_store_dwordx4 v[32:35], v4, s[32:35], s10 offen sc1
K1_EX3:
    s_mov_b64 exec, -1
    s_add_u32 s10, s10, 2105344
    s_branch K1_EXTR
K1_OVF:
    v_lshrrev_b32 v72, 16, v112
    v_lshrrev_b32 v76, 18, v112
    v_sub_u32 v72, v72, v76
    v_lshrrev_b32 v73, 16, v113
    v_lshrrev_b32 v76, 18, v113
    v_sub_u32 v73, v73, v76
    v_lshrrev_b32 v74, 16, v114
    v_lshrrev_b32 v76, 18, v114
    v_sub_u32 v74, v74, v76
    v_lshrrev_b32 v75, 16, v115
    v_lshrrev_b32 v76, 18, v115
    v_sub_u32 v75, v75, v76
    v_add_u32 v77, v72, v73
    v_add_u32 v78, v77, v74
    v_add_u32 v79, v78, v75
    v_mov_b32 v1, v79
    s_nop 1
    v_add_u32_dpp v1, v1, v1 row_shr:1 row_mask:0xf bank_mask:0xf bound_ctrl:0
    s_nop 1
    v_add_u32_dpp v1, v1, v1 row_shr:2 row_mask:0xf bank_mask:0xf bound_ctrl:0
    s_nop 1
    v_add_u32_dpp v1, v1, v1 row_shr:4 row_mask:0xf bank_mask:0xf bound_ctrl:0
    s_nop 1
    v_add_u32_dpp v1, v1, v1 row_shr:8 row_mask:0xf bank_mask:0xf bound_ctrl:0
    s_nop 1
    v_add_u32_dpp v1, v1, v1 row_bcast:15 row_mask:0xa bank_mask:0xf
    s_nop 1
    v_add_u32_dpp v1, v1, v1 row_bcast:31 row_mask:0xc bank_mask:0xf
    s_nop 0
    v_sub_u32 v76, v1, v79
    v_add_u32 v79, v76, v78
    v_add_u32 v78, v76, v77
    v_add_u32 v77, v76, v72
    v_lshl_or_b32 v76, v72, 16, v76
    v_lshl_or_b32 v77, v73, 16, v77
    v_lshl_or_b32 v78, v74, 16, v78
    v_lshl_or_b32 v79, v75, 16, v79
    s_waitcnt lgkmcnt(0)
    ds_write_b128 v172, v[76:79] offset:52736
    v_min_u32 v108, 255, v108
    v_min_u32 v109, 255, v109
    v_min_u32 v110, 255, v110
    v_min_u32 v111, 255, v111
    s_lshl_b32 s15, s12, 2
    s_add_u32 s15, s15, 23068672
    s_add_u32 s64, s8, s15
    s_addc_u32 s65, s9, 0
    s_mov_b32 s66, 262144
    s_mov_b32 s67, 0x20000
    v_lshlrev_b32 v1, 12, v254
    buffer_store_dword v76, v1, s[64:67], 0 offen offset:0 sc1
    buffer_store_dword v77, v1, s[64:67], 0 offen offset:1024 sc1
    buffer_store_dword v78, v1, s[64:67], 0 offen offset:2048 sc1
    buffer_store_dword v79, v1, s[64:67], 0 offen offset:3072 sc1
    s_add_u32 s15, s13, 17825792
    s_add_u32 s64, s8, s15
    s_addc_u32 s65, s9, 0
    s_mov_b32 s66, 12500
    s_mov_b32 s67, 0x20000
    s_lshr_b32 s15, s13, 2
    s_add_u32 s15, s15, 22020096
    s_add_u32 s68, s8, s15
    s_addc_u32 s69, s9, 0
    s_mov_b32 s70, 3125
    s_mov_b32 s71, 0x20000
    v_cndmask_b32 v30, v24, v30, s[78:79]
    v_cndmask_b32 v38, 0, v38, s[78:79]
    ds_read_u16 v40, v24 offset:50736
    ds_read_u16 v41, v25 offset:50736
    ds_read_u16 v42, v26 offset:50736
    ds_read_u16 v43, v27 offset:50736
    ds_read_u16 v44, v28 offset:50736
    ds_read_u16 v45, v29 offset:50736
    ds_read_u16 v46, v30 offset:50736
    s_waitcnt lgkmcnt(0)
    v_lshrrev_b32 v1, 2, v32
    v_sub_u32 v1, v32, v1
    v_add_u32 v40, v40, v1
    v_cmp_le_u32 vcc, 48, v32
    v_lshlrev_b32 v48, 2, v40
    s_and_saveexec_b64 s[14:15], vcc
    s_cbranch_execz K1_OV3_0
    buffer_store_byte v23, v40, s[68:71], 0 offen sc1
    buffer_store_dword v16, v48, s[64:67], 0 offen sc1
K1_OV3_0:
    s_mov_b64 exec, -1
    v_lshrrev_b32 v1, 2, v33
    v_sub_u32 v1, v33, v1
    v_add_u32 v41, v41, v1
    v_cmp_le_u32 vcc, 48, v33
    v_lshlrev_b32 v49, 2, v41
    s_and_saveexec_b64 s[14:15], vcc
    s_cbranch_execz K1_OV3_1
    buffer_store_byte v23, v41, s[68:71], 0 offen sc1
    buffer_store_dword v17, v49, s[64:67], 0 offen sc1
K1_OV3_1:
    s_mov_b64 exec, -1
    v_lshrrev_b32 v1, 2, v34
    v_sub_u32 v1, v34, v1
    v_add_u32 v42, v42, v1
    v_cmp_le_u32 vcc, 48, v34
    v_lshlrev_b32 v50, 2, v42
    s_and_saveexec_b64 s[14:15], vcc
    s_cbranch_execz K1_OV3_2
    buffer_store_byte v23, v42, s[68:71], 0 offen sc1
    buffer_store_dword v18, v50, s[64:67], 0 offen sc1
K1_OV3_2:
    s_mov_b64 exec, -1
    v_lshrrev_b32 v1, 2, v35
    v_sub_u32 v1, v35, v1
    v_add_u32 v43, v43, v1
    v_cmp_le_u32 vcc, 48, v35
    v_lshlrev_b32 v51, 2, v43
    s_and_saveexec_b64 s[14:15], vcc
    s_cbranch_execz K1_OV3_3
    buffer_store_byte v23, v43, s[68:71], 0 offen sc1
    buffer_store_dword v19, v51, s[64:67], 0 offen sc1
K1_OV3_3:
    s_mov_b64 exec, -1
    v_lshrrev_b32 v1, 2, v36
    v_sub_u32 v1, v36, v1
    v_add_u32 v44, v44, v1
    v_cmp_le_u32 vcc, 48, v36
    v_lshlrev_b32 v52, 2, v44
    s_and_saveexec_b64 s[14:15], vcc
    s_cbranch_execz K1_OV3_4
    buffer_store_byte v31, v44, s[68:71], 0 offen sc1
    buffer_store_dword v20, v52, s[64:67], 0 offen sc1
K1_OV3_4:
    s_mov_b64 exec, -1
    v_lshrrev_b32 v1, 2, v37
    v_sub_u32 v1, v37, v1
    v_add_u32 v45, v45, v1
    v_cmp_le_u32 vcc, 48, v37
    v_lshlrev_b32 v53, 2, v45
    s_and_saveexec_b64 s[14:15], vcc
    s_cbranch_execz K1_OV3_5
    buffer_store_byte v31, v45, s[68:71], 0 offen sc1
    buffer_store_dword v21, v53, s[64:67], 0 offen sc1
K1_OV3_5:
    s_mov_b64 exec, -1
    v_lshrrev_b32 v1, 2, v38
    v_sub_u32 v1, v38, v1
    v_add_u32 v46, v46, v1
    v_cmp_le_u32 vcc, 48, v38
    v_lshlrev_b32 v54, 2, v46
    s_and_saveexec_b64 s[14:15], vcc
    s_cbranch_execz K1_OV3_6
    buffer_store_byte v39, v46, s[68:71], 0 offen sc1
    buffer_store_dword v22, v54, s[64:67], 0 offen sc1
K1_OV3_6:
    s_mov_b64 exec, -1
    s_waitcnt vmcnt(0)
    s_barrier
    s_branch K1_OUT
K2_XT1:
    s_mov_b32 s97, 1
    v_cmp_le_u32 vcc, 822083584, v188
    v_mov_b32 v166, 2180
    s_cbranch_vccz K2_XT1A
    ds_write_b32 v166, v171
K2_XT1A:
    s_mov_b32 s10, 0xf0f0f0f0
    s_mov_b32 s11, s10
    v_and_b32 v166, 12, v168
    v_add_u32 v166, 32, v166
    v_and_b32 v164, 64, v189
    v_mul_u32_u24 v164, 127, v164
    v_add_u32 v164, v164, v189
    v_add_u32 v165, 16384, v164
    v_mov_b32 v167, 0x7ffffff0
    v_cndmask_b32 v204, v91, v95, s[10:11]
    v_cndmask_b32 v206, v208, v209, s[10:11]
    v_cmp_le_u32 vcc, 553648128, v204
    v_sub_u32_sdwa v204, v204, v166 dst_sel:DWORD dst_unused:UNUSED_PAD src0_sel:BYTE_3 src1_sel:DWORD
    s_nop 0
    v_cndmask_b32 v164, v167, v164, vcc
    v_cndmask_b32 v205, v99, v103, s[10:11]
    v_cndmask_b32 v207, v210, v211, s[10:11]
    v_cmp_le_u32 vcc, 553648128, v205
    v_sub_u32_sdwa v205, v205, v166 dst_sel:DWORD dst_unused:UNUSED_PAD src0_sel:BYTE_3 src1_sel:DWORD
    s_nop 0
    v_cndmask_b32 v165, v167, v165, vcc
    s_add_u32 s32, s32, 8421376
    s_addc_u32 s33, s33, 0
    buffer_load_dwordx4 v[132:135], v164, s[32:35], 0 offen sc1
    buffer_load_dwordx4 v[136:139], v165, s[32:35], 0 offen sc1
    v_med3_i32 v166, v204, 0, 3
    v_med3_i32 v167, v205, 0, 3
    v_add_u32 v166, v166, v167
    v_mov_b32 v167, 2176
    v_cmpx_lt_u32 vcc, 0, v166
    ds_add_u32 v167, v166
    s_mov_b64 exec, -1
    s_branch K2_XT1R
K2_XT2:
K2_XVa:
    s_mov_b64 s[10:11], 0
    v_bitop3_b32 v166, v135, s36, v214 bitop3:0x28
    v_cmp_ne_u32 s[86:87], 0, v166
    v_cmp_gt_u32 vcc, 0x7ffffff0, v164
    s_and_b64 vcc, vcc, s[86:87]
    s_or_b64 s[10:11], s[10:11], vcc
    v_bitop3_b32 v166, v139, s36, v214 bitop3:0x28
    v_cmp_ne_u32 s[86:87], 0, v166
    v_cmp_gt_u32 vcc, 0x7ffffff0, v165
    s_and_b64 vcc, vcc, s[86:87]
    s_or_b64 s[10:11], s[10:11], vcc
    s_cbranch_scc0 K2_XWa
    s_sub_u32 s101, s101, 1
    s_cbranch_scc1 K2_END
    buffer_load_dwordx4 v[132:135], v164, s[32:35], 0 offen sc1
    buffer_load_dwordx4 v[136:139], v165, s[32:35], 0 offen sc1
    s_waitcnt vmcnt(0)
    s_branch K2_XVa
K2_XWa:
    v_and_b32 v140, 255, v132
    v_lshlrev_b32 v140, 2, v140
    ds_read_b32 v140, v140 offset:6400
    v_and_b32 v141, 255, v133
    v_lshlrev_b32 v141, 2, v141
    ds_read_b32 v141, v141 offset:6400
    v_and_b32 v142, 255, v134
    v_lshlrev_b32 v142, 2, v142
    ds_read_b32 v142, v142 offset:6400
    v_and_b32 v135, 0x0f0f0f, v135
    v_and_b32 v143, 255, v136
    v_lshlrev_b32 v143, 2, v143
    ds_read_b32 v143, v143 offset:6400
    v_and_b32 v144, 255, v137
    v_lshlrev_b32 v144, 2, v144
    ds_read_b32 v144, v144 offset:6400
    v_and_b32 v145, 255, v138
    v_lshlrev_b32 v145, 2, v145
    ds_read_b32 v145, v145 offset:6400
    v_and_b32 v139, 0x0f0f0f, v139
    s_waitcnt lgkmcnt(0)
    v_perm_b32 v146, v135, v132, s64
    v_lshl_add_u32 v146, v146, 5, v206
    v_cmpx_lt_i32 vcc, 0, v204
    ds_add_rtn_u32 v140, v140, v171 offset:2112
    s_mov_b64 exec, -1
    v_perm_b32 v147, v135, v133, s65
    v_lshl_add_u32 v147, v147, 5, v206
    v_cmpx_lt_i32 vcc, 1, v204
    ds_add_rtn_u32 v141, v141, v171 offset:2112
    s_mov_b64 exec, -1
    v_perm_b32 v148, v135, v134, s66
    v_lshl_add_u32 v148, v148, 5, v206
    v_cmpx_lt_i32 vcc, 2, v204
    ds_add_rtn_u32 v142, v142, v171 offset:2112
    s_mov_b64 exec, -1
    v_perm_b32 v149, v139, v136, s64
    v_lshl_add_u32 v149, v149, 5, v207
    v_cmpx_lt_i32 vcc, 0, v205
    ds_add_rtn_u32 v143, v143, v171 offset:2112
    s_mov_b64 exec, -1
    v_perm_b32 v150, v139, v137, s65
    v_lshl_add_u32 v150, v150, 5, v207
    v_cmpx_lt_i32 vcc, 1, v205
    ds_add_rtn_u32 v144, v144, v171 offset:2112
    s_mov_b64 exec, -1
    v_perm_b32 v151, v139, v138, s66
    v_lshl_add_u32 v151, v151, 5, v207
    v_cmpx_lt_i32 vcc, 2, v205
    ds_add_rtn_u32 v145, v145, v171 offset:2112
    s_mov_b64 exec, -1
    s_waitcnt lgkmcnt(0)
    v_cmpx_lt_i32 vcc, 0, v204
    ds_write2st64_b32 v140, v132, v146 offset0:0 offset1:84
    s_mov_b64 exec, -1
    v_cmpx_lt_i32 vcc, 1, v204
    ds_write2st64_b32 v141, v133, v147 offset0:0 offset1:84
    s_mov_b64 exec, -1
    v_cmpx_lt_i32 vcc, 2, v204
    ds_write2st64_b32 v142, v134, v148 offset0:0 offset1:84
    s_mov_b64 exec, -1
    v_cmpx_lt_i32 vcc, 0, v205
    ds_write2st64_b32 v143, v136, v149 offset0:0 offset1:84
    s_mov_b64 exec, -1
    v_cmpx_lt_i32 vcc, 1, v205
    ds_write2st64_b32 v144, v137, v150 offset0:0 offset1:84
    s_mov_b64 exec, -1
    v_cmpx_lt_i32 vcc, 2, v205
    ds_write2st64_b32 v145, v138, v151 offset0:0 offset1:84
    s_mov_b64 exec, -1
    s_waitcnt lgkmcnt(0)
    s_branch K2_XT2R
K2_OVF:
    s_mov_b32 s80, 1
    s_mov_b32 s83, 0
    s_mov_b32 s77, 0
    s_mov_b32 s15, s76
    v_mov_b32 v190, 0xffff0000
    v_or_b32 v189, s39, v190
    v_mov_b32 v190, 0x7fffff00
    v_lshl_add_u32 v188, v254, 2, s15
    s_sub_u32 s73, s15, s76
    ds_write2st64_b32 v188, v189, v190 offset0:0 offset1:84
    ds_write2st64_b32 v188, v189, v190 offset0:1 offset1:85
    s_add_u32 s73, s73, 127
    s_lshr_b32 s73, s73, 7
    s_sub_i32 s38, s73, 1
    s_cmp_eq_u32 s97, 0
    s_cbranch_scc1 K2_PADS0
    s_mov_b32 s97, 0
    s_waitcnt vmcnt(0)
K2_XVb:
    s_mov_b64 s[10:11], 0
    v_bitop3_b32 v166, v135, s36, v214 bitop3:0x28
    v_cmp_ne_u32 s[86:87], 0, v166
    v_cmp_gt_u32 vcc, 0x7ffffff0, v164
    s_and_b64 vcc, vcc, s[86:87]
    s_or_b64 s[10:11], s[10:11], vcc
    v_bitop3_b32 v166, v139, s36, v214 bitop3:0x28
    v_cmp_ne_u32 s[86:87], 0, v166
    v_cmp_gt_u32 vcc, 0x7ffffff0, v165
    s_and_b64 vcc, vcc, s[86:87]
    s_or_b64 s[10:11], s[10:11], vcc
    s_cbranch_scc0 K2_XWb
    s_sub_u32 s101, s101, 1
    s_cbranch_scc1 K2_END
    buffer_load_dwordx4 v[132:135], v164, s[32:35], 0 offen sc1
    buffer_load_dwordx4 v[136:139], v165, s[32:35], 0 offen sc1
    s_waitcnt vmcnt(0)
    s_branch K2_XVb
K2_XWb:
    s_branch K2_PADS0
K2_SLOW:
    s_add_u32 s81, s81, 448
    s_cmp_lt_u32 s81, s82
    s_cbranch_scc1 K2_BATCH
K2_FIND:
    s_cmp_lg_u64 s[84:85], 0
    s_cbranch_scc1 K2_GOT
    s_add_u32 s79, s79, 1
    s_cmp_ge_u32 s79, 4
    s_cbranch_scc1 K2_EPI
    s_mul_i32 s10, s12, 32896
    s_lshl_b32 s11, s79, 13
    s_add_u32 s10, s10, s11
    v_lshlrev_b32 v252, 7, v254
    buffer_load_ubyte v252, v252, s[24:27], s10 offen offset:15 sc1
    s_waitcnt vmcnt(0)
    v_cmp_lt_u32 s[84:85], s77, v252
    s_nop 3
    s_branch K2_FIND
K2_GOT:
    s_ff1_i32_b64 s10, s[84:85]
    s_bitset0_b64 s[84:85], s10
    s_lshl_b32 s11, s79, 6
    s_add_u32 s80, s10, s11
    s_mul_i32 s10, s12, 32896
    s_lshl_b32 s11, s80, 7
    s_add_u32 s10, s10, s11
    s_lshl_b32 s11, s12, 8
    s_add_u32 s11, s11, s80
    s_lshl_b32 s11, s11, 2
    s_add_u32 s11, s11, 23068672
    v_mov_b32 v188, 0
    buffer_load_ubyte v189, v188, s[24:27], s10 offen offset:15 sc1
    buffer_load_dword v190, v188, s[24:27], s11 offen sc1
    s_waitcnt vmcnt(0)
    v_readfirstlane_b32 s10, v189
    v_readfirstlane_b32 s11, v190
    s_nop 3
    s_and_b32 s83, s11, 0xffff
    s_lshr_b32 s11, s11, 16
    s_lshr_b32 s82, s10, 2
    s_sub_u32 s82, s10, s82
    s_cmp_gt_u32 s10, 48
    s_cselect_b32 s82, s11, s82
    s_lshr_b32 s10, s77, 2
    s_sub_u32 s81, s77, s10
K2_BATCH:
    s_barrier
    v_and_b32 v188, 7, v254
    v_mul_u32_u24 v189, 2688, v188
    v_add_u32 v189, 9728, v189
    v_lshlrev_b32 v188, 2, v188
    ds_write_b32 v188, v189 offset:2112
    v_add_u32 v188, s81, v255
    s_mul_i32 s10, s12, 32896
    s_lshl_b32 s11, s80, 7
    s_add_u32 s10, s10, s11
    v_mul_u32_u24 v190, 87382, v188
    v_lshrrev_b32 v190, 16, v190
    v_lshl_add_u32 v189, v190, 2, s10
    v_add_u32 v191, 8421248, v189
    v_cmp_lt_u32 vcc, 31, v190
    s_mul_i32 s11, s80, 3125
    s_add_u32 s11, s11, s83
    v_cndmask_b32 v189, v189, v191, vcc
    v_or_b32 v191, 12, v189
    v_and_b32 v192, 3, v190
    v_add_u32 v191, v191, v192
    v_cmp_le_u32 vcc, 48, v190
    v_add_u32 v190, s11, v188
    v_add_u32 v192, 22020096, v190
    v_cndmask_b32 v191, v191, v192, vcc
    v_lshlrev_b32 v190, 2, v190
    v_add_u32 v190, 17825792, v190
    v_cndmask_b32 v189, v189, v190, vcc
    s_add_u32 s10, s81, 448
    s_min_u32 s10, s10, s82
    v_cmp_gt_u32 vcc, s10, v188
    v_mov_b32 v190, 0x7ffffff0
    s_mul_i32 s86, s80, 100000
    v_cndmask_b32 v189, v190, v189, vcc
    v_cndmask_b32 v191, v190, v191, vcc
    buffer_load_dword v189, v189, s[24:27], 0 offen sc1
    buffer_load_ubyte v191, v191, s[24:27], 0 offen sc1
    s_waitcnt lgkmcnt(0)
    s_barrier
    s_and_saveexec_b64 s[10:11], vcc
    s_waitcnt vmcnt(0)
    v_and_b32 v188, 255, v189
    v_lshlrev_b32 v188, 2, v188
    ds_read_b32 v188, v188 offset:6400
    v_bfe_u32 v190, v189, 8, 8
    v_and_b32 v191, 15, v191
    v_lshl_or_b32 v191, v191, 8, v190
    v_mov_b32 v190, 4
    v_lshl_add_u32 v191, v191, 5, s86
    s_waitcnt lgkmcnt(0)
    ds_add_rtn_u32 v188, v188, v190 offset:2112
    s_waitcnt lgkmcnt(0)
    ds_write2st64_b32 v188, v189, v191 offset0:0 offset1:84
    s_mov_b64 exec, -1
    s_waitcnt lgkmcnt(0)
    s_barrier
    s_lshl_b32 s10, s3, 2
    v_mov_b32 v188, s10
    ds_read_b32 v188, v188 offset:2112
    v_mov_b32 v180, 0
    v_mov_b32 v181, 0
    v_mov_b32 v182, 0
    v_mov_b32 v183, 0
    v_mov_b32 v184, 0
    v_mov_b32 v185, 0
    v_mov_b32 v186, 0
    v_mov_b32 v187, 0
    v_lshrrev_b32 v189, 3, v254
    v_lshl_add_u32 v247, v189, 4, s76
    v_and_b32 v189, 31, v254
    v_lshl_add_u32 v249, v189, 2, s76
    v_lshrrev_b32 v190, 1, v254
    v_lshl_add_u32 v251, v190, 2, s76
    v_add_u32 v251, 21504, v251
    v_and_b32 v189, 44, v254
    v_add_u32 v248, s76, v189
    s_waitcnt lgkmcnt(0)
    v_readfirstlane_b32 s15, v188
    s_nop 3
    v_mov_b32 v190, 0xffff0000
    v_or_b32 v189, s39, v190
    v_mov_b32 v190, 0x7fffff00
    v_lshl_add_u32 v188, v254, 2, s15
    s_sub_u32 s73, s15, s76
    ds_write2st64_b32 v188, v189, v190 offset0:0 offset1:84
    ds_write2st64_b32 v188, v189, v190 offset0:1 offset1:85
    s_add_u32 s73, s73, 127
    s_lshr_b32 s73, s73, 7
    s_sub_i32 s38, s73, 1
K2_LAST:
    s_branch K2_GO
.section .rodata,"a"
.p2align 6
.amdhsa_kernel standalone__edge_featured_mpnn_gatedgcn__graph_kernel
  .amdhsa_next_free_vgpr 256
  .amdhsa_next_free_sgpr 102
  .amdhsa_accum_offset 256
  .amdhsa_group_segment_fixed_size 0
  .amdhsa_kernarg_size 96
  .amdhsa_user_sgpr_count 2
  .amdhsa_user_sgpr_kernarg_segment_ptr 1
  .amdhsa_system_sgpr_workgroup_id_x 1
.end_amdhsa_kernel
```
